```python
import torch

def _softmax(x, axis=-1):
    return torch.softmax(x, dim=axis)
def _gelu(x):
    return torch.nn.functional.gelu(x, approximate="tanh")
def _silu(x):
    return torch.nn.functional.silu(x)
def _sigmoid(x):
    return torch.sigmoid(x)
def _layernorm(x, axis=-1, eps=1e-5):
    m = x.mean(dim=axis, keepdim=True)
    v = x.var(dim=axis, keepdim=True, unbiased=False)
    return (x - m) / torch.sqrt(v + eps)
def _scatter_add(tgt, idx, src, axis=0):
    return tgt.clone().index_add_(axis, idx, src)
def _segment_sum(src, seg, n):
    out = torch.zeros((n,) + src.shape[1:], dtype=src.dtype)
    return out.index_add_(0, seg, src)
def _pad(x, pw):
    flat = tuple(v for pair in reversed(pw) for v in pair)
    return torch.nn.functional.pad(x, flat)

kernel_name = 'recurrent_scan__ssm_conv_h3__mixer_token_mlp__prompt'

def setup_inputs():

    _w = (lambda a: (lambda t: t.to(torch.bfloat16) if t.is_floating_point() else t)(torch.as_tensor(a)))
    def _A_setup():
        B, S, D = 1, 2048, 576
        ks = 4
        return {
            "q": _w((lambda *s: torch.randn(*s, dtype=torch.bfloat16) * 0.05)(B, S, D)),
            "k": _w((lambda *s: torch.randn(*s, dtype=torch.bfloat16) * 0.8)(B, S, D)),
            "v": _w((lambda *s: torch.randn(*s, dtype=torch.bfloat16) * 0.8)(B, S, D)),
            "shift_k": _w((lambda *s: torch.randn(*s, dtype=torch.bfloat16) * 0.8)(D, ks) * 0.5),
            "ssm_k": _w((lambda *s: torch.randn(*s, dtype=torch.bfloat16) * 0.8)(D, S) * (1.0 / S ** 0.5)),
            "ssm_D": _w((lambda *s: torch.randn(*s, dtype=torch.bfloat16) * 0.8)(D)),
        }
    _A_in = _A_setup()

    def _B_setup():
        B, S, D, F = 1, 2048, 576, 4608
        return {
            "x": _w((lambda *s: torch.randn(*s, dtype=torch.bfloat16) * 0.05)(B, S, D)),
            "w1": _w((lambda *s: torch.randn(*s, dtype=torch.bfloat16) * 0.8)(S, F) * (S ** -0.5)),
            "b1": _w((lambda *s: torch.randn(*s, dtype=torch.bfloat16) * 12.8)(F) * 0.02),
            "w2": _w((lambda *s: torch.randn(*s, dtype=torch.bfloat16) * 0.2)(F, S) * (F ** -0.5)),
            "b2": _w((lambda *s: torch.randn(*s, dtype=torch.bfloat16) * 3.2)(S) * 0.02),
        }
    _B_in = _B_setup()

    return {
        "A_q": _A_in["q"],
        "A_k": _A_in["k"],
        "A_v": _A_in["v"],
        "A_shift_k": _A_in["shift_k"],
        "A_ssm_k": _A_in["ssm_k"],
        "A_ssm_D": _A_in["ssm_D"],
        "B_x": _B_in["x"],
        "B_w1": _B_in["w1"],
        "B_b1": _B_in["b1"],
        "B_w2": _B_in["w2"],
        "B_b2": _B_in["b2"],
    }

def reference(A_q, A_k, A_v, A_shift_k, A_ssm_k, A_ssm_D, B_x, B_w1, B_b1, B_w2, B_b2):
    def _A_ref(q, k, v, shift_k, ssm_k, ssm_D):
        B, S, D = q.shape
        ks = shift_k.shape[-1]
        k_pad = _pad(k, ((0, 0), (ks - 1, 0), (0, 0)))
        k_shift = torch.zeros_like(k)
        for t in range(ks):
            k_shift = k_shift + k_pad[:, t:t + S, :] * shift_k[:, ks - 1 - t][None, None, :]
        kv = k_shift * v
        L = 2 * S
        kv_pad = _pad(kv, ((0, 0), (0, S), (0, 0)))
        kf_pad = _pad(ssm_k, ((0, 0), (0, S)))
        kv_f = (lambda x, axes=(-2,-1): torch.fft.rfft2(x.float(), dim=axes))(kv_pad[:, None, :, :], axes=(1, 2))
        kf_f = (lambda x, axes=(-2,-1): torch.fft.rfft2(x.float(), dim=axes))(kf_pad[:, None, :], axes=(1, 2))
        kf_f = (lambda x, *d: x.permute(*d))(kf_f, 1, 2, 0)
        y_f = kv_f * kf_f[None, :, :, :]
        y = (lambda x, s, axes=(-2,-1): torch.fft.irfft2(x, s=s, dim=axes).to(torch.bfloat16))(y_f, (1, L), axes=(1, 2))[:, 0, :S, :]
        y = y + kv * ssm_D[None, None, :]
        return q * y

    def _B_ref(x, w1, b1, w2, b2):
        B, S, D = x.shape
        h = _layernorm(x, axis=-1)
        u = torch.einsum("bsd,sf->bdf", h, w1) + b1
        u = _gelu(u)
        y = torch.einsum("bdf,fs->bds", u, w2) + b2
        return (lambda x, *d: x.permute(*d))(y, 0, 2, 1)

    x = A_q
    xn = _layernorm(x, axis=-1)
    s = _A_ref(xn, A_k, A_v, A_shift_k, A_ssm_k, A_ssm_D)
    g = _silu(_B_ref(xn, B_w1, B_b1, B_w2, B_b2))
    return x + s * g
```

```asm
; @launch grid=(256,1,1) block=(256,1,1) lds=163840
.amdgcn_target "amdgcn-amd-amdhsa--gfx950"
.text
.globl recurrent_scan__ssm_conv_h3__mixer_token_mlp__prompt_kernel
.p2align 8
.type recurrent_scan__ssm_conv_h3__mixer_token_mlp__prompt_kernel,@function
recurrent_scan__ssm_conv_h3__mixer_token_mlp__prompt_kernel:
    s_cmp_lt_u32 s2, 256
    s_cbranch_scc0 L_exit
    s_load_dwordx2 s[56:57], s[0:1], 0
    s_load_dwordx2 s[48:49], s[0:1], 8
    s_load_dwordx2 s[52:53], s[0:1], 16
    s_load_dwordx2 s[60:61], s[0:1], 24
    s_load_dwordx16 s[16:31], s[0:1], 0
    s_load_dwordx8 s[32:39], s[0:1], 64
    s_load_dwordx4 s[40:43], s[0:1], 96
    s_memrealtime s[12:13]
    v_lshrrev_b32 v1, 6, v0
    v_and_b32 v2, 63, v0
    s_getpc_b64 s[6:7]
L_pc:
    s_lshr_b32 s4, s2, 1
    s_and_b32 s4, s4, 124
    v_add_u32 v22, s4, v1
    v_lshl_add_u32 v22, v2, 7, v22
    v_lshlrev_b32 v22, 7, v22
    v_min_u32 v22, L_end-L_pc-4, v22
    s_mov_b64 exec, 15
    global_load_dword v255, v22, s[6:7]
    s_mov_b64 exec, -1
    v_readfirstlane_b32 s3, v1
    s_and_b32 s4, s2, 7
    s_lshr_b32 s5, s2, 3
    s_lshl_b32 s4, s4, 5
    s_add_u32 s68, s4, s5
    v_lshrrev_b32 v3, 5, v0
    v_and_b32 v4, 31, v0
    v_mul_u32_u24 v5, 1152, v3
    v_mad_u32_u24 v5, v4, 12, v5
    s_mul_i32 s15, s68, 9216
    s_mul_i32 s4, s3, 3072
    s_add_u32 s5, s4, s15
    s_sub_u32 s5, s5, 3456
    v_lshlrev_b32 v6, 4, v2
    v_add_u32 v7, s5, v6
    v_add_u32 v58, 1024, v7
    s_add_u32 s4, s4, 114688
    s_lshl_b32 s5, s3, 11
    s_add_u32 s11, s5, s15
    s_add_u32 s5, s5, 127360
    s_mov_b32 m0, s4
    s_mov_b32 s58, 2359296
    s_mov_b32 s59, 0x20000
    s_mov_b32 s50, 2359296
    s_mov_b32 s51, 0x20000
    s_mov_b32 s54, 2359296
    s_mov_b32 s55, 0x20000
    s_mov_b32 s62, 4608
    s_mov_b32 s63, 0x20000
    v_lshlrev_b32 v59, 3, v0
    s_movk_i32 s10, 4096
    s_waitcnt lgkmcnt(0)
    buffer_load_dwordx3 v[8:10], v5, s[56:59], s15 offen offset:0
    buffer_load_dwordx3 v[12:14], v5, s[56:59], s15 offen offset:384
    buffer_load_dwordx3 v[16:18], v5, s[56:59], s15 offen offset:768
    buffer_load_dwordx4 v7, s[48:51], 0 offen lds
    s_add_u32 m0, s4, 1024
    s_cmp_eq_u32 s3, 3
    buffer_load_dwordx4 v58, s[48:51], 0 offen lds
    buffer_load_dwordx4 v58, s[48:51], 0 offen offset:1024 lds
    s_cbranch_scc1 L_xld
L_nox:
    s_mov_b32 m0, s5
    buffer_load_dwordx2 v[98:99], v59, s[60:63], 0 offen
    buffer_load_dwordx4 v6, s[52:55], s11 offen lds
    buffer_load_dwordx4 v6, s[52:55], s11 offen offset:1024 lds
    buffer_load_dwordx2 v[100:101], v59, s[60:63], 0 offen offset:2048
    buffer_load_dwordx2 v[102:103], v59, s[60:63], s10 offen
    s_mov_b32 s64, s40
    s_and_b32 s65, s41, 0xffff
    s_mov_b32 s66, 256
    s_mov_b32 s67, 0x20000
    s_or_b32 s12, s12, 1
    v_or_b32 v22, s2, v0
    v_lshlrev_b32 v22, 8, v22
    v_mov_b32 v23, s12
    buffer_store_dword v23, v22, s[64:67], 0 offen sc1
    s_mov_b32 s44, s42
    s_and_b32 s45, s43, 0xffff
    s_mov_b32 s46, 40779776
    s_mov_b32 s47, 0x20000
    s_and_b32 s5, s2, 7
    s_lshr_b32 s6, s2, 3
    s_lshr_b32 s7, s6, 2
    s_lshr_b32 s13, s5, 1
    s_cmp_ge_u32 s7, 3
    s_addc_u32 s8, s7, 0
    s_cmp_eq_u32 s7, 7
    s_cselect_b32 s8, 3, s8
    s_lshl3_add_u32 s71, s13, s8
    s_and_b32 s7, s6, 3
    s_and_b32 s4, s5, 1
    s_lshl1_add_u32 s72, s7, s4
    s_add_u32 s7, s7, s13
    s_and_b32 s7, s7, 3
    s_mov_b32 s101, s7
    s_mul_i32 s7, s7, 9
    s_lshr_b32 s84, s7, 2
    s_lshl_b32 s73, s3, 12
    s_mov_b32 s52, s34
    s_and_b32 s53, s35, 0xffff
    s_mov_b32 s54, 18874368
    s_mov_b32 s55, 0x20000
    s_cmp_lt_u32 s6, 27
    s_cbranch_scc0 L_aux
    s_branch L_org
L_exit:
    s_endpgm
L_xld:
    s_mov_b64 exec, 0xffffff
    buffer_load_dwordx4 v58, s[48:51], 0 offen offset:2048 lds
    s_mov_b64 exec, -1
    s_mov_b32 m0, s5
    s_nop 0
    buffer_load_dwordx4 v6, s[52:55], s11 offen offset:2048 lds
    s_branch L_nox
L_nw_G:
    s_mov_b32 s5, 0
L_nl_G:
    buffer_load_dword v45, v44, s[64:67], 0 offen sc1
    s_waitcnt vmcnt(0)
    v_readfirstlane_b32 s68, v45
    s_nop 1
    s_cmp_lg_u32 s68, 0
    s_cbranch_scc1 L_ng_G
    s_add_u32 s5, s5, 1
    s_cmp_lt_u32 s5, 100000
    s_cbranch_scc1 L_nl_G
    s_branch L_ng_G
L_rs_p1G:
    s_mov_b32 s5, 0
L_rt_p1G:
    s_mov_b64 exec, vcc
    buffer_load_dword v29, v28, s[44:47], 0 offen sc1
    s_waitcnt vmcnt(0)
    v_cmp_ne_u32 vcc, s68, v29
    s_cbranch_vccz L_rx_p1G
    s_add_u32 s5, s5, 1
    s_cmp_lt_u32 s5, 100000
    s_cbranch_scc1 L_rt_p1G
L_rx_p1G:
    s_mov_b64 exec, -1
    s_branch L_ok_p1G
L_rs_p5:
    s_mov_b32 s5, 0
L_rt_p5:
    s_mov_b64 exec, vcc
    buffer_load_dword v29, v28, s[44:47], 0 offen sc1
    s_waitcnt vmcnt(0)
    v_cmp_ne_u32 vcc, s68, v29
    s_cbranch_vccz L_rx_p5
    s_add_u32 s5, s5, 1
    s_cmp_lt_u32 s5, 100000
    s_cbranch_scc1 L_rt_p5
L_rx_p5:
    s_mov_b64 exec, -1
    s_branch L_ok_p5
L_nw_X:
    s_mov_b32 s5, 0
L_nl_X:
    buffer_load_dword v45, v44, s[64:67], 0 offen sc1
    s_waitcnt vmcnt(0)
    v_readfirstlane_b32 s68, v45
    s_nop 1
    s_cmp_lg_u32 s68, 0
    s_cbranch_scc1 L_ng_X
    s_add_u32 s5, s5, 1
    s_cmp_lt_u32 s5, 100000
    s_cbranch_scc1 L_nl_X
    s_branch L_ng_X
L_rs_p1X:
    s_mov_b32 s5, 0
L_rt_p1X:
    s_mov_b64 exec, vcc
    buffer_load_dword v29, v28, s[44:47], 0 offen sc1
    s_waitcnt vmcnt(0)
    v_cmp_ne_u32 vcc, s68, v29
    s_cbranch_vccz L_rx_p1X
    s_add_u32 s5, s5, 1
    s_cmp_lt_u32 s5, 100000
    s_cbranch_scc1 L_rt_p1X
L_rx_p1X:
    s_mov_b64 exec, -1
    s_branch L_ok_p1X
L_rs_p4:
    s_mov_b32 s5, 0
L_rt_p4:
    s_mov_b64 exec, vcc
    buffer_load_dword v29, v28, s[44:47], 0 offen sc1
    s_waitcnt vmcnt(0)
    v_cmp_ne_u32 vcc, s68, v29
    s_cbranch_vccz L_rx_p4
    s_add_u32 s5, s5, 1
    s_cmp_lt_u32 s5, 100000
    s_cbranch_scc1 L_rt_p4
L_rx_p4:
    s_mov_b64 exec, -1
    s_branch L_ok_p4
L_rs_p3:
    s_mov_b32 s5, 0
L_rt_p3:
    s_mov_b64 exec, vcc
    buffer_load_dword v29, v28, s[44:47], 0 offen sc1
    s_waitcnt vmcnt(0)
    v_cmp_ne_u32 vcc, s68, v29
    s_cbranch_vccz L_rx_p3
    s_add_u32 s5, s5, 1
    s_cmp_lt_u32 s5, 100000
    s_cbranch_scc1 L_rt_p3
L_rx_p3:
    s_mov_b64 exec, -1
    s_branch L_ok_p3
L_rs_p2G:
    s_mov_b32 s5, 0
L_rt_p2G:
    s_mov_b64 exec, vcc
    buffer_load_dword v19, v18, s[44:47], 0 offen sc1
    s_waitcnt vmcnt(0)
    v_cmp_ne_u32 vcc, s68, v19
    s_cbranch_vccz L_rx_p2G
    s_add_u32 s5, s5, 1
    s_cmp_lt_u32 s5, 100000
    s_cbranch_scc1 L_rt_p2G
L_rx_p2G:
    s_mov_b64 exec, -1
    s_branch L_ok_p2G
L_rs_p2X:
    s_mov_b32 s5, 0
L_rt_p2X:
    s_mov_b64 exec, vcc
    buffer_load_dword v29, v28, s[44:47], 0 offen sc1
    s_waitcnt vmcnt(0)
    v_cmp_ne_u32 vcc, s68, v29
    s_cbranch_vccz L_rx_p2X
    s_add_u32 s5, s5, 1
    s_cmp_lt_u32 s5, 100000
    s_cbranch_scc1 L_rt_p2X
L_rx_p2X:
    s_mov_b64 exec, -1
    s_branch L_ok_p2X
L_wc_G:
    s_cmp_eq_u32 s3, 0
    s_cbranch_scc1 L_pl_G_0
    s_cmp_eq_u32 s3, 1
    s_cbranch_scc1 L_pl_G_1
    s_cmp_eq_u32 s3, 2
    s_cbranch_scc1 L_pl_G_2
    s_branch L_pl_G_3
L_wc_X:
    s_cmp_eq_u32 s3, 0
    s_cbranch_scc1 L_pl_X_0
    s_cmp_eq_u32 s3, 1
    s_cbranch_scc1 L_pl_X_1
    s_cmp_eq_u32 s3, 2
    s_cbranch_scc1 L_pl_X_2
    s_branch L_pl_X_3
L_wc_D:
    s_cmp_eq_u32 s3, 0
    s_cbranch_scc1 L_pl_D_0
    s_cmp_eq_u32 s3, 1
    s_cbranch_scc1 L_pl_D_1
    s_cmp_eq_u32 s3, 2
    s_cbranch_scc1 L_wret
    s_branch L_wret
L_wret:
    s_setpc_b64 s[82:83]
.p2align 12
L_org:
    s_mul_i32 s7, s6, 21846
    s_lshr_b32 s7, s7, 16
    s_mul_i32 s8, s7, 3
    s_sub_u32 s12, s6, s8
    s_mul_i32 s8, s13, 9
    s_add_u32 s69, s8, s7
    s_lshl1_add_u32 s70, s12, s4
    s_mul_i32 s8, s69, 6
    s_add_u32 s75, s8, s70
    s_mov_b32 s48, s30
    s_and_b32 s49, s31, 0xffff
    s_mov_b32 s50, 18874368
    s_mov_b32 s51, 0x20000
    s_add_u32 s12, s12, s7
    s_mul_i32 s8, s12, 21846
    s_lshr_b32 s8, s8, 16
    s_mul_i32 s8, s8, 3
    s_sub_u32 s12, s12, s8
    s_mul_i32 s4, s4, 1179648
    s_mul_i32 s7, s12, 65538
    s_lshr_b32 s7, s7, 16
    s_mul_i32 s7, s7, 73728
    s_add_u32 s5, s4, 0
    s_add_u32 s18, s7, s5
    s_add_u32 s8, s5, 221184
    s_add_u32 s19, s18, 73728
    s_cmp_eq_u32 s19, s8
    s_cselect_b32 s19, s5, s19
    s_add_u32 s20, s19, 73728
    s_cmp_eq_u32 s20, s8
    s_cselect_b32 s20, s5, s20
    s_mul_i32 s7, s12, 131076
    s_lshr_b32 s7, s7, 16
    s_mul_i32 s7, s7, 73728
    s_add_u32 s5, s4, 221184
    s_add_u32 s21, s7, s5
    s_add_u32 s8, s5, 442368
    s_add_u32 s22, s21, 73728
    s_cmp_eq_u32 s22, s8
    s_cselect_b32 s22, s5, s22
    s_add_u32 s23, s22, 73728
    s_cmp_eq_u32 s23, s8
    s_cselect_b32 s23, s5, s23
    s_add_u32 s24, s23, 73728
    s_cmp_eq_u32 s24, s8
    s_cselect_b32 s24, s5, s24
    s_add_u32 s25, s24, 73728
    s_cmp_eq_u32 s25, s8
    s_cselect_b32 s25, s5, s25
    s_add_u32 s26, s25, 73728
    s_cmp_eq_u32 s26, s8
    s_cselect_b32 s26, s5, s26
    s_mul_i32 s7, s12, 152922
    s_lshr_b32 s7, s7, 16
    s_mul_i32 s7, s7, 73728
    s_add_u32 s5, s4, 663552
    s_add_u32 s27, s7, s5
    s_add_u32 s8, s5, 516096
    s_add_u32 s76, s27, 73728
    s_cmp_eq_u32 s76, s8
    s_cselect_b32 s76, s5, s76
    s_add_u32 s77, s76, 73728
    s_cmp_eq_u32 s77, s8
    s_cselect_b32 s77, s5, s77
    s_add_u32 s78, s77, 73728
    s_cmp_eq_u32 s78, s8
    s_cselect_b32 s78, s5, s78
    s_add_u32 s79, s78, 73728
    s_cmp_eq_u32 s79, s8
    s_cselect_b32 s79, s5, s79
    s_add_u32 s80, s79, 73728
    s_cmp_eq_u32 s80, s8
    s_cselect_b32 s80, s5, s80
    s_add_u32 s81, s80, 73728
    s_cmp_eq_u32 s81, s8
    s_cselect_b32 s81, s5, s81
    v_lshrrev_b32 v24, 4, v2
    v_and_b32 v25, 15, v2
    v_lshlrev_b32 v26, 1, v24
    v_xor_b32 v25, v25, v26
    v_mul_u32_u24 v24, 9216, v24
    v_lshl_add_u32 v24, v25, 4, v24
    s_mul_i32 s7, s3, 147456
    s_lshl_b32 s8, s69, 8
    s_add_u32 s7, s7, s8
    v_add_u32 v148, s7, v24
    v_add_u32 v149, 35840, v148
    v_xor_b32 v24, 128, v148
    v_add_u32 v150, 71680, v24
    v_add_u32 v151, 35840, v150
    v_bfe_u32 v140, v2, 2, 2
    v_lshrrev_b32 v141, 4, v2
    v_lshl_add_u32 v142, v141, 3, v140
    v_lshlrev_b32 v142, 8, v142
    v_and_b32 v143, 3, v2
    v_lshl_add_u32 v142, v143, 3, v142
    v_and_b32 v141, 1, v141
    v_lshl_add_u32 v140, v141, 2, v140
    s_lshl_b32 s7, s3, 1
    v_xor_b32 v140, s7, v140
    v_lshl_add_u32 v152, v140, 5, v142
    v_xor_b32 v153, 32, v152
    v_add_u32 v154, 0x10000, v152
    v_add_u32 v155, 0x10000, v153
    v_and_b32 v24, 15, v2
    v_lshrrev_b32 v25, 4, v2
    v_mul_u32_u24 v26, 17408, v25
    v_lshl_add_u32 v26, v24, 4, v26
    v_mul_u32_u24 v25, 1536, v25
    v_lshl_add_u32 v25, v24, 4, v25
    v_add_u32 v159, 81920, v25
    v_add_u32 v250, 36864, v159
    s_mul_i32 s7, s3, 18432
    s_xor_b32 s8, s70, 1
    s_mul_i32 s8, s8, 1536
    s_add_u32 s7, s7, s8
    v_lshlrev_b32 v246, 4, v2
    v_add_u32 v156, s7, v246
    v_lshrrev_b32 v25, 5, v2
    v_mul_u32_u24 v25, 7680, v25
    v_add_u32 v157, v156, v25
    v_add_u32 v158, 7680, v156
    s_mul_i32 s74, s3, 3072
    s_add_u32 s74, s74, 81920
    v_mov_b32 v245, v26
    s_mov_b32 s9, 144896
    s_mov_b32 s11, 114688
    s_waitcnt vmcnt(9)
    v_and_b32 v21, 0xffff0000, v8
    s_add_u32 m0, s73, 81920
    s_lshl_b32 s14, s18, 3
    buffer_load_dwordx4 v148, s[48:51], s14 offen offset:0 lds
    v_lshlrev_b32 v20, 16, v8
    v_and_b32 v23, 0xffff0000, v9
    v_lshlrev_b32 v22, 16, v9
    v_and_b32 v25, 0xffff0000, v10
    v_lshlrev_b32 v24, 16, v10
    v_and_b32 v27, 0xffff0000, v12
    v_lshlrev_b32 v26, 16, v12
    v_and_b32 v29, 0xffff0000, v13
    v_lshlrev_b32 v28, 16, v13
    v_and_b32 v31, 0xffff0000, v14
    v_lshlrev_b32 v30, 16, v14
    v_and_b32 v33, 0xffff0000, v16
    v_lshlrev_b32 v32, 16, v16
    v_and_b32 v35, 0xffff0000, v17
    v_lshlrev_b32 v34, 16, v17
    v_and_b32 v37, 0xffff0000, v18
    v_lshlrev_b32 v36, 16, v18
    v_pk_add_f32 v[38:39], v[20:21], v[22:23]
    v_pk_add_f32 v[40:41], v[24:25], v[26:27]
    v_pk_add_f32 v[42:43], v[28:29], v[30:31]
    v_pk_add_f32 v[44:45], v[32:33], v[34:35]
    v_pk_add_f32 v[38:39], v[38:39], v[40:41]
    v_pk_add_f32 v[42:43], v[42:43], v[44:45]
    v_pk_add_f32 v[38:39], v[38:39], v[36:37]
    v_pk_add_f32 v[38:39], v[38:39], v[42:43]
    v_add_f32 v56, v38, v39
    buffer_load_dwordx4 v149, s[48:51], s14 offen offset:1024 lds
    s_nop 0
    v_add_f32_dpp v56, v56, v56 row_ror:8 row_mask:0xf bank_mask:0xf
    s_nop 1
    v_add_f32_dpp v56, v56, v56 row_ror:4 row_mask:0xf bank_mask:0xf
    s_nop 1
    v_add_f32_dpp v56, v56, v56 row_ror:2 row_mask:0xf bank_mask:0xf
    s_nop 1
    v_add_f32_dpp v56, v56, v56 row_ror:1 row_mask:0xf bank_mask:0xf
    v_mov_b32 v57, v56
    s_nop 1
    v_permlane16_swap_b32 v56, v57
    v_add_f32 v56, v56, v57
    v_mul_f32 v56, 0x3ae38e39, v56
    v_pk_add_f32 v[20:21], v[20:21], v[56:57] op_sel_hi:[1,0] neg_lo:[0,1] neg_hi:[0,1]
    v_pk_add_f32 v[22:23], v[22:23], v[56:57] op_sel_hi:[1,0] neg_lo:[0,1] neg_hi:[0,1]
    v_pk_add_f32 v[24:25], v[24:25], v[56:57] op_sel_hi:[1,0] neg_lo:[0,1] neg_hi:[0,1]
    v_pk_add_f32 v[26:27], v[26:27], v[56:57] op_sel_hi:[1,0] neg_lo:[0,1] neg_hi:[0,1]
    v_pk_add_f32 v[28:29], v[28:29], v[56:57] op_sel_hi:[1,0] neg_lo:[0,1] neg_hi:[0,1]
    v_pk_add_f32 v[30:31], v[30:31], v[56:57] op_sel_hi:[1,0] neg_lo:[0,1] neg_hi:[0,1]
    v_pk_add_f32 v[32:33], v[32:33], v[56:57] op_sel_hi:[1,0] neg_lo:[0,1] neg_hi:[0,1]
    v_pk_add_f32 v[34:35], v[34:35], v[56:57] op_sel_hi:[1,0] neg_lo:[0,1] neg_hi:[0,1]
    v_pk_add_f32 v[36:37], v[36:37], v[56:57] op_sel_hi:[1,0] neg_lo:[0,1] neg_hi:[0,1]
    v_pk_mul_f32 v[38:39], v[20:21], v[20:21]
    v_pk_mul_f32 v[40:41], v[22:23], v[22:23]
    v_pk_fma_f32 v[38:39], v[24:25], v[24:25], v[38:39]
    v_pk_fma_f32 v[40:41], v[26:27], v[26:27], v[40:41]
    v_pk_fma_f32 v[38:39], v[28:29], v[28:29], v[38:39]
    v_pk_fma_f32 v[40:41], v[30:31], v[30:31], v[40:41]
    v_pk_fma_f32 v[38:39], v[32:33], v[32:33], v[38:39]
    v_pk_fma_f32 v[40:41], v[34:35], v[34:35], v[40:41]
    v_pk_fma_f32 v[38:39], v[36:37], v[36:37], v[38:39]
    buffer_load_dwordx4 v150, s[48:51], s14 offen offset:2048 lds
    v_pk_add_f32 v[38:39], v[38:39], v[40:41]
    v_add_f32 v18, v38, v39
    s_nop 1
    v_add_f32_dpp v18, v18, v18 row_ror:8 row_mask:0xf bank_mask:0xf
    s_nop 1
    v_add_f32_dpp v18, v18, v18 row_ror:4 row_mask:0xf bank_mask:0xf
    s_nop 1
    v_add_f32_dpp v18, v18, v18 row_ror:2 row_mask:0xf bank_mask:0xf
    s_nop 1
    v_add_f32_dpp v18, v18, v18 row_ror:1 row_mask:0xf bank_mask:0xf
    v_mov_b32 v19, v18
    s_nop 1
    v_permlane16_swap_b32 v18, v19
    v_add_f32 v18, v18, v19
    v_mul_f32 v18, 0x3ae38e39, v18
    v_cvt_pk_bf16_f32 v38, v56, v18
    v_lshlrev_b32 v106, 16, v38
    v_and_b32 v38, 0xffff0000, v38
    v_add_f32 v38, 0x3727c5ac, v38
    v_sub_f32 v56, v56, v106
    v_cvt_pk_bf16_f32 v38, v38, v38
    v_lshlrev_b32 v38, 16, v38
    v_sqrt_f32 v38, v38
    s_nop 0
    v_cvt_pk_bf16_f32 v38, v38, v38
    v_lshlrev_b32 v38, 16, v38
    v_rcp_f32 v107, v38
    s_nop 0
    v_mul_f32 v56, v56, v107
    v_mul_f32 v18, v18, v107
    v_mul_f32 v18, v18, v107
    v_cvt_pk_bf16_f32 v38, v56, v18
    v_lshlrev_b32 v39, 16, v38
    buffer_load_dwordx4 v151, s[48:51], s14 offen offset:3072 lds
    v_and_b32 v38, 0xffff0000, v38
    v_add_f32 v38, 0x3727c5ac, v38
    v_sub_f32 v56, v56, v39
    v_cvt_pk_bf16_f32 v38, v38, v38
    v_lshlrev_b32 v38, 16, v38
    v_sqrt_f32 v38, v38
    s_nop 0
    v_cvt_pk_bf16_f32 v38, v38, v38
    v_lshlrev_b32 v38, 16, v38
    v_rcp_f32 v38, v38
    s_nop 0
    v_mul_f32 v18, v107, v38
    v_mul_f32 v56, v56, v38
    v_pk_fma_f32 v[20:21], v[20:21], v[18:19], v[56:57] op_sel_hi:[1,0,0]
    v_pk_fma_f32 v[22:23], v[22:23], v[18:19], v[56:57] op_sel_hi:[1,0,0]
    v_pk_fma_f32 v[24:25], v[24:25], v[18:19], v[56:57] op_sel_hi:[1,0,0]
    v_pk_fma_f32 v[26:27], v[26:27], v[18:19], v[56:57] op_sel_hi:[1,0,0]
    v_pk_fma_f32 v[28:29], v[28:29], v[18:19], v[56:57] op_sel_hi:[1,0,0]
    v_pk_fma_f32 v[30:31], v[30:31], v[18:19], v[56:57] op_sel_hi:[1,0,0]
    v_pk_fma_f32 v[32:33], v[32:33], v[18:19], v[56:57] op_sel_hi:[1,0,0]
    v_pk_fma_f32 v[34:35], v[34:35], v[18:19], v[56:57] op_sel_hi:[1,0,0]
    v_pk_fma_f32 v[36:37], v[36:37], v[18:19], v[56:57] op_sel_hi:[1,0,0]
    v_cvt_pk_bf16_f32 v8, v20, v21
    v_cvt_pk_bf16_f32 v9, v22, v23
    v_cvt_pk_bf16_f32 v10, v24, v25
    v_cvt_pk_bf16_f32 v11, v26, v27
    v_cvt_pk_bf16_f32 v12, v28, v29
    v_cvt_pk_bf16_f32 v13, v30, v31
    v_cvt_pk_bf16_f32 v14, v32, v33
    v_cvt_pk_bf16_f32 v15, v34, v35
    v_cvt_pk_bf16_f32 v16, v36, v37
    v_lshrrev_b32 v3, 5, v0
    v_and_b32 v1, 31, v0
    v_mul_u32_u24 v17, 1216, v3
    v_mad_u32_u24 v17, v1, 12, v17
    v_add_u32 v17, 144896, v17
    ds_write_b32 v17, v8 offset:0
    ds_write_b32 v17, v9 offset:4
    ds_write_b32 v17, v10 offset:8
    ds_write_b32 v17, v11 offset:384
    ds_write_b32 v17, v12 offset:388
    ds_write_b32 v17, v13 offset:392
    ds_write_b32 v17, v14 offset:768
    ds_write_b32 v17, v15 offset:772
    ds_write_b32 v17, v16 offset:776
    v_lshlrev_b32 v3, 3, v3
    s_lshl_b32 s5, s68, 6
    s_add_u32 s5, s5, 12386304
    v_cmp_eq_u32 vcc, 0, v1
    v_mov_b32 v18, 0x40000000
    s_nop 0
    v_cndmask_b32 v3, v18, v3, vcc
    buffer_store_dwordx2 v[106:107], v3, s[44:47], s5 offen sc1
    v_lshrrev_b32 v19, 4, v0
    v_and_b32 v17, 3, v2
    v_lshlrev_b32 v17, 3, v17
    v_lshl_add_u32 v19, v19, 5, v17
    v_bfe_u32 v6, v2, 2, 2
    v_mul_u32_u24 v17, 1216, v6
    v_mul_u32_u24 v6, 1152, v6
    v_add3_u32 v17, v17, v19, s9
    v_add3_u32 v6, v6, v19, s11
    v_lshlrev_b32 v19, 4, v0
    s_add_u32 s7, s15, 4096
    s_add_u32 s8, s15, 8192
    s_cmp_eq_u32 s3, 0
    s_cselect_b32 s8, s8, 0x40000000
    v_add_u32 v18, 2359296, v19
    v_mov_b32 v44, 0
    s_waitcnt vmcnt(6) lgkmcnt(0)
    s_barrier
    ds_read_b64_tr_b16 v[60:61], v6 offset:0
    ds_read_b64_tr_b16 v[62:63], v6 offset:4608
    ds_read_b64_tr_b16 v[64:65], v6 offset:9216
    ds_read_b64_tr_b16 v[66:67], v6 offset:12672
    ds_read_b64_tr_b16 v[68:69], v6 offset:17280
    ds_read_b64_tr_b16 v[20:21], v17 offset:0
    ds_read_b64_tr_b16 v[22:23], v17 offset:4864
    ds_read_b64_tr_b16 v[24:25], v17 offset:512
    ds_read_b64_tr_b16 v[26:27], v17 offset:5376
    ds_read_b64_tr_b16 v[28:29], v17 offset:1024
    ds_read_b64_tr_b16 v[30:31], v17 offset:5888
    ds_read_b64_tr_b16 v[70:71], v6 offset:512
    ds_read_b64_tr_b16 v[72:73], v6 offset:5120
    ds_read_b64_tr_b16 v[74:75], v6 offset:9728
    ds_read_b64_tr_b16 v[76:77], v6 offset:13184
    v_alignbit_b32 v114, v99, v99, 16
    v_alignbit_b32 v115, v98, v98, 16
    s_waitcnt lgkmcnt(10)
    v_alignbit_b32 v108, v61, v60, 16
    v_alignbit_b32 v109, v62, v61, 16
    v_alignbit_b32 v110, v63, v62, 16
    v_alignbit_b32 v111, v64, v63, 16
    v_alignbit_b32 v112, v65, v64, 16
    v_dot2_f32_bf16 v116, v60, v114, 0
    ds_read_b64_tr_b16 v[78:79], v6 offset:17792
    v_dot2_f32_bf16 v117, v108, v114, 0
    v_dot2_f32_bf16 v118, v61, v114, 0
    ds_read_b64_tr_b16 v[80:81], v6 offset:1024
    v_dot2_f32_bf16 v119, v109, v114, 0
    v_dot2_f32_bf16 v120, v62, v114, 0
    v_dot2_f32_bf16 v121, v110, v114, 0
    ds_read_b64_tr_b16 v[82:83], v6 offset:5632
    v_dot2_f32_bf16 v122, v63, v114, 0
    v_dot2_f32_bf16 v123, v111, v114, 0
    v_dot2_f32_bf16 v116, v61, v115, v116
    ds_read_b64_tr_b16 v[84:85], v6 offset:10240
    v_dot2_f32_bf16 v117, v109, v115, v117
    v_dot2_f32_bf16 v118, v62, v115, v118
    ds_read_b64_tr_b16 v[86:87], v6 offset:13696
    v_dot2_f32_bf16 v119, v110, v115, v119
    v_dot2_f32_bf16 v120, v63, v115, v120
    v_dot2_f32_bf16 v121, v111, v115, v121
    ds_read_b64_tr_b16 v[88:89], v6 offset:18304
    v_dot2_f32_bf16 v122, v64, v115, v122
    v_dot2_f32_bf16 v123, v112, v115, v123
    v_and_b32 v133, 0xffff0000, v66
    s_waitcnt lgkmcnt(14)
    buffer_store_dwordx4 v[20:23], v19, s[44:47], s15 offen sc1
    v_lshlrev_b32 v132, 16, v66
    v_and_b32 v135, 0xffff0000, v67
    s_waitcnt lgkmcnt(12)
    buffer_store_dwordx4 v[24:27], v19, s[44:47], s7 offen sc1
    v_lshlrev_b32 v134, 16, v67
    v_and_b32 v137, 0xffff0000, v68
    v_lshlrev_b32 v136, 16, v68
    s_waitcnt lgkmcnt(10)
    buffer_store_dwordx4 v[28:31], v19, s[44:47], s8 offen sc1
    v_and_b32 v139, 0xffff0000, v69
    v_lshlrev_b32 v138, 16, v69
    v_pk_mul_f32 v[116:117], v[116:117], v[132:133]
    v_pk_mul_f32 v[118:119], v[118:119], v[134:135]
    v_pk_mul_f32 v[120:121], v[120:121], v[136:137]
    v_pk_mul_f32 v[122:123], v[122:123], v[138:139]
    v_cvt_pk_bf16_f32 v160, v123, v122
    v_cvt_pk_bf16_f32 v161, v121, v120
    v_cvt_pk_bf16_f32 v162, v119, v118
    v_cvt_pk_bf16_f32 v163, v117, v116
    buffer_store_dwordx4 v[160:163], v18, s[44:47], s15 offen sc1
    v_alignbit_b32 v114, v101, v101, 16
    v_alignbit_b32 v115, v100, v100, 16
    s_waitcnt lgkmcnt(5)
    v_alignbit_b32 v108, v71, v70, 16
    v_alignbit_b32 v109, v72, v71, 16
    v_alignbit_b32 v110, v73, v72, 16
    v_alignbit_b32 v111, v74, v73, 16
    v_alignbit_b32 v112, v75, v74, 16
    v_dot2_f32_bf16 v124, v70, v114, 0
    v_dot2_f32_bf16 v125, v108, v114, 0
    v_dot2_f32_bf16 v126, v71, v114, 0
    v_dot2_f32_bf16 v127, v109, v114, 0
    v_dot2_f32_bf16 v128, v72, v114, 0
    v_dot2_f32_bf16 v129, v110, v114, 0
    v_dot2_f32_bf16 v130, v73, v114, 0
    v_dot2_f32_bf16 v131, v111, v114, 0
    v_dot2_f32_bf16 v124, v71, v115, v124
    v_dot2_f32_bf16 v125, v109, v115, v125
    v_dot2_f32_bf16 v126, v72, v115, v126
    v_dot2_f32_bf16 v127, v110, v115, v127
    v_dot2_f32_bf16 v128, v73, v115, v128
    v_dot2_f32_bf16 v129, v111, v115, v129
    v_dot2_f32_bf16 v130, v74, v115, v130
    v_dot2_f32_bf16 v131, v112, v115, v131
    v_and_b32 v133, 0xffff0000, v76
    v_lshlrev_b32 v132, 16, v76
    v_and_b32 v135, 0xffff0000, v77
    v_lshlrev_b32 v134, 16, v77
    v_and_b32 v137, 0xffff0000, v78
    v_lshlrev_b32 v136, 16, v78
    v_and_b32 v139, 0xffff0000, v79
    v_lshlrev_b32 v138, 16, v79
    v_pk_mul_f32 v[124:125], v[124:125], v[132:133]
    v_pk_mul_f32 v[126:127], v[126:127], v[134:135]
    v_pk_mul_f32 v[128:129], v[128:129], v[136:137]
    v_pk_mul_f32 v[130:131], v[130:131], v[138:139]
    v_cvt_pk_bf16_f32 v164, v131, v130
    v_cvt_pk_bf16_f32 v165, v129, v128
    v_cvt_pk_bf16_f32 v166, v127, v126
    v_cvt_pk_bf16_f32 v167, v125, v124
    buffer_store_dwordx4 v[164:167], v18, s[44:47], s7 offen sc1
    v_alignbit_b32 v114, v103, v103, 16
    v_alignbit_b32 v115, v102, v102, 16
    s_waitcnt lgkmcnt(0)
    v_alignbit_b32 v108, v81, v80, 16
    v_alignbit_b32 v109, v82, v81, 16
    v_alignbit_b32 v110, v83, v82, 16
    v_alignbit_b32 v111, v84, v83, 16
    v_alignbit_b32 v112, v85, v84, 16
    v_dot2_f32_bf16 v116, v80, v114, 0
    v_dot2_f32_bf16 v117, v108, v114, 0
    v_dot2_f32_bf16 v118, v81, v114, 0
    v_dot2_f32_bf16 v119, v109, v114, 0
    v_dot2_f32_bf16 v120, v82, v114, 0
    v_dot2_f32_bf16 v121, v110, v114, 0
    v_dot2_f32_bf16 v122, v83, v114, 0
    v_dot2_f32_bf16 v123, v111, v114, 0
    v_dot2_f32_bf16 v116, v81, v115, v116
    v_dot2_f32_bf16 v117, v109, v115, v117
    v_dot2_f32_bf16 v118, v82, v115, v118
    v_dot2_f32_bf16 v119, v110, v115, v119
    v_dot2_f32_bf16 v120, v83, v115, v120
    v_dot2_f32_bf16 v121, v111, v115, v121
    v_dot2_f32_bf16 v122, v84, v115, v122
    v_dot2_f32_bf16 v123, v112, v115, v123
    v_and_b32 v133, 0xffff0000, v86
    v_lshlrev_b32 v132, 16, v86
    v_and_b32 v135, 0xffff0000, v87
    v_lshlrev_b32 v134, 16, v87
    v_and_b32 v137, 0xffff0000, v88
    v_lshlrev_b32 v136, 16, v88
    v_and_b32 v139, 0xffff0000, v89
    v_lshlrev_b32 v138, 16, v89
    v_pk_mul_f32 v[116:117], v[116:117], v[132:133]
    v_pk_mul_f32 v[118:119], v[118:119], v[134:135]
    v_pk_mul_f32 v[120:121], v[120:121], v[136:137]
    v_pk_mul_f32 v[122:123], v[122:123], v[138:139]
    v_cvt_pk_bf16_f32 v168, v123, v122
    v_cvt_pk_bf16_f32 v169, v121, v120
    v_cvt_pk_bf16_f32 v170, v119, v118
    v_cvt_pk_bf16_f32 v171, v117, v116
    buffer_store_dwordx4 v[168:171], v18, s[44:47], s8 offen sc1
    buffer_load_dword v45, v44, s[64:67], 0 offen sc1
    s_add_u32 m0, s73, 98304
    s_lshl_b32 s14, s19, 3
    buffer_load_dwordx4 v148, s[48:51], s14 offen offset:0 lds
    buffer_load_dwordx4 v149, s[48:51], s14 offen offset:1024 lds
    buffer_load_dwordx4 v150, s[48:51], s14 offen offset:2048 lds
    buffer_load_dwordx4 v151, s[48:51], s14 offen offset:3072 lds
    s_add_u32 m0, s73, 0
    s_lshl_b32 s14, s20, 3
    buffer_load_dwordx4 v148, s[48:51], s14 offen offset:0 lds
    buffer_load_dwordx4 v149, s[48:51], s14 offen offset:1024 lds
    buffer_load_dwordx4 v150, s[48:51], s14 offen offset:2048 lds
    buffer_load_dwordx4 v151, s[48:51], s14 offen offset:3072 lds
    s_add_u32 m0, s73, 16384
    s_lshl_b32 s14, s21, 3
    buffer_load_dwordx4 v148, s[48:51], s14 offen offset:0 lds
    buffer_load_dwordx4 v149, s[48:51], s14 offen offset:1024 lds
    s_bfe_u32 s6, s68, 0x20001
    s_lshl_b32 s6, s6, 6
    s_lshr_b32 s7, s68, 3
    s_lshl_b32 s7, s7, 1
    s_add_u32 s6, s6, s7
    s_and_b32 s7, s68, 1
    s_add_u32 s6, s6, s7
    s_lshr_b32 s4, s6, 2
    s_lshl_b32 s4, s4, 7
    s_and_b32 s5, s6, 3
    s_lshl2_add_u32 s4, s5, s4
    s_add_u32 s4, s4, 12533760
    v_min_u32 v1, 1, v0
    v_lshlrev_b32 v1, 30, v1
    v_add_u32 v1, s4, v1
    s_waitcnt vmcnt(10)
    v_readfirstlane_b32 s68, v45
    s_nop 1
    s_cmp_eq_u32 s68, 0
    s_cbranch_scc1 L_nw_G
L_ng_G:
    s_barrier
    v_mov_b32 v3, s68
    buffer_store_dword v3, v1, s[44:47], 0 offen sc1
L_segG:
L_pl_G_0:
    s_cbranch_execz L_pl_G_4
    buffer_load_dwordx4 v150, s[48:51], s14 offen offset:2048 lds
    buffer_load_dwordx4 v151, s[48:51], s14 offen offset:3072 lds
    s_add_u32 m0, s73, 32768
    s_lshl_b32 s14, s22, 3
    buffer_load_dwordx4 v148, s[48:51], s14 offen offset:0 lds
    buffer_load_dwordx4 v149, s[48:51], s14 offen offset:1024 lds
    buffer_load_dwordx4 v150, s[48:51], s14 offen offset:2048 lds
    buffer_load_dwordx4 v151, s[48:51], s14 offen offset:3072 lds
    s_add_u32 m0, s73, 49152
    s_lshl_b32 s14, s23, 3
    buffer_load_dwordx4 v148, s[48:51], s14 offen offset:0 lds
    buffer_load_dwordx4 v149, s[48:51], s14 offen offset:1024 lds
    buffer_load_dwordx4 v150, s[48:51], s14 offen offset:2048 lds
    buffer_load_dwordx4 v151, s[48:51], s14 offen offset:3072 lds
    s_add_u32 m0, s73, 65536
    s_lshl_b32 s14, s24, 3
    buffer_load_dwordx4 v148, s[48:51], s14 offen offset:0 lds
    buffer_load_dwordx4 v149, s[48:51], s14 offen offset:1024 lds
    buffer_load_dwordx4 v150, s[48:51], s14 offen offset:2048 lds
    buffer_load_dwordx4 v151, s[48:51], s14 offen offset:3072 lds
    s_mov_b64 exec, 0
    s_call_b64 s[82:83], L_wc_G
    s_mov_b64 exec, -1
    s_mov_b64 exec, 0
    s_call_b64 s[82:83], L_wc_D
    s_mov_b64 exec, -1
    s_mov_b32 s56, s32
    s_and_b32 s57, s33, 0xffff
    s_mov_b32 s58, 9216
    s_mov_b32 s59, 0x20000
    s_mov_b32 s60, s36
    s_and_b32 s61, s37, 0xffff
    s_mov_b32 s62, 4096
    s_mov_b32 s63, 0x20000
    s_waitcnt lgkmcnt(0)
    s_barrier
    ds_read_b64_tr_b16 a[0:1], v154 offset:16384
    ds_read_b64_tr_b16 a[2:3], v154 offset:17408
    ds_read_b64_tr_b16 a[4:5], v155 offset:16384
    ds_read_b64_tr_b16 a[6:7], v155 offset:17408
    ds_read_b64_tr_b16 a[8:9], v154 offset:24576
    ds_read_b64_tr_b16 a[10:11], v154 offset:25600
    ds_read_b64_tr_b16 a[12:13], v155 offset:24576
    ds_read_b64_tr_b16 a[14:15], v155 offset:25600
    s_and_b32 s4, s70, 1
    s_lshl1_add_u32 s4, s3, s4
    s_lshl_b32 s4, s4, 5
    v_min_u32 v28, 31, v2
    v_add_u32 v28, s4, v28
    v_and_b32 v29, 3, v28
    v_lshrrev_b32 v28, 2, v28
    v_lshlrev_b32 v28, 7, v28
    v_lshl_add_u32 v28, v29, 2, v28
    v_add_u32 v28, 12533760, v28
    s_waitcnt vmcnt(21) lgkmcnt(0)
    s_barrier
    ds_read_b64_tr_b16 a[16:17], v154 offset:32768
    ds_read_b64_tr_b16 a[18:19], v154 offset:33792
    ds_read_b64_tr_b16 a[20:21], v155 offset:32768
    ds_read_b64_tr_b16 a[22:23], v155 offset:33792
    ds_read_b64_tr_b16 a[24:25], v154 offset:40960
    ds_read_b64_tr_b16 a[26:27], v154 offset:41984
    ds_read_b64_tr_b16 a[28:29], v155 offset:40960
    ds_read_b64_tr_b16 a[30:31], v155 offset:41984
    v_lshrrev_b32 v24, 4, v2
    v_lshlrev_b32 v25, 3, v24
    s_lshl_b32 s7, s69, 8
    s_lshl_b32 s8, s3, 6
    s_add_u32 s7, s7, s8
    buffer_load_dwordx2 v[144:145], v25, s[56:59], s7 offen
    buffer_load_dwordx2 v[146:147], v25, s[56:59], s7 offen offset:32
    s_waitcnt vmcnt(19) lgkmcnt(0)
    s_barrier
    ds_read_b64_tr_b16 a[32:33], v152 offset:0
    ds_read_b64_tr_b16 a[34:35], v152 offset:1024
    ds_read_b64_tr_b16 a[36:37], v153 offset:0
    ds_read_b64_tr_b16 a[38:39], v153 offset:1024
    ds_read_b64_tr_b16 a[40:41], v152 offset:8192
    ds_read_b64_tr_b16 a[42:43], v152 offset:9216
    ds_read_b64_tr_b16 a[44:45], v153 offset:8192
    ds_read_b64_tr_b16 a[46:47], v153 offset:9216
    s_waitcnt vmcnt(14) lgkmcnt(0)
    s_barrier
    ds_read_b64_tr_b16 a[48:49], v152 offset:16384
    s_add_u32 m0, s73, 0
    s_lshl_b32 s14, s25, 3
    ds_read_b64_tr_b16 a[50:51], v152 offset:17408
    buffer_load_dwordx4 v148, s[48:51], s14 offen offset:0 lds
    ds_read_b64_tr_b16 a[52:53], v153 offset:16384
    ds_read_b64_tr_b16 a[54:55], v153 offset:17408
    buffer_load_dwordx4 v149, s[48:51], s14 offen offset:1024 lds
    ds_read_b64_tr_b16 a[56:57], v152 offset:24576
    buffer_load_dwordx4 v150, s[48:51], s14 offen offset:2048 lds
    ds_read_b64_tr_b16 a[58:59], v152 offset:25600
    ds_read_b64_tr_b16 a[60:61], v153 offset:24576
    buffer_load_dwordx4 v151, s[48:51], s14 offen offset:3072 lds
    ds_read_b64_tr_b16 a[62:63], v153 offset:25600
    buffer_load_dword v29, v28, s[44:47], 0 offen sc1
    s_waitcnt vmcnt(15) lgkmcnt(0)
    s_barrier
    ds_read_b64_tr_b16 a[64:65], v152 offset:32768
    s_add_u32 m0, s73, 16384
    s_lshl_b32 s14, s26, 3
    ds_read_b64_tr_b16 a[66:67], v152 offset:33792
    buffer_load_dwordx4 v148, s[48:51], s14 offen offset:0 lds
    ds_read_b64_tr_b16 a[68:69], v153 offset:32768
    ds_read_b64_tr_b16 a[70:71], v153 offset:33792
    buffer_load_dwordx4 v149, s[48:51], s14 offen offset:1024 lds
    ds_read_b64_tr_b16 a[72:73], v152 offset:40960
    buffer_load_dwordx4 v150, s[48:51], s14 offen offset:2048 lds
    ds_read_b64_tr_b16 a[74:75], v152 offset:41984
    ds_read_b64_tr_b16 a[76:77], v153 offset:40960
    buffer_load_dwordx4 v151, s[48:51], s14 offen offset:3072 lds
    ds_read_b64_tr_b16 a[78:79], v153 offset:41984
    s_waitcnt vmcnt(4)
    v_cmp_ne_u32 vcc, s68, v29
    s_cbranch_vccnz L_rs_p1G
L_ok_p1G:
    s_add_u32 m0, s74, 0
    s_nop 0
    buffer_load_dwordx4 v156, s[44:47], s18 offen offset:0 sc1 lds
    buffer_load_dwordx4 v157, s[44:47], s18 offen offset:1024 sc1 lds
    buffer_load_dwordx4 v158, s[44:47], s18 offen offset:2048 sc1 lds
    s_add_u32 m0, s74, 12288
    s_nop 0
    buffer_load_dwordx4 v156, s[44:47], s19 offen offset:0 sc1 lds
    buffer_load_dwordx4 v157, s[44:47], s19 offen offset:1024 sc1 lds
    buffer_load_dwordx4 v158, s[44:47], s19 offen offset:2048 sc1 lds
    s_add_u32 m0, s74, 24576
    s_nop 0
    buffer_load_dwordx4 v156, s[44:47], s20 offen offset:0 sc1 lds
    buffer_load_dwordx4 v157, s[44:47], s20 offen offset:1024 sc1 lds
    buffer_load_dwordx4 v158, s[44:47], s20 offen offset:2048 sc1 lds
    s_add_u32 m0, s74, 36864
    s_nop 0
    buffer_load_dwordx4 v156, s[44:47], s21 offen offset:0 sc1 lds
    buffer_load_dwordx4 v157, s[44:47], s21 offen offset:1024 sc1 lds
    buffer_load_dwordx4 v158, s[44:47], s21 offen offset:2048 sc1 lds
L_pl_G_1:
    s_cbranch_execz L_pl_G_5
    s_add_u32 m0, s74, 49152
    s_nop 0
    buffer_load_dwordx4 v156, s[44:47], s22 offen offset:0 sc1 lds
    buffer_load_dwordx4 v157, s[44:47], s22 offen offset:1024 sc1 lds
    buffer_load_dwordx4 v158, s[44:47], s22 offen offset:2048 sc1 lds
    s_add_u32 m0, s74, 61440
    s_nop 0
    buffer_load_dwordx4 v156, s[44:47], s23 offen offset:0 sc1 lds
    buffer_load_dwordx4 v157, s[44:47], s23 offen offset:1024 sc1 lds
    buffer_load_dwordx4 v158, s[44:47], s23 offen offset:2048 sc1 lds
    s_waitcnt vmcnt(15) lgkmcnt(0)
    s_barrier
    ds_read_b128 v[80:83], v159 offset:0
    ds_read_b128 v[84:87], v159 offset:6144
    ds_read_b128 v[88:91], v159 offset:256
    ds_read_b128 v[92:95], v159 offset:6400
    ds_read_b128 v[96:99], v159 offset:512
    ds_read_b128 v[100:103], v159 offset:6656
    s_waitcnt lgkmcnt(0)
    v_mfma_f32_16x16x32_bf16 v[192:195], a[0:3], v[80:83], 0
    v_mfma_f32_16x16x32_bf16 v[192:195], a[8:11], v[84:87], v[192:195]
    ds_read_b128 v[104:107], v159 offset:768
    v_mfma_f32_16x16x32_bf16 v[196:199], a[12:15], v[84:87], 0
    ds_read_b128 v[108:111], v159 offset:6912
    v_mfma_f32_16x16x32_bf16 v[196:199], a[4:7], v[80:83], v[196:199]
    ds_read_b128 v[112:115], v159 offset:1024
    v_mfma_f32_16x16x32_bf16 v[204:207], a[4:7], v[88:91], 0
    ds_read_b128 v[116:119], v159 offset:7168
    v_mfma_f32_16x16x32_bf16 v[204:207], a[12:15], v[92:95], v[204:207]
    ds_read_b128 v[120:123], v159 offset:1280
    v_mfma_f32_16x16x32_bf16 v[200:203], a[8:11], v[92:95], 0
    ds_read_b128 v[124:127], v159 offset:7424
    v_mfma_f32_16x16x32_bf16 v[200:203], a[0:3], v[88:91], v[200:203]
    v_mfma_f32_16x16x32_bf16 v[208:211], a[0:3], v[96:99], 0
    v_mfma_f32_16x16x32_bf16 v[208:211], a[8:11], v[100:103], v[208:211]
    v_mfma_f32_16x16x32_bf16 v[212:215], a[12:15], v[100:103], 0
    v_mfma_f32_16x16x32_bf16 v[212:215], a[4:7], v[96:99], v[212:215]
    s_waitcnt lgkmcnt(0)
    v_mfma_f32_16x16x32_bf16 v[220:223], a[4:7], v[104:107], 0
    s_waitcnt vmcnt(12)
    s_barrier
    v_mfma_f32_16x16x32_bf16 v[220:223], a[12:15], v[108:111], v[220:223]
    ds_read_b128 v[80:83], v159 offset:12288
    s_add_u32 m0, s74, 0
    v_mfma_f32_16x16x32_bf16 v[216:219], a[8:11], v[108:111], 0
    ds_read_b128 v[84:87], v159 offset:18432
    v_mfma_f32_16x16x32_bf16 v[216:219], a[0:3], v[104:107], v[216:219]
    ds_read_b128 v[88:91], v159 offset:12544
    buffer_load_dwordx4 v156, s[44:47], s24 offen offset:0 sc1 lds
    v_mfma_f32_16x16x32_bf16 v[224:227], a[0:3], v[112:115], 0
    ds_read_b128 v[92:95], v159 offset:18688
    v_mfma_f32_16x16x32_bf16 v[224:227], a[8:11], v[116:119], v[224:227]
    ds_read_b128 v[96:99], v159 offset:12800
    v_mfma_f32_16x16x32_bf16 v[228:231], a[12:15], v[116:119], 0
    ds_read_b128 v[100:103], v159 offset:18944
    buffer_load_dwordx4 v157, s[44:47], s24 offen offset:1024 sc1 lds
    v_mfma_f32_16x16x32_bf16 v[228:231], a[4:7], v[112:115], v[228:231]
    ds_read_b64_tr_b16 a[80:81], v152 offset:49152
    v_mfma_f32_16x16x32_bf16 v[236:239], a[4:7], v[120:123], 0
    ds_read_b64_tr_b16 a[82:83], v152 offset:50176
    v_mfma_f32_16x16x32_bf16 v[236:239], a[12:15], v[124:127], v[236:239]
    ds_read_b64_tr_b16 a[84:85], v153 offset:49152
    buffer_load_dwordx4 v158, s[44:47], s24 offen offset:2048 sc1 lds
    v_mfma_f32_16x16x32_bf16 v[232:235], a[8:11], v[124:127], 0
    ds_read_b64_tr_b16 a[86:87], v153 offset:50176
    v_mfma_f32_16x16x32_bf16 v[232:235], a[0:3], v[120:123], v[232:235]
    s_waitcnt lgkmcnt(4)
    v_mfma_f32_16x16x32_bf16 v[192:195], a[16:19], v[80:83], v[192:195]
    s_add_u32 m0, s73, 32768
    s_lshl_b32 s14, s27, 3
    v_mfma_f32_16x16x32_bf16 v[192:195], a[24:27], v[84:87], v[192:195]
    ds_read_b128 v[104:107], v159 offset:13056
    v_mfma_f32_16x16x32_bf16 v[196:199], a[28:31], v[84:87], v[196:199]
    ds_read_b128 v[108:111], v159 offset:19200
    buffer_load_dwordx4 v148, s[48:51], s14 offen offset:0 lds
    v_mfma_f32_16x16x32_bf16 v[196:199], a[20:23], v[80:83], v[196:199]
    ds_read_b128 v[112:115], v159 offset:13312
    v_mfma_f32_16x16x32_bf16 v[204:207], a[20:23], v[88:91], v[204:207]
    ds_read_b128 v[116:119], v159 offset:19456
    buffer_load_dwordx4 v149, s[48:51], s14 offen offset:1024 lds
    v_mfma_f32_16x16x32_bf16 v[204:207], a[28:31], v[92:95], v[204:207]
    ds_read_b128 v[120:123], v159 offset:13568
    v_mfma_f32_16x16x32_bf16 v[200:203], a[24:27], v[92:95], v[200:203]
    ds_read_b128 v[124:127], v159 offset:19712
    v_and_b32 v24, 15, v2
    s_lshl_b32 s7, s71, 6
    s_lshl_b32 s8, s3, 4
    s_add_u32 s7, s7, s8
    v_add_u32 v24, s7, v24
    v_mul_u32_u24 v25, 1152, v24
    v_lshrrev_b32 v31, 4, v2
    v_lshl_add_u32 v25, v31, 3, v25
    s_mul_i32 s8, s72, 144
    v_add_u32 v25, s8, v25
    s_and_b32 s7, s72, 1
    s_lshl_b32 s8, s7, 4
    v_add_u32 v252, s8, v25
    s_mul_i32 s8, s7, 144
    s_sub_u32 s8, 128, s8
    v_add_u32 v25, s8, v25
    v_lshrrev_b32 v31, 5, v2
    v_cmp_eq_u32 vcc, s7, v31
    v_mov_b32 v31, 0x40000000
    s_nop 0
    v_cndmask_b32 v253, v31, v25, vcc
    v_lshlrev_b32 v25, 1, v24
    v_lshlrev_b32 v26, 3, v24
    buffer_load_ushort v30, v25, s[60:63], 0 offen
    v_lshrrev_b32 v24, 3, v2
    v_and_b32 v25, 7, v2
    v_bfe_u32 v31, v2, 4, 2
    v_lshlrev_b32 v31, 1, v31
    v_mfma_f32_16x16x32_bf16 v[200:203], a[16:19], v[88:91], v[200:203]
    ds_read_b64_tr_b16 a[88:89], v152 offset:57344
    buffer_load_dwordx4 v150, s[48:51], s14 offen offset:2048 lds
    v_mfma_f32_16x16x32_bf16 v[208:211], a[16:19], v[96:99], v[208:211]
    ds_read_b64_tr_b16 a[90:91], v152 offset:58368
    v_mfma_f32_16x16x32_bf16 v[208:211], a[24:27], v[100:103], v[208:211]
    ds_read_b64_tr_b16 a[92:93], v153 offset:57344
    buffer_load_dwordx4 v151, s[48:51], s14 offen offset:3072 lds
    v_mfma_f32_16x16x32_bf16 v[212:215], a[28:31], v[100:103], v[212:215]
    ds_read_b64_tr_b16 a[94:95], v153 offset:58368
    v_mfma_f32_16x16x32_bf16 v[212:215], a[20:23], v[96:99], v[212:215]
    s_waitcnt lgkmcnt(4)
    v_mfma_f32_16x16x32_bf16 v[220:223], a[20:23], v[104:107], v[220:223]
    s_waitcnt vmcnt(17)
    s_barrier
    v_mfma_f32_16x16x32_bf16 v[220:223], a[28:31], v[108:111], v[220:223]
    ds_read_b128 v[80:83], v159 offset:24576
    s_add_u32 m0, s74, 12288
    v_mfma_f32_16x16x32_bf16 v[216:219], a[24:27], v[108:111], v[216:219]
    ds_read_b128 v[84:87], v159 offset:30720
    v_mfma_f32_16x16x32_bf16 v[216:219], a[16:19], v[104:107], v[216:219]
    ds_read_b128 v[88:91], v159 offset:24832
    buffer_load_dwordx4 v156, s[44:47], s25 offen offset:0 sc1 lds
    v_mfma_f32_16x16x32_bf16 v[224:227], a[16:19], v[112:115], v[224:227]
    ds_read_b128 v[92:95], v159 offset:30976
    v_mfma_f32_16x16x32_bf16 v[224:227], a[24:27], v[116:119], v[224:227]
    ds_read_b128 v[96:99], v159 offset:25088
    v_mfma_f32_16x16x32_bf16 v[228:231], a[28:31], v[116:119], v[228:231]
    ds_read_b128 v[100:103], v159 offset:31232
    buffer_load_dwordx4 v157, s[44:47], s25 offen offset:1024 sc1 lds
    v_xor_b32 v25, v25, v31
    v_lshlrev_b32 v24, 12, v24
    v_lshl_add_u32 v24, v25, 4, v24
    s_and_b32 s7, s72, 1
    s_lshl_b32 s7, s7, 2
    s_add_u32 s7, s7, s3
    s_mul_i32 s7, s7, 2359296
    s_lshl_b32 s8, s71, 7
    s_add_u32 s7, s7, s8
    v_add_u32 v4, s7, v24
    v_add_u32 v5, 31744, v4
    v_add_u32 v6, 31744, v5
    v_add_u32 v7, 31744, v6
    v_lshrrev_b32 v24, 2, v2
    v_lshlrev_b32 v24, 7, v24
    v_and_b32 v25, 3, v2
    v_lshl_add_u32 v24, v25, 3, v24
    v_add_u32 v24, s73, v24
    v_bfe_u32 v31, v2, 3, 2
    v_xor_b32 v31, s3, v31
    v_xor_b32 v25, 0, v31
    v_lshl_add_u32 v10, v25, 5, v24
    v_xor_b32 v25, 1, v31
    v_lshl_add_u32 v11, v25, 5, v24
    v_xor_b32 v25, 2, v31
    v_lshl_add_u32 v12, v25, 5, v24
    v_xor_b32 v25, 3, v31
    v_mfma_f32_16x16x32_bf16 v[228:231], a[20:23], v[112:115], v[228:231]
    ds_read_b64_tr_b16 a[96:97], v154 offset:0
    v_mfma_f32_16x16x32_bf16 v[236:239], a[20:23], v[120:123], v[236:239]
    ds_read_b64_tr_b16 a[98:99], v154 offset:1024
    v_mfma_f32_16x16x32_bf16 v[236:239], a[28:31], v[124:127], v[236:239]
    ds_read_b64_tr_b16 a[100:101], v155 offset:0
    buffer_load_dwordx4 v158, s[44:47], s25 offen offset:2048 sc1 lds
    v_mfma_f32_16x16x32_bf16 v[232:235], a[24:27], v[124:127], v[232:235]
    ds_read_b64_tr_b16 a[102:103], v155 offset:1024
    v_mfma_f32_16x16x32_bf16 v[232:235], a[16:19], v[120:123], v[232:235]
    s_waitcnt lgkmcnt(4)
    v_mfma_f32_16x16x32_bf16 v[192:195], a[32:35], v[80:83], v[192:195]
    v_mfma_f32_16x16x32_bf16 v[192:195], a[40:43], v[84:87], v[192:195]
    ds_read_b128 v[104:107], v159 offset:25344
    v_mfma_f32_16x16x32_bf16 v[196:199], a[44:47], v[84:87], v[196:199]
    ds_read_b128 v[108:111], v159 offset:31488
    v_mfma_f32_16x16x32_bf16 v[196:199], a[36:39], v[80:83], v[196:199]
    ds_read_b128 v[112:115], v159 offset:25600
    v_mfma_f32_16x16x32_bf16 v[204:207], a[36:39], v[88:91], v[204:207]
    ds_read_b128 v[116:119], v159 offset:31744
    v_mfma_f32_16x16x32_bf16 v[204:207], a[44:47], v[92:95], v[204:207]
    ds_read_b128 v[120:123], v159 offset:25856
    v_mfma_f32_16x16x32_bf16 v[200:203], a[40:43], v[92:95], v[200:203]
    ds_read_b128 v[124:127], v159 offset:32000
    v_lshl_add_u32 v13, v25, 5, v24
    s_mul_i32 s84, s101, 16
    s_lshr_b32 s84, s84, 2
    s_add_u32 s84, s84, 0
    s_add_u32 s85, s84, 1
    s_cmp_eq_u32 s85, 16
    s_cselect_b32 s85, 0, s85
    s_add_u32 s86, s85, 1
    s_cmp_eq_u32 s86, 16
    s_cselect_b32 s86, 0, s86
    s_add_u32 s87, s86, 1
    s_cmp_eq_u32 s87, 16
    s_cselect_b32 s87, 0, s87
    s_add_u32 s88, s87, 1
    s_cmp_eq_u32 s88, 16
    s_cselect_b32 s88, 0, s88
    s_add_u32 s89, s88, 1
    s_cmp_eq_u32 s89, 16
    s_cselect_b32 s89, 0, s89
    s_add_u32 s90, s89, 1
    s_cmp_eq_u32 s90, 16
    s_cselect_b32 s90, 0, s90
    s_add_u32 s91, s90, 1
    s_cmp_eq_u32 s91, 16
    s_cselect_b32 s91, 0, s91
    s_add_u32 s92, s91, 1
    s_cmp_eq_u32 s92, 16
    s_cselect_b32 s92, 0, s92
    s_add_u32 s93, s92, 1
    s_cmp_eq_u32 s93, 16
    s_cselect_b32 s93, 0, s93
    s_add_u32 s94, s93, 1
    s_cmp_eq_u32 s94, 16
    s_cselect_b32 s94, 0, s94
    s_add_u32 s95, s94, 1
    s_cmp_eq_u32 s95, 16
    s_cselect_b32 s95, 0, s95
    s_add_u32 s96, s95, 1
    s_cmp_eq_u32 s96, 16
    s_cselect_b32 s96, 0, s96
    s_add_u32 s97, s96, 1
    s_cmp_eq_u32 s97, 16
    s_cselect_b32 s97, 0, s97
    s_add_u32 s98, s97, 1
    s_cmp_eq_u32 s98, 16
    s_cselect_b32 s98, 0, s98
    s_add_u32 s99, s98, 1
    s_cmp_eq_u32 s99, 16
    s_cselect_b32 s99, 0, s99
    s_mul_i32 s100, s101, 2
    s_lshr_b32 s100, s100, 2
    s_add_u32 s100, s100, 16
    s_add_u32 s101, s100, 1
    s_cmp_eq_u32 s101, 18
    s_cselect_b32 s101, 16, s101
    s_mul_i32 s7, s70, 6
    s_add_u32 s7, s7, 0
    s_mul_i32 s8, s7, 7282
    s_lshr_b32 s8, s8, 16
    s_mul_i32 s5, s8, 9
    s_sub_u32 s7, s7, s5
    s_lshl_b32 s7, s7, 2
    s_mov_b32 s4, 0xba864320
    v_mfma_f32_16x16x32_bf16 v[200:203], a[32:35], v[88:91], v[200:203]
    ds_read_b64_tr_b16 a[104:105], v154 offset:8192
    v_mfma_f32_16x16x32_bf16 v[208:211], a[32:35], v[96:99], v[208:211]
    ds_read_b64_tr_b16 a[106:107], v154 offset:9216
    v_mfma_f32_16x16x32_bf16 v[208:211], a[40:43], v[100:103], v[208:211]
    ds_read_b64_tr_b16 a[108:109], v155 offset:8192
    v_mfma_f32_16x16x32_bf16 v[212:215], a[44:47], v[100:103], v[212:215]
    ds_read_b64_tr_b16 a[110:111], v155 offset:9216
    v_mfma_f32_16x16x32_bf16 v[212:215], a[36:39], v[96:99], v[212:215]
    s_waitcnt lgkmcnt(4)
    v_mfma_f32_16x16x32_bf16 v[220:223], a[36:39], v[104:107], v[220:223]
    s_waitcnt vmcnt(17)
    s_barrier
    v_mfma_f32_16x16x32_bf16 v[220:223], a[44:47], v[108:111], v[220:223]
    ds_read_b128 v[80:83], v250 offset:0
    s_add_u32 m0, s74, 24576
    v_mfma_f32_16x16x32_bf16 v[216:219], a[40:43], v[108:111], v[216:219]
    ds_read_b128 v[84:87], v250 offset:6144
    v_mfma_f32_16x16x32_bf16 v[216:219], a[32:35], v[104:107], v[216:219]
    ds_read_b128 v[88:91], v250 offset:256
    buffer_load_dwordx4 v156, s[44:47], s26 offen offset:0 sc1 lds
    v_mfma_f32_16x16x32_bf16 v[224:227], a[32:35], v[112:115], v[224:227]
    ds_read_b128 v[92:95], v250 offset:6400
    v_mfma_f32_16x16x32_bf16 v[224:227], a[40:43], v[116:119], v[224:227]
    ds_read_b128 v[96:99], v250 offset:512
    v_mfma_f32_16x16x32_bf16 v[228:231], a[44:47], v[116:119], v[228:231]
    ds_read_b128 v[100:103], v250 offset:6656
    buffer_load_dwordx4 v157, s[44:47], s26 offen offset:1024 sc1 lds
    s_mov_b32 s5, 12
    s_lshr_b64 s[4:5], s[4:5], s7
    s_and_b32 s4, s4, 15
    s_lshl4_add_u32 s4, s8, s4
    v_lshl_add_u32 v240, s4, 8, v245
    s_mul_i32 s7, s70, 6
    s_add_u32 s7, s7, 1
    s_mul_i32 s8, s7, 7282
    s_lshr_b32 s8, s8, 16
    s_mul_i32 s5, s8, 9
    s_sub_u32 s7, s7, s5
    s_lshl_b32 s7, s7, 2
    s_mov_b32 s4, 0xba864320
    s_mov_b32 s5, 12
    s_lshr_b64 s[4:5], s[4:5], s7
    s_and_b32 s4, s4, 15
    s_lshl4_add_u32 s4, s8, s4
    v_lshl_add_u32 v241, s4, 8, v245
    s_mul_i32 s7, s70, 6
    s_add_u32 s7, s7, 2
    s_mul_i32 s8, s7, 7282
    s_lshr_b32 s8, s8, 16
    s_mul_i32 s5, s8, 9
    s_sub_u32 s7, s7, s5
    s_lshl_b32 s7, s7, 2
    s_mov_b32 s4, 0xba864320
    s_mov_b32 s5, 12
    v_mfma_f32_16x16x32_bf16 v[228:231], a[36:39], v[112:115], v[228:231]
    ds_read_b64_tr_b16 a[112:113], v152 offset:0
    v_mfma_f32_16x16x32_bf16 v[236:239], a[36:39], v[120:123], v[236:239]
    ds_read_b64_tr_b16 a[114:115], v152 offset:1024
    v_mfma_f32_16x16x32_bf16 v[236:239], a[44:47], v[124:127], v[236:239]
    ds_read_b64_tr_b16 a[116:117], v153 offset:0
    buffer_load_dwordx4 v158, s[44:47], s26 offen offset:2048 sc1 lds
    v_mfma_f32_16x16x32_bf16 v[232:235], a[40:43], v[124:127], v[232:235]
    ds_read_b64_tr_b16 a[118:119], v153 offset:1024
    v_mfma_f32_16x16x32_bf16 v[232:235], a[32:35], v[120:123], v[232:235]
    s_waitcnt lgkmcnt(4)
    v_mfma_f32_16x16x32_bf16 v[192:195], a[48:51], v[80:83], v[192:195]
    s_add_u32 m0, s73, 49152
    s_lshl_b32 s14, s76, 3
    v_mfma_f32_16x16x32_bf16 v[192:195], a[56:59], v[84:87], v[192:195]
    ds_read_b128 v[104:107], v250 offset:768
    v_mfma_f32_16x16x32_bf16 v[196:199], a[60:63], v[84:87], v[196:199]
    ds_read_b128 v[108:111], v250 offset:6912
    buffer_load_dwordx4 v148, s[48:51], s14 offen offset:0 lds
    v_mfma_f32_16x16x32_bf16 v[196:199], a[52:55], v[80:83], v[196:199]
    ds_read_b128 v[112:115], v250 offset:1024
    v_mfma_f32_16x16x32_bf16 v[204:207], a[52:55], v[88:91], v[204:207]
    ds_read_b128 v[116:119], v250 offset:7168
    buffer_load_dwordx4 v149, s[48:51], s14 offen offset:1024 lds
    v_mfma_f32_16x16x32_bf16 v[204:207], a[60:63], v[92:95], v[204:207]
    ds_read_b128 v[120:123], v250 offset:1280
    v_mfma_f32_16x16x32_bf16 v[200:203], a[56:59], v[92:95], v[200:203]
    ds_read_b128 v[124:127], v250 offset:7424
    s_lshr_b64 s[4:5], s[4:5], s7
    s_and_b32 s4, s4, 15
    s_lshl4_add_u32 s4, s8, s4
    v_lshl_add_u32 v242, s4, 8, v245
    s_mul_i32 s7, s70, 6
    s_add_u32 s7, s7, 3
    s_mul_i32 s8, s7, 7282
    s_lshr_b32 s8, s8, 16
    s_mul_i32 s5, s8, 9
    s_sub_u32 s7, s7, s5
    s_lshl_b32 s7, s7, 2
    s_mov_b32 s4, 0xba864320
    s_mov_b32 s5, 12
    s_lshr_b64 s[4:5], s[4:5], s7
    s_and_b32 s4, s4, 15
    s_lshl4_add_u32 s4, s8, s4
    v_lshl_add_u32 v243, s4, 8, v245
    s_mul_i32 s7, s70, 6
    s_add_u32 s7, s7, 4
    s_mul_i32 s8, s7, 7282
    s_lshr_b32 s8, s8, 16
    s_mul_i32 s5, s8, 9
    s_sub_u32 s7, s7, s5
    s_lshl_b32 s7, s7, 2
    s_mov_b32 s4, 0xba864320
    s_mov_b32 s5, 12
    v_mfma_f32_16x16x32_bf16 v[200:203], a[48:51], v[88:91], v[200:203]
    ds_read_b64_tr_b16 a[120:121], v152 offset:8192
    buffer_load_dwordx4 v150, s[48:51], s14 offen offset:2048 lds
    v_mfma_f32_16x16x32_bf16 v[208:211], a[48:51], v[96:99], v[208:211]
    ds_read_b64_tr_b16 a[122:123], v152 offset:9216
    v_mfma_f32_16x16x32_bf16 v[208:211], a[56:59], v[100:103], v[208:211]
    ds_read_b64_tr_b16 a[124:125], v153 offset:8192
    buffer_load_dwordx4 v151, s[48:51], s14 offen offset:3072 lds
    v_mfma_f32_16x16x32_bf16 v[212:215], a[60:63], v[100:103], v[212:215]
    ds_read_b64_tr_b16 a[126:127], v153 offset:9216
    v_mfma_f32_16x16x32_bf16 v[212:215], a[52:55], v[96:99], v[212:215]
    s_waitcnt lgkmcnt(4)
    v_mfma_f32_16x16x32_bf16 v[220:223], a[52:55], v[104:107], v[220:223]
    s_waitcnt vmcnt(21)
    s_barrier
    v_mfma_f32_16x16x32_bf16 v[220:223], a[60:63], v[108:111], v[220:223]
    ds_read_b128 v[80:83], v250 offset:12288
    s_add_u32 m0, s74, 36864
    v_mfma_f32_16x16x32_bf16 v[216:219], a[56:59], v[108:111], v[216:219]
    ds_read_b128 v[84:87], v250 offset:18432
    v_mfma_f32_16x16x32_bf16 v[216:219], a[48:51], v[104:107], v[216:219]
    ds_read_b128 v[88:91], v250 offset:12544
    buffer_load_dwordx4 v156, s[44:47], s27 offen offset:0 sc1 lds
    v_mfma_f32_16x16x32_bf16 v[224:227], a[48:51], v[112:115], v[224:227]
    ds_read_b128 v[92:95], v250 offset:18688
    v_mfma_f32_16x16x32_bf16 v[224:227], a[56:59], v[116:119], v[224:227]
    ds_read_b128 v[96:99], v250 offset:12800
    v_mfma_f32_16x16x32_bf16 v[228:231], a[60:63], v[116:119], v[228:231]
    ds_read_b128 v[100:103], v250 offset:18944
    buffer_load_dwordx4 v157, s[44:47], s27 offen offset:1024 sc1 lds
    s_lshr_b64 s[4:5], s[4:5], s7
    s_and_b32 s4, s4, 15
    s_lshl4_add_u32 s4, s8, s4
    v_lshl_add_u32 v244, s4, 8, v245
    s_mul_i32 s7, s70, 6
    s_add_u32 s7, s7, 5
    s_mul_i32 s8, s7, 7282
    s_lshr_b32 s8, s8, 16
    s_mul_i32 s5, s8, 9
    s_sub_u32 s7, s7, s5
    s_lshl_b32 s7, s7, 2
    s_mov_b32 s4, 0xba864320
    s_mov_b32 s5, 12
    s_lshr_b64 s[4:5], s[4:5], s7
    s_and_b32 s4, s4, 15
    s_lshl4_add_u32 s4, s8, s4
    v_lshl_add_u32 v245, s4, 8, v245
    s_xor_b32 s7, s75, 1
    s_lshl2_add_u32 s7, s7, s3
    s_mul_i32 s9, s7, 6144
    s_add_u32 s9, s9, 28065792
    s_lshl_b32 s7, s7, 7
    s_add_u32 s6, s7, 33374208
    s_lshl2_add_u32 s7, s75, s3
    s_mul_i32 s10, s7, 6144
    s_add_u32 s10, s10, 28065792
    s_lshl_b32 s7, s7, 7
    s_add_u32 s7, s7, 33374208
    v_mov_b32 v28, s7
    v_add_u32 v247, 3072, v246
    v_cmp_eq_u32 vcc, 0, v2
    v_mov_b32 v248, 0x40000000
    s_nop 0
    v_cndmask_b32 v248, v248, 0, vcc
    v_mfma_f32_16x16x32_bf16 v[228:231], a[52:55], v[112:115], v[228:231]
    ds_read_b64_tr_b16 a[128:129], v152 offset:16384
    v_mfma_f32_16x16x32_bf16 v[236:239], a[52:55], v[120:123], v[236:239]
    ds_read_b64_tr_b16 a[130:131], v152 offset:17408
    v_mfma_f32_16x16x32_bf16 v[236:239], a[60:63], v[124:127], v[236:239]
    ds_read_b64_tr_b16 a[132:133], v153 offset:16384
    buffer_load_dwordx4 v158, s[44:47], s27 offen offset:2048 sc1 lds
    v_mfma_f32_16x16x32_bf16 v[232:235], a[56:59], v[124:127], v[232:235]
    ds_read_b64_tr_b16 a[134:135], v153 offset:17408
    v_mfma_f32_16x16x32_bf16 v[232:235], a[48:51], v[120:123], v[232:235]
    s_waitcnt lgkmcnt(4)
    v_mfma_f32_16x16x32_bf16 v[192:195], a[64:67], v[80:83], v[192:195]
    s_add_u32 m0, s73, 65536
    s_lshl_b32 s14, s77, 3
    v_mfma_f32_16x16x32_bf16 v[192:195], a[72:75], v[84:87], v[192:195]
    ds_read_b128 v[104:107], v250 offset:13056
    v_mfma_f32_16x16x32_bf16 v[196:199], a[76:79], v[84:87], v[196:199]
    ds_read_b128 v[108:111], v250 offset:19200
    buffer_load_dwordx4 v148, s[48:51], s14 offen offset:0 lds
    v_mfma_f32_16x16x32_bf16 v[196:199], a[68:71], v[80:83], v[196:199]
    ds_read_b128 v[112:115], v250 offset:13312
    v_mfma_f32_16x16x32_bf16 v[204:207], a[68:71], v[88:91], v[204:207]
    ds_read_b128 v[116:119], v250 offset:19456
    buffer_load_dwordx4 v149, s[48:51], s14 offen offset:1024 lds
    v_mfma_f32_16x16x32_bf16 v[204:207], a[76:79], v[92:95], v[204:207]
    ds_read_b128 v[120:123], v250 offset:13568
    v_mfma_f32_16x16x32_bf16 v[200:203], a[72:75], v[92:95], v[200:203]
    ds_read_b128 v[124:127], v250 offset:19712
    v_mov_b32 v249, s68
    v_and_b32 v129, 0xffff0000, v144
    v_lshlrev_b32 v128, 16, v144
    v_and_b32 v131, 0xffff0000, v145
    v_lshlrev_b32 v130, 16, v145
    v_and_b32 v133, 0xffff0000, v146
    v_lshlrev_b32 v132, 16, v146
    v_and_b32 v135, 0xffff0000, v147
    v_lshlrev_b32 v134, 16, v147
    s_lshr_b32 s4, s75, 2
    s_lshl_b32 s4, s4, 7
    s_and_b32 s5, s75, 3
    s_lshl2_add_u32 s4, s5, s4
    s_add_u32 s4, s4, 12566528
    v_min_u32 v17, 1, v0
    v_lshlrev_b32 v17, 30, v17
    v_add_u32 v17, s4, v17
    s_and_b32 s4, s72, 1
    s_lshl_b32 s4, s4, 2
    s_add_u32 s4, s4, s3
    s_mul_i32 s4, s4, 18
    s_lshr_b32 s4, s4, 2
    s_mul_i32 s4, s4, 6
    s_lshr_b32 s5, s72, 1
    s_mul_i32 s5, s5, 3
    s_lshr_b32 s5, s5, 1
    v_mfma_f32_16x16x32_bf16 v[200:203], a[64:67], v[88:91], v[200:203]
    ds_read_b64_tr_b16 a[136:137], v152 offset:24576
    buffer_load_dwordx4 v150, s[48:51], s14 offen offset:2048 lds
    v_mfma_f32_16x16x32_bf16 v[208:211], a[64:67], v[96:99], v[208:211]
    ds_read_b64_tr_b16 a[138:139], v152 offset:25600
    v_mfma_f32_16x16x32_bf16 v[208:211], a[72:75], v[100:103], v[208:211]
    ds_read_b64_tr_b16 a[140:141], v153 offset:24576
    buffer_load_dwordx4 v151, s[48:51], s14 offen offset:3072 lds
    v_mfma_f32_16x16x32_bf16 v[212:215], a[76:79], v[100:103], v[212:215]
    ds_read_b64_tr_b16 a[142:143], v153 offset:25600
    v_mfma_f32_16x16x32_bf16 v[212:215], a[68:71], v[96:99], v[212:215]
    s_waitcnt lgkmcnt(4)
    v_mfma_f32_16x16x32_bf16 v[220:223], a[68:71], v[104:107], v[220:223]
    s_waitcnt vmcnt(17)
    s_barrier
    v_mfma_f32_16x16x32_bf16 v[220:223], a[76:79], v[108:111], v[220:223]
    ds_read_b128 v[80:83], v250 offset:24576
    s_add_u32 m0, s74, 49152
    v_mfma_f32_16x16x32_bf16 v[216:219], a[72:75], v[108:111], v[216:219]
    ds_read_b128 v[84:87], v250 offset:30720
    v_mfma_f32_16x16x32_bf16 v[216:219], a[64:67], v[104:107], v[216:219]
    ds_read_b128 v[88:91], v250 offset:24832
    buffer_load_dwordx4 v156, s[44:47], s76 offen offset:0 sc1 lds
    v_mfma_f32_16x16x32_bf16 v[224:227], a[64:67], v[112:115], v[224:227]
    ds_read_b128 v[92:95], v250 offset:30976
    v_mfma_f32_16x16x32_bf16 v[224:227], a[72:75], v[116:119], v[224:227]
    ds_read_b128 v[96:99], v250 offset:25088
    v_mfma_f32_16x16x32_bf16 v[228:231], a[76:79], v[116:119], v[228:231]
    ds_read_b128 v[100:103], v250 offset:31232
    buffer_load_dwordx4 v157, s[44:47], s76 offen offset:1024 sc1 lds
    s_add_u32 s4, s4, s5
    v_min_u32 v18, 9, v2
    v_lshrrev_b32 v19, 1, v18
    v_lshl_add_u32 v18, v19, 2, v18
    v_add_u32 v18, s4, v18
    v_and_b32 v19, 3, v18
    v_lshrrev_b32 v18, 2, v18
    v_lshlrev_b32 v18, 7, v18
    v_lshl_add_u32 v18, v19, 2, v18
    v_add_u32 v18, 12566528, v18
    v_lshrrev_b32 v31, 4, v2
    v_mul_u32_u24 v24, 17408, v31
    v_and_b32 v25, 15, v2
    v_lshl_add_u32 v24, v25, 4, v24
    s_and_b32 s7, s72, 1
    s_lshl_b32 s7, s7, 2
    s_add_u32 s7, s7, s3
    s_mul_i32 s7, s7, 1253376
    s_lshr_b32 s8, s72, 1
    s_lshl_b32 s8, s8, 12
    s_add_u32 s7, s7, s8
    s_add_u32 s7, s7, 12795904
    v_add_u32 v9, s7, v24
    s_and_b32 s12, s72, 1
    s_xor_b32 s8, s12, 1
    s_lshl_b32 s8, s8, 11
    v_add_u32 v8, s8, v9
    v_mfma_f32_16x16x32_bf16 v[228:231], a[68:71], v[112:115], v[228:231]
    ds_read_b64_tr_b16 a[144:145], v152 offset:32768
    v_mfma_f32_16x16x32_bf16 v[236:239], a[68:71], v[120:123], v[236:239]
    ds_read_b64_tr_b16 a[146:147], v152 offset:33792
    v_mfma_f32_16x16x32_bf16 v[236:239], a[76:79], v[124:127], v[236:239]
    ds_read_b64_tr_b16 a[148:149], v153 offset:32768
    buffer_load_dwordx4 v158, s[44:47], s76 offen offset:2048 sc1 lds
    v_mfma_f32_16x16x32_bf16 v[232:235], a[72:75], v[124:127], v[232:235]
    ds_read_b64_tr_b16 a[150:151], v153 offset:33792
    v_mfma_f32_16x16x32_bf16 v[232:235], a[64:67], v[120:123], v[232:235]
    s_waitcnt lgkmcnt(4)
    v_mfma_f32_16x16x32_bf16 v[192:195], a[80:83], v[80:83], v[192:195]
    s_add_u32 m0, s73, 0
    s_lshl_b32 s14, s78, 3
    v_mfma_f32_16x16x32_bf16 v[192:195], a[88:91], v[84:87], v[192:195]
    ds_read_b128 v[104:107], v250 offset:25344
    v_mfma_f32_16x16x32_bf16 v[196:199], a[92:95], v[84:87], v[196:199]
    ds_read_b128 v[108:111], v250 offset:31488
    buffer_load_dwordx4 v148, s[48:51], s14 offen offset:0 lds
    v_mfma_f32_16x16x32_bf16 v[196:199], a[84:87], v[80:83], v[196:199]
    ds_read_b128 v[112:115], v250 offset:25600
    v_mfma_f32_16x16x32_bf16 v[204:207], a[84:87], v[88:91], v[204:207]
    ds_read_b128 v[116:119], v250 offset:31744
    buffer_load_dwordx4 v149, s[48:51], s14 offen offset:1024 lds
    v_mfma_f32_16x16x32_bf16 v[204:207], a[92:95], v[92:95], v[204:207]
    ds_read_b128 v[120:123], v250 offset:25856
    v_mfma_f32_16x16x32_bf16 v[200:203], a[88:91], v[92:95], v[200:203]
    ds_read_b128 v[124:127], v250 offset:32000
    s_lshl_b32 s11, s12, 12
    s_sub_u32 s11, s11, 2048
    s_mov_b32 s64, s38
    s_and_b32 s65, s39, 0xffff
    s_mov_b32 s66, 2359296
    s_mov_b32 s67, 0x20000
    s_mov_b32 s56, s16
    s_and_b32 s57, s17, 0xffff
    s_mov_b32 s58, 2359296
    s_mov_b32 s59, 0x20000
    v_add_u32 v24, 0, v2
    v_mul_u32_u24 v25, 7282, v24
    v_lshrrev_b32 v25, 16, v25
    v_mul_u32_u24 v25, 1008, v25
    v_lshl_add_u32 v14, v2, 4, v25
    v_add_u32 v24, 64, v2
    v_mul_u32_u24 v25, 7282, v24
    v_lshrrev_b32 v25, 16, v25
    v_mul_u32_u24 v25, 1008, v25
    v_lshl_add_u32 v15, v2, 4, v25
    v_add_u32 v24, 128, v2
    v_mul_u32_u24 v25, 7282, v24
    v_lshrrev_b32 v25, 16, v25
    v_mul_u32_u24 v25, 1008, v25
    v_lshl_add_u32 v16, v2, 4, v25
    v_cmp_gt_u32 vcc, 16, v2
    v_mov_b32 v25, 0x40000000
    v_mfma_f32_16x16x32_bf16 v[200:203], a[80:83], v[88:91], v[200:203]
    ds_read_b64_tr_b16 a[152:153], v152 offset:40960
    buffer_load_dwordx4 v150, s[48:51], s14 offen offset:2048 lds
    v_mfma_f32_16x16x32_bf16 v[208:211], a[80:83], v[96:99], v[208:211]
    ds_read_b64_tr_b16 a[154:155], v152 offset:41984
    v_mfma_f32_16x16x32_bf16 v[208:211], a[88:91], v[100:103], v[208:211]
    ds_read_b64_tr_b16 a[156:157], v153 offset:40960
    buffer_load_dwordx4 v151, s[48:51], s14 offen offset:3072 lds
    v_mfma_f32_16x16x32_bf16 v[212:215], a[92:95], v[100:103], v[212:215]
    ds_read_b64_tr_b16 a[158:159], v153 offset:41984
    v_mfma_f32_16x16x32_bf16 v[212:215], a[84:87], v[96:99], v[212:215]
    s_waitcnt lgkmcnt(4)
    v_mfma_f32_16x16x32_bf16 v[220:223], a[84:87], v[104:107], v[220:223]
    s_waitcnt vmcnt(14)
    s_barrier
    v_mfma_f32_16x16x32_bf16 v[220:223], a[92:95], v[108:111], v[220:223]
    ds_read_b128 v[80:83], v159 offset:0
    s_add_u32 m0, s74, 61440
    v_mfma_f32_16x16x32_bf16 v[216:219], a[88:91], v[108:111], v[216:219]
    ds_read_b128 v[84:87], v159 offset:6144
    v_mfma_f32_16x16x32_bf16 v[216:219], a[80:83], v[104:107], v[216:219]
    ds_read_b128 v[88:91], v159 offset:256
    buffer_load_dwordx4 v156, s[44:47], s77 offen offset:0 sc1 lds
    v_mfma_f32_16x16x32_bf16 v[224:227], a[80:83], v[112:115], v[224:227]
    ds_read_b128 v[92:95], v159 offset:6400
    v_mfma_f32_16x16x32_bf16 v[224:227], a[88:91], v[116:119], v[224:227]
    ds_read_b128 v[96:99], v159 offset:512
    v_mfma_f32_16x16x32_bf16 v[228:231], a[92:95], v[116:119], v[228:231]
    ds_read_b128 v[100:103], v159 offset:6656
    buffer_load_dwordx4 v157, s[44:47], s77 offen offset:1024 sc1 lds
    v_cndmask_b32 v16, v25, v16, vcc
    s_and_b32 s7, s72, 1
    s_lshl_b32 s7, s7, 2
    s_add_u32 s7, s7, s3
    s_mul_i32 s7, s7, 2359296
    v_subrev_u32 v3, s7, v4
    v_and_b32 v24, 15, v2
    v_mul_u32_u24 v24, 144, v24
    v_lshrrev_b32 v25, 4, v2
    v_lshl_add_u32 v24, v25, 3, v24
    s_add_u32 s7, s73, 131072
    s_lshl_b32 s4, s12, 4
    s_add_u32 s4, s4, s7
    v_add_u32 v1, s4, v24
    s_mul_i32 s4, s12, 144
L_pl_G_2:
    s_cbranch_execz L_pl_G_6
    s_sub_u32 s4, s7, s4
    v_add_u32 v24, s4, v24
    v_bfe_u32 v25, v2, 2, 3
    v_lshlrev_b32 v25, 7, v25
    v_lshrrev_b32 v31, 5, v2
    v_lshl_add_u32 v25, v31, 12, v25
    v_bfe_u32 v31, v2, 3, 2
    v_xor_b32 v31, s3, v31
    v_lshl_add_u32 v25, v31, 5, v25
    v_and_b32 v31, 3, v2
    v_lshl_add_u32 v25, v31, 3, v25
    v_add_u32 v25, 147456, v25
    v_mfma_f32_16x16x32_bf16 v[228:231], a[84:87], v[112:115], v[228:231]
    ds_read_b64_tr_b16 a[160:161], v152 offset:49152
    v_mfma_f32_16x16x32_bf16 v[236:239], a[84:87], v[120:123], v[236:239]
    ds_read_b64_tr_b16 a[162:163], v152 offset:50176
    v_mfma_f32_16x16x32_bf16 v[236:239], a[92:95], v[124:127], v[236:239]
    ds_read_b64_tr_b16 a[164:165], v153 offset:49152
    buffer_load_dwordx4 v158, s[44:47], s77 offen offset:2048 sc1 lds
    v_mfma_f32_16x16x32_bf16 v[232:235], a[88:91], v[124:127], v[232:235]
    ds_read_b64_tr_b16 a[166:167], v153 offset:50176
    v_mfma_f32_16x16x32_bf16 v[232:235], a[80:83], v[120:123], v[232:235]
    s_waitcnt lgkmcnt(4)
    v_mfma_f32_16x16x32_bf16 v[192:195], a[96:99], v[80:83], v[192:195]
    s_add_u32 m0, s73, 16384
    s_lshl_b32 s14, s79, 3
    v_mfma_f32_16x16x32_bf16 v[192:195], a[104:107], v[84:87], v[192:195]
    ds_read_b128 v[104:107], v159 offset:768
    v_mfma_f32_16x16x32_bf16 v[196:199], a[108:111], v[84:87], v[196:199]
    ds_read_b128 v[108:111], v159 offset:6912
    buffer_load_dwordx4 v148, s[48:51], s14 offen offset:0 lds
    v_mfma_f32_16x16x32_bf16 v[196:199], a[100:103], v[80:83], v[196:199]
    ds_read_b128 v[112:115], v159 offset:1024
    v_mfma_f32_16x16x32_bf16 v[204:207], a[100:103], v[88:91], v[204:207]
    ds_read_b128 v[116:119], v159 offset:7168
    buffer_load_dwordx4 v149, s[48:51], s14 offen offset:1024 lds
    v_mfma_f32_16x16x32_bf16 v[204:207], a[108:111], v[92:95], v[204:207]
    ds_read_b128 v[120:123], v159 offset:1280
    v_mfma_f32_16x16x32_bf16 v[200:203], a[104:107], v[92:95], v[200:203]
    ds_read_b128 v[124:127], v159 offset:7424
    v_mfma_f32_16x16x32_bf16 v[200:203], a[96:99], v[88:91], v[200:203]
    ds_read_b64_tr_b16 a[168:169], v152 offset:57344
    buffer_load_dwordx4 v150, s[48:51], s14 offen offset:2048 lds
    v_mfma_f32_16x16x32_bf16 v[208:211], a[96:99], v[96:99], v[208:211]
    ds_read_b64_tr_b16 a[170:171], v152 offset:58368
    v_mfma_f32_16x16x32_bf16 v[208:211], a[104:107], v[100:103], v[208:211]
    ds_read_b64_tr_b16 a[172:173], v153 offset:57344
    buffer_load_dwordx4 v151, s[48:51], s14 offen offset:3072 lds
    v_mfma_f32_16x16x32_bf16 v[212:215], a[108:111], v[100:103], v[212:215]
    ds_read_b64_tr_b16 a[174:175], v153 offset:58368
    v_mfma_f32_16x16x32_bf16 v[212:215], a[100:103], v[96:99], v[212:215]
    s_waitcnt lgkmcnt(4)
    v_mfma_f32_16x16x32_bf16 v[220:223], a[100:103], v[104:107], v[220:223]
    s_waitcnt vmcnt(14)
    s_barrier
    v_mfma_f32_16x16x32_bf16 v[220:223], a[108:111], v[108:111], v[220:223]
    ds_read_b128 v[80:83], v159 offset:12288
    s_add_u32 m0, s74, 0
    v_mfma_f32_16x16x32_bf16 v[216:219], a[104:107], v[108:111], v[216:219]
    ds_read_b128 v[84:87], v159 offset:18432
    v_mfma_f32_16x16x32_bf16 v[216:219], a[96:99], v[104:107], v[216:219]
    ds_read_b128 v[88:91], v159 offset:12544
    buffer_load_dwordx4 v156, s[44:47], s78 offen offset:0 sc1 lds
    v_mfma_f32_16x16x32_bf16 v[224:227], a[96:99], v[112:115], v[224:227]
    ds_read_b128 v[92:95], v159 offset:18688
    v_mfma_f32_16x16x32_bf16 v[224:227], a[104:107], v[116:119], v[224:227]
    ds_read_b128 v[96:99], v159 offset:12800
    v_mfma_f32_16x16x32_bf16 v[228:231], a[108:111], v[116:119], v[228:231]
    ds_read_b128 v[100:103], v159 offset:18944
    buffer_load_dwordx4 v157, s[44:47], s78 offen offset:1024 sc1 lds
    v_mfma_f32_16x16x32_bf16 v[228:231], a[100:103], v[112:115], v[228:231]
    ds_read_b64_tr_b16 a[176:177], v154 offset:0
    v_mfma_f32_16x16x32_bf16 v[236:239], a[100:103], v[120:123], v[236:239]
    ds_read_b64_tr_b16 a[178:179], v154 offset:1024
    v_mfma_f32_16x16x32_bf16 v[236:239], a[108:111], v[124:127], v[236:239]
    ds_read_b64_tr_b16 a[180:181], v155 offset:0
    buffer_load_dwordx4 v158, s[44:47], s78 offen offset:2048 sc1 lds
    v_mfma_f32_16x16x32_bf16 v[232:235], a[104:107], v[124:127], v[232:235]
    ds_read_b64_tr_b16 a[182:183], v155 offset:1024
    v_mfma_f32_16x16x32_bf16 v[232:235], a[96:99], v[120:123], v[232:235]
    s_waitcnt lgkmcnt(4)
    v_mfma_f32_16x16x32_bf16 v[192:195], a[112:115], v[80:83], v[192:195]
    s_add_u32 m0, s73, 32768
    s_lshl_b32 s14, s80, 3
    v_mfma_f32_16x16x32_bf16 v[192:195], a[120:123], v[84:87], v[192:195]
    ds_read_b128 v[104:107], v159 offset:13056
    v_mfma_f32_16x16x32_bf16 v[196:199], a[124:127], v[84:87], v[196:199]
    ds_read_b128 v[108:111], v159 offset:19200
    buffer_load_dwordx4 v148, s[48:51], s14 offen offset:0 lds
    v_mfma_f32_16x16x32_bf16 v[196:199], a[116:119], v[80:83], v[196:199]
    ds_read_b128 v[112:115], v159 offset:13312
    v_mfma_f32_16x16x32_bf16 v[204:207], a[116:119], v[88:91], v[204:207]
    ds_read_b128 v[116:119], v159 offset:19456
    buffer_load_dwordx4 v149, s[48:51], s14 offen offset:1024 lds
    v_mfma_f32_16x16x32_bf16 v[204:207], a[124:127], v[92:95], v[204:207]
    ds_read_b128 v[120:123], v159 offset:13568
    v_mfma_f32_16x16x32_bf16 v[200:203], a[120:123], v[92:95], v[200:203]
    ds_read_b128 v[124:127], v159 offset:19712
    v_mfma_f32_16x16x32_bf16 v[200:203], a[112:115], v[88:91], v[200:203]
    ds_read_b64_tr_b16 a[184:185], v154 offset:8192
    buffer_load_dwordx4 v150, s[48:51], s14 offen offset:2048 lds
    v_mfma_f32_16x16x32_bf16 v[208:211], a[112:115], v[96:99], v[208:211]
    ds_read_b64_tr_b16 a[186:187], v154 offset:9216
    v_mfma_f32_16x16x32_bf16 v[208:211], a[120:123], v[100:103], v[208:211]
    ds_read_b64_tr_b16 a[188:189], v155 offset:8192
    buffer_load_dwordx4 v151, s[48:51], s14 offen offset:3072 lds
    v_mfma_f32_16x16x32_bf16 v[212:215], a[124:127], v[100:103], v[212:215]
    ds_read_b64_tr_b16 a[190:191], v155 offset:9216
    v_mfma_f32_16x16x32_bf16 v[212:215], a[116:119], v[96:99], v[212:215]
    s_waitcnt lgkmcnt(4)
    v_mfma_f32_16x16x32_bf16 v[220:223], a[116:119], v[104:107], v[220:223]
    s_waitcnt vmcnt(14)
    s_barrier
    v_mfma_f32_16x16x32_bf16 v[220:223], a[124:127], v[108:111], v[220:223]
    ds_read_b128 v[80:83], v159 offset:24576
    s_add_u32 m0, s74, 12288
    v_mfma_f32_16x16x32_bf16 v[216:219], a[120:123], v[108:111], v[216:219]
    ds_read_b128 v[84:87], v159 offset:30720
    v_mfma_f32_16x16x32_bf16 v[216:219], a[112:115], v[104:107], v[216:219]
    ds_read_b128 v[88:91], v159 offset:24832
    buffer_load_dwordx4 v156, s[44:47], s79 offen offset:0 sc1 lds
    v_mfma_f32_16x16x32_bf16 v[224:227], a[112:115], v[112:115], v[224:227]
    ds_read_b128 v[92:95], v159 offset:30976
    v_mfma_f32_16x16x32_bf16 v[224:227], a[120:123], v[116:119], v[224:227]
    ds_read_b128 v[96:99], v159 offset:25088
    v_mfma_f32_16x16x32_bf16 v[228:231], a[124:127], v[116:119], v[228:231]
    ds_read_b128 v[100:103], v159 offset:31232
    buffer_load_dwordx4 v157, s[44:47], s79 offen offset:1024 sc1 lds
    v_mfma_f32_16x16x32_bf16 v[228:231], a[116:119], v[112:115], v[228:231]
    ds_read_b64_tr_b16 a[192:193], v152 offset:0
    v_mfma_f32_16x16x32_bf16 v[236:239], a[116:119], v[120:123], v[236:239]
    ds_read_b64_tr_b16 a[194:195], v152 offset:1024
    v_mfma_f32_16x16x32_bf16 v[236:239], a[124:127], v[124:127], v[236:239]
    ds_read_b64_tr_b16 a[196:197], v153 offset:0
    buffer_load_dwordx4 v158, s[44:47], s79 offen offset:2048 sc1 lds
    v_mfma_f32_16x16x32_bf16 v[232:235], a[120:123], v[124:127], v[232:235]
    ds_read_b64_tr_b16 a[198:199], v153 offset:1024
    v_mfma_f32_16x16x32_bf16 v[232:235], a[112:115], v[120:123], v[232:235]
    s_waitcnt lgkmcnt(4)
    v_mfma_f32_16x16x32_bf16 v[192:195], a[128:131], v[80:83], v[192:195]
    s_add_u32 m0, s73, 49152
    s_lshl_b32 s14, s81, 3
    v_mfma_f32_16x16x32_bf16 v[192:195], a[136:139], v[84:87], v[192:195]
    ds_read_b128 v[104:107], v159 offset:25344
    v_mfma_f32_16x16x32_bf16 v[196:199], a[140:143], v[84:87], v[196:199]
    ds_read_b128 v[108:111], v159 offset:31488
    buffer_load_dwordx4 v148, s[48:51], s14 offen offset:0 lds
    v_mfma_f32_16x16x32_bf16 v[196:199], a[132:135], v[80:83], v[196:199]
    ds_read_b128 v[112:115], v159 offset:25600
    v_mfma_f32_16x16x32_bf16 v[204:207], a[132:135], v[88:91], v[204:207]
    ds_read_b128 v[116:119], v159 offset:31744
    buffer_load_dwordx4 v149, s[48:51], s14 offen offset:1024 lds
    v_mfma_f32_16x16x32_bf16 v[204:207], a[140:143], v[92:95], v[204:207]
    ds_read_b128 v[120:123], v159 offset:25856
    v_mfma_f32_16x16x32_bf16 v[200:203], a[136:139], v[92:95], v[200:203]
    ds_read_b128 v[124:127], v159 offset:32000
    v_mfma_f32_16x16x32_bf16 v[200:203], a[128:131], v[88:91], v[200:203]
    ds_read_b64_tr_b16 a[200:201], v152 offset:8192
    buffer_load_dwordx4 v150, s[48:51], s14 offen offset:2048 lds
    v_mfma_f32_16x16x32_bf16 v[208:211], a[128:131], v[96:99], v[208:211]
    ds_read_b64_tr_b16 a[202:203], v152 offset:9216
    v_mfma_f32_16x16x32_bf16 v[208:211], a[136:139], v[100:103], v[208:211]
    ds_read_b64_tr_b16 a[204:205], v153 offset:8192
    buffer_load_dwordx4 v151, s[48:51], s14 offen offset:3072 lds
    v_mfma_f32_16x16x32_bf16 v[212:215], a[140:143], v[100:103], v[212:215]
    ds_read_b64_tr_b16 a[206:207], v153 offset:9216
    v_mfma_f32_16x16x32_bf16 v[212:215], a[132:135], v[96:99], v[212:215]
    s_waitcnt lgkmcnt(4)
    v_mfma_f32_16x16x32_bf16 v[220:223], a[132:135], v[104:107], v[220:223]
    s_waitcnt vmcnt(14)
    s_barrier
    v_mfma_f32_16x16x32_bf16 v[220:223], a[140:143], v[108:111], v[220:223]
    ds_read_b128 v[80:83], v250 offset:0
    s_add_u32 m0, s74, 24576
    v_mfma_f32_16x16x32_bf16 v[216:219], a[136:139], v[108:111], v[216:219]
    ds_read_b128 v[84:87], v250 offset:6144
    v_mfma_f32_16x16x32_bf16 v[216:219], a[128:131], v[104:107], v[216:219]
    ds_read_b128 v[88:91], v250 offset:256
    buffer_load_dwordx4 v156, s[44:47], s80 offen offset:0 sc1 lds
    v_mfma_f32_16x16x32_bf16 v[224:227], a[128:131], v[112:115], v[224:227]
    ds_read_b128 v[92:95], v250 offset:6400
    v_mfma_f32_16x16x32_bf16 v[224:227], a[136:139], v[116:119], v[224:227]
    ds_read_b128 v[96:99], v250 offset:512
    v_mfma_f32_16x16x32_bf16 v[228:231], a[140:143], v[116:119], v[228:231]
    ds_read_b128 v[100:103], v250 offset:6656
    buffer_load_dwordx4 v157, s[44:47], s80 offen offset:1024 sc1 lds
    v_mfma_f32_16x16x32_bf16 v[228:231], a[132:135], v[112:115], v[228:231]
    ds_read_b64_tr_b16 a[208:209], v152 offset:16384
    v_mfma_f32_16x16x32_bf16 v[236:239], a[132:135], v[120:123], v[236:239]
    ds_read_b64_tr_b16 a[210:211], v152 offset:17408
    v_mfma_f32_16x16x32_bf16 v[236:239], a[140:143], v[124:127], v[236:239]
    ds_read_b64_tr_b16 a[212:213], v153 offset:16384
    buffer_load_dwordx4 v158, s[44:47], s80 offen offset:2048 sc1 lds
    v_mfma_f32_16x16x32_bf16 v[232:235], a[136:139], v[124:127], v[232:235]
    ds_read_b64_tr_b16 a[214:215], v153 offset:17408
    v_mfma_f32_16x16x32_bf16 v[232:235], a[128:131], v[120:123], v[232:235]
    s_waitcnt lgkmcnt(4)
    v_mfma_f32_16x16x32_bf16 v[192:195], a[144:147], v[80:83], v[192:195]
    s_add_u32 m0, s73, 65536
    s_lshl_b32 s14, s84, 17
    v_mfma_f32_16x16x32_bf16 v[192:195], a[152:155], v[84:87], v[192:195]
    ds_read_b128 v[104:107], v250 offset:768
    v_mfma_f32_16x16x32_bf16 v[196:199], a[156:159], v[84:87], v[196:199]
    ds_read_b128 v[108:111], v250 offset:6912
    buffer_load_dwordx4 v4, s[52:55], s14 offen offset:0 lds
    v_mfma_f32_16x16x32_bf16 v[196:199], a[148:151], v[80:83], v[196:199]
    ds_read_b128 v[112:115], v250 offset:1024
    v_mfma_f32_16x16x32_bf16 v[204:207], a[148:151], v[88:91], v[204:207]
    ds_read_b128 v[116:119], v250 offset:7168
    buffer_load_dwordx4 v5, s[52:55], s14 offen offset:1024 lds
    v_mfma_f32_16x16x32_bf16 v[204:207], a[156:159], v[92:95], v[204:207]
    ds_read_b128 v[120:123], v250 offset:1280
    v_mfma_f32_16x16x32_bf16 v[200:203], a[152:155], v[92:95], v[200:203]
    ds_read_b128 v[124:127], v250 offset:7424
    v_mfma_f32_16x16x32_bf16 v[200:203], a[144:147], v[88:91], v[200:203]
    ds_read_b64_tr_b16 a[216:217], v152 offset:24576
    buffer_load_dwordx4 v6, s[52:55], s14 offen offset:2048 lds
    v_mfma_f32_16x16x32_bf16 v[208:211], a[144:147], v[96:99], v[208:211]
    ds_read_b64_tr_b16 a[218:219], v152 offset:25600
    v_mfma_f32_16x16x32_bf16 v[208:211], a[152:155], v[100:103], v[208:211]
    ds_read_b64_tr_b16 a[220:221], v153 offset:24576
    buffer_load_dwordx4 v7, s[52:55], s14 offen offset:3072 lds
    v_mfma_f32_16x16x32_bf16 v[212:215], a[156:159], v[100:103], v[212:215]
    ds_read_b64_tr_b16 a[222:223], v153 offset:25600
    v_mfma_f32_16x16x32_bf16 v[212:215], a[148:151], v[96:99], v[212:215]
    s_waitcnt lgkmcnt(4)
    v_mfma_f32_16x16x32_bf16 v[220:223], a[148:151], v[104:107], v[220:223]
    s_waitcnt vmcnt(14)
    s_barrier
    v_mfma_f32_16x16x32_bf16 v[220:223], a[156:159], v[108:111], v[220:223]
    ds_read_b128 v[80:83], v250 offset:12288
    v_mfma_f32_16x16x32_bf16 v[216:219], a[152:155], v[108:111], v[216:219]
    ds_read_b128 v[84:87], v250 offset:18432
    v_mfma_f32_16x16x32_bf16 v[216:219], a[144:147], v[104:107], v[216:219]
    ds_read_b128 v[88:91], v250 offset:12544
    v_mfma_f32_16x16x32_bf16 v[224:227], a[144:147], v[112:115], v[224:227]
    ds_read_b128 v[92:95], v250 offset:18688
    v_mfma_f32_16x16x32_bf16 v[224:227], a[152:155], v[116:119], v[224:227]
    ds_read_b128 v[96:99], v250 offset:12800
    v_mfma_f32_16x16x32_bf16 v[228:231], a[156:159], v[116:119], v[228:231]
    ds_read_b128 v[100:103], v250 offset:18944
    v_mfma_f32_16x16x32_bf16 v[228:231], a[148:151], v[112:115], v[228:231]
    ds_read_b64_tr_b16 a[224:225], v152 offset:32768
    v_mfma_f32_16x16x32_bf16 v[236:239], a[148:151], v[120:123], v[236:239]
    ds_read_b64_tr_b16 a[226:227], v152 offset:33792
    v_mfma_f32_16x16x32_bf16 v[236:239], a[156:159], v[124:127], v[236:239]
    ds_read_b64_tr_b16 a[228:229], v153 offset:32768
    v_mfma_f32_16x16x32_bf16 v[232:235], a[152:155], v[124:127], v[232:235]
    ds_read_b64_tr_b16 a[230:231], v153 offset:33792
    v_mfma_f32_16x16x32_bf16 v[232:235], a[144:147], v[120:123], v[232:235]
    s_waitcnt lgkmcnt(4)
    v_mfma_f32_16x16x32_bf16 v[192:195], a[160:163], v[80:83], v[192:195]
    v_mfma_f32_16x16x32_bf16 v[192:195], a[168:171], v[84:87], v[192:195]
    ds_read_b128 v[104:107], v250 offset:13056
    v_mfma_f32_16x16x32_bf16 v[196:199], a[172:175], v[84:87], v[196:199]
    ds_read_b128 v[108:111], v250 offset:19200
    v_mfma_f32_16x16x32_bf16 v[196:199], a[164:167], v[80:83], v[196:199]
    ds_read_b128 v[112:115], v250 offset:13312
    v_mfma_f32_16x16x32_bf16 v[204:207], a[164:167], v[88:91], v[204:207]
    ds_read_b128 v[116:119], v250 offset:19456
    v_mfma_f32_16x16x32_bf16 v[204:207], a[172:175], v[92:95], v[204:207]
    ds_read_b128 v[120:123], v250 offset:13568
    v_mfma_f32_16x16x32_bf16 v[200:203], a[168:171], v[92:95], v[200:203]
    ds_read_b128 v[124:127], v250 offset:19712
    v_mfma_f32_16x16x32_bf16 v[200:203], a[160:163], v[88:91], v[200:203]
    ds_read_b64_tr_b16 a[232:233], v152 offset:40960
    v_mfma_f32_16x16x32_bf16 v[208:211], a[160:163], v[96:99], v[208:211]
    ds_read_b64_tr_b16 a[234:235], v152 offset:41984
    v_mfma_f32_16x16x32_bf16 v[208:211], a[168:171], v[100:103], v[208:211]
    ds_read_b64_tr_b16 a[236:237], v153 offset:40960
    v_mfma_f32_16x16x32_bf16 v[212:215], a[172:175], v[100:103], v[212:215]
    ds_read_b64_tr_b16 a[238:239], v153 offset:41984
    v_mfma_f32_16x16x32_bf16 v[212:215], a[164:167], v[96:99], v[212:215]
    s_waitcnt lgkmcnt(4)
    v_mfma_f32_16x16x32_bf16 v[220:223], a[164:167], v[104:107], v[220:223]
    s_waitcnt vmcnt(7)
    s_barrier
    v_mfma_f32_16x16x32_bf16 v[220:223], a[172:175], v[108:111], v[220:223]
    ds_read_b128 v[80:83], v250 offset:24576
    v_mfma_f32_16x16x32_bf16 v[216:219], a[168:171], v[108:111], v[216:219]
    ds_read_b128 v[84:87], v250 offset:30720
    v_mfma_f32_16x16x32_bf16 v[216:219], a[160:163], v[104:107], v[216:219]
    ds_read_b128 v[88:91], v250 offset:24832
    v_mfma_f32_16x16x32_bf16 v[224:227], a[160:163], v[112:115], v[224:227]
    ds_read_b128 v[92:95], v250 offset:30976
    v_mfma_f32_16x16x32_bf16 v[224:227], a[168:171], v[116:119], v[224:227]
    ds_read_b128 v[96:99], v250 offset:25088
    v_mfma_f32_16x16x32_bf16 v[228:231], a[172:175], v[116:119], v[228:231]
    ds_read_b128 v[100:103], v250 offset:31232
    v_mfma_f32_16x16x32_bf16 v[228:231], a[164:167], v[112:115], v[228:231]
    ds_read_b64_tr_b16 a[240:241], v152 offset:49152
    v_mfma_f32_16x16x32_bf16 v[236:239], a[164:167], v[120:123], v[236:239]
    ds_read_b64_tr_b16 a[242:243], v152 offset:50176
    v_mfma_f32_16x16x32_bf16 v[236:239], a[172:175], v[124:127], v[236:239]
    ds_read_b64_tr_b16 a[244:245], v153 offset:49152
    v_mfma_f32_16x16x32_bf16 v[232:235], a[168:171], v[124:127], v[232:235]
    ds_read_b64_tr_b16 a[246:247], v153 offset:50176
    v_mfma_f32_16x16x32_bf16 v[232:235], a[160:163], v[120:123], v[232:235]
    s_waitcnt lgkmcnt(4)
    v_mfma_f32_16x16x32_bf16 v[192:195], a[176:179], v[80:83], v[192:195]
    v_mfma_f32_16x16x32_bf16 v[192:195], a[184:187], v[84:87], v[192:195]
    ds_read_b128 v[104:107], v250 offset:25344
    v_mfma_f32_16x16x32_bf16 v[196:199], a[188:191], v[84:87], v[196:199]
    ds_read_b128 v[108:111], v250 offset:31488
    v_mfma_f32_16x16x32_bf16 v[196:199], a[180:183], v[80:83], v[196:199]
    ds_read_b128 v[112:115], v250 offset:25600
    v_mfma_f32_16x16x32_bf16 v[204:207], a[180:183], v[88:91], v[204:207]
    ds_read_b128 v[116:119], v250 offset:31744
    v_mfma_f32_16x16x32_bf16 v[204:207], a[188:191], v[92:95], v[204:207]
    ds_read_b128 v[120:123], v250 offset:25856
    v_mfma_f32_16x16x32_bf16 v[200:203], a[184:187], v[92:95], v[200:203]
    ds_read_b128 v[124:127], v250 offset:32000
    v_mfma_f32_16x16x32_bf16 v[200:203], a[176:179], v[88:91], v[200:203]
    ds_read_b64_tr_b16 a[248:249], v152 offset:57344
    v_mfma_f32_16x16x32_bf16 v[208:211], a[176:179], v[96:99], v[208:211]
    ds_read_b64_tr_b16 a[250:251], v152 offset:58368
    v_mfma_f32_16x16x32_bf16 v[208:211], a[184:187], v[100:103], v[208:211]
    ds_read_b64_tr_b16 a[252:253], v153 offset:57344
    v_mfma_f32_16x16x32_bf16 v[212:215], a[188:191], v[100:103], v[212:215]
    ds_read_b64_tr_b16 a[254:255], v153 offset:58368
    v_mfma_f32_16x16x32_bf16 v[212:215], a[180:183], v[96:99], v[212:215]
    s_waitcnt lgkmcnt(4)
    v_mfma_f32_16x16x32_bf16 v[220:223], a[180:183], v[104:107], v[220:223]
    s_barrier
    v_mfma_f32_16x16x32_bf16 v[220:223], a[188:191], v[108:111], v[220:223]
    ds_read_b128 v[80:83], v159 offset:0
    s_add_u32 m0, s74, 36864
    v_mfma_f32_16x16x32_bf16 v[216:219], a[184:187], v[108:111], v[216:219]
    ds_read_b128 v[84:87], v159 offset:6144
    v_mfma_f32_16x16x32_bf16 v[216:219], a[176:179], v[104:107], v[216:219]
    ds_read_b128 v[88:91], v159 offset:256
    buffer_load_dwordx4 v156, s[44:47], s81 offen offset:0 sc1 lds
    v_mfma_f32_16x16x32_bf16 v[224:227], a[176:179], v[112:115], v[224:227]
    ds_read_b128 v[92:95], v159 offset:6400
    v_mfma_f32_16x16x32_bf16 v[224:227], a[184:187], v[116:119], v[224:227]
    ds_read_b128 v[96:99], v159 offset:512
    v_mfma_f32_16x16x32_bf16 v[228:231], a[188:191], v[116:119], v[228:231]
    ds_read_b128 v[100:103], v159 offset:6656
    buffer_load_dwordx4 v157, s[44:47], s81 offen offset:1024 sc1 lds
    v_mfma_f32_16x16x32_bf16 v[228:231], a[180:183], v[112:115], v[228:231]
    v_mfma_f32_16x16x32_bf16 v[236:239], a[180:183], v[120:123], v[236:239]
    v_mfma_f32_16x16x32_bf16 v[236:239], a[188:191], v[124:127], v[236:239]
    buffer_load_dwordx4 v158, s[44:47], s81 offen offset:2048 sc1 lds
    v_mfma_f32_16x16x32_bf16 v[232:235], a[184:187], v[124:127], v[232:235]
    v_mfma_f32_16x16x32_bf16 v[232:235], a[176:179], v[120:123], v[232:235]
    s_waitcnt lgkmcnt(0)
    v_mfma_f32_16x16x32_bf16 v[192:195], a[192:195], v[80:83], v[192:195]
    s_and_b32 s13, s70, 1
    s_mul_i32 s13, s13, 3072
    v_mfma_f32_16x16x32_bf16 v[192:195], a[200:203], v[84:87], v[192:195]
    ds_read_b128 v[104:107], v159 offset:768
    s_sub_u32 s13, s13, 1536
    v_mfma_f32_16x16x32_bf16 v[196:199], a[204:207], v[84:87], v[196:199]
    ds_read_b128 v[108:111], v159 offset:6912
    v_add_u32 v156, s13, v156
    v_mfma_f32_16x16x32_bf16 v[196:199], a[196:199], v[80:83], v[196:199]
    ds_read_b128 v[112:115], v159 offset:1024
    v_mfma_f32_16x16x32_bf16 v[204:207], a[196:199], v[88:91], v[204:207]
    ds_read_b128 v[116:119], v159 offset:7168
    v_add_u32 v157, s13, v157
    v_mfma_f32_16x16x32_bf16 v[204:207], a[204:207], v[92:95], v[204:207]
    ds_read_b128 v[120:123], v159 offset:1280
    v_add_u32 v158, s13, v158
    v_mfma_f32_16x16x32_bf16 v[200:203], a[200:203], v[92:95], v[200:203]
    ds_read_b128 v[124:127], v159 offset:7424
    s_add_u32 m0, s74, 49152
    v_mfma_f32_16x16x32_bf16 v[200:203], a[192:195], v[88:91], v[200:203]
    v_mfma_f32_16x16x32_bf16 v[208:211], a[192:195], v[96:99], v[208:211]
    buffer_load_dwordx4 v156, s[44:47], s18 offen offset:0 sc1 lds
    v_mfma_f32_16x16x32_bf16 v[208:211], a[200:203], v[100:103], v[208:211]
    buffer_load_dwordx4 v157, s[44:47], s18 offen offset:1024 sc1 lds
    v_mfma_f32_16x16x32_bf16 v[212:215], a[204:207], v[100:103], v[212:215]
    buffer_load_dwordx4 v158, s[44:47], s18 offen offset:2048 sc1 lds
    v_mfma_f32_16x16x32_bf16 v[212:215], a[196:199], v[96:99], v[212:215]
    s_waitcnt lgkmcnt(0)
    v_mfma_f32_16x16x32_bf16 v[220:223], a[196:199], v[104:107], v[220:223]
    s_barrier
    v_mfma_f32_16x16x32_bf16 v[220:223], a[204:207], v[108:111], v[220:223]
    ds_read_b128 v[80:83], v159 offset:12288
    s_add_u32 m0, s74, 61440
    v_mfma_f32_16x16x32_bf16 v[216:219], a[200:203], v[108:111], v[216:219]
    ds_read_b128 v[84:87], v159 offset:18432
    v_mfma_f32_16x16x32_bf16 v[216:219], a[192:195], v[104:107], v[216:219]
    ds_read_b128 v[88:91], v159 offset:12544
    buffer_load_dwordx4 v156, s[44:47], s19 offen offset:0 sc1 lds
    v_mfma_f32_16x16x32_bf16 v[224:227], a[192:195], v[112:115], v[224:227]
    ds_read_b128 v[92:95], v159 offset:18688
    v_mfma_f32_16x16x32_bf16 v[224:227], a[200:203], v[116:119], v[224:227]
    ds_read_b128 v[96:99], v159 offset:12800
    v_mfma_f32_16x16x32_bf16 v[228:231], a[204:207], v[116:119], v[228:231]
    ds_read_b128 v[100:103], v159 offset:18944
    buffer_load_dwordx4 v157, s[44:47], s19 offen offset:1024 sc1 lds
    v_mfma_f32_16x16x32_bf16 v[228:231], a[196:199], v[112:115], v[228:231]
    v_mfma_f32_16x16x32_bf16 v[236:239], a[196:199], v[120:123], v[236:239]
    v_mfma_f32_16x16x32_bf16 v[236:239], a[204:207], v[124:127], v[236:239]
    buffer_load_dwordx4 v158, s[44:47], s19 offen offset:2048 sc1 lds
    v_mfma_f32_16x16x32_bf16 v[232:235], a[200:203], v[124:127], v[232:235]
    v_mfma_f32_16x16x32_bf16 v[232:235], a[192:195], v[120:123], v[232:235]
    s_waitcnt lgkmcnt(0)
    v_mfma_f32_16x16x32_bf16 v[192:195], a[208:211], v[80:83], v[192:195]
    s_add_u32 m0, s74, 0
    v_mfma_f32_16x16x32_bf16 v[192:195], a[216:219], v[84:87], v[192:195]
    ds_read_b128 v[104:107], v159 offset:13056
    v_mfma_f32_16x16x32_bf16 v[196:199], a[220:223], v[84:87], v[196:199]
    ds_read_b128 v[108:111], v159 offset:19200
    v_mfma_f32_16x16x32_bf16 v[196:199], a[212:215], v[80:83], v[196:199]
    ds_read_b128 v[112:115], v159 offset:13312
    buffer_load_dwordx4 v156, s[44:47], s20 offen offset:0 sc1 lds
    v_mfma_f32_16x16x32_bf16 v[204:207], a[212:215], v[88:91], v[204:207]
    ds_read_b128 v[116:119], v159 offset:19456
    v_mfma_f32_16x16x32_bf16 v[204:207], a[220:223], v[92:95], v[204:207]
    ds_read_b128 v[120:123], v159 offset:13568
    v_mfma_f32_16x16x32_bf16 v[200:203], a[216:219], v[92:95], v[200:203]
    ds_read_b128 v[124:127], v159 offset:19712
    buffer_load_dwordx4 v157, s[44:47], s20 offen offset:1024 sc1 lds
    v_mfma_f32_16x16x32_bf16 v[200:203], a[208:211], v[88:91], v[200:203]
    v_mfma_f32_16x16x32_bf16 v[208:211], a[208:211], v[96:99], v[208:211]
    v_mfma_f32_16x16x32_bf16 v[208:211], a[216:219], v[100:103], v[208:211]
    buffer_load_dwordx4 v158, s[44:47], s20 offen offset:2048 sc1 lds
    v_mfma_f32_16x16x32_bf16 v[212:215], a[220:223], v[100:103], v[212:215]
    v_mfma_f32_16x16x32_bf16 v[212:215], a[212:215], v[96:99], v[212:215]
    s_waitcnt lgkmcnt(0)
    v_mfma_f32_16x16x32_bf16 v[220:223], a[212:215], v[104:107], v[220:223]
    s_waitcnt vmcnt(16)
    s_barrier
    v_mfma_f32_16x16x32_bf16 v[220:223], a[220:223], v[108:111], v[220:223]
    ds_read_b128 v[80:83], v159 offset:24576
    s_add_u32 m0, s74, 12288
    v_mfma_f32_16x16x32_bf16 v[216:219], a[216:219], v[108:111], v[216:219]
    ds_read_b128 v[84:87], v159 offset:30720
    v_mfma_f32_16x16x32_bf16 v[216:219], a[208:211], v[104:107], v[216:219]
    ds_read_b128 v[88:91], v159 offset:24832
    buffer_load_dwordx4 v156, s[44:47], s21 offen offset:0 sc1 lds
    v_mfma_f32_16x16x32_bf16 v[224:227], a[208:211], v[112:115], v[224:227]
    ds_read_b128 v[92:95], v159 offset:30976
    v_mfma_f32_16x16x32_bf16 v[224:227], a[216:219], v[116:119], v[224:227]
    ds_read_b128 v[96:99], v159 offset:25088
    v_mfma_f32_16x16x32_bf16 v[228:231], a[220:223], v[116:119], v[228:231]
    ds_read_b128 v[100:103], v159 offset:31232
    buffer_load_dwordx4 v157, s[44:47], s21 offen offset:1024 sc1 lds
    v_mfma_f32_16x16x32_bf16 v[228:231], a[212:215], v[112:115], v[228:231]
    v_mfma_f32_16x16x32_bf16 v[236:239], a[212:215], v[120:123], v[236:239]
    v_mfma_f32_16x16x32_bf16 v[236:239], a[220:223], v[124:127], v[236:239]
    buffer_load_dwordx4 v158, s[44:47], s21 offen offset:2048 sc1 lds
    v_mfma_f32_16x16x32_bf16 v[232:235], a[216:219], v[124:127], v[232:235]
    v_mfma_f32_16x16x32_bf16 v[232:235], a[208:211], v[120:123], v[232:235]
    s_waitcnt lgkmcnt(0)
    v_mfma_f32_16x16x32_bf16 v[192:195], a[224:227], v[80:83], v[192:195]
    v_mfma_f32_16x16x32_bf16 v[192:195], a[232:235], v[84:87], v[192:195]
    ds_read_b128 v[104:107], v159 offset:25344
    v_mfma_f32_16x16x32_bf16 v[196:199], a[236:239], v[84:87], v[196:199]
    ds_read_b128 v[108:111], v159 offset:31488
    v_mfma_f32_16x16x32_bf16 v[196:199], a[228:231], v[80:83], v[196:199]
    ds_read_b128 v[112:115], v159 offset:25600
    v_mfma_f32_16x16x32_bf16 v[204:207], a[228:231], v[88:91], v[204:207]
    ds_read_b128 v[116:119], v159 offset:31744
    v_mfma_f32_16x16x32_bf16 v[204:207], a[236:239], v[92:95], v[204:207]
    ds_read_b128 v[120:123], v159 offset:25856
    v_mfma_f32_16x16x32_bf16 v[200:203], a[232:235], v[92:95], v[200:203]
    ds_read_b128 v[124:127], v159 offset:32000
    v_mfma_f32_16x16x32_bf16 v[200:203], a[224:227], v[88:91], v[200:203]
    v_mfma_f32_16x16x32_bf16 v[208:211], a[224:227], v[96:99], v[208:211]
    v_mfma_f32_16x16x32_bf16 v[208:211], a[232:235], v[100:103], v[208:211]
    v_mfma_f32_16x16x32_bf16 v[212:215], a[236:239], v[100:103], v[212:215]
    v_mfma_f32_16x16x32_bf16 v[212:215], a[228:231], v[96:99], v[212:215]
    s_waitcnt lgkmcnt(0)
    v_mfma_f32_16x16x32_bf16 v[220:223], a[228:231], v[104:107], v[220:223]
    s_waitcnt vmcnt(12)
    s_barrier
    v_mfma_f32_16x16x32_bf16 v[220:223], a[236:239], v[108:111], v[220:223]
    ds_read_b128 v[80:83], v250 offset:0
    s_add_u32 m0, s74, 24576
    v_mfma_f32_16x16x32_bf16 v[216:219], a[232:235], v[108:111], v[216:219]
    ds_read_b128 v[84:87], v250 offset:6144
    v_mfma_f32_16x16x32_bf16 v[216:219], a[224:227], v[104:107], v[216:219]
    ds_read_b128 v[88:91], v250 offset:256
    buffer_load_dwordx4 v156, s[44:47], s22 offen offset:0 sc1 lds
    v_mfma_f32_16x16x32_bf16 v[224:227], a[224:227], v[112:115], v[224:227]
    ds_read_b128 v[92:95], v250 offset:6400
    v_mfma_f32_16x16x32_bf16 v[224:227], a[232:235], v[116:119], v[224:227]
    ds_read_b128 v[96:99], v250 offset:512
    v_mfma_f32_16x16x32_bf16 v[228:231], a[236:239], v[116:119], v[228:231]
    ds_read_b128 v[100:103], v250 offset:6656
    buffer_load_dwordx4 v157, s[44:47], s22 offen offset:1024 sc1 lds
    v_mfma_f32_16x16x32_bf16 v[228:231], a[228:231], v[112:115], v[228:231]
    v_mfma_f32_16x16x32_bf16 v[236:239], a[228:231], v[120:123], v[236:239]
    v_mfma_f32_16x16x32_bf16 v[236:239], a[236:239], v[124:127], v[236:239]
    buffer_load_dwordx4 v158, s[44:47], s22 offen offset:2048 sc1 lds
    v_mfma_f32_16x16x32_bf16 v[232:235], a[232:235], v[124:127], v[232:235]
    v_mfma_f32_16x16x32_bf16 v[232:235], a[224:227], v[120:123], v[232:235]
    s_waitcnt lgkmcnt(0)
    v_mfma_f32_16x16x32_bf16 v[192:195], a[240:243], v[80:83], v[192:195]
    s_add_u32 m0, s73, 0
    s_lshl_b32 s14, s85, 17
    v_mfma_f32_16x16x32_bf16 v[192:195], a[248:251], v[84:87], v[192:195]
    ds_read_b128 v[104:107], v250 offset:768
    v_mfma_f32_16x16x32_bf16 v[196:199], a[252:255], v[84:87], v[196:199]
    ds_read_b128 v[108:111], v250 offset:6912
    buffer_load_dwordx4 v4, s[52:55], s14 offen offset:0 lds
    v_mfma_f32_16x16x32_bf16 v[196:199], a[244:247], v[80:83], v[196:199]
    ds_read_b128 v[112:115], v250 offset:1024
    v_mfma_f32_16x16x32_bf16 v[204:207], a[244:247], v[88:91], v[204:207]
    ds_read_b128 v[116:119], v250 offset:7168
    buffer_load_dwordx4 v5, s[52:55], s14 offen offset:1024 lds
    v_mfma_f32_16x16x32_bf16 v[204:207], a[252:255], v[92:95], v[204:207]
    ds_read_b128 v[120:123], v250 offset:1280
    v_mfma_f32_16x16x32_bf16 v[200:203], a[248:251], v[92:95], v[200:203]
    ds_read_b128 v[124:127], v250 offset:7424
    v_mfma_f32_16x16x32_bf16 v[200:203], a[240:243], v[88:91], v[200:203]
    buffer_load_dwordx4 v6, s[52:55], s14 offen offset:2048 lds
    v_mfma_f32_16x16x32_bf16 v[208:211], a[240:243], v[96:99], v[208:211]
    v_mfma_f32_16x16x32_bf16 v[208:211], a[248:251], v[100:103], v[208:211]
    buffer_load_dwordx4 v7, s[52:55], s14 offen offset:3072 lds
    v_mfma_f32_16x16x32_bf16 v[212:215], a[252:255], v[100:103], v[212:215]
    v_mfma_f32_16x16x32_bf16 v[212:215], a[244:247], v[96:99], v[212:215]
    s_waitcnt lgkmcnt(0)
    v_mfma_f32_16x16x32_bf16 v[220:223], a[244:247], v[104:107], v[220:223]
    s_waitcnt vmcnt(16)
    s_barrier
    v_mfma_f32_16x16x32_bf16 v[220:223], a[252:255], v[108:111], v[220:223]
    ds_read_b128 v[80:83], v250 offset:12288
    v_mfma_f32_16x16x32_bf16 v[216:219], a[248:251], v[108:111], v[216:219]
    ds_read_b128 v[84:87], v250 offset:18432
    v_mfma_f32_16x16x32_bf16 v[216:219], a[240:243], v[104:107], v[216:219]
    ds_read_b128 v[88:91], v250 offset:12544
    v_mfma_f32_16x16x32_bf16 v[224:227], a[240:243], v[112:115], v[224:227]
    ds_read_b128 v[92:95], v250 offset:18688
    v_mfma_f32_16x16x32_bf16 v[224:227], a[248:251], v[116:119], v[224:227]
    ds_read_b128 v[96:99], v250 offset:12800
    v_mfma_f32_16x16x32_bf16 v[228:231], a[252:255], v[116:119], v[228:231]
    ds_read_b128 v[100:103], v250 offset:18944
    v_mfma_f32_16x16x32_bf16 v[228:231], a[244:247], v[112:115], v[228:231]
    v_mfma_f32_16x16x32_bf16 v[236:239], a[244:247], v[120:123], v[236:239]
    v_mfma_f32_16x16x32_bf16 v[236:239], a[252:255], v[124:127], v[236:239]
    v_mfma_f32_16x16x32_bf16 v[232:235], a[248:251], v[124:127], v[232:235]
    v_mfma_f32_16x16x32_bf16 v[232:235], a[240:243], v[120:123], v[232:235]
    s_waitcnt lgkmcnt(0)
    v_mfma_f32_16x16x32_bf16 v[32:35], a[0:3], v[80:83], v[128:131]
    v_mfma_f32_16x16x32_bf16 v[32:35], a[8:11], v[84:87], v[32:35]
    ds_read_b128 v[104:107], v250 offset:13056
L_pl_G_3:
    s_cbranch_execz L_wret
    v_mfma_f32_16x16x32_bf16 v[36:39], a[12:15], v[84:87], v[132:135]
    ds_read_b128 v[108:111], v250 offset:19200
    v_mfma_f32_16x16x32_bf16 v[36:39], a[4:7], v[80:83], v[36:39]
    ds_read_b128 v[112:115], v250 offset:13312
    v_mfma_f32_16x16x32_bf16 v[44:47], a[4:7], v[88:91], v[132:135]
    ds_read_b128 v[116:119], v250 offset:19456
    v_mfma_f32_16x16x32_bf16 v[44:47], a[12:15], v[92:95], v[44:47]
    ds_read_b128 v[120:123], v250 offset:13568
    v_mfma_f32_16x16x32_bf16 v[40:43], a[8:11], v[92:95], v[128:131]
    ds_read_b128 v[124:127], v250 offset:19712
    v_mfma_f32_16x16x32_bf16 v[40:43], a[0:3], v[88:91], v[40:43]
    v_mfma_f32_16x16x32_bf16 v[48:51], a[0:3], v[96:99], v[128:131]
    v_mfma_f32_16x16x32_bf16 v[48:51], a[8:11], v[100:103], v[48:51]
    v_mfma_f32_16x16x32_bf16 v[52:55], a[12:15], v[100:103], v[132:135]
    v_mfma_f32_16x16x32_bf16 v[52:55], a[4:7], v[96:99], v[52:55]
    s_waitcnt lgkmcnt(0)
    v_mfma_f32_16x16x32_bf16 v[60:63], a[4:7], v[104:107], v[132:135]
    s_waitcnt vmcnt(13)
    s_barrier
    v_mfma_f32_16x16x32_bf16 v[60:63], a[12:15], v[108:111], v[60:63]
    ds_read_b128 v[80:83], v250 offset:24576
    v_mfma_f32_16x16x32_bf16 v[56:59], a[8:11], v[108:111], v[128:131]
    ds_read_b128 v[84:87], v250 offset:30720
    v_mfma_f32_16x16x32_bf16 v[56:59], a[0:3], v[104:107], v[56:59]
    ds_read_b128 v[88:91], v250 offset:24832
    v_mfma_f32_16x16x32_bf16 v[64:67], a[0:3], v[112:115], v[128:131]
    ds_read_b128 v[92:95], v250 offset:30976
    v_mfma_f32_16x16x32_bf16 v[64:67], a[8:11], v[116:119], v[64:67]
    ds_read_b128 v[96:99], v250 offset:25088
    v_mfma_f32_16x16x32_bf16 v[68:71], a[12:15], v[116:119], v[132:135]
    ds_read_b128 v[100:103], v250 offset:31232
    v_mfma_f32_16x16x32_bf16 v[68:71], a[4:7], v[112:115], v[68:71]
    v_cvt_pk_bf16_f32 v192, v192, v193
    v_cvt_pk_bf16_f32 v193, v194, v195
    v_mfma_f32_16x16x32_bf16 v[76:79], a[4:7], v[120:123], v[132:135]
    v_cvt_pk_bf16_f32 v194, v196, v197
    v_mfma_f32_16x16x32_bf16 v[76:79], a[12:15], v[124:127], v[76:79]
    v_cvt_pk_bf16_f32 v195, v198, v199
    v_mfma_f32_16x16x32_bf16 v[72:75], a[8:11], v[124:127], v[128:131]
    buffer_store_dwordx4 v[192:195], v246, s[44:47], s9 offen offset:0 sc1
    v_mfma_f32_16x16x32_bf16 v[72:75], a[0:3], v[120:123], v[72:75]
    s_waitcnt lgkmcnt(0)
    v_mfma_f32_16x16x32_bf16 v[32:35], a[16:19], v[80:83], v[32:35]
    v_cvt_pk_bf16_f32 v200, v200, v201
    v_mfma_f32_16x16x32_bf16 v[32:35], a[24:27], v[84:87], v[32:35]
    ds_read_b128 v[104:107], v250 offset:25344
    v_mfma_f32_16x16x32_bf16 v[36:39], a[28:31], v[84:87], v[36:39]
    ds_read_b128 v[108:111], v250 offset:31488
    v_mfma_f32_16x16x32_bf16 v[36:39], a[20:23], v[80:83], v[36:39]
    ds_read_b128 v[112:115], v250 offset:25600
    v_mfma_f32_16x16x32_bf16 v[44:47], a[20:23], v[88:91], v[44:47]
    ds_read_b128 v[116:119], v250 offset:31744
    v_mfma_f32_16x16x32_bf16 v[44:47], a[28:31], v[92:95], v[44:47]
    ds_read_b128 v[120:123], v250 offset:25856
    v_mfma_f32_16x16x32_bf16 v[40:43], a[24:27], v[92:95], v[40:43]
    ds_read_b128 v[124:127], v250 offset:32000
    v_mfma_f32_16x16x32_bf16 v[40:43], a[16:19], v[88:91], v[40:43]
    v_cvt_pk_bf16_f32 v201, v202, v203
    v_mfma_f32_16x16x32_bf16 v[48:51], a[16:19], v[96:99], v[48:51]
    v_cvt_pk_bf16_f32 v202, v204, v205
    v_mfma_f32_16x16x32_bf16 v[48:51], a[24:27], v[100:103], v[48:51]
    v_cvt_pk_bf16_f32 v203, v206, v207
    v_mfma_f32_16x16x32_bf16 v[52:55], a[28:31], v[100:103], v[52:55]
    buffer_store_dwordx4 v[200:203], v246, s[44:47], s9 offen offset:1024 sc1
    v_mfma_f32_16x16x32_bf16 v[52:55], a[20:23], v[96:99], v[52:55]
    s_waitcnt lgkmcnt(0)
    v_mfma_f32_16x16x32_bf16 v[60:63], a[20:23], v[104:107], v[60:63]
    s_waitcnt vmcnt(12)
    s_barrier
    v_mfma_f32_16x16x32_bf16 v[60:63], a[28:31], v[108:111], v[60:63]
    ds_read_b128 v[80:83], v159 offset:0
    s_add_u32 m0, s74, 36864
    v_mfma_f32_16x16x32_bf16 v[56:59], a[24:27], v[108:111], v[56:59]
    ds_read_b128 v[84:87], v159 offset:6144
    v_cvt_pk_bf16_f32 v208, v208, v209
    v_mfma_f32_16x16x32_bf16 v[56:59], a[16:19], v[104:107], v[56:59]
    ds_read_b128 v[88:91], v159 offset:256
    buffer_load_dwordx4 v156, s[44:47], s23 offen offset:0 sc1 lds
    v_mfma_f32_16x16x32_bf16 v[64:67], a[16:19], v[112:115], v[64:67]
    ds_read_b128 v[92:95], v159 offset:6400
    v_cvt_pk_bf16_f32 v209, v210, v211
    v_mfma_f32_16x16x32_bf16 v[64:67], a[24:27], v[116:119], v[64:67]
    ds_read_b128 v[96:99], v159 offset:512
    v_cvt_pk_bf16_f32 v210, v212, v213
    v_mfma_f32_16x16x32_bf16 v[68:71], a[28:31], v[116:119], v[68:71]
    ds_read_b128 v[100:103], v159 offset:6656
    buffer_load_dwordx4 v157, s[44:47], s23 offen offset:1024 sc1 lds
    v_mfma_f32_16x16x32_bf16 v[68:71], a[20:23], v[112:115], v[68:71]
    v_add_u32 v10, 65536, v10
    ds_read_b64_tr_b16 a[0:1], v10 offset:0
    v_mfma_f32_16x16x32_bf16 v[76:79], a[20:23], v[120:123], v[76:79]
    ds_read_b64_tr_b16 a[2:3], v10 offset:2048
    v_cvt_pk_bf16_f32 v211, v214, v215
    v_mfma_f32_16x16x32_bf16 v[76:79], a[28:31], v[124:127], v[76:79]
    v_add_u32 v11, 65536, v11
    ds_read_b64_tr_b16 a[4:5], v11 offset:0
    buffer_load_dwordx4 v158, s[44:47], s23 offen offset:2048 sc1 lds
    v_mfma_f32_16x16x32_bf16 v[72:75], a[24:27], v[124:127], v[72:75]
    ds_read_b64_tr_b16 a[6:7], v11 offset:2048
    v_mfma_f32_16x16x32_bf16 v[72:75], a[16:19], v[120:123], v[72:75]
    buffer_store_dwordx4 v[208:211], v246, s[44:47], s9 offen offset:2048 sc1
    s_waitcnt lgkmcnt(4)
    v_mfma_f32_16x16x32_bf16 v[32:35], a[32:35], v[80:83], v[32:35]
    s_add_u32 m0, s74, 49152
    v_cvt_pk_bf16_f32 v216, v216, v217
    v_mfma_f32_16x16x32_bf16 v[32:35], a[40:43], v[84:87], v[32:35]
    ds_read_b128 v[104:107], v159 offset:768
    v_mfma_f32_16x16x32_bf16 v[36:39], a[44:47], v[84:87], v[36:39]
    ds_read_b128 v[108:111], v159 offset:6912
    v_mfma_f32_16x16x32_bf16 v[36:39], a[36:39], v[80:83], v[36:39]
    ds_read_b128 v[112:115], v159 offset:1024
    buffer_load_dwordx4 v156, s[44:47], s24 offen offset:0 sc1 lds
    v_mfma_f32_16x16x32_bf16 v[44:47], a[36:39], v[88:91], v[44:47]
    ds_read_b128 v[116:119], v159 offset:7168
    v_cvt_pk_bf16_f32 v217, v218, v219
    v_mfma_f32_16x16x32_bf16 v[44:47], a[44:47], v[92:95], v[44:47]
    ds_read_b128 v[120:123], v159 offset:1280
    v_cvt_pk_bf16_f32 v218, v220, v221
    v_mfma_f32_16x16x32_bf16 v[40:43], a[40:43], v[92:95], v[40:43]
    ds_read_b128 v[124:127], v159 offset:7424
    buffer_load_dwordx4 v157, s[44:47], s24 offen offset:1024 sc1 lds
    v_mfma_f32_16x16x32_bf16 v[40:43], a[32:35], v[88:91], v[40:43]
    v_add_u32 v12, 65536, v12
    ds_read_b64_tr_b16 a[8:9], v12 offset:0
    v_mfma_f32_16x16x32_bf16 v[48:51], a[32:35], v[96:99], v[48:51]
    ds_read_b64_tr_b16 a[10:11], v12 offset:2048
    v_cvt_pk_bf16_f32 v219, v222, v223
    v_mfma_f32_16x16x32_bf16 v[48:51], a[40:43], v[100:103], v[48:51]
    v_add_u32 v13, 65536, v13
    ds_read_b64_tr_b16 a[12:13], v13 offset:0
    buffer_load_dwordx4 v158, s[44:47], s24 offen offset:2048 sc1 lds
    v_mfma_f32_16x16x32_bf16 v[52:55], a[44:47], v[100:103], v[52:55]
    ds_read_b64_tr_b16 a[14:15], v13 offset:2048
    v_mfma_f32_16x16x32_bf16 v[52:55], a[36:39], v[96:99], v[52:55]
    buffer_store_dwordx4 v[216:219], v247, s[44:47], s9 offen offset:0 sc1
    s_waitcnt lgkmcnt(4)
    v_mfma_f32_16x16x32_bf16 v[60:63], a[36:39], v[104:107], v[60:63]
    s_waitcnt vmcnt(17)
    s_barrier
    v_mfma_f32_16x16x32_bf16 v[60:63], a[44:47], v[108:111], v[60:63]
    ds_read_b128 v[80:83], v159 offset:12288
    s_add_u32 m0, s74, 61440
    v_mfma_f32_16x16x32_bf16 v[56:59], a[40:43], v[108:111], v[56:59]
    ds_read_b128 v[84:87], v159 offset:18432
    v_cvt_pk_bf16_f32 v224, v224, v225
    v_mfma_f32_16x16x32_bf16 v[56:59], a[32:35], v[104:107], v[56:59]
    ds_read_b128 v[88:91], v159 offset:12544
    buffer_load_dwordx4 v156, s[44:47], s25 offen offset:0 sc1 lds
    v_mfma_f32_16x16x32_bf16 v[64:67], a[32:35], v[112:115], v[64:67]
    ds_read_b128 v[92:95], v159 offset:18688
    v_mfma_f32_16x16x32_bf16 v[64:67], a[40:43], v[116:119], v[64:67]
    ds_read_b128 v[96:99], v159 offset:12800
    v_mfma_f32_16x16x32_bf16 v[68:71], a[44:47], v[116:119], v[68:71]
    ds_read_b128 v[100:103], v159 offset:18944
    buffer_load_dwordx4 v157, s[44:47], s25 offen offset:1024 sc1 lds
    v_mfma_f32_16x16x32_bf16 v[68:71], a[36:39], v[112:115], v[68:71]
    v_cvt_pk_bf16_f32 v225, v226, v227
    v_cvt_pk_bf16_f32 v226, v228, v229
    v_mfma_f32_16x16x32_bf16 v[76:79], a[36:39], v[120:123], v[76:79]
    v_cvt_pk_bf16_f32 v227, v230, v231
    v_mfma_f32_16x16x32_bf16 v[76:79], a[44:47], v[124:127], v[76:79]
    buffer_load_dwordx4 v158, s[44:47], s25 offen offset:2048 sc1 lds
    v_mfma_f32_16x16x32_bf16 v[72:75], a[40:43], v[124:127], v[72:75]
    buffer_store_dwordx4 v[224:227], v247, s[44:47], s9 offen offset:1024 sc1
    v_mfma_f32_16x16x32_bf16 v[72:75], a[32:35], v[120:123], v[72:75]
    s_waitcnt lgkmcnt(0)
    v_mfma_f32_16x16x32_bf16 v[32:35], a[48:51], v[80:83], v[32:35]
    s_add_u32 m0, s74, 0
    v_cvt_pk_bf16_f32 v232, v232, v233
    v_mfma_f32_16x16x32_bf16 v[32:35], a[56:59], v[84:87], v[32:35]
    ds_read_b128 v[104:107], v159 offset:13056
    v_mfma_f32_16x16x32_bf16 v[36:39], a[60:63], v[84:87], v[36:39]
    ds_read_b128 v[108:111], v159 offset:19200
    v_mfma_f32_16x16x32_bf16 v[36:39], a[52:55], v[80:83], v[36:39]
    ds_read_b128 v[112:115], v159 offset:13312
    buffer_load_dwordx4 v156, s[44:47], s26 offen offset:0 sc1 lds
    v_mfma_f32_16x16x32_bf16 v[44:47], a[52:55], v[88:91], v[44:47]
    ds_read_b128 v[116:119], v159 offset:19456
    v_mfma_f32_16x16x32_bf16 v[44:47], a[60:63], v[92:95], v[44:47]
    ds_read_b128 v[120:123], v159 offset:13568
    v_mfma_f32_16x16x32_bf16 v[40:43], a[56:59], v[92:95], v[40:43]
    ds_read_b128 v[124:127], v159 offset:19712
    buffer_load_dwordx4 v157, s[44:47], s26 offen offset:1024 sc1 lds
    v_mfma_f32_16x16x32_bf16 v[40:43], a[48:51], v[88:91], v[40:43]
    v_cvt_pk_bf16_f32 v233, v234, v235
    v_cvt_pk_bf16_f32 v234, v236, v237
    v_mfma_f32_16x16x32_bf16 v[48:51], a[48:51], v[96:99], v[48:51]
    v_cvt_pk_bf16_f32 v235, v238, v239
    v_mfma_f32_16x16x32_bf16 v[48:51], a[56:59], v[100:103], v[48:51]
    buffer_load_dwordx4 v158, s[44:47], s26 offen offset:2048 sc1 lds
    v_mfma_f32_16x16x32_bf16 v[52:55], a[60:63], v[100:103], v[52:55]
    buffer_store_dwordx4 v[232:235], v247, s[44:47], s9 offen offset:2048 sc1
    v_mfma_f32_16x16x32_bf16 v[52:55], a[52:55], v[96:99], v[52:55]
    s_waitcnt lgkmcnt(0)
    v_mfma_f32_16x16x32_bf16 v[60:63], a[52:55], v[104:107], v[60:63]
    s_waitcnt vmcnt(18)
    s_barrier
    v_mfma_f32_16x16x32_bf16 v[60:63], a[60:63], v[108:111], v[60:63]
    ds_read_b128 v[80:83], v159 offset:24576
    s_add_u32 m0, s74, 12288
    v_mfma_f32_16x16x32_bf16 v[56:59], a[56:59], v[108:111], v[56:59]
    ds_read_b128 v[84:87], v159 offset:30720
    v_mfma_f32_16x16x32_bf16 v[56:59], a[48:51], v[104:107], v[56:59]
    ds_read_b128 v[88:91], v159 offset:24832
    buffer_load_dwordx4 v156, s[44:47], s27 offen offset:0 sc1 lds
    v_mfma_f32_16x16x32_bf16 v[64:67], a[48:51], v[112:115], v[64:67]
    ds_read_b128 v[92:95], v159 offset:30976
    v_mfma_f32_16x16x32_bf16 v[64:67], a[56:59], v[116:119], v[64:67]
    ds_read_b128 v[96:99], v159 offset:25088
    v_mfma_f32_16x16x32_bf16 v[68:71], a[60:63], v[116:119], v[68:71]
    ds_read_b128 v[100:103], v159 offset:31232
    buffer_load_dwordx4 v157, s[44:47], s27 offen offset:1024 sc1 lds
    v_mfma_f32_16x16x32_bf16 v[68:71], a[52:55], v[112:115], v[68:71]
    v_add_u32 v10, -65536, v10
    ds_read_b64_tr_b16 a[16:17], v10 offset:0
    v_mfma_f32_16x16x32_bf16 v[76:79], a[52:55], v[120:123], v[76:79]
    ds_read_b64_tr_b16 a[18:19], v10 offset:2048
    v_mfma_f32_16x16x32_bf16 v[76:79], a[60:63], v[124:127], v[76:79]
    v_add_u32 v11, -65536, v11
    ds_read_b64_tr_b16 a[20:21], v11 offset:0
    buffer_load_dwordx4 v158, s[44:47], s27 offen offset:2048 sc1 lds
    v_mfma_f32_16x16x32_bf16 v[72:75], a[56:59], v[124:127], v[72:75]
    ds_read_b64_tr_b16 a[22:23], v11 offset:2048
    v_mfma_f32_16x16x32_bf16 v[72:75], a[48:51], v[120:123], v[72:75]
    s_waitcnt lgkmcnt(4)
    v_mfma_f32_16x16x32_bf16 v[32:35], a[64:67], v[80:83], v[32:35]
    s_add_u32 m0, s73, 16384
    s_lshl_b32 s14, s86, 17
    v_mfma_f32_16x16x32_bf16 v[32:35], a[72:75], v[84:87], v[32:35]
    ds_read_b128 v[104:107], v159 offset:25344
    v_mfma_f32_16x16x32_bf16 v[36:39], a[76:79], v[84:87], v[36:39]
    ds_read_b128 v[108:111], v159 offset:31488
    buffer_load_dwordx4 v4, s[52:55], s14 offen offset:0 lds
    v_mfma_f32_16x16x32_bf16 v[36:39], a[68:71], v[80:83], v[36:39]
    ds_read_b128 v[112:115], v159 offset:25600
    v_mfma_f32_16x16x32_bf16 v[44:47], a[68:71], v[88:91], v[44:47]
    ds_read_b128 v[116:119], v159 offset:31744
    buffer_load_dwordx4 v5, s[52:55], s14 offen offset:1024 lds
    v_mfma_f32_16x16x32_bf16 v[44:47], a[76:79], v[92:95], v[44:47]
    ds_read_b128 v[120:123], v159 offset:25856
    v_mfma_f32_16x16x32_bf16 v[40:43], a[72:75], v[92:95], v[40:43]
    ds_read_b128 v[124:127], v159 offset:32000
    v_mfma_f32_16x16x32_bf16 v[40:43], a[64:67], v[88:91], v[40:43]
    v_add_u32 v12, -65536, v12
    ds_read_b64_tr_b16 a[24:25], v12 offset:0
    buffer_load_dwordx4 v6, s[52:55], s14 offen offset:2048 lds
    v_mfma_f32_16x16x32_bf16 v[48:51], a[64:67], v[96:99], v[48:51]
    ds_read_b64_tr_b16 a[26:27], v12 offset:2048
    v_mfma_f32_16x16x32_bf16 v[48:51], a[72:75], v[100:103], v[48:51]
    v_add_u32 v13, -65536, v13
    ds_read_b64_tr_b16 a[28:29], v13 offset:0
    buffer_load_dwordx4 v7, s[52:55], s14 offen offset:3072 lds
    v_mfma_f32_16x16x32_bf16 v[52:55], a[76:79], v[100:103], v[52:55]
    ds_read_b64_tr_b16 a[30:31], v13 offset:2048
    v_mfma_f32_16x16x32_bf16 v[52:55], a[68:71], v[96:99], v[52:55]
    s_waitcnt lgkmcnt(4)
    v_mfma_f32_16x16x32_bf16 v[60:63], a[68:71], v[104:107], v[60:63]
    s_waitcnt vmcnt(20)
    s_barrier
    v_mfma_f32_16x16x32_bf16 v[60:63], a[76:79], v[108:111], v[60:63]
    ds_read_b128 v[80:83], v250 offset:0
    v_mfma_f32_16x16x32_bf16 v[56:59], a[72:75], v[108:111], v[56:59]
    ds_read_b128 v[84:87], v250 offset:6144
    v_mfma_f32_16x16x32_bf16 v[56:59], a[64:67], v[104:107], v[56:59]
    ds_read_b128 v[88:91], v250 offset:256
    v_mfma_f32_16x16x32_bf16 v[64:67], a[64:67], v[112:115], v[64:67]
    ds_read_b128 v[92:95], v250 offset:6400
    v_mfma_f32_16x16x32_bf16 v[64:67], a[72:75], v[116:119], v[64:67]
    ds_read_b128 v[96:99], v250 offset:512
    v_mfma_f32_16x16x32_bf16 v[68:71], a[76:79], v[116:119], v[68:71]
    ds_read_b128 v[100:103], v250 offset:6656
    v_mfma_f32_16x16x32_bf16 v[68:71], a[68:71], v[112:115], v[68:71]
    v_mfma_f32_16x16x32_bf16 v[76:79], a[68:71], v[120:123], v[76:79]
    v_mfma_f32_16x16x32_bf16 v[76:79], a[76:79], v[124:127], v[76:79]
    v_mfma_f32_16x16x32_bf16 v[72:75], a[72:75], v[124:127], v[72:75]
    v_mfma_f32_16x16x32_bf16 v[72:75], a[64:67], v[120:123], v[72:75]
    s_waitcnt lgkmcnt(0)
    v_mfma_f32_16x16x32_bf16 v[32:35], a[80:83], v[80:83], v[32:35]
    v_mfma_f32_16x16x32_bf16 v[32:35], a[88:91], v[84:87], v[32:35]
    ds_read_b128 v[104:107], v250 offset:768
    v_mfma_f32_16x16x32_bf16 v[36:39], a[92:95], v[84:87], v[36:39]
    ds_read_b128 v[108:111], v250 offset:6912
    v_mfma_f32_16x16x32_bf16 v[36:39], a[84:87], v[80:83], v[36:39]
    ds_read_b128 v[112:115], v250 offset:1024
    v_mfma_f32_16x16x32_bf16 v[44:47], a[84:87], v[88:91], v[44:47]
    ds_read_b128 v[116:119], v250 offset:7168
    v_mfma_f32_16x16x32_bf16 v[44:47], a[92:95], v[92:95], v[44:47]
    ds_read_b128 v[120:123], v250 offset:1280
    v_mfma_f32_16x16x32_bf16 v[40:43], a[88:91], v[92:95], v[40:43]
    ds_read_b128 v[124:127], v250 offset:7424
    v_mfma_f32_16x16x32_bf16 v[40:43], a[80:83], v[88:91], v[40:43]
    v_mfma_f32_16x16x32_bf16 v[48:51], a[80:83], v[96:99], v[48:51]
    v_mfma_f32_16x16x32_bf16 v[48:51], a[88:91], v[100:103], v[48:51]
    v_mfma_f32_16x16x32_bf16 v[52:55], a[92:95], v[100:103], v[52:55]
    v_mfma_f32_16x16x32_bf16 v[52:55], a[84:87], v[96:99], v[52:55]
    s_waitcnt lgkmcnt(0)
    v_mfma_f32_16x16x32_bf16 v[60:63], a[84:87], v[104:107], v[60:63]
    s_waitcnt vmcnt(16)
    s_barrier
    v_mfma_f32_16x16x32_bf16 v[60:63], a[92:95], v[108:111], v[60:63]
    ds_read_b128 v[80:83], v250 offset:12288
    v_mfma_f32_16x16x32_bf16 v[56:59], a[88:91], v[108:111], v[56:59]
    ds_read_b128 v[84:87], v250 offset:18432
    v_mfma_f32_16x16x32_bf16 v[56:59], a[80:83], v[104:107], v[56:59]
    ds_read_b128 v[88:91], v250 offset:12544
    v_mfma_f32_16x16x32_bf16 v[64:67], a[80:83], v[112:115], v[64:67]
    ds_read_b128 v[92:95], v250 offset:18688
    v_mfma_f32_16x16x32_bf16 v[64:67], a[88:91], v[116:119], v[64:67]
    ds_read_b128 v[96:99], v250 offset:12800
    v_mfma_f32_16x16x32_bf16 v[68:71], a[92:95], v[116:119], v[68:71]
    ds_read_b128 v[100:103], v250 offset:18944
    v_mfma_f32_16x16x32_bf16 v[68:71], a[84:87], v[112:115], v[68:71]
    v_mfma_f32_16x16x32_bf16 v[76:79], a[84:87], v[120:123], v[76:79]
    v_mfma_f32_16x16x32_bf16 v[76:79], a[92:95], v[124:127], v[76:79]
    v_mfma_f32_16x16x32_bf16 v[72:75], a[88:91], v[124:127], v[72:75]
    v_mfma_f32_16x16x32_bf16 v[72:75], a[80:83], v[120:123], v[72:75]
    s_waitcnt lgkmcnt(0)
    v_mfma_f32_16x16x32_bf16 v[32:35], a[96:99], v[80:83], v[32:35]
    v_mfma_f32_16x16x32_bf16 v[32:35], a[104:107], v[84:87], v[32:35]
    ds_read_b128 v[104:107], v250 offset:13056
    v_mfma_f32_16x16x32_bf16 v[36:39], a[108:111], v[84:87], v[36:39]
    ds_read_b128 v[108:111], v250 offset:19200
    v_mfma_f32_16x16x32_bf16 v[36:39], a[100:103], v[80:83], v[36:39]
    ds_read_b128 v[112:115], v250 offset:13312
    v_mfma_f32_16x16x32_bf16 v[44:47], a[100:103], v[88:91], v[44:47]
    ds_read_b128 v[116:119], v250 offset:19456
    v_mfma_f32_16x16x32_bf16 v[44:47], a[108:111], v[92:95], v[44:47]
    ds_read_b128 v[120:123], v250 offset:13568
    v_mfma_f32_16x16x32_bf16 v[40:43], a[104:107], v[92:95], v[40:43]
    ds_read_b128 v[124:127], v250 offset:19712
    v_mfma_f32_16x16x32_bf16 v[40:43], a[96:99], v[88:91], v[40:43]
    s_waitcnt vmcnt(7)
    buffer_store_dword v249, v248, s[44:47], s6 offen sc1
    v_mfma_f32_16x16x32_bf16 v[48:51], a[96:99], v[96:99], v[48:51]
    v_mfma_f32_16x16x32_bf16 v[48:51], a[104:107], v[100:103], v[48:51]
    v_mfma_f32_16x16x32_bf16 v[52:55], a[108:111], v[100:103], v[52:55]
    v_mfma_f32_16x16x32_bf16 v[52:55], a[100:103], v[96:99], v[52:55]
    s_waitcnt lgkmcnt(0)
    v_mfma_f32_16x16x32_bf16 v[60:63], a[100:103], v[104:107], v[60:63]
    s_barrier
    v_mfma_f32_16x16x32_bf16 v[60:63], a[108:111], v[108:111], v[60:63]
    ds_read_b128 v[80:83], v250 offset:24576
    s_add_u32 m0, s74, 24576
    v_mfma_f32_16x16x32_bf16 v[56:59], a[104:107], v[108:111], v[56:59]
    ds_read_b128 v[84:87], v250 offset:30720
    v_mfma_f32_16x16x32_bf16 v[56:59], a[96:99], v[104:107], v[56:59]
    ds_read_b128 v[88:91], v250 offset:24832
    buffer_load_dwordx4 v156, s[44:47], s76 offen offset:0 sc1 lds
    v_mfma_f32_16x16x32_bf16 v[64:67], a[96:99], v[112:115], v[64:67]
    ds_read_b128 v[92:95], v250 offset:30976
    v_mfma_f32_16x16x32_bf16 v[64:67], a[104:107], v[116:119], v[64:67]
    ds_read_b128 v[96:99], v250 offset:25088
    v_mfma_f32_16x16x32_bf16 v[68:71], a[108:111], v[116:119], v[68:71]
    ds_read_b128 v[100:103], v250 offset:31232
    buffer_load_dwordx4 v157, s[44:47], s76 offen offset:1024 sc1 lds
    v_mfma_f32_16x16x32_bf16 v[68:71], a[100:103], v[112:115], v[68:71]
    v_mfma_f32_16x16x32_bf16 v[76:79], a[100:103], v[120:123], v[76:79]
    v_mfma_f32_16x16x32_bf16 v[76:79], a[108:111], v[124:127], v[76:79]
    buffer_load_dwordx4 v158, s[44:47], s76 offen offset:2048 sc1 lds
    v_mfma_f32_16x16x32_bf16 v[72:75], a[104:107], v[124:127], v[72:75]
    v_mfma_f32_16x16x32_bf16 v[72:75], a[96:99], v[120:123], v[72:75]
    s_waitcnt lgkmcnt(0)
    v_mfma_f32_16x16x32_bf16 v[32:35], a[112:115], v[80:83], v[32:35]
    s_add_u32 m0, s74, 36864
    v_mfma_f32_16x16x32_bf16 v[32:35], a[120:123], v[84:87], v[32:35]
    ds_read_b128 v[104:107], v250 offset:25344
    v_mfma_f32_16x16x32_bf16 v[36:39], a[124:127], v[84:87], v[36:39]
    ds_read_b128 v[108:111], v250 offset:31488
    v_mfma_f32_16x16x32_bf16 v[36:39], a[116:119], v[80:83], v[36:39]
    ds_read_b128 v[112:115], v250 offset:25600
    buffer_load_dwordx4 v156, s[44:47], s77 offen offset:0 sc1 lds
    v_mfma_f32_16x16x32_bf16 v[44:47], a[116:119], v[88:91], v[44:47]
    ds_read_b128 v[116:119], v250 offset:31744
    v_mfma_f32_16x16x32_bf16 v[44:47], a[124:127], v[92:95], v[44:47]
    ds_read_b128 v[120:123], v250 offset:25856
    v_mfma_f32_16x16x32_bf16 v[40:43], a[120:123], v[92:95], v[40:43]
    ds_read_b128 v[124:127], v250 offset:32000
    buffer_load_dwordx4 v157, s[44:47], s77 offen offset:1024 sc1 lds
    v_mfma_f32_16x16x32_bf16 v[40:43], a[112:115], v[88:91], v[40:43]
    v_mfma_f32_16x16x32_bf16 v[48:51], a[112:115], v[96:99], v[48:51]
    v_mfma_f32_16x16x32_bf16 v[48:51], a[120:123], v[100:103], v[48:51]
    buffer_load_dwordx4 v158, s[44:47], s77 offen offset:2048 sc1 lds
    v_mfma_f32_16x16x32_bf16 v[52:55], a[124:127], v[100:103], v[52:55]
    v_mfma_f32_16x16x32_bf16 v[52:55], a[116:119], v[96:99], v[52:55]
    s_waitcnt lgkmcnt(0)
    v_mfma_f32_16x16x32_bf16 v[60:63], a[116:119], v[104:107], v[60:63]
    s_barrier
    v_mfma_f32_16x16x32_bf16 v[60:63], a[124:127], v[108:111], v[60:63]
    ds_read_b128 v[80:83], v159 offset:0
    s_add_u32 m0, s74, 49152
    v_mfma_f32_16x16x32_bf16 v[56:59], a[120:123], v[108:111], v[56:59]
    ds_read_b128 v[84:87], v159 offset:6144
    v_mfma_f32_16x16x32_bf16 v[56:59], a[112:115], v[104:107], v[56:59]
    ds_read_b128 v[88:91], v159 offset:256
    buffer_load_dwordx4 v156, s[44:47], s78 offen offset:0 sc1 lds
    v_mfma_f32_16x16x32_bf16 v[64:67], a[112:115], v[112:115], v[64:67]
    ds_read_b128 v[92:95], v159 offset:6400
    v_mfma_f32_16x16x32_bf16 v[64:67], a[120:123], v[116:119], v[64:67]
    ds_read_b128 v[96:99], v159 offset:512
    v_mfma_f32_16x16x32_bf16 v[68:71], a[124:127], v[116:119], v[68:71]
    ds_read_b128 v[100:103], v159 offset:6656
    buffer_load_dwordx4 v157, s[44:47], s78 offen offset:1024 sc1 lds
    v_mfma_f32_16x16x32_bf16 v[68:71], a[116:119], v[112:115], v[68:71]
    v_mfma_f32_16x16x32_bf16 v[76:79], a[116:119], v[120:123], v[76:79]
    v_mfma_f32_16x16x32_bf16 v[76:79], a[124:127], v[124:127], v[76:79]
    buffer_load_dwordx4 v158, s[44:47], s78 offen offset:2048 sc1 lds
    v_mfma_f32_16x16x32_bf16 v[72:75], a[120:123], v[124:127], v[72:75]
    v_mfma_f32_16x16x32_bf16 v[72:75], a[112:115], v[120:123], v[72:75]
    s_waitcnt lgkmcnt(0)
    v_mfma_f32_16x16x32_bf16 v[32:35], a[128:131], v[80:83], v[32:35]
    s_add_u32 m0, s74, 61440
    v_mfma_f32_16x16x32_bf16 v[32:35], a[136:139], v[84:87], v[32:35]
    ds_read_b128 v[104:107], v159 offset:768
    v_mfma_f32_16x16x32_bf16 v[36:39], a[140:143], v[84:87], v[36:39]
    ds_read_b128 v[108:111], v159 offset:6912
    v_mfma_f32_16x16x32_bf16 v[36:39], a[132:135], v[80:83], v[36:39]
    ds_read_b128 v[112:115], v159 offset:1024
    buffer_load_dwordx4 v156, s[44:47], s79 offen offset:0 sc1 lds
    v_mfma_f32_16x16x32_bf16 v[44:47], a[132:135], v[88:91], v[44:47]
    ds_read_b128 v[116:119], v159 offset:7168
    v_mfma_f32_16x16x32_bf16 v[44:47], a[140:143], v[92:95], v[44:47]
    ds_read_b128 v[120:123], v159 offset:1280
    v_mfma_f32_16x16x32_bf16 v[40:43], a[136:139], v[92:95], v[40:43]
    ds_read_b128 v[124:127], v159 offset:7424
    buffer_load_dwordx4 v157, s[44:47], s79 offen offset:1024 sc1 lds
    v_mfma_f32_16x16x32_bf16 v[40:43], a[128:131], v[88:91], v[40:43]
    v_mfma_f32_16x16x32_bf16 v[48:51], a[128:131], v[96:99], v[48:51]
    v_mfma_f32_16x16x32_bf16 v[48:51], a[136:139], v[100:103], v[48:51]
    buffer_load_dwordx4 v158, s[44:47], s79 offen offset:2048 sc1 lds
    v_mfma_f32_16x16x32_bf16 v[52:55], a[140:143], v[100:103], v[52:55]
    v_mfma_f32_16x16x32_bf16 v[52:55], a[132:135], v[96:99], v[52:55]
    s_waitcnt lgkmcnt(0)
    v_mfma_f32_16x16x32_bf16 v[60:63], a[132:135], v[104:107], v[60:63]
    s_waitcnt vmcnt(13)
    s_barrier
    v_mfma_f32_16x16x32_bf16 v[60:63], a[140:143], v[108:111], v[60:63]
    ds_read_b128 v[80:83], v159 offset:12288
    s_add_u32 m0, s74, 0
    v_mfma_f32_16x16x32_bf16 v[56:59], a[136:139], v[108:111], v[56:59]
    ds_read_b128 v[84:87], v159 offset:18432
    v_mfma_f32_16x16x32_bf16 v[56:59], a[128:131], v[104:107], v[56:59]
    ds_read_b128 v[88:91], v159 offset:12544
    buffer_load_dwordx4 v156, s[44:47], s80 offen offset:0 sc1 lds
    v_mfma_f32_16x16x32_bf16 v[64:67], a[128:131], v[112:115], v[64:67]
    ds_read_b128 v[92:95], v159 offset:18688
    v_mfma_f32_16x16x32_bf16 v[64:67], a[136:139], v[116:119], v[64:67]
    ds_read_b128 v[96:99], v159 offset:12800
    v_mfma_f32_16x16x32_bf16 v[68:71], a[140:143], v[116:119], v[68:71]
    ds_read_b128 v[100:103], v159 offset:18944
    buffer_load_dwordx4 v157, s[44:47], s80 offen offset:1024 sc1 lds
    v_mfma_f32_16x16x32_bf16 v[68:71], a[132:135], v[112:115], v[68:71]
    ds_read_b64_tr_b16 a[32:33], v10 offset:16384
    v_mfma_f32_16x16x32_bf16 v[76:79], a[132:135], v[120:123], v[76:79]
    ds_read_b64_tr_b16 a[34:35], v10 offset:18432
    v_mfma_f32_16x16x32_bf16 v[76:79], a[140:143], v[124:127], v[76:79]
    ds_read_b64_tr_b16 a[36:37], v11 offset:16384
    buffer_load_dwordx4 v158, s[44:47], s80 offen offset:2048 sc1 lds
    v_mfma_f32_16x16x32_bf16 v[72:75], a[136:139], v[124:127], v[72:75]
    ds_read_b64_tr_b16 a[38:39], v11 offset:18432
    v_mfma_f32_16x16x32_bf16 v[72:75], a[128:131], v[120:123], v[72:75]
    buffer_load_dword v29, v28, s[44:47], 0 offen sc1
    s_waitcnt lgkmcnt(4)
    v_mfma_f32_16x16x32_bf16 v[32:35], a[144:147], v[80:83], v[32:35]
    s_add_u32 m0, s73, 32768
    s_lshl_b32 s14, s87, 17
    v_mfma_f32_16x16x32_bf16 v[32:35], a[152:155], v[84:87], v[32:35]
    ds_read_b128 v[104:107], v159 offset:13056
    v_mfma_f32_16x16x32_bf16 v[36:39], a[156:159], v[84:87], v[36:39]
    ds_read_b128 v[108:111], v159 offset:19200
    buffer_load_dwordx4 v4, s[52:55], s14 offen offset:0 lds
    v_mfma_f32_16x16x32_bf16 v[36:39], a[148:151], v[80:83], v[36:39]
    ds_read_b128 v[112:115], v159 offset:13312
    v_mfma_f32_16x16x32_bf16 v[44:47], a[148:151], v[88:91], v[44:47]
    ds_read_b128 v[116:119], v159 offset:19456
    buffer_load_dwordx4 v5, s[52:55], s14 offen offset:1024 lds
    v_mfma_f32_16x16x32_bf16 v[44:47], a[156:159], v[92:95], v[44:47]
    ds_read_b128 v[120:123], v159 offset:13568
    v_mfma_f32_16x16x32_bf16 v[40:43], a[152:155], v[92:95], v[40:43]
    ds_read_b128 v[124:127], v159 offset:19712
    v_mfma_f32_16x16x32_bf16 v[40:43], a[144:147], v[88:91], v[40:43]
    ds_read_b64_tr_b16 a[40:41], v12 offset:16384
    buffer_load_dwordx4 v6, s[52:55], s14 offen offset:2048 lds
    v_mfma_f32_16x16x32_bf16 v[48:51], a[144:147], v[96:99], v[48:51]
    ds_read_b64_tr_b16 a[42:43], v12 offset:18432
    v_mfma_f32_16x16x32_bf16 v[48:51], a[152:155], v[100:103], v[48:51]
    ds_read_b64_tr_b16 a[44:45], v13 offset:16384
    buffer_load_dwordx4 v7, s[52:55], s14 offen offset:3072 lds
    v_mfma_f32_16x16x32_bf16 v[52:55], a[156:159], v[100:103], v[52:55]
    ds_read_b64_tr_b16 a[46:47], v13 offset:18432
    v_mfma_f32_16x16x32_bf16 v[52:55], a[148:151], v[96:99], v[52:55]
    s_waitcnt lgkmcnt(4)
    v_mfma_f32_16x16x32_bf16 v[60:63], a[148:151], v[104:107], v[60:63]
    s_waitcnt vmcnt(17)
    s_barrier
    v_mfma_f32_16x16x32_bf16 v[60:63], a[156:159], v[108:111], v[60:63]
    ds_read_b128 v[80:83], v159 offset:24576
    v_mfma_f32_16x16x32_bf16 v[56:59], a[152:155], v[108:111], v[56:59]
    ds_read_b128 v[84:87], v159 offset:30720
    v_mfma_f32_16x16x32_bf16 v[56:59], a[144:147], v[104:107], v[56:59]
    ds_read_b128 v[88:91], v159 offset:24832
    v_mfma_f32_16x16x32_bf16 v[64:67], a[144:147], v[112:115], v[64:67]
    ds_read_b128 v[92:95], v159 offset:30976
    v_mfma_f32_16x16x32_bf16 v[64:67], a[152:155], v[116:119], v[64:67]
    ds_read_b128 v[96:99], v159 offset:25088
    v_mfma_f32_16x16x32_bf16 v[68:71], a[156:159], v[116:119], v[68:71]
    ds_read_b128 v[100:103], v159 offset:31232
    v_mfma_f32_16x16x32_bf16 v[68:71], a[148:151], v[112:115], v[68:71]
    v_mfma_f32_16x16x32_bf16 v[76:79], a[148:151], v[120:123], v[76:79]
    v_mfma_f32_16x16x32_bf16 v[76:79], a[156:159], v[124:127], v[76:79]
    v_mfma_f32_16x16x32_bf16 v[72:75], a[152:155], v[124:127], v[72:75]
    v_mfma_f32_16x16x32_bf16 v[72:75], a[144:147], v[120:123], v[72:75]
    s_waitcnt lgkmcnt(0)
    v_mfma_f32_16x16x32_bf16 v[32:35], a[160:163], v[80:83], v[32:35]
    v_mfma_f32_16x16x32_bf16 v[32:35], a[168:171], v[84:87], v[32:35]
    ds_read_b128 v[104:107], v159 offset:25344
    v_mfma_f32_16x16x32_bf16 v[36:39], a[172:175], v[84:87], v[36:39]
    ds_read_b128 v[108:111], v159 offset:31488
    v_mfma_f32_16x16x32_bf16 v[36:39], a[164:167], v[80:83], v[36:39]
    ds_read_b128 v[112:115], v159 offset:25600
    v_mfma_f32_16x16x32_bf16 v[44:47], a[164:167], v[88:91], v[44:47]
    ds_read_b128 v[116:119], v159 offset:31744
    v_mfma_f32_16x16x32_bf16 v[44:47], a[172:175], v[92:95], v[44:47]
    ds_read_b128 v[120:123], v159 offset:25856
    v_mfma_f32_16x16x32_bf16 v[40:43], a[168:171], v[92:95], v[40:43]
    ds_read_b128 v[124:127], v159 offset:32000
    v_mfma_f32_16x16x32_bf16 v[40:43], a[160:163], v[88:91], v[40:43]
    v_mfma_f32_16x16x32_bf16 v[48:51], a[160:163], v[96:99], v[48:51]
    v_mfma_f32_16x16x32_bf16 v[48:51], a[168:171], v[100:103], v[48:51]
    v_mfma_f32_16x16x32_bf16 v[52:55], a[172:175], v[100:103], v[52:55]
    v_mfma_f32_16x16x32_bf16 v[52:55], a[164:167], v[96:99], v[52:55]
    s_waitcnt lgkmcnt(0)
    v_mfma_f32_16x16x32_bf16 v[60:63], a[164:167], v[104:107], v[60:63]
    s_waitcnt vmcnt(14)
    s_barrier
L_pl_G_4:
    s_cbranch_execz L_wret
    v_mfma_f32_16x16x32_bf16 v[60:63], a[172:175], v[108:111], v[60:63]
    ds_read_b128 v[80:83], v250 offset:0
    v_mfma_f32_16x16x32_bf16 v[56:59], a[168:171], v[108:111], v[56:59]
    ds_read_b128 v[84:87], v250 offset:6144
    v_mfma_f32_16x16x32_bf16 v[56:59], a[160:163], v[104:107], v[56:59]
    ds_read_b128 v[88:91], v250 offset:256
    v_mfma_f32_16x16x32_bf16 v[64:67], a[160:163], v[112:115], v[64:67]
    ds_read_b128 v[92:95], v250 offset:6400
    v_mfma_f32_16x16x32_bf16 v[64:67], a[168:171], v[116:119], v[64:67]
    ds_read_b128 v[96:99], v250 offset:512
    v_mfma_f32_16x16x32_bf16 v[68:71], a[172:175], v[116:119], v[68:71]
    ds_read_b128 v[100:103], v250 offset:6656
    v_mfma_f32_16x16x32_bf16 v[68:71], a[164:167], v[112:115], v[68:71]
    s_waitcnt vmcnt(4)
    v_cmp_ne_u32 vcc, s68, v29
    s_cbranch_vccnz L_rs_p5
L_ok_p5:
    v_mfma_f32_16x16x32_bf16 v[76:79], a[164:167], v[120:123], v[76:79]
    buffer_load_dwordx4 v[160:163], v246, s[44:47], s10 offen offset:0 sc1
    v_mfma_f32_16x16x32_bf16 v[76:79], a[172:175], v[124:127], v[76:79]
    buffer_load_dwordx4 v[164:167], v246, s[44:47], s10 offen offset:1024 sc1
    v_mfma_f32_16x16x32_bf16 v[72:75], a[168:171], v[124:127], v[72:75]
    buffer_load_dwordx4 v[168:171], v246, s[44:47], s10 offen offset:2048 sc1
    v_mfma_f32_16x16x32_bf16 v[72:75], a[160:163], v[120:123], v[72:75]
    s_waitcnt lgkmcnt(0)
    v_mfma_f32_16x16x32_bf16 v[32:35], a[176:179], v[80:83], v[32:35]
    buffer_load_dwordx4 v[172:175], v247, s[44:47], s10 offen offset:0 sc1
    v_mfma_f32_16x16x32_bf16 v[32:35], a[184:187], v[84:87], v[32:35]
    ds_read_b128 v[104:107], v250 offset:768
    v_mfma_f32_16x16x32_bf16 v[36:39], a[188:191], v[84:87], v[36:39]
    ds_read_b128 v[108:111], v250 offset:6912
    v_mfma_f32_16x16x32_bf16 v[36:39], a[180:183], v[80:83], v[36:39]
    ds_read_b128 v[112:115], v250 offset:1024
    v_mfma_f32_16x16x32_bf16 v[44:47], a[180:183], v[88:91], v[44:47]
    ds_read_b128 v[116:119], v250 offset:7168
    v_mfma_f32_16x16x32_bf16 v[44:47], a[188:191], v[92:95], v[44:47]
    ds_read_b128 v[120:123], v250 offset:1280
    v_mfma_f32_16x16x32_bf16 v[40:43], a[184:187], v[92:95], v[40:43]
    ds_read_b128 v[124:127], v250 offset:7424
    v_mfma_f32_16x16x32_bf16 v[40:43], a[176:179], v[88:91], v[40:43]
    buffer_load_dwordx4 v[176:179], v247, s[44:47], s10 offen offset:1024 sc1
    v_mfma_f32_16x16x32_bf16 v[48:51], a[176:179], v[96:99], v[48:51]
    v_mfma_f32_16x16x32_bf16 v[48:51], a[184:187], v[100:103], v[48:51]
    v_mfma_f32_16x16x32_bf16 v[52:55], a[188:191], v[100:103], v[52:55]
    buffer_load_dwordx4 v[180:183], v247, s[44:47], s10 offen offset:2048 sc1
    v_mfma_f32_16x16x32_bf16 v[52:55], a[180:183], v[96:99], v[52:55]
    s_waitcnt lgkmcnt(0)
    v_mfma_f32_16x16x32_bf16 v[60:63], a[180:183], v[104:107], v[60:63]
    s_barrier
    v_mfma_f32_16x16x32_bf16 v[60:63], a[188:191], v[108:111], v[60:63]
    ds_read_b128 v[80:83], v250 offset:12288
    s_add_u32 m0, s74, 12288
    v_mfma_f32_16x16x32_bf16 v[56:59], a[184:187], v[108:111], v[56:59]
    ds_read_b128 v[84:87], v250 offset:18432
    v_mfma_f32_16x16x32_bf16 v[56:59], a[176:179], v[104:107], v[56:59]
    ds_read_b128 v[88:91], v250 offset:12544
    buffer_load_dwordx4 v156, s[44:47], s81 offen offset:0 sc1 lds
    v_mfma_f32_16x16x32_bf16 v[64:67], a[176:179], v[112:115], v[64:67]
    ds_read_b128 v[92:95], v250 offset:18688
    v_mfma_f32_16x16x32_bf16 v[64:67], a[184:187], v[116:119], v[64:67]
    ds_read_b128 v[96:99], v250 offset:12800
    v_mfma_f32_16x16x32_bf16 v[68:71], a[188:191], v[116:119], v[68:71]
    ds_read_b128 v[100:103], v250 offset:18944
    buffer_load_dwordx4 v157, s[44:47], s81 offen offset:1024 sc1 lds
    v_mfma_f32_16x16x32_bf16 v[68:71], a[180:183], v[112:115], v[68:71]
    v_mfma_f32_16x16x32_bf16 v[76:79], a[180:183], v[120:123], v[76:79]
    v_mfma_f32_16x16x32_bf16 v[76:79], a[188:191], v[124:127], v[76:79]
    buffer_load_dwordx4 v158, s[44:47], s81 offen offset:2048 sc1 lds
    v_mfma_f32_16x16x32_bf16 v[72:75], a[184:187], v[124:127], v[72:75]
    v_mfma_f32_16x16x32_bf16 v[72:75], a[176:179], v[120:123], v[72:75]
    s_waitcnt lgkmcnt(0)
    v_mfma_f32_16x16x32_bf16 v[32:35], a[192:195], v[80:83], v[32:35]
    s_add_u32 m0, s73, 49152
    s_lshl_b32 s14, s88, 17
    v_mfma_f32_16x16x32_bf16 v[32:35], a[200:203], v[84:87], v[32:35]
    ds_read_b128 v[104:107], v250 offset:13056
    v_mfma_f32_16x16x32_bf16 v[36:39], a[204:207], v[84:87], v[36:39]
    ds_read_b128 v[108:111], v250 offset:19200
    buffer_load_dwordx4 v4, s[52:55], s14 offen offset:0 lds
    v_mfma_f32_16x16x32_bf16 v[36:39], a[196:199], v[80:83], v[36:39]
    ds_read_b128 v[112:115], v250 offset:13312
    v_mfma_f32_16x16x32_bf16 v[44:47], a[196:199], v[88:91], v[44:47]
    ds_read_b128 v[116:119], v250 offset:19456
    buffer_load_dwordx4 v5, s[52:55], s14 offen offset:1024 lds
    v_mfma_f32_16x16x32_bf16 v[44:47], a[204:207], v[92:95], v[44:47]
    ds_read_b128 v[120:123], v250 offset:13568
    v_mfma_f32_16x16x32_bf16 v[40:43], a[200:203], v[92:95], v[40:43]
    ds_read_b128 v[124:127], v250 offset:19712
    v_mfma_f32_16x16x32_bf16 v[40:43], a[192:195], v[88:91], v[40:43]
    buffer_load_dwordx4 v6, s[52:55], s14 offen offset:2048 lds
    v_mfma_f32_16x16x32_bf16 v[48:51], a[192:195], v[96:99], v[48:51]
    v_mfma_f32_16x16x32_bf16 v[48:51], a[200:203], v[100:103], v[48:51]
    buffer_load_dwordx4 v7, s[52:55], s14 offen offset:3072 lds
    v_mfma_f32_16x16x32_bf16 v[52:55], a[204:207], v[100:103], v[52:55]
    v_mfma_f32_16x16x32_bf16 v[52:55], a[196:199], v[96:99], v[52:55]
    s_waitcnt lgkmcnt(0)
    v_mfma_f32_16x16x32_bf16 v[60:63], a[196:199], v[104:107], v[60:63]
    s_barrier
    v_mfma_f32_16x16x32_bf16 v[60:63], a[204:207], v[108:111], v[60:63]
    ds_read_b128 v[80:83], v250 offset:24576
    v_mfma_f32_16x16x32_bf16 v[56:59], a[200:203], v[108:111], v[56:59]
    ds_read_b128 v[84:87], v250 offset:30720
    v_mfma_f32_16x16x32_bf16 v[56:59], a[192:195], v[104:107], v[56:59]
    ds_read_b128 v[88:91], v250 offset:24832
    v_mfma_f32_16x16x32_bf16 v[64:67], a[192:195], v[112:115], v[64:67]
    ds_read_b128 v[92:95], v250 offset:30976
    v_mfma_f32_16x16x32_bf16 v[64:67], a[200:203], v[116:119], v[64:67]
    ds_read_b128 v[96:99], v250 offset:25088
    v_mfma_f32_16x16x32_bf16 v[68:71], a[204:207], v[116:119], v[68:71]
    ds_read_b128 v[100:103], v250 offset:31232
    v_mfma_f32_16x16x32_bf16 v[68:71], a[196:199], v[112:115], v[68:71]
    s_waitcnt vmcnt(7)
    v_mfma_f32_16x16x32_bf16 v[76:79], a[196:199], v[120:123], v[76:79]
    v_mfma_f32_16x16x32_bf16 v[76:79], a[204:207], v[124:127], v[76:79]
    v_mfma_f32_16x16x32_bf16 v[72:75], a[200:203], v[124:127], v[72:75]
    v_mfma_f32_16x16x32_bf16 v[72:75], a[192:195], v[120:123], v[72:75]
    s_waitcnt lgkmcnt(0)
    v_mfma_f32_16x16x32_bf16 v[32:35], a[208:211], v[80:83], v[32:35]
    s_add_u32 m0, s73, 65536
    s_lshl_b32 s14, s89, 17
    v_mfma_f32_16x16x32_bf16 v[32:35], a[216:219], v[84:87], v[32:35]
    ds_read_b128 v[104:107], v250 offset:25344
    v_mfma_f32_16x16x32_bf16 v[36:39], a[220:223], v[84:87], v[36:39]
    ds_read_b128 v[108:111], v250 offset:31488
    buffer_load_dwordx4 v4, s[52:55], s14 offen offset:0 lds
    v_mfma_f32_16x16x32_bf16 v[36:39], a[212:215], v[80:83], v[36:39]
    ds_read_b128 v[112:115], v250 offset:25600
    v_and_b32 v193, 0xffff0000, v172
    v_lshlrev_b32 v192, 16, v172
    v_mfma_f32_16x16x32_bf16 v[44:47], a[212:215], v[88:91], v[44:47]
    ds_read_b128 v[116:119], v250 offset:31744
    buffer_load_dwordx4 v5, s[52:55], s14 offen offset:1024 lds
    v_mfma_f32_16x16x32_bf16 v[44:47], a[220:223], v[92:95], v[44:47]
    ds_read_b128 v[120:123], v250 offset:25856
    v_and_b32 v195, 0xffff0000, v173
    v_lshlrev_b32 v194, 16, v173
    v_mfma_f32_16x16x32_bf16 v[40:43], a[216:219], v[92:95], v[40:43]
    ds_read_b128 v[124:127], v250 offset:32000
    v_add_f32 v56, v56, v192
    v_add_f32 v57, v57, v193
    v_mfma_f32_16x16x32_bf16 v[40:43], a[208:211], v[88:91], v[40:43]
    buffer_load_dwordx4 v6, s[52:55], s14 offen offset:2048 lds
    v_add_f32 v58, v58, v194
    v_add_f32 v59, v59, v195
    v_mfma_f32_16x16x32_bf16 v[48:51], a[208:211], v[96:99], v[48:51]
    v_and_b32 v197, 0xffff0000, v174
    v_lshlrev_b32 v196, 16, v174
    v_and_b32 v199, 0xffff0000, v175
    v_mfma_f32_16x16x32_bf16 v[48:51], a[216:219], v[100:103], v[48:51]
    buffer_load_dwordx4 v7, s[52:55], s14 offen offset:3072 lds
    v_lshlrev_b32 v198, 16, v175
    v_add_f32 v60, v60, v196
    v_mfma_f32_16x16x32_bf16 v[52:55], a[220:223], v[100:103], v[52:55]
    v_add_f32 v61, v61, v197
    v_add_f32 v62, v62, v198
    v_add_f32 v63, v63, v199
    v_mfma_f32_16x16x32_bf16 v[52:55], a[212:215], v[96:99], v[52:55]
    s_waitcnt lgkmcnt(0)
    v_mfma_f32_16x16x32_bf16 v[60:63], a[212:215], v[104:107], v[60:63]
    s_barrier
    v_mfma_f32_16x16x32_bf16 v[60:63], a[220:223], v[108:111], v[60:63]
    ds_read_b128 v[80:83], v159 offset:0
    v_mfma_f32_16x16x32_bf16 v[56:59], a[216:219], v[108:111], v[56:59]
    ds_read_b128 v[84:87], v159 offset:6144
    v_and_b32 v193, 0xffff0000, v160
    v_lshlrev_b32 v192, 16, v160
    v_mfma_f32_16x16x32_bf16 v[56:59], a[208:211], v[104:107], v[56:59]
    ds_read_b128 v[88:91], v159 offset:256
    v_and_b32 v195, 0xffff0000, v161
    v_lshlrev_b32 v194, 16, v161
    v_mfma_f32_16x16x32_bf16 v[64:67], a[208:211], v[112:115], v[64:67]
    ds_read_b128 v[92:95], v159 offset:6400
    v_add_f32 v32, v32, v192
    v_mfma_f32_16x16x32_bf16 v[64:67], a[216:219], v[116:119], v[64:67]
    ds_read_b128 v[96:99], v159 offset:512
    v_add_f32 v33, v33, v193
    v_add_f32 v34, v34, v194
    v_mfma_f32_16x16x32_bf16 v[68:71], a[220:223], v[116:119], v[68:71]
    ds_read_b128 v[100:103], v159 offset:6656
    v_add_f32 v35, v35, v195
    v_and_b32 v197, 0xffff0000, v162
    v_mfma_f32_16x16x32_bf16 v[68:71], a[212:215], v[112:115], v[68:71]
    ds_read_b64_tr_b16 a[48:49], v10 offset:32768
    v_lshlrev_b32 v196, 16, v162
    v_and_b32 v199, 0xffff0000, v163
    v_mfma_f32_16x16x32_bf16 v[76:79], a[212:215], v[120:123], v[76:79]
    ds_read_b64_tr_b16 a[50:51], v10 offset:34816
    v_lshlrev_b32 v198, 16, v163
    v_mfma_f32_16x16x32_bf16 v[76:79], a[220:223], v[124:127], v[76:79]
    ds_read_b64_tr_b16 a[52:53], v11 offset:32768
    v_add_f32 v36, v36, v196
    v_add_f32 v37, v37, v197
    v_mfma_f32_16x16x32_bf16 v[72:75], a[216:219], v[124:127], v[72:75]
    ds_read_b64_tr_b16 a[54:55], v11 offset:34816
    v_add_f32 v38, v38, v198
    v_add_f32 v39, v39, v199
    v_mfma_f32_16x16x32_bf16 v[72:75], a[208:211], v[120:123], v[72:75]
    s_waitcnt lgkmcnt(4)
    v_mfma_f32_16x16x32_bf16 v[32:35], a[224:227], v[80:83], v[32:35]
    s_add_u32 m0, s73, 0
    s_lshl_b32 s14, s90, 17
    v_mfma_f32_16x16x32_bf16 v[32:35], a[232:235], v[84:87], v[32:35]
    ds_read_b128 v[104:107], v159 offset:768
    v_mfma_f32_16x16x32_bf16 v[36:39], a[236:239], v[84:87], v[36:39]
    ds_read_b128 v[108:111], v159 offset:6912
    buffer_load_dwordx4 v4, s[52:55], s14 offen offset:0 lds
    v_and_b32 v193, 0xffff0000, v176
    v_mfma_f32_16x16x32_bf16 v[36:39], a[228:231], v[80:83], v[36:39]
    ds_read_b128 v[112:115], v159 offset:1024
    v_lshlrev_b32 v192, 16, v176
    v_and_b32 v195, 0xffff0000, v177
    v_lshlrev_b32 v194, 16, v177
    v_mfma_f32_16x16x32_bf16 v[44:47], a[228:231], v[88:91], v[44:47]
    ds_read_b128 v[116:119], v159 offset:7168
    buffer_load_dwordx4 v5, s[52:55], s14 offen offset:1024 lds
    v_add_f32 v64, v64, v192
    v_mfma_f32_16x16x32_bf16 v[44:47], a[236:239], v[92:95], v[44:47]
    ds_read_b128 v[120:123], v159 offset:1280
    v_add_f32 v65, v65, v193
    v_add_f32 v66, v66, v194
    v_mfma_f32_16x16x32_bf16 v[40:43], a[232:235], v[92:95], v[40:43]
    ds_read_b128 v[124:127], v159 offset:7424
    v_add_f32 v67, v67, v195
    v_and_b32 v197, 0xffff0000, v178
    v_mfma_f32_16x16x32_bf16 v[40:43], a[224:227], v[88:91], v[40:43]
    ds_read_b64_tr_b16 a[56:57], v12 offset:32768
    buffer_load_dwordx4 v6, s[52:55], s14 offen offset:2048 lds
    v_lshlrev_b32 v196, 16, v178
    v_mfma_f32_16x16x32_bf16 v[48:51], a[224:227], v[96:99], v[48:51]
    ds_read_b64_tr_b16 a[58:59], v12 offset:34816
    v_and_b32 v199, 0xffff0000, v179
    v_lshlrev_b32 v198, 16, v179
    v_add_f32 v68, v68, v196
    v_mfma_f32_16x16x32_bf16 v[48:51], a[232:235], v[100:103], v[48:51]
    ds_read_b64_tr_b16 a[60:61], v13 offset:32768
    buffer_load_dwordx4 v7, s[52:55], s14 offen offset:3072 lds
    v_add_f32 v69, v69, v197
    v_mfma_f32_16x16x32_bf16 v[52:55], a[236:239], v[100:103], v[52:55]
    ds_read_b64_tr_b16 a[62:63], v13 offset:34816
    v_add_f32 v70, v70, v198
    v_add_f32 v71, v71, v199
    v_mfma_f32_16x16x32_bf16 v[52:55], a[228:231], v[96:99], v[52:55]
    s_waitcnt lgkmcnt(4)
    v_mfma_f32_16x16x32_bf16 v[60:63], a[228:231], v[104:107], v[60:63]
    s_waitcnt vmcnt(12)
    s_barrier
    v_mfma_f32_16x16x32_bf16 v[60:63], a[236:239], v[108:111], v[60:63]
    ds_read_b128 v[80:83], v159 offset:12288
    v_mfma_f32_16x16x32_bf16 v[56:59], a[232:235], v[108:111], v[56:59]
    ds_read_b128 v[84:87], v159 offset:18432
    v_and_b32 v193, 0xffff0000, v164
    v_mfma_f32_16x16x32_bf16 v[56:59], a[224:227], v[104:107], v[56:59]
    ds_read_b128 v[88:91], v159 offset:12544
    v_lshlrev_b32 v192, 16, v164
    v_mfma_f32_16x16x32_bf16 v[64:67], a[224:227], v[112:115], v[64:67]
    ds_read_b128 v[92:95], v159 offset:18688
    v_and_b32 v195, 0xffff0000, v165
    v_mfma_f32_16x16x32_bf16 v[64:67], a[232:235], v[116:119], v[64:67]
    ds_read_b128 v[96:99], v159 offset:12800
    v_lshlrev_b32 v194, 16, v165
    v_mfma_f32_16x16x32_bf16 v[68:71], a[236:239], v[116:119], v[68:71]
    ds_read_b128 v[100:103], v159 offset:18944
    v_add_f32 v40, v40, v192
    v_mfma_f32_16x16x32_bf16 v[68:71], a[228:231], v[112:115], v[68:71]
    v_add_f32 v41, v41, v193
    v_add_f32 v42, v42, v194
    v_add_f32 v43, v43, v195
    v_mfma_f32_16x16x32_bf16 v[76:79], a[228:231], v[120:123], v[76:79]
    v_and_b32 v197, 0xffff0000, v166
    v_lshlrev_b32 v196, 16, v166
    v_and_b32 v199, 0xffff0000, v167
    v_mfma_f32_16x16x32_bf16 v[76:79], a[236:239], v[124:127], v[76:79]
    v_lshlrev_b32 v198, 16, v167
    v_add_f32 v44, v44, v196
    v_add_f32 v45, v45, v197
    v_mfma_f32_16x16x32_bf16 v[72:75], a[232:235], v[124:127], v[72:75]
    v_add_f32 v46, v46, v198
    v_add_f32 v47, v47, v199
    v_mfma_f32_16x16x32_bf16 v[72:75], a[224:227], v[120:123], v[72:75]
    s_waitcnt lgkmcnt(0)
    v_mfma_f32_16x16x32_bf16 v[32:35], a[240:243], v[80:83], v[32:35]
    s_add_u32 m0, s73, 16384
    s_lshl_b32 s14, s91, 17
    v_mfma_f32_16x16x32_bf16 v[32:35], a[248:251], v[84:87], v[32:35]
    ds_read_b128 v[104:107], v159 offset:13056
    v_mfma_f32_16x16x32_bf16 v[36:39], a[252:255], v[84:87], v[36:39]
    ds_read_b128 v[108:111], v159 offset:19200
    buffer_load_dwordx4 v4, s[52:55], s14 offen offset:0 lds
    v_mfma_f32_16x16x32_bf16 v[36:39], a[244:247], v[80:83], v[36:39]
    ds_read_b128 v[112:115], v159 offset:13312
    v_and_b32 v193, 0xffff0000, v180
    v_lshlrev_b32 v192, 16, v180
    v_mfma_f32_16x16x32_bf16 v[44:47], a[244:247], v[88:91], v[44:47]
    ds_read_b128 v[116:119], v159 offset:19456
    buffer_load_dwordx4 v5, s[52:55], s14 offen offset:1024 lds
    v_mfma_f32_16x16x32_bf16 v[44:47], a[252:255], v[92:95], v[44:47]
    ds_read_b128 v[120:123], v159 offset:13568
    v_and_b32 v195, 0xffff0000, v181
    v_lshlrev_b32 v194, 16, v181
    v_mfma_f32_16x16x32_bf16 v[40:43], a[248:251], v[92:95], v[40:43]
    ds_read_b128 v[124:127], v159 offset:19712
    v_add_f32 v72, v72, v192
    v_add_f32 v73, v73, v193
    v_mfma_f32_16x16x32_bf16 v[40:43], a[240:243], v[88:91], v[40:43]
    buffer_load_dwordx4 v6, s[52:55], s14 offen offset:2048 lds
    v_add_f32 v74, v74, v194
    v_add_f32 v75, v75, v195
    v_mfma_f32_16x16x32_bf16 v[48:51], a[240:243], v[96:99], v[48:51]
    v_and_b32 v197, 0xffff0000, v182
    v_lshlrev_b32 v196, 16, v182
    v_and_b32 v199, 0xffff0000, v183
    v_mfma_f32_16x16x32_bf16 v[48:51], a[248:251], v[100:103], v[48:51]
    buffer_load_dwordx4 v7, s[52:55], s14 offen offset:3072 lds
    v_lshlrev_b32 v198, 16, v183
    v_add_f32 v76, v76, v196
    v_mfma_f32_16x16x32_bf16 v[52:55], a[252:255], v[100:103], v[52:55]
    v_add_f32 v77, v77, v197
    v_add_f32 v78, v78, v198
    v_add_f32 v79, v79, v199
    v_mfma_f32_16x16x32_bf16 v[52:55], a[244:247], v[96:99], v[52:55]
    s_waitcnt lgkmcnt(0)
    v_mfma_f32_16x16x32_bf16 v[60:63], a[244:247], v[104:107], v[60:63]
    s_barrier
    v_mfma_f32_16x16x32_bf16 v[60:63], a[252:255], v[108:111], v[60:63]
    s_add_u32 m0, s73, 131072
    s_lshl_b32 s14, s92, 17
    v_mfma_f32_16x16x32_bf16 v[56:59], a[248:251], v[108:111], v[56:59]
    v_and_b32 v193, 0xffff0000, v168
    v_lshlrev_b32 v192, 16, v168
    v_mfma_f32_16x16x32_bf16 v[56:59], a[240:243], v[104:107], v[56:59]
    buffer_load_dwordx4 v4, s[52:55], s14 offen offset:0 lds
    v_and_b32 v195, 0xffff0000, v169
    v_mfma_f32_16x16x32_bf16 v[64:67], a[240:243], v[112:115], v[64:67]
    v_lshlrev_b32 v194, 16, v169
    v_add_f32 v48, v48, v192
    v_add_f32 v49, v49, v193
    v_mfma_f32_16x16x32_bf16 v[64:67], a[248:251], v[116:119], v[64:67]
    buffer_load_dwordx4 v5, s[52:55], s14 offen offset:1024 lds
    v_add_f32 v50, v50, v194
    v_mfma_f32_16x16x32_bf16 v[68:71], a[252:255], v[116:119], v[68:71]
    v_add_f32 v51, v51, v195
    v_and_b32 v197, 0xffff0000, v170
    v_mfma_f32_16x16x32_bf16 v[68:71], a[244:247], v[112:115], v[68:71]
    buffer_load_dwordx4 v6, s[52:55], s14 offen offset:2048 lds
    v_lshlrev_b32 v196, 16, v170
    v_mfma_f32_16x16x32_bf16 v[76:79], a[244:247], v[120:123], v[76:79]
    v_and_b32 v199, 0xffff0000, v171
    v_lshlrev_b32 v198, 16, v171
    v_add_f32 v52, v52, v196
    v_mfma_f32_16x16x32_bf16 v[76:79], a[252:255], v[124:127], v[76:79]
    buffer_load_dwordx4 v7, s[52:55], s14 offen offset:3072 lds
    v_add_f32 v53, v53, v197
    v_mfma_f32_16x16x32_bf16 v[72:75], a[248:251], v[124:127], v[72:75]
    v_add_f32 v54, v54, v198
    v_add_f32 v55, v55, v199
    v_mfma_f32_16x16x32_bf16 v[72:75], a[240:243], v[120:123], v[72:75]
    s_waitcnt lgkmcnt(0)
    v_mov_b32 v88, 0xc0135761
    s_mov_b32 s10, 0xbdd2d3e8
    s_lshl_b32 s9, s69, 2
    s_add_u32 s9, s9, s3
    s_mul_i32 s9, s9, 69632
    s_add_u32 s9, s9, 12795904
    v_pk_mul_f32 v[160:161], v[32:33], v[32:33]
    v_pk_mul_f32 v[162:163], v[34:35], v[34:35]
    v_pk_mul_f32 v[164:165], v[36:37], v[36:37]
    v_pk_mul_f32 v[166:167], v[38:39], v[38:39]
    v_pk_mul_f32 v[168:169], v[40:41], v[40:41]
    v_pk_mul_f32 v[170:171], v[42:43], v[42:43]
    v_pk_mul_f32 v[172:173], v[44:45], v[44:45]
    v_pk_mul_f32 v[174:175], v[46:47], v[46:47]
    v_pk_fma_f32 v[160:161], v[160:161], s[10:11], v[88:89] op_sel_hi:[1,0,0]
    v_pk_fma_f32 v[162:163], v[162:163], s[10:11], v[88:89] op_sel_hi:[1,0,0]
    v_pk_fma_f32 v[164:165], v[164:165], s[10:11], v[88:89] op_sel_hi:[1,0,0]
    v_pk_fma_f32 v[166:167], v[166:167], s[10:11], v[88:89] op_sel_hi:[1,0,0]
    v_pk_fma_f32 v[168:169], v[168:169], s[10:11], v[88:89] op_sel_hi:[1,0,0]
    v_pk_fma_f32 v[170:171], v[170:171], s[10:11], v[88:89] op_sel_hi:[1,0,0]
    v_pk_fma_f32 v[172:173], v[172:173], s[10:11], v[88:89] op_sel_hi:[1,0,0]
    v_pk_fma_f32 v[174:175], v[174:175], s[10:11], v[88:89] op_sel_hi:[1,0,0]
    v_pk_mul_f32 v[160:161], v[160:161], v[32:33]
    v_pk_mul_f32 v[162:163], v[162:163], v[34:35]
    v_pk_mul_f32 v[164:165], v[164:165], v[36:37]
    v_pk_mul_f32 v[166:167], v[166:167], v[38:39]
    v_pk_mul_f32 v[168:169], v[168:169], v[40:41]
    v_pk_mul_f32 v[170:171], v[170:171], v[42:43]
    v_pk_mul_f32 v[172:173], v[172:173], v[44:45]
    v_pk_mul_f32 v[174:175], v[174:175], v[46:47]
    v_exp_f32 v160, v160
    v_exp_f32 v161, v161
    v_exp_f32 v162, v162
    v_exp_f32 v163, v163
    v_exp_f32 v164, v164
    v_exp_f32 v165, v165
    v_exp_f32 v166, v166
    v_exp_f32 v167, v167
    v_exp_f32 v168, v168
    v_exp_f32 v169, v169
    v_exp_f32 v170, v170
    v_exp_f32 v171, v171
    v_exp_f32 v172, v172
    v_exp_f32 v173, v173
    v_exp_f32 v174, v174
    v_exp_f32 v175, v175
    v_pk_add_f32 v[160:161], v[160:161], 1.0 op_sel_hi:[1,0]
    v_pk_add_f32 v[162:163], v[162:163], 1.0 op_sel_hi:[1,0]
    v_pk_add_f32 v[164:165], v[164:165], 1.0 op_sel_hi:[1,0]
    v_pk_add_f32 v[166:167], v[166:167], 1.0 op_sel_hi:[1,0]
    v_pk_add_f32 v[168:169], v[168:169], 1.0 op_sel_hi:[1,0]
    v_pk_add_f32 v[170:171], v[170:171], 1.0 op_sel_hi:[1,0]
    v_pk_add_f32 v[172:173], v[172:173], 1.0 op_sel_hi:[1,0]
    v_pk_add_f32 v[174:175], v[174:175], 1.0 op_sel_hi:[1,0]
    v_rcp_f32 v160, v160
    v_rcp_f32 v161, v161
    v_rcp_f32 v162, v162
    v_rcp_f32 v163, v163
    v_rcp_f32 v164, v164
    v_rcp_f32 v165, v165
    v_rcp_f32 v166, v166
    v_rcp_f32 v167, v167
    v_rcp_f32 v168, v168
    v_rcp_f32 v169, v169
    v_rcp_f32 v170, v170
    v_rcp_f32 v171, v171
    v_rcp_f32 v172, v172
    v_rcp_f32 v173, v173
    v_rcp_f32 v174, v174
    v_rcp_f32 v175, v175
    v_pk_mul_f32 v[32:33], v[32:33], v[160:161]
    v_pk_mul_f32 v[34:35], v[34:35], v[162:163]
    v_pk_mul_f32 v[36:37], v[36:37], v[164:165]
    v_pk_mul_f32 v[38:39], v[38:39], v[166:167]
    v_pk_mul_f32 v[40:41], v[40:41], v[168:169]
    v_pk_mul_f32 v[42:43], v[42:43], v[170:171]
    v_pk_mul_f32 v[44:45], v[44:45], v[172:173]
    v_pk_mul_f32 v[46:47], v[46:47], v[174:175]
    v_cvt_pk_bf16_f32 v96, v32, v33
    v_cvt_pk_bf16_f32 v97, v34, v35
    v_cvt_pk_bf16_f32 v98, v36, v37
    v_cvt_pk_bf16_f32 v99, v38, v39
    v_cvt_pk_bf16_f32 v100, v40, v41
    v_cvt_pk_bf16_f32 v101, v42, v43
    v_cvt_pk_bf16_f32 v102, v44, v45
    v_cvt_pk_bf16_f32 v103, v46, v47
    buffer_store_dwordx4 v[96:99], v240, s[44:47], s9 offen sc1
    buffer_store_dwordx4 v[100:103], v241, s[44:47], s9 offen sc1
    v_pk_mul_f32 v[160:161], v[48:49], v[48:49]
    v_pk_mul_f32 v[162:163], v[50:51], v[50:51]
    v_pk_mul_f32 v[164:165], v[52:53], v[52:53]
    v_pk_mul_f32 v[166:167], v[54:55], v[54:55]
    v_pk_mul_f32 v[168:169], v[56:57], v[56:57]
    v_pk_mul_f32 v[170:171], v[58:59], v[58:59]
    v_pk_mul_f32 v[172:173], v[60:61], v[60:61]
    v_pk_mul_f32 v[174:175], v[62:63], v[62:63]
    v_pk_fma_f32 v[160:161], v[160:161], s[10:11], v[88:89] op_sel_hi:[1,0,0]
    v_pk_fma_f32 v[162:163], v[162:163], s[10:11], v[88:89] op_sel_hi:[1,0,0]
    v_pk_fma_f32 v[164:165], v[164:165], s[10:11], v[88:89] op_sel_hi:[1,0,0]
    v_pk_fma_f32 v[166:167], v[166:167], s[10:11], v[88:89] op_sel_hi:[1,0,0]
    v_pk_fma_f32 v[168:169], v[168:169], s[10:11], v[88:89] op_sel_hi:[1,0,0]
    v_pk_fma_f32 v[170:171], v[170:171], s[10:11], v[88:89] op_sel_hi:[1,0,0]
    v_pk_fma_f32 v[172:173], v[172:173], s[10:11], v[88:89] op_sel_hi:[1,0,0]
    v_pk_fma_f32 v[174:175], v[174:175], s[10:11], v[88:89] op_sel_hi:[1,0,0]
    v_pk_mul_f32 v[160:161], v[160:161], v[48:49]
    v_pk_mul_f32 v[162:163], v[162:163], v[50:51]
    v_pk_mul_f32 v[164:165], v[164:165], v[52:53]
    v_pk_mul_f32 v[166:167], v[166:167], v[54:55]
    v_pk_mul_f32 v[168:169], v[168:169], v[56:57]
    v_pk_mul_f32 v[170:171], v[170:171], v[58:59]
    v_pk_mul_f32 v[172:173], v[172:173], v[60:61]
    v_pk_mul_f32 v[174:175], v[174:175], v[62:63]
    v_exp_f32 v160, v160
    v_exp_f32 v161, v161
    v_exp_f32 v162, v162
    v_exp_f32 v163, v163
    v_exp_f32 v164, v164
    v_exp_f32 v165, v165
    v_exp_f32 v166, v166
    v_exp_f32 v167, v167
    v_exp_f32 v168, v168
    v_exp_f32 v169, v169
    v_exp_f32 v170, v170
    v_exp_f32 v171, v171
    v_exp_f32 v172, v172
    v_exp_f32 v173, v173
    v_exp_f32 v174, v174
    v_exp_f32 v175, v175
    v_pk_add_f32 v[160:161], v[160:161], 1.0 op_sel_hi:[1,0]
    v_pk_add_f32 v[162:163], v[162:163], 1.0 op_sel_hi:[1,0]
    v_pk_add_f32 v[164:165], v[164:165], 1.0 op_sel_hi:[1,0]
    v_pk_add_f32 v[166:167], v[166:167], 1.0 op_sel_hi:[1,0]
    v_pk_add_f32 v[168:169], v[168:169], 1.0 op_sel_hi:[1,0]
    v_pk_add_f32 v[170:171], v[170:171], 1.0 op_sel_hi:[1,0]
    v_pk_add_f32 v[172:173], v[172:173], 1.0 op_sel_hi:[1,0]
    v_pk_add_f32 v[174:175], v[174:175], 1.0 op_sel_hi:[1,0]
    v_rcp_f32 v160, v160
    v_rcp_f32 v161, v161
    v_rcp_f32 v162, v162
    v_rcp_f32 v163, v163
    v_rcp_f32 v164, v164
    v_rcp_f32 v165, v165
    v_rcp_f32 v166, v166
    v_rcp_f32 v167, v167
    v_rcp_f32 v168, v168
    v_rcp_f32 v169, v169
    v_rcp_f32 v170, v170
    v_rcp_f32 v171, v171
    v_rcp_f32 v172, v172
    v_rcp_f32 v173, v173
    v_rcp_f32 v174, v174
    v_rcp_f32 v175, v175
    v_pk_mul_f32 v[48:49], v[48:49], v[160:161]
    v_pk_mul_f32 v[50:51], v[50:51], v[162:163]
    v_pk_mul_f32 v[52:53], v[52:53], v[164:165]
    v_pk_mul_f32 v[54:55], v[54:55], v[166:167]
    v_pk_mul_f32 v[56:57], v[56:57], v[168:169]
    v_pk_mul_f32 v[58:59], v[58:59], v[170:171]
    v_pk_mul_f32 v[60:61], v[60:61], v[172:173]
    v_pk_mul_f32 v[62:63], v[62:63], v[174:175]
    v_cvt_pk_bf16_f32 v104, v48, v49
    v_cvt_pk_bf16_f32 v105, v50, v51
    v_cvt_pk_bf16_f32 v106, v52, v53
    v_cvt_pk_bf16_f32 v107, v54, v55
    v_cvt_pk_bf16_f32 v108, v56, v57
    v_cvt_pk_bf16_f32 v109, v58, v59
    v_cvt_pk_bf16_f32 v110, v60, v61
    v_cvt_pk_bf16_f32 v111, v62, v63
    buffer_store_dwordx4 v[104:107], v242, s[44:47], s9 offen sc1
    buffer_store_dwordx4 v[108:111], v243, s[44:47], s9 offen sc1
    v_pk_mul_f32 v[160:161], v[64:65], v[64:65]
    v_pk_mul_f32 v[162:163], v[66:67], v[66:67]
    v_pk_mul_f32 v[164:165], v[68:69], v[68:69]
    v_pk_mul_f32 v[166:167], v[70:71], v[70:71]
    v_pk_mul_f32 v[168:169], v[72:73], v[72:73]
    v_pk_mul_f32 v[170:171], v[74:75], v[74:75]
    v_pk_mul_f32 v[172:173], v[76:77], v[76:77]
    v_pk_mul_f32 v[174:175], v[78:79], v[78:79]
    v_pk_fma_f32 v[160:161], v[160:161], s[10:11], v[88:89] op_sel_hi:[1,0,0]
    v_pk_fma_f32 v[162:163], v[162:163], s[10:11], v[88:89] op_sel_hi:[1,0,0]
    v_pk_fma_f32 v[164:165], v[164:165], s[10:11], v[88:89] op_sel_hi:[1,0,0]
    v_pk_fma_f32 v[166:167], v[166:167], s[10:11], v[88:89] op_sel_hi:[1,0,0]
    v_pk_fma_f32 v[168:169], v[168:169], s[10:11], v[88:89] op_sel_hi:[1,0,0]
    v_pk_fma_f32 v[170:171], v[170:171], s[10:11], v[88:89] op_sel_hi:[1,0,0]
    v_pk_fma_f32 v[172:173], v[172:173], s[10:11], v[88:89] op_sel_hi:[1,0,0]
    v_pk_fma_f32 v[174:175], v[174:175], s[10:11], v[88:89] op_sel_hi:[1,0,0]
    v_pk_mul_f32 v[160:161], v[160:161], v[64:65]
    v_pk_mul_f32 v[162:163], v[162:163], v[66:67]
    v_pk_mul_f32 v[164:165], v[164:165], v[68:69]
    v_pk_mul_f32 v[166:167], v[166:167], v[70:71]
    v_pk_mul_f32 v[168:169], v[168:169], v[72:73]
    v_pk_mul_f32 v[170:171], v[170:171], v[74:75]
    v_pk_mul_f32 v[172:173], v[172:173], v[76:77]
    v_pk_mul_f32 v[174:175], v[174:175], v[78:79]
    v_exp_f32 v160, v160
    v_exp_f32 v161, v161
    v_exp_f32 v162, v162
    v_exp_f32 v163, v163
    v_exp_f32 v164, v164
    v_exp_f32 v165, v165
    v_exp_f32 v166, v166
    v_exp_f32 v167, v167
    v_exp_f32 v168, v168
    v_exp_f32 v169, v169
    v_exp_f32 v170, v170
    v_exp_f32 v171, v171
    v_exp_f32 v172, v172
    v_exp_f32 v173, v173
    v_exp_f32 v174, v174
    v_exp_f32 v175, v175
    v_pk_add_f32 v[160:161], v[160:161], 1.0 op_sel_hi:[1,0]
    v_pk_add_f32 v[162:163], v[162:163], 1.0 op_sel_hi:[1,0]
    v_pk_add_f32 v[164:165], v[164:165], 1.0 op_sel_hi:[1,0]
    v_pk_add_f32 v[166:167], v[166:167], 1.0 op_sel_hi:[1,0]
    v_pk_add_f32 v[168:169], v[168:169], 1.0 op_sel_hi:[1,0]
    v_pk_add_f32 v[170:171], v[170:171], 1.0 op_sel_hi:[1,0]
    v_pk_add_f32 v[172:173], v[172:173], 1.0 op_sel_hi:[1,0]
    v_pk_add_f32 v[174:175], v[174:175], 1.0 op_sel_hi:[1,0]
    v_rcp_f32 v160, v160
    v_rcp_f32 v161, v161
    v_rcp_f32 v162, v162
    v_rcp_f32 v163, v163
    v_rcp_f32 v164, v164
    v_rcp_f32 v165, v165
    v_rcp_f32 v166, v166
    v_rcp_f32 v167, v167
    v_rcp_f32 v168, v168
    v_rcp_f32 v169, v169
    v_rcp_f32 v170, v170
    v_rcp_f32 v171, v171
    v_rcp_f32 v172, v172
    v_rcp_f32 v173, v173
    v_rcp_f32 v174, v174
    v_rcp_f32 v175, v175
    v_pk_mul_f32 v[64:65], v[64:65], v[160:161]
    v_pk_mul_f32 v[66:67], v[66:67], v[162:163]
    v_pk_mul_f32 v[68:69], v[68:69], v[164:165]
    v_pk_mul_f32 v[70:71], v[70:71], v[166:167]
    v_pk_mul_f32 v[72:73], v[72:73], v[168:169]
    v_pk_mul_f32 v[74:75], v[74:75], v[170:171]
    v_pk_mul_f32 v[76:77], v[76:77], v[172:173]
    v_pk_mul_f32 v[78:79], v[78:79], v[174:175]
    v_cvt_pk_bf16_f32 v112, v64, v65
    v_cvt_pk_bf16_f32 v113, v66, v67
    v_cvt_pk_bf16_f32 v114, v68, v69
    v_cvt_pk_bf16_f32 v115, v70, v71
    v_cvt_pk_bf16_f32 v116, v72, v73
    v_cvt_pk_bf16_f32 v117, v74, v75
    v_cvt_pk_bf16_f32 v118, v76, v77
    v_cvt_pk_bf16_f32 v119, v78, v79
    buffer_store_dwordx4 v[112:115], v244, s[44:47], s9 offen sc1
    buffer_store_dwordx4 v[116:119], v245, s[44:47], s9 offen sc1
    s_waitcnt vmcnt(0)
    s_barrier
    buffer_store_dword v249, v17, s[44:47], 0 offen sc1
L_pl_G_5:
    s_cbranch_execz L_wret
    s_add_u32 m0, s73, 81920
    s_lshl_b32 s14, s93, 17
    buffer_load_dwordx4 v4, s[52:55], s14 offen offset:0 lds
    buffer_load_dwordx4 v5, s[52:55], s14 offen offset:1024 lds
    buffer_load_dwordx4 v6, s[52:55], s14 offen offset:2048 lds
    buffer_load_dwordx4 v7, s[52:55], s14 offen offset:3072 lds
    s_add_u32 m0, s73, 98304
    s_lshl_b32 s14, s94, 17
    buffer_load_dwordx4 v4, s[52:55], s14 offen offset:0 lds
    buffer_load_dwordx4 v5, s[52:55], s14 offen offset:1024 lds
    buffer_load_dwordx4 v6, s[52:55], s14 offen offset:2048 lds
    buffer_load_dwordx4 v7, s[52:55], s14 offen offset:3072 lds
    s_add_u32 m0, s73, 114688
    s_lshl_b32 s14, s95, 17
    buffer_load_dwordx4 v4, s[52:55], s14 offen offset:0 lds
    buffer_load_dwordx4 v5, s[52:55], s14 offen offset:1024 lds
    buffer_load_dwordx4 v6, s[52:55], s14 offen offset:2048 lds
    buffer_load_dwordx4 v7, s[52:55], s14 offen offset:3072 lds
    s_add_u32 m0, s73, 147456
    s_lshl_b32 s14, s96, 17
    buffer_load_dwordx4 v4, s[52:55], s14 offen offset:0 lds
    buffer_load_dwordx4 v5, s[52:55], s14 offen offset:1024 lds
    buffer_load_dwordx4 v6, s[52:55], s14 offen offset:2048 lds
    buffer_load_dwordx4 v7, s[52:55], s14 offen offset:3072 lds
    s_add_u32 m0, s73, 32768
    s_lshl_b32 s14, s97, 17
    buffer_load_dwordx4 v4, s[52:55], s14 offen offset:0 lds
    buffer_load_dwordx4 v5, s[52:55], s14 offen offset:1024 lds
    buffer_load_dwordx4 v6, s[52:55], s14 offen offset:2048 lds
    buffer_load_dwordx4 v7, s[52:55], s14 offen offset:3072 lds
    ds_read_b64_tr_b16 a[64:65], v10 offset:49152
    ds_read_b64_tr_b16 a[66:67], v10 offset:51200
    ds_read_b64_tr_b16 a[68:69], v11 offset:49152
    ds_read_b64_tr_b16 a[70:71], v11 offset:51200
    ds_read_b64_tr_b16 a[72:73], v12 offset:49152
    ds_read_b64_tr_b16 a[74:75], v12 offset:51200
    ds_read_b64_tr_b16 a[76:77], v13 offset:49152
    ds_read_b64_tr_b16 a[78:79], v13 offset:51200
    s_waitcnt lgkmcnt(0)
    v_add_u32 v10, 65536, v10
    ds_read_b64_tr_b16 a[80:81], v10 offset:0
    s_add_u32 m0, s73, 49152
    s_lshl_b32 s14, s98, 17
    ds_read_b64_tr_b16 a[82:83], v10 offset:2048
    buffer_load_dwordx4 v4, s[52:55], s14 offen offset:0 lds
    v_add_u32 v11, 65536, v11
    ds_read_b64_tr_b16 a[84:85], v11 offset:0
    ds_read_b64_tr_b16 a[86:87], v11 offset:2048
    buffer_load_dwordx4 v5, s[52:55], s14 offen offset:1024 lds
    v_add_u32 v12, 65536, v12
    ds_read_b64_tr_b16 a[88:89], v12 offset:0
    buffer_load_dwordx4 v6, s[52:55], s14 offen offset:2048 lds
    ds_read_b64_tr_b16 a[90:91], v12 offset:2048
    v_add_u32 v13, 65536, v13
    ds_read_b64_tr_b16 a[92:93], v13 offset:0
    buffer_load_dwordx4 v7, s[52:55], s14 offen offset:3072 lds
    ds_read_b64_tr_b16 a[94:95], v13 offset:2048
    s_waitcnt lgkmcnt(0)
    v_add_u32 v10, -65536, v10
    ds_read_b64_tr_b16 a[96:97], v10 offset:0
    s_add_u32 m0, s73, 65536
    s_lshl_b32 s14, s99, 17
    ds_read_b64_tr_b16 a[98:99], v10 offset:2048
    buffer_load_dwordx4 v4, s[52:55], s14 offen offset:0 lds
    v_add_u32 v11, -65536, v11
    ds_read_b64_tr_b16 a[100:101], v11 offset:0
    ds_read_b64_tr_b16 a[102:103], v11 offset:2048
    buffer_load_dwordx4 v5, s[52:55], s14 offen offset:1024 lds
    v_add_u32 v12, -65536, v12
    ds_read_b64_tr_b16 a[104:105], v12 offset:0
    buffer_load_dwordx4 v6, s[52:55], s14 offen offset:2048 lds
    ds_read_b64_tr_b16 a[106:107], v12 offset:2048
    v_add_u32 v13, -65536, v13
    ds_read_b64_tr_b16 a[108:109], v13 offset:0
    buffer_load_dwordx4 v7, s[52:55], s14 offen offset:3072 lds
    ds_read_b64_tr_b16 a[110:111], v13 offset:2048
    s_waitcnt lgkmcnt(0)
    ds_read_b64_tr_b16 a[112:113], v10 offset:16384
    s_add_u32 m0, s73, 0
    s_lshl_b32 s14, s100, 17
    ds_read_b64_tr_b16 a[114:115], v10 offset:18432
    buffer_load_dwordx4 v4, s[52:55], s14 offen offset:0 lds
    ds_read_b64_tr_b16 a[116:117], v11 offset:16384
    ds_read_b64_tr_b16 a[118:119], v11 offset:18432
    buffer_load_dwordx4 v5, s[52:55], s14 offen offset:1024 lds
    ds_read_b64_tr_b16 a[120:121], v12 offset:16384
    buffer_load_dwordx4 v6, s[52:55], s14 offen offset:2048 lds
    ds_read_b64_tr_b16 a[122:123], v12 offset:18432
    ds_read_b64_tr_b16 a[124:125], v13 offset:16384
    buffer_load_dwordx4 v7, s[52:55], s14 offen offset:3072 lds
    ds_read_b64_tr_b16 a[126:127], v13 offset:18432
    s_waitcnt lgkmcnt(0)
    v_add_u32 v10, 131072, v10
    ds_read_b64_tr_b16 a[128:129], v10 offset:0
    s_add_u32 m0, s73, 16384
    s_lshl_b32 s14, s101, 17
    ds_read_b64_tr_b16 a[130:131], v10 offset:2048
    buffer_load_dwordx4 v4, s[52:55], s14 offen offset:0 lds
    v_add_u32 v11, 131072, v11
    ds_read_b64_tr_b16 a[132:133], v11 offset:0
    ds_read_b64_tr_b16 a[134:135], v11 offset:2048
    buffer_load_dwordx4 v5, s[52:55], s14 offen offset:1024 lds
    v_add_u32 v12, 131072, v12
    ds_read_b64_tr_b16 a[136:137], v12 offset:0
    buffer_load_dwordx4 v6, s[52:55], s14 offen offset:2048 lds
    ds_read_b64_tr_b16 a[138:139], v12 offset:2048
    v_add_u32 v13, 131072, v13
    ds_read_b64_tr_b16 a[140:141], v13 offset:0
    buffer_load_dwordx4 v7, s[52:55], s14 offen offset:3072 lds
    ds_read_b64_tr_b16 a[142:143], v13 offset:2048
    s_waitcnt vmcnt(32)
    v_add_u32 v10, -65536, v10
    ds_read_b64_tr_b16 a[144:145], v10 offset:16384
    ds_read_b64_tr_b16 a[146:147], v10 offset:18432
    v_add_u32 v11, -65536, v11
    ds_read_b64_tr_b16 a[148:149], v11 offset:16384
    ds_read_b64_tr_b16 a[150:151], v11 offset:18432
    v_add_u32 v12, -65536, v12
    ds_read_b64_tr_b16 a[152:153], v12 offset:16384
    ds_read_b64_tr_b16 a[154:155], v12 offset:18432
    v_add_u32 v13, -65536, v13
    ds_read_b64_tr_b16 a[156:157], v13 offset:16384
    ds_read_b64_tr_b16 a[158:159], v13 offset:18432
    s_waitcnt vmcnt(28)
    ds_read_b64_tr_b16 a[160:161], v10 offset:32768
    ds_read_b64_tr_b16 a[162:163], v10 offset:34816
    ds_read_b64_tr_b16 a[164:165], v11 offset:32768
    ds_read_b64_tr_b16 a[166:167], v11 offset:34816
    ds_read_b64_tr_b16 a[168:169], v12 offset:32768
    ds_read_b64_tr_b16 a[170:171], v12 offset:34816
    ds_read_b64_tr_b16 a[172:173], v13 offset:32768
    ds_read_b64_tr_b16 a[174:175], v13 offset:34816
    s_waitcnt vmcnt(24)
    ds_read_b64_tr_b16 a[176:177], v10 offset:49152
    ds_read_b64_tr_b16 a[178:179], v10 offset:51200
    ds_read_b64_tr_b16 a[180:181], v11 offset:49152
    ds_read_b64_tr_b16 a[182:183], v11 offset:51200
    ds_read_b64_tr_b16 a[184:185], v12 offset:49152
    ds_read_b64_tr_b16 a[186:187], v12 offset:51200
    ds_read_b64_tr_b16 a[188:189], v13 offset:49152
    ds_read_b64_tr_b16 a[190:191], v13 offset:51200
    s_waitcnt vmcnt(20)
    v_add_u32 v10, 65536, v10
    ds_read_b64_tr_b16 a[192:193], v10 offset:16384
    ds_read_b64_tr_b16 a[194:195], v10 offset:18432
    v_add_u32 v11, 65536, v11
    ds_read_b64_tr_b16 a[196:197], v11 offset:16384
    ds_read_b64_tr_b16 a[198:199], v11 offset:18432
    v_add_u32 v12, 65536, v12
    ds_read_b64_tr_b16 a[200:201], v12 offset:16384
    ds_read_b64_tr_b16 a[202:203], v12 offset:18432
    v_add_u32 v13, 65536, v13
    ds_read_b64_tr_b16 a[204:205], v13 offset:16384
    ds_read_b64_tr_b16 a[206:207], v13 offset:18432
    buffer_load_dword v19, v18, s[44:47], 0 offen sc1
    s_waitcnt vmcnt(17)
    v_add_u32 v10, -131072, v10
    ds_read_b64_tr_b16 a[208:209], v10 offset:32768
    ds_read_b64_tr_b16 a[210:211], v10 offset:34816
    v_add_u32 v11, -131072, v11
    ds_read_b64_tr_b16 a[212:213], v11 offset:32768
    ds_read_b64_tr_b16 a[214:215], v11 offset:34816
    v_add_u32 v12, -131072, v12
    ds_read_b64_tr_b16 a[216:217], v12 offset:32768
    ds_read_b64_tr_b16 a[218:219], v12 offset:34816
    v_add_u32 v13, -131072, v13
    ds_read_b64_tr_b16 a[220:221], v13 offset:32768
    ds_read_b64_tr_b16 a[222:223], v13 offset:34816
    s_waitcnt lgkmcnt(0)
L_DG:
    s_mov_b32 s8, 12386304
    s_lshl_b32 s7, s71, 6
    s_lshl_b32 s4, s3, 4
    s_add_u32 s7, s7, s4
    s_mul_i32 s7, s7, 1152
    s_mul_i32 s4, s72, 144
    s_add_u32 s7, s7, s4
    s_add_u32 m0, s73, 131072
    s_nop 0
    buffer_load_dwordx4 v14, s[56:59], s7 offen offset:0 lds
    buffer_load_dwordx4 v15, s[56:59], s7 offen offset:1024 lds
    buffer_load_dwordx4 v16, s[56:59], s7 offen offset:2048 lds
    buffer_load_dwordx2 v[26:27], v26, s[44:47], s8 offen sc1
    s_mul_i32 s84, s84, 69632
    s_mul_i32 s85, s85, 69632
    s_mul_i32 s86, s86, 69632
    s_mul_i32 s87, s87, 69632
    s_mul_i32 s88, s88, 69632
    s_mul_i32 s89, s89, 69632
    s_mul_i32 s90, s90, 69632
    s_mul_i32 s91, s91, 69632
    s_mul_i32 s92, s92, 69632
    s_mul_i32 s93, s93, 69632
    s_mul_i32 s94, s94, 69632
    s_mul_i32 s95, s95, 69632
    s_mul_i32 s96, s96, 69632
    s_mul_i32 s97, s97, 69632
    s_mul_i32 s98, s98, 69632
    s_mul_i32 s99, s99, 69632
    s_mul_i32 s100, s100, 69632
    s_mul_i32 s101, s101, 69632
    s_waitcnt vmcnt(4)
    v_cmp_ne_u32 vcc, s68, v19
    s_cbranch_vccnz L_rs_p2G
L_ok_p2G:
    buffer_load_dwordx4 v[140:143], v8, s[44:47], s84 offen offset:0 sc1
    buffer_load_dwordx4 v[144:147], v8, s[44:47], s85 offen offset:0 sc1
    buffer_load_dwordx4 v[148:151], v8, s[44:47], s84 offen offset:512 sc1
    buffer_load_dwordx4 v[152:155], v8, s[44:47], s85 offen offset:512 sc1
    buffer_load_dwordx4 v[156:159], v8, s[44:47], s84 offen offset:768 sc1
    buffer_load_dwordx4 v[160:163], v8, s[44:47], s85 offen offset:768 sc1
    buffer_load_dwordx4 v[164:167], v8, s[44:47], s84 offen offset:1024 sc1
    buffer_load_dwordx4 v[168:171], v8, s[44:47], s85 offen offset:1024 sc1
    buffer_load_dwordx4 v[172:175], v9, s[44:47], s84 offen offset:1536 sc1
    buffer_load_dwordx4 v[176:179], v9, s[44:47], s85 offen offset:1536 sc1
    buffer_load_dwordx4 v[180:183], v8, s[44:47], s86 offen offset:0 sc1
    buffer_load_dwordx4 v[184:187], v8, s[44:47], s87 offen offset:0 sc1
    buffer_load_dwordx4 v[188:191], v8, s[44:47], s86 offen offset:512 sc1
    buffer_load_dwordx4 v[192:195], v8, s[44:47], s87 offen offset:512 sc1
    buffer_load_dwordx4 v[196:199], v8, s[44:47], s86 offen offset:768 sc1
    buffer_load_dwordx4 v[200:203], v8, s[44:47], s87 offen offset:768 sc1
    buffer_load_dwordx4 v[204:207], v8, s[44:47], s86 offen offset:1024 sc1
    buffer_load_dwordx4 v[208:211], v8, s[44:47], s87 offen offset:1024 sc1
    s_waitcnt vmcnt(16)
    v_mfma_f32_16x16x32_bf16 v[52:55], v[140:143], a[4:7], 0
    v_mfma_f32_16x16x32_bf16 v[52:55], v[144:147], a[20:23], v[52:55]
    buffer_load_dwordx4 v[212:215], v9, s[44:47], s86 offen offset:1536 sc1
    v_mfma_f32_16x16x32_bf16 v[56:59], v[144:147], a[24:27], 0
    v_mfma_f32_16x16x32_bf16 v[56:59], v[140:143], a[8:11], v[56:59]
    v_mfma_f32_16x16x32_bf16 v[60:63], v[140:143], a[12:15], 0
    buffer_load_dwordx4 v[216:219], v9, s[44:47], s87 offen offset:1536 sc1
    v_mfma_f32_16x16x32_bf16 v[60:63], v[144:147], a[28:31], v[60:63]
    v_mfma_f32_16x16x32_bf16 v[32:35], v[144:147], a[16:19], 0
    v_mfma_f32_16x16x32_bf16 v[32:35], v[140:143], a[0:3], v[32:35]
    s_waitcnt vmcnt(16)
    v_mfma_f32_16x16x32_bf16 v[36:39], v[148:151], a[0:3], 0
    v_mfma_f32_16x16x32_bf16 v[36:39], v[152:155], a[16:19], v[36:39]
    buffer_load_dwordx4 v[140:143], v8, s[44:47], s88 offen offset:0 sc1
    v_mfma_f32_16x16x32_bf16 v[72:75], v[152:155], a[28:31], 0
    v_mfma_f32_16x16x32_bf16 v[72:75], v[148:151], a[12:15], v[72:75]
    v_mfma_f32_16x16x32_bf16 v[68:71], v[148:151], a[8:11], 0
    buffer_load_dwordx4 v[144:147], v8, s[44:47], s89 offen offset:0 sc1
    v_mfma_f32_16x16x32_bf16 v[68:71], v[152:155], a[24:27], v[68:71]
    v_mfma_f32_16x16x32_bf16 v[64:67], v[152:155], a[20:23], 0
    v_mfma_f32_16x16x32_bf16 v[64:67], v[148:151], a[4:7], v[64:67]
    s_waitcnt vmcnt(16)
    v_mfma_f32_16x16x32_bf16 v[76:79], v[156:159], a[4:7], 0
    v_mfma_f32_16x16x32_bf16 v[76:79], v[160:163], a[20:23], v[76:79]
    buffer_load_dwordx4 v[148:151], v8, s[44:47], s88 offen offset:512 sc1
    v_mfma_f32_16x16x32_bf16 v[80:83], v[160:163], a[24:27], 0
    v_mfma_f32_16x16x32_bf16 v[80:83], v[156:159], a[8:11], v[80:83]
    v_mfma_f32_16x16x32_bf16 v[84:87], v[156:159], a[12:15], 0
    buffer_load_dwordx4 v[152:155], v8, s[44:47], s89 offen offset:512 sc1
    v_mfma_f32_16x16x32_bf16 v[84:87], v[160:163], a[28:31], v[84:87]
    s_xor_b32 s7, s3, 1
    s_lshl_b32 s7, s7, 14
    v_mfma_f32_16x16x32_bf16 v[40:43], v[160:163], a[16:19], 0
    v_mfma_f32_16x16x32_bf16 v[40:43], v[156:159], a[0:3], v[40:43]
    s_waitcnt vmcnt(16)
    v_mfma_f32_16x16x32_bf16 v[44:47], v[164:167], a[0:3], 0
    s_add_u32 s7, s7, 0
    v_lshl_add_u32 v4, v2, 4, s7
    v_mfma_f32_16x16x32_bf16 v[44:47], v[168:171], a[16:19], v[44:47]
    buffer_load_dwordx4 v[156:159], v8, s[44:47], s88 offen offset:768 sc1
    v_mfma_f32_16x16x32_bf16 v[96:99], v[168:171], a[28:31], 0
    v_mfma_f32_16x16x32_bf16 v[96:99], v[164:167], a[12:15], v[96:99]
    s_xor_b32 s7, s3, 2
    s_lshl_b32 s7, s7, 14
    v_mfma_f32_16x16x32_bf16 v[92:95], v[164:167], a[8:11], 0
    buffer_load_dwordx4 v[160:163], v8, s[44:47], s89 offen offset:768 sc1
    v_mfma_f32_16x16x32_bf16 v[92:95], v[168:171], a[24:27], v[92:95]
    v_mfma_f32_16x16x32_bf16 v[88:91], v[168:171], a[20:23], 0
    s_add_u32 s7, s7, 5120
    v_lshl_add_u32 v5, v2, 4, s7
    v_mfma_f32_16x16x32_bf16 v[88:91], v[164:167], a[4:7], v[88:91]
    s_waitcnt vmcnt(16)
    v_mfma_f32_16x16x32_bf16 v[100:103], v[172:175], a[4:7], 0
    s_xor_b32 s7, s3, 3
    s_lshl_b32 s7, s7, 14
    v_mfma_f32_16x16x32_bf16 v[100:103], v[176:179], a[20:23], v[100:103]
    buffer_load_dwordx4 v[164:167], v8, s[44:47], s88 offen offset:1024 sc1
    v_mfma_f32_16x16x32_bf16 v[104:107], v[176:179], a[24:27], 0
    v_mfma_f32_16x16x32_bf16 v[104:107], v[172:175], a[8:11], v[104:107]
    s_add_u32 s7, s7, 10240
    v_lshl_add_u32 v6, v2, 4, s7
    v_mfma_f32_16x16x32_bf16 v[108:111], v[172:175], a[12:15], 0
    buffer_load_dwordx4 v[168:171], v8, s[44:47], s89 offen offset:1024 sc1
    v_mfma_f32_16x16x32_bf16 v[108:111], v[176:179], a[28:31], v[108:111]
    v_mfma_f32_16x16x32_bf16 v[48:51], v[176:179], a[16:19], 0
    s_lshl_b32 s7, s3, 14
    v_lshl_add_u32 v7, v2, 4, s7
    v_mfma_f32_16x16x32_bf16 v[48:51], v[172:175], a[0:3], v[48:51]
    s_waitcnt vmcnt(16)
    v_mfma_f32_16x16x32_bf16 v[32:35], v[180:183], a[32:35], v[32:35]
    v_mfma_f32_16x16x32_bf16 v[32:35], v[184:187], a[48:51], v[32:35]
    buffer_load_dwordx4 v[172:175], v9, s[44:47], s88 offen offset:1536 sc1
    v_mfma_f32_16x16x32_bf16 v[60:63], v[184:187], a[60:63], v[60:63]
    v_lshlrev_b32 v30, 16, v30
    v_mfma_f32_16x16x32_bf16 v[60:63], v[180:183], a[44:47], v[60:63]
    v_mfma_f32_16x16x32_bf16 v[56:59], v[180:183], a[40:43], v[56:59]
    buffer_load_dwordx4 v[176:179], v9, s[44:47], s89 offen offset:1536 sc1
    v_mfma_f32_16x16x32_bf16 v[56:59], v[184:187], a[56:59], v[56:59]
    v_mfma_f32_16x16x32_bf16 v[52:55], v[184:187], a[52:55], v[52:55]
    v_mov_b32 v112, v30
    v_mfma_f32_16x16x32_bf16 v[52:55], v[180:183], a[36:39], v[52:55]
    s_waitcnt vmcnt(16)
    v_mfma_f32_16x16x32_bf16 v[64:67], v[188:191], a[36:39], v[64:67]
    v_mfma_f32_16x16x32_bf16 v[64:67], v[192:195], a[52:55], v[64:67]
    buffer_load_dwordx4 v[180:183], v8, s[44:47], s90 offen offset:0 sc1
    v_mfma_f32_16x16x32_bf16 v[68:71], v[192:195], a[56:59], v[68:71]
    v_mov_b32 v113, v30
    v_mfma_f32_16x16x32_bf16 v[68:71], v[188:191], a[40:43], v[68:71]
    v_mfma_f32_16x16x32_bf16 v[72:75], v[188:191], a[44:47], v[72:75]
    buffer_load_dwordx4 v[184:187], v8, s[44:47], s91 offen offset:0 sc1
    v_mfma_f32_16x16x32_bf16 v[72:75], v[192:195], a[60:63], v[72:75]
    v_mfma_f32_16x16x32_bf16 v[36:39], v[192:195], a[48:51], v[36:39]
    v_mov_b32 v114, v30
    v_mfma_f32_16x16x32_bf16 v[36:39], v[188:191], a[32:35], v[36:39]
    s_waitcnt vmcnt(16)
    v_mfma_f32_16x16x32_bf16 v[40:43], v[196:199], a[32:35], v[40:43]
    v_mfma_f32_16x16x32_bf16 v[40:43], v[200:203], a[48:51], v[40:43]
    buffer_load_dwordx4 v[188:191], v8, s[44:47], s90 offen offset:512 sc1
    v_mfma_f32_16x16x32_bf16 v[84:87], v[200:203], a[60:63], v[84:87]
    v_mov_b32 v115, v30
    v_mfma_f32_16x16x32_bf16 v[84:87], v[196:199], a[44:47], v[84:87]
    v_mfma_f32_16x16x32_bf16 v[80:83], v[196:199], a[40:43], v[80:83]
    buffer_load_dwordx4 v[192:195], v8, s[44:47], s91 offen offset:512 sc1
    v_mfma_f32_16x16x32_bf16 v[80:83], v[200:203], a[56:59], v[80:83]
    v_mfma_f32_16x16x32_bf16 v[76:79], v[200:203], a[52:55], v[76:79]
    v_mfma_f32_16x16x32_bf16 v[76:79], v[196:199], a[36:39], v[76:79]
    s_waitcnt vmcnt(16)
    v_mfma_f32_16x16x32_bf16 v[88:91], v[204:207], a[36:39], v[88:91]
    v_mfma_f32_16x16x32_bf16 v[88:91], v[208:211], a[52:55], v[88:91]
    buffer_load_dwordx4 v[196:199], v8, s[44:47], s90 offen offset:768 sc1
    v_mfma_f32_16x16x32_bf16 v[92:95], v[208:211], a[56:59], v[92:95]
    ds_read_b64_tr_b16 a[224:225], v10 offset:49152
    v_mfma_f32_16x16x32_bf16 v[92:95], v[204:207], a[40:43], v[92:95]
    v_mfma_f32_16x16x32_bf16 v[96:99], v[204:207], a[44:47], v[96:99]
    buffer_load_dwordx4 v[200:203], v8, s[44:47], s91 offen offset:768 sc1
    v_mfma_f32_16x16x32_bf16 v[96:99], v[208:211], a[60:63], v[96:99]
    v_mfma_f32_16x16x32_bf16 v[44:47], v[208:211], a[48:51], v[44:47]
    ds_read_b64_tr_b16 a[226:227], v10 offset:51200
    v_mfma_f32_16x16x32_bf16 v[44:47], v[204:207], a[32:35], v[44:47]
    s_waitcnt vmcnt(16)
    v_mfma_f32_16x16x32_bf16 v[48:51], v[212:215], a[32:35], v[48:51]
    v_mfma_f32_16x16x32_bf16 v[48:51], v[216:219], a[48:51], v[48:51]
    buffer_load_dwordx4 v[204:207], v8, s[44:47], s90 offen offset:1024 sc1
    v_mfma_f32_16x16x32_bf16 v[108:111], v[216:219], a[60:63], v[108:111]
    ds_read_b64_tr_b16 a[228:229], v11 offset:49152
    v_mfma_f32_16x16x32_bf16 v[108:111], v[212:215], a[44:47], v[108:111]
    v_mfma_f32_16x16x32_bf16 v[104:107], v[212:215], a[40:43], v[104:107]
    buffer_load_dwordx4 v[208:211], v8, s[44:47], s91 offen offset:1024 sc1
    v_mfma_f32_16x16x32_bf16 v[104:107], v[216:219], a[56:59], v[104:107]
    v_mfma_f32_16x16x32_bf16 v[100:103], v[216:219], a[52:55], v[100:103]
    ds_read_b64_tr_b16 a[230:231], v11 offset:51200
    v_mfma_f32_16x16x32_bf16 v[100:103], v[212:215], a[36:39], v[100:103]
    s_waitcnt vmcnt(16)
    v_mfma_f32_16x16x32_bf16 v[52:55], v[140:143], a[68:71], v[52:55]
    v_mfma_f32_16x16x32_bf16 v[52:55], v[144:147], a[84:87], v[52:55]
    buffer_load_dwordx4 v[212:215], v9, s[44:47], s90 offen offset:1536 sc1
    v_mfma_f32_16x16x32_bf16 v[56:59], v[144:147], a[88:91], v[56:59]
    ds_read_b64_tr_b16 a[232:233], v12 offset:49152
    v_mfma_f32_16x16x32_bf16 v[56:59], v[140:143], a[72:75], v[56:59]
    v_mfma_f32_16x16x32_bf16 v[60:63], v[140:143], a[76:79], v[60:63]
    buffer_load_dwordx4 v[216:219], v9, s[44:47], s91 offen offset:1536 sc1
    v_mfma_f32_16x16x32_bf16 v[60:63], v[144:147], a[92:95], v[60:63]
    ds_read_b64_tr_b16 a[234:235], v12 offset:51200
    v_mfma_f32_16x16x32_bf16 v[32:35], v[144:147], a[80:83], v[32:35]
    v_mfma_f32_16x16x32_bf16 v[32:35], v[140:143], a[64:67], v[32:35]
    s_waitcnt vmcnt(16)
    v_mfma_f32_16x16x32_bf16 v[36:39], v[148:151], a[64:67], v[36:39]
    ds_read_b64_tr_b16 a[236:237], v13 offset:49152
    v_mfma_f32_16x16x32_bf16 v[36:39], v[152:155], a[80:83], v[36:39]
    buffer_load_dwordx4 v[140:143], v8, s[44:47], s92 offen offset:0 sc1
    v_mfma_f32_16x16x32_bf16 v[72:75], v[152:155], a[92:95], v[72:75]
    v_mfma_f32_16x16x32_bf16 v[72:75], v[148:151], a[76:79], v[72:75]
    ds_read_b64_tr_b16 a[238:239], v13 offset:51200
    v_mfma_f32_16x16x32_bf16 v[68:71], v[148:151], a[72:75], v[68:71]
    buffer_load_dwordx4 v[144:147], v8, s[44:47], s93 offen offset:0 sc1
    v_mfma_f32_16x16x32_bf16 v[68:71], v[152:155], a[88:91], v[68:71]
    v_mfma_f32_16x16x32_bf16 v[64:67], v[152:155], a[84:87], v[64:67]
    v_mfma_f32_16x16x32_bf16 v[64:67], v[148:151], a[68:71], v[64:67]
    s_waitcnt vmcnt(16)
    v_mfma_f32_16x16x32_bf16 v[76:79], v[156:159], a[68:71], v[76:79]
    v_mfma_f32_16x16x32_bf16 v[76:79], v[160:163], a[84:87], v[76:79]
    buffer_load_dwordx4 v[148:151], v8, s[44:47], s92 offen offset:512 sc1
    v_mfma_f32_16x16x32_bf16 v[80:83], v[160:163], a[88:91], v[80:83]
    v_add_u32 v10, 65536, v10
    v_mfma_f32_16x16x32_bf16 v[80:83], v[156:159], a[72:75], v[80:83]
    v_mfma_f32_16x16x32_bf16 v[84:87], v[156:159], a[76:79], v[84:87]
    buffer_load_dwordx4 v[152:155], v8, s[44:47], s93 offen offset:512 sc1
    v_mfma_f32_16x16x32_bf16 v[84:87], v[160:163], a[92:95], v[84:87]
    v_mfma_f32_16x16x32_bf16 v[40:43], v[160:163], a[80:83], v[40:43]
    ds_read_b64_tr_b16 a[240:241], v10 offset:0
    v_mfma_f32_16x16x32_bf16 v[40:43], v[156:159], a[64:67], v[40:43]
    s_waitcnt vmcnt(16)
    v_mfma_f32_16x16x32_bf16 v[44:47], v[164:167], a[64:67], v[44:47]
    v_mfma_f32_16x16x32_bf16 v[44:47], v[168:171], a[80:83], v[44:47]
    buffer_load_dwordx4 v[156:159], v8, s[44:47], s92 offen offset:768 sc1
    v_mfma_f32_16x16x32_bf16 v[96:99], v[168:171], a[92:95], v[96:99]
    ds_read_b64_tr_b16 a[242:243], v10 offset:2048
    v_mfma_f32_16x16x32_bf16 v[96:99], v[164:167], a[76:79], v[96:99]
    v_mfma_f32_16x16x32_bf16 v[92:95], v[164:167], a[72:75], v[92:95]
    buffer_load_dwordx4 v[160:163], v8, s[44:47], s93 offen offset:768 sc1
    v_mfma_f32_16x16x32_bf16 v[92:95], v[168:171], a[88:91], v[92:95]
    v_mfma_f32_16x16x32_bf16 v[88:91], v[168:171], a[84:87], v[88:91]
    v_add_u32 v11, 65536, v11
    v_mfma_f32_16x16x32_bf16 v[88:91], v[164:167], a[68:71], v[88:91]
    s_waitcnt vmcnt(16)
    v_mfma_f32_16x16x32_bf16 v[100:103], v[172:175], a[68:71], v[100:103]
    v_mfma_f32_16x16x32_bf16 v[100:103], v[176:179], a[84:87], v[100:103]
    buffer_load_dwordx4 v[164:167], v8, s[44:47], s92 offen offset:1024 sc1
    v_mfma_f32_16x16x32_bf16 v[104:107], v[176:179], a[88:91], v[104:107]
    ds_read_b64_tr_b16 a[244:245], v11 offset:0
    v_mfma_f32_16x16x32_bf16 v[104:107], v[172:175], a[72:75], v[104:107]
    v_mfma_f32_16x16x32_bf16 v[108:111], v[172:175], a[76:79], v[108:111]
    buffer_load_dwordx4 v[168:171], v8, s[44:47], s93 offen offset:1024 sc1
    v_mfma_f32_16x16x32_bf16 v[108:111], v[176:179], a[92:95], v[108:111]
    v_mfma_f32_16x16x32_bf16 v[48:51], v[176:179], a[80:83], v[48:51]
    ds_read_b64_tr_b16 a[246:247], v11 offset:2048
    v_mfma_f32_16x16x32_bf16 v[48:51], v[172:175], a[64:67], v[48:51]
    s_waitcnt vmcnt(16)
    v_mfma_f32_16x16x32_bf16 v[32:35], v[180:183], a[96:99], v[32:35]
    v_mfma_f32_16x16x32_bf16 v[32:35], v[184:187], a[112:115], v[32:35]
    buffer_load_dwordx4 v[172:175], v9, s[44:47], s92 offen offset:1536 sc1
    v_mfma_f32_16x16x32_bf16 v[60:63], v[184:187], a[124:127], v[60:63]
    v_add_u32 v12, 65536, v12
    v_mfma_f32_16x16x32_bf16 v[60:63], v[180:183], a[108:111], v[60:63]
    ds_read_b64 v[14:15], v1 offset:0
    v_mfma_f32_16x16x32_bf16 v[56:59], v[180:183], a[104:107], v[56:59]
    buffer_load_dwordx4 v[176:179], v9, s[44:47], s93 offen offset:1536 sc1
    v_mfma_f32_16x16x32_bf16 v[56:59], v[184:187], a[120:123], v[56:59]
    ds_read_b64_tr_b16 a[248:249], v12 offset:0
    v_mfma_f32_16x16x32_bf16 v[52:55], v[184:187], a[116:119], v[52:55]
    ds_read_b64 v[16:17], v1 offset:32
    v_mfma_f32_16x16x32_bf16 v[52:55], v[180:183], a[100:103], v[52:55]
    s_waitcnt vmcnt(16)
    v_mfma_f32_16x16x32_bf16 v[64:67], v[188:191], a[100:103], v[64:67]
    ds_read_b64_tr_b16 a[250:251], v12 offset:2048
    v_mfma_f32_16x16x32_bf16 v[64:67], v[192:195], a[116:119], v[64:67]
    buffer_load_dwordx4 v[180:183], v8, s[44:47], s94 offen offset:0 sc1
    v_mfma_f32_16x16x32_bf16 v[68:71], v[192:195], a[120:123], v[68:71]
    ds_read_b64 v[18:19], v1 offset:64
    v_mfma_f32_16x16x32_bf16 v[68:71], v[188:191], a[104:107], v[68:71]
    v_add_u32 v13, 65536, v13
    v_mfma_f32_16x16x32_bf16 v[72:75], v[188:191], a[108:111], v[72:75]
    buffer_load_dwordx4 v[184:187], v8, s[44:47], s95 offen offset:0 sc1
    v_mfma_f32_16x16x32_bf16 v[72:75], v[192:195], a[124:127], v[72:75]
    v_mfma_f32_16x16x32_bf16 v[36:39], v[192:195], a[112:115], v[36:39]
    ds_read_b64_tr_b16 a[252:253], v13 offset:0
    v_mfma_f32_16x16x32_bf16 v[36:39], v[188:191], a[96:99], v[36:39]
    s_waitcnt vmcnt(16)
    v_mfma_f32_16x16x32_bf16 v[40:43], v[196:199], a[96:99], v[40:43]
    ds_read_b64 v[20:21], v1 offset:96
    v_mfma_f32_16x16x32_bf16 v[40:43], v[200:203], a[112:115], v[40:43]
    buffer_load_dwordx4 v[188:191], v8, s[44:47], s94 offen offset:512 sc1
    v_mfma_f32_16x16x32_bf16 v[84:87], v[200:203], a[124:127], v[84:87]
    ds_read_b64_tr_b16 a[254:255], v13 offset:2048
    v_mfma_f32_16x16x32_bf16 v[84:87], v[196:199], a[108:111], v[84:87]
    ds_read_b64 v[22:23], v24 offset:128
    v_mfma_f32_16x16x32_bf16 v[80:83], v[196:199], a[104:107], v[80:83]
    buffer_load_dwordx4 v[192:195], v8, s[44:47], s95 offen offset:512 sc1
    v_mfma_f32_16x16x32_bf16 v[80:83], v[200:203], a[120:123], v[80:83]
    v_mfma_f32_16x16x32_bf16 v[76:79], v[200:203], a[116:119], v[76:79]
    v_mfma_f32_16x16x32_bf16 v[76:79], v[196:199], a[100:103], v[76:79]
    s_waitcnt vmcnt(16)
    v_mfma_f32_16x16x32_bf16 v[88:91], v[204:207], a[100:103], v[88:91]
    v_mfma_f32_16x16x32_bf16 v[88:91], v[208:211], a[116:119], v[88:91]
    buffer_load_dwordx4 v[196:199], v8, s[44:47], s94 offen offset:768 sc1
    v_mfma_f32_16x16x32_bf16 v[92:95], v[208:211], a[120:123], v[92:95]
    v_add_u32 v10, -65536, v10
    v_mfma_f32_16x16x32_bf16 v[92:95], v[204:207], a[104:107], v[92:95]
    v_mfma_f32_16x16x32_bf16 v[96:99], v[204:207], a[108:111], v[96:99]
    buffer_load_dwordx4 v[200:203], v8, s[44:47], s95 offen offset:768 sc1
    v_mfma_f32_16x16x32_bf16 v[96:99], v[208:211], a[124:127], v[96:99]
    v_mfma_f32_16x16x32_bf16 v[44:47], v[208:211], a[112:115], v[44:47]
    ds_read_b64_tr_b16 v[220:221], v10 offset:0
    v_mfma_f32_16x16x32_bf16 v[44:47], v[204:207], a[96:99], v[44:47]
    s_waitcnt vmcnt(16)
    v_mfma_f32_16x16x32_bf16 v[48:51], v[212:215], a[96:99], v[48:51]
    v_mfma_f32_16x16x32_bf16 v[48:51], v[216:219], a[112:115], v[48:51]
    buffer_load_dwordx4 v[204:207], v8, s[44:47], s94 offen offset:1024 sc1
    v_mfma_f32_16x16x32_bf16 v[108:111], v[216:219], a[124:127], v[108:111]
    ds_read_b64_tr_b16 v[222:223], v10 offset:2048
    v_mfma_f32_16x16x32_bf16 v[108:111], v[212:215], a[108:111], v[108:111]
    v_mfma_f32_16x16x32_bf16 v[104:107], v[212:215], a[104:107], v[104:107]
    buffer_load_dwordx4 v[208:211], v8, s[44:47], s95 offen offset:1024 sc1
    v_mfma_f32_16x16x32_bf16 v[104:107], v[216:219], a[120:123], v[104:107]
    v_mfma_f32_16x16x32_bf16 v[100:103], v[216:219], a[116:119], v[100:103]
    v_add_u32 v11, -65536, v11
    v_mfma_f32_16x16x32_bf16 v[100:103], v[212:215], a[100:103], v[100:103]
    s_waitcnt vmcnt(16)
    v_mfma_f32_16x16x32_bf16 v[52:55], v[140:143], a[132:135], v[52:55]
    v_mfma_f32_16x16x32_bf16 v[52:55], v[144:147], a[148:151], v[52:55]
    buffer_load_dwordx4 v[212:215], v9, s[44:47], s94 offen offset:1536 sc1
    v_mfma_f32_16x16x32_bf16 v[56:59], v[144:147], a[152:155], v[56:59]
    ds_read_b64_tr_b16 v[224:225], v11 offset:0
    v_mfma_f32_16x16x32_bf16 v[56:59], v[140:143], a[136:139], v[56:59]
    v_mfma_f32_16x16x32_bf16 v[60:63], v[140:143], a[140:143], v[60:63]
    buffer_load_dwordx4 v[216:219], v9, s[44:47], s95 offen offset:1536 sc1
    v_mfma_f32_16x16x32_bf16 v[60:63], v[144:147], a[156:159], v[60:63]
    ds_read_b64_tr_b16 v[226:227], v11 offset:2048
    v_mfma_f32_16x16x32_bf16 v[32:35], v[144:147], a[144:147], v[32:35]
    v_mfma_f32_16x16x32_bf16 v[32:35], v[140:143], a[128:131], v[32:35]
    s_waitcnt vmcnt(16)
    v_mfma_f32_16x16x32_bf16 v[36:39], v[148:151], a[128:131], v[36:39]
    v_add_u32 v12, -65536, v12
    v_mfma_f32_16x16x32_bf16 v[36:39], v[152:155], a[144:147], v[36:39]
    buffer_load_dwordx4 v[140:143], v8, s[44:47], s96 offen offset:0 sc1
    v_mfma_f32_16x16x32_bf16 v[72:75], v[152:155], a[156:159], v[72:75]
    v_mfma_f32_16x16x32_bf16 v[72:75], v[148:151], a[140:143], v[72:75]
    ds_read_b64_tr_b16 v[228:229], v12 offset:0
    v_mfma_f32_16x16x32_bf16 v[68:71], v[148:151], a[136:139], v[68:71]
    buffer_load_dwordx4 v[144:147], v8, s[44:47], s97 offen offset:0 sc1
    v_mfma_f32_16x16x32_bf16 v[68:71], v[152:155], a[152:155], v[68:71]
    v_mfma_f32_16x16x32_bf16 v[64:67], v[152:155], a[148:151], v[64:67]
    ds_read_b64_tr_b16 v[230:231], v12 offset:2048
    v_mfma_f32_16x16x32_bf16 v[64:67], v[148:151], a[132:135], v[64:67]
    s_waitcnt vmcnt(16)
    v_mfma_f32_16x16x32_bf16 v[76:79], v[156:159], a[132:135], v[76:79]
    v_mfma_f32_16x16x32_bf16 v[76:79], v[160:163], a[148:151], v[76:79]
    buffer_load_dwordx4 v[148:151], v8, s[44:47], s96 offen offset:512 sc1
    v_mfma_f32_16x16x32_bf16 v[80:83], v[160:163], a[152:155], v[80:83]
    v_add_u32 v13, -65536, v13
    v_mfma_f32_16x16x32_bf16 v[80:83], v[156:159], a[136:139], v[80:83]
    v_mfma_f32_16x16x32_bf16 v[84:87], v[156:159], a[140:143], v[84:87]
    buffer_load_dwordx4 v[152:155], v8, s[44:47], s97 offen offset:512 sc1
    v_mfma_f32_16x16x32_bf16 v[84:87], v[160:163], a[156:159], v[84:87]
    s_mul_i32 s4, s72, 9
    s_lshr_b32 s4, s4, 1
    s_lshl_b32 s4, s4, 2
    v_min_u32 v28, 19, v2
    v_mfma_f32_16x16x32_bf16 v[40:43], v[160:163], a[144:147], v[40:43]
    ds_read_b64_tr_b16 v[232:233], v13 offset:0
    v_mfma_f32_16x16x32_bf16 v[40:43], v[156:159], a[128:131], v[40:43]
    s_waitcnt vmcnt(16)
    v_mfma_f32_16x16x32_bf16 v[44:47], v[164:167], a[128:131], v[44:47]
    v_add_u32 v28, s4, v28
    v_mfma_f32_16x16x32_bf16 v[44:47], v[168:171], a[144:147], v[44:47]
    buffer_load_dwordx4 v[156:159], v8, s[44:47], s96 offen offset:768 sc1
    v_mfma_f32_16x16x32_bf16 v[96:99], v[168:171], a[156:159], v[96:99]
    ds_read_b64_tr_b16 v[234:235], v13 offset:2048
    v_mfma_f32_16x16x32_bf16 v[96:99], v[164:167], a[140:143], v[96:99]
    v_and_b32 v29, 3, v28
    v_mfma_f32_16x16x32_bf16 v[92:95], v[164:167], a[136:139], v[92:95]
    buffer_load_dwordx4 v[160:163], v8, s[44:47], s97 offen offset:768 sc1
    v_mfma_f32_16x16x32_bf16 v[92:95], v[168:171], a[152:155], v[92:95]
    v_lshrrev_b32 v28, 2, v28
    v_mfma_f32_16x16x32_bf16 v[88:91], v[168:171], a[148:151], v[88:91]
    v_mfma_f32_16x16x32_bf16 v[88:91], v[164:167], a[132:135], v[88:91]
L_pl_G_6:
    s_cbranch_execz L_wret
    v_lshlrev_b32 v28, 7, v28
    s_waitcnt vmcnt(16)
    v_mfma_f32_16x16x32_bf16 v[100:103], v[172:175], a[132:135], v[100:103]
    v_lshl_add_u32 v28, v29, 2, v28
    v_mfma_f32_16x16x32_bf16 v[100:103], v[176:179], a[148:151], v[100:103]
    buffer_load_dwordx4 v[164:167], v8, s[44:47], s96 offen offset:1024 sc1
    v_mfma_f32_16x16x32_bf16 v[104:107], v[176:179], a[152:155], v[104:107]
    ds_read_b64_tr_b16 v[236:237], v10 offset:16384
    v_mfma_f32_16x16x32_bf16 v[104:107], v[172:175], a[136:139], v[104:107]
    v_add_u32 v28, 12582912, v28
    v_mfma_f32_16x16x32_bf16 v[108:111], v[172:175], a[140:143], v[108:111]
    buffer_load_dwordx4 v[168:171], v8, s[44:47], s97 offen offset:1024 sc1
    v_mfma_f32_16x16x32_bf16 v[108:111], v[176:179], a[156:159], v[108:111]
    buffer_load_dword v29, v28, s[44:47], 0 offen sc1
    v_mfma_f32_16x16x32_bf16 v[48:51], v[176:179], a[144:147], v[48:51]
    ds_read_b64_tr_b16 v[238:239], v10 offset:18432
    v_mfma_f32_16x16x32_bf16 v[48:51], v[172:175], a[128:131], v[48:51]
    s_waitcnt vmcnt(17)
    v_mfma_f32_16x16x32_bf16 v[32:35], v[180:183], a[160:163], v[32:35]
    v_mfma_f32_16x16x32_bf16 v[32:35], v[184:187], a[176:179], v[32:35]
    buffer_load_dwordx4 v[172:175], v9, s[44:47], s96 offen offset:1536 sc1
    v_mfma_f32_16x16x32_bf16 v[60:63], v[184:187], a[188:191], v[60:63]
    ds_read_b64_tr_b16 v[240:241], v11 offset:16384
    v_mfma_f32_16x16x32_bf16 v[60:63], v[180:183], a[172:175], v[60:63]
    v_mfma_f32_16x16x32_bf16 v[56:59], v[180:183], a[168:171], v[56:59]
    buffer_load_dwordx4 v[176:179], v9, s[44:47], s97 offen offset:1536 sc1
    v_mfma_f32_16x16x32_bf16 v[56:59], v[184:187], a[184:187], v[56:59]
    ds_read_b64_tr_b16 v[242:243], v11 offset:18432
    v_mfma_f32_16x16x32_bf16 v[52:55], v[184:187], a[180:183], v[52:55]
    v_mfma_f32_16x16x32_bf16 v[52:55], v[180:183], a[164:167], v[52:55]
    s_waitcnt vmcnt(17)
    v_mfma_f32_16x16x32_bf16 v[64:67], v[188:191], a[164:167], v[64:67]
    ds_read_b64_tr_b16 v[244:245], v12 offset:16384
    v_mfma_f32_16x16x32_bf16 v[64:67], v[192:195], a[180:183], v[64:67]
    buffer_load_dwordx4 v[180:183], v8, s[44:47], s98 offen offset:0 sc1
    v_mfma_f32_16x16x32_bf16 v[68:71], v[192:195], a[184:187], v[68:71]
    v_mfma_f32_16x16x32_bf16 v[68:71], v[188:191], a[168:171], v[68:71]
    ds_read_b64_tr_b16 v[246:247], v12 offset:18432
    v_mfma_f32_16x16x32_bf16 v[72:75], v[188:191], a[172:175], v[72:75]
    buffer_load_dwordx4 v[184:187], v8, s[44:47], s99 offen offset:0 sc1
    v_mfma_f32_16x16x32_bf16 v[72:75], v[192:195], a[188:191], v[72:75]
    v_mfma_f32_16x16x32_bf16 v[36:39], v[192:195], a[176:179], v[36:39]
    ds_read_b64_tr_b16 v[248:249], v13 offset:16384
    v_mfma_f32_16x16x32_bf16 v[36:39], v[188:191], a[160:163], v[36:39]
    s_waitcnt vmcnt(17)
    v_mfma_f32_16x16x32_bf16 v[40:43], v[196:199], a[160:163], v[40:43]
    v_mfma_f32_16x16x32_bf16 v[40:43], v[200:203], a[176:179], v[40:43]
    buffer_load_dwordx4 v[188:191], v8, s[44:47], s98 offen offset:512 sc1
    v_mfma_f32_16x16x32_bf16 v[84:87], v[200:203], a[188:191], v[84:87]
    ds_read_b64_tr_b16 v[250:251], v13 offset:18432
    v_mfma_f32_16x16x32_bf16 v[84:87], v[196:199], a[172:175], v[84:87]
    v_mfma_f32_16x16x32_bf16 v[80:83], v[196:199], a[168:171], v[80:83]
    buffer_load_dwordx4 v[192:195], v8, s[44:47], s99 offen offset:512 sc1
    v_mfma_f32_16x16x32_bf16 v[80:83], v[200:203], a[184:187], v[80:83]
    v_mfma_f32_16x16x32_bf16 v[76:79], v[200:203], a[180:183], v[76:79]
    v_mfma_f32_16x16x32_bf16 v[76:79], v[196:199], a[164:167], v[76:79]
    s_waitcnt vmcnt(17)
    v_mfma_f32_16x16x32_bf16 v[88:91], v[204:207], a[164:167], v[88:91]
    v_mfma_f32_16x16x32_bf16 v[88:91], v[208:211], a[180:183], v[88:91]
    buffer_load_dwordx4 v[196:199], v8, s[44:47], s98 offen offset:768 sc1
    v_mfma_f32_16x16x32_bf16 v[92:95], v[208:211], a[184:187], v[92:95]
    v_mfma_f32_16x16x32_bf16 v[92:95], v[204:207], a[168:171], v[92:95]
    v_mfma_f32_16x16x32_bf16 v[96:99], v[204:207], a[172:175], v[96:99]
    buffer_load_dwordx4 v[200:203], v8, s[44:47], s99 offen offset:768 sc1
    v_mfma_f32_16x16x32_bf16 v[96:99], v[208:211], a[188:191], v[96:99]
    v_mfma_f32_16x16x32_bf16 v[44:47], v[208:211], a[176:179], v[44:47]
    v_mfma_f32_16x16x32_bf16 v[44:47], v[204:207], a[160:163], v[44:47]
    s_waitcnt vmcnt(17)
    v_mfma_f32_16x16x32_bf16 v[48:51], v[212:215], a[160:163], v[48:51]
    v_mfma_f32_16x16x32_bf16 v[48:51], v[216:219], a[176:179], v[48:51]
    buffer_load_dwordx4 v[204:207], v8, s[44:47], s98 offen offset:1024 sc1
    v_mfma_f32_16x16x32_bf16 v[108:111], v[216:219], a[188:191], v[108:111]
    v_mfma_f32_16x16x32_bf16 v[108:111], v[212:215], a[172:175], v[108:111]
    v_mfma_f32_16x16x32_bf16 v[104:107], v[212:215], a[168:171], v[104:107]
    buffer_load_dwordx4 v[208:211], v8, s[44:47], s99 offen offset:1024 sc1
    v_mfma_f32_16x16x32_bf16 v[104:107], v[216:219], a[184:187], v[104:107]
    v_mfma_f32_16x16x32_bf16 v[100:103], v[216:219], a[180:183], v[100:103]
    v_mfma_f32_16x16x32_bf16 v[100:103], v[212:215], a[164:167], v[100:103]
L_Dc:
L_pl_D_0:
    s_cbranch_execz L_wret
    s_waitcnt vmcnt(17) lgkmcnt(0)
    v_mfma_f32_16x16x32_bf16 v[52:55], v[140:143], a[196:199], v[52:55]
    s_lshr_b32 s7, s72, 1
    s_lshl_b32 s7, s7, 5
    v_mfma_f32_16x16x32_bf16 v[52:55], v[144:147], a[212:215], v[52:55]
    buffer_load_dwordx4 v[212:215], v9, s[44:47], s98 offen offset:1536 sc1
    v_mfma_f32_16x16x32_bf16 v[56:59], v[144:147], a[216:219], v[56:59]
    v_mfma_f32_16x16x32_bf16 v[56:59], v[140:143], a[200:203], v[56:59]
    s_add_u32 s7, s7, s71
    s_lshl_b32 s7, s7, 1
    v_mfma_f32_16x16x32_bf16 v[60:63], v[140:143], a[204:207], v[60:63]
    buffer_load_dwordx4 v[216:219], v9, s[44:47], s99 offen offset:1536 sc1
    v_mfma_f32_16x16x32_bf16 v[60:63], v[144:147], a[220:223], v[60:63]
    s_add_u32 s15, s7, s12
    s_xor_b32 s6, s15, 1
    v_mfma_f32_16x16x32_bf16 v[32:35], v[144:147], a[208:211], v[32:35]
    v_mfma_f32_16x16x32_bf16 v[32:35], v[140:143], a[192:195], v[32:35]
    s_waitcnt vmcnt(17)
    v_mfma_f32_16x16x32_bf16 v[36:39], v[148:151], a[192:195], v[36:39]
    s_lshl_b32 s7, s6, 2
    s_add_u32 s7, s7, s3
    v_mfma_f32_16x16x32_bf16 v[36:39], v[152:155], a[208:211], v[36:39]
    buffer_load_dwordx4 v[140:143], v8, s[44:47], s100 offen offset:0 sc1
    v_mfma_f32_16x16x32_bf16 v[72:75], v[152:155], a[220:223], v[72:75]
    s_mul_i32 s9, s7, 5120
    s_add_u32 s9, s9, 22822912
    v_mfma_f32_16x16x32_bf16 v[72:75], v[148:151], a[204:207], v[72:75]
    s_lshl_b32 s7, s15, 2
    s_add_u32 s7, s7, s3
    v_mfma_f32_16x16x32_bf16 v[68:71], v[148:151], a[200:203], v[68:71]
    buffer_load_dwordx4 v[144:147], v8, s[44:47], s101 offen offset:0 sc1
    v_mfma_f32_16x16x32_bf16 v[68:71], v[152:155], a[216:219], v[68:71]
    v_mfma_f32_16x16x32_bf16 v[64:67], v[152:155], a[212:215], v[64:67]
    s_mul_i32 s10, s7, 5120
    s_add_u32 s10, s10, 22822912
    v_mfma_f32_16x16x32_bf16 v[64:67], v[148:151], a[196:199], v[64:67]
    s_waitcnt vmcnt(17)
    v_mfma_f32_16x16x32_bf16 v[76:79], v[156:159], a[196:199], v[76:79]
    v_lshlrev_b32 v10, 4, v2
    v_mfma_f32_16x16x32_bf16 v[76:79], v[160:163], a[212:215], v[76:79]
    buffer_load_dwordx4 v[148:151], v8, s[44:47], s100 offen offset:512 sc1
    v_mfma_f32_16x16x32_bf16 v[80:83], v[160:163], a[216:219], v[80:83]
    v_lshlrev_b32 v11, 3, v2
    v_mfma_f32_16x16x32_bf16 v[80:83], v[156:159], a[200:203], v[80:83]
    v_mfma_f32_16x16x32_bf16 v[84:87], v[156:159], a[204:207], v[84:87]
    buffer_load_dwordx4 v[152:155], v8, s[44:47], s101 offen offset:512 sc1
    v_mfma_f32_16x16x32_bf16 v[84:87], v[160:163], a[220:223], v[84:87]
    s_waitcnt vmcnt(16)
    v_cmp_ne_u32 vcc, s68, v29
    s_cbranch_vccnz L_rs_p3
L_ok_p3:
    v_mfma_f32_16x16x32_bf16 v[40:43], v[160:163], a[208:211], v[40:43]
    s_mul_i32 s7, s72, 294912
    s_add_u32 s7, s7, 4718592
    v_mfma_f32_16x16x32_bf16 v[40:43], v[156:159], a[192:195], v[40:43]
    v_mfma_f32_16x16x32_bf16 v[44:47], v[164:167], a[192:195], v[44:47]
    s_add_u32 s4, s3, s12
    s_lshl_b32 s4, s4, 15
    v_mfma_f32_16x16x32_bf16 v[44:47], v[168:171], a[208:211], v[44:47]
    buffer_load_dwordx4 v[156:159], v8, s[44:47], s100 offen offset:768 sc1
    v_mfma_f32_16x16x32_bf16 v[96:99], v[168:171], a[220:223], v[96:99]
    s_add_u32 m0, s73, 147456
    s_add_u32 s4, s4, s7
    v_mfma_f32_16x16x32_bf16 v[96:99], v[164:167], a[204:207], v[96:99]
    buffer_load_dwordx4 v3, s[44:47], s4 offen sc1 lds
    v_mfma_f32_16x16x32_bf16 v[92:95], v[164:167], a[200:203], v[92:95]
    buffer_load_dwordx4 v[160:163], v8, s[44:47], s101 offen offset:768 sc1
    v_mfma_f32_16x16x32_bf16 v[92:95], v[168:171], a[216:219], v[92:95]
    v_mfma_f32_16x16x32_bf16 v[88:91], v[168:171], a[212:215], v[88:91]
    s_add_u32 m0, s73, 148480
    s_add_u32 s4, s4, 131072
    v_mfma_f32_16x16x32_bf16 v[88:91], v[164:167], a[196:199], v[88:91]
    s_waitcnt vmcnt(17)
    v_mfma_f32_16x16x32_bf16 v[100:103], v[172:175], a[196:199], v[100:103]
    buffer_load_dwordx4 v3, s[44:47], s4 offen sc1 lds
    v_mfma_f32_16x16x32_bf16 v[100:103], v[176:179], a[212:215], v[100:103]
    buffer_load_dwordx4 v[164:167], v8, s[44:47], s100 offen offset:1024 sc1
    v_mfma_f32_16x16x32_bf16 v[104:107], v[176:179], a[216:219], v[104:107]
    s_xor_b32 s4, s12, 1
    s_lshl_b32 s4, s4, 18
    v_mfma_f32_16x16x32_bf16 v[104:107], v[172:175], a[200:203], v[104:107]
    s_add_u32 s4, s4, s7
    s_add_u32 m0, s73, 149504
    v_mfma_f32_16x16x32_bf16 v[108:111], v[172:175], a[204:207], v[108:111]
    buffer_load_dwordx4 v[168:171], v8, s[44:47], s101 offen offset:1024 sc1
    v_mfma_f32_16x16x32_bf16 v[108:111], v[176:179], a[220:223], v[108:111]
    s_cmp_lt_u32 s3, 2
    s_cselect_b32 s4, s4, 0x40000000
    v_mfma_f32_16x16x32_bf16 v[48:51], v[176:179], a[208:211], v[48:51]
    buffer_load_dwordx4 v3, s[44:47], s4 offen sc1 lds
    v_mfma_f32_16x16x32_bf16 v[48:51], v[172:175], a[192:195], v[48:51]
    s_waitcnt vmcnt(19)
    v_mfma_f32_16x16x32_bf16 v[32:35], v[180:183], a[224:227], v[32:35]
    s_barrier
    v_mfma_f32_16x16x32_bf16 v[32:35], v[184:187], a[240:243], v[32:35]
    buffer_load_dwordx4 v[172:175], v9, s[44:47], s100 offen offset:1536 sc1
    v_mfma_f32_16x16x32_bf16 v[60:63], v[184:187], a[252:255], v[60:63]
    v_mfma_f32_16x16x32_bf16 v[60:63], v[180:183], a[236:239], v[60:63]
    s_lshl_b32 s7, s6, 9
    s_lshl_b32 s4, s3, 7
    v_mfma_f32_16x16x32_bf16 v[56:59], v[180:183], a[232:235], v[56:59]
    buffer_load_dwordx4 v[176:179], v9, s[44:47], s101 offen offset:1536 sc1
    v_mfma_f32_16x16x32_bf16 v[56:59], v[184:187], a[248:251], v[56:59]
    v_mfma_f32_16x16x32_bf16 v[52:55], v[184:187], a[244:247], v[52:55]
    s_add_u32 s7, s7, s4
    s_add_u32 s14, s7, 12599296
    v_mfma_f32_16x16x32_bf16 v[52:55], v[180:183], a[228:231], v[52:55]
    s_waitcnt vmcnt(19)
    v_mfma_f32_16x16x32_bf16 v[64:67], v[188:191], a[228:231], v[64:67]
    v_mfma_f32_16x16x32_bf16 v[64:67], v[192:195], a[244:247], v[64:67]
    v_add_u32 v8, s11, v8
    buffer_load_dwordx4 v[180:183], v8, s[44:47], s100 offen offset:0 sc1
    v_mfma_f32_16x16x32_bf16 v[68:71], v[192:195], a[248:251], v[68:71]
    v_cmp_eq_u32 vcc, 0, v2
    v_mfma_f32_16x16x32_bf16 v[68:71], v[188:191], a[232:235], v[68:71]
    v_mfma_f32_16x16x32_bf16 v[72:75], v[188:191], a[236:239], v[72:75]
    buffer_load_dwordx4 v[184:187], v8, s[44:47], s101 offen offset:0 sc1
    v_mfma_f32_16x16x32_bf16 v[72:75], v[192:195], a[252:255], v[72:75]
    v_mov_b32 v12, 0x40000000
    v_mfma_f32_16x16x32_bf16 v[36:39], v[192:195], a[240:243], v[36:39]
    v_mfma_f32_16x16x32_bf16 v[36:39], v[188:191], a[224:227], v[36:39]
    s_waitcnt vmcnt(19)
    v_mfma_f32_16x16x32_bf16 v[40:43], v[196:199], a[224:227], v[40:43]
    v_cndmask_b32 v12, v12, 0, vcc
    v_mfma_f32_16x16x32_bf16 v[40:43], v[200:203], a[240:243], v[40:43]
    buffer_load_dwordx4 v[188:191], v8, s[44:47], s100 offen offset:512 sc1
    v_mfma_f32_16x16x32_bf16 v[84:87], v[200:203], a[252:255], v[84:87]
    v_mov_b32 v13, s68
    v_mfma_f32_16x16x32_bf16 v[84:87], v[196:199], a[236:239], v[84:87]
    v_mfma_f32_16x16x32_bf16 v[80:83], v[196:199], a[232:235], v[80:83]
    buffer_load_dwordx4 v[192:195], v8, s[44:47], s101 offen offset:512 sc1
    v_mfma_f32_16x16x32_bf16 v[80:83], v[200:203], a[248:251], v[80:83]
    v_mfma_f32_16x16x32_bf16 v[76:79], v[200:203], a[244:247], v[76:79]
    v_mfma_f32_16x16x32_bf16 v[76:79], v[196:199], a[228:231], v[76:79]
    s_waitcnt vmcnt(19)
    v_mfma_f32_16x16x32_bf16 v[88:91], v[204:207], a[228:231], v[88:91]
    v_mfma_f32_16x16x32_bf16 v[88:91], v[208:211], a[244:247], v[88:91]
    buffer_load_dwordx4 v[196:199], v8, s[44:47], s100 offen offset:768 sc1
    v_mfma_f32_16x16x32_bf16 v[92:95], v[208:211], a[248:251], v[92:95]
    v_mfma_f32_16x16x32_bf16 v[92:95], v[204:207], a[232:235], v[92:95]
    v_mfma_f32_16x16x32_bf16 v[96:99], v[204:207], a[236:239], v[96:99]
    buffer_load_dwordx4 v[200:203], v8, s[44:47], s101 offen offset:768 sc1
    v_mfma_f32_16x16x32_bf16 v[96:99], v[208:211], a[252:255], v[96:99]
    v_mfma_f32_16x16x32_bf16 v[44:47], v[208:211], a[240:243], v[44:47]
    v_mfma_f32_16x16x32_bf16 v[44:47], v[204:207], a[224:227], v[44:47]
    s_waitcnt vmcnt(19)
    v_mfma_f32_16x16x32_bf16 v[48:51], v[212:215], a[224:227], v[48:51]
    v_mfma_f32_16x16x32_bf16 v[48:51], v[216:219], a[240:243], v[48:51]
    buffer_load_dwordx4 v[204:207], v8, s[44:47], s100 offen offset:1024 sc1
    v_mfma_f32_16x16x32_bf16 v[108:111], v[216:219], a[252:255], v[108:111]
    v_mfma_f32_16x16x32_bf16 v[108:111], v[212:215], a[236:239], v[108:111]
    v_mfma_f32_16x16x32_bf16 v[104:107], v[212:215], a[232:235], v[104:107]
    buffer_load_dwordx4 v[208:211], v8, s[44:47], s101 offen offset:1024 sc1
    v_mfma_f32_16x16x32_bf16 v[104:107], v[216:219], a[248:251], v[104:107]
    v_mfma_f32_16x16x32_bf16 v[100:103], v[216:219], a[244:247], v[100:103]
    v_mfma_f32_16x16x32_bf16 v[100:103], v[212:215], a[228:231], v[100:103]
    s_waitcnt vmcnt(19)
    v_mfma_f32_16x16x32_bf16 v[52:55], v[140:143], v[224:227], v[52:55]
    v_mfma_f32_16x16x32_bf16 v[52:55], v[144:147], v[240:243], v[52:55]
    buffer_load_dwordx4 v[212:215], v8, s[44:47], s84 offen offset:0 sc1
    v_mfma_f32_16x16x32_bf16 v[56:59], v[144:147], v[244:247], v[56:59]
    v_mfma_f32_16x16x32_bf16 v[56:59], v[140:143], v[228:231], v[56:59]
    v_mfma_f32_16x16x32_bf16 v[60:63], v[140:143], v[232:235], v[60:63]
    buffer_load_dwordx4 v[216:219], v8, s[44:47], s85 offen offset:0 sc1
    v_mfma_f32_16x16x32_bf16 v[60:63], v[144:147], v[248:251], v[60:63]
    v_mfma_f32_16x16x32_bf16 v[32:35], v[144:147], v[236:239], v[32:35]
    v_mfma_f32_16x16x32_bf16 v[32:35], v[140:143], v[220:223], v[32:35]
    s_waitcnt vmcnt(19)
    v_mfma_f32_16x16x32_bf16 v[36:39], v[148:151], v[220:223], v[36:39]
    v_mfma_f32_16x16x32_bf16 v[36:39], v[152:155], v[236:239], v[36:39]
    buffer_load_dwordx4 v[140:143], v8, s[44:47], s84 offen offset:512 sc1
    v_mfma_f32_16x16x32_bf16 v[72:75], v[152:155], v[248:251], v[72:75]
    ds_write_b128 v4, v[52:55] offset:0
    v_mfma_f32_16x16x32_bf16 v[72:75], v[148:151], v[232:235], v[72:75]
    v_mfma_f32_16x16x32_bf16 v[68:71], v[148:151], v[228:231], v[68:71]
    ds_write_b128 v5, v[56:59] offset:0
    buffer_load_dwordx4 v[144:147], v8, s[44:47], s85 offen offset:512 sc1
    v_mfma_f32_16x16x32_bf16 v[68:71], v[152:155], v[244:247], v[68:71]
    v_mfma_f32_16x16x32_bf16 v[64:67], v[152:155], v[240:243], v[64:67]
    ds_write_b128 v6, v[60:63] offset:0
    v_mfma_f32_16x16x32_bf16 v[64:67], v[148:151], v[224:227], v[64:67]
    s_waitcnt vmcnt(18)
    v_mfma_f32_16x16x32_bf16 v[76:79], v[156:159], v[224:227], v[76:79]
    v_mfma_f32_16x16x32_bf16 v[76:79], v[160:163], v[240:243], v[76:79]
    buffer_load_dwordx4 v[148:151], v8, s[44:47], s84 offen offset:768 sc1
    v_mfma_f32_16x16x32_bf16 v[80:83], v[160:163], v[244:247], v[80:83]
    ds_write_b128 v6, v[72:75] offset:1024
    v_mfma_f32_16x16x32_bf16 v[80:83], v[156:159], v[228:231], v[80:83]
    v_mfma_f32_16x16x32_bf16 v[84:87], v[156:159], v[232:235], v[84:87]
    ds_write_b128 v5, v[68:71] offset:1024
    buffer_load_dwordx4 v[152:155], v8, s[44:47], s85 offen offset:768 sc1
    v_mfma_f32_16x16x32_bf16 v[84:87], v[160:163], v[248:251], v[84:87]
    v_mfma_f32_16x16x32_bf16 v[40:43], v[160:163], v[236:239], v[40:43]
    ds_write_b128 v4, v[64:67] offset:1024
    v_mfma_f32_16x16x32_bf16 v[40:43], v[156:159], v[220:223], v[40:43]
    s_waitcnt vmcnt(17)
    v_mfma_f32_16x16x32_bf16 v[44:47], v[164:167], v[220:223], v[44:47]
    v_mfma_f32_16x16x32_bf16 v[44:47], v[168:171], v[236:239], v[44:47]
    buffer_load_dwordx4 v[156:159], v8, s[44:47], s84 offen offset:1024 sc1
    v_mfma_f32_16x16x32_bf16 v[96:99], v[168:171], v[248:251], v[96:99]
    ds_write_b128 v4, v[76:79] offset:2048
    v_mfma_f32_16x16x32_bf16 v[96:99], v[164:167], v[232:235], v[96:99]
    v_mfma_f32_16x16x32_bf16 v[92:95], v[164:167], v[228:231], v[92:95]
    ds_write_b128 v5, v[80:83] offset:2048
    buffer_load_dwordx4 v[160:163], v8, s[44:47], s85 offen offset:1024 sc1
    v_mfma_f32_16x16x32_bf16 v[92:95], v[168:171], v[244:247], v[92:95]
    v_mfma_f32_16x16x32_bf16 v[88:91], v[168:171], v[240:243], v[88:91]
    ds_write_b128 v6, v[84:87] offset:2048
    v_mfma_f32_16x16x32_bf16 v[88:91], v[164:167], v[224:227], v[88:91]
    s_waitcnt vmcnt(16)
    v_mfma_f32_16x16x32_bf16 v[100:103], v[172:175], v[224:227], v[100:103]
    v_mfma_f32_16x16x32_bf16 v[100:103], v[176:179], v[240:243], v[100:103]
    buffer_load_dwordx4 v[164:167], v8, s[44:47], s86 offen offset:0 sc1
    v_mfma_f32_16x16x32_bf16 v[104:107], v[176:179], v[244:247], v[104:107]
    ds_write_b128 v6, v[96:99] offset:3072
    v_mfma_f32_16x16x32_bf16 v[104:107], v[172:175], v[228:231], v[104:107]
    v_mfma_f32_16x16x32_bf16 v[108:111], v[172:175], v[232:235], v[108:111]
    ds_write_b128 v5, v[92:95] offset:3072
    buffer_load_dwordx4 v[168:171], v8, s[44:47], s87 offen offset:0 sc1
    v_mfma_f32_16x16x32_bf16 v[108:111], v[176:179], v[248:251], v[108:111]
    v_mfma_f32_16x16x32_bf16 v[48:51], v[176:179], v[236:239], v[48:51]
    ds_write_b128 v4, v[88:91] offset:3072
    v_mfma_f32_16x16x32_bf16 v[48:51], v[172:175], v[220:223], v[48:51]
    ds_write_b128 v4, v[100:103] offset:4096
    s_waitcnt vmcnt(16) lgkmcnt(7)
    v_mfma_f32_16x16x32_bf16 v[64:67], v[180:183], v[220:223], v[112:115]
    v_mfma_f32_16x16x32_bf16 v[64:67], v[184:187], v[236:239], v[64:67]
    ds_write_b128 v5, v[104:107] offset:4096
    buffer_load_dwordx4 v[172:175], v8, s[44:47], s86 offen offset:512 sc1
    v_mfma_f32_16x16x32_bf16 v[60:63], v[184:187], v[248:251], 0
    v_mfma_f32_16x16x32_bf16 v[60:63], v[180:183], v[232:235], v[60:63]
    ds_write_b128 v6, v[108:111] offset:4096
    v_mfma_f32_16x16x32_bf16 v[56:59], v[180:183], v[228:231], 0
    buffer_load_dwordx4 v[176:179], v8, s[44:47], s87 offen offset:512 sc1
    v_mfma_f32_16x16x32_bf16 v[56:59], v[184:187], v[244:247], v[56:59]
    v_mfma_f32_16x16x32_bf16 v[52:55], v[184:187], v[240:243], 0
    v_mfma_f32_16x16x32_bf16 v[52:55], v[180:183], v[224:227], v[52:55]
    s_waitcnt vmcnt(16) lgkmcnt(6)
    v_mfma_f32_16x16x32_bf16 v[68:71], v[188:191], v[224:227], 0
    v_mfma_f32_16x16x32_bf16 v[68:71], v[192:195], v[240:243], v[68:71]
    buffer_load_dwordx4 v[180:183], v8, s[44:47], s86 offen offset:768 sc1
    v_mfma_f32_16x16x32_bf16 v[72:75], v[192:195], v[244:247], 0
    v_mfma_f32_16x16x32_bf16 v[72:75], v[188:191], v[228:231], v[72:75]
    v_mfma_f32_16x16x32_bf16 v[76:79], v[188:191], v[232:235], 0
    buffer_load_dwordx4 v[184:187], v8, s[44:47], s87 offen offset:768 sc1
    v_mfma_f32_16x16x32_bf16 v[76:79], v[192:195], v[248:251], v[76:79]
    v_mfma_f32_16x16x32_bf16 v[80:83], v[192:195], v[236:239], v[112:115]
    v_mfma_f32_16x16x32_bf16 v[80:83], v[188:191], v[220:223], v[80:83]
    s_waitcnt vmcnt(16) lgkmcnt(3)
    v_mfma_f32_16x16x32_bf16 v[96:99], v[196:199], v[220:223], v[112:115]
    v_mfma_f32_16x16x32_bf16 v[96:99], v[200:203], v[236:239], v[96:99]
    buffer_load_dwordx4 v[188:191], v8, s[44:47], s86 offen offset:1024 sc1
    v_mfma_f32_16x16x32_bf16 v[92:95], v[200:203], v[248:251], 0
    v_mfma_f32_16x16x32_bf16 v[92:95], v[196:199], v[232:235], v[92:95]
    v_mfma_f32_16x16x32_bf16 v[88:91], v[196:199], v[228:231], 0
    buffer_load_dwordx4 v[192:195], v8, s[44:47], s87 offen offset:1024 sc1
    v_mfma_f32_16x16x32_bf16 v[88:91], v[200:203], v[244:247], v[88:91]
    v_mfma_f32_16x16x32_bf16 v[84:87], v[200:203], v[240:243], 0
    v_mfma_f32_16x16x32_bf16 v[84:87], v[196:199], v[224:227], v[84:87]
    s_waitcnt vmcnt(16) lgkmcnt(0)
    v_mfma_f32_16x16x32_bf16 v[100:103], v[204:207], v[224:227], 0
    v_mfma_f32_16x16x32_bf16 v[100:103], v[208:211], v[240:243], v[100:103]
    buffer_load_dwordx4 v[196:199], v8, s[44:47], s88 offen offset:0 sc1
    v_mfma_f32_16x16x32_bf16 v[104:107], v[208:211], v[244:247], 0
    v_mfma_f32_16x16x32_bf16 v[104:107], v[204:207], v[228:231], v[104:107]
    v_mfma_f32_16x16x32_bf16 v[108:111], v[204:207], v[232:235], 0
    buffer_load_dwordx4 v[200:203], v8, s[44:47], s89 offen offset:0 sc1
    v_mfma_f32_16x16x32_bf16 v[108:111], v[208:211], v[248:251], v[108:111]
    v_mfma_f32_16x16x32_bf16 v[112:115], v[208:211], v[236:239], v[112:115]
    v_mfma_f32_16x16x32_bf16 v[112:115], v[204:207], v[220:223], v[112:115]
    s_waitcnt vmcnt(16)
    v_mfma_f32_16x16x32_bf16 v[64:67], v[212:215], a[0:3], v[64:67]
    s_barrier
    v_mfma_f32_16x16x32_bf16 v[64:67], v[216:219], a[16:19], v[64:67]
    buffer_load_dwordx4 v[204:207], v8, s[44:47], s88 offen offset:512 sc1
    ds_read_b128 v[116:119], v7 offset:0
    v_mfma_f32_16x16x32_bf16 v[60:63], v[216:219], a[28:31], v[60:63]
    ds_read_b128 v[120:123], v7 offset:5120
    ds_read_b128 v[124:127], v7 offset:10240
    v_mfma_f32_16x16x32_bf16 v[60:63], v[212:215], a[12:15], v[60:63]
    ds_read_b128 v[128:131], v7 offset:1024
    ds_read_b128 v[132:135], v7 offset:6144
    v_mfma_f32_16x16x32_bf16 v[56:59], v[212:215], a[8:11], v[56:59]
    buffer_load_dwordx4 v[208:211], v8, s[44:47], s89 offen offset:512 sc1
    ds_read_b128 v[136:139], v7 offset:11264
    v_mfma_f32_16x16x32_bf16 v[56:59], v[216:219], a[24:27], v[56:59]
    s_waitcnt lgkmcnt(3)
    v_add_f32 v32, v32, v116
    v_add_f32 v33, v33, v117
    v_mfma_f32_16x16x32_bf16 v[52:55], v[216:219], a[20:23], v[52:55]
    v_add_f32 v34, v34, v118
    v_add_f32 v35, v35, v119
    v_add_f32 v120, v120, v124
    v_mfma_f32_16x16x32_bf16 v[52:55], v[212:215], a[4:7], v[52:55]
    v_add_f32 v121, v121, v125
    v_add_f32 v122, v122, v126
    s_waitcnt vmcnt(16)
    v_mfma_f32_16x16x32_bf16 v[68:71], v[140:143], a[4:7], v[68:71]
    v_add_f32 v123, v123, v127
    v_add_f32 v32, v32, v120
    v_add_f32 v33, v33, v121
    v_mfma_f32_16x16x32_bf16 v[68:71], v[144:147], a[20:23], v[68:71]
    buffer_load_dwordx4 v[212:215], v8, s[44:47], s88 offen offset:768 sc1
    v_add_f32 v34, v34, v122
    v_mfma_f32_16x16x32_bf16 v[72:75], v[144:147], a[24:27], v[72:75]
    v_add_f32 v35, v35, v123
    v_cvt_pk_bf16_f32 v32, v32, v33
    v_cvt_pk_bf16_f32 v33, v34, v35
    v_mfma_f32_16x16x32_bf16 v[72:75], v[140:143], a[8:11], v[72:75]
    ds_read_b128 v[116:119], v7 offset:2048
    ds_read_b128 v[120:123], v7 offset:7168
    v_mfma_f32_16x16x32_bf16 v[76:79], v[140:143], a[12:15], v[76:79]
    buffer_load_dwordx4 v[216:219], v8, s[44:47], s89 offen offset:768 sc1
    ds_read_b128 v[124:127], v7 offset:12288
    v_mfma_f32_16x16x32_bf16 v[76:79], v[144:147], a[28:31], v[76:79]
    s_waitcnt lgkmcnt(3)
    v_add_f32 v36, v36, v128
    v_add_f32 v37, v37, v129
    v_mfma_f32_16x16x32_bf16 v[80:83], v[144:147], a[16:19], v[80:83]
    v_add_f32 v38, v38, v130
    v_add_f32 v39, v39, v131
    v_mfma_f32_16x16x32_bf16 v[80:83], v[140:143], a[0:3], v[80:83]
    v_add_f32 v132, v132, v136
    v_add_f32 v133, v133, v137
    s_waitcnt vmcnt(16)
    v_mfma_f32_16x16x32_bf16 v[96:99], v[148:151], a[0:3], v[96:99]
    v_add_f32 v134, v134, v138
    v_add_f32 v135, v135, v139
    v_add_f32 v36, v36, v132
    v_mfma_f32_16x16x32_bf16 v[96:99], v[152:155], a[16:19], v[96:99]
    buffer_load_dwordx4 v[140:143], v8, s[44:47], s88 offen offset:1024 sc1
    v_add_f32 v37, v37, v133
    v_mfma_f32_16x16x32_bf16 v[92:95], v[152:155], a[28:31], v[92:95]
    v_add_f32 v38, v38, v134
    v_add_f32 v39, v39, v135
    v_cvt_pk_bf16_f32 v34, v36, v37
    v_mfma_f32_16x16x32_bf16 v[92:95], v[148:151], a[12:15], v[92:95]
    v_cvt_pk_bf16_f32 v35, v38, v39
    buffer_store_dwordx4 v[32:35], v10, s[44:47], s9 offen offset:0 sc1
    v_mfma_f32_16x16x32_bf16 v[88:91], v[148:151], a[8:11], v[88:91]
    buffer_load_dwordx4 v[144:147], v8, s[44:47], s89 offen offset:1024 sc1
    ds_read_b128 v[128:131], v7 offset:3072
    v_mfma_f32_16x16x32_bf16 v[88:91], v[152:155], a[24:27], v[88:91]
    ds_read_b128 v[132:135], v7 offset:8192
    ds_read_b128 v[136:139], v7 offset:13312
    v_mfma_f32_16x16x32_bf16 v[84:87], v[152:155], a[20:23], v[84:87]
    s_waitcnt lgkmcnt(3)
    v_add_f32 v40, v40, v116
    v_mfma_f32_16x16x32_bf16 v[84:87], v[148:151], a[4:7], v[84:87]
    v_add_f32 v41, v41, v117
    s_waitcnt vmcnt(17)
    v_mfma_f32_16x16x32_bf16 v[100:103], v[156:159], a[4:7], v[100:103]
    v_add_f32 v42, v42, v118
    v_add_f32 v43, v43, v119
    v_add_f32 v120, v120, v124
    v_mfma_f32_16x16x32_bf16 v[100:103], v[160:163], a[20:23], v[100:103]
    buffer_load_dwordx4 v[148:151], v8, s[44:47], s90 offen offset:0 sc1
    v_add_f32 v121, v121, v125
    v_mfma_f32_16x16x32_bf16 v[104:107], v[160:163], a[24:27], v[104:107]
    v_add_f32 v122, v122, v126
    v_add_f32 v123, v123, v127
    v_add_f32 v40, v40, v120
    v_mfma_f32_16x16x32_bf16 v[104:107], v[156:159], a[8:11], v[104:107]
    v_add_f32 v41, v41, v121
    v_add_f32 v42, v42, v122
    v_add_f32 v43, v43, v123
    v_mfma_f32_16x16x32_bf16 v[108:111], v[156:159], a[12:15], v[108:111]
    buffer_load_dwordx4 v[152:155], v8, s[44:47], s91 offen offset:0 sc1
    v_cvt_pk_bf16_f32 v36, v40, v41
    v_mfma_f32_16x16x32_bf16 v[108:111], v[160:163], a[28:31], v[108:111]
    v_cvt_pk_bf16_f32 v37, v42, v43
    ds_read_b128 v[116:119], v7 offset:4096
    v_mfma_f32_16x16x32_bf16 v[112:115], v[160:163], a[16:19], v[112:115]
    ds_read_b128 v[120:123], v7 offset:9216
    ds_read_b128 v[124:127], v7 offset:14336
    v_mfma_f32_16x16x32_bf16 v[112:115], v[156:159], a[0:3], v[112:115]
    s_waitcnt lgkmcnt(3)
    s_waitcnt vmcnt(17)
    v_mfma_f32_16x16x32_bf16 v[64:67], v[164:167], a[32:35], v[64:67]
    v_add_f32 v44, v44, v128
    v_add_f32 v45, v45, v129
    v_mfma_f32_16x16x32_bf16 v[64:67], v[168:171], a[48:51], v[64:67]
    buffer_load_dwordx4 v[156:159], v8, s[44:47], s90 offen offset:512 sc1
    v_add_f32 v46, v46, v130
    v_mfma_f32_16x16x32_bf16 v[60:63], v[168:171], a[60:63], v[60:63]
    v_add_f32 v47, v47, v131
    v_add_f32 v132, v132, v136
    v_add_f32 v133, v133, v137
    v_mfma_f32_16x16x32_bf16 v[60:63], v[164:167], a[44:47], v[60:63]
    v_add_f32 v134, v134, v138
    v_add_f32 v135, v135, v139
    v_mfma_f32_16x16x32_bf16 v[56:59], v[164:167], a[40:43], v[56:59]
    buffer_load_dwordx4 v[160:163], v8, s[44:47], s91 offen offset:512 sc1
    v_add_f32 v44, v44, v132
    v_mfma_f32_16x16x32_bf16 v[56:59], v[168:171], a[56:59], v[56:59]
    v_add_f32 v45, v45, v133
    v_add_f32 v46, v46, v134
    v_add_f32 v47, v47, v135
    v_mfma_f32_16x16x32_bf16 v[52:55], v[168:171], a[52:55], v[52:55]
    v_cvt_pk_bf16_f32 v38, v44, v45
    v_cvt_pk_bf16_f32 v39, v46, v47
    v_mfma_f32_16x16x32_bf16 v[52:55], v[164:167], a[36:39], v[52:55]
    buffer_store_dwordx4 v[36:39], v10, s[44:47], s9 offen offset:1024 sc1
    s_waitcnt vmcnt(18)
    v_mfma_f32_16x16x32_bf16 v[68:71], v[172:175], a[36:39], v[68:71]
    s_waitcnt lgkmcnt(0)
    v_add_f32 v48, v48, v116
    v_add_f32 v49, v49, v117
    v_mfma_f32_16x16x32_bf16 v[68:71], v[176:179], a[52:55], v[68:71]
    buffer_load_dwordx4 v[164:167], v8, s[44:47], s90 offen offset:768 sc1
    v_add_f32 v50, v50, v118
    v_mfma_f32_16x16x32_bf16 v[72:75], v[176:179], a[56:59], v[72:75]
    v_add_f32 v51, v51, v119
    v_add_f32 v120, v120, v124
    v_mfma_f32_16x16x32_bf16 v[72:75], v[172:175], a[40:43], v[72:75]
    v_add_f32 v121, v121, v125
    v_add_f32 v122, v122, v126
    v_add_f32 v123, v123, v127
    v_mfma_f32_16x16x32_bf16 v[76:79], v[172:175], a[44:47], v[76:79]
    buffer_load_dwordx4 v[168:171], v8, s[44:47], s91 offen offset:768 sc1
    v_add_f32 v48, v48, v120
    v_mfma_f32_16x16x32_bf16 v[76:79], v[176:179], a[60:63], v[76:79]
    v_add_f32 v49, v49, v121
    v_add_f32 v50, v50, v122
    v_mfma_f32_16x16x32_bf16 v[80:83], v[176:179], a[48:51], v[80:83]
    v_add_f32 v51, v51, v123
    v_cvt_pk_bf16_f32 v40, v48, v49
    v_cvt_pk_bf16_f32 v41, v50, v51
    v_mfma_f32_16x16x32_bf16 v[80:83], v[172:175], a[32:35], v[80:83]
    buffer_store_dwordx2 v[40:41], v11, s[44:47], s9 offen offset:2048 sc1
    s_waitcnt vmcnt(19)
    v_mfma_f32_16x16x32_bf16 v[96:99], v[180:183], a[32:35], v[96:99]
    v_mfma_f32_16x16x32_bf16 v[96:99], v[184:187], a[48:51], v[96:99]
    buffer_load_dwordx4 v[172:175], v8, s[44:47], s90 offen offset:1024 sc1
    v_mfma_f32_16x16x32_bf16 v[92:95], v[184:187], a[60:63], v[92:95]
    v_and_b32 v221, 0xffff0000, v14
    v_mfma_f32_16x16x32_bf16 v[92:95], v[180:183], a[44:47], v[92:95]
    v_lshlrev_b32 v220, 16, v14
    v_mfma_f32_16x16x32_bf16 v[88:91], v[180:183], a[40:43], v[88:91]
    buffer_load_dwordx4 v[176:179], v8, s[44:47], s91 offen offset:1024 sc1
    v_mfma_f32_16x16x32_bf16 v[88:91], v[184:187], a[56:59], v[88:91]
    v_mfma_f32_16x16x32_bf16 v[84:87], v[184:187], a[52:55], v[84:87]
    v_and_b32 v223, 0xffff0000, v15
    v_mfma_f32_16x16x32_bf16 v[84:87], v[180:183], a[36:39], v[84:87]
    s_waitcnt vmcnt(19)
    v_mfma_f32_16x16x32_bf16 v[100:103], v[188:191], a[36:39], v[100:103]
    v_lshlrev_b32 v222, 16, v15
    v_mfma_f32_16x16x32_bf16 v[100:103], v[192:195], a[52:55], v[100:103]
    buffer_load_dwordx4 v[180:183], v8, s[44:47], s92 offen offset:0 sc1
    v_mfma_f32_16x16x32_bf16 v[104:107], v[192:195], a[56:59], v[104:107]
    v_and_b32 v225, 0xffff0000, v16
    v_mfma_f32_16x16x32_bf16 v[104:107], v[188:191], a[40:43], v[104:107]
    v_lshlrev_b32 v224, 16, v16
    v_mfma_f32_16x16x32_bf16 v[108:111], v[188:191], a[44:47], v[108:111]
    buffer_load_dwordx4 v[184:187], v8, s[44:47], s93 offen offset:0 sc1
    v_mfma_f32_16x16x32_bf16 v[108:111], v[192:195], a[60:63], v[108:111]
    v_and_b32 v227, 0xffff0000, v17
    v_mfma_f32_16x16x32_bf16 v[112:115], v[192:195], a[48:51], v[112:115]
    v_lshlrev_b32 v226, 16, v17
    v_mfma_f32_16x16x32_bf16 v[112:115], v[188:191], a[32:35], v[112:115]
    s_waitcnt vmcnt(19)
    v_mfma_f32_16x16x32_bf16 v[64:67], v[196:199], a[64:67], v[64:67]
    v_and_b32 v229, 0xffff0000, v18
    v_mfma_f32_16x16x32_bf16 v[64:67], v[200:203], a[80:83], v[64:67]
    buffer_load_dwordx4 v[188:191], v8, s[44:47], s92 offen offset:512 sc1
    v_mfma_f32_16x16x32_bf16 v[60:63], v[200:203], a[92:95], v[60:63]
    v_lshlrev_b32 v228, 16, v18
    v_mfma_f32_16x16x32_bf16 v[60:63], v[196:199], a[76:79], v[60:63]
    v_and_b32 v231, 0xffff0000, v19
    v_mfma_f32_16x16x32_bf16 v[56:59], v[196:199], a[72:75], v[56:59]
    buffer_load_dwordx4 v[192:195], v8, s[44:47], s93 offen offset:512 sc1
    v_mfma_f32_16x16x32_bf16 v[56:59], v[200:203], a[88:91], v[56:59]
    v_mfma_f32_16x16x32_bf16 v[52:55], v[200:203], a[84:87], v[52:55]
    v_lshlrev_b32 v230, 16, v19
    v_mfma_f32_16x16x32_bf16 v[52:55], v[196:199], a[68:71], v[52:55]
    s_waitcnt vmcnt(19)
    v_mfma_f32_16x16x32_bf16 v[68:71], v[204:207], a[68:71], v[68:71]
    v_and_b32 v233, 0xffff0000, v20
    v_mfma_f32_16x16x32_bf16 v[68:71], v[208:211], a[84:87], v[68:71]
    buffer_load_dwordx4 v[196:199], v8, s[44:47], s92 offen offset:768 sc1
    v_mfma_f32_16x16x32_bf16 v[72:75], v[208:211], a[88:91], v[72:75]
    v_lshlrev_b32 v232, 16, v20
    v_mfma_f32_16x16x32_bf16 v[72:75], v[204:207], a[72:75], v[72:75]
    v_and_b32 v235, 0xffff0000, v21
    v_mfma_f32_16x16x32_bf16 v[76:79], v[204:207], a[76:79], v[76:79]
    buffer_load_dwordx4 v[200:203], v8, s[44:47], s93 offen offset:768 sc1
    v_mfma_f32_16x16x32_bf16 v[76:79], v[208:211], a[92:95], v[76:79]
    v_lshlrev_b32 v234, 16, v21
    v_mfma_f32_16x16x32_bf16 v[80:83], v[208:211], a[80:83], v[80:83]
    v_and_b32 v237, 0xffff0000, v22
    v_mfma_f32_16x16x32_bf16 v[80:83], v[204:207], a[64:67], v[80:83]
    s_waitcnt vmcnt(19)
    v_mfma_f32_16x16x32_bf16 v[96:99], v[212:215], a[64:67], v[96:99]
    s_waitcnt vmcnt(8)
    buffer_store_dword v13, v12, s[44:47], s14 offen sc1
    v_mfma_f32_16x16x32_bf16 v[96:99], v[216:219], a[80:83], v[96:99]
    buffer_load_dwordx4 v[204:207], v8, s[44:47], s92 offen offset:1024 sc1
    v_mfma_f32_16x16x32_bf16 v[92:95], v[216:219], a[92:95], v[92:95]
    v_lshlrev_b32 v236, 16, v22
    v_mfma_f32_16x16x32_bf16 v[92:95], v[212:215], a[76:79], v[92:95]
    v_and_b32 v239, 0xffff0000, v23
    v_mfma_f32_16x16x32_bf16 v[88:91], v[212:215], a[72:75], v[88:91]
    buffer_load_dwordx4 v[208:211], v8, s[44:47], s93 offen offset:1024 sc1
    v_mfma_f32_16x16x32_bf16 v[88:91], v[216:219], a[88:91], v[88:91]
    v_lshlrev_b32 v238, 16, v23
    v_mfma_f32_16x16x32_bf16 v[84:87], v[216:219], a[84:87], v[84:87]
L_pl_D_1:
    s_cbranch_execz L_wret
    v_mul_f32 v26, v26, v27
    v_mfma_f32_16x16x32_bf16 v[84:87], v[212:215], a[68:71], v[84:87]
    v_mfma_f32_16x16x32_bf16 v[100:103], v[140:143], a[68:71], v[100:103]
    s_barrier
    v_mfma_f32_16x16x32_bf16 v[100:103], v[144:147], a[84:87], v[100:103]
    buffer_load_dwordx4 v[212:215], v8, s[44:47], s94 offen offset:0 sc1
    v_mfma_f32_16x16x32_bf16 v[104:107], v[144:147], a[88:91], v[104:107]
    ds_read_b64_tr_b16 v[14:15], v25 offset:0
    v_mfma_f32_16x16x32_bf16 v[104:107], v[140:143], a[72:75], v[104:107]
    ds_read_b64_tr_b16 v[16:17], v25 offset:8192
    v_mfma_f32_16x16x32_bf16 v[108:111], v[140:143], a[76:79], v[108:111]
    buffer_load_dwordx4 v[216:219], v8, s[44:47], s95 offen offset:0 sc1
    v_mfma_f32_16x16x32_bf16 v[108:111], v[144:147], a[92:95], v[108:111]
    ds_read_b64_tr_b16 v[18:19], v25 offset:1024
    v_mfma_f32_16x16x32_bf16 v[112:115], v[144:147], a[80:83], v[112:115]
    ds_read_b64_tr_b16 v[20:21], v25 offset:9216
    v_mfma_f32_16x16x32_bf16 v[112:115], v[140:143], a[64:67], v[112:115]
    v_mfma_f32_16x16x32_bf16 v[64:67], v[148:151], a[96:99], v[64:67]
    ds_read_b64_tr_b16 v[22:23], v25 offset:2048
    v_mfma_f32_16x16x32_bf16 v[64:67], v[152:155], a[112:115], v[64:67]
    buffer_load_dwordx4 v[140:143], v8, s[44:47], s94 offen offset:512 sc1
    v_mfma_f32_16x16x32_bf16 v[60:63], v[152:155], a[124:127], v[60:63]
    v_fma_f32 v116, v220, v27, -v26
    v_mfma_f32_16x16x32_bf16 v[60:63], v[148:151], a[108:111], v[60:63]
    v_fma_f32 v117, v221, v27, -v26
    v_mfma_f32_16x16x32_bf16 v[56:59], v[148:151], a[104:107], v[56:59]
    buffer_load_dwordx4 v[144:147], v8, s[44:47], s95 offen offset:512 sc1
    v_mfma_f32_16x16x32_bf16 v[56:59], v[152:155], a[120:123], v[56:59]
    v_mfma_f32_16x16x32_bf16 v[52:55], v[152:155], a[116:119], v[52:55]
    v_fma_f32 v118, v222, v27, -v26
    v_mfma_f32_16x16x32_bf16 v[52:55], v[148:151], a[100:103], v[52:55]
    v_mfma_f32_16x16x32_bf16 v[68:71], v[156:159], a[100:103], v[68:71]
    v_fma_f32 v119, v223, v27, -v26
    v_mfma_f32_16x16x32_bf16 v[68:71], v[160:163], a[116:119], v[68:71]
    buffer_load_dwordx4 v[148:151], v8, s[44:47], s94 offen offset:768 sc1
    v_mfma_f32_16x16x32_bf16 v[72:75], v[160:163], a[120:123], v[72:75]
    v_fma_f32 v120, v224, v27, -v26
    v_mfma_f32_16x16x32_bf16 v[72:75], v[156:159], a[104:107], v[72:75]
    v_fma_f32 v121, v225, v27, -v26
    v_mfma_f32_16x16x32_bf16 v[76:79], v[156:159], a[108:111], v[76:79]
    buffer_load_dwordx4 v[152:155], v8, s[44:47], s95 offen offset:768 sc1
    v_mfma_f32_16x16x32_bf16 v[76:79], v[160:163], a[124:127], v[76:79]
    v_fma_f32 v122, v226, v27, -v26
    v_mfma_f32_16x16x32_bf16 v[80:83], v[160:163], a[112:115], v[80:83]
    v_fma_f32 v123, v227, v27, -v26
    v_mfma_f32_16x16x32_bf16 v[80:83], v[156:159], a[96:99], v[80:83]
    v_mfma_f32_16x16x32_bf16 v[96:99], v[164:167], a[96:99], v[96:99]
    v_fma_f32 v124, v228, v27, -v26
    v_mfma_f32_16x16x32_bf16 v[96:99], v[168:171], a[112:115], v[96:99]
    buffer_load_dwordx4 v[156:159], v8, s[44:47], s94 offen offset:1024 sc1
    v_mfma_f32_16x16x32_bf16 v[92:95], v[168:171], a[124:127], v[92:95]
    v_fma_f32 v125, v229, v27, -v26
    v_mfma_f32_16x16x32_bf16 v[92:95], v[164:167], a[108:111], v[92:95]
    v_fma_f32 v126, v230, v27, -v26
    v_mfma_f32_16x16x32_bf16 v[88:91], v[164:167], a[104:107], v[88:91]
    buffer_load_dwordx4 v[160:163], v8, s[44:47], s95 offen offset:1024 sc1
    v_mfma_f32_16x16x32_bf16 v[88:91], v[168:171], a[120:123], v[88:91]
    v_mfma_f32_16x16x32_bf16 v[84:87], v[168:171], a[116:119], v[84:87]
    v_fma_f32 v127, v231, v27, -v26
    v_mfma_f32_16x16x32_bf16 v[84:87], v[164:167], a[100:103], v[84:87]
    s_waitcnt vmcnt(17)
    v_mfma_f32_16x16x32_bf16 v[100:103], v[172:175], a[100:103], v[100:103]
    v_fma_f32 v128, v232, v27, -v26
    v_mfma_f32_16x16x32_bf16 v[100:103], v[176:179], a[116:119], v[100:103]
    buffer_load_dwordx4 v[164:167], v8, s[44:47], s96 offen offset:0 sc1
    v_mfma_f32_16x16x32_bf16 v[104:107], v[176:179], a[120:123], v[104:107]
    v_fma_f32 v129, v233, v27, -v26
    v_mfma_f32_16x16x32_bf16 v[104:107], v[172:175], a[104:107], v[104:107]
    v_fma_f32 v130, v234, v27, -v26
    v_mfma_f32_16x16x32_bf16 v[108:111], v[172:175], a[108:111], v[108:111]
    buffer_load_dwordx4 v[168:171], v8, s[44:47], s97 offen offset:0 sc1
    v_mfma_f32_16x16x32_bf16 v[108:111], v[176:179], a[124:127], v[108:111]
    v_fma_f32 v131, v235, v27, -v26
    v_mfma_f32_16x16x32_bf16 v[112:115], v[176:179], a[112:115], v[112:115]
    v_fma_f32 v132, v236, v27, -v26
    v_mfma_f32_16x16x32_bf16 v[112:115], v[172:175], a[96:99], v[112:115]
    s_waitcnt vmcnt(17)
    v_mfma_f32_16x16x32_bf16 v[64:67], v[180:183], a[128:131], v[64:67]
    v_fma_f32 v133, v237, v27, -v26
    v_mfma_f32_16x16x32_bf16 v[64:67], v[184:187], a[144:147], v[64:67]
    buffer_load_dwordx4 v[172:175], v8, s[44:47], s96 offen offset:512 sc1
    v_mfma_f32_16x16x32_bf16 v[60:63], v[184:187], a[156:159], v[60:63]
    v_fma_f32 v134, v238, v27, -v26
    v_mfma_f32_16x16x32_bf16 v[60:63], v[180:183], a[140:143], v[60:63]
    v_fma_f32 v135, v239, v27, -v26
    v_mfma_f32_16x16x32_bf16 v[56:59], v[180:183], a[136:139], v[56:59]
    buffer_load_dwordx4 v[176:179], v8, s[44:47], s97 offen offset:512 sc1
    v_mfma_f32_16x16x32_bf16 v[56:59], v[184:187], a[152:155], v[56:59]
    v_mfma_f32_16x16x32_bf16 v[52:55], v[184:187], a[148:151], v[52:55]
    s_waitcnt lgkmcnt(0)
    v_mfma_f32_16x16x32_bf16 v[52:55], v[180:183], a[132:135], v[52:55]
    s_waitcnt vmcnt(17)
    v_mfma_f32_16x16x32_bf16 v[68:71], v[188:191], a[132:135], v[68:71]
    v_and_b32 v241, 0xffff0000, v14
    v_mfma_f32_16x16x32_bf16 v[68:71], v[192:195], a[148:151], v[68:71]
    buffer_load_dwordx4 v[180:183], v8, s[44:47], s96 offen offset:768 sc1
    v_mfma_f32_16x16x32_bf16 v[72:75], v[192:195], a[152:155], v[72:75]
    v_lshlrev_b32 v240, 16, v14
    v_mfma_f32_16x16x32_bf16 v[72:75], v[188:191], a[136:139], v[72:75]
    v_mul_f32 v117, v117, v241
    v_mfma_f32_16x16x32_bf16 v[76:79], v[188:191], a[140:143], v[76:79]
    buffer_load_dwordx4 v[184:187], v8, s[44:47], s97 offen offset:768 sc1
    v_mfma_f32_16x16x32_bf16 v[76:79], v[192:195], a[156:159], v[76:79]
    v_mul_f32 v116, v116, v240
    v_mfma_f32_16x16x32_bf16 v[80:83], v[192:195], a[144:147], v[80:83]
    v_and_b32 v243, 0xffff0000, v15
    v_mfma_f32_16x16x32_bf16 v[80:83], v[188:191], a[128:131], v[80:83]
    s_waitcnt vmcnt(17)
    v_mfma_f32_16x16x32_bf16 v[96:99], v[196:199], a[128:131], v[96:99]
    s_lshl_b32 s7, s15, 9
    s_lshl_b32 s4, s3, 7
    v_mfma_f32_16x16x32_bf16 v[96:99], v[200:203], a[144:147], v[96:99]
    buffer_load_dwordx4 v[188:191], v8, s[44:47], s96 offen offset:1024 sc1
    v_mfma_f32_16x16x32_bf16 v[92:95], v[200:203], a[156:159], v[92:95]
    s_add_u32 s7, s7, s4
    s_add_u32 s7, s7, 12599296
    v_mfma_f32_16x16x32_bf16 v[92:95], v[196:199], a[140:143], v[92:95]
    v_mov_b32 v28, s7
    v_mfma_f32_16x16x32_bf16 v[88:91], v[196:199], a[136:139], v[88:91]
    buffer_load_dwordx4 v[192:195], v8, s[44:47], s97 offen offset:1024 sc1
    v_mfma_f32_16x16x32_bf16 v[88:91], v[200:203], a[152:155], v[88:91]
    buffer_load_dword v29, v28, s[44:47], 0 offen sc1
    v_mfma_f32_16x16x32_bf16 v[84:87], v[200:203], a[148:151], v[84:87]
    v_lshlrev_b32 v242, 16, v15
    v_mul_f32 v119, v119, v243
    v_mfma_f32_16x16x32_bf16 v[84:87], v[196:199], a[132:135], v[84:87]
    s_waitcnt vmcnt(17)
    v_mfma_f32_16x16x32_bf16 v[100:103], v[204:207], a[132:135], v[100:103]
    v_mul_f32 v118, v118, v242
    v_and_b32 v245, 0xffff0000, v16
    v_mfma_f32_16x16x32_bf16 v[100:103], v[208:211], a[148:151], v[100:103]
    buffer_load_dwordx4 v[196:199], v8, s[44:47], s98 offen offset:0 sc1
    v_mfma_f32_16x16x32_bf16 v[104:107], v[208:211], a[152:155], v[104:107]
    v_lshlrev_b32 v244, 16, v16
    v_mfma_f32_16x16x32_bf16 v[104:107], v[204:207], a[136:139], v[104:107]
    v_mul_f32 v121, v121, v245
    v_mfma_f32_16x16x32_bf16 v[108:111], v[204:207], a[140:143], v[108:111]
    buffer_load_dwordx4 v[200:203], v8, s[44:47], s99 offen offset:0 sc1
    v_mfma_f32_16x16x32_bf16 v[108:111], v[208:211], a[156:159], v[108:111]
    v_mul_f32 v120, v120, v244
    v_mfma_f32_16x16x32_bf16 v[112:115], v[208:211], a[144:147], v[112:115]
    v_and_b32 v247, 0xffff0000, v17
    v_mfma_f32_16x16x32_bf16 v[112:115], v[204:207], a[128:131], v[112:115]
    v_lshlrev_b32 v246, 16, v17
    s_waitcnt vmcnt(17)
    v_mfma_f32_16x16x32_bf16 v[64:67], v[212:215], a[160:163], v[64:67]
    v_mul_f32 v123, v123, v247
    v_mfma_f32_16x16x32_bf16 v[64:67], v[216:219], a[176:179], v[64:67]
    buffer_load_dwordx4 v[204:207], v8, s[44:47], s98 offen offset:512 sc1
    v_mfma_f32_16x16x32_bf16 v[60:63], v[216:219], a[188:191], v[60:63]
    v_mul_f32 v122, v122, v246
    v_mfma_f32_16x16x32_bf16 v[60:63], v[212:215], a[172:175], v[60:63]
    v_and_b32 v241, 0xffff0000, v18
    v_mfma_f32_16x16x32_bf16 v[56:59], v[212:215], a[168:171], v[56:59]
    buffer_load_dwordx4 v[208:211], v8, s[44:47], s99 offen offset:512 sc1
    v_mfma_f32_16x16x32_bf16 v[56:59], v[216:219], a[184:187], v[56:59]
    v_mfma_f32_16x16x32_bf16 v[52:55], v[216:219], a[180:183], v[52:55]
    v_lshlrev_b32 v240, 16, v18
    v_mfma_f32_16x16x32_bf16 v[52:55], v[212:215], a[164:167], v[52:55]
    s_waitcnt vmcnt(17)
    v_mfma_f32_16x16x32_bf16 v[68:71], v[140:143], a[164:167], v[68:71]
    v_mul_f32 v125, v125, v241
    v_mfma_f32_16x16x32_bf16 v[68:71], v[144:147], a[180:183], v[68:71]
    buffer_load_dwordx4 v[212:215], v8, s[44:47], s98 offen offset:768 sc1
    v_mfma_f32_16x16x32_bf16 v[72:75], v[144:147], a[184:187], v[72:75]
    v_mul_f32 v124, v124, v240
    v_mfma_f32_16x16x32_bf16 v[72:75], v[140:143], a[168:171], v[72:75]
    v_and_b32 v243, 0xffff0000, v19
    v_mfma_f32_16x16x32_bf16 v[76:79], v[140:143], a[172:175], v[76:79]
    buffer_load_dwordx4 v[216:219], v8, s[44:47], s99 offen offset:768 sc1
    v_mfma_f32_16x16x32_bf16 v[76:79], v[144:147], a[188:191], v[76:79]
    v_lshlrev_b32 v242, 16, v19
    v_mfma_f32_16x16x32_bf16 v[80:83], v[144:147], a[176:179], v[80:83]
    v_mul_f32 v127, v127, v243
    v_mfma_f32_16x16x32_bf16 v[80:83], v[140:143], a[160:163], v[80:83]
    s_waitcnt vmcnt(17)
    v_mfma_f32_16x16x32_bf16 v[96:99], v[148:151], a[160:163], v[96:99]
    v_mul_f32 v126, v126, v242
    v_mfma_f32_16x16x32_bf16 v[96:99], v[152:155], a[176:179], v[96:99]
    buffer_load_dwordx4 v[140:143], v8, s[44:47], s98 offen offset:1024 sc1
    v_mfma_f32_16x16x32_bf16 v[92:95], v[152:155], a[188:191], v[92:95]
    v_and_b32 v245, 0xffff0000, v20
    v_mfma_f32_16x16x32_bf16 v[92:95], v[148:151], a[172:175], v[92:95]
    v_lshlrev_b32 v244, 16, v20
    v_mfma_f32_16x16x32_bf16 v[88:91], v[148:151], a[168:171], v[88:91]
    buffer_load_dwordx4 v[144:147], v8, s[44:47], s99 offen offset:1024 sc1
    v_mfma_f32_16x16x32_bf16 v[88:91], v[152:155], a[184:187], v[88:91]
    v_mfma_f32_16x16x32_bf16 v[84:87], v[152:155], a[180:183], v[84:87]
    v_mul_f32 v129, v129, v245
    v_mfma_f32_16x16x32_bf16 v[84:87], v[148:151], a[164:167], v[84:87]
    s_waitcnt vmcnt(17)
    v_mfma_f32_16x16x32_bf16 v[100:103], v[156:159], a[164:167], v[100:103]
    v_mul_f32 v128, v128, v244
    v_mfma_f32_16x16x32_bf16 v[100:103], v[160:163], a[180:183], v[100:103]
    v_and_b32 v247, 0xffff0000, v21
    v_mfma_f32_16x16x32_bf16 v[104:107], v[160:163], a[184:187], v[104:107]
    v_mfma_f32_16x16x32_bf16 v[104:107], v[156:159], a[168:171], v[104:107]
    v_lshlrev_b32 v246, 16, v21
    v_mfma_f32_16x16x32_bf16 v[108:111], v[156:159], a[172:175], v[108:111]
    v_mfma_f32_16x16x32_bf16 v[108:111], v[160:163], a[188:191], v[108:111]
    v_mul_f32 v131, v131, v247
    v_mfma_f32_16x16x32_bf16 v[112:115], v[160:163], a[176:179], v[112:115]
    v_mul_f32 v130, v130, v246
    v_mfma_f32_16x16x32_bf16 v[112:115], v[156:159], a[160:163], v[112:115]
    s_waitcnt vmcnt(15)
    v_mfma_f32_16x16x32_bf16 v[64:67], v[164:167], a[192:195], v[64:67]
    v_and_b32 v241, 0xffff0000, v22
    v_mfma_f32_16x16x32_bf16 v[64:67], v[168:171], a[208:211], v[64:67]
    v_mfma_f32_16x16x32_bf16 v[60:63], v[168:171], a[220:223], v[60:63]
    v_lshlrev_b32 v240, 16, v22
    v_mfma_f32_16x16x32_bf16 v[60:63], v[164:167], a[204:207], v[60:63]
    v_mfma_f32_16x16x32_bf16 v[56:59], v[164:167], a[200:203], v[56:59]
    v_mul_f32 v133, v133, v241
    v_mfma_f32_16x16x32_bf16 v[56:59], v[168:171], a[216:219], v[56:59]
    v_mfma_f32_16x16x32_bf16 v[52:55], v[168:171], a[212:215], v[52:55]
    v_mul_f32 v132, v132, v240
    v_mfma_f32_16x16x32_bf16 v[52:55], v[164:167], a[196:199], v[52:55]
    s_waitcnt vmcnt(13)
    v_mfma_f32_16x16x32_bf16 v[68:71], v[172:175], a[196:199], v[68:71]
    v_and_b32 v243, 0xffff0000, v23
    v_mfma_f32_16x16x32_bf16 v[68:71], v[176:179], a[212:215], v[68:71]
    v_lshlrev_b32 v242, 16, v23
    v_mfma_f32_16x16x32_bf16 v[72:75], v[176:179], a[216:219], v[72:75]
    v_mfma_f32_16x16x32_bf16 v[72:75], v[172:175], a[200:203], v[72:75]
    v_mul_f32 v135, v135, v243
    v_mfma_f32_16x16x32_bf16 v[76:79], v[172:175], a[204:207], v[76:79]
    v_mfma_f32_16x16x32_bf16 v[76:79], v[176:179], a[220:223], v[76:79]
    v_mul_f32 v134, v134, v242
    v_mfma_f32_16x16x32_bf16 v[80:83], v[176:179], a[208:211], v[80:83]
    v_add_u32 v4, 0x10000, v4
    v_mfma_f32_16x16x32_bf16 v[80:83], v[172:175], a[192:195], v[80:83]
    s_waitcnt vmcnt(11)
    v_mfma_f32_16x16x32_bf16 v[96:99], v[180:183], a[192:195], v[96:99]
    v_add_u32 v5, 0x10000, v5
    v_mfma_f32_16x16x32_bf16 v[96:99], v[184:187], a[208:211], v[96:99]
    v_mfma_f32_16x16x32_bf16 v[92:95], v[184:187], a[220:223], v[92:95]
    v_add_u32 v6, 0x10000, v6
    v_mfma_f32_16x16x32_bf16 v[92:95], v[180:183], a[204:207], v[92:95]
    v_mfma_f32_16x16x32_bf16 v[88:91], v[180:183], a[200:203], v[88:91]
    v_add_u32 v7, 0x10000, v7
    v_mfma_f32_16x16x32_bf16 v[88:91], v[184:187], a[216:219], v[88:91]
    s_mov_b32 s8, 0xbfb8aa3b
    v_mfma_f32_16x16x32_bf16 v[84:87], v[184:187], a[212:215], v[84:87]
    v_add_f32 v48, v48, v30
    v_mfma_f32_16x16x32_bf16 v[84:87], v[180:183], a[196:199], v[84:87]
    s_waitcnt vmcnt(9)
    v_mfma_f32_16x16x32_bf16 v[100:103], v[188:191], a[196:199], v[100:103]
    v_add_f32 v49, v49, v30
    v_mfma_f32_16x16x32_bf16 v[100:103], v[192:195], a[212:215], v[100:103]
    v_mfma_f32_16x16x32_bf16 v[104:107], v[192:195], a[216:219], v[104:107]
    v_add_f32 v50, v50, v30
    v_mfma_f32_16x16x32_bf16 v[104:107], v[188:191], a[200:203], v[104:107]
    v_mfma_f32_16x16x32_bf16 v[108:111], v[188:191], a[204:207], v[108:111]
    v_add_f32 v51, v51, v30
    v_mfma_f32_16x16x32_bf16 v[108:111], v[192:195], a[220:223], v[108:111]
    v_bfe_u32 v31, v2, 4, 1
    v_mfma_f32_16x16x32_bf16 v[112:115], v[192:195], a[208:211], v[112:115]
    v_mad_u32_u24 v252, v31, 24, v252
    v_mfma_f32_16x16x32_bf16 v[112:115], v[188:191], a[192:195], v[112:115]
    s_waitcnt vmcnt(6)
    v_mfma_f32_16x16x32_bf16 v[64:67], v[196:199], a[224:227], v[64:67]
    v_mfma_f32_16x16x32_bf16 v[64:67], v[200:203], a[240:243], v[64:67]
    v_mfma_f32_16x16x32_bf16 v[60:63], v[200:203], a[252:255], v[60:63]
    v_cmp_ne_u32 vcc, s68, v29
    s_cbranch_vccnz L_rs_p4
L_ok_p4:
    v_mfma_f32_16x16x32_bf16 v[60:63], v[196:199], a[236:239], v[60:63]
    v_mfma_f32_16x16x32_bf16 v[56:59], v[196:199], a[232:235], v[56:59]
    v_mfma_f32_16x16x32_bf16 v[56:59], v[200:203], a[248:251], v[56:59]
    v_mfma_f32_16x16x32_bf16 v[52:55], v[200:203], a[244:247], v[52:55]
    buffer_load_dwordx4 v[240:243], v10, s[44:47], s10 offen offset:0 sc1
    v_mfma_f32_16x16x32_bf16 v[52:55], v[196:199], a[228:231], v[52:55]
    s_waitcnt vmcnt(5)
    v_mfma_f32_16x16x32_bf16 v[68:71], v[204:207], a[228:231], v[68:71]
    v_mfma_f32_16x16x32_bf16 v[68:71], v[208:211], a[244:247], v[68:71]
    buffer_load_dwordx4 v[244:247], v10, s[44:47], s10 offen offset:1024 sc1
    v_mfma_f32_16x16x32_bf16 v[72:75], v[208:211], a[248:251], v[72:75]
    ds_write_b128 v6, v[60:63] offset:0
    v_mfma_f32_16x16x32_bf16 v[72:75], v[204:207], a[232:235], v[72:75]
    v_mfma_f32_16x16x32_bf16 v[76:79], v[204:207], a[236:239], v[76:79]
    ds_write_b128 v5, v[56:59] offset:0
    v_mfma_f32_16x16x32_bf16 v[76:79], v[208:211], a[252:255], v[76:79]
    buffer_load_dwordx2 v[248:249], v11, s[44:47], s10 offen offset:2048 sc1
    v_mfma_f32_16x16x32_bf16 v[80:83], v[208:211], a[240:243], v[80:83]
    ds_write_b128 v4, v[52:55] offset:0
    v_mfma_f32_16x16x32_bf16 v[80:83], v[204:207], a[224:227], v[80:83]
    s_waitcnt vmcnt(5)
    v_mfma_f32_16x16x32_bf16 v[96:99], v[212:215], a[224:227], v[96:99]
    v_mfma_f32_16x16x32_bf16 v[96:99], v[216:219], a[240:243], v[96:99]
    v_mfma_f32_16x16x32_bf16 v[92:95], v[216:219], a[252:255], v[92:95]
    ds_write_b128 v4, v[68:71] offset:1024
    v_mfma_f32_16x16x32_bf16 v[92:95], v[212:215], a[236:239], v[92:95]
    v_mfma_f32_16x16x32_bf16 v[88:91], v[212:215], a[232:235], v[88:91]
    ds_write_b128 v5, v[72:75] offset:1024
    v_mfma_f32_16x16x32_bf16 v[88:91], v[216:219], a[248:251], v[88:91]
    v_mfma_f32_16x16x32_bf16 v[84:87], v[216:219], a[244:247], v[84:87]
    ds_write_b128 v6, v[76:79] offset:1024
    v_mfma_f32_16x16x32_bf16 v[84:87], v[212:215], a[228:231], v[84:87]
    s_waitcnt vmcnt(3)
    v_mfma_f32_16x16x32_bf16 v[100:103], v[140:143], a[228:231], v[100:103]
    v_mfma_f32_16x16x32_bf16 v[100:103], v[144:147], a[244:247], v[100:103]
    v_mfma_f32_16x16x32_bf16 v[104:107], v[144:147], a[248:251], v[104:107]
    ds_write_b128 v6, v[92:95] offset:2048
    v_mfma_f32_16x16x32_bf16 v[104:107], v[140:143], a[232:235], v[104:107]
    v_mfma_f32_16x16x32_bf16 v[108:111], v[140:143], a[236:239], v[108:111]
    ds_write_b128 v5, v[88:91] offset:2048
    v_mfma_f32_16x16x32_bf16 v[108:111], v[144:147], a[252:255], v[108:111]
    v_mfma_f32_16x16x32_bf16 v[112:115], v[144:147], a[240:243], v[112:115]
    ds_write_b128 v4, v[84:87] offset:2048
    v_mfma_f32_16x16x32_bf16 v[112:115], v[140:143], a[224:227], v[112:115]
    ds_write_b128 v4, v[100:103] offset:3072
    s_nop 0
    ds_write_b128 v5, v[104:107] offset:3072
    s_nop 1
    ds_write_b128 v6, v[108:111] offset:3072
    s_waitcnt lgkmcnt(0)
    s_barrier
    ds_read_b128 v[52:55], v7 offset:0
    ds_read_b128 v[56:59], v7 offset:5120
    ds_read_b128 v[60:63], v7 offset:10240
    ds_read_b128 v[68:71], v7 offset:1024
    ds_read_b128 v[72:75], v7 offset:6144
    ds_read_b128 v[76:79], v7 offset:11264
    ds_read_b128 v[84:87], v7 offset:2048
    ds_read_b128 v[88:91], v7 offset:7168
    ds_read_b128 v[92:95], v7 offset:12288
    ds_read_b128 v[100:103], v7 offset:3072
    ds_read_b128 v[104:107], v7 offset:8192
    ds_read_b128 v[108:111], v7 offset:13312
    s_waitcnt vmcnt(0)
    v_and_b32 v33, 0xffff0000, v240
    v_lshlrev_b32 v32, 16, v240
    v_and_b32 v35, 0xffff0000, v241
    v_lshlrev_b32 v34, 16, v241
    v_and_b32 v37, 0xffff0000, v242
    v_lshlrev_b32 v36, 16, v242
    v_and_b32 v39, 0xffff0000, v243
    v_lshlrev_b32 v38, 16, v243
    v_and_b32 v41, 0xffff0000, v244
    v_lshlrev_b32 v40, 16, v244
    v_and_b32 v43, 0xffff0000, v245
    v_lshlrev_b32 v42, 16, v245
    v_and_b32 v45, 0xffff0000, v246
    v_lshlrev_b32 v44, 16, v246
    v_and_b32 v47, 0xffff0000, v247
    v_lshlrev_b32 v46, 16, v247
    v_and_b32 v137, 0xffff0000, v248
    v_lshlrev_b32 v136, 16, v248
    v_and_b32 v139, 0xffff0000, v249
    v_lshlrev_b32 v138, 16, v249
    v_add_f32 v48, v48, v136
    v_add_f32 v49, v49, v137
    v_add_f32 v50, v50, v138
    v_add_f32 v51, v51, v139
    v_mul_f32 v136, s8, v48
    v_mul_f32 v137, s8, v49
    v_mul_f32 v138, s8, v50
    v_mul_f32 v139, s8, v51
    v_exp_f32 v136, v136
    v_exp_f32 v137, v137
    v_exp_f32 v138, v138
    v_exp_f32 v139, v139
    v_mul_f32 v132, v132, v48
    v_mul_f32 v133, v133, v49
    v_mul_f32 v134, v134, v50
    v_mul_f32 v135, v135, v51
    v_add_f32 v136, 1.0, v136
    v_add_f32 v137, 1.0, v137
    v_add_f32 v138, 1.0, v138
    v_add_f32 v139, 1.0, v139
    v_rcp_f32 v136, v136
    v_rcp_f32 v137, v137
    v_rcp_f32 v138, v138
    v_rcp_f32 v139, v139
    v_fma_f32 v132, v132, v136, v236
    v_fma_f32 v133, v133, v137, v237
    v_fma_f32 v134, v134, v138, v238
    v_fma_f32 v135, v135, v139, v239
    v_cvt_pk_bf16_f32 v48, v132, v133
    v_cvt_pk_bf16_f32 v49, v134, v135
    buffer_store_dwordx2 v[48:49], v253, s[64:67], 0 offen sc1
    v_pk_add_f32 v[32:33], v[32:33], v[64:65]
    v_pk_add_f32 v[34:35], v[34:35], v[66:67]
    v_pk_add_f32 v[36:37], v[36:37], v[80:81]
    v_pk_add_f32 v[38:39], v[38:39], v[82:83]
    v_pk_add_f32 v[40:41], v[40:41], v[96:97]
    v_pk_add_f32 v[42:43], v[42:43], v[98:99]
    v_pk_add_f32 v[44:45], v[44:45], v[112:113]
    v_pk_add_f32 v[46:47], v[46:47], v[114:115]
    s_waitcnt lgkmcnt(9)
    v_pk_add_f32 v[32:33], v[32:33], v[52:53]
    v_pk_add_f32 v[34:35], v[34:35], v[54:55]
    v_pk_add_f32 v[56:57], v[56:57], v[60:61]
    v_pk_add_f32 v[58:59], v[58:59], v[62:63]
    v_pk_add_f32 v[32:33], v[32:33], v[56:57]
    v_pk_add_f32 v[34:35], v[34:35], v[58:59]
    s_waitcnt lgkmcnt(6)
    v_pk_add_f32 v[36:37], v[36:37], v[68:69]
    v_pk_add_f32 v[38:39], v[38:39], v[70:71]
    v_pk_add_f32 v[72:73], v[72:73], v[76:77]
    v_pk_add_f32 v[74:75], v[74:75], v[78:79]
    v_pk_add_f32 v[36:37], v[36:37], v[72:73]
    v_pk_add_f32 v[38:39], v[38:39], v[74:75]
    v_pk_mul_f32 v[52:53], v[32:33], s[8:9] op_sel_hi:[1,0]
    v_pk_mul_f32 v[54:55], v[34:35], s[8:9] op_sel_hi:[1,0]
    v_pk_mul_f32 v[68:69], v[36:37], s[8:9] op_sel_hi:[1,0]
    v_pk_mul_f32 v[70:71], v[38:39], s[8:9] op_sel_hi:[1,0]
    v_exp_f32 v52, v52
    v_exp_f32 v53, v53
    v_exp_f32 v54, v54
    v_exp_f32 v55, v55
    v_exp_f32 v68, v68
    v_exp_f32 v69, v69
    v_exp_f32 v70, v70
    v_exp_f32 v71, v71
    v_pk_mul_f32 v[116:117], v[116:117], v[32:33]
    v_pk_mul_f32 v[118:119], v[118:119], v[34:35]
    v_pk_mul_f32 v[120:121], v[120:121], v[36:37]
    v_pk_mul_f32 v[122:123], v[122:123], v[38:39]
    v_pk_add_f32 v[52:53], v[52:53], 1.0 op_sel_hi:[1,0]
    v_pk_add_f32 v[54:55], v[54:55], 1.0 op_sel_hi:[1,0]
    v_pk_add_f32 v[68:69], v[68:69], 1.0 op_sel_hi:[1,0]
    v_pk_add_f32 v[70:71], v[70:71], 1.0 op_sel_hi:[1,0]
    v_rcp_f32 v52, v52
    v_rcp_f32 v53, v53
    v_rcp_f32 v54, v54
    v_rcp_f32 v55, v55
    v_rcp_f32 v68, v68
    v_rcp_f32 v69, v69
    v_rcp_f32 v70, v70
    v_rcp_f32 v71, v71
    v_pk_fma_f32 v[116:117], v[116:117], v[52:53], v[220:221]
    v_pk_fma_f32 v[118:119], v[118:119], v[54:55], v[222:223]
    v_pk_fma_f32 v[120:121], v[120:121], v[68:69], v[224:225]
    v_pk_fma_f32 v[122:123], v[122:123], v[70:71], v[226:227]
    v_cvt_pk_bf16_f32 v32, v116, v117
    v_cvt_pk_bf16_f32 v34, v120, v121
    v_cvt_pk_bf16_f32 v33, v118, v119
    v_cvt_pk_bf16_f32 v35, v122, v123
    v_permlane16_swap_b32 v32, v34
    s_nop 0
    v_permlane16_swap_b32 v33, v35
    buffer_store_dwordx4 v[32:35], v252, s[64:67], 0 offen offset:0 sc1
    s_waitcnt lgkmcnt(3)
    v_pk_add_f32 v[40:41], v[40:41], v[84:85]
    v_pk_add_f32 v[42:43], v[42:43], v[86:87]
    v_pk_add_f32 v[88:89], v[88:89], v[92:93]
    v_pk_add_f32 v[90:91], v[90:91], v[94:95]
    v_pk_add_f32 v[40:41], v[40:41], v[88:89]
    v_pk_add_f32 v[42:43], v[42:43], v[90:91]
    s_waitcnt lgkmcnt(0)
    v_pk_add_f32 v[44:45], v[44:45], v[100:101]
    v_pk_add_f32 v[46:47], v[46:47], v[102:103]
    v_pk_add_f32 v[104:105], v[104:105], v[108:109]
    v_pk_add_f32 v[106:107], v[106:107], v[110:111]
    v_pk_add_f32 v[44:45], v[44:45], v[104:105]
    v_pk_add_f32 v[46:47], v[46:47], v[106:107]
    v_pk_mul_f32 v[84:85], v[40:41], s[8:9] op_sel_hi:[1,0]
    v_pk_mul_f32 v[86:87], v[42:43], s[8:9] op_sel_hi:[1,0]
    v_pk_mul_f32 v[100:101], v[44:45], s[8:9] op_sel_hi:[1,0]
    v_pk_mul_f32 v[102:103], v[46:47], s[8:9] op_sel_hi:[1,0]
    v_exp_f32 v84, v84
    v_exp_f32 v85, v85
    v_exp_f32 v86, v86
    v_exp_f32 v87, v87
    v_exp_f32 v100, v100
    v_exp_f32 v101, v101
    v_exp_f32 v102, v102
    v_exp_f32 v103, v103
    v_pk_mul_f32 v[124:125], v[124:125], v[40:41]
    v_pk_mul_f32 v[126:127], v[126:127], v[42:43]
    v_pk_mul_f32 v[128:129], v[128:129], v[44:45]
    v_pk_mul_f32 v[130:131], v[130:131], v[46:47]
    v_pk_add_f32 v[84:85], v[84:85], 1.0 op_sel_hi:[1,0]
    v_pk_add_f32 v[86:87], v[86:87], 1.0 op_sel_hi:[1,0]
    v_pk_add_f32 v[100:101], v[100:101], 1.0 op_sel_hi:[1,0]
    v_pk_add_f32 v[102:103], v[102:103], 1.0 op_sel_hi:[1,0]
    v_rcp_f32 v84, v84
    v_rcp_f32 v85, v85
    v_rcp_f32 v86, v86
    v_rcp_f32 v87, v87
    v_rcp_f32 v100, v100
    v_rcp_f32 v101, v101
    v_rcp_f32 v102, v102
    v_rcp_f32 v103, v103
    v_pk_fma_f32 v[124:125], v[124:125], v[84:85], v[228:229]
    v_pk_fma_f32 v[126:127], v[126:127], v[86:87], v[230:231]
    v_pk_fma_f32 v[128:129], v[128:129], v[100:101], v[232:233]
    v_pk_fma_f32 v[130:131], v[130:131], v[102:103], v[234:235]
    v_cvt_pk_bf16_f32 v40, v124, v125
    v_cvt_pk_bf16_f32 v42, v128, v129
    v_cvt_pk_bf16_f32 v41, v126, v127
    v_cvt_pk_bf16_f32 v43, v130, v131
    v_permlane16_swap_b32 v40, v42
    s_nop 0
    v_permlane16_swap_b32 v41, v43
    buffer_store_dwordx4 v[40:43], v252, s[64:67], 0 offen offset:64 sc1
    s_endpgm
L_segE:
.p2align 12
L_aux:
    s_mul_i32 s84, s101, 16
    s_lshr_b32 s84, s84, 2
    s_add_u32 s84, s84, 0
    s_add_u32 s85, s84, 1
    s_cmp_eq_u32 s85, 16
    s_cselect_b32 s85, 0, s85
    s_add_u32 s86, s85, 1
    s_cmp_eq_u32 s86, 16
    s_cselect_b32 s86, 0, s86
    s_add_u32 s87, s86, 1
    s_cmp_eq_u32 s87, 16
    s_cselect_b32 s87, 0, s87
    s_add_u32 s88, s87, 1
    s_cmp_eq_u32 s88, 16
    s_cselect_b32 s88, 0, s88
    s_add_u32 s89, s88, 1
    s_cmp_eq_u32 s89, 16
    s_cselect_b32 s89, 0, s89
    s_add_u32 s90, s89, 1
    s_cmp_eq_u32 s90, 16
    s_cselect_b32 s90, 0, s90
    s_add_u32 s91, s90, 1
    s_cmp_eq_u32 s91, 16
    s_cselect_b32 s91, 0, s91
    s_add_u32 s92, s91, 1
    s_cmp_eq_u32 s92, 16
    s_cselect_b32 s92, 0, s92
    s_add_u32 s93, s92, 1
    s_cmp_eq_u32 s93, 16
    s_cselect_b32 s93, 0, s93
    s_add_u32 s94, s93, 1
    s_cmp_eq_u32 s94, 16
    s_cselect_b32 s94, 0, s94
    s_add_u32 s95, s94, 1
    s_cmp_eq_u32 s95, 16
    s_cselect_b32 s95, 0, s95
    s_add_u32 s96, s95, 1
    s_cmp_eq_u32 s96, 16
    s_cselect_b32 s96, 0, s96
    s_add_u32 s97, s96, 1
    s_cmp_eq_u32 s97, 16
    s_cselect_b32 s97, 0, s97
    s_add_u32 s98, s97, 1
    s_cmp_eq_u32 s98, 16
    s_cselect_b32 s98, 0, s98
    s_add_u32 s99, s98, 1
    s_cmp_eq_u32 s99, 16
    s_cselect_b32 s99, 0, s99
    s_mul_i32 s100, s101, 2
    s_lshr_b32 s100, s100, 2
    s_add_u32 s100, s100, 16
    s_add_u32 s101, s100, 1
    s_cmp_eq_u32 s101, 18
    s_cselect_b32 s101, 16, s101
    s_lshl2_add_u32 s7, s5, s6
    s_add_u32 s7, s7, 188
    s_add_u32 s8, s5, 248
    s_cmp_eq_u32 s6, 27
    s_cselect_b32 s75, s8, s7
    s_mov_b32 s48, s24
    s_and_b32 s49, s25, 0xffff
    s_mov_b32 s50, 2359296
    s_mov_b32 s51, 0x20000
    v_lshlrev_b32 v240, 4, v2
    s_mul_i32 s74, s3, 16640
    s_add_u32 s74, s74, 73728
    s_sub_u32 s69, s75, 216
    s_lshl_b32 s70, s69, 4
    s_add_u32 s70, s70, s3
    s_lshl_b32 s12, s70, 12
    s_lshl_b32 s70, s70, 1
    s_and_b32 s7, s72, 1
    s_lshl_b32 s7, s7, 2
    s_add_u32 s7, s7, s3
    s_mul_i32 s7, s7, 576
    s_lshr_b32 s8, s72, 1
    s_mul_i32 s8, s8, 144
    s_add_u32 s7, s7, s8
    v_min_u32 v241, 47, v2
    v_add_u32 v241, s7, v241
    v_lshlrev_b32 v241, 12, v241
    s_lshl_b32 s7, s71, 7
    v_add_u32 v241, s7, v241
    v_lshrrev_b32 v242, 5, v2
    v_and_b32 v243, 31, v2
    v_lshlrev_b32 v242, 14, v242
    v_lshl_add_u32 v242, v243, 7, v242
    s_add_u32 s13, s12, 32768
    s_mov_b32 s9, 144896
    s_mov_b32 s11, 114688
    s_waitcnt vmcnt(9)
    v_and_b32 v21, 0xffff0000, v8
    v_lshlrev_b32 v20, 16, v8
    v_and_b32 v23, 0xffff0000, v9
    v_lshlrev_b32 v22, 16, v9
    v_and_b32 v25, 0xffff0000, v10
    v_lshlrev_b32 v24, 16, v10
    v_and_b32 v27, 0xffff0000, v12
    v_lshlrev_b32 v26, 16, v12
    v_and_b32 v29, 0xffff0000, v13
    v_lshlrev_b32 v28, 16, v13
    v_and_b32 v31, 0xffff0000, v14
    v_lshlrev_b32 v30, 16, v14
    v_and_b32 v33, 0xffff0000, v16
    v_lshlrev_b32 v32, 16, v16
    v_and_b32 v35, 0xffff0000, v17
    v_lshlrev_b32 v34, 16, v17
    v_and_b32 v37, 0xffff0000, v18
    v_lshlrev_b32 v36, 16, v18
    v_pk_add_f32 v[38:39], v[20:21], v[22:23]
    v_pk_add_f32 v[40:41], v[24:25], v[26:27]
    v_pk_add_f32 v[42:43], v[28:29], v[30:31]
    v_pk_add_f32 v[44:45], v[32:33], v[34:35]
    v_pk_add_f32 v[38:39], v[38:39], v[40:41]
    v_pk_add_f32 v[42:43], v[42:43], v[44:45]
    v_pk_add_f32 v[38:39], v[38:39], v[36:37]
    v_pk_add_f32 v[38:39], v[38:39], v[42:43]
    v_add_f32 v56, v38, v39
    s_nop 1
    v_add_f32_dpp v56, v56, v56 row_ror:8 row_mask:0xf bank_mask:0xf
    s_nop 1
    v_add_f32_dpp v56, v56, v56 row_ror:4 row_mask:0xf bank_mask:0xf
    s_nop 1
    v_add_f32_dpp v56, v56, v56 row_ror:2 row_mask:0xf bank_mask:0xf
    s_nop 1
    v_add_f32_dpp v56, v56, v56 row_ror:1 row_mask:0xf bank_mask:0xf
    v_mov_b32 v57, v56
    s_nop 1
    v_permlane16_swap_b32 v56, v57
    v_add_f32 v56, v56, v57
    v_mul_f32 v56, 0x3ae38e39, v56
    v_pk_add_f32 v[20:21], v[20:21], v[56:57] op_sel_hi:[1,0] neg_lo:[0,1] neg_hi:[0,1]
    v_pk_add_f32 v[22:23], v[22:23], v[56:57] op_sel_hi:[1,0] neg_lo:[0,1] neg_hi:[0,1]
    v_pk_add_f32 v[24:25], v[24:25], v[56:57] op_sel_hi:[1,0] neg_lo:[0,1] neg_hi:[0,1]
    v_pk_add_f32 v[26:27], v[26:27], v[56:57] op_sel_hi:[1,0] neg_lo:[0,1] neg_hi:[0,1]
    v_pk_add_f32 v[28:29], v[28:29], v[56:57] op_sel_hi:[1,0] neg_lo:[0,1] neg_hi:[0,1]
    v_pk_add_f32 v[30:31], v[30:31], v[56:57] op_sel_hi:[1,0] neg_lo:[0,1] neg_hi:[0,1]
    v_pk_add_f32 v[32:33], v[32:33], v[56:57] op_sel_hi:[1,0] neg_lo:[0,1] neg_hi:[0,1]
    v_pk_add_f32 v[34:35], v[34:35], v[56:57] op_sel_hi:[1,0] neg_lo:[0,1] neg_hi:[0,1]
    v_pk_add_f32 v[36:37], v[36:37], v[56:57] op_sel_hi:[1,0] neg_lo:[0,1] neg_hi:[0,1]
    v_pk_mul_f32 v[38:39], v[20:21], v[20:21]
    v_pk_mul_f32 v[40:41], v[22:23], v[22:23]
    v_pk_fma_f32 v[38:39], v[24:25], v[24:25], v[38:39]
    v_pk_fma_f32 v[40:41], v[26:27], v[26:27], v[40:41]
    v_pk_fma_f32 v[38:39], v[28:29], v[28:29], v[38:39]
    v_pk_fma_f32 v[40:41], v[30:31], v[30:31], v[40:41]
    v_pk_fma_f32 v[38:39], v[32:33], v[32:33], v[38:39]
    v_pk_fma_f32 v[40:41], v[34:35], v[34:35], v[40:41]
    v_pk_fma_f32 v[38:39], v[36:37], v[36:37], v[38:39]
    v_pk_add_f32 v[38:39], v[38:39], v[40:41]
    v_add_f32 v18, v38, v39
    s_nop 1
    v_add_f32_dpp v18, v18, v18 row_ror:8 row_mask:0xf bank_mask:0xf
    s_nop 1
    v_add_f32_dpp v18, v18, v18 row_ror:4 row_mask:0xf bank_mask:0xf
    s_nop 1
    v_add_f32_dpp v18, v18, v18 row_ror:2 row_mask:0xf bank_mask:0xf
    s_nop 1
    v_add_f32_dpp v18, v18, v18 row_ror:1 row_mask:0xf bank_mask:0xf
    v_mov_b32 v19, v18
    s_nop 1
    v_permlane16_swap_b32 v18, v19
    v_add_f32 v18, v18, v19
    v_mul_f32 v18, 0x3ae38e39, v18
    v_cvt_pk_bf16_f32 v38, v56, v18
    v_lshlrev_b32 v106, 16, v38
    v_and_b32 v38, 0xffff0000, v38
    v_add_f32 v38, 0x3727c5ac, v38
    v_sub_f32 v56, v56, v106
    v_cvt_pk_bf16_f32 v38, v38, v38
    v_lshlrev_b32 v38, 16, v38
    v_sqrt_f32 v38, v38
    s_nop 0
    v_cvt_pk_bf16_f32 v38, v38, v38
    v_lshlrev_b32 v38, 16, v38
    v_rcp_f32 v107, v38
    s_nop 0
    v_mul_f32 v56, v56, v107
    v_mul_f32 v18, v18, v107
    v_mul_f32 v18, v18, v107
    v_cvt_pk_bf16_f32 v38, v56, v18
    v_lshlrev_b32 v39, 16, v38
    v_and_b32 v38, 0xffff0000, v38
    v_add_f32 v38, 0x3727c5ac, v38
    v_sub_f32 v56, v56, v39
    v_cvt_pk_bf16_f32 v38, v38, v38
    v_lshlrev_b32 v38, 16, v38
    v_sqrt_f32 v38, v38
    s_nop 0
    v_cvt_pk_bf16_f32 v38, v38, v38
    v_lshlrev_b32 v38, 16, v38
    v_rcp_f32 v38, v38
    s_nop 0
    v_mul_f32 v18, v107, v38
    v_mul_f32 v56, v56, v38
    v_pk_fma_f32 v[20:21], v[20:21], v[18:19], v[56:57] op_sel_hi:[1,0,0]
    v_pk_fma_f32 v[22:23], v[22:23], v[18:19], v[56:57] op_sel_hi:[1,0,0]
    v_pk_fma_f32 v[24:25], v[24:25], v[18:19], v[56:57] op_sel_hi:[1,0,0]
    v_pk_fma_f32 v[26:27], v[26:27], v[18:19], v[56:57] op_sel_hi:[1,0,0]
    v_pk_fma_f32 v[28:29], v[28:29], v[18:19], v[56:57] op_sel_hi:[1,0,0]
    v_pk_fma_f32 v[30:31], v[30:31], v[18:19], v[56:57] op_sel_hi:[1,0,0]
    v_pk_fma_f32 v[32:33], v[32:33], v[18:19], v[56:57] op_sel_hi:[1,0,0]
    v_pk_fma_f32 v[34:35], v[34:35], v[18:19], v[56:57] op_sel_hi:[1,0,0]
    v_pk_fma_f32 v[36:37], v[36:37], v[18:19], v[56:57] op_sel_hi:[1,0,0]
    v_cvt_pk_bf16_f32 v8, v20, v21
    v_cvt_pk_bf16_f32 v9, v22, v23
    v_cvt_pk_bf16_f32 v10, v24, v25
    v_cvt_pk_bf16_f32 v11, v26, v27
    v_cvt_pk_bf16_f32 v12, v28, v29
    v_cvt_pk_bf16_f32 v13, v30, v31
    v_cvt_pk_bf16_f32 v14, v32, v33
    v_cvt_pk_bf16_f32 v15, v34, v35
    v_cvt_pk_bf16_f32 v16, v36, v37
    v_lshrrev_b32 v3, 5, v0
    v_and_b32 v1, 31, v0
    v_mul_u32_u24 v17, 1216, v3
    v_mad_u32_u24 v17, v1, 12, v17
    v_add_u32 v17, 144896, v17
    ds_write_b32 v17, v8 offset:0
    ds_write_b32 v17, v9 offset:4
    ds_write_b32 v17, v10 offset:8
    ds_write_b32 v17, v11 offset:384
    ds_write_b32 v17, v12 offset:388
    ds_write_b32 v17, v13 offset:392
    ds_write_b32 v17, v14 offset:768
    ds_write_b32 v17, v15 offset:772
    ds_write_b32 v17, v16 offset:776
    v_lshlrev_b32 v3, 3, v3
    s_lshl_b32 s5, s68, 6
    s_add_u32 s5, s5, 12386304
    v_cmp_eq_u32 vcc, 0, v1
    v_mov_b32 v18, 0x40000000
    s_nop 0
    v_cndmask_b32 v3, v18, v3, vcc
    buffer_store_dwordx2 v[106:107], v3, s[44:47], s5 offen sc1
    v_lshrrev_b32 v19, 4, v0
    v_and_b32 v17, 3, v2
    v_lshlrev_b32 v17, 3, v17
    v_lshl_add_u32 v19, v19, 5, v17
    v_bfe_u32 v6, v2, 2, 2
    v_mul_u32_u24 v17, 1216, v6
    v_mul_u32_u24 v6, 1152, v6
    v_add3_u32 v17, v17, v19, s9
    v_add3_u32 v6, v6, v19, s11
    v_lshlrev_b32 v19, 4, v0
    s_add_u32 s7, s15, 4096
    s_add_u32 s8, s15, 8192
    s_cmp_eq_u32 s3, 0
    s_cselect_b32 s8, s8, 0x40000000
    v_add_u32 v18, 2359296, v19
    v_mov_b32 v44, 0
    s_waitcnt vmcnt(2) lgkmcnt(0)
    s_barrier
    ds_read_b64_tr_b16 v[60:61], v6 offset:0
    ds_read_b64_tr_b16 v[62:63], v6 offset:4608
    ds_read_b64_tr_b16 v[64:65], v6 offset:9216
    ds_read_b64_tr_b16 v[66:67], v6 offset:12672
    ds_read_b64_tr_b16 v[68:69], v6 offset:17280
    ds_read_b64_tr_b16 v[20:21], v17 offset:0
    ds_read_b64_tr_b16 v[22:23], v17 offset:4864
    ds_read_b64_tr_b16 v[24:25], v17 offset:512
    ds_read_b64_tr_b16 v[26:27], v17 offset:5376
    ds_read_b64_tr_b16 v[28:29], v17 offset:1024
    ds_read_b64_tr_b16 v[30:31], v17 offset:5888
    ds_read_b64_tr_b16 v[70:71], v6 offset:512
    ds_read_b64_tr_b16 v[72:73], v6 offset:5120
    ds_read_b64_tr_b16 v[74:75], v6 offset:9728
    ds_read_b64_tr_b16 v[76:77], v6 offset:13184
    v_alignbit_b32 v114, v99, v99, 16
    v_alignbit_b32 v115, v98, v98, 16
    s_waitcnt lgkmcnt(10)
    v_alignbit_b32 v108, v61, v60, 16
    v_alignbit_b32 v109, v62, v61, 16
    v_alignbit_b32 v110, v63, v62, 16
    v_alignbit_b32 v111, v64, v63, 16
    v_alignbit_b32 v112, v65, v64, 16
    v_dot2_f32_bf16 v116, v60, v114, 0
    ds_read_b64_tr_b16 v[78:79], v6 offset:17792
    v_dot2_f32_bf16 v117, v108, v114, 0
    v_dot2_f32_bf16 v118, v61, v114, 0
    ds_read_b64_tr_b16 v[80:81], v6 offset:1024
    v_dot2_f32_bf16 v119, v109, v114, 0
    v_dot2_f32_bf16 v120, v62, v114, 0
    v_dot2_f32_bf16 v121, v110, v114, 0
    ds_read_b64_tr_b16 v[82:83], v6 offset:5632
    v_dot2_f32_bf16 v122, v63, v114, 0
    v_dot2_f32_bf16 v123, v111, v114, 0
    v_dot2_f32_bf16 v116, v61, v115, v116
    ds_read_b64_tr_b16 v[84:85], v6 offset:10240
    v_dot2_f32_bf16 v117, v109, v115, v117
    v_dot2_f32_bf16 v118, v62, v115, v118
    ds_read_b64_tr_b16 v[86:87], v6 offset:13696
    v_dot2_f32_bf16 v119, v110, v115, v119
    v_dot2_f32_bf16 v120, v63, v115, v120
    v_dot2_f32_bf16 v121, v111, v115, v121
    ds_read_b64_tr_b16 v[88:89], v6 offset:18304
    v_dot2_f32_bf16 v122, v64, v115, v122
    v_dot2_f32_bf16 v123, v112, v115, v123
    v_and_b32 v133, 0xffff0000, v66
    s_waitcnt lgkmcnt(14)
    buffer_store_dwordx4 v[20:23], v19, s[44:47], s15 offen sc1
    v_lshlrev_b32 v132, 16, v66
    v_and_b32 v135, 0xffff0000, v67
    s_waitcnt lgkmcnt(12)
    buffer_store_dwordx4 v[24:27], v19, s[44:47], s7 offen sc1
    v_lshlrev_b32 v134, 16, v67
    v_and_b32 v137, 0xffff0000, v68
    v_lshlrev_b32 v136, 16, v68
    s_waitcnt lgkmcnt(10)
    buffer_store_dwordx4 v[28:31], v19, s[44:47], s8 offen sc1
    v_and_b32 v139, 0xffff0000, v69
    v_lshlrev_b32 v138, 16, v69
    v_pk_mul_f32 v[116:117], v[116:117], v[132:133]
    v_pk_mul_f32 v[118:119], v[118:119], v[134:135]
    v_pk_mul_f32 v[120:121], v[120:121], v[136:137]
    v_pk_mul_f32 v[122:123], v[122:123], v[138:139]
    v_cvt_pk_bf16_f32 v160, v123, v122
    v_cvt_pk_bf16_f32 v161, v121, v120
    v_cvt_pk_bf16_f32 v162, v119, v118
    v_cvt_pk_bf16_f32 v163, v117, v116
    buffer_store_dwordx4 v[160:163], v18, s[44:47], s15 offen sc1
    v_alignbit_b32 v114, v101, v101, 16
    v_alignbit_b32 v115, v100, v100, 16
    s_waitcnt lgkmcnt(5)
    v_alignbit_b32 v108, v71, v70, 16
    v_alignbit_b32 v109, v72, v71, 16
    v_alignbit_b32 v110, v73, v72, 16
    v_alignbit_b32 v111, v74, v73, 16
    v_alignbit_b32 v112, v75, v74, 16
    v_dot2_f32_bf16 v124, v70, v114, 0
    v_dot2_f32_bf16 v125, v108, v114, 0
    v_dot2_f32_bf16 v126, v71, v114, 0
    v_dot2_f32_bf16 v127, v109, v114, 0
    v_dot2_f32_bf16 v128, v72, v114, 0
    v_dot2_f32_bf16 v129, v110, v114, 0
    v_dot2_f32_bf16 v130, v73, v114, 0
    v_dot2_f32_bf16 v131, v111, v114, 0
    v_dot2_f32_bf16 v124, v71, v115, v124
    v_dot2_f32_bf16 v125, v109, v115, v125
    v_dot2_f32_bf16 v126, v72, v115, v126
    v_dot2_f32_bf16 v127, v110, v115, v127
    v_dot2_f32_bf16 v128, v73, v115, v128
    v_dot2_f32_bf16 v129, v111, v115, v129
    v_dot2_f32_bf16 v130, v74, v115, v130
    v_dot2_f32_bf16 v131, v112, v115, v131
    v_and_b32 v133, 0xffff0000, v76
    v_lshlrev_b32 v132, 16, v76
    v_and_b32 v135, 0xffff0000, v77
    v_lshlrev_b32 v134, 16, v77
    v_and_b32 v137, 0xffff0000, v78
    v_lshlrev_b32 v136, 16, v78
    v_and_b32 v139, 0xffff0000, v79
    v_lshlrev_b32 v138, 16, v79
    v_pk_mul_f32 v[124:125], v[124:125], v[132:133]
    v_pk_mul_f32 v[126:127], v[126:127], v[134:135]
    v_pk_mul_f32 v[128:129], v[128:129], v[136:137]
    v_pk_mul_f32 v[130:131], v[130:131], v[138:139]
    v_cvt_pk_bf16_f32 v164, v131, v130
    v_cvt_pk_bf16_f32 v165, v129, v128
    v_cvt_pk_bf16_f32 v166, v127, v126
    v_cvt_pk_bf16_f32 v167, v125, v124
    buffer_store_dwordx4 v[164:167], v18, s[44:47], s7 offen sc1
    v_alignbit_b32 v114, v103, v103, 16
    v_alignbit_b32 v115, v102, v102, 16
    s_waitcnt lgkmcnt(0)
    v_alignbit_b32 v108, v81, v80, 16
    v_alignbit_b32 v109, v82, v81, 16
    v_alignbit_b32 v110, v83, v82, 16
    v_alignbit_b32 v111, v84, v83, 16
    v_alignbit_b32 v112, v85, v84, 16
    v_dot2_f32_bf16 v116, v80, v114, 0
    v_dot2_f32_bf16 v117, v108, v114, 0
    v_dot2_f32_bf16 v118, v81, v114, 0
    v_dot2_f32_bf16 v119, v109, v114, 0
    v_dot2_f32_bf16 v120, v82, v114, 0
    v_dot2_f32_bf16 v121, v110, v114, 0
    v_dot2_f32_bf16 v122, v83, v114, 0
    v_dot2_f32_bf16 v123, v111, v114, 0
    v_dot2_f32_bf16 v116, v81, v115, v116
    v_dot2_f32_bf16 v117, v109, v115, v117
    v_dot2_f32_bf16 v118, v82, v115, v118
    v_dot2_f32_bf16 v119, v110, v115, v119
    v_dot2_f32_bf16 v120, v83, v115, v120
    v_dot2_f32_bf16 v121, v111, v115, v121
    v_dot2_f32_bf16 v122, v84, v115, v122
    v_dot2_f32_bf16 v123, v112, v115, v123
    v_and_b32 v133, 0xffff0000, v86
    v_lshlrev_b32 v132, 16, v86
    v_and_b32 v135, 0xffff0000, v87
    v_lshlrev_b32 v134, 16, v87
    v_and_b32 v137, 0xffff0000, v88
    v_lshlrev_b32 v136, 16, v88
    v_and_b32 v139, 0xffff0000, v89
    v_lshlrev_b32 v138, 16, v89
    v_pk_mul_f32 v[116:117], v[116:117], v[132:133]
    v_pk_mul_f32 v[118:119], v[118:119], v[134:135]
    v_pk_mul_f32 v[120:121], v[120:121], v[136:137]
    v_pk_mul_f32 v[122:123], v[122:123], v[138:139]
    v_cvt_pk_bf16_f32 v168, v123, v122
    v_cvt_pk_bf16_f32 v169, v121, v120
    v_cvt_pk_bf16_f32 v170, v119, v118
    v_cvt_pk_bf16_f32 v171, v117, v116
    buffer_store_dwordx4 v[168:171], v18, s[44:47], s8 offen sc1
    buffer_load_dword v45, v44, s[64:67], 0 offen sc1
    s_mov_b64 exec, 0
    s_call_b64 s[82:83], L_wc_X
    s_mov_b64 exec, -1
    s_bfe_u32 s6, s68, 0x20001
    s_lshl_b32 s6, s6, 6
    s_lshr_b32 s7, s68, 3
    s_lshl_b32 s7, s7, 1
    s_add_u32 s6, s6, s7
    s_and_b32 s7, s68, 1
    s_add_u32 s6, s6, s7
    s_lshr_b32 s4, s6, 2
    s_lshl_b32 s4, s4, 7
    s_and_b32 s5, s6, 3
    s_lshl2_add_u32 s4, s5, s4
    s_add_u32 s4, s4, 12533760
    v_min_u32 v1, 1, v0
    v_lshlrev_b32 v1, 30, v1
    v_add_u32 v1, s4, v1
    s_waitcnt vmcnt(0)
    v_readfirstlane_b32 s68, v45
    s_nop 1
    s_cmp_eq_u32 s68, 0
    s_cbranch_scc1 L_nw_X
L_ng_X:
    s_barrier
    v_mov_b32 v3, s68
    buffer_store_dword v3, v1, s[44:47], 0 offen sc1
    s_mov_b64 exec, 0
    s_call_b64 s[82:83], L_wc_D
    s_mov_b64 exec, -1
L_segX:
L_pl_X_0:
    s_cbranch_execz L_pl_X_4
    s_add_u32 m0, s74, 32
    s_add_u32 s13, s12, 0
    buffer_load_dwordx4 v240, s[48:51], s13 offen offset:0 lds
    buffer_load_dwordx4 v240, s[48:51], s13 offen offset:1024 lds
    buffer_load_dwordx4 v240, s[48:51], s13 offen offset:2048 lds
    buffer_load_dwordx4 v240, s[48:51], s13 offen offset:3072 lds
    s_mov_b32 s60, s36
    s_and_b32 s61, s37, 0xffff
    s_mov_b32 s62, 4096
    s_mov_b32 s63, 0x20000
    v_and_b32 v24, 15, v2
    s_lshl_b32 s7, s71, 6
    s_lshl_b32 s8, s3, 4
    s_add_u32 s7, s7, s8
    v_add_u32 v24, s7, v24
    v_mul_u32_u24 v25, 1152, v24
    v_lshrrev_b32 v31, 4, v2
    v_lshl_add_u32 v25, v31, 3, v25
    s_mul_i32 s8, s72, 144
    v_add_u32 v25, s8, v25
    s_and_b32 s7, s72, 1
    s_lshl_b32 s8, s7, 4
    v_add_u32 v252, s8, v25
    s_mul_i32 s8, s7, 144
    s_sub_u32 s8, 128, s8
    v_add_u32 v25, s8, v25
    v_lshrrev_b32 v31, 5, v2
    v_cmp_eq_u32 vcc, s7, v31
    v_mov_b32 v31, 0x40000000
    s_nop 0
    v_cndmask_b32 v253, v31, v25, vcc
    v_lshlrev_b32 v25, 1, v24
    v_lshlrev_b32 v26, 3, v24
    buffer_load_ushort v30, v25, s[60:63], 0 offen
    v_lshrrev_b32 v24, 3, v2
    v_and_b32 v25, 7, v2
    v_bfe_u32 v31, v2, 4, 2
    v_lshlrev_b32 v31, 1, v31
    v_xor_b32 v25, v25, v31
    v_lshlrev_b32 v24, 12, v24
    v_lshl_add_u32 v24, v25, 4, v24
    s_and_b32 s7, s72, 1
    s_lshl_b32 s7, s7, 2
    s_add_u32 s7, s7, s3
    s_mul_i32 s7, s7, 2359296
    s_lshl_b32 s8, s71, 7
    s_add_u32 s7, s7, s8
    v_add_u32 v4, s7, v24
    v_add_u32 v5, 31744, v4
    v_add_u32 v6, 31744, v5
    v_add_u32 v7, 31744, v6
    v_lshrrev_b32 v24, 2, v2
    v_lshlrev_b32 v24, 7, v24
    v_and_b32 v25, 3, v2
    v_lshl_add_u32 v24, v25, 3, v24
    v_add_u32 v24, s73, v24
    v_bfe_u32 v31, v2, 3, 2
    v_xor_b32 v31, s3, v31
    v_xor_b32 v25, 0, v31
    v_lshl_add_u32 v10, v25, 5, v24
    v_xor_b32 v25, 1, v31
    v_lshl_add_u32 v11, v25, 5, v24
    v_xor_b32 v25, 2, v31
    v_lshl_add_u32 v12, v25, 5, v24
    v_xor_b32 v25, 3, v31
    v_lshl_add_u32 v13, v25, 5, v24
    s_cmp_lt_u32 s75, 252
    s_cbranch_scc0 L_idle
    s_mov_b32 s56, s26
    s_and_b32 s57, s27, 0xffff
    s_mov_b32 s58, 1152
    s_mov_b32 s59, 0x20000
    v_mov_b32 v9, 0
    buffer_load_ushort v9, v9, s[56:59], s70 offen
    v_and_b32 v196, 15, v2
    v_lshrrev_b32 v197, 4, v2
    v_lshlrev_b32 v197, 3, v197
    v_add_u32 v196, v196, v197
    v_sub_u32 v196, 15, v196
    v_and_b32 v197, 1, v196
    v_lshlrev_b32 v197, 4, v197
    v_mov_b32 v198, 0xffff
    v_lshlrev_b32 v197, v197, v198
    v_ashrrev_i32 v196, 1, v196
    v_cmp_eq_u32 vcc, 0, v196
    s_nop 1
    v_cndmask_b32 v208, 0, v197, vcc
    v_cmp_eq_u32 vcc, 1, v196
    s_nop 1
    v_cndmask_b32 v209, 0, v197, vcc
    v_cmp_eq_u32 vcc, 2, v196
    s_nop 1
    v_cndmask_b32 v210, 0, v197, vcc
    v_cmp_eq_u32 vcc, 3, v196
    s_nop 1
    v_cndmask_b32 v211, 0, v197, vcc
    s_lshl_b32 s4, s3, 6
    v_min_u32 v28, 63, v2
    v_add_u32 v28, s4, v28
    v_and_b32 v29, 3, v28
    v_lshrrev_b32 v28, 2, v28
    v_lshlrev_b32 v28, 7, v28
    v_lshl_add_u32 v28, v29, 2, v28
    v_add_u32 v28, 12533760, v28
    v_add_u32 v241, s74, v240
    v_cmp_eq_u32 vcc, 0, v2
    v_mov_b32 v196, 4136
    s_nop 0
    v_cndmask_b32 v196, v196, 30, vcc
    v_add_u32 v242, s74, v196
    v_bfe_u32 v196, v2, 3, 2
    v_mul_u32_u24 v196, 4160, v196
    v_and_b32 v197, 7, v2
    v_lshl_add_u32 v196, v197, 2, v196
    v_add_u32 v200, s74, v196
    v_mov_b32 v196, 0
    v_mov_b32 v197, 0
    v_mov_b32 v198, 0
    v_mov_b32 v199, 0
    ds_write_b32 v200, v196
    v_lshlrev_b32 v201, 4, v0
    ds_write_b128 v201, v[196:199]
    ds_write_b128 v201, v[196:199] offset:36864
    s_waitcnt vmcnt(2)
    ds_read_b128 v[212:215], v241 offset:32
    ds_read_b32 v216, v241 offset:48
    ds_read_b128 v[218:221], v241 offset:1056
    ds_read_b32 v222, v241 offset:1072
    ds_read_b128 v[224:227], v241 offset:2080
    ds_read_b32 v228, v241 offset:2096
    ds_read_b128 v[230:233], v241 offset:3104
    ds_read_b32 v234, v241 offset:3120
    v_lshrrev_b32 v202, 3, v2
    v_and_b32 v203, 7, v2
    v_lshrrev_b32 v204, 1, v202
    v_xor_b32 v203, v203, v204
    v_mul_u32_u24 v202, 9216, v202
    v_lshl_add_u32 v24, v203, 4, v202
    v_xor_b32 v25, 64, v24
    v_and_b32 v202, 15, v2
    v_add_u32 v202, 1, v202
    v_and_b32 v203, 1, v202
    v_mul_u32_u24 v203, 4160, v203
    v_lshrrev_b32 v202, 1, v202
    v_lshl_add_u32 v203, v202, 2, v203
    v_lshrrev_b32 v204, 4, v2
    v_lshl_add_u32 v203, v204, 4, v203
    v_add_u32 v236, s74, v203
    v_add_u32 v237, 1024, v236
    v_add_u32 v238, 1024, v237
    v_add_u32 v239, 1024, v238
    s_waitcnt lgkmcnt(0)
    ds_write_b16 v242, v212 offset:4160
    v_alignbit_b32 v212, v213, v212, 16
    v_alignbit_b32 v213, v214, v213, 16
    v_alignbit_b32 v214, v215, v214, 16
    v_alignbit_b32 v215, v216, v215, 16
    ds_write_b128 v241, v[212:215] offset:4192
    v_alignbit_b32 v218, v219, v218, 16
    v_alignbit_b32 v219, v220, v219, 16
    v_alignbit_b32 v220, v221, v220, 16
    v_alignbit_b32 v221, v222, v221, 16
    ds_write_b128 v241, v[218:221] offset:5216
    v_alignbit_b32 v224, v225, v224, 16
    v_alignbit_b32 v225, v226, v225, 16
    v_alignbit_b32 v226, v227, v226, 16
    v_alignbit_b32 v227, v228, v227, 16
    ds_write_b128 v241, v[224:227] offset:6240
    v_alignbit_b32 v230, v231, v230, 16
    v_alignbit_b32 v231, v232, v231, 16
    v_alignbit_b32 v232, v233, v232, 16
    v_alignbit_b32 v233, v234, v233, 16
    ds_write_b128 v241, v[230:233] offset:7264
    v_and_b32 v202, 15, v2
    v_lshlrev_b32 v202, 1, v202
    v_sub_u32 v202, v202, v204
    v_add_u32 v202, 17, v202
    v_bfe_u32 v203, v202, 1, 3
    v_xor_b32 v203, s3, v203
    v_lshlrev_b32 v203, 4, v203
    v_lshl_add_u32 v244, v202, 7, v203
    v_and_b32 v202, 15, v2
    v_lshlrev_b32 v202, 1, v202
    v_sub_u32 v202, v202, v204
    v_add_u32 v202, 13, v202
    v_bfe_u32 v203, v202, 1, 3
    v_xor_b32 v203, s3, v203
    v_lshlrev_b32 v203, 4, v203
    v_lshl_add_u32 v245, v202, 7, v203
    v_and_b32 v202, 15, v2
    v_lshlrev_b32 v202, 1, v202
    v_sub_u32 v202, v202, v204
    v_add_u32 v202, 9, v202
    v_bfe_u32 v203, v202, 1, 3
    v_xor_b32 v203, s3, v203
    v_lshlrev_b32 v203, 4, v203
    v_lshl_add_u32 v246, v202, 7, v203
    v_and_b32 v202, 15, v2
    v_lshlrev_b32 v202, 1, v202
    v_sub_u32 v202, v202, v204
    v_add_u32 v202, 5, v202
    v_bfe_u32 v203, v202, 1, 3
    v_xor_b32 v203, s3, v203
    v_lshlrev_b32 v203, 4, v203
    v_lshl_add_u32 v247, v202, 7, v203
    v_and_b32 v202, 15, v2
    v_lshlrev_b32 v202, 5, v202
    v_lshl_add_u32 v8, v204, 3, v202
    s_mul_i32 s7, s3, 589824
    s_lshl_b32 s8, s69, 8
    s_add_u32 s7, s7, s8
    s_add_u32 s7, s7, 2359296
    s_lshl_b32 s9, s3, 13
    s_add_u32 s9, s9, 4096
    ds_read2_b32 v[64:65], v236 offset0:0 offset1:1
    ds_read2_b32 v[66:67], v236 offset0:2 offset1:3
    ds_read2_b32 v[68:69], v236 offset0:128 offset1:129
    ds_read2_b32 v[70:71], v236 offset0:130 offset1:131
    ds_read2_b32 v[72:73], v237 offset0:0 offset1:1
    ds_read2_b32 v[74:75], v237 offset0:2 offset1:3
    ds_read2_b32 v[76:77], v237 offset0:128 offset1:129
    ds_read2_b32 v[78:79], v237 offset0:130 offset1:131
    ds_read2_b32 v[80:81], v238 offset0:0 offset1:1
    ds_read2_b32 v[82:83], v238 offset0:2 offset1:3
    ds_read2_b32 v[84:85], v238 offset0:128 offset1:129
    ds_read2_b32 v[86:87], v238 offset0:130 offset1:131
    ds_read2_b32 v[88:89], v239 offset0:0 offset1:1
    ds_read2_b32 v[90:91], v239 offset0:2 offset1:3
    ds_read2_b32 v[92:93], v239 offset0:128 offset1:129
    ds_read2_b32 v[94:95], v239 offset0:130 offset1:131
    buffer_load_dword v29, v28, s[44:47], 0 offen sc1
    s_waitcnt vmcnt(1)
    v_lshl_or_b32 v9, v9, 16, v9
    v_and_b32 v248, v9, v208
    v_and_b32 v249, v9, v209
L_pl_X_1:
    s_cbranch_execz L_pl_X_5
    v_and_b32 v250, v9, v210
    v_and_b32 v251, v9, v211
    v_add_u32 v10, 131072, v10
    v_add_u32 v11, 131072, v11
    v_add_u32 v12, 131072, v12
    v_add_u32 v13, 131072, v13
    s_waitcnt vmcnt(0)
    v_cmp_ne_u32 vcc, s68, v29
    s_cbranch_vccnz L_rs_p1X
L_ok_p1X:
    s_barrier
    s_add_u32 m0, s9, 0
    s_add_u32 s13, s7, 0
    buffer_load_dwordx4 v24, s[44:47], s13 offen sc1 lds
    s_add_u32 m0, s9, 1024
    s_add_u32 s13, s7, 73728
    buffer_load_dwordx4 v25, s[44:47], s13 offen sc1 lds
    s_add_u32 m0, s9, 2048
    s_add_u32 s13, s7, 147456
    buffer_load_dwordx4 v24, s[44:47], s13 offen sc1 lds
    s_add_u32 m0, s9, 3072
    s_add_u32 s13, s7, 221184
    buffer_load_dwordx4 v25, s[44:47], s13 offen sc1 lds
    s_add_u32 m0, s9, 4096
    s_add_u32 s13, s7, 294912
    buffer_load_dwordx4 v24, s[44:47], s13 offen sc1 lds
    s_add_u32 m0, s9, 5120
    s_add_u32 s13, s7, 368640
    buffer_load_dwordx4 v25, s[44:47], s13 offen sc1 lds
    s_add_u32 m0, s9, 6144
    s_add_u32 s13, s7, 442368
    buffer_load_dwordx4 v24, s[44:47], s13 offen sc1 lds
    s_add_u32 m0, s9, 7168
    s_add_u32 s13, s7, 516096
    buffer_load_dwordx4 v25, s[44:47], s13 offen sc1 lds
    s_waitcnt vmcnt(0) lgkmcnt(0)
    s_barrier
    ds_read_b128 v[96:99], v244 offset:2048
    ds_read_b128 v[100:103], v244 offset:6144
    ds_read_b128 v[104:107], v244 offset:10240
    ds_read_b128 v[108:111], v244 offset:14336
    ds_read_b128 v[112:115], v244 offset:18432
    ds_read_b128 v[116:119], v244 offset:22528
    ds_read_b128 v[120:123], v244 offset:26624
    ds_read_b128 v[124:127], v244 offset:30720
    s_waitcnt lgkmcnt(0)
    v_mfma_f32_16x16x32_bf16 v[32:35], v[248:251], v[96:99], 0
    s_lshl_b32 s14, s84, 17
    v_mfma_f32_16x16x32_bf16 v[32:35], v[64:67], v[96:99], v[32:35]
    s_add_u32 m0, s73, 147456
    v_mfma_f32_16x16x32_bf16 v[36:39], v[248:251], v[100:103], 0
    buffer_load_dwordx4 v4, s[52:55], s14 offen offset:0 lds
    v_mfma_f32_16x16x32_bf16 v[36:39], v[68:71], v[96:99], v[36:39]
    ds_read_b128 v[160:163], v245 offset:2048
    v_mfma_f32_16x16x32_bf16 v[36:39], v[64:67], v[100:103], v[36:39]
    ds_read2_b32 v[128:129], v236 offset0:16 offset1:17
    v_mfma_f32_16x16x32_bf16 v[40:43], v[248:251], v[104:107], 0
    ds_read2_b32 v[130:131], v236 offset0:18 offset1:19
    v_mfma_f32_16x16x32_bf16 v[40:43], v[64:67], v[104:107], v[40:43]
    ds_read_b128 v[164:167], v245 offset:6144
    v_mfma_f32_16x16x32_bf16 v[40:43], v[68:71], v[100:103], v[40:43]
    v_mfma_f32_16x16x32_bf16 v[40:43], v[72:75], v[96:99], v[40:43]
    ds_read2_b32 v[132:133], v236 offset0:144 offset1:145
    v_mfma_f32_16x16x32_bf16 v[44:47], v[248:251], v[108:111], 0
    ds_read2_b32 v[134:135], v236 offset0:146 offset1:147
    v_mfma_f32_16x16x32_bf16 v[44:47], v[76:79], v[96:99], v[44:47]
    v_mfma_f32_16x16x32_bf16 v[44:47], v[72:75], v[100:103], v[44:47]
    ds_read_b128 v[168:171], v245 offset:10240
    v_mfma_f32_16x16x32_bf16 v[44:47], v[68:71], v[104:107], v[44:47]
    ds_read2_b32 v[136:137], v237 offset0:16 offset1:17
    v_mfma_f32_16x16x32_bf16 v[44:47], v[64:67], v[108:111], v[44:47]
    v_mfma_f32_16x16x32_bf16 v[48:51], v[248:251], v[112:115], 0
    v_mfma_f32_16x16x32_bf16 v[48:51], v[64:67], v[112:115], v[48:51]
    ds_read2_b32 v[138:139], v237 offset0:18 offset1:19
    v_mfma_f32_16x16x32_bf16 v[48:51], v[68:71], v[108:111], v[48:51]
    v_mfma_f32_16x16x32_bf16 v[48:51], v[72:75], v[104:107], v[48:51]
    ds_read_b128 v[172:175], v245 offset:14336
    v_mfma_f32_16x16x32_bf16 v[48:51], v[76:79], v[100:103], v[48:51]
    ds_read2_b32 v[140:141], v237 offset0:144 offset1:145
    v_mfma_f32_16x16x32_bf16 v[48:51], v[80:83], v[96:99], v[48:51]
    v_mfma_f32_16x16x32_bf16 v[52:55], v[248:251], v[116:119], 0
    ds_read2_b32 v[142:143], v237 offset0:146 offset1:147
    v_mfma_f32_16x16x32_bf16 v[52:55], v[84:87], v[96:99], v[52:55]
    v_mfma_f32_16x16x32_bf16 v[52:55], v[80:83], v[100:103], v[52:55]
    ds_read_b128 v[176:179], v245 offset:18432
    v_mfma_f32_16x16x32_bf16 v[52:55], v[76:79], v[104:107], v[52:55]
    s_add_u32 m0, s73, 147456
    v_mfma_f32_16x16x32_bf16 v[52:55], v[72:75], v[108:111], v[52:55]
    buffer_load_dwordx4 v5, s[52:55], s14 offen offset:1024 lds
    v_mfma_f32_16x16x32_bf16 v[52:55], v[68:71], v[112:115], v[52:55]
    ds_read2_b32 v[144:145], v238 offset0:16 offset1:17
    v_mfma_f32_16x16x32_bf16 v[52:55], v[64:67], v[116:119], v[52:55]
    ds_read2_b32 v[146:147], v238 offset0:18 offset1:19
    v_mfma_f32_16x16x32_bf16 v[56:59], v[248:251], v[120:123], 0
    ds_read_b128 v[180:183], v245 offset:22528
    v_mfma_f32_16x16x32_bf16 v[56:59], v[64:67], v[120:123], v[56:59]
    v_mfma_f32_16x16x32_bf16 v[56:59], v[68:71], v[116:119], v[56:59]
    ds_read2_b32 v[148:149], v238 offset0:144 offset1:145
    v_mfma_f32_16x16x32_bf16 v[56:59], v[72:75], v[112:115], v[56:59]
    v_mfma_f32_16x16x32_bf16 v[56:59], v[76:79], v[108:111], v[56:59]
    ds_read2_b32 v[150:151], v238 offset0:146 offset1:147
    v_mfma_f32_16x16x32_bf16 v[56:59], v[80:83], v[104:107], v[56:59]
    v_mfma_f32_16x16x32_bf16 v[56:59], v[84:87], v[100:103], v[56:59]
    ds_read_b128 v[184:187], v245 offset:26624
    v_mfma_f32_16x16x32_bf16 v[56:59], v[88:91], v[96:99], v[56:59]
    ds_read2_b32 v[152:153], v239 offset0:16 offset1:17
    v_mfma_f32_16x16x32_bf16 v[60:63], v[248:251], v[124:127], 0
    v_mfma_f32_16x16x32_bf16 v[60:63], v[92:95], v[96:99], v[60:63]
    ds_read2_b32 v[154:155], v239 offset0:18 offset1:19
    v_mfma_f32_16x16x32_bf16 v[60:63], v[88:91], v[100:103], v[60:63]
    v_mfma_f32_16x16x32_bf16 v[60:63], v[84:87], v[104:107], v[60:63]
    ds_read_b128 v[188:191], v245 offset:30720
    v_mfma_f32_16x16x32_bf16 v[60:63], v[80:83], v[108:111], v[60:63]
    v_mfma_f32_16x16x32_bf16 v[60:63], v[76:79], v[112:115], v[60:63]
    ds_read2_b32 v[156:157], v239 offset0:144 offset1:145
    v_mfma_f32_16x16x32_bf16 v[60:63], v[72:75], v[116:119], v[60:63]
    v_mfma_f32_16x16x32_bf16 v[60:63], v[68:71], v[120:123], v[60:63]
    ds_read2_b32 v[158:159], v239 offset0:146 offset1:147
    v_mfma_f32_16x16x32_bf16 v[60:63], v[64:67], v[124:127], v[60:63]
    s_waitcnt lgkmcnt(12)
    v_mfma_f32_16x16x32_bf16 v[32:35], v[128:131], v[160:163], v[32:35]
    ds_read_b128 v[96:99], v246 offset:2048
    v_mfma_f32_16x16x32_bf16 v[36:39], v[132:135], v[160:163], v[36:39]
    s_add_u32 m0, s73, 147456
    ds_read2_b32 v[64:65], v236 offset0:32 offset1:33
    v_mfma_f32_16x16x32_bf16 v[36:39], v[128:131], v[164:167], v[36:39]
    buffer_load_dwordx4 v6, s[52:55], s14 offen offset:2048 lds
    v_mfma_f32_16x16x32_bf16 v[40:43], v[128:131], v[168:171], v[40:43]
    s_add_u32 s13, s12, 16384
    ds_read2_b32 v[66:67], v236 offset0:34 offset1:35
    v_mfma_f32_16x16x32_bf16 v[40:43], v[132:135], v[164:167], v[40:43]
    ds_read_b128 v[100:103], v246 offset:6144
    v_mfma_f32_16x16x32_bf16 v[40:43], v[136:139], v[160:163], v[40:43]
    s_add_u32 m0, s74, 8352
    v_mfma_f32_16x16x32_bf16 v[44:47], v[140:143], v[160:163], v[44:47]
    buffer_load_dwordx4 v240, s[48:51], s13 offen offset:0 lds
    v_mfma_f32_16x16x32_bf16 v[44:47], v[136:139], v[164:167], v[44:47]
    ds_read2_b32 v[68:69], v236 offset0:160 offset1:161
    v_mfma_f32_16x16x32_bf16 v[44:47], v[132:135], v[168:171], v[44:47]
    ds_read2_b32 v[70:71], v236 offset0:162 offset1:163
    v_mfma_f32_16x16x32_bf16 v[44:47], v[128:131], v[172:175], v[44:47]
    s_waitcnt lgkmcnt(6)
    v_mfma_f32_16x16x32_bf16 v[48:51], v[128:131], v[176:179], v[48:51]
    ds_read_b128 v[104:107], v246 offset:10240
    v_mfma_f32_16x16x32_bf16 v[48:51], v[132:135], v[172:175], v[48:51]
    ds_read2_b32 v[72:73], v237 offset0:32 offset1:33
    v_mfma_f32_16x16x32_bf16 v[48:51], v[136:139], v[168:171], v[48:51]
    ds_read2_b32 v[74:75], v237 offset0:34 offset1:35
    v_mfma_f32_16x16x32_bf16 v[48:51], v[140:143], v[164:167], v[48:51]
    s_add_u32 m0, s74, 8352
    ds_read_b128 v[108:111], v246 offset:14336
    v_mfma_f32_16x16x32_bf16 v[48:51], v[144:147], v[160:163], v[48:51]
    buffer_load_dwordx4 v240, s[48:51], s13 offen offset:1024 lds
    v_mfma_f32_16x16x32_bf16 v[52:55], v[148:151], v[160:163], v[52:55]
    ds_read2_b32 v[76:77], v237 offset0:160 offset1:161
    v_mfma_f32_16x16x32_bf16 v[52:55], v[144:147], v[164:167], v[52:55]
    ds_read2_b32 v[78:79], v237 offset0:162 offset1:163
    v_mfma_f32_16x16x32_bf16 v[52:55], v[140:143], v[168:171], v[52:55]
    ds_read_b128 v[112:115], v246 offset:18432
    v_mfma_f32_16x16x32_bf16 v[52:55], v[136:139], v[172:175], v[52:55]
    ds_read2_b32 v[80:81], v238 offset0:32 offset1:33
    v_mfma_f32_16x16x32_bf16 v[52:55], v[132:135], v[176:179], v[52:55]
    s_add_u32 m0, s73, 147456
    v_mfma_f32_16x16x32_bf16 v[52:55], v[128:131], v[180:183], v[52:55]
    buffer_load_dwordx4 v7, s[52:55], s14 offen offset:3072 lds
    v_mfma_f32_16x16x32_bf16 v[56:59], v[128:131], v[184:187], v[56:59]
    s_add_u32 m0, s74, 8352
    v_mfma_f32_16x16x32_bf16 v[56:59], v[132:135], v[180:183], v[56:59]
    buffer_load_dwordx4 v240, s[48:51], s13 offen offset:2048 lds
    v_mfma_f32_16x16x32_bf16 v[56:59], v[136:139], v[176:179], v[56:59]
    ds_read2_b32 v[82:83], v238 offset0:34 offset1:35
    v_mfma_f32_16x16x32_bf16 v[56:59], v[140:143], v[172:175], v[56:59]
    ds_read_b128 v[116:119], v246 offset:22528
    v_mfma_f32_16x16x32_bf16 v[56:59], v[144:147], v[168:171], v[56:59]
    ds_read2_b32 v[84:85], v238 offset0:160 offset1:161
    v_mfma_f32_16x16x32_bf16 v[56:59], v[148:151], v[164:167], v[56:59]
    ds_read2_b32 v[86:87], v238 offset0:162 offset1:163
    v_mfma_f32_16x16x32_bf16 v[56:59], v[152:155], v[160:163], v[56:59]
    ds_read_b128 v[120:123], v246 offset:26624
    v_mfma_f32_16x16x32_bf16 v[60:63], v[156:159], v[160:163], v[60:63]
    ds_read2_b32 v[88:89], v239 offset0:32 offset1:33
    v_mfma_f32_16x16x32_bf16 v[60:63], v[152:155], v[164:167], v[60:63]
    s_add_u32 m0, s74, 8352
    v_mfma_f32_16x16x32_bf16 v[60:63], v[148:151], v[168:171], v[60:63]
    buffer_load_dwordx4 v240, s[48:51], s13 offen offset:3072 lds
    v_mfma_f32_16x16x32_bf16 v[60:63], v[144:147], v[172:175], v[60:63]
    ds_read2_b32 v[90:91], v239 offset0:34 offset1:35
    v_mfma_f32_16x16x32_bf16 v[60:63], v[140:143], v[176:179], v[60:63]
    ds_read_b128 v[124:127], v246 offset:30720
    v_mfma_f32_16x16x32_bf16 v[60:63], v[136:139], v[180:183], v[60:63]
    ds_read2_b32 v[92:93], v239 offset0:160 offset1:161
    v_mfma_f32_16x16x32_bf16 v[60:63], v[132:135], v[184:187], v[60:63]
    ds_read2_b32 v[94:95], v239 offset0:162 offset1:163
    v_mfma_f32_16x16x32_bf16 v[60:63], v[128:131], v[188:191], v[60:63]
    s_waitcnt lgkmcnt(12)
    v_mfma_f32_16x16x32_bf16 v[32:35], v[64:67], v[96:99], v[32:35]
    s_lshl_b32 s14, s85, 17
    v_mfma_f32_16x16x32_bf16 v[36:39], v[68:71], v[96:99], v[36:39]
    s_add_u32 m0, s73, 49152
    v_mfma_f32_16x16x32_bf16 v[36:39], v[64:67], v[100:103], v[36:39]
    buffer_load_dwordx4 v4, s[52:55], s14 offen offset:0 lds
    v_mfma_f32_16x16x32_bf16 v[40:43], v[64:67], v[104:107], v[40:43]
    ds_read_b128 v[160:163], v247 offset:2048
    v_mfma_f32_16x16x32_bf16 v[40:43], v[68:71], v[100:103], v[40:43]
    ds_read2_b32 v[128:129], v236 offset0:48 offset1:49
    v_mfma_f32_16x16x32_bf16 v[40:43], v[72:75], v[96:99], v[40:43]
    ds_read2_b32 v[130:131], v236 offset0:50 offset1:51
    v_mfma_f32_16x16x32_bf16 v[44:47], v[76:79], v[96:99], v[44:47]
    ds_read_b128 v[164:167], v247 offset:6144
    v_mfma_f32_16x16x32_bf16 v[44:47], v[72:75], v[100:103], v[44:47]
    ds_read2_b32 v[132:133], v236 offset0:176 offset1:177
    v_mfma_f32_16x16x32_bf16 v[44:47], v[68:71], v[104:107], v[44:47]
    ds_read2_b32 v[134:135], v236 offset0:178 offset1:179
    v_mfma_f32_16x16x32_bf16 v[44:47], v[64:67], v[108:111], v[44:47]
    v_mov_b32 v9, 8
    buffer_load_ushort v9, v9, s[56:59], s70 offen
    s_waitcnt lgkmcnt(6)
    v_mfma_f32_16x16x32_bf16 v[48:51], v[64:67], v[112:115], v[48:51]
    ds_read_b128 v[168:171], v247 offset:10240
    v_mfma_f32_16x16x32_bf16 v[48:51], v[68:71], v[108:111], v[48:51]
    ds_read2_b32 v[136:137], v237 offset0:48 offset1:49
    v_mfma_f32_16x16x32_bf16 v[48:51], v[72:75], v[104:107], v[48:51]
    ds_read2_b32 v[138:139], v237 offset0:50 offset1:51
    v_mfma_f32_16x16x32_bf16 v[48:51], v[76:79], v[100:103], v[48:51]
    ds_read_b128 v[172:175], v247 offset:14336
    v_mfma_f32_16x16x32_bf16 v[48:51], v[80:83], v[96:99], v[48:51]
    v_mfma_f32_16x16x32_bf16 v[52:55], v[84:87], v[96:99], v[52:55]
    ds_read2_b32 v[140:141], v237 offset0:176 offset1:177
    v_mfma_f32_16x16x32_bf16 v[52:55], v[80:83], v[100:103], v[52:55]
    ds_read2_b32 v[142:143], v237 offset0:178 offset1:179
    v_mfma_f32_16x16x32_bf16 v[52:55], v[76:79], v[104:107], v[52:55]
    ds_read_b128 v[176:179], v247 offset:18432
    v_mfma_f32_16x16x32_bf16 v[52:55], v[72:75], v[108:111], v[52:55]
    ds_read2_b32 v[144:145], v238 offset0:48 offset1:49
    v_mfma_f32_16x16x32_bf16 v[52:55], v[68:71], v[112:115], v[52:55]
    s_add_u32 m0, s73, 49152
    v_mfma_f32_16x16x32_bf16 v[52:55], v[64:67], v[116:119], v[52:55]
    buffer_load_dwordx4 v5, s[52:55], s14 offen offset:1024 lds
    v_mfma_f32_16x16x32_bf16 v[56:59], v[64:67], v[120:123], v[56:59]
    ds_read2_b32 v[146:147], v238 offset0:50 offset1:51
    v_mfma_f32_16x16x32_bf16 v[56:59], v[68:71], v[116:119], v[56:59]
    ds_read_b128 v[180:183], v247 offset:22528
    v_mfma_f32_16x16x32_bf16 v[56:59], v[72:75], v[112:115], v[56:59]
    v_mfma_f32_16x16x32_bf16 v[56:59], v[76:79], v[108:111], v[56:59]
    ds_read2_b32 v[148:149], v238 offset0:176 offset1:177
    v_mfma_f32_16x16x32_bf16 v[56:59], v[80:83], v[104:107], v[56:59]
    ds_read2_b32 v[150:151], v238 offset0:178 offset1:179
    v_mfma_f32_16x16x32_bf16 v[56:59], v[84:87], v[100:103], v[56:59]
    ds_read_b128 v[184:187], v247 offset:26624
    v_mfma_f32_16x16x32_bf16 v[56:59], v[88:91], v[96:99], v[56:59]
    v_mfma_f32_16x16x32_bf16 v[60:63], v[92:95], v[96:99], v[60:63]
    ds_read2_b32 v[152:153], v239 offset0:48 offset1:49
    v_mfma_f32_16x16x32_bf16 v[60:63], v[88:91], v[100:103], v[60:63]
    ds_read2_b32 v[154:155], v239 offset0:50 offset1:51
    v_mfma_f32_16x16x32_bf16 v[60:63], v[84:87], v[104:107], v[60:63]
    v_mfma_f32_16x16x32_bf16 v[60:63], v[80:83], v[108:111], v[60:63]
    ds_read_b128 v[188:191], v247 offset:30720
    v_mfma_f32_16x16x32_bf16 v[60:63], v[76:79], v[112:115], v[60:63]
    ds_read2_b32 v[156:157], v239 offset0:176 offset1:177
    v_mfma_f32_16x16x32_bf16 v[60:63], v[72:75], v[116:119], v[60:63]
    v_mfma_f32_16x16x32_bf16 v[60:63], v[68:71], v[120:123], v[60:63]
    ds_read2_b32 v[158:159], v239 offset0:178 offset1:179
    v_mfma_f32_16x16x32_bf16 v[60:63], v[64:67], v[124:127], v[60:63]
    s_waitcnt lgkmcnt(12)
    v_mfma_f32_16x16x32_bf16 v[32:35], v[128:131], v[160:163], v[32:35]
    ds_read_b128 v[96:99], v244 offset:0
    v_mfma_f32_16x16x32_bf16 v[36:39], v[132:135], v[160:163], v[36:39]
    s_add_u32 m0, s73, 49152
    v_mfma_f32_16x16x32_bf16 v[36:39], v[128:131], v[164:167], v[36:39]
    buffer_load_dwordx4 v6, s[52:55], s14 offen offset:2048 lds
    v_mfma_f32_16x16x32_bf16 v[40:43], v[128:131], v[168:171], v[40:43]
    ds_read2_b32 v[64:65], v236 offset0:64 offset1:65
    v_mfma_f32_16x16x32_bf16 v[40:43], v[132:135], v[164:167], v[40:43]
    ds_read2_b32 v[66:67], v236 offset0:66 offset1:67
    v_mfma_f32_16x16x32_bf16 v[40:43], v[136:139], v[160:163], v[40:43]
    ds_read_b128 v[100:103], v244 offset:4096
    v_mfma_f32_16x16x32_bf16 v[44:47], v[140:143], v[160:163], v[44:47]
    ds_read2_b32 v[68:69], v236 offset0:192 offset1:193
    v_mfma_f32_16x16x32_bf16 v[44:47], v[136:139], v[164:167], v[44:47]
    ds_read2_b32 v[70:71], v236 offset0:194 offset1:195
    v_mfma_f32_16x16x32_bf16 v[44:47], v[132:135], v[168:171], v[44:47]
    ds_read_b128 v[104:107], v244 offset:8192
    v_mfma_f32_16x16x32_bf16 v[44:47], v[128:131], v[172:175], v[44:47]
    s_waitcnt lgkmcnt(7)
    v_mfma_f32_16x16x32_bf16 v[48:51], v[128:131], v[176:179], v[48:51]
    ds_read2_b32 v[72:73], v237 offset0:64 offset1:65
    v_mfma_f32_16x16x32_bf16 v[48:51], v[132:135], v[172:175], v[48:51]
    ds_read2_b32 v[74:75], v237 offset0:66 offset1:67
    v_mfma_f32_16x16x32_bf16 v[48:51], v[136:139], v[168:171], v[48:51]
    ds_read_b128 v[108:111], v244 offset:12288
    v_mfma_f32_16x16x32_bf16 v[48:51], v[140:143], v[164:167], v[48:51]
    ds_read2_b32 v[76:77], v237 offset0:192 offset1:193
    v_mfma_f32_16x16x32_bf16 v[48:51], v[144:147], v[160:163], v[48:51]
    ds_read2_b32 v[78:79], v237 offset0:194 offset1:195
    v_mfma_f32_16x16x32_bf16 v[52:55], v[148:151], v[160:163], v[52:55]
    ds_read_b128 v[112:115], v244 offset:16384
    v_mfma_f32_16x16x32_bf16 v[52:55], v[144:147], v[164:167], v[52:55]
    s_waitcnt vmcnt(4)
    ds_read2_b32 v[80:81], v238 offset0:64 offset1:65
    v_mfma_f32_16x16x32_bf16 v[52:55], v[140:143], v[168:171], v[52:55]
    ds_read_b128 v[212:215], v241 offset:8352
    v_mfma_f32_16x16x32_bf16 v[52:55], v[136:139], v[172:175], v[52:55]
    ds_read_b32 v216, v241 offset:8368
    v_mfma_f32_16x16x32_bf16 v[52:55], v[132:135], v[176:179], v[52:55]
    s_add_u32 m0, s73, 49152
    ds_read2_b32 v[82:83], v238 offset0:66 offset1:67
    v_mfma_f32_16x16x32_bf16 v[52:55], v[128:131], v[180:183], v[52:55]
    buffer_load_dwordx4 v7, s[52:55], s14 offen offset:3072 lds
    v_mfma_f32_16x16x32_bf16 v[56:59], v[128:131], v[184:187], v[56:59]
    ds_read_b128 v[116:119], v244 offset:20480
    v_mfma_f32_16x16x32_bf16 v[56:59], v[132:135], v[180:183], v[56:59]
    ds_read_b128 v[218:221], v241 offset:9376
    v_mfma_f32_16x16x32_bf16 v[56:59], v[136:139], v[176:179], v[56:59]
    ds_read_b64_tr_b16 a[0:1], v10 offset:16384
    v_mfma_f32_16x16x32_bf16 v[56:59], v[140:143], v[172:175], v[56:59]
    ds_read_b64_tr_b16 a[2:3], v10 offset:18432
    ds_read2_b32 v[84:85], v238 offset0:192 offset1:193
    v_mfma_f32_16x16x32_bf16 v[56:59], v[144:147], v[168:171], v[56:59]
    ds_read_b64_tr_b16 a[4:5], v11 offset:16384
    ds_read2_b32 v[86:87], v238 offset0:194 offset1:195
    v_mfma_f32_16x16x32_bf16 v[56:59], v[148:151], v[164:167], v[56:59]
    ds_read_b32 v222, v241 offset:9392
    ds_read_b128 v[120:123], v244 offset:24576
    v_mfma_f32_16x16x32_bf16 v[56:59], v[152:155], v[160:163], v[56:59]
    ds_read_b64_tr_b16 a[6:7], v11 offset:18432
    v_mfma_f32_16x16x32_bf16 v[60:63], v[156:159], v[160:163], v[60:63]
    ds_read_b64_tr_b16 a[8:9], v12 offset:16384
    ds_read2_b32 v[88:89], v239 offset0:64 offset1:65
    v_mfma_f32_16x16x32_bf16 v[60:63], v[152:155], v[164:167], v[60:63]
    ds_read_b128 v[224:227], v241 offset:10400
    ds_read2_b32 v[90:91], v239 offset0:66 offset1:67
    v_mfma_f32_16x16x32_bf16 v[60:63], v[148:151], v[168:171], v[60:63]
    ds_read_b64_tr_b16 a[10:11], v12 offset:18432
    v_mfma_f32_16x16x32_bf16 v[60:63], v[144:147], v[172:175], v[60:63]
    ds_read_b64_tr_b16 a[12:13], v13 offset:16384
    ds_read_b128 v[124:127], v244 offset:28672
    v_mfma_f32_16x16x32_bf16 v[60:63], v[140:143], v[176:179], v[60:63]
    ds_read_b32 v228, v241 offset:10416
    ds_read2_b32 v[92:93], v239 offset0:192 offset1:193
    v_mfma_f32_16x16x32_bf16 v[60:63], v[136:139], v[180:183], v[60:63]
    ds_read_b64_tr_b16 a[14:15], v13 offset:18432
    v_mfma_f32_16x16x32_bf16 v[60:63], v[132:135], v[184:187], v[60:63]
    ds_read_b128 v[230:233], v241 offset:11424
    ds_read2_b32 v[94:95], v239 offset0:194 offset1:195
    v_mfma_f32_16x16x32_bf16 v[60:63], v[128:131], v[188:191], v[60:63]
    ds_read_b32 v234, v241 offset:11440
    s_waitcnt lgkmcnt(15)
    v_mfma_f32_16x16x32_bf16 v[32:35], v[64:67], v[96:99], v[32:35]
    s_waitcnt lgkmcnt(3)
    s_lshl_b32 s14, s86, 17
    v_mfma_f32_16x16x32_bf16 v[36:39], v[68:71], v[96:99], v[36:39]
    s_add_u32 m0, s73, 147456
    ds_read_b128 v[160:163], v245 offset:0
    v_mfma_f32_16x16x32_bf16 v[36:39], v[64:67], v[100:103], v[36:39]
    buffer_load_dwordx4 v4, s[52:55], s14 offen offset:0 lds
    v_mfma_f32_16x16x32_bf16 v[40:43], v[64:67], v[104:107], v[40:43]
    ds_read2_b32 v[128:129], v236 offset0:80 offset1:81
    v_mfma_f32_16x16x32_bf16 v[40:43], v[68:71], v[100:103], v[40:43]
    ds_read2_b32 v[130:131], v236 offset0:82 offset1:83
    v_mfma_f32_16x16x32_bf16 v[40:43], v[72:75], v[96:99], v[40:43]
    s_waitcnt lgkmcnt(3)
    ds_read_b128 v[164:167], v245 offset:4096
    v_mfma_f32_16x16x32_bf16 v[44:47], v[76:79], v[96:99], v[44:47]
    ds_read2_b32 v[132:133], v236 offset0:208 offset1:209
    v_mfma_f32_16x16x32_bf16 v[44:47], v[72:75], v[100:103], v[44:47]
    ds_read2_b32 v[134:135], v236 offset0:210 offset1:211
    v_mfma_f32_16x16x32_bf16 v[44:47], v[68:71], v[104:107], v[44:47]
    ds_write_b16 v242, v212 offset:12480
    v_mfma_f32_16x16x32_bf16 v[44:47], v[64:67], v[108:111], v[44:47]
    ds_read_b128 v[168:171], v245 offset:8192
    v_mfma_f32_16x16x32_bf16 v[48:51], v[64:67], v[112:115], v[48:51]
    v_alignbit_b32 v212, v213, v212, 16
    v_mfma_f32_16x16x32_bf16 v[48:51], v[68:71], v[108:111], v[48:51]
    ds_read2_b32 v[136:137], v237 offset0:80 offset1:81
    v_mfma_f32_16x16x32_bf16 v[48:51], v[72:75], v[104:107], v[48:51]
    ds_read2_b32 v[138:139], v237 offset0:82 offset1:83
    v_mfma_f32_16x16x32_bf16 v[48:51], v[76:79], v[100:103], v[48:51]
    v_alignbit_b32 v213, v214, v213, 16
    v_mfma_f32_16x16x32_bf16 v[48:51], v[80:83], v[96:99], v[48:51]
    ds_read_b128 v[172:175], v245 offset:12288
    v_mfma_f32_16x16x32_bf16 v[52:55], v[84:87], v[96:99], v[52:55]
    ds_read2_b32 v[140:141], v237 offset0:208 offset1:209
    v_mfma_f32_16x16x32_bf16 v[52:55], v[80:83], v[100:103], v[52:55]
    v_alignbit_b32 v214, v215, v214, 16
    v_mfma_f32_16x16x32_bf16 v[52:55], v[76:79], v[104:107], v[52:55]
    ds_read2_b32 v[142:143], v237 offset0:210 offset1:211
    v_mfma_f32_16x16x32_bf16 v[52:55], v[72:75], v[108:111], v[52:55]
    v_alignbit_b32 v215, v216, v215, 16
    ds_read_b128 v[176:179], v245 offset:16384
    v_mfma_f32_16x16x32_bf16 v[52:55], v[68:71], v[112:115], v[52:55]
    s_add_u32 m0, s73, 147456
    ds_read2_b32 v[144:145], v238 offset0:80 offset1:81
    v_mfma_f32_16x16x32_bf16 v[52:55], v[64:67], v[116:119], v[52:55]
    buffer_load_dwordx4 v5, s[52:55], s14 offen offset:1024 lds
    v_mfma_f32_16x16x32_bf16 v[56:59], v[64:67], v[120:123], v[56:59]
    ds_write_b128 v241, v[212:215] offset:12512
    v_mfma_f32_16x16x32_bf16 v[56:59], v[68:71], v[116:119], v[56:59]
    ds_read2_b32 v[146:147], v238 offset0:82 offset1:83
    v_mfma_f32_16x16x32_bf16 v[56:59], v[72:75], v[112:115], v[56:59]
    ds_read_b128 v[180:183], v245 offset:20480
    v_mfma_f32_16x16x32_bf16 v[56:59], v[76:79], v[108:111], v[56:59]
    v_alignbit_b32 v218, v219, v218, 16
    ds_read2_b32 v[148:149], v238 offset0:208 offset1:209
    v_mfma_f32_16x16x32_bf16 v[56:59], v[80:83], v[104:107], v[56:59]
    ds_read2_b32 v[150:151], v238 offset0:210 offset1:211
    v_mfma_f32_16x16x32_bf16 v[56:59], v[84:87], v[100:103], v[56:59]
    v_alignbit_b32 v219, v220, v219, 16
    v_mfma_f32_16x16x32_bf16 v[56:59], v[88:91], v[96:99], v[56:59]
    ds_read_b128 v[184:187], v245 offset:24576
    v_mfma_f32_16x16x32_bf16 v[60:63], v[92:95], v[96:99], v[60:63]
    ds_read2_b32 v[152:153], v239 offset0:80 offset1:81
    v_mfma_f32_16x16x32_bf16 v[60:63], v[88:91], v[100:103], v[60:63]
    v_alignbit_b32 v220, v221, v220, 16
    v_mfma_f32_16x16x32_bf16 v[60:63], v[84:87], v[104:107], v[60:63]
    ds_read2_b32 v[154:155], v239 offset0:82 offset1:83
    v_mfma_f32_16x16x32_bf16 v[60:63], v[80:83], v[108:111], v[60:63]
    ds_read_b128 v[188:191], v245 offset:28672
    v_mfma_f32_16x16x32_bf16 v[60:63], v[76:79], v[112:115], v[60:63]
    v_alignbit_b32 v221, v222, v221, 16
    ds_read2_b32 v[156:157], v239 offset0:208 offset1:209
    v_mfma_f32_16x16x32_bf16 v[60:63], v[72:75], v[116:119], v[60:63]
    ds_read2_b32 v[158:159], v239 offset0:210 offset1:211
    v_mfma_f32_16x16x32_bf16 v[60:63], v[68:71], v[120:123], v[60:63]
    ds_write_b128 v241, v[218:221] offset:13536
    v_mfma_f32_16x16x32_bf16 v[60:63], v[64:67], v[124:127], v[60:63]
    s_waitcnt lgkmcnt(14)
    v_mfma_f32_16x16x32_bf16 v[32:35], v[128:131], v[160:163], v[32:35]
    v_alignbit_b32 v224, v225, v224, 16
    ds_read_b128 v[96:99], v246 offset:0
    v_mfma_f32_16x16x32_bf16 v[36:39], v[132:135], v[160:163], v[36:39]
    s_add_u32 m0, s73, 147456
    ds_read2_b32 v[64:65], v236 offset0:96 offset1:97
    v_mfma_f32_16x16x32_bf16 v[36:39], v[128:131], v[164:167], v[36:39]
    buffer_load_dwordx4 v6, s[52:55], s14 offen offset:2048 lds
    v_mfma_f32_16x16x32_bf16 v[40:43], v[128:131], v[168:171], v[40:43]
    v_alignbit_b32 v225, v226, v225, 16
    ds_read2_b32 v[66:67], v236 offset0:98 offset1:99
    v_mfma_f32_16x16x32_bf16 v[40:43], v[132:135], v[164:167], v[40:43]
    ds_read_b128 v[100:103], v246 offset:4096
    v_mfma_f32_16x16x32_bf16 v[40:43], v[136:139], v[160:163], v[40:43]
    v_alignbit_b32 v226, v227, v226, 16
    v_mfma_f32_16x16x32_bf16 v[44:47], v[140:143], v[160:163], v[44:47]
    ds_read2_b32 v[68:69], v236 offset0:224 offset1:225
    v_mfma_f32_16x16x32_bf16 v[44:47], v[136:139], v[164:167], v[44:47]
    v_alignbit_b32 v227, v228, v227, 16
    ds_read2_b32 v[70:71], v236 offset0:226 offset1:227
    v_mfma_f32_16x16x32_bf16 v[44:47], v[132:135], v[168:171], v[44:47]
    ds_read_b128 v[104:107], v246 offset:8192
    v_mfma_f32_16x16x32_bf16 v[44:47], v[128:131], v[172:175], v[44:47]
    ds_read2_b32 v[72:73], v237 offset0:96 offset1:97
    s_waitcnt lgkmcnt(9)
    v_mfma_f32_16x16x32_bf16 v[48:51], v[128:131], v[176:179], v[48:51]
    ds_write_b128 v241, v[224:227] offset:14560
    v_mfma_f32_16x16x32_bf16 v[48:51], v[132:135], v[172:175], v[48:51]
    v_alignbit_b32 v230, v231, v230, 16
    ds_read2_b32 v[74:75], v237 offset0:98 offset1:99
    v_mfma_f32_16x16x32_bf16 v[48:51], v[136:139], v[168:171], v[48:51]
    v_alignbit_b32 v231, v232, v231, 16
    ds_read_b128 v[108:111], v246 offset:12288
    v_mfma_f32_16x16x32_bf16 v[48:51], v[140:143], v[164:167], v[48:51]
    v_alignbit_b32 v232, v233, v232, 16
    ds_read2_b32 v[76:77], v237 offset0:224 offset1:225
    v_mfma_f32_16x16x32_bf16 v[48:51], v[144:147], v[160:163], v[48:51]
    v_alignbit_b32 v233, v234, v233, 16
    ds_read2_b32 v[78:79], v237 offset0:226 offset1:227
    v_mfma_f32_16x16x32_bf16 v[52:55], v[148:151], v[160:163], v[52:55]
    ds_write_b128 v241, v[230:233] offset:15584
    v_mfma_f32_16x16x32_bf16 v[52:55], v[144:147], v[164:167], v[52:55]
    s_waitcnt vmcnt(6)
    ds_read_b128 v[112:115], v246 offset:16384
    v_mfma_f32_16x16x32_bf16 v[52:55], v[140:143], v[168:171], v[52:55]
    v_lshl_or_b32 v9, v9, 16, v9
    ds_read2_b32 v[80:81], v238 offset0:96 offset1:97
    v_mfma_f32_16x16x32_bf16 v[52:55], v[136:139], v[172:175], v[52:55]
    v_and_b32 v248, v9, v208
    ds_read2_b32 v[82:83], v238 offset0:98 offset1:99
    v_mfma_f32_16x16x32_bf16 v[52:55], v[132:135], v[176:179], v[52:55]
    s_add_u32 m0, s73, 147456
    ds_read_b128 v[116:119], v246 offset:20480
    v_mfma_f32_16x16x32_bf16 v[52:55], v[128:131], v[180:183], v[52:55]
    buffer_load_dwordx4 v7, s[52:55], s14 offen offset:3072 lds
    v_mfma_f32_16x16x32_bf16 v[56:59], v[128:131], v[184:187], v[56:59]
    s_waitcnt vmcnt(4)
    ds_read2_b32 v[84:85], v238 offset0:224 offset1:225
    v_mfma_f32_16x16x32_bf16 v[56:59], v[132:135], v[180:183], v[56:59]
    v_add_u32 v10, -131072, v10
    ds_read2_b32 v[86:87], v238 offset0:226 offset1:227
    v_mfma_f32_16x16x32_bf16 v[56:59], v[136:139], v[176:179], v[56:59]
    ds_read_b64_tr_b16 a[16:17], v10 offset:49152
    v_mfma_f32_16x16x32_bf16 v[56:59], v[140:143], v[172:175], v[56:59]
    ds_read_b64_tr_b16 a[18:19], v10 offset:51200
    v_mfma_f32_16x16x32_bf16 v[56:59], v[144:147], v[168:171], v[56:59]
    v_add_u32 v11, -131072, v11
    ds_read_b128 v[120:123], v246 offset:24576
    v_mfma_f32_16x16x32_bf16 v[56:59], v[148:151], v[164:167], v[56:59]
    ds_read_b64_tr_b16 a[20:21], v11 offset:49152
    v_mfma_f32_16x16x32_bf16 v[56:59], v[152:155], v[160:163], v[56:59]
    ds_read_b64_tr_b16 a[22:23], v11 offset:51200
    v_mfma_f32_16x16x32_bf16 v[60:63], v[156:159], v[160:163], v[60:63]
    v_add_u32 v12, -131072, v12
    ds_read2_b32 v[88:89], v239 offset0:96 offset1:97
    v_mfma_f32_16x16x32_bf16 v[60:63], v[152:155], v[164:167], v[60:63]
    ds_read_b64_tr_b16 a[24:25], v12 offset:49152
    ds_read2_b32 v[90:91], v239 offset0:98 offset1:99
    v_mfma_f32_16x16x32_bf16 v[60:63], v[148:151], v[168:171], v[60:63]
    ds_read_b64_tr_b16 a[26:27], v12 offset:51200
    ds_read_b128 v[124:127], v246 offset:28672
    v_mfma_f32_16x16x32_bf16 v[60:63], v[144:147], v[172:175], v[60:63]
    v_add_u32 v13, -131072, v13
    v_and_b32 v249, v9, v209
    v_mfma_f32_16x16x32_bf16 v[60:63], v[140:143], v[176:179], v[60:63]
    ds_read_b64_tr_b16 a[28:29], v13 offset:49152
    ds_read2_b32 v[92:93], v239 offset0:224 offset1:225
    v_mfma_f32_16x16x32_bf16 v[60:63], v[136:139], v[180:183], v[60:63]
    ds_read_b64_tr_b16 a[30:31], v13 offset:51200
    ds_read2_b32 v[94:95], v239 offset0:226 offset1:227
    v_mfma_f32_16x16x32_bf16 v[60:63], v[132:135], v[184:187], v[60:63]
    v_and_b32 v250, v9, v210
    v_and_b32 v251, v9, v211
    v_mfma_f32_16x16x32_bf16 v[60:63], v[128:131], v[188:191], v[60:63]
    s_waitcnt lgkmcnt(15)
    v_mfma_f32_16x16x32_bf16 v[32:35], v[64:67], v[96:99], v[32:35]
    s_waitcnt lgkmcnt(1)
    s_lshl_b32 s14, s87, 17
    v_mfma_f32_16x16x32_bf16 v[36:39], v[68:71], v[96:99], v[36:39]
    s_add_u32 m0, s73, 49152
    v_mfma_f32_16x16x32_bf16 v[36:39], v[64:67], v[100:103], v[36:39]
    buffer_load_dwordx4 v4, s[52:55], s14 offen offset:0 lds
    v_mfma_f32_16x16x32_bf16 v[40:43], v[64:67], v[104:107], v[40:43]
    ds_read_b128 v[160:163], v247 offset:0
    v_mfma_f32_16x16x32_bf16 v[40:43], v[68:71], v[100:103], v[40:43]
L_pl_X_2:
    s_cbranch_execz L_pl_X_6
    ds_read_b128 v[164:167], v247 offset:4096
    v_mfma_f32_16x16x32_bf16 v[40:43], v[72:75], v[96:99], v[40:43]
    ds_read_b128 v[168:171], v247 offset:8192
    v_mfma_f32_16x16x32_bf16 v[44:47], v[76:79], v[96:99], v[44:47]
    ds_read_b128 v[172:175], v247 offset:12288
    v_mfma_f32_16x16x32_bf16 v[44:47], v[72:75], v[100:103], v[44:47]
    ds_read_b128 v[176:179], v247 offset:16384
    v_mfma_f32_16x16x32_bf16 v[44:47], v[68:71], v[104:107], v[44:47]
    ds_read_b128 v[180:183], v247 offset:20480
    v_mfma_f32_16x16x32_bf16 v[44:47], v[64:67], v[108:111], v[44:47]
    s_waitcnt lgkmcnt(6)
    v_mfma_f32_16x16x32_bf16 v[48:51], v[64:67], v[112:115], v[48:51]
    ds_read_b128 v[184:187], v247 offset:24576
    v_mfma_f32_16x16x32_bf16 v[48:51], v[68:71], v[108:111], v[48:51]
    ds_read_b128 v[188:191], v247 offset:28672
    v_mfma_f32_16x16x32_bf16 v[48:51], v[72:75], v[104:107], v[48:51]
    ds_read2_b32 v[128:129], v236 offset0:112 offset1:113
    v_mfma_f32_16x16x32_bf16 v[48:51], v[76:79], v[100:103], v[48:51]
    ds_read2_b32 v[130:131], v236 offset0:114 offset1:115
    v_mfma_f32_16x16x32_bf16 v[48:51], v[80:83], v[96:99], v[48:51]
    ds_read2_b32 v[132:133], v236 offset0:240 offset1:241
    v_mfma_f32_16x16x32_bf16 v[52:55], v[84:87], v[96:99], v[52:55]
    ds_read2_b32 v[134:135], v236 offset0:242 offset1:243
    v_mfma_f32_16x16x32_bf16 v[52:55], v[80:83], v[100:103], v[52:55]
    ds_read2_b32 v[136:137], v237 offset0:112 offset1:113
    v_mfma_f32_16x16x32_bf16 v[52:55], v[76:79], v[104:107], v[52:55]
    ds_read2_b32 v[138:139], v237 offset0:114 offset1:115
    v_mfma_f32_16x16x32_bf16 v[52:55], v[72:75], v[108:111], v[52:55]
    s_add_u32 s6, s12, 4718592
    ds_read2_b32 v[140:141], v237 offset0:240 offset1:241
    v_mfma_f32_16x16x32_bf16 v[52:55], v[68:71], v[112:115], v[52:55]
    s_add_u32 m0, s73, 49152
    ds_read2_b32 v[142:143], v237 offset0:242 offset1:243
    v_mfma_f32_16x16x32_bf16 v[52:55], v[64:67], v[116:119], v[52:55]
    buffer_load_dwordx4 v5, s[52:55], s14 offen offset:1024 lds
    v_mfma_f32_16x16x32_bf16 v[56:59], v[64:67], v[120:123], v[56:59]
    v_xor_b32 v244, 64, v244
    ds_read2_b32 v[144:145], v238 offset0:112 offset1:113
    v_mfma_f32_16x16x32_bf16 v[56:59], v[68:71], v[116:119], v[56:59]
    ds_read2_b32 v[146:147], v238 offset0:114 offset1:115
    v_mfma_f32_16x16x32_bf16 v[56:59], v[72:75], v[112:115], v[56:59]
    ds_read2_b32 v[148:149], v238 offset0:240 offset1:241
    v_mfma_f32_16x16x32_bf16 v[56:59], v[76:79], v[108:111], v[56:59]
    v_xor_b32 v245, 64, v245
    ds_read2_b32 v[150:151], v238 offset0:242 offset1:243
    v_mfma_f32_16x16x32_bf16 v[56:59], v[80:83], v[104:107], v[56:59]
    ds_read2_b32 v[152:153], v239 offset0:112 offset1:113
    v_mfma_f32_16x16x32_bf16 v[56:59], v[84:87], v[100:103], v[56:59]
    ds_read2_b32 v[154:155], v239 offset0:114 offset1:115
    v_mfma_f32_16x16x32_bf16 v[56:59], v[88:91], v[96:99], v[56:59]
    ds_read2_b32 v[156:157], v239 offset0:240 offset1:241
    v_mfma_f32_16x16x32_bf16 v[60:63], v[92:95], v[96:99], v[60:63]
    ds_read2_b32 v[158:159], v239 offset0:242 offset1:243
    v_mfma_f32_16x16x32_bf16 v[60:63], v[88:91], v[100:103], v[60:63]
    v_xor_b32 v246, 64, v246
    v_mfma_f32_16x16x32_bf16 v[60:63], v[84:87], v[104:107], v[60:63]
    v_add_u32 v236, 8320, v236
    v_mfma_f32_16x16x32_bf16 v[60:63], v[80:83], v[108:111], v[60:63]
    v_add_u32 v237, 8320, v237
    v_mfma_f32_16x16x32_bf16 v[60:63], v[76:79], v[112:115], v[60:63]
    v_add_u32 v238, 8320, v238
    v_mfma_f32_16x16x32_bf16 v[60:63], v[72:75], v[116:119], v[60:63]
    v_xor_b32 v247, 64, v247
    v_mfma_f32_16x16x32_bf16 v[60:63], v[68:71], v[120:123], v[60:63]
    v_add_u32 v239, 8320, v239
    v_mfma_f32_16x16x32_bf16 v[60:63], v[64:67], v[124:127], v[60:63]
    s_waitcnt lgkmcnt(0)
    v_mfma_f32_16x16x32_bf16 v[60:63], v[128:131], v[188:191], v[60:63]
    ds_read_b128 v[96:99], v244 offset:2048
    v_mfma_f32_16x16x32_bf16 v[60:63], v[132:135], v[184:187], v[60:63]
    s_add_u32 m0, s73, 49152
    ds_read2_b32 v[64:65], v236 offset0:0 offset1:1
    v_mfma_f32_16x16x32_bf16 v[60:63], v[136:139], v[180:183], v[60:63]
    buffer_load_dwordx4 v6, s[52:55], s14 offen offset:2048 lds
    v_mfma_f32_16x16x32_bf16 v[60:63], v[140:143], v[176:179], v[60:63]
    ds_read2_b32 v[66:67], v236 offset0:2 offset1:3
    v_mfma_f32_16x16x32_bf16 v[60:63], v[144:147], v[172:175], v[60:63]
    ds_read_b128 v[100:103], v244 offset:6144
    v_mfma_f32_16x16x32_bf16 v[60:63], v[148:151], v[168:171], v[60:63]
    ds_read2_b32 v[68:69], v236 offset0:128 offset1:129
    v_mfma_f32_16x16x32_bf16 v[60:63], v[152:155], v[164:167], v[60:63]
    ds_read2_b32 v[70:71], v236 offset0:130 offset1:131
    v_mfma_f32_16x16x32_bf16 v[60:63], v[156:159], v[160:163], v[60:63]
    ds_read_b128 v[104:107], v244 offset:10240
    v_mfma_f32_16x16x32_bf16 v[56:59], v[128:131], v[184:187], v[56:59]
    ds_read2_b32 v[72:73], v237 offset0:0 offset1:1
    v_mfma_f32_16x16x32_bf16 v[56:59], v[132:135], v[180:183], v[56:59]
    ds_read2_b32 v[74:75], v237 offset0:2 offset1:3
    v_mfma_f32_16x16x32_bf16 v[56:59], v[136:139], v[176:179], v[56:59]
    ds_read_b128 v[108:111], v244 offset:14336
    v_mfma_f32_16x16x32_bf16 v[56:59], v[140:143], v[172:175], v[56:59]
    ds_read2_b32 v[76:77], v237 offset0:128 offset1:129
    v_mfma_f32_16x16x32_bf16 v[56:59], v[144:147], v[168:171], v[56:59]
    ds_read2_b32 v[78:79], v237 offset0:130 offset1:131
    v_mfma_f32_16x16x32_bf16 v[56:59], v[148:151], v[164:167], v[56:59]
    v_cvt_pk_bf16_f32 v206, v60, v61
    ds_read_b128 v[112:115], v244 offset:18432
    v_mfma_f32_16x16x32_bf16 v[56:59], v[152:155], v[160:163], v[56:59]
    ds_read2_b32 v[80:81], v238 offset0:0 offset1:1
    v_mfma_f32_16x16x32_bf16 v[52:55], v[128:131], v[180:183], v[52:55]
    ds_read2_b32 v[82:83], v238 offset0:2 offset1:3
    ds_read_b128 v[116:119], v244 offset:22528
    v_mfma_f32_16x16x32_bf16 v[52:55], v[132:135], v[176:179], v[52:55]
    v_cvt_pk_bf16_f32 v207, v62, v63
    ds_read2_b32 v[84:85], v238 offset0:128 offset1:129
    v_mfma_f32_16x16x32_bf16 v[52:55], v[136:139], v[172:175], v[52:55]
    ds_read2_b32 v[86:87], v238 offset0:130 offset1:131
    ds_read_b128 v[120:123], v244 offset:26624
    v_mfma_f32_16x16x32_bf16 v[52:55], v[140:143], v[168:171], v[52:55]
    buffer_store_dwordx2 v[206:207], v8, s[44:47], s6 offen offset:3584 sc1
    v_mfma_f32_16x16x32_bf16 v[52:55], v[144:147], v[164:167], v[52:55]
    s_add_u32 m0, s73, 49152
    ds_read2_b32 v[88:89], v239 offset0:0 offset1:1
    v_mfma_f32_16x16x32_bf16 v[52:55], v[148:151], v[160:163], v[52:55]
    buffer_load_dwordx4 v7, s[52:55], s14 offen offset:3072 lds
    v_mfma_f32_16x16x32_bf16 v[48:51], v[128:131], v[176:179], v[48:51]
    s_waitcnt vmcnt(5)
    v_cvt_pk_bf16_f32 v204, v56, v57
    v_mfma_f32_16x16x32_bf16 v[48:51], v[132:135], v[172:175], v[48:51]
    v_add_u32 v10, 131072, v10
    v_cvt_pk_bf16_f32 v205, v58, v59
    v_mfma_f32_16x16x32_bf16 v[48:51], v[136:139], v[168:171], v[48:51]
    ds_read_b64_tr_b16 a[32:33], v10 offset:16384
    ds_read2_b32 v[90:91], v239 offset0:2 offset1:3
    v_mfma_f32_16x16x32_bf16 v[48:51], v[140:143], v[164:167], v[48:51]
    ds_read_b64_tr_b16 a[34:35], v10 offset:18432
    ds_read_b128 v[124:127], v244 offset:30720
    v_mfma_f32_16x16x32_bf16 v[48:51], v[144:147], v[160:163], v[48:51]
    v_add_u32 v11, 131072, v11
    buffer_store_dwordx2 v[204:205], v8, s[44:47], s6 offen offset:3072 sc1
    v_mfma_f32_16x16x32_bf16 v[44:47], v[128:131], v[172:175], v[44:47]
    ds_read_b64_tr_b16 a[36:37], v11 offset:16384
    ds_read2_b32 v[92:93], v239 offset0:128 offset1:129
    v_mfma_f32_16x16x32_bf16 v[44:47], v[132:135], v[168:171], v[44:47]
    ds_read_b64_tr_b16 a[38:39], v11 offset:18432
    ds_read2_b32 v[94:95], v239 offset0:130 offset1:131
    v_mfma_f32_16x16x32_bf16 v[44:47], v[136:139], v[164:167], v[44:47]
    v_add_u32 v12, 131072, v12
    v_cvt_pk_bf16_f32 v202, v52, v53
    v_mfma_f32_16x16x32_bf16 v[44:47], v[140:143], v[160:163], v[44:47]
    ds_read_b64_tr_b16 a[40:41], v12 offset:16384
    v_mfma_f32_16x16x32_bf16 v[40:43], v[128:131], v[168:171], v[40:43]
    ds_read_b64_tr_b16 a[42:43], v12 offset:18432
    v_mfma_f32_16x16x32_bf16 v[40:43], v[132:135], v[164:167], v[40:43]
    v_add_u32 v13, 131072, v13
    v_cvt_pk_bf16_f32 v203, v54, v55
    v_mfma_f32_16x16x32_bf16 v[40:43], v[136:139], v[160:163], v[40:43]
    ds_read_b64_tr_b16 a[44:45], v13 offset:16384
    v_mfma_f32_16x16x32_bf16 v[36:39], v[128:131], v[164:167], v[36:39]
    ds_read_b64_tr_b16 a[46:47], v13 offset:18432
    v_mfma_f32_16x16x32_bf16 v[36:39], v[132:135], v[160:163], v[36:39]
    buffer_store_dwordx2 v[202:203], v8, s[44:47], s6 offen offset:2560 sc1
    v_mfma_f32_16x16x32_bf16 v[32:35], v[128:131], v[160:163], v[32:35]
    s_waitcnt lgkmcnt(4)
    v_mfma_f32_16x16x32_bf16 v[60:63], v[248:251], v[124:127], 0
    s_waitcnt lgkmcnt(0)
    s_lshl_b32 s14, s88, 17
    v_mfma_f32_16x16x32_bf16 v[60:63], v[64:67], v[124:127], v[60:63]
    s_add_u32 m0, s73, 147456
    ds_read_b128 v[160:163], v245 offset:2048
    v_mfma_f32_16x16x32_bf16 v[60:63], v[68:71], v[120:123], v[60:63]
    buffer_load_dwordx4 v4, s[52:55], s14 offen offset:0 lds
    v_mfma_f32_16x16x32_bf16 v[60:63], v[72:75], v[116:119], v[60:63]
    v_cvt_pk_bf16_f32 v200, v48, v49
    v_mfma_f32_16x16x32_bf16 v[60:63], v[76:79], v[112:115], v[60:63]
    v_cvt_pk_bf16_f32 v201, v50, v51
    v_mfma_f32_16x16x32_bf16 v[60:63], v[80:83], v[108:111], v[60:63]
    ds_read2_b32 v[128:129], v236 offset0:16 offset1:17
    v_mfma_f32_16x16x32_bf16 v[60:63], v[84:87], v[104:107], v[60:63]
    buffer_store_dwordx2 v[200:201], v8, s[44:47], s6 offen offset:2048 sc1
    v_mfma_f32_16x16x32_bf16 v[60:63], v[88:91], v[100:103], v[60:63]
    ds_read2_b32 v[130:131], v236 offset0:18 offset1:19
    v_mfma_f32_16x16x32_bf16 v[60:63], v[92:95], v[96:99], v[60:63]
    v_cvt_pk_bf16_f32 v198, v44, v45
    v_mfma_f32_16x16x32_bf16 v[56:59], v[248:251], v[120:123], 0
    ds_read_b128 v[164:167], v245 offset:6144
    v_mfma_f32_16x16x32_bf16 v[56:59], v[64:67], v[120:123], v[56:59]
    ds_read2_b32 v[132:133], v236 offset0:144 offset1:145
    v_mfma_f32_16x16x32_bf16 v[56:59], v[68:71], v[116:119], v[56:59]
    v_cvt_pk_bf16_f32 v199, v46, v47
    v_mfma_f32_16x16x32_bf16 v[56:59], v[72:75], v[112:115], v[56:59]
    ds_read2_b32 v[134:135], v236 offset0:146 offset1:147
    v_mfma_f32_16x16x32_bf16 v[56:59], v[76:79], v[108:111], v[56:59]
    ds_read_b128 v[168:171], v245 offset:10240
    v_mfma_f32_16x16x32_bf16 v[56:59], v[80:83], v[104:107], v[56:59]
    buffer_store_dwordx2 v[198:199], v8, s[44:47], s6 offen offset:1536 sc1
    v_mfma_f32_16x16x32_bf16 v[56:59], v[84:87], v[100:103], v[56:59]
    ds_read2_b32 v[136:137], v237 offset0:16 offset1:17
    v_mfma_f32_16x16x32_bf16 v[56:59], v[88:91], v[96:99], v[56:59]
    v_cvt_pk_bf16_f32 v196, v40, v41
    v_mfma_f32_16x16x32_bf16 v[52:55], v[248:251], v[116:119], 0
    ds_read2_b32 v[138:139], v237 offset0:18 offset1:19
    v_mfma_f32_16x16x32_bf16 v[52:55], v[64:67], v[116:119], v[52:55]
    ds_read_b128 v[172:175], v245 offset:14336
    v_mfma_f32_16x16x32_bf16 v[52:55], v[68:71], v[112:115], v[52:55]
    v_cvt_pk_bf16_f32 v197, v42, v43
    v_mfma_f32_16x16x32_bf16 v[52:55], v[72:75], v[108:111], v[52:55]
    ds_read2_b32 v[140:141], v237 offset0:144 offset1:145
    v_mfma_f32_16x16x32_bf16 v[52:55], v[76:79], v[104:107], v[52:55]
    buffer_store_dwordx2 v[196:197], v8, s[44:47], s6 offen offset:1024 sc1
    v_mfma_f32_16x16x32_bf16 v[52:55], v[80:83], v[100:103], v[52:55]
    ds_read2_b32 v[142:143], v237 offset0:146 offset1:147
    v_mfma_f32_16x16x32_bf16 v[52:55], v[84:87], v[96:99], v[52:55]
    s_add_u32 m0, s73, 147456
    v_mfma_f32_16x16x32_bf16 v[48:51], v[248:251], v[112:115], 0
    buffer_load_dwordx4 v5, s[52:55], s14 offen offset:1024 lds
    v_mfma_f32_16x16x32_bf16 v[48:51], v[64:67], v[112:115], v[48:51]
    v_cvt_pk_bf16_f32 v194, v36, v37
    v_mfma_f32_16x16x32_bf16 v[48:51], v[68:71], v[108:111], v[48:51]
    v_cvt_pk_bf16_f32 v195, v38, v39
    v_mfma_f32_16x16x32_bf16 v[48:51], v[72:75], v[104:107], v[48:51]
    ds_read_b128 v[176:179], v245 offset:18432
    v_mfma_f32_16x16x32_bf16 v[48:51], v[76:79], v[100:103], v[48:51]
    ds_read2_b32 v[144:145], v238 offset0:16 offset1:17
    v_mfma_f32_16x16x32_bf16 v[48:51], v[80:83], v[96:99], v[48:51]
    buffer_store_dwordx2 v[194:195], v8, s[44:47], s6 offen offset:512 sc1
    v_mfma_f32_16x16x32_bf16 v[44:47], v[248:251], v[108:111], 0
    ds_read2_b32 v[146:147], v238 offset0:18 offset1:19
    v_mfma_f32_16x16x32_bf16 v[44:47], v[64:67], v[108:111], v[44:47]
    v_cvt_pk_bf16_f32 v192, v32, v33
    v_mfma_f32_16x16x32_bf16 v[44:47], v[68:71], v[104:107], v[44:47]
    ds_read_b128 v[180:183], v245 offset:22528
    v_mfma_f32_16x16x32_bf16 v[44:47], v[72:75], v[100:103], v[44:47]
    ds_read2_b32 v[148:149], v238 offset0:144 offset1:145
    v_mfma_f32_16x16x32_bf16 v[44:47], v[76:79], v[96:99], v[44:47]
    v_cvt_pk_bf16_f32 v193, v34, v35
    v_mfma_f32_16x16x32_bf16 v[40:43], v[248:251], v[104:107], 0
    ds_read2_b32 v[150:151], v238 offset0:146 offset1:147
    v_mfma_f32_16x16x32_bf16 v[40:43], v[64:67], v[104:107], v[40:43]
    buffer_store_dwordx2 v[192:193], v8, s[44:47], s6 offen offset:0 sc1
    v_mfma_f32_16x16x32_bf16 v[40:43], v[68:71], v[100:103], v[40:43]
    ds_read_b128 v[184:187], v245 offset:26624
    v_mfma_f32_16x16x32_bf16 v[40:43], v[72:75], v[96:99], v[40:43]
    ds_read2_b32 v[152:153], v239 offset0:16 offset1:17
    v_mfma_f32_16x16x32_bf16 v[36:39], v[248:251], v[100:103], 0
    ds_read2_b32 v[154:155], v239 offset0:18 offset1:19
    v_mfma_f32_16x16x32_bf16 v[36:39], v[64:67], v[100:103], v[36:39]
    ds_read_b128 v[188:191], v245 offset:30720
    v_mfma_f32_16x16x32_bf16 v[36:39], v[68:71], v[96:99], v[36:39]
    ds_read2_b32 v[156:157], v239 offset0:144 offset1:145
    v_mfma_f32_16x16x32_bf16 v[32:35], v[248:251], v[96:99], 0
    ds_read2_b32 v[158:159], v239 offset0:146 offset1:147
    v_mfma_f32_16x16x32_bf16 v[32:35], v[64:67], v[96:99], v[32:35]
    s_waitcnt lgkmcnt(12)
    v_mfma_f32_16x16x32_bf16 v[32:35], v[128:131], v[160:163], v[32:35]
    ds_read_b128 v[96:99], v246 offset:2048
    v_mfma_f32_16x16x32_bf16 v[36:39], v[132:135], v[160:163], v[36:39]
    s_add_u32 m0, s73, 147456
    ds_read2_b32 v[64:65], v236 offset0:32 offset1:33
    v_mfma_f32_16x16x32_bf16 v[36:39], v[128:131], v[164:167], v[36:39]
    buffer_load_dwordx4 v6, s[52:55], s14 offen offset:2048 lds
    v_mfma_f32_16x16x32_bf16 v[40:43], v[128:131], v[168:171], v[40:43]
    s_add_u32 s13, s12, 32768
    ds_read2_b32 v[66:67], v236 offset0:34 offset1:35
    v_mfma_f32_16x16x32_bf16 v[40:43], v[132:135], v[164:167], v[40:43]
    ds_read_b128 v[100:103], v246 offset:6144
    v_mfma_f32_16x16x32_bf16 v[40:43], v[136:139], v[160:163], v[40:43]
    s_add_u32 m0, s74, 32
    ds_read2_b32 v[68:69], v236 offset0:160 offset1:161
    v_mfma_f32_16x16x32_bf16 v[44:47], v[140:143], v[160:163], v[44:47]
    buffer_load_dwordx4 v240, s[48:51], s13 offen offset:0 lds
    v_mfma_f32_16x16x32_bf16 v[44:47], v[136:139], v[164:167], v[44:47]
    ds_read2_b32 v[70:71], v236 offset0:162 offset1:163
    v_mfma_f32_16x16x32_bf16 v[44:47], v[132:135], v[168:171], v[44:47]
    ds_read_b128 v[104:107], v246 offset:10240
    v_mfma_f32_16x16x32_bf16 v[44:47], v[128:131], v[172:175], v[44:47]
    ds_read2_b32 v[72:73], v237 offset0:32 offset1:33
    s_waitcnt lgkmcnt(8)
    v_mfma_f32_16x16x32_bf16 v[48:51], v[128:131], v[176:179], v[48:51]
    ds_read2_b32 v[74:75], v237 offset0:34 offset1:35
    v_mfma_f32_16x16x32_bf16 v[48:51], v[132:135], v[172:175], v[48:51]
    ds_read_b128 v[108:111], v246 offset:14336
    v_mfma_f32_16x16x32_bf16 v[48:51], v[136:139], v[168:171], v[48:51]
    ds_read2_b32 v[76:77], v237 offset0:160 offset1:161
    v_mfma_f32_16x16x32_bf16 v[48:51], v[140:143], v[164:167], v[48:51]
    s_add_u32 m0, s74, 32
    ds_read2_b32 v[78:79], v237 offset0:162 offset1:163
    v_mfma_f32_16x16x32_bf16 v[48:51], v[144:147], v[160:163], v[48:51]
    s_waitcnt vmcnt(11)
    buffer_load_dwordx4 v240, s[48:51], s13 offen offset:1024 lds
    v_mfma_f32_16x16x32_bf16 v[52:55], v[148:151], v[160:163], v[52:55]
    v_add_u32 v10, -131072, v10
    ds_read_b128 v[112:115], v246 offset:18432
    v_mfma_f32_16x16x32_bf16 v[52:55], v[144:147], v[164:167], v[52:55]
    ds_read_b64_tr_b16 a[48:49], v10 offset:49152
    v_mfma_f32_16x16x32_bf16 v[52:55], v[140:143], v[168:171], v[52:55]
    ds_read_b64_tr_b16 a[50:51], v10 offset:51200
    v_mfma_f32_16x16x32_bf16 v[52:55], v[136:139], v[172:175], v[52:55]
    v_add_u32 v11, -131072, v11
    ds_read2_b32 v[80:81], v238 offset0:32 offset1:33
    v_mfma_f32_16x16x32_bf16 v[52:55], v[132:135], v[176:179], v[52:55]
    s_add_u32 m0, s73, 147456
    ds_read_b64_tr_b16 a[52:53], v11 offset:49152
    v_mfma_f32_16x16x32_bf16 v[52:55], v[128:131], v[180:183], v[52:55]
    buffer_load_dwordx4 v7, s[52:55], s14 offen offset:3072 lds
    ds_read_b64_tr_b16 a[54:55], v11 offset:51200
    v_mfma_f32_16x16x32_bf16 v[56:59], v[128:131], v[184:187], v[56:59]
    v_add_u32 v12, -131072, v12
    s_add_u32 m0, s74, 32
    v_mfma_f32_16x16x32_bf16 v[56:59], v[132:135], v[180:183], v[56:59]
    ds_read_b64_tr_b16 a[56:57], v12 offset:49152
    buffer_load_dwordx4 v240, s[48:51], s13 offen offset:2048 lds
    v_mfma_f32_16x16x32_bf16 v[56:59], v[136:139], v[176:179], v[56:59]
    ds_read_b64_tr_b16 a[58:59], v12 offset:51200
    ds_read2_b32 v[82:83], v238 offset0:34 offset1:35
    v_mfma_f32_16x16x32_bf16 v[56:59], v[140:143], v[172:175], v[56:59]
    v_add_u32 v13, -131072, v13
    ds_read_b128 v[116:119], v246 offset:22528
    v_mfma_f32_16x16x32_bf16 v[56:59], v[144:147], v[168:171], v[56:59]
    ds_read_b64_tr_b16 a[60:61], v13 offset:49152
    ds_read2_b32 v[84:85], v238 offset0:160 offset1:161
    v_mfma_f32_16x16x32_bf16 v[56:59], v[148:151], v[164:167], v[56:59]
    ds_read_b64_tr_b16 a[62:63], v13 offset:51200
    v_mfma_f32_16x16x32_bf16 v[56:59], v[152:155], v[160:163], v[56:59]
    ds_read2_b32 v[86:87], v238 offset0:162 offset1:163
    v_mfma_f32_16x16x32_bf16 v[60:63], v[156:159], v[160:163], v[60:63]
    ds_read_b128 v[120:123], v246 offset:26624
    v_mfma_f32_16x16x32_bf16 v[60:63], v[152:155], v[164:167], v[60:63]
    s_add_u32 m0, s74, 32
    ds_read2_b32 v[88:89], v239 offset0:32 offset1:33
    v_mfma_f32_16x16x32_bf16 v[60:63], v[148:151], v[168:171], v[60:63]
    buffer_load_dwordx4 v240, s[48:51], s13 offen offset:3072 lds
    v_mfma_f32_16x16x32_bf16 v[60:63], v[144:147], v[172:175], v[60:63]
    ds_read2_b32 v[90:91], v239 offset0:34 offset1:35
    v_mfma_f32_16x16x32_bf16 v[60:63], v[140:143], v[176:179], v[60:63]
    ds_read_b128 v[124:127], v246 offset:30720
    v_mfma_f32_16x16x32_bf16 v[60:63], v[136:139], v[180:183], v[60:63]
    ds_read2_b32 v[92:93], v239 offset0:160 offset1:161
    v_mfma_f32_16x16x32_bf16 v[60:63], v[132:135], v[184:187], v[60:63]
    ds_read2_b32 v[94:95], v239 offset0:162 offset1:163
    v_mfma_f32_16x16x32_bf16 v[60:63], v[128:131], v[188:191], v[60:63]
    s_waitcnt lgkmcnt(15)
    v_mfma_f32_16x16x32_bf16 v[32:35], v[64:67], v[96:99], v[32:35]
    ds_read_b128 v[160:163], v247 offset:2048
    v_mfma_f32_16x16x32_bf16 v[36:39], v[68:71], v[96:99], v[36:39]
    v_mfma_f32_16x16x32_bf16 v[36:39], v[64:67], v[100:103], v[36:39]
    ds_read2_b32 v[128:129], v236 offset0:48 offset1:49
    v_mfma_f32_16x16x32_bf16 v[40:43], v[64:67], v[104:107], v[40:43]
    ds_read2_b32 v[130:131], v236 offset0:50 offset1:51
    v_mfma_f32_16x16x32_bf16 v[40:43], v[68:71], v[100:103], v[40:43]
    v_mfma_f32_16x16x32_bf16 v[40:43], v[72:75], v[96:99], v[40:43]
    ds_read_b128 v[164:167], v247 offset:6144
    v_mfma_f32_16x16x32_bf16 v[44:47], v[76:79], v[96:99], v[44:47]
    s_waitcnt lgkmcnt(11)
    s_barrier
    v_mfma_f32_16x16x32_bf16 v[44:47], v[72:75], v[100:103], v[44:47]
    ds_read2_b32 v[132:133], v236 offset0:176 offset1:177
    v_mfma_f32_16x16x32_bf16 v[44:47], v[68:71], v[104:107], v[44:47]
    ds_read2_b32 v[134:135], v236 offset0:178 offset1:179
    v_mfma_f32_16x16x32_bf16 v[44:47], v[64:67], v[108:111], v[44:47]
    v_mov_b32 v9, 16
    buffer_load_ushort v9, v9, s[56:59], s70 offen
    s_waitcnt lgkmcnt(6)
    v_mfma_f32_16x16x32_bf16 v[48:51], v[64:67], v[112:115], v[48:51]
    ds_read_b128 v[168:171], v247 offset:10240
    v_mfma_f32_16x16x32_bf16 v[48:51], v[68:71], v[108:111], v[48:51]
    ds_read2_b32 v[136:137], v237 offset0:48 offset1:49
    v_mfma_f32_16x16x32_bf16 v[48:51], v[72:75], v[104:107], v[48:51]
    ds_read2_b32 v[138:139], v237 offset0:50 offset1:51
    v_mfma_f32_16x16x32_bf16 v[48:51], v[76:79], v[100:103], v[48:51]
    ds_read_b128 v[172:175], v247 offset:14336
    v_mfma_f32_16x16x32_bf16 v[48:51], v[80:83], v[96:99], v[48:51]
    v_mfma_f32_16x16x32_bf16 v[52:55], v[84:87], v[96:99], v[52:55]
    ds_read2_b32 v[140:141], v237 offset0:176 offset1:177
    v_mfma_f32_16x16x32_bf16 v[52:55], v[80:83], v[100:103], v[52:55]
    ds_read2_b32 v[142:143], v237 offset0:178 offset1:179
    v_mfma_f32_16x16x32_bf16 v[52:55], v[76:79], v[104:107], v[52:55]
    v_mfma_f32_16x16x32_bf16 v[52:55], v[72:75], v[108:111], v[52:55]
    ds_read_b128 v[176:179], v247 offset:18432
    v_mfma_f32_16x16x32_bf16 v[52:55], v[68:71], v[112:115], v[52:55]
    ds_read2_b32 v[144:145], v238 offset0:48 offset1:49
    v_mfma_f32_16x16x32_bf16 v[52:55], v[64:67], v[116:119], v[52:55]
    v_mfma_f32_16x16x32_bf16 v[56:59], v[64:67], v[120:123], v[56:59]
    ds_read2_b32 v[146:147], v238 offset0:50 offset1:51
    v_mfma_f32_16x16x32_bf16 v[56:59], v[68:71], v[116:119], v[56:59]
    ds_read_b128 v[180:183], v247 offset:22528
    v_mfma_f32_16x16x32_bf16 v[56:59], v[72:75], v[112:115], v[56:59]
    v_mfma_f32_16x16x32_bf16 v[56:59], v[76:79], v[108:111], v[56:59]
    ds_read2_b32 v[148:149], v238 offset0:176 offset1:177
    v_mfma_f32_16x16x32_bf16 v[56:59], v[80:83], v[104:107], v[56:59]
    ds_read2_b32 v[150:151], v238 offset0:178 offset1:179
    v_mfma_f32_16x16x32_bf16 v[56:59], v[84:87], v[100:103], v[56:59]
    ds_read_b128 v[184:187], v247 offset:26624
    v_mfma_f32_16x16x32_bf16 v[56:59], v[88:91], v[96:99], v[56:59]
    v_mfma_f32_16x16x32_bf16 v[60:63], v[92:95], v[96:99], v[60:63]
    ds_read2_b32 v[152:153], v239 offset0:48 offset1:49
    v_mfma_f32_16x16x32_bf16 v[60:63], v[88:91], v[100:103], v[60:63]
    ds_read2_b32 v[154:155], v239 offset0:50 offset1:51
    v_mfma_f32_16x16x32_bf16 v[60:63], v[84:87], v[104:107], v[60:63]
    v_mfma_f32_16x16x32_bf16 v[60:63], v[80:83], v[108:111], v[60:63]
    ds_read_b128 v[188:191], v247 offset:30720
    v_mfma_f32_16x16x32_bf16 v[60:63], v[76:79], v[112:115], v[60:63]
    ds_read2_b32 v[156:157], v239 offset0:176 offset1:177
    v_mfma_f32_16x16x32_bf16 v[60:63], v[72:75], v[116:119], v[60:63]
    v_mfma_f32_16x16x32_bf16 v[60:63], v[68:71], v[120:123], v[60:63]
    ds_read2_b32 v[158:159], v239 offset0:178 offset1:179
    v_mfma_f32_16x16x32_bf16 v[60:63], v[64:67], v[124:127], v[60:63]
    s_waitcnt lgkmcnt(12)
    v_mfma_f32_16x16x32_bf16 v[32:35], v[128:131], v[160:163], v[32:35]
    ds_read_b128 v[96:99], v244 offset:0
    v_mfma_f32_16x16x32_bf16 v[36:39], v[132:135], v[160:163], v[36:39]
    ds_read2_b32 v[64:65], v236 offset0:64 offset1:65
    v_mfma_f32_16x16x32_bf16 v[36:39], v[128:131], v[164:167], v[36:39]
    ds_read2_b32 v[66:67], v236 offset0:66 offset1:67
    v_mfma_f32_16x16x32_bf16 v[40:43], v[128:131], v[168:171], v[40:43]
    ds_read_b128 v[100:103], v244 offset:4096
    v_mfma_f32_16x16x32_bf16 v[40:43], v[132:135], v[164:167], v[40:43]
    ds_read2_b32 v[68:69], v236 offset0:192 offset1:193
    v_mfma_f32_16x16x32_bf16 v[40:43], v[136:139], v[160:163], v[40:43]
    ds_read2_b32 v[70:71], v236 offset0:194 offset1:195
    v_mfma_f32_16x16x32_bf16 v[44:47], v[140:143], v[160:163], v[44:47]
    ds_read_b128 v[104:107], v244 offset:8192
    v_mfma_f32_16x16x32_bf16 v[44:47], v[136:139], v[164:167], v[44:47]
    s_add_u32 m0, s9, 36864
    s_add_u32 s13, s7, 128
    v_mfma_f32_16x16x32_bf16 v[44:47], v[132:135], v[168:171], v[44:47]
    buffer_load_dwordx4 v24, s[44:47], s13 offen sc1 lds
    v_mfma_f32_16x16x32_bf16 v[44:47], v[128:131], v[172:175], v[44:47]
    ds_read2_b32 v[72:73], v237 offset0:64 offset1:65
    s_waitcnt lgkmcnt(8)
    v_mfma_f32_16x16x32_bf16 v[48:51], v[128:131], v[176:179], v[48:51]
    ds_read2_b32 v[74:75], v237 offset0:66 offset1:67
    v_mfma_f32_16x16x32_bf16 v[48:51], v[132:135], v[172:175], v[48:51]
    ds_read_b128 v[108:111], v244 offset:12288
    v_mfma_f32_16x16x32_bf16 v[48:51], v[136:139], v[168:171], v[48:51]
    ds_read2_b32 v[76:77], v237 offset0:192 offset1:193
    v_mfma_f32_16x16x32_bf16 v[48:51], v[140:143], v[164:167], v[48:51]
    ds_read2_b32 v[78:79], v237 offset0:194 offset1:195
    v_mfma_f32_16x16x32_bf16 v[48:51], v[144:147], v[160:163], v[48:51]
    ds_read_b128 v[112:115], v244 offset:16384
    ds_read2_b32 v[80:81], v238 offset0:64 offset1:65
    v_mfma_f32_16x16x32_bf16 v[52:55], v[148:151], v[160:163], v[52:55]
    ds_read2_b32 v[82:83], v238 offset0:66 offset1:67
    ds_read_b128 v[116:119], v244 offset:20480
    v_mfma_f32_16x16x32_bf16 v[52:55], v[144:147], v[164:167], v[52:55]
    s_add_u32 m0, s9, 37888
    s_add_u32 s13, s7, 73856
    v_mfma_f32_16x16x32_bf16 v[52:55], v[140:143], v[168:171], v[52:55]
    buffer_load_dwordx4 v25, s[44:47], s13 offen sc1 lds
    v_mfma_f32_16x16x32_bf16 v[52:55], v[136:139], v[172:175], v[52:55]
    s_waitcnt vmcnt(3)
    ds_read_b128 v[212:215], v241 offset:32
    v_mfma_f32_16x16x32_bf16 v[52:55], v[132:135], v[176:179], v[52:55]
    ds_read_b32 v216, v241 offset:48
    ds_read2_b32 v[84:85], v238 offset0:192 offset1:193
    v_mfma_f32_16x16x32_bf16 v[52:55], v[128:131], v[180:183], v[52:55]
    ds_read_b128 v[218:221], v241 offset:1056
    ds_read2_b32 v[86:87], v238 offset0:194 offset1:195
    v_mfma_f32_16x16x32_bf16 v[56:59], v[128:131], v[184:187], v[56:59]
    ds_read_b32 v222, v241 offset:1072
    v_mfma_f32_16x16x32_bf16 v[56:59], v[132:135], v[180:183], v[56:59]
    v_add_u32 v10, 131072, v10
    ds_read_b128 v[224:227], v241 offset:2080
    v_mfma_f32_16x16x32_bf16 v[56:59], v[136:139], v[176:179], v[56:59]
    ds_read_b64_tr_b16 a[64:65], v10 offset:16384
    ds_read_b128 v[120:123], v244 offset:24576
    v_mfma_f32_16x16x32_bf16 v[56:59], v[140:143], v[172:175], v[56:59]
    ds_read_b64_tr_b16 a[66:67], v10 offset:18432
    ds_read2_b32 v[88:89], v239 offset0:64 offset1:65
    v_mfma_f32_16x16x32_bf16 v[56:59], v[144:147], v[168:171], v[56:59]
    v_add_u32 v11, 131072, v11
    s_add_u32 m0, s9, 38912
    s_add_u32 s13, s7, 147584
    v_mfma_f32_16x16x32_bf16 v[56:59], v[148:151], v[164:167], v[56:59]
    ds_read_b64_tr_b16 a[68:69], v11 offset:16384
    buffer_load_dwordx4 v24, s[44:47], s13 offen sc1 lds
    v_mfma_f32_16x16x32_bf16 v[56:59], v[152:155], v[160:163], v[56:59]
    ds_read_b64_tr_b16 a[70:71], v11 offset:18432
    ds_read2_b32 v[90:91], v239 offset0:66 offset1:67
    v_mfma_f32_16x16x32_bf16 v[60:63], v[156:159], v[160:163], v[60:63]
    v_add_u32 v12, 131072, v12
    ds_read_b32 v228, v241 offset:2096
    v_mfma_f32_16x16x32_bf16 v[60:63], v[152:155], v[164:167], v[60:63]
    ds_read_b64_tr_b16 a[72:73], v12 offset:16384
    ds_read_b128 v[124:127], v244 offset:28672
    v_mfma_f32_16x16x32_bf16 v[60:63], v[148:151], v[168:171], v[60:63]
    ds_read_b64_tr_b16 a[74:75], v12 offset:18432
    ds_read2_b32 v[92:93], v239 offset0:192 offset1:193
    v_mfma_f32_16x16x32_bf16 v[60:63], v[144:147], v[172:175], v[60:63]
    v_add_u32 v13, 131072, v13
    ds_read_b128 v[230:233], v241 offset:3104
    v_mfma_f32_16x16x32_bf16 v[60:63], v[140:143], v[176:179], v[60:63]
    ds_read_b64_tr_b16 a[76:77], v13 offset:16384
    ds_read2_b32 v[94:95], v239 offset0:194 offset1:195
    v_mfma_f32_16x16x32_bf16 v[60:63], v[136:139], v[180:183], v[60:63]
    ds_read_b64_tr_b16 a[78:79], v13 offset:18432
    ds_read_b32 v234, v241 offset:3120
    v_mfma_f32_16x16x32_bf16 v[60:63], v[132:135], v[184:187], v[60:63]
    s_add_u32 m0, s9, 39936
    s_add_u32 s13, s7, 221312
    v_mfma_f32_16x16x32_bf16 v[60:63], v[128:131], v[188:191], v[60:63]
    buffer_load_dwordx4 v25, s[44:47], s13 offen sc1 lds
    s_waitcnt lgkmcnt(15)
    v_mfma_f32_16x16x32_bf16 v[32:35], v[64:67], v[96:99], v[32:35]
    s_waitcnt lgkmcnt(1)
    s_lshl_b32 s14, s89, 17
    v_mfma_f32_16x16x32_bf16 v[36:39], v[68:71], v[96:99], v[36:39]
    s_add_u32 m0, s73, 147456
    ds_read_b128 v[160:163], v245 offset:0
    v_mfma_f32_16x16x32_bf16 v[36:39], v[64:67], v[100:103], v[36:39]
    buffer_load_dwordx4 v4, s[52:55], s14 offen offset:0 lds
    v_mfma_f32_16x16x32_bf16 v[40:43], v[64:67], v[104:107], v[40:43]
    ds_read2_b32 v[128:129], v236 offset0:80 offset1:81
    v_mfma_f32_16x16x32_bf16 v[40:43], v[68:71], v[100:103], v[40:43]
    ds_read2_b32 v[130:131], v236 offset0:82 offset1:83
    v_mfma_f32_16x16x32_bf16 v[40:43], v[72:75], v[96:99], v[40:43]
    s_waitcnt lgkmcnt(3)
    ds_read_b128 v[164:167], v245 offset:4096
    v_mfma_f32_16x16x32_bf16 v[44:47], v[76:79], v[96:99], v[44:47]
    ds_write_b16 v242, v212 offset:4160
    ds_read2_b32 v[132:133], v236 offset0:208 offset1:209
    v_mfma_f32_16x16x32_bf16 v[44:47], v[72:75], v[100:103], v[44:47]
    s_add_u32 m0, s9, 40960
    s_add_u32 s13, s7, 295040
    v_mfma_f32_16x16x32_bf16 v[44:47], v[68:71], v[104:107], v[44:47]
    buffer_load_dwordx4 v24, s[44:47], s13 offen sc1 lds
    v_mfma_f32_16x16x32_bf16 v[44:47], v[64:67], v[108:111], v[44:47]
    ds_read2_b32 v[134:135], v236 offset0:210 offset1:211
    v_mfma_f32_16x16x32_bf16 v[48:51], v[64:67], v[112:115], v[48:51]
    v_alignbit_b32 v212, v213, v212, 16
    ds_read_b128 v[168:171], v245 offset:8192
    v_mfma_f32_16x16x32_bf16 v[48:51], v[68:71], v[108:111], v[48:51]
    ds_read2_b32 v[136:137], v237 offset0:80 offset1:81
    v_mfma_f32_16x16x32_bf16 v[48:51], v[72:75], v[104:107], v[48:51]
    ds_read2_b32 v[138:139], v237 offset0:82 offset1:83
    v_mfma_f32_16x16x32_bf16 v[48:51], v[76:79], v[100:103], v[48:51]
L_pl_X_3:
    s_cbranch_execz L_pl_X_7
    v_alignbit_b32 v213, v214, v213, 16
    ds_read_b128 v[172:175], v245 offset:12288
    v_mfma_f32_16x16x32_bf16 v[48:51], v[80:83], v[96:99], v[48:51]
    ds_read2_b32 v[140:141], v237 offset0:208 offset1:209
    v_mfma_f32_16x16x32_bf16 v[52:55], v[84:87], v[96:99], v[52:55]
    v_alignbit_b32 v214, v215, v214, 16
    ds_read2_b32 v[142:143], v237 offset0:210 offset1:211
    v_mfma_f32_16x16x32_bf16 v[52:55], v[80:83], v[100:103], v[52:55]
    s_add_u32 m0, s9, 41984
    s_add_u32 s13, s7, 368768
    v_mfma_f32_16x16x32_bf16 v[52:55], v[76:79], v[104:107], v[52:55]
    buffer_load_dwordx4 v25, s[44:47], s13 offen sc1 lds
    v_mfma_f32_16x16x32_bf16 v[52:55], v[72:75], v[108:111], v[52:55]
    v_alignbit_b32 v215, v216, v215, 16
    ds_read_b128 v[176:179], v245 offset:16384
    v_mfma_f32_16x16x32_bf16 v[52:55], v[68:71], v[112:115], v[52:55]
    s_add_u32 m0, s73, 147456
    ds_read2_b32 v[144:145], v238 offset0:80 offset1:81
    v_mfma_f32_16x16x32_bf16 v[52:55], v[64:67], v[116:119], v[52:55]
    buffer_load_dwordx4 v5, s[52:55], s14 offen offset:1024 lds
    v_mfma_f32_16x16x32_bf16 v[56:59], v[64:67], v[120:123], v[56:59]
    ds_write_b128 v241, v[212:215] offset:4192
    v_mfma_f32_16x16x32_bf16 v[56:59], v[68:71], v[116:119], v[56:59]
    ds_read2_b32 v[146:147], v238 offset0:82 offset1:83
    ds_read_b128 v[180:183], v245 offset:20480
    v_mfma_f32_16x16x32_bf16 v[56:59], v[72:75], v[112:115], v[56:59]
    ds_read2_b32 v[148:149], v238 offset0:208 offset1:209
    v_mfma_f32_16x16x32_bf16 v[56:59], v[76:79], v[108:111], v[56:59]
    v_alignbit_b32 v218, v219, v218, 16
    ds_read2_b32 v[150:151], v238 offset0:210 offset1:211
    v_mfma_f32_16x16x32_bf16 v[56:59], v[80:83], v[104:107], v[56:59]
    s_add_u32 m0, s9, 43008
    s_add_u32 s13, s7, 442496
    v_mfma_f32_16x16x32_bf16 v[56:59], v[84:87], v[100:103], v[56:59]
    buffer_load_dwordx4 v24, s[44:47], s13 offen sc1 lds
    v_mfma_f32_16x16x32_bf16 v[56:59], v[88:91], v[96:99], v[56:59]
    v_alignbit_b32 v219, v220, v219, 16
    ds_read_b128 v[184:187], v245 offset:24576
    v_mfma_f32_16x16x32_bf16 v[60:63], v[92:95], v[96:99], v[60:63]
    ds_read2_b32 v[152:153], v239 offset0:80 offset1:81
    v_mfma_f32_16x16x32_bf16 v[60:63], v[88:91], v[100:103], v[60:63]
    v_alignbit_b32 v220, v221, v220, 16
    ds_read2_b32 v[154:155], v239 offset0:82 offset1:83
    v_mfma_f32_16x16x32_bf16 v[60:63], v[84:87], v[104:107], v[60:63]
    ds_read_b128 v[188:191], v245 offset:28672
    v_mfma_f32_16x16x32_bf16 v[60:63], v[80:83], v[108:111], v[60:63]
    ds_read2_b32 v[156:157], v239 offset0:208 offset1:209
    v_mfma_f32_16x16x32_bf16 v[60:63], v[76:79], v[112:115], v[60:63]
    v_alignbit_b32 v221, v222, v221, 16
    ds_read2_b32 v[158:159], v239 offset0:210 offset1:211
    v_mfma_f32_16x16x32_bf16 v[60:63], v[72:75], v[116:119], v[60:63]
    ds_write_b128 v241, v[218:221] offset:5216
    v_mfma_f32_16x16x32_bf16 v[60:63], v[68:71], v[120:123], v[60:63]
    s_add_u32 m0, s9, 44032
    s_add_u32 s13, s7, 516224
    v_mfma_f32_16x16x32_bf16 v[60:63], v[64:67], v[124:127], v[60:63]
    buffer_load_dwordx4 v25, s[44:47], s13 offen sc1 lds
    s_waitcnt lgkmcnt(14)
    v_mfma_f32_16x16x32_bf16 v[32:35], v[128:131], v[160:163], v[32:35]
    v_alignbit_b32 v224, v225, v224, 16
    ds_read_b128 v[96:99], v246 offset:0
    v_mfma_f32_16x16x32_bf16 v[36:39], v[132:135], v[160:163], v[36:39]
    s_add_u32 m0, s73, 147456
    ds_read2_b32 v[64:65], v236 offset0:96 offset1:97
    v_mfma_f32_16x16x32_bf16 v[36:39], v[128:131], v[164:167], v[36:39]
    buffer_load_dwordx4 v6, s[52:55], s14 offen offset:2048 lds
    v_mfma_f32_16x16x32_bf16 v[40:43], v[128:131], v[168:171], v[40:43]
    v_alignbit_b32 v225, v226, v225, 16
    ds_read2_b32 v[66:67], v236 offset0:98 offset1:99
    v_mfma_f32_16x16x32_bf16 v[40:43], v[132:135], v[164:167], v[40:43]
    ds_read_b128 v[100:103], v246 offset:4096
    v_mfma_f32_16x16x32_bf16 v[40:43], v[136:139], v[160:163], v[40:43]
    v_alignbit_b32 v226, v227, v226, 16
    v_mfma_f32_16x16x32_bf16 v[44:47], v[140:143], v[160:163], v[44:47]
    ds_read2_b32 v[68:69], v236 offset0:224 offset1:225
    v_mfma_f32_16x16x32_bf16 v[44:47], v[136:139], v[164:167], v[44:47]
    v_alignbit_b32 v227, v228, v227, 16
    v_mfma_f32_16x16x32_bf16 v[44:47], v[132:135], v[168:171], v[44:47]
    ds_read2_b32 v[70:71], v236 offset0:226 offset1:227
    v_mfma_f32_16x16x32_bf16 v[44:47], v[128:131], v[172:175], v[44:47]
    ds_read_b128 v[104:107], v246 offset:8192
    s_waitcnt lgkmcnt(8)
    v_mfma_f32_16x16x32_bf16 v[48:51], v[128:131], v[176:179], v[48:51]
    ds_write_b128 v241, v[224:227] offset:6240
    v_mfma_f32_16x16x32_bf16 v[48:51], v[132:135], v[172:175], v[48:51]
    ds_read2_b32 v[72:73], v237 offset0:96 offset1:97
    v_mfma_f32_16x16x32_bf16 v[48:51], v[136:139], v[168:171], v[48:51]
    v_alignbit_b32 v230, v231, v230, 16
    ds_read2_b32 v[74:75], v237 offset0:98 offset1:99
    v_mfma_f32_16x16x32_bf16 v[48:51], v[140:143], v[164:167], v[48:51]
    ds_read_b128 v[108:111], v246 offset:12288
    v_mfma_f32_16x16x32_bf16 v[48:51], v[144:147], v[160:163], v[48:51]
    v_alignbit_b32 v231, v232, v231, 16
    v_mfma_f32_16x16x32_bf16 v[52:55], v[148:151], v[160:163], v[52:55]
    ds_read2_b32 v[76:77], v237 offset0:224 offset1:225
    v_mfma_f32_16x16x32_bf16 v[52:55], v[144:147], v[164:167], v[52:55]
    v_alignbit_b32 v232, v233, v232, 16
    v_mfma_f32_16x16x32_bf16 v[52:55], v[140:143], v[168:171], v[52:55]
    ds_read2_b32 v[78:79], v237 offset0:226 offset1:227
    v_mfma_f32_16x16x32_bf16 v[52:55], v[136:139], v[172:175], v[52:55]
    v_alignbit_b32 v233, v234, v233, 16
    ds_read_b128 v[112:115], v246 offset:16384
    v_mfma_f32_16x16x32_bf16 v[52:55], v[132:135], v[176:179], v[52:55]
    s_add_u32 m0, s73, 147456
    ds_read2_b32 v[80:81], v238 offset0:96 offset1:97
    v_mfma_f32_16x16x32_bf16 v[52:55], v[128:131], v[180:183], v[52:55]
    buffer_load_dwordx4 v7, s[52:55], s14 offen offset:3072 lds
    v_mfma_f32_16x16x32_bf16 v[56:59], v[128:131], v[184:187], v[56:59]
    ds_write_b128 v241, v[230:233] offset:7264
    v_mfma_f32_16x16x32_bf16 v[56:59], v[132:135], v[180:183], v[56:59]
    ds_read2_b32 v[82:83], v238 offset0:98 offset1:99
    v_mfma_f32_16x16x32_bf16 v[56:59], v[136:139], v[176:179], v[56:59]
    s_waitcnt vmcnt(12)
    ds_read_b128 v[116:119], v246 offset:20480
    v_mfma_f32_16x16x32_bf16 v[56:59], v[140:143], v[172:175], v[56:59]
    ds_read2_b32 v[84:85], v238 offset0:224 offset1:225
    v_mfma_f32_16x16x32_bf16 v[56:59], v[144:147], v[168:171], v[56:59]
    v_lshl_or_b32 v9, v9, 16, v9
    ds_read2_b32 v[86:87], v238 offset0:226 offset1:227
    v_mfma_f32_16x16x32_bf16 v[56:59], v[148:151], v[164:167], v[56:59]
    ds_read_b128 v[120:123], v246 offset:24576
    v_mfma_f32_16x16x32_bf16 v[56:59], v[152:155], v[160:163], v[56:59]
    ds_read2_b32 v[88:89], v239 offset0:96 offset1:97
    v_mfma_f32_16x16x32_bf16 v[60:63], v[156:159], v[160:163], v[60:63]
    v_and_b32 v248, v9, v208
    v_mfma_f32_16x16x32_bf16 v[60:63], v[152:155], v[164:167], v[60:63]
    ds_read2_b32 v[90:91], v239 offset0:98 offset1:99
    v_mfma_f32_16x16x32_bf16 v[60:63], v[148:151], v[168:171], v[60:63]
    v_and_b32 v249, v9, v209
    v_mfma_f32_16x16x32_bf16 v[60:63], v[144:147], v[172:175], v[60:63]
    ds_read_b128 v[124:127], v246 offset:28672
    v_mfma_f32_16x16x32_bf16 v[60:63], v[140:143], v[176:179], v[60:63]
    v_and_b32 v250, v9, v210
    v_mfma_f32_16x16x32_bf16 v[60:63], v[136:139], v[180:183], v[60:63]
    ds_read2_b32 v[92:93], v239 offset0:224 offset1:225
    v_mfma_f32_16x16x32_bf16 v[60:63], v[132:135], v[184:187], v[60:63]
    v_and_b32 v251, v9, v211
    ds_read2_b32 v[94:95], v239 offset0:226 offset1:227
    v_mfma_f32_16x16x32_bf16 v[60:63], v[128:131], v[188:191], v[60:63]
    s_waitcnt lgkmcnt(13)
    v_mfma_f32_16x16x32_bf16 v[32:35], v[64:67], v[96:99], v[32:35]
    ds_read_b128 v[160:163], v247 offset:0
    v_mfma_f32_16x16x32_bf16 v[36:39], v[68:71], v[96:99], v[36:39]
    v_mfma_f32_16x16x32_bf16 v[36:39], v[64:67], v[100:103], v[36:39]
    ds_read_b128 v[164:167], v247 offset:4096
    v_mfma_f32_16x16x32_bf16 v[40:43], v[64:67], v[104:107], v[40:43]
    ds_read_b128 v[168:171], v247 offset:8192
    v_mfma_f32_16x16x32_bf16 v[40:43], v[68:71], v[100:103], v[40:43]
    ds_read_b128 v[172:175], v247 offset:12288
    v_mfma_f32_16x16x32_bf16 v[40:43], v[72:75], v[96:99], v[40:43]
    v_mfma_f32_16x16x32_bf16 v[44:47], v[76:79], v[96:99], v[44:47]
    ds_read_b128 v[176:179], v247 offset:16384
    v_mfma_f32_16x16x32_bf16 v[44:47], v[72:75], v[100:103], v[44:47]
    ds_read_b128 v[180:183], v247 offset:20480
    v_mfma_f32_16x16x32_bf16 v[44:47], v[68:71], v[104:107], v[44:47]
    ds_read_b128 v[184:187], v247 offset:24576
    v_mfma_f32_16x16x32_bf16 v[44:47], v[64:67], v[108:111], v[44:47]
    s_waitcnt lgkmcnt(7)
    v_mfma_f32_16x16x32_bf16 v[48:51], v[64:67], v[112:115], v[48:51]
    ds_read_b128 v[188:191], v247 offset:28672
    v_mfma_f32_16x16x32_bf16 v[48:51], v[68:71], v[108:111], v[48:51]
    ds_read2_b32 v[128:129], v236 offset0:112 offset1:113
    v_mfma_f32_16x16x32_bf16 v[48:51], v[72:75], v[104:107], v[48:51]
    v_mfma_f32_16x16x32_bf16 v[48:51], v[76:79], v[100:103], v[48:51]
    ds_read2_b32 v[130:131], v236 offset0:114 offset1:115
    v_mfma_f32_16x16x32_bf16 v[48:51], v[80:83], v[96:99], v[48:51]
    ds_read2_b32 v[132:133], v236 offset0:240 offset1:241
    v_mfma_f32_16x16x32_bf16 v[52:55], v[84:87], v[96:99], v[52:55]
    ds_read2_b32 v[134:135], v236 offset0:242 offset1:243
    v_mfma_f32_16x16x32_bf16 v[52:55], v[80:83], v[100:103], v[52:55]
    ds_read2_b32 v[136:137], v237 offset0:112 offset1:113
    v_mfma_f32_16x16x32_bf16 v[52:55], v[76:79], v[104:107], v[52:55]
    ds_read2_b32 v[138:139], v237 offset0:114 offset1:115
    v_mfma_f32_16x16x32_bf16 v[52:55], v[72:75], v[108:111], v[52:55]
    s_add_u32 s6, s12, 4734976
    ds_read2_b32 v[140:141], v237 offset0:240 offset1:241
    v_mfma_f32_16x16x32_bf16 v[52:55], v[68:71], v[112:115], v[52:55]
    v_xor_b32 v244, 64, v244
    ds_read2_b32 v[142:143], v237 offset0:242 offset1:243
    v_mfma_f32_16x16x32_bf16 v[52:55], v[64:67], v[116:119], v[52:55]
    ds_read2_b32 v[144:145], v238 offset0:112 offset1:113
    v_mfma_f32_16x16x32_bf16 v[56:59], v[64:67], v[120:123], v[56:59]
    v_xor_b32 v245, 64, v245
    v_mfma_f32_16x16x32_bf16 v[56:59], v[68:71], v[116:119], v[56:59]
    ds_read2_b32 v[146:147], v238 offset0:114 offset1:115
    v_mfma_f32_16x16x32_bf16 v[56:59], v[72:75], v[112:115], v[56:59]
    v_xor_b32 v246, 64, v246
    ds_read2_b32 v[148:149], v238 offset0:240 offset1:241
    v_mfma_f32_16x16x32_bf16 v[56:59], v[76:79], v[108:111], v[56:59]
    ds_read2_b32 v[150:151], v238 offset0:242 offset1:243
    v_mfma_f32_16x16x32_bf16 v[56:59], v[80:83], v[104:107], v[56:59]
    v_xor_b32 v247, 64, v247
    ds_read2_b32 v[152:153], v239 offset0:112 offset1:113
    v_mfma_f32_16x16x32_bf16 v[56:59], v[84:87], v[100:103], v[56:59]
    ds_read2_b32 v[154:155], v239 offset0:114 offset1:115
    v_mfma_f32_16x16x32_bf16 v[56:59], v[88:91], v[96:99], v[56:59]
    ds_read2_b32 v[156:157], v239 offset0:240 offset1:241
    v_mfma_f32_16x16x32_bf16 v[60:63], v[92:95], v[96:99], v[60:63]
    v_add_u32 v244, 36864, v244
    ds_read2_b32 v[158:159], v239 offset0:242 offset1:243
    v_mfma_f32_16x16x32_bf16 v[60:63], v[88:91], v[100:103], v[60:63]
    v_add_u32 v236, -8320, v236
    v_mfma_f32_16x16x32_bf16 v[60:63], v[84:87], v[104:107], v[60:63]
    v_add_u32 v245, 36864, v245
    v_mfma_f32_16x16x32_bf16 v[60:63], v[80:83], v[108:111], v[60:63]
    v_add_u32 v237, -8320, v237
    v_add_u32 v238, -8320, v238
    v_mfma_f32_16x16x32_bf16 v[60:63], v[76:79], v[112:115], v[60:63]
    v_add_u32 v246, 36864, v246
    v_add_u32 v239, -8320, v239
    v_mfma_f32_16x16x32_bf16 v[60:63], v[72:75], v[116:119], v[60:63]
    s_waitcnt vmcnt(2)
    s_barrier
    v_mfma_f32_16x16x32_bf16 v[60:63], v[68:71], v[120:123], v[60:63]
    v_add_u32 v247, 36864, v247
    v_mfma_f32_16x16x32_bf16 v[60:63], v[64:67], v[124:127], v[60:63]
    s_waitcnt lgkmcnt(0)
    v_mfma_f32_16x16x32_bf16 v[60:63], v[128:131], v[188:191], v[60:63]
    ds_read_b128 v[96:99], v244 offset:2048
    v_mfma_f32_16x16x32_bf16 v[60:63], v[132:135], v[184:187], v[60:63]
    ds_read2_b32 v[64:65], v236 offset0:0 offset1:1
    v_mfma_f32_16x16x32_bf16 v[60:63], v[136:139], v[180:183], v[60:63]
    ds_read2_b32 v[66:67], v236 offset0:2 offset1:3
    v_mfma_f32_16x16x32_bf16 v[60:63], v[140:143], v[176:179], v[60:63]
    ds_read_b128 v[100:103], v244 offset:6144
    v_mfma_f32_16x16x32_bf16 v[60:63], v[144:147], v[172:175], v[60:63]
    ds_read2_b32 v[68:69], v236 offset0:128 offset1:129
    v_mfma_f32_16x16x32_bf16 v[60:63], v[148:151], v[168:171], v[60:63]
    ds_read2_b32 v[70:71], v236 offset0:130 offset1:131
    v_mfma_f32_16x16x32_bf16 v[60:63], v[152:155], v[164:167], v[60:63]
    ds_read_b128 v[104:107], v244 offset:10240
    v_mfma_f32_16x16x32_bf16 v[60:63], v[156:159], v[160:163], v[60:63]
    ds_read2_b32 v[72:73], v237 offset0:0 offset1:1
    v_mfma_f32_16x16x32_bf16 v[56:59], v[128:131], v[184:187], v[56:59]
    ds_read2_b32 v[74:75], v237 offset0:2 offset1:3
    v_mfma_f32_16x16x32_bf16 v[56:59], v[132:135], v[180:183], v[56:59]
    ds_read_b128 v[108:111], v244 offset:14336
    v_mfma_f32_16x16x32_bf16 v[56:59], v[136:139], v[176:179], v[56:59]
    ds_read2_b32 v[76:77], v237 offset0:128 offset1:129
    v_mfma_f32_16x16x32_bf16 v[56:59], v[140:143], v[172:175], v[56:59]
    ds_read2_b32 v[78:79], v237 offset0:130 offset1:131
    v_mfma_f32_16x16x32_bf16 v[56:59], v[144:147], v[168:171], v[56:59]
    ds_read_b128 v[112:115], v244 offset:18432
    v_mfma_f32_16x16x32_bf16 v[56:59], v[148:151], v[164:167], v[56:59]
    v_cvt_pk_bf16_f32 v206, v60, v61
    ds_read2_b32 v[80:81], v238 offset0:0 offset1:1
    v_mfma_f32_16x16x32_bf16 v[56:59], v[152:155], v[160:163], v[56:59]
    ds_read2_b32 v[82:83], v238 offset0:2 offset1:3
    v_mfma_f32_16x16x32_bf16 v[52:55], v[128:131], v[180:183], v[52:55]
    ds_read_b128 v[116:119], v244 offset:22528
    v_mfma_f32_16x16x32_bf16 v[52:55], v[132:135], v[176:179], v[52:55]
    v_cvt_pk_bf16_f32 v207, v62, v63
    ds_read2_b32 v[84:85], v238 offset0:128 offset1:129
    v_mfma_f32_16x16x32_bf16 v[52:55], v[136:139], v[172:175], v[52:55]
    ds_read2_b32 v[86:87], v238 offset0:130 offset1:131
    v_mfma_f32_16x16x32_bf16 v[52:55], v[140:143], v[168:171], v[52:55]
    buffer_store_dwordx2 v[206:207], v8, s[44:47], s6 offen offset:3584 sc1
    v_mfma_f32_16x16x32_bf16 v[52:55], v[144:147], v[164:167], v[52:55]
    ds_read_b128 v[120:123], v244 offset:26624
    v_mfma_f32_16x16x32_bf16 v[52:55], v[148:151], v[160:163], v[52:55]
    v_cvt_pk_bf16_f32 v204, v56, v57
    ds_read2_b32 v[88:89], v239 offset0:0 offset1:1
    v_mfma_f32_16x16x32_bf16 v[48:51], v[128:131], v[176:179], v[48:51]
    s_waitcnt vmcnt(1)
    ds_read2_b32 v[90:91], v239 offset0:2 offset1:3
    v_mfma_f32_16x16x32_bf16 v[48:51], v[132:135], v[172:175], v[48:51]
    v_cvt_pk_bf16_f32 v205, v58, v59
    ds_read_b128 v[124:127], v244 offset:30720
    v_mfma_f32_16x16x32_bf16 v[48:51], v[136:139], v[168:171], v[48:51]
    ds_read_b64_tr_b16 a[80:81], v10 offset:16384
    v_mfma_f32_16x16x32_bf16 v[48:51], v[140:143], v[164:167], v[48:51]
    ds_read_b64_tr_b16 a[82:83], v10 offset:18432
    v_mfma_f32_16x16x32_bf16 v[48:51], v[144:147], v[160:163], v[48:51]
    ds_read_b64_tr_b16 a[84:85], v11 offset:16384
    v_mfma_f32_16x16x32_bf16 v[44:47], v[128:131], v[172:175], v[44:47]
    buffer_store_dwordx2 v[204:205], v8, s[44:47], s6 offen offset:3072 sc1
    v_mfma_f32_16x16x32_bf16 v[44:47], v[132:135], v[168:171], v[44:47]
    ds_read_b64_tr_b16 a[86:87], v11 offset:18432
    ds_read2_b32 v[92:93], v239 offset0:128 offset1:129
    v_mfma_f32_16x16x32_bf16 v[44:47], v[136:139], v[164:167], v[44:47]
    ds_read_b64_tr_b16 a[88:89], v12 offset:16384
    ds_read2_b32 v[94:95], v239 offset0:130 offset1:131
    v_mfma_f32_16x16x32_bf16 v[44:47], v[140:143], v[160:163], v[44:47]
    v_cvt_pk_bf16_f32 v202, v52, v53
    v_mfma_f32_16x16x32_bf16 v[40:43], v[128:131], v[168:171], v[40:43]
    ds_read_b64_tr_b16 a[90:91], v12 offset:18432
    v_mfma_f32_16x16x32_bf16 v[40:43], v[132:135], v[164:167], v[40:43]
    ds_read_b64_tr_b16 a[92:93], v13 offset:16384
    v_mfma_f32_16x16x32_bf16 v[40:43], v[136:139], v[160:163], v[40:43]
    v_cvt_pk_bf16_f32 v203, v54, v55
    v_mfma_f32_16x16x32_bf16 v[36:39], v[128:131], v[164:167], v[36:39]
    ds_read_b64_tr_b16 a[94:95], v13 offset:18432
    v_mfma_f32_16x16x32_bf16 v[36:39], v[132:135], v[160:163], v[36:39]
    buffer_store_dwordx2 v[202:203], v8, s[44:47], s6 offen offset:2560 sc1
    v_mfma_f32_16x16x32_bf16 v[32:35], v[128:131], v[160:163], v[32:35]
    s_waitcnt lgkmcnt(3)
    v_mfma_f32_16x16x32_bf16 v[60:63], v[248:251], v[124:127], 0
    s_waitcnt lgkmcnt(0)
    s_lshl_b32 s14, s90, 17
    v_mfma_f32_16x16x32_bf16 v[60:63], v[64:67], v[124:127], v[60:63]
    s_add_u32 m0, s73, 147456
    ds_read_b128 v[160:163], v245 offset:2048
    v_mfma_f32_16x16x32_bf16 v[60:63], v[68:71], v[120:123], v[60:63]
    buffer_load_dwordx4 v4, s[52:55], s14 offen offset:0 lds
    v_mfma_f32_16x16x32_bf16 v[60:63], v[72:75], v[116:119], v[60:63]
    v_cvt_pk_bf16_f32 v200, v48, v49
    ds_read2_b32 v[128:129], v236 offset0:16 offset1:17
    v_mfma_f32_16x16x32_bf16 v[60:63], v[76:79], v[112:115], v[60:63]
    v_cvt_pk_bf16_f32 v201, v50, v51
    v_mfma_f32_16x16x32_bf16 v[60:63], v[80:83], v[108:111], v[60:63]
    ds_read2_b32 v[130:131], v236 offset0:18 offset1:19
    v_mfma_f32_16x16x32_bf16 v[60:63], v[84:87], v[104:107], v[60:63]
    buffer_store_dwordx2 v[200:201], v8, s[44:47], s6 offen offset:2048 sc1
    v_mfma_f32_16x16x32_bf16 v[60:63], v[88:91], v[100:103], v[60:63]
    ds_read_b128 v[164:167], v245 offset:6144
    v_mfma_f32_16x16x32_bf16 v[60:63], v[92:95], v[96:99], v[60:63]
    v_cvt_pk_bf16_f32 v198, v44, v45
    v_mfma_f32_16x16x32_bf16 v[56:59], v[248:251], v[120:123], 0
    ds_read2_b32 v[132:133], v236 offset0:144 offset1:145
    v_mfma_f32_16x16x32_bf16 v[56:59], v[64:67], v[120:123], v[56:59]
    ds_read2_b32 v[134:135], v236 offset0:146 offset1:147
    v_mfma_f32_16x16x32_bf16 v[56:59], v[68:71], v[116:119], v[56:59]
    v_cvt_pk_bf16_f32 v199, v46, v47
    v_mfma_f32_16x16x32_bf16 v[56:59], v[72:75], v[112:115], v[56:59]
    ds_read_b128 v[168:171], v245 offset:10240
    v_mfma_f32_16x16x32_bf16 v[56:59], v[76:79], v[108:111], v[56:59]
    ds_read2_b32 v[136:137], v237 offset0:16 offset1:17
    v_mfma_f32_16x16x32_bf16 v[56:59], v[80:83], v[104:107], v[56:59]
    buffer_store_dwordx2 v[198:199], v8, s[44:47], s6 offen offset:1536 sc1
    v_mfma_f32_16x16x32_bf16 v[56:59], v[84:87], v[100:103], v[56:59]
    ds_read2_b32 v[138:139], v237 offset0:18 offset1:19
    v_mfma_f32_16x16x32_bf16 v[56:59], v[88:91], v[96:99], v[56:59]
    v_cvt_pk_bf16_f32 v196, v40, v41
    v_mfma_f32_16x16x32_bf16 v[52:55], v[248:251], v[116:119], 0
    s_add_u32 m0, s73, 147456
    ds_read_b128 v[172:175], v245 offset:14336
    v_mfma_f32_16x16x32_bf16 v[52:55], v[64:67], v[116:119], v[52:55]
    buffer_load_dwordx4 v5, s[52:55], s14 offen offset:1024 lds
    v_mfma_f32_16x16x32_bf16 v[52:55], v[68:71], v[112:115], v[52:55]
    v_cvt_pk_bf16_f32 v197, v42, v43
    v_mfma_f32_16x16x32_bf16 v[52:55], v[72:75], v[108:111], v[52:55]
    ds_read2_b32 v[140:141], v237 offset0:144 offset1:145
    v_mfma_f32_16x16x32_bf16 v[52:55], v[76:79], v[104:107], v[52:55]
    buffer_store_dwordx2 v[196:197], v8, s[44:47], s6 offen offset:1024 sc1
    v_mfma_f32_16x16x32_bf16 v[52:55], v[80:83], v[100:103], v[52:55]
    ds_read2_b32 v[142:143], v237 offset0:146 offset1:147
    v_mfma_f32_16x16x32_bf16 v[52:55], v[84:87], v[96:99], v[52:55]
    ds_read_b128 v[176:179], v245 offset:18432
    v_mfma_f32_16x16x32_bf16 v[48:51], v[248:251], v[112:115], 0
    v_cvt_pk_bf16_f32 v194, v36, v37
    v_mfma_f32_16x16x32_bf16 v[48:51], v[64:67], v[112:115], v[48:51]
    ds_read2_b32 v[144:145], v238 offset0:16 offset1:17
    v_mfma_f32_16x16x32_bf16 v[48:51], v[68:71], v[108:111], v[48:51]
    v_cvt_pk_bf16_f32 v195, v38, v39
    v_mfma_f32_16x16x32_bf16 v[48:51], v[72:75], v[104:107], v[48:51]
    ds_read2_b32 v[146:147], v238 offset0:18 offset1:19
    v_mfma_f32_16x16x32_bf16 v[48:51], v[76:79], v[100:103], v[48:51]
    ds_read_b128 v[180:183], v245 offset:22528
    v_mfma_f32_16x16x32_bf16 v[48:51], v[80:83], v[96:99], v[48:51]
    buffer_store_dwordx2 v[194:195], v8, s[44:47], s6 offen offset:512 sc1
    v_mfma_f32_16x16x32_bf16 v[44:47], v[248:251], v[108:111], 0
    ds_read2_b32 v[148:149], v238 offset0:144 offset1:145
    v_mfma_f32_16x16x32_bf16 v[44:47], v[64:67], v[108:111], v[44:47]
    v_cvt_pk_bf16_f32 v192, v32, v33
    v_mfma_f32_16x16x32_bf16 v[44:47], v[68:71], v[104:107], v[44:47]
    ds_read2_b32 v[150:151], v238 offset0:146 offset1:147
    v_mfma_f32_16x16x32_bf16 v[44:47], v[72:75], v[100:103], v[44:47]
    v_cvt_pk_bf16_f32 v193, v34, v35
    v_mfma_f32_16x16x32_bf16 v[44:47], v[76:79], v[96:99], v[44:47]
    s_add_u32 m0, s73, 147456
    v_mfma_f32_16x16x32_bf16 v[40:43], v[248:251], v[104:107], 0
    buffer_load_dwordx4 v6, s[52:55], s14 offen offset:2048 lds
    v_mfma_f32_16x16x32_bf16 v[40:43], v[64:67], v[104:107], v[40:43]
    buffer_store_dwordx2 v[192:193], v8, s[44:47], s6 offen offset:0 sc1
    v_mfma_f32_16x16x32_bf16 v[40:43], v[68:71], v[100:103], v[40:43]
    ds_read_b128 v[184:187], v245 offset:26624
    v_mfma_f32_16x16x32_bf16 v[40:43], v[72:75], v[96:99], v[40:43]
    ds_read2_b32 v[152:153], v239 offset0:16 offset1:17
    v_mfma_f32_16x16x32_bf16 v[36:39], v[248:251], v[100:103], 0
    ds_read2_b32 v[154:155], v239 offset0:18 offset1:19
    v_mfma_f32_16x16x32_bf16 v[36:39], v[64:67], v[100:103], v[36:39]
    ds_read_b128 v[188:191], v245 offset:30720
    v_mfma_f32_16x16x32_bf16 v[36:39], v[68:71], v[96:99], v[36:39]
    ds_read2_b32 v[156:157], v239 offset0:144 offset1:145
    v_mfma_f32_16x16x32_bf16 v[32:35], v[248:251], v[96:99], 0
    ds_read2_b32 v[158:159], v239 offset0:146 offset1:147
    v_mfma_f32_16x16x32_bf16 v[32:35], v[64:67], v[96:99], v[32:35]
    s_waitcnt lgkmcnt(12)
    v_mfma_f32_16x16x32_bf16 v[32:35], v[128:131], v[160:163], v[32:35]
    ds_read_b128 v[96:99], v246 offset:2048
    v_mfma_f32_16x16x32_bf16 v[36:39], v[132:135], v[160:163], v[36:39]
    ds_read2_b32 v[64:65], v236 offset0:32 offset1:33
    v_mfma_f32_16x16x32_bf16 v[36:39], v[128:131], v[164:167], v[36:39]
    s_barrier
    v_mfma_f32_16x16x32_bf16 v[40:43], v[128:131], v[168:171], v[40:43]
    s_add_u32 s13, s12, 49152
    ds_read2_b32 v[66:67], v236 offset0:34 offset1:35
    v_mfma_f32_16x16x32_bf16 v[40:43], v[132:135], v[164:167], v[40:43]
    ds_read_b128 v[100:103], v246 offset:6144
    v_mfma_f32_16x16x32_bf16 v[40:43], v[136:139], v[160:163], v[40:43]
    s_add_u32 m0, s73, 147456
    ds_read2_b32 v[68:69], v236 offset0:160 offset1:161
    v_mfma_f32_16x16x32_bf16 v[44:47], v[140:143], v[160:163], v[44:47]
    buffer_load_dwordx4 v7, s[52:55], s14 offen offset:3072 lds
    v_mfma_f32_16x16x32_bf16 v[44:47], v[136:139], v[164:167], v[44:47]
    s_add_u32 m0, s74, 8352
    ds_read2_b32 v[70:71], v236 offset0:162 offset1:163
    v_mfma_f32_16x16x32_bf16 v[44:47], v[132:135], v[168:171], v[44:47]
    buffer_load_dwordx4 v240, s[48:51], s13 offen offset:0 lds
    v_mfma_f32_16x16x32_bf16 v[44:47], v[128:131], v[172:175], v[44:47]
    s_waitcnt lgkmcnt(6)
    v_mfma_f32_16x16x32_bf16 v[48:51], v[128:131], v[176:179], v[48:51]
    ds_read_b128 v[104:107], v246 offset:10240
    v_mfma_f32_16x16x32_bf16 v[48:51], v[132:135], v[172:175], v[48:51]
    ds_read2_b32 v[72:73], v237 offset0:32 offset1:33
    v_mfma_f32_16x16x32_bf16 v[48:51], v[136:139], v[168:171], v[48:51]
    ds_read2_b32 v[74:75], v237 offset0:34 offset1:35
    v_mfma_f32_16x16x32_bf16 v[48:51], v[140:143], v[164:167], v[48:51]
    s_add_u32 m0, s74, 8352
    ds_read_b128 v[108:111], v246 offset:14336
    v_mfma_f32_16x16x32_bf16 v[48:51], v[144:147], v[160:163], v[48:51]
    buffer_load_dwordx4 v240, s[48:51], s13 offen offset:1024 lds
    v_mfma_f32_16x16x32_bf16 v[52:55], v[148:151], v[160:163], v[52:55]
    ds_read2_b32 v[76:77], v237 offset0:160 offset1:161
    v_mfma_f32_16x16x32_bf16 v[52:55], v[144:147], v[164:167], v[52:55]
    ds_read2_b32 v[78:79], v237 offset0:162 offset1:163
    v_mfma_f32_16x16x32_bf16 v[52:55], v[140:143], v[168:171], v[52:55]
    ds_read_b128 v[112:115], v246 offset:18432
    v_mfma_f32_16x16x32_bf16 v[52:55], v[136:139], v[172:175], v[52:55]
    s_lshl_b32 s14, s91, 17
    v_mfma_f32_16x16x32_bf16 v[52:55], v[132:135], v[176:179], v[52:55]
    s_add_u32 m0, s73, 0
    ds_read2_b32 v[80:81], v238 offset0:32 offset1:33
    v_mfma_f32_16x16x32_bf16 v[52:55], v[128:131], v[180:183], v[52:55]
    buffer_load_dwordx4 v4, s[52:55], s14 offen offset:0 lds
    v_mfma_f32_16x16x32_bf16 v[56:59], v[128:131], v[184:187], v[56:59]
    s_add_u32 m0, s74, 8352
    ds_read2_b32 v[82:83], v238 offset0:34 offset1:35
    v_mfma_f32_16x16x32_bf16 v[56:59], v[132:135], v[180:183], v[56:59]
    buffer_load_dwordx4 v240, s[48:51], s13 offen offset:2048 lds
    v_mfma_f32_16x16x32_bf16 v[56:59], v[136:139], v[176:179], v[56:59]
    ds_read_b128 v[116:119], v246 offset:22528
    v_mfma_f32_16x16x32_bf16 v[56:59], v[140:143], v[172:175], v[56:59]
    ds_read2_b32 v[84:85], v238 offset0:160 offset1:161
    v_mfma_f32_16x16x32_bf16 v[56:59], v[144:147], v[168:171], v[56:59]
    ds_read2_b32 v[86:87], v238 offset0:162 offset1:163
    v_mfma_f32_16x16x32_bf16 v[56:59], v[148:151], v[164:167], v[56:59]
    ds_read_b128 v[120:123], v246 offset:26624
    v_mfma_f32_16x16x32_bf16 v[56:59], v[152:155], v[160:163], v[56:59]
    ds_read2_b32 v[88:89], v239 offset0:32 offset1:33
    v_mfma_f32_16x16x32_bf16 v[60:63], v[156:159], v[160:163], v[60:63]
    ds_read2_b32 v[90:91], v239 offset0:34 offset1:35
    v_mfma_f32_16x16x32_bf16 v[60:63], v[152:155], v[164:167], v[60:63]
    s_add_u32 m0, s74, 8352
    v_mfma_f32_16x16x32_bf16 v[60:63], v[148:151], v[168:171], v[60:63]
    buffer_load_dwordx4 v240, s[48:51], s13 offen offset:3072 lds
    v_mfma_f32_16x16x32_bf16 v[60:63], v[144:147], v[172:175], v[60:63]
    s_add_u32 m0, s73, 0
    ds_read_b128 v[124:127], v246 offset:30720
    v_mfma_f32_16x16x32_bf16 v[60:63], v[140:143], v[176:179], v[60:63]
    buffer_load_dwordx4 v5, s[52:55], s14 offen offset:1024 lds
    v_mfma_f32_16x16x32_bf16 v[60:63], v[136:139], v[180:183], v[60:63]
    ds_read2_b32 v[92:93], v239 offset0:160 offset1:161
    v_mfma_f32_16x16x32_bf16 v[60:63], v[132:135], v[184:187], v[60:63]
    ds_read2_b32 v[94:95], v239 offset0:162 offset1:163
    v_mfma_f32_16x16x32_bf16 v[60:63], v[128:131], v[188:191], v[60:63]
    s_waitcnt lgkmcnt(12)
    v_mfma_f32_16x16x32_bf16 v[32:35], v[64:67], v[96:99], v[32:35]
    ds_read_b128 v[160:163], v247 offset:2048
    v_mfma_f32_16x16x32_bf16 v[36:39], v[68:71], v[96:99], v[36:39]
    v_mfma_f32_16x16x32_bf16 v[36:39], v[64:67], v[100:103], v[36:39]
    ds_read2_b32 v[128:129], v236 offset0:48 offset1:49
    v_mfma_f32_16x16x32_bf16 v[40:43], v[64:67], v[104:107], v[40:43]
    ds_read2_b32 v[130:131], v236 offset0:50 offset1:51
    v_mfma_f32_16x16x32_bf16 v[40:43], v[68:71], v[100:103], v[40:43]
    ds_read_b128 v[164:167], v247 offset:6144
    v_mfma_f32_16x16x32_bf16 v[40:43], v[72:75], v[96:99], v[40:43]
    ds_read2_b32 v[132:133], v236 offset0:176 offset1:177
    v_mfma_f32_16x16x32_bf16 v[44:47], v[76:79], v[96:99], v[44:47]
    ds_read2_b32 v[134:135], v236 offset0:178 offset1:179
    v_mfma_f32_16x16x32_bf16 v[44:47], v[72:75], v[100:103], v[44:47]
    s_add_u32 m0, s73, 0
    v_mfma_f32_16x16x32_bf16 v[44:47], v[68:71], v[104:107], v[44:47]
    buffer_load_dwordx4 v6, s[52:55], s14 offen offset:2048 lds
    v_mfma_f32_16x16x32_bf16 v[44:47], v[64:67], v[108:111], v[44:47]
    v_mov_b32 v9, 24
    buffer_load_ushort v9, v9, s[56:59], s70 offen
    s_waitcnt lgkmcnt(6)
    v_mfma_f32_16x16x32_bf16 v[48:51], v[64:67], v[112:115], v[48:51]
    ds_read_b128 v[168:171], v247 offset:10240
    v_mfma_f32_16x16x32_bf16 v[48:51], v[68:71], v[108:111], v[48:51]
    ds_read2_b32 v[136:137], v237 offset0:48 offset1:49
    v_mfma_f32_16x16x32_bf16 v[48:51], v[72:75], v[104:107], v[48:51]
    ds_read2_b32 v[138:139], v237 offset0:50 offset1:51
    v_mfma_f32_16x16x32_bf16 v[48:51], v[76:79], v[100:103], v[48:51]
    ds_read_b128 v[172:175], v247 offset:14336
    v_mfma_f32_16x16x32_bf16 v[48:51], v[80:83], v[96:99], v[48:51]
    v_mfma_f32_16x16x32_bf16 v[52:55], v[84:87], v[96:99], v[52:55]
    ds_read2_b32 v[140:141], v237 offset0:176 offset1:177
    v_mfma_f32_16x16x32_bf16 v[52:55], v[80:83], v[100:103], v[52:55]
    ds_read2_b32 v[142:143], v237 offset0:178 offset1:179
    v_mfma_f32_16x16x32_bf16 v[52:55], v[76:79], v[104:107], v[52:55]
    ds_read_b128 v[176:179], v247 offset:18432
    v_mfma_f32_16x16x32_bf16 v[52:55], v[72:75], v[108:111], v[52:55]
    s_add_u32 m0, s73, 0
    v_mfma_f32_16x16x32_bf16 v[52:55], v[68:71], v[112:115], v[52:55]
    buffer_load_dwordx4 v7, s[52:55], s14 offen offset:3072 lds
    v_mfma_f32_16x16x32_bf16 v[52:55], v[64:67], v[116:119], v[52:55]
    ds_read2_b32 v[144:145], v238 offset0:48 offset1:49
    v_mfma_f32_16x16x32_bf16 v[56:59], v[64:67], v[120:123], v[56:59]
    ds_read2_b32 v[146:147], v238 offset0:50 offset1:51
    v_mfma_f32_16x16x32_bf16 v[56:59], v[68:71], v[116:119], v[56:59]
    ds_read_b128 v[180:183], v247 offset:22528
    v_mfma_f32_16x16x32_bf16 v[56:59], v[72:75], v[112:115], v[56:59]
    v_mfma_f32_16x16x32_bf16 v[56:59], v[76:79], v[108:111], v[56:59]
    ds_read2_b32 v[148:149], v238 offset0:176 offset1:177
    v_mfma_f32_16x16x32_bf16 v[56:59], v[80:83], v[104:107], v[56:59]
    ds_read2_b32 v[150:151], v238 offset0:178 offset1:179
    v_mfma_f32_16x16x32_bf16 v[56:59], v[84:87], v[100:103], v[56:59]
    ds_read_b128 v[184:187], v247 offset:26624
    v_mfma_f32_16x16x32_bf16 v[56:59], v[88:91], v[96:99], v[56:59]
    ds_read2_b32 v[152:153], v239 offset0:48 offset1:49
    v_mfma_f32_16x16x32_bf16 v[60:63], v[92:95], v[96:99], v[60:63]
    ds_read2_b32 v[154:155], v239 offset0:50 offset1:51
    v_mfma_f32_16x16x32_bf16 v[60:63], v[88:91], v[100:103], v[60:63]
    s_lshl_b32 s14, s92, 17
    v_mfma_f32_16x16x32_bf16 v[60:63], v[84:87], v[104:107], v[60:63]
L_pl_X_4:
    s_cbranch_execz L_wret
    s_add_u32 m0, s73, 16384
    v_mfma_f32_16x16x32_bf16 v[60:63], v[80:83], v[108:111], v[60:63]
    buffer_load_dwordx4 v4, s[52:55], s14 offen offset:0 lds
    v_mfma_f32_16x16x32_bf16 v[60:63], v[76:79], v[112:115], v[60:63]
    ds_read_b128 v[188:191], v247 offset:30720
    v_mfma_f32_16x16x32_bf16 v[60:63], v[72:75], v[116:119], v[60:63]
    ds_read2_b32 v[156:157], v239 offset0:176 offset1:177
    v_mfma_f32_16x16x32_bf16 v[60:63], v[68:71], v[120:123], v[60:63]
    ds_read2_b32 v[158:159], v239 offset0:178 offset1:179
    v_mfma_f32_16x16x32_bf16 v[60:63], v[64:67], v[124:127], v[60:63]
    s_waitcnt lgkmcnt(12)
    v_mfma_f32_16x16x32_bf16 v[32:35], v[128:131], v[160:163], v[32:35]
    ds_read_b128 v[96:99], v244 offset:0
    v_mfma_f32_16x16x32_bf16 v[36:39], v[132:135], v[160:163], v[36:39]
    ds_read2_b32 v[64:65], v236 offset0:64 offset1:65
    v_mfma_f32_16x16x32_bf16 v[36:39], v[128:131], v[164:167], v[36:39]
    ds_read2_b32 v[66:67], v236 offset0:66 offset1:67
    v_mfma_f32_16x16x32_bf16 v[40:43], v[128:131], v[168:171], v[40:43]
    ds_read_b128 v[100:103], v244 offset:4096
    v_mfma_f32_16x16x32_bf16 v[40:43], v[132:135], v[164:167], v[40:43]
    ds_read2_b32 v[68:69], v236 offset0:192 offset1:193
    v_mfma_f32_16x16x32_bf16 v[40:43], v[136:139], v[160:163], v[40:43]
    ds_read2_b32 v[70:71], v236 offset0:194 offset1:195
    v_mfma_f32_16x16x32_bf16 v[44:47], v[140:143], v[160:163], v[44:47]
    s_add_u32 m0, s73, 16384
    ds_read_b128 v[104:107], v244 offset:8192
    v_mfma_f32_16x16x32_bf16 v[44:47], v[136:139], v[164:167], v[44:47]
    buffer_load_dwordx4 v5, s[52:55], s14 offen offset:1024 lds
    s_waitcnt vmcnt(11)
    v_mfma_f32_16x16x32_bf16 v[44:47], v[132:135], v[168:171], v[44:47]
    ds_read_b64_tr_b16 a[96:97], v10 offset:16384
    v_mfma_f32_16x16x32_bf16 v[44:47], v[128:131], v[172:175], v[44:47]
    ds_read2_b32 v[72:73], v237 offset0:64 offset1:65
    s_waitcnt lgkmcnt(9)
    v_mfma_f32_16x16x32_bf16 v[48:51], v[128:131], v[176:179], v[48:51]
    ds_read_b64_tr_b16 a[98:99], v10 offset:18432
    v_mfma_f32_16x16x32_bf16 v[48:51], v[132:135], v[172:175], v[48:51]
    ds_read_b64_tr_b16 a[100:101], v11 offset:16384
    v_mfma_f32_16x16x32_bf16 v[48:51], v[136:139], v[168:171], v[48:51]
    ds_read_b64_tr_b16 a[102:103], v11 offset:18432
    ds_read2_b32 v[74:75], v237 offset0:66 offset1:67
    v_mfma_f32_16x16x32_bf16 v[48:51], v[140:143], v[164:167], v[48:51]
    ds_read_b128 v[108:111], v244 offset:12288
    v_mfma_f32_16x16x32_bf16 v[48:51], v[144:147], v[160:163], v[48:51]
    ds_read_b64_tr_b16 a[104:105], v12 offset:16384
    v_mfma_f32_16x16x32_bf16 v[52:55], v[148:151], v[160:163], v[52:55]
    ds_read_b64_tr_b16 a[106:107], v12 offset:18432
    ds_read2_b32 v[76:77], v237 offset0:192 offset1:193
    v_mfma_f32_16x16x32_bf16 v[52:55], v[144:147], v[164:167], v[52:55]
    s_waitcnt vmcnt(6)
    ds_read2_b32 v[78:79], v237 offset0:194 offset1:195
    v_mfma_f32_16x16x32_bf16 v[52:55], v[140:143], v[168:171], v[52:55]
    ds_read_b64_tr_b16 a[108:109], v13 offset:16384
    ds_read_b128 v[112:115], v244 offset:16384
    v_mfma_f32_16x16x32_bf16 v[52:55], v[136:139], v[172:175], v[52:55]
    s_add_u32 m0, s73, 16384
    ds_read_b64_tr_b16 a[110:111], v13 offset:18432
    v_mfma_f32_16x16x32_bf16 v[52:55], v[132:135], v[176:179], v[52:55]
    buffer_load_dwordx4 v6, s[52:55], s14 offen offset:2048 lds
    v_mfma_f32_16x16x32_bf16 v[52:55], v[128:131], v[180:183], v[52:55]
    ds_read_b128 v[212:215], v241 offset:8352
    ds_read2_b32 v[80:81], v238 offset0:64 offset1:65
    v_mfma_f32_16x16x32_bf16 v[56:59], v[128:131], v[184:187], v[56:59]
    ds_read_b32 v216, v241 offset:8368
    ds_read2_b32 v[82:83], v238 offset0:66 offset1:67
    v_mfma_f32_16x16x32_bf16 v[56:59], v[132:135], v[180:183], v[56:59]
    ds_read_b128 v[116:119], v244 offset:20480
    v_mfma_f32_16x16x32_bf16 v[56:59], v[136:139], v[176:179], v[56:59]
    ds_read_b128 v[218:221], v241 offset:9376
    v_mfma_f32_16x16x32_bf16 v[56:59], v[140:143], v[172:175], v[56:59]
    ds_read2_b32 v[84:85], v238 offset0:192 offset1:193
    v_mfma_f32_16x16x32_bf16 v[56:59], v[144:147], v[168:171], v[56:59]
    ds_read2_b32 v[86:87], v238 offset0:194 offset1:195
    v_mfma_f32_16x16x32_bf16 v[56:59], v[148:151], v[164:167], v[56:59]
    ds_read_b32 v222, v241 offset:9392
    v_mfma_f32_16x16x32_bf16 v[56:59], v[152:155], v[160:163], v[56:59]
    ds_read_b128 v[120:123], v244 offset:24576
    v_mfma_f32_16x16x32_bf16 v[60:63], v[156:159], v[160:163], v[60:63]
    ds_read_b128 v[224:227], v241 offset:10400
    ds_read2_b32 v[88:89], v239 offset0:64 offset1:65
    v_mfma_f32_16x16x32_bf16 v[60:63], v[152:155], v[164:167], v[60:63]
    ds_read_b32 v228, v241 offset:10416
    ds_read2_b32 v[90:91], v239 offset0:66 offset1:67
    v_mfma_f32_16x16x32_bf16 v[60:63], v[148:151], v[168:171], v[60:63]
    s_add_u32 m0, s73, 16384
    ds_read_b128 v[124:127], v244 offset:28672
    v_mfma_f32_16x16x32_bf16 v[60:63], v[144:147], v[172:175], v[60:63]
    buffer_load_dwordx4 v7, s[52:55], s14 offen offset:3072 lds
    v_mfma_f32_16x16x32_bf16 v[60:63], v[140:143], v[176:179], v[60:63]
    ds_read_b128 v[230:233], v241 offset:11424
    v_mfma_f32_16x16x32_bf16 v[60:63], v[136:139], v[180:183], v[60:63]
    ds_read2_b32 v[92:93], v239 offset0:192 offset1:193
    v_mfma_f32_16x16x32_bf16 v[60:63], v[132:135], v[184:187], v[60:63]
    ds_read_b32 v234, v241 offset:11440
    ds_read2_b32 v[94:95], v239 offset0:194 offset1:195
    v_mfma_f32_16x16x32_bf16 v[60:63], v[128:131], v[188:191], v[60:63]
    s_waitcnt lgkmcnt(15)
    v_mfma_f32_16x16x32_bf16 v[32:35], v[64:67], v[96:99], v[32:35]
    ds_read_b128 v[160:163], v245 offset:0
    v_mfma_f32_16x16x32_bf16 v[36:39], v[68:71], v[96:99], v[36:39]
    ds_read2_b32 v[128:129], v236 offset0:80 offset1:81
    v_mfma_f32_16x16x32_bf16 v[36:39], v[64:67], v[100:103], v[36:39]
    ds_read2_b32 v[130:131], v236 offset0:82 offset1:83
    v_mfma_f32_16x16x32_bf16 v[40:43], v[64:67], v[104:107], v[40:43]
    ds_read_b128 v[164:167], v245 offset:4096
    v_mfma_f32_16x16x32_bf16 v[40:43], v[68:71], v[100:103], v[40:43]
    s_waitcnt lgkmcnt(5)
    v_mfma_f32_16x16x32_bf16 v[40:43], v[72:75], v[96:99], v[40:43]
    s_lshl_b32 s14, s93, 17
    v_mfma_f32_16x16x32_bf16 v[44:47], v[76:79], v[96:99], v[44:47]
    s_add_u32 m0, s73, 147456
    ds_read2_b32 v[132:133], v236 offset0:208 offset1:209
    v_mfma_f32_16x16x32_bf16 v[44:47], v[72:75], v[100:103], v[44:47]
    buffer_load_dwordx4 v4, s[52:55], s14 offen offset:0 lds
    v_mfma_f32_16x16x32_bf16 v[44:47], v[68:71], v[104:107], v[44:47]
    ds_write_b16 v242, v212 offset:12480
    v_mfma_f32_16x16x32_bf16 v[44:47], v[64:67], v[108:111], v[44:47]
    ds_read2_b32 v[134:135], v236 offset0:210 offset1:211
    s_waitcnt lgkmcnt(7)
    v_mfma_f32_16x16x32_bf16 v[48:51], v[64:67], v[112:115], v[48:51]
    v_alignbit_b32 v212, v213, v212, 16
    ds_read_b128 v[168:171], v245 offset:8192
    v_mfma_f32_16x16x32_bf16 v[48:51], v[68:71], v[108:111], v[48:51]
    ds_read2_b32 v[136:137], v237 offset0:80 offset1:81
    v_mfma_f32_16x16x32_bf16 v[48:51], v[72:75], v[104:107], v[48:51]
    ds_read2_b32 v[138:139], v237 offset0:82 offset1:83
    v_mfma_f32_16x16x32_bf16 v[48:51], v[76:79], v[100:103], v[48:51]
    v_alignbit_b32 v213, v214, v213, 16
    ds_read_b128 v[172:175], v245 offset:12288
    v_mfma_f32_16x16x32_bf16 v[48:51], v[80:83], v[96:99], v[48:51]
    ds_read2_b32 v[140:141], v237 offset0:208 offset1:209
    v_mfma_f32_16x16x32_bf16 v[52:55], v[84:87], v[96:99], v[52:55]
    v_alignbit_b32 v214, v215, v214, 16
    ds_read2_b32 v[142:143], v237 offset0:210 offset1:211
    v_mfma_f32_16x16x32_bf16 v[52:55], v[80:83], v[100:103], v[52:55]
    v_alignbit_b32 v215, v216, v215, 16
    ds_read_b128 v[176:179], v245 offset:16384
    v_mfma_f32_16x16x32_bf16 v[52:55], v[76:79], v[104:107], v[52:55]
    ds_write_b128 v241, v[212:215] offset:12512
    v_mfma_f32_16x16x32_bf16 v[52:55], v[72:75], v[108:111], v[52:55]
    s_add_u32 m0, s73, 147456
    ds_read2_b32 v[144:145], v238 offset0:80 offset1:81
    v_mfma_f32_16x16x32_bf16 v[52:55], v[68:71], v[112:115], v[52:55]
    buffer_load_dwordx4 v5, s[52:55], s14 offen offset:1024 lds
    v_mfma_f32_16x16x32_bf16 v[52:55], v[64:67], v[116:119], v[52:55]
    v_alignbit_b32 v218, v219, v218, 16
    ds_read2_b32 v[146:147], v238 offset0:82 offset1:83
    v_mfma_f32_16x16x32_bf16 v[56:59], v[64:67], v[120:123], v[56:59]
    v_alignbit_b32 v219, v220, v219, 16
    ds_read_b128 v[180:183], v245 offset:20480
    v_mfma_f32_16x16x32_bf16 v[56:59], v[68:71], v[116:119], v[56:59]
    v_alignbit_b32 v220, v221, v220, 16
    ds_read2_b32 v[148:149], v238 offset0:208 offset1:209
    v_mfma_f32_16x16x32_bf16 v[56:59], v[72:75], v[112:115], v[56:59]
    v_alignbit_b32 v221, v222, v221, 16
    ds_read2_b32 v[150:151], v238 offset0:210 offset1:211
    v_mfma_f32_16x16x32_bf16 v[56:59], v[76:79], v[108:111], v[56:59]
    ds_write_b128 v241, v[218:221] offset:13536
    v_mfma_f32_16x16x32_bf16 v[56:59], v[80:83], v[104:107], v[56:59]
    s_waitcnt vmcnt(6)
    ds_read_b128 v[184:187], v245 offset:24576
    v_mfma_f32_16x16x32_bf16 v[56:59], v[84:87], v[100:103], v[56:59]
    v_add_u32 v10, -131072, v10
    ds_read2_b32 v[152:153], v239 offset0:80 offset1:81
    v_mfma_f32_16x16x32_bf16 v[56:59], v[88:91], v[96:99], v[56:59]
    ds_read_b64_tr_b16 a[112:113], v10 offset:0
    v_mfma_f32_16x16x32_bf16 v[60:63], v[92:95], v[96:99], v[60:63]
    ds_read_b64_tr_b16 a[114:115], v10 offset:2048
    v_mfma_f32_16x16x32_bf16 v[60:63], v[88:91], v[100:103], v[60:63]
    v_add_u32 v11, -131072, v11
    ds_read2_b32 v[154:155], v239 offset0:82 offset1:83
    v_mfma_f32_16x16x32_bf16 v[60:63], v[84:87], v[104:107], v[60:63]
    s_add_u32 m0, s73, 147456
    ds_read_b64_tr_b16 a[116:117], v11 offset:0
    v_mfma_f32_16x16x32_bf16 v[60:63], v[80:83], v[108:111], v[60:63]
    buffer_load_dwordx4 v6, s[52:55], s14 offen offset:2048 lds
    ds_read_b64_tr_b16 a[118:119], v11 offset:2048
    v_mfma_f32_16x16x32_bf16 v[60:63], v[76:79], v[112:115], v[60:63]
    v_add_u32 v12, -131072, v12
    ds_read_b128 v[188:191], v245 offset:28672
    v_mfma_f32_16x16x32_bf16 v[60:63], v[72:75], v[116:119], v[60:63]
    ds_read_b64_tr_b16 a[120:121], v12 offset:0
    ds_read2_b32 v[156:157], v239 offset0:208 offset1:209
    v_mfma_f32_16x16x32_bf16 v[60:63], v[68:71], v[120:123], v[60:63]
    ds_read_b64_tr_b16 a[122:123], v12 offset:2048
    ds_read2_b32 v[158:159], v239 offset0:210 offset1:211
    v_mfma_f32_16x16x32_bf16 v[60:63], v[64:67], v[124:127], v[60:63]
    v_add_u32 v13, -131072, v13
    s_waitcnt lgkmcnt(15)
    v_mfma_f32_16x16x32_bf16 v[32:35], v[128:131], v[160:163], v[32:35]
    ds_read_b64_tr_b16 a[124:125], v13 offset:0
    v_mfma_f32_16x16x32_bf16 v[36:39], v[132:135], v[160:163], v[36:39]
    ds_read_b64_tr_b16 a[126:127], v13 offset:2048
    v_mfma_f32_16x16x32_bf16 v[36:39], v[128:131], v[164:167], v[36:39]
    v_alignbit_b32 v224, v225, v224, 16
    ds_read_b128 v[96:99], v246 offset:0
    v_mfma_f32_16x16x32_bf16 v[40:43], v[128:131], v[168:171], v[40:43]
    v_alignbit_b32 v225, v226, v225, 16
    ds_read2_b32 v[64:65], v236 offset0:96 offset1:97
    v_mfma_f32_16x16x32_bf16 v[40:43], v[132:135], v[164:167], v[40:43]
    ds_read2_b32 v[66:67], v236 offset0:98 offset1:99
    v_mfma_f32_16x16x32_bf16 v[40:43], v[136:139], v[160:163], v[40:43]
    v_alignbit_b32 v226, v227, v226, 16
    ds_read_b128 v[100:103], v246 offset:4096
    v_mfma_f32_16x16x32_bf16 v[44:47], v[140:143], v[160:163], v[44:47]
    s_add_u32 m0, s73, 147456
    ds_read2_b32 v[68:69], v236 offset0:224 offset1:225
    v_mfma_f32_16x16x32_bf16 v[44:47], v[136:139], v[164:167], v[44:47]
    buffer_load_dwordx4 v7, s[52:55], s14 offen offset:3072 lds
    v_mfma_f32_16x16x32_bf16 v[44:47], v[132:135], v[168:171], v[44:47]
    v_alignbit_b32 v227, v228, v227, 16
    ds_read2_b32 v[70:71], v236 offset0:226 offset1:227
    v_mfma_f32_16x16x32_bf16 v[44:47], v[128:131], v[172:175], v[44:47]
    ds_read_b128 v[104:107], v246 offset:8192
    s_waitcnt lgkmcnt(9)
    v_mfma_f32_16x16x32_bf16 v[48:51], v[128:131], v[176:179], v[48:51]
    ds_write_b128 v241, v[224:227] offset:14560
    v_mfma_f32_16x16x32_bf16 v[48:51], v[132:135], v[172:175], v[48:51]
    ds_read2_b32 v[72:73], v237 offset0:96 offset1:97
    v_mfma_f32_16x16x32_bf16 v[48:51], v[136:139], v[168:171], v[48:51]
    v_alignbit_b32 v230, v231, v230, 16
    ds_read2_b32 v[74:75], v237 offset0:98 offset1:99
    v_mfma_f32_16x16x32_bf16 v[48:51], v[140:143], v[164:167], v[48:51]
    ds_read_b128 v[108:111], v246 offset:12288
    v_mfma_f32_16x16x32_bf16 v[48:51], v[144:147], v[160:163], v[48:51]
    v_alignbit_b32 v231, v232, v231, 16
    v_mfma_f32_16x16x32_bf16 v[52:55], v[148:151], v[160:163], v[52:55]
    ds_read2_b32 v[76:77], v237 offset0:224 offset1:225
    v_mfma_f32_16x16x32_bf16 v[52:55], v[144:147], v[164:167], v[52:55]
    v_alignbit_b32 v232, v233, v232, 16
    ds_read2_b32 v[78:79], v237 offset0:226 offset1:227
    v_mfma_f32_16x16x32_bf16 v[52:55], v[140:143], v[168:171], v[52:55]
    s_waitcnt lgkmcnt(13)
    s_lshl_b32 s14, s94, 17
    v_mfma_f32_16x16x32_bf16 v[52:55], v[136:139], v[172:175], v[52:55]
    s_add_u32 m0, s73, 0
    ds_read_b128 v[112:115], v246 offset:16384
    v_mfma_f32_16x16x32_bf16 v[52:55], v[132:135], v[176:179], v[52:55]
    buffer_load_dwordx4 v4, s[52:55], s14 offen offset:0 lds
    v_mfma_f32_16x16x32_bf16 v[52:55], v[128:131], v[180:183], v[52:55]
    v_alignbit_b32 v233, v234, v233, 16
    ds_read2_b32 v[80:81], v238 offset0:96 offset1:97
    v_mfma_f32_16x16x32_bf16 v[56:59], v[128:131], v[184:187], v[56:59]
    ds_write_b128 v241, v[230:233] offset:15584
    v_mfma_f32_16x16x32_bf16 v[56:59], v[132:135], v[180:183], v[56:59]
    ds_read2_b32 v[82:83], v238 offset0:98 offset1:99
    v_mfma_f32_16x16x32_bf16 v[56:59], v[136:139], v[176:179], v[56:59]
    ds_read_b128 v[116:119], v246 offset:20480
    v_mfma_f32_16x16x32_bf16 v[56:59], v[140:143], v[172:175], v[56:59]
    ds_read2_b32 v[84:85], v238 offset0:224 offset1:225
    v_mfma_f32_16x16x32_bf16 v[56:59], v[144:147], v[168:171], v[56:59]
    v_lshl_or_b32 v9, v9, 16, v9
    ds_read2_b32 v[86:87], v238 offset0:226 offset1:227
    v_mfma_f32_16x16x32_bf16 v[56:59], v[148:151], v[164:167], v[56:59]
    ds_read_b128 v[120:123], v246 offset:24576
    v_mfma_f32_16x16x32_bf16 v[56:59], v[152:155], v[160:163], v[56:59]
    ds_read2_b32 v[88:89], v239 offset0:96 offset1:97
    v_mfma_f32_16x16x32_bf16 v[60:63], v[156:159], v[160:163], v[60:63]
    v_and_b32 v248, v9, v208
    v_mfma_f32_16x16x32_bf16 v[60:63], v[152:155], v[164:167], v[60:63]
    v_and_b32 v249, v9, v209
    ds_read2_b32 v[90:91], v239 offset0:98 offset1:99
    v_mfma_f32_16x16x32_bf16 v[60:63], v[148:151], v[168:171], v[60:63]
    s_add_u32 m0, s73, 0
    ds_read_b128 v[124:127], v246 offset:28672
    v_mfma_f32_16x16x32_bf16 v[60:63], v[144:147], v[172:175], v[60:63]
    buffer_load_dwordx4 v5, s[52:55], s14 offen offset:1024 lds
    v_mfma_f32_16x16x32_bf16 v[60:63], v[140:143], v[176:179], v[60:63]
    v_and_b32 v250, v9, v210
    v_mfma_f32_16x16x32_bf16 v[60:63], v[136:139], v[180:183], v[60:63]
    ds_read2_b32 v[92:93], v239 offset0:224 offset1:225
    v_mfma_f32_16x16x32_bf16 v[60:63], v[132:135], v[184:187], v[60:63]
    v_and_b32 v251, v9, v211
    ds_read2_b32 v[94:95], v239 offset0:226 offset1:227
    v_mfma_f32_16x16x32_bf16 v[60:63], v[128:131], v[188:191], v[60:63]
    s_waitcnt lgkmcnt(13)
    v_mfma_f32_16x16x32_bf16 v[32:35], v[64:67], v[96:99], v[32:35]
    ds_read_b128 v[160:163], v247 offset:0
    v_mfma_f32_16x16x32_bf16 v[36:39], v[68:71], v[96:99], v[36:39]
    s_waitcnt vmcnt(6)
    ds_read_b128 v[164:167], v247 offset:4096
    v_mfma_f32_16x16x32_bf16 v[36:39], v[64:67], v[100:103], v[36:39]
    ds_read_b64_tr_b16 a[128:129], v10 offset:16384
    v_mfma_f32_16x16x32_bf16 v[40:43], v[64:67], v[104:107], v[40:43]
    ds_read_b64_tr_b16 a[130:131], v10 offset:18432
    ds_read_b128 v[168:171], v247 offset:8192
    v_mfma_f32_16x16x32_bf16 v[40:43], v[68:71], v[100:103], v[40:43]
    ds_read_b128 v[172:175], v247 offset:12288
    v_mfma_f32_16x16x32_bf16 v[40:43], v[72:75], v[96:99], v[40:43]
    ds_read_b64_tr_b16 a[132:133], v11 offset:16384
    ds_read_b128 v[176:179], v247 offset:16384
    v_mfma_f32_16x16x32_bf16 v[44:47], v[76:79], v[96:99], v[44:47]
    s_add_u32 m0, s73, 0
    ds_read_b64_tr_b16 a[134:135], v11 offset:18432
    v_mfma_f32_16x16x32_bf16 v[44:47], v[72:75], v[100:103], v[44:47]
    buffer_load_dwordx4 v6, s[52:55], s14 offen offset:2048 lds
    v_mfma_f32_16x16x32_bf16 v[44:47], v[68:71], v[104:107], v[44:47]
    ds_read_b64_tr_b16 a[136:137], v12 offset:16384
    ds_read_b128 v[180:183], v247 offset:20480
    v_mfma_f32_16x16x32_bf16 v[44:47], v[64:67], v[108:111], v[44:47]
    ds_read_b64_tr_b16 a[138:139], v12 offset:18432
    s_waitcnt lgkmcnt(12)
    v_mfma_f32_16x16x32_bf16 v[48:51], v[64:67], v[112:115], v[48:51]
    ds_read_b128 v[184:187], v247 offset:24576
    ds_read_b128 v[188:191], v247 offset:28672
    v_mfma_f32_16x16x32_bf16 v[48:51], v[68:71], v[108:111], v[48:51]
    ds_read_b64_tr_b16 a[140:141], v13 offset:16384
    ds_read2_b32 v[128:129], v236 offset0:112 offset1:113
    v_mfma_f32_16x16x32_bf16 v[48:51], v[72:75], v[104:107], v[48:51]
    ds_read_b64_tr_b16 a[142:143], v13 offset:18432
    v_mfma_f32_16x16x32_bf16 v[48:51], v[76:79], v[100:103], v[48:51]
    ds_read2_b32 v[130:131], v236 offset0:114 offset1:115
    v_mfma_f32_16x16x32_bf16 v[48:51], v[80:83], v[96:99], v[48:51]
    ds_read2_b32 v[132:133], v236 offset0:240 offset1:241
    v_mfma_f32_16x16x32_bf16 v[52:55], v[84:87], v[96:99], v[52:55]
    ds_read2_b32 v[134:135], v236 offset0:242 offset1:243
    v_mfma_f32_16x16x32_bf16 v[52:55], v[80:83], v[100:103], v[52:55]
    ds_read2_b32 v[136:137], v237 offset0:112 offset1:113
    v_mfma_f32_16x16x32_bf16 v[52:55], v[76:79], v[104:107], v[52:55]
    s_add_u32 s6, s12, 4751360
    ds_read2_b32 v[138:139], v237 offset0:114 offset1:115
    v_mfma_f32_16x16x32_bf16 v[52:55], v[72:75], v[108:111], v[52:55]
    s_add_u32 m0, s73, 0
    ds_read2_b32 v[140:141], v237 offset0:240 offset1:241
    v_mfma_f32_16x16x32_bf16 v[52:55], v[68:71], v[112:115], v[52:55]
    buffer_load_dwordx4 v7, s[52:55], s14 offen offset:3072 lds
    v_mfma_f32_16x16x32_bf16 v[52:55], v[64:67], v[116:119], v[52:55]
    v_xor_b32 v244, 64, v244
    ds_read2_b32 v[142:143], v237 offset0:242 offset1:243
    v_mfma_f32_16x16x32_bf16 v[56:59], v[64:67], v[120:123], v[56:59]
    ds_read2_b32 v[144:145], v238 offset0:112 offset1:113
    v_mfma_f32_16x16x32_bf16 v[56:59], v[68:71], v[116:119], v[56:59]
    ds_read2_b32 v[146:147], v238 offset0:114 offset1:115
    v_mfma_f32_16x16x32_bf16 v[56:59], v[72:75], v[112:115], v[56:59]
    ds_read2_b32 v[148:149], v238 offset0:240 offset1:241
    v_mfma_f32_16x16x32_bf16 v[56:59], v[76:79], v[108:111], v[56:59]
    v_xor_b32 v245, 64, v245
    ds_read2_b32 v[150:151], v238 offset0:242 offset1:243
    v_mfma_f32_16x16x32_bf16 v[56:59], v[80:83], v[104:107], v[56:59]
    ds_read2_b32 v[152:153], v239 offset0:112 offset1:113
    v_mfma_f32_16x16x32_bf16 v[56:59], v[84:87], v[100:103], v[56:59]
    ds_read2_b32 v[154:155], v239 offset0:114 offset1:115
    v_mfma_f32_16x16x32_bf16 v[56:59], v[88:91], v[96:99], v[56:59]
    ds_read2_b32 v[156:157], v239 offset0:240 offset1:241
    v_mfma_f32_16x16x32_bf16 v[60:63], v[92:95], v[96:99], v[60:63]
    v_xor_b32 v246, 64, v246
    ds_read2_b32 v[158:159], v239 offset0:242 offset1:243
    v_mfma_f32_16x16x32_bf16 v[60:63], v[88:91], v[100:103], v[60:63]
    s_waitcnt lgkmcnt(15)
    s_lshl_b32 s14, s95, 17
    v_mfma_f32_16x16x32_bf16 v[60:63], v[84:87], v[104:107], v[60:63]
    s_add_u32 m0, s73, 16384
    v_add_u32 v236, 8320, v236
    v_mfma_f32_16x16x32_bf16 v[60:63], v[80:83], v[108:111], v[60:63]
    buffer_load_dwordx4 v4, s[52:55], s14 offen offset:0 lds
    v_mfma_f32_16x16x32_bf16 v[60:63], v[76:79], v[112:115], v[60:63]
    v_add_u32 v237, 8320, v237
    v_mfma_f32_16x16x32_bf16 v[60:63], v[72:75], v[116:119], v[60:63]
    v_xor_b32 v247, 64, v247
    v_add_u32 v238, 8320, v238
    v_mfma_f32_16x16x32_bf16 v[60:63], v[68:71], v[120:123], v[60:63]
    v_add_u32 v239, 8320, v239
    v_mfma_f32_16x16x32_bf16 v[60:63], v[64:67], v[124:127], v[60:63]
    s_waitcnt lgkmcnt(0)
    v_mfma_f32_16x16x32_bf16 v[60:63], v[128:131], v[188:191], v[60:63]
    ds_read_b128 v[96:99], v244 offset:2048
    v_mfma_f32_16x16x32_bf16 v[60:63], v[132:135], v[184:187], v[60:63]
    ds_read2_b32 v[64:65], v236 offset0:0 offset1:1
    v_mfma_f32_16x16x32_bf16 v[60:63], v[136:139], v[180:183], v[60:63]
    ds_read2_b32 v[66:67], v236 offset0:2 offset1:3
    v_mfma_f32_16x16x32_bf16 v[60:63], v[140:143], v[176:179], v[60:63]
    ds_read_b128 v[100:103], v244 offset:6144
    v_mfma_f32_16x16x32_bf16 v[60:63], v[144:147], v[172:175], v[60:63]
    ds_read2_b32 v[68:69], v236 offset0:128 offset1:129
    v_mfma_f32_16x16x32_bf16 v[60:63], v[148:151], v[168:171], v[60:63]
    ds_read2_b32 v[70:71], v236 offset0:130 offset1:131
    v_mfma_f32_16x16x32_bf16 v[60:63], v[152:155], v[164:167], v[60:63]
    s_add_u32 m0, s73, 16384
    ds_read_b128 v[104:107], v244 offset:10240
    v_mfma_f32_16x16x32_bf16 v[60:63], v[156:159], v[160:163], v[60:63]
    buffer_load_dwordx4 v5, s[52:55], s14 offen offset:1024 lds
    v_mfma_f32_16x16x32_bf16 v[56:59], v[128:131], v[184:187], v[56:59]
    ds_read2_b32 v[72:73], v237 offset0:0 offset1:1
    v_mfma_f32_16x16x32_bf16 v[56:59], v[132:135], v[180:183], v[56:59]
    ds_read2_b32 v[74:75], v237 offset0:2 offset1:3
    v_mfma_f32_16x16x32_bf16 v[56:59], v[136:139], v[176:179], v[56:59]
    ds_read_b128 v[108:111], v244 offset:14336
    v_mfma_f32_16x16x32_bf16 v[56:59], v[140:143], v[172:175], v[56:59]
    ds_read2_b32 v[76:77], v237 offset0:128 offset1:129
    ds_read2_b32 v[78:79], v237 offset0:130 offset1:131
    v_mfma_f32_16x16x32_bf16 v[56:59], v[144:147], v[168:171], v[56:59]
    s_waitcnt vmcnt(6)
    v_cvt_pk_bf16_f32 v206, v60, v61
    v_mfma_f32_16x16x32_bf16 v[56:59], v[148:151], v[164:167], v[56:59]
    v_add_u32 v10, 131072, v10
    v_cvt_pk_bf16_f32 v207, v62, v63
    v_mfma_f32_16x16x32_bf16 v[56:59], v[152:155], v[160:163], v[56:59]
    ds_read_b64_tr_b16 a[144:145], v10 offset:16384
    ds_read_b128 v[112:115], v244 offset:18432
    v_mfma_f32_16x16x32_bf16 v[52:55], v[128:131], v[180:183], v[52:55]
    ds_read_b64_tr_b16 a[146:147], v10 offset:18432
    ds_read2_b32 v[80:81], v238 offset0:0 offset1:1
    v_mfma_f32_16x16x32_bf16 v[52:55], v[132:135], v[176:179], v[52:55]
    v_add_u32 v11, 131072, v11
    buffer_store_dwordx2 v[206:207], v8, s[44:47], s6 offen offset:3584 sc1
    v_mfma_f32_16x16x32_bf16 v[52:55], v[136:139], v[172:175], v[52:55]
    ds_read_b64_tr_b16 a[148:149], v11 offset:16384
    ds_read2_b32 v[82:83], v238 offset0:2 offset1:3
    v_mfma_f32_16x16x32_bf16 v[52:55], v[140:143], v[168:171], v[52:55]
    s_add_u32 m0, s73, 16384
    ds_read_b64_tr_b16 a[150:151], v11 offset:18432
    v_mfma_f32_16x16x32_bf16 v[52:55], v[144:147], v[164:167], v[52:55]
    buffer_load_dwordx4 v6, s[52:55], s14 offen offset:2048 lds
    v_add_u32 v12, 131072, v12
    v_mfma_f32_16x16x32_bf16 v[52:55], v[148:151], v[160:163], v[52:55]
    ds_read_b64_tr_b16 a[152:153], v12 offset:16384
    ds_read_b128 v[116:119], v244 offset:22528
    v_mfma_f32_16x16x32_bf16 v[48:51], v[128:131], v[176:179], v[48:51]
    ds_read_b64_tr_b16 a[154:155], v12 offset:18432
    ds_read2_b32 v[84:85], v238 offset0:128 offset1:129
    v_mfma_f32_16x16x32_bf16 v[48:51], v[132:135], v[172:175], v[48:51]
    v_add_u32 v13, 131072, v13
    ds_read2_b32 v[86:87], v238 offset0:130 offset1:131
    v_mfma_f32_16x16x32_bf16 v[48:51], v[136:139], v[168:171], v[48:51]
    ds_read_b64_tr_b16 a[156:157], v13 offset:16384
    ds_read_b128 v[120:123], v244 offset:26624
    v_mfma_f32_16x16x32_bf16 v[48:51], v[140:143], v[164:167], v[48:51]
    ds_read_b64_tr_b16 a[158:159], v13 offset:18432
    ds_read2_b32 v[88:89], v239 offset0:0 offset1:1
    v_mfma_f32_16x16x32_bf16 v[48:51], v[144:147], v[160:163], v[48:51]
    v_cvt_pk_bf16_f32 v204, v56, v57
    ds_read2_b32 v[90:91], v239 offset0:2 offset1:3
    v_mfma_f32_16x16x32_bf16 v[44:47], v[128:131], v[172:175], v[44:47]
    v_cvt_pk_bf16_f32 v205, v58, v59
    ds_read_b128 v[124:127], v244 offset:30720
    v_mfma_f32_16x16x32_bf16 v[44:47], v[132:135], v[168:171], v[44:47]
    buffer_store_dwordx2 v[204:205], v8, s[44:47], s6 offen offset:3072 sc1
    v_mfma_f32_16x16x32_bf16 v[44:47], v[136:139], v[164:167], v[44:47]
    ds_read2_b32 v[92:93], v239 offset0:128 offset1:129
    ds_read2_b32 v[94:95], v239 offset0:130 offset1:131
    v_mfma_f32_16x16x32_bf16 v[44:47], v[140:143], v[160:163], v[44:47]
    v_cvt_pk_bf16_f32 v202, v52, v53
    v_mfma_f32_16x16x32_bf16 v[40:43], v[128:131], v[168:171], v[40:43]
    s_add_u32 m0, s73, 16384
    v_mfma_f32_16x16x32_bf16 v[40:43], v[132:135], v[164:167], v[40:43]
    buffer_load_dwordx4 v7, s[52:55], s14 offen offset:3072 lds
    v_mfma_f32_16x16x32_bf16 v[40:43], v[136:139], v[160:163], v[40:43]
    v_cvt_pk_bf16_f32 v203, v54, v55
    v_mfma_f32_16x16x32_bf16 v[36:39], v[128:131], v[164:167], v[36:39]
    v_mfma_f32_16x16x32_bf16 v[36:39], v[132:135], v[160:163], v[36:39]
    buffer_store_dwordx2 v[202:203], v8, s[44:47], s6 offen offset:2560 sc1
    v_mfma_f32_16x16x32_bf16 v[32:35], v[128:131], v[160:163], v[32:35]
    s_waitcnt lgkmcnt(0)
    v_mfma_f32_16x16x32_bf16 v[60:63], v[248:251], v[124:127], 0
    ds_read_b128 v[160:163], v245 offset:2048
    v_mfma_f32_16x16x32_bf16 v[60:63], v[64:67], v[124:127], v[60:63]
    v_cvt_pk_bf16_f32 v200, v48, v49
    v_mfma_f32_16x16x32_bf16 v[60:63], v[68:71], v[120:123], v[60:63]
    ds_read2_b32 v[128:129], v236 offset0:16 offset1:17
    v_mfma_f32_16x16x32_bf16 v[60:63], v[72:75], v[116:119], v[60:63]
    v_cvt_pk_bf16_f32 v201, v50, v51
    v_mfma_f32_16x16x32_bf16 v[60:63], v[76:79], v[112:115], v[60:63]
    ds_read2_b32 v[130:131], v236 offset0:18 offset1:19
    v_mfma_f32_16x16x32_bf16 v[60:63], v[80:83], v[108:111], v[60:63]
    buffer_store_dwordx2 v[200:201], v8, s[44:47], s6 offen offset:2048 sc1
    v_mfma_f32_16x16x32_bf16 v[60:63], v[84:87], v[104:107], v[60:63]
    s_lshl_b32 s14, s96, 17
    v_mfma_f32_16x16x32_bf16 v[60:63], v[88:91], v[100:103], v[60:63]
    s_add_u32 m0, s73, 147456
    ds_read_b128 v[164:167], v245 offset:6144
    v_mfma_f32_16x16x32_bf16 v[60:63], v[92:95], v[96:99], v[60:63]
    buffer_load_dwordx4 v4, s[52:55], s14 offen offset:0 lds
    v_mfma_f32_16x16x32_bf16 v[56:59], v[248:251], v[120:123], 0
    v_cvt_pk_bf16_f32 v198, v44, v45
    ds_read2_b32 v[132:133], v236 offset0:144 offset1:145
    v_mfma_f32_16x16x32_bf16 v[56:59], v[64:67], v[120:123], v[56:59]
    ds_read2_b32 v[134:135], v236 offset0:146 offset1:147
    v_mfma_f32_16x16x32_bf16 v[56:59], v[68:71], v[116:119], v[56:59]
    v_cvt_pk_bf16_f32 v199, v46, v47
    v_mfma_f32_16x16x32_bf16 v[56:59], v[72:75], v[112:115], v[56:59]
    ds_read_b128 v[168:171], v245 offset:10240
    v_mfma_f32_16x16x32_bf16 v[56:59], v[76:79], v[108:111], v[56:59]
    ds_read2_b32 v[136:137], v237 offset0:16 offset1:17
    v_mfma_f32_16x16x32_bf16 v[56:59], v[80:83], v[104:107], v[56:59]
    buffer_store_dwordx2 v[198:199], v8, s[44:47], s6 offen offset:1536 sc1
    v_mfma_f32_16x16x32_bf16 v[56:59], v[84:87], v[100:103], v[56:59]
    ds_read2_b32 v[138:139], v237 offset0:18 offset1:19
    v_mfma_f32_16x16x32_bf16 v[56:59], v[88:91], v[96:99], v[56:59]
    v_cvt_pk_bf16_f32 v196, v40, v41
    v_mfma_f32_16x16x32_bf16 v[52:55], v[248:251], v[116:119], 0
    ds_read_b128 v[172:175], v245 offset:14336
    v_mfma_f32_16x16x32_bf16 v[52:55], v[64:67], v[116:119], v[52:55]
    ds_read2_b32 v[140:141], v237 offset0:144 offset1:145
    v_mfma_f32_16x16x32_bf16 v[52:55], v[68:71], v[112:115], v[52:55]
    v_cvt_pk_bf16_f32 v197, v42, v43
    v_mfma_f32_16x16x32_bf16 v[52:55], v[72:75], v[108:111], v[52:55]
    ds_read2_b32 v[142:143], v237 offset0:146 offset1:147
    v_mfma_f32_16x16x32_bf16 v[52:55], v[76:79], v[104:107], v[52:55]
    buffer_store_dwordx2 v[196:197], v8, s[44:47], s6 offen offset:1024 sc1
    v_mfma_f32_16x16x32_bf16 v[52:55], v[80:83], v[100:103], v[52:55]
    s_add_u32 m0, s73, 147456
    ds_read_b128 v[176:179], v245 offset:18432
    v_mfma_f32_16x16x32_bf16 v[52:55], v[84:87], v[96:99], v[52:55]
    buffer_load_dwordx4 v5, s[52:55], s14 offen offset:1024 lds
    v_mfma_f32_16x16x32_bf16 v[48:51], v[248:251], v[112:115], 0
    v_cvt_pk_bf16_f32 v194, v36, v37
    ds_read2_b32 v[144:145], v238 offset0:16 offset1:17
    v_mfma_f32_16x16x32_bf16 v[48:51], v[64:67], v[112:115], v[48:51]
    ds_read2_b32 v[146:147], v238 offset0:18 offset1:19
    v_mfma_f32_16x16x32_bf16 v[48:51], v[68:71], v[108:111], v[48:51]
    v_cvt_pk_bf16_f32 v195, v38, v39
    ds_read_b128 v[180:183], v245 offset:22528
    v_mfma_f32_16x16x32_bf16 v[48:51], v[72:75], v[104:107], v[48:51]
    buffer_store_dwordx2 v[194:195], v8, s[44:47], s6 offen offset:512 sc1
    v_mfma_f32_16x16x32_bf16 v[48:51], v[76:79], v[100:103], v[48:51]
    v_cvt_pk_bf16_f32 v192, v32, v33
    ds_read2_b32 v[148:149], v238 offset0:144 offset1:145
    v_mfma_f32_16x16x32_bf16 v[48:51], v[80:83], v[96:99], v[48:51]
    v_cvt_pk_bf16_f32 v193, v34, v35
    ds_read2_b32 v[150:151], v238 offset0:146 offset1:147
    v_mfma_f32_16x16x32_bf16 v[44:47], v[248:251], v[108:111], 0
    s_waitcnt vmcnt(13)
    ds_read_b128 v[184:187], v245 offset:26624
    v_mfma_f32_16x16x32_bf16 v[44:47], v[64:67], v[108:111], v[44:47]
    v_add_u32 v10, -131072, v10
    ds_read2_b32 v[152:153], v239 offset0:16 offset1:17
    v_mfma_f32_16x16x32_bf16 v[44:47], v[68:71], v[104:107], v[44:47]
    ds_read_b64_tr_b16 a[160:161], v10 offset:0
    v_mfma_f32_16x16x32_bf16 v[44:47], v[72:75], v[100:103], v[44:47]
L_pl_X_5:
    s_cbranch_execz L_wret
    buffer_store_dwordx2 v[192:193], v8, s[44:47], s6 offen offset:0 sc1
    v_mfma_f32_16x16x32_bf16 v[44:47], v[76:79], v[96:99], v[44:47]
    ds_read_b64_tr_b16 a[162:163], v10 offset:2048
    v_mfma_f32_16x16x32_bf16 v[40:43], v[248:251], v[104:107], 0
    v_add_u32 v11, -131072, v11
    ds_read2_b32 v[154:155], v239 offset0:18 offset1:19
    v_mfma_f32_16x16x32_bf16 v[40:43], v[64:67], v[104:107], v[40:43]
    ds_read_b64_tr_b16 a[164:165], v11 offset:0
    v_mfma_f32_16x16x32_bf16 v[40:43], v[68:71], v[100:103], v[40:43]
    s_add_u32 m0, s73, 147456
    ds_read_b64_tr_b16 a[166:167], v11 offset:2048
    v_mfma_f32_16x16x32_bf16 v[40:43], v[72:75], v[96:99], v[40:43]
    buffer_load_dwordx4 v6, s[52:55], s14 offen offset:2048 lds
    v_add_u32 v12, -131072, v12
    v_mfma_f32_16x16x32_bf16 v[36:39], v[248:251], v[100:103], 0
    ds_read_b128 v[188:191], v245 offset:30720
    v_mfma_f32_16x16x32_bf16 v[36:39], v[64:67], v[100:103], v[36:39]
    ds_read_b64_tr_b16 a[168:169], v12 offset:0
    ds_read2_b32 v[156:157], v239 offset0:144 offset1:145
    v_mfma_f32_16x16x32_bf16 v[36:39], v[68:71], v[96:99], v[36:39]
    ds_read_b64_tr_b16 a[170:171], v12 offset:2048
    v_mfma_f32_16x16x32_bf16 v[32:35], v[248:251], v[96:99], 0
    v_add_u32 v13, -131072, v13
    ds_read2_b32 v[158:159], v239 offset0:146 offset1:147
    v_mfma_f32_16x16x32_bf16 v[32:35], v[64:67], v[96:99], v[32:35]
    ds_read_b64_tr_b16 a[172:173], v13 offset:0
    s_waitcnt lgkmcnt(15)
    v_mfma_f32_16x16x32_bf16 v[32:35], v[128:131], v[160:163], v[32:35]
    ds_read_b64_tr_b16 a[174:175], v13 offset:2048
    v_mfma_f32_16x16x32_bf16 v[36:39], v[132:135], v[160:163], v[36:39]
    ds_read_b128 v[96:99], v246 offset:2048
    v_mfma_f32_16x16x32_bf16 v[36:39], v[128:131], v[164:167], v[36:39]
    ds_read2_b32 v[64:65], v236 offset0:32 offset1:33
    v_mfma_f32_16x16x32_bf16 v[40:43], v[128:131], v[168:171], v[40:43]
    ds_read2_b32 v[66:67], v236 offset0:34 offset1:35
    v_mfma_f32_16x16x32_bf16 v[40:43], v[132:135], v[164:167], v[40:43]
    ds_read_b128 v[100:103], v246 offset:6144
    v_mfma_f32_16x16x32_bf16 v[40:43], v[136:139], v[160:163], v[40:43]
    ds_read2_b32 v[68:69], v236 offset0:160 offset1:161
    v_mfma_f32_16x16x32_bf16 v[44:47], v[140:143], v[160:163], v[44:47]
    s_add_u32 m0, s73, 147456
    v_mfma_f32_16x16x32_bf16 v[44:47], v[136:139], v[164:167], v[44:47]
    buffer_load_dwordx4 v7, s[52:55], s14 offen offset:3072 lds
    v_mfma_f32_16x16x32_bf16 v[44:47], v[132:135], v[168:171], v[44:47]
    ds_read2_b32 v[70:71], v236 offset0:162 offset1:163
    v_mfma_f32_16x16x32_bf16 v[44:47], v[128:131], v[172:175], v[44:47]
    s_waitcnt lgkmcnt(8)
    v_mfma_f32_16x16x32_bf16 v[48:51], v[128:131], v[176:179], v[48:51]
    ds_read_b128 v[104:107], v246 offset:10240
    v_mfma_f32_16x16x32_bf16 v[48:51], v[132:135], v[172:175], v[48:51]
    ds_read2_b32 v[72:73], v237 offset0:32 offset1:33
    v_mfma_f32_16x16x32_bf16 v[48:51], v[136:139], v[168:171], v[48:51]
    ds_read2_b32 v[74:75], v237 offset0:34 offset1:35
    v_mfma_f32_16x16x32_bf16 v[48:51], v[140:143], v[164:167], v[48:51]
    ds_read_b128 v[108:111], v246 offset:14336
    v_mfma_f32_16x16x32_bf16 v[48:51], v[144:147], v[160:163], v[48:51]
    ds_read2_b32 v[76:77], v237 offset0:160 offset1:161
    v_mfma_f32_16x16x32_bf16 v[52:55], v[148:151], v[160:163], v[52:55]
    ds_read2_b32 v[78:79], v237 offset0:162 offset1:163
    v_mfma_f32_16x16x32_bf16 v[52:55], v[144:147], v[164:167], v[52:55]
    ds_read_b128 v[112:115], v246 offset:18432
    v_mfma_f32_16x16x32_bf16 v[52:55], v[140:143], v[168:171], v[52:55]
    s_waitcnt lgkmcnt(13)
    s_lshl_b32 s14, s97, 17
    v_mfma_f32_16x16x32_bf16 v[52:55], v[136:139], v[172:175], v[52:55]
    s_add_u32 m0, s73, 0
    v_mfma_f32_16x16x32_bf16 v[52:55], v[132:135], v[176:179], v[52:55]
    buffer_load_dwordx4 v4, s[52:55], s14 offen offset:0 lds
    v_mfma_f32_16x16x32_bf16 v[52:55], v[128:131], v[180:183], v[52:55]
    ds_read2_b32 v[80:81], v238 offset0:32 offset1:33
    v_mfma_f32_16x16x32_bf16 v[56:59], v[128:131], v[184:187], v[56:59]
    ds_read2_b32 v[82:83], v238 offset0:34 offset1:35
    v_mfma_f32_16x16x32_bf16 v[56:59], v[132:135], v[180:183], v[56:59]
    ds_read_b128 v[116:119], v246 offset:22528
    v_mfma_f32_16x16x32_bf16 v[56:59], v[136:139], v[176:179], v[56:59]
    v_mfma_f32_16x16x32_bf16 v[56:59], v[140:143], v[172:175], v[56:59]
    ds_read2_b32 v[84:85], v238 offset0:160 offset1:161
    v_mfma_f32_16x16x32_bf16 v[56:59], v[144:147], v[168:171], v[56:59]
    ds_read2_b32 v[86:87], v238 offset0:162 offset1:163
    v_mfma_f32_16x16x32_bf16 v[56:59], v[148:151], v[164:167], v[56:59]
    ds_read_b128 v[120:123], v246 offset:26624
    v_mfma_f32_16x16x32_bf16 v[56:59], v[152:155], v[160:163], v[56:59]
    v_mfma_f32_16x16x32_bf16 v[60:63], v[156:159], v[160:163], v[60:63]
    ds_read2_b32 v[88:89], v239 offset0:32 offset1:33
    v_mfma_f32_16x16x32_bf16 v[60:63], v[152:155], v[164:167], v[60:63]
    ds_read2_b32 v[90:91], v239 offset0:34 offset1:35
    v_mfma_f32_16x16x32_bf16 v[60:63], v[148:151], v[168:171], v[60:63]
    s_add_u32 m0, s73, 0
    v_mfma_f32_16x16x32_bf16 v[60:63], v[144:147], v[172:175], v[60:63]
    buffer_load_dwordx4 v5, s[52:55], s14 offen offset:1024 lds
    v_mfma_f32_16x16x32_bf16 v[60:63], v[140:143], v[176:179], v[60:63]
    ds_read_b128 v[124:127], v246 offset:30720
    v_mfma_f32_16x16x32_bf16 v[60:63], v[136:139], v[180:183], v[60:63]
    ds_read2_b32 v[92:93], v239 offset0:160 offset1:161
    v_mfma_f32_16x16x32_bf16 v[60:63], v[132:135], v[184:187], v[60:63]
    ds_read2_b32 v[94:95], v239 offset0:162 offset1:163
    v_mfma_f32_16x16x32_bf16 v[60:63], v[128:131], v[188:191], v[60:63]
    s_waitcnt lgkmcnt(12)
    v_mfma_f32_16x16x32_bf16 v[32:35], v[64:67], v[96:99], v[32:35]
    s_waitcnt vmcnt(12)
    ds_read_b128 v[160:163], v247 offset:2048
    v_mfma_f32_16x16x32_bf16 v[36:39], v[68:71], v[96:99], v[36:39]
    ds_read2_b32 v[128:129], v236 offset0:48 offset1:49
    v_mfma_f32_16x16x32_bf16 v[36:39], v[64:67], v[100:103], v[36:39]
    ds_read_b64_tr_b16 a[176:177], v10 offset:16384
    v_mfma_f32_16x16x32_bf16 v[40:43], v[64:67], v[104:107], v[40:43]
    ds_read_b64_tr_b16 a[178:179], v10 offset:18432
    ds_read2_b32 v[130:131], v236 offset0:50 offset1:51
    v_mfma_f32_16x16x32_bf16 v[40:43], v[68:71], v[100:103], v[40:43]
    ds_read_b128 v[164:167], v247 offset:6144
    v_mfma_f32_16x16x32_bf16 v[40:43], v[72:75], v[96:99], v[40:43]
    ds_read_b64_tr_b16 a[180:181], v11 offset:16384
    v_mfma_f32_16x16x32_bf16 v[44:47], v[76:79], v[96:99], v[44:47]
    s_add_u32 m0, s73, 0
    ds_read_b64_tr_b16 a[182:183], v11 offset:18432
    v_mfma_f32_16x16x32_bf16 v[44:47], v[72:75], v[100:103], v[44:47]
    buffer_load_dwordx4 v6, s[52:55], s14 offen offset:2048 lds
    ds_read_b64_tr_b16 a[184:185], v12 offset:16384
    v_mfma_f32_16x16x32_bf16 v[44:47], v[68:71], v[104:107], v[44:47]
    ds_read2_b32 v[132:133], v236 offset0:176 offset1:177
    v_mfma_f32_16x16x32_bf16 v[44:47], v[64:67], v[108:111], v[44:47]
    ds_read_b64_tr_b16 a[186:187], v12 offset:18432
    s_waitcnt lgkmcnt(11)
    v_mfma_f32_16x16x32_bf16 v[48:51], v[64:67], v[112:115], v[48:51]
    ds_read_b64_tr_b16 a[188:189], v13 offset:16384
    v_mfma_f32_16x16x32_bf16 v[48:51], v[68:71], v[108:111], v[48:51]
    ds_read2_b32 v[134:135], v236 offset0:178 offset1:179
    v_mfma_f32_16x16x32_bf16 v[48:51], v[72:75], v[104:107], v[48:51]
    ds_read_b64_tr_b16 a[190:191], v13 offset:18432
    v_mfma_f32_16x16x32_bf16 v[48:51], v[76:79], v[100:103], v[48:51]
    ds_read_b128 v[168:171], v247 offset:10240
    v_mfma_f32_16x16x32_bf16 v[48:51], v[80:83], v[96:99], v[48:51]
    ds_read2_b32 v[136:137], v237 offset0:48 offset1:49
    v_mfma_f32_16x16x32_bf16 v[52:55], v[84:87], v[96:99], v[52:55]
    ds_read2_b32 v[138:139], v237 offset0:50 offset1:51
    v_mfma_f32_16x16x32_bf16 v[52:55], v[80:83], v[100:103], v[52:55]
    ds_read_b128 v[172:175], v247 offset:14336
    v_mfma_f32_16x16x32_bf16 v[52:55], v[76:79], v[104:107], v[52:55]
    ds_read2_b32 v[140:141], v237 offset0:176 offset1:177
    v_mfma_f32_16x16x32_bf16 v[52:55], v[72:75], v[108:111], v[52:55]
    s_add_u32 m0, s73, 0
    ds_read2_b32 v[142:143], v237 offset0:178 offset1:179
    v_mfma_f32_16x16x32_bf16 v[52:55], v[68:71], v[112:115], v[52:55]
    buffer_load_dwordx4 v7, s[52:55], s14 offen offset:3072 lds
    v_mfma_f32_16x16x32_bf16 v[52:55], v[64:67], v[116:119], v[52:55]
    ds_read_b128 v[176:179], v247 offset:18432
    v_mfma_f32_16x16x32_bf16 v[56:59], v[64:67], v[120:123], v[56:59]
    ds_read2_b32 v[144:145], v238 offset0:48 offset1:49
    v_mfma_f32_16x16x32_bf16 v[56:59], v[68:71], v[116:119], v[56:59]
    ds_read2_b32 v[146:147], v238 offset0:50 offset1:51
    v_mfma_f32_16x16x32_bf16 v[56:59], v[72:75], v[112:115], v[56:59]
    ds_read_b128 v[180:183], v247 offset:22528
    v_mfma_f32_16x16x32_bf16 v[56:59], v[76:79], v[108:111], v[56:59]
    ds_read2_b32 v[148:149], v238 offset0:176 offset1:177
    v_mfma_f32_16x16x32_bf16 v[56:59], v[80:83], v[104:107], v[56:59]
    ds_read2_b32 v[150:151], v238 offset0:178 offset1:179
    v_mfma_f32_16x16x32_bf16 v[56:59], v[84:87], v[100:103], v[56:59]
    ds_read_b128 v[184:187], v247 offset:26624
    v_mfma_f32_16x16x32_bf16 v[56:59], v[88:91], v[96:99], v[56:59]
    ds_read2_b32 v[152:153], v239 offset0:48 offset1:49
    v_mfma_f32_16x16x32_bf16 v[60:63], v[92:95], v[96:99], v[60:63]
    ds_read2_b32 v[154:155], v239 offset0:50 offset1:51
    v_mfma_f32_16x16x32_bf16 v[60:63], v[88:91], v[100:103], v[60:63]
    s_waitcnt lgkmcnt(15)
    s_lshl_b32 s14, s98, 17
    v_mfma_f32_16x16x32_bf16 v[60:63], v[84:87], v[104:107], v[60:63]
    s_add_u32 m0, s73, 16384
    v_mfma_f32_16x16x32_bf16 v[60:63], v[80:83], v[108:111], v[60:63]
    buffer_load_dwordx4 v4, s[52:55], s14 offen offset:0 lds
    v_mfma_f32_16x16x32_bf16 v[60:63], v[76:79], v[112:115], v[60:63]
    ds_read_b128 v[188:191], v247 offset:30720
    v_mfma_f32_16x16x32_bf16 v[60:63], v[72:75], v[116:119], v[60:63]
    ds_read2_b32 v[156:157], v239 offset0:176 offset1:177
    v_mfma_f32_16x16x32_bf16 v[60:63], v[68:71], v[120:123], v[60:63]
    ds_read2_b32 v[158:159], v239 offset0:178 offset1:179
    v_mfma_f32_16x16x32_bf16 v[60:63], v[64:67], v[124:127], v[60:63]
    s_waitcnt lgkmcnt(12)
    v_mfma_f32_16x16x32_bf16 v[32:35], v[128:131], v[160:163], v[32:35]
    ds_read_b128 v[96:99], v244 offset:0
    v_mfma_f32_16x16x32_bf16 v[36:39], v[132:135], v[160:163], v[36:39]
    ds_read2_b32 v[64:65], v236 offset0:64 offset1:65
    v_mfma_f32_16x16x32_bf16 v[36:39], v[128:131], v[164:167], v[36:39]
    ds_read2_b32 v[66:67], v236 offset0:66 offset1:67
    v_mfma_f32_16x16x32_bf16 v[40:43], v[128:131], v[168:171], v[40:43]
    ds_read_b128 v[100:103], v244 offset:4096
    v_mfma_f32_16x16x32_bf16 v[40:43], v[132:135], v[164:167], v[40:43]
    ds_read2_b32 v[68:69], v236 offset0:192 offset1:193
    v_mfma_f32_16x16x32_bf16 v[40:43], v[136:139], v[160:163], v[40:43]
    ds_read2_b32 v[70:71], v236 offset0:194 offset1:195
    v_mfma_f32_16x16x32_bf16 v[44:47], v[140:143], v[160:163], v[44:47]
    s_add_u32 m0, s73, 16384
    v_mfma_f32_16x16x32_bf16 v[44:47], v[136:139], v[164:167], v[44:47]
    buffer_load_dwordx4 v5, s[52:55], s14 offen offset:1024 lds
    v_mfma_f32_16x16x32_bf16 v[44:47], v[132:135], v[168:171], v[44:47]
    ds_read_b128 v[104:107], v244 offset:8192
    v_mfma_f32_16x16x32_bf16 v[44:47], v[128:131], v[172:175], v[44:47]
    ds_read2_b32 v[72:73], v237 offset0:64 offset1:65
    s_waitcnt lgkmcnt(8)
    v_mfma_f32_16x16x32_bf16 v[48:51], v[128:131], v[176:179], v[48:51]
    ds_read2_b32 v[74:75], v237 offset0:66 offset1:67
    v_mfma_f32_16x16x32_bf16 v[48:51], v[132:135], v[172:175], v[48:51]
    ds_read_b128 v[108:111], v244 offset:12288
    v_mfma_f32_16x16x32_bf16 v[48:51], v[136:139], v[168:171], v[48:51]
    s_waitcnt vmcnt(6)
    ds_read2_b32 v[76:77], v237 offset0:192 offset1:193
    v_mfma_f32_16x16x32_bf16 v[48:51], v[140:143], v[164:167], v[48:51]
    v_add_u32 v10, 131072, v10
    ds_read2_b32 v[78:79], v237 offset0:194 offset1:195
    v_mfma_f32_16x16x32_bf16 v[48:51], v[144:147], v[160:163], v[48:51]
    ds_read_b64_tr_b16 a[192:193], v10 offset:16384
    v_mfma_f32_16x16x32_bf16 v[52:55], v[148:151], v[160:163], v[52:55]
    ds_read_b64_tr_b16 a[194:195], v10 offset:18432
    v_mfma_f32_16x16x32_bf16 v[52:55], v[144:147], v[164:167], v[52:55]
    v_add_u32 v11, 131072, v11
    ds_read_b128 v[112:115], v244 offset:16384
    v_mfma_f32_16x16x32_bf16 v[52:55], v[140:143], v[168:171], v[52:55]
    ds_read_b64_tr_b16 a[196:197], v11 offset:16384
    v_mfma_f32_16x16x32_bf16 v[52:55], v[136:139], v[172:175], v[52:55]
    s_add_u32 m0, s73, 16384
    ds_read_b64_tr_b16 a[198:199], v11 offset:18432
    v_mfma_f32_16x16x32_bf16 v[52:55], v[132:135], v[176:179], v[52:55]
    buffer_load_dwordx4 v6, s[52:55], s14 offen offset:2048 lds
    v_add_u32 v12, 131072, v12
    v_mfma_f32_16x16x32_bf16 v[52:55], v[128:131], v[180:183], v[52:55]
    ds_read_b64_tr_b16 a[200:201], v12 offset:16384
    ds_read2_b32 v[80:81], v238 offset0:64 offset1:65
    v_mfma_f32_16x16x32_bf16 v[56:59], v[128:131], v[184:187], v[56:59]
    ds_read_b64_tr_b16 a[202:203], v12 offset:18432
    v_mfma_f32_16x16x32_bf16 v[56:59], v[132:135], v[180:183], v[56:59]
    v_add_u32 v13, 131072, v13
    ds_read2_b32 v[82:83], v238 offset0:66 offset1:67
    v_mfma_f32_16x16x32_bf16 v[56:59], v[136:139], v[176:179], v[56:59]
    ds_read_b64_tr_b16 a[204:205], v13 offset:16384
    v_mfma_f32_16x16x32_bf16 v[56:59], v[140:143], v[172:175], v[56:59]
    ds_read_b64_tr_b16 a[206:207], v13 offset:18432
    v_mfma_f32_16x16x32_bf16 v[56:59], v[144:147], v[168:171], v[56:59]
    ds_read_b128 v[116:119], v244 offset:20480
    v_mfma_f32_16x16x32_bf16 v[56:59], v[148:151], v[164:167], v[56:59]
    ds_read2_b32 v[84:85], v238 offset0:192 offset1:193
    v_mfma_f32_16x16x32_bf16 v[56:59], v[152:155], v[160:163], v[56:59]
    ds_read2_b32 v[86:87], v238 offset0:194 offset1:195
    v_mfma_f32_16x16x32_bf16 v[60:63], v[156:159], v[160:163], v[60:63]
    ds_read_b128 v[120:123], v244 offset:24576
    v_mfma_f32_16x16x32_bf16 v[60:63], v[152:155], v[164:167], v[60:63]
    ds_read2_b32 v[88:89], v239 offset0:64 offset1:65
    v_mfma_f32_16x16x32_bf16 v[60:63], v[148:151], v[168:171], v[60:63]
    s_add_u32 m0, s73, 16384
    ds_read2_b32 v[90:91], v239 offset0:66 offset1:67
    v_mfma_f32_16x16x32_bf16 v[60:63], v[144:147], v[172:175], v[60:63]
    buffer_load_dwordx4 v7, s[52:55], s14 offen offset:3072 lds
    v_mfma_f32_16x16x32_bf16 v[60:63], v[140:143], v[176:179], v[60:63]
    ds_read_b128 v[124:127], v244 offset:28672
    v_mfma_f32_16x16x32_bf16 v[60:63], v[136:139], v[180:183], v[60:63]
    ds_read2_b32 v[92:93], v239 offset0:192 offset1:193
    v_mfma_f32_16x16x32_bf16 v[60:63], v[132:135], v[184:187], v[60:63]
    ds_read2_b32 v[94:95], v239 offset0:194 offset1:195
    v_mfma_f32_16x16x32_bf16 v[60:63], v[128:131], v[188:191], v[60:63]
    s_waitcnt lgkmcnt(15)
    v_mfma_f32_16x16x32_bf16 v[32:35], v[64:67], v[96:99], v[32:35]
    ds_read_b128 v[160:163], v245 offset:0
    v_mfma_f32_16x16x32_bf16 v[36:39], v[68:71], v[96:99], v[36:39]
    ds_read2_b32 v[128:129], v236 offset0:80 offset1:81
    v_mfma_f32_16x16x32_bf16 v[36:39], v[64:67], v[100:103], v[36:39]
    ds_read2_b32 v[130:131], v236 offset0:82 offset1:83
    v_mfma_f32_16x16x32_bf16 v[40:43], v[64:67], v[104:107], v[40:43]
    ds_read_b128 v[164:167], v245 offset:4096
    v_mfma_f32_16x16x32_bf16 v[40:43], v[68:71], v[100:103], v[40:43]
    ds_read2_b32 v[132:133], v236 offset0:208 offset1:209
    v_mfma_f32_16x16x32_bf16 v[40:43], v[72:75], v[96:99], v[40:43]
    s_waitcnt lgkmcnt(14)
    s_lshl_b32 s14, s99, 17
    v_mfma_f32_16x16x32_bf16 v[44:47], v[76:79], v[96:99], v[44:47]
    s_add_u32 m0, s73, 147456
    v_mfma_f32_16x16x32_bf16 v[44:47], v[72:75], v[100:103], v[44:47]
    buffer_load_dwordx4 v4, s[52:55], s14 offen offset:0 lds
    v_mfma_f32_16x16x32_bf16 v[44:47], v[68:71], v[104:107], v[44:47]
    ds_read2_b32 v[134:135], v236 offset0:210 offset1:211
    v_mfma_f32_16x16x32_bf16 v[44:47], v[64:67], v[108:111], v[44:47]
    s_waitcnt lgkmcnt(6)
    v_mfma_f32_16x16x32_bf16 v[48:51], v[64:67], v[112:115], v[48:51]
    ds_read_b128 v[168:171], v245 offset:8192
    v_mfma_f32_16x16x32_bf16 v[48:51], v[68:71], v[108:111], v[48:51]
    ds_read2_b32 v[136:137], v237 offset0:80 offset1:81
    v_mfma_f32_16x16x32_bf16 v[48:51], v[72:75], v[104:107], v[48:51]
    ds_read2_b32 v[138:139], v237 offset0:82 offset1:83
    v_mfma_f32_16x16x32_bf16 v[48:51], v[76:79], v[100:103], v[48:51]
    ds_read_b128 v[172:175], v245 offset:12288
    v_mfma_f32_16x16x32_bf16 v[48:51], v[80:83], v[96:99], v[48:51]
    ds_read2_b32 v[140:141], v237 offset0:208 offset1:209
    v_mfma_f32_16x16x32_bf16 v[52:55], v[84:87], v[96:99], v[52:55]
    ds_read2_b32 v[142:143], v237 offset0:210 offset1:211
    v_mfma_f32_16x16x32_bf16 v[52:55], v[80:83], v[100:103], v[52:55]
    ds_read_b128 v[176:179], v245 offset:16384
    v_mfma_f32_16x16x32_bf16 v[52:55], v[76:79], v[104:107], v[52:55]
    ds_read2_b32 v[144:145], v238 offset0:80 offset1:81
    v_mfma_f32_16x16x32_bf16 v[52:55], v[72:75], v[108:111], v[52:55]
    s_add_u32 m0, s73, 147456
    ds_read2_b32 v[146:147], v238 offset0:82 offset1:83
    v_mfma_f32_16x16x32_bf16 v[52:55], v[68:71], v[112:115], v[52:55]
    buffer_load_dwordx4 v5, s[52:55], s14 offen offset:1024 lds
    v_mfma_f32_16x16x32_bf16 v[52:55], v[64:67], v[116:119], v[52:55]
    ds_read_b128 v[180:183], v245 offset:20480
    v_mfma_f32_16x16x32_bf16 v[56:59], v[64:67], v[120:123], v[56:59]
    ds_read2_b32 v[148:149], v238 offset0:208 offset1:209
    v_mfma_f32_16x16x32_bf16 v[56:59], v[68:71], v[116:119], v[56:59]
    ds_read2_b32 v[150:151], v238 offset0:210 offset1:211
    v_mfma_f32_16x16x32_bf16 v[56:59], v[72:75], v[112:115], v[56:59]
    ds_read_b128 v[184:187], v245 offset:24576
    v_mfma_f32_16x16x32_bf16 v[56:59], v[76:79], v[108:111], v[56:59]
    s_waitcnt vmcnt(6)
    ds_read2_b32 v[152:153], v239 offset0:80 offset1:81
    v_mfma_f32_16x16x32_bf16 v[56:59], v[80:83], v[104:107], v[56:59]
    v_add_u32 v10, -131072, v10
    ds_read2_b32 v[154:155], v239 offset0:82 offset1:83
    v_mfma_f32_16x16x32_bf16 v[56:59], v[84:87], v[100:103], v[56:59]
    ds_read_b64_tr_b16 a[208:209], v10 offset:0
    v_mfma_f32_16x16x32_bf16 v[56:59], v[88:91], v[96:99], v[56:59]
    ds_read_b64_tr_b16 a[210:211], v10 offset:2048
    v_mfma_f32_16x16x32_bf16 v[60:63], v[92:95], v[96:99], v[60:63]
    v_add_u32 v11, -131072, v11
    ds_read_b128 v[188:191], v245 offset:28672
    v_mfma_f32_16x16x32_bf16 v[60:63], v[88:91], v[100:103], v[60:63]
    ds_read_b64_tr_b16 a[212:213], v11 offset:0
    v_mfma_f32_16x16x32_bf16 v[60:63], v[84:87], v[104:107], v[60:63]
    s_add_u32 m0, s73, 147456
    ds_read_b64_tr_b16 a[214:215], v11 offset:2048
    v_mfma_f32_16x16x32_bf16 v[60:63], v[80:83], v[108:111], v[60:63]
    buffer_load_dwordx4 v6, s[52:55], s14 offen offset:2048 lds
    v_add_u32 v12, -131072, v12
    v_mfma_f32_16x16x32_bf16 v[60:63], v[76:79], v[112:115], v[60:63]
    ds_read_b64_tr_b16 a[216:217], v12 offset:0
    ds_read2_b32 v[156:157], v239 offset0:208 offset1:209
    v_mfma_f32_16x16x32_bf16 v[60:63], v[72:75], v[116:119], v[60:63]
    ds_read_b64_tr_b16 a[218:219], v12 offset:2048
    v_mfma_f32_16x16x32_bf16 v[60:63], v[68:71], v[120:123], v[60:63]
    v_add_u32 v13, -131072, v13
    ds_read2_b32 v[158:159], v239 offset0:210 offset1:211
    v_mfma_f32_16x16x32_bf16 v[60:63], v[64:67], v[124:127], v[60:63]
    ds_read_b64_tr_b16 a[220:221], v13 offset:0
    s_waitcnt lgkmcnt(15)
    v_mfma_f32_16x16x32_bf16 v[32:35], v[128:131], v[160:163], v[32:35]
    ds_read_b64_tr_b16 a[222:223], v13 offset:2048
    v_mfma_f32_16x16x32_bf16 v[36:39], v[132:135], v[160:163], v[36:39]
    ds_read_b128 v[96:99], v246 offset:0
    v_mfma_f32_16x16x32_bf16 v[36:39], v[128:131], v[164:167], v[36:39]
    ds_read2_b32 v[64:65], v236 offset0:96 offset1:97
    v_mfma_f32_16x16x32_bf16 v[40:43], v[128:131], v[168:171], v[40:43]
    ds_read2_b32 v[66:67], v236 offset0:98 offset1:99
    v_mfma_f32_16x16x32_bf16 v[40:43], v[132:135], v[164:167], v[40:43]
    ds_read_b128 v[100:103], v246 offset:4096
    v_mfma_f32_16x16x32_bf16 v[40:43], v[136:139], v[160:163], v[40:43]
    ds_read2_b32 v[68:69], v236 offset0:224 offset1:225
    v_mfma_f32_16x16x32_bf16 v[44:47], v[140:143], v[160:163], v[44:47]
    s_add_u32 m0, s73, 147456
    v_mfma_f32_16x16x32_bf16 v[44:47], v[136:139], v[164:167], v[44:47]
    buffer_load_dwordx4 v7, s[52:55], s14 offen offset:3072 lds
    v_mfma_f32_16x16x32_bf16 v[44:47], v[132:135], v[168:171], v[44:47]
    ds_read2_b32 v[70:71], v236 offset0:226 offset1:227
    v_mfma_f32_16x16x32_bf16 v[44:47], v[128:131], v[172:175], v[44:47]
    s_waitcnt lgkmcnt(8)
    v_mfma_f32_16x16x32_bf16 v[48:51], v[128:131], v[176:179], v[48:51]
    ds_read_b128 v[104:107], v246 offset:8192
    v_mfma_f32_16x16x32_bf16 v[48:51], v[132:135], v[172:175], v[48:51]
    ds_read2_b32 v[72:73], v237 offset0:96 offset1:97
    v_mfma_f32_16x16x32_bf16 v[48:51], v[136:139], v[168:171], v[48:51]
    ds_read2_b32 v[74:75], v237 offset0:98 offset1:99
    v_mfma_f32_16x16x32_bf16 v[48:51], v[140:143], v[164:167], v[48:51]
    ds_read_b128 v[108:111], v246 offset:12288
    v_mfma_f32_16x16x32_bf16 v[48:51], v[144:147], v[160:163], v[48:51]
    v_mfma_f32_16x16x32_bf16 v[52:55], v[148:151], v[160:163], v[52:55]
    ds_read2_b32 v[76:77], v237 offset0:224 offset1:225
    v_mfma_f32_16x16x32_bf16 v[52:55], v[144:147], v[164:167], v[52:55]
    ds_read2_b32 v[78:79], v237 offset0:226 offset1:227
    v_mfma_f32_16x16x32_bf16 v[52:55], v[140:143], v[168:171], v[52:55]
    ds_read_b128 v[112:115], v246 offset:16384
    v_mfma_f32_16x16x32_bf16 v[52:55], v[136:139], v[172:175], v[52:55]
    s_waitcnt lgkmcnt(13)
    s_lshl_b32 s14, s100, 17
    v_mfma_f32_16x16x32_bf16 v[52:55], v[132:135], v[176:179], v[52:55]
    s_add_u32 m0, s73, 0
    v_mfma_f32_16x16x32_bf16 v[52:55], v[128:131], v[180:183], v[52:55]
    buffer_load_dwordx4 v4, s[52:55], s14 offen offset:0 lds
    v_mfma_f32_16x16x32_bf16 v[56:59], v[128:131], v[184:187], v[56:59]
    ds_read2_b32 v[80:81], v238 offset0:96 offset1:97
    v_mfma_f32_16x16x32_bf16 v[56:59], v[132:135], v[180:183], v[56:59]
    ds_read2_b32 v[82:83], v238 offset0:98 offset1:99
    v_mfma_f32_16x16x32_bf16 v[56:59], v[136:139], v[176:179], v[56:59]
    ds_read_b128 v[116:119], v246 offset:20480
    v_mfma_f32_16x16x32_bf16 v[56:59], v[140:143], v[172:175], v[56:59]
    ds_read2_b32 v[84:85], v238 offset0:224 offset1:225
    v_mfma_f32_16x16x32_bf16 v[56:59], v[144:147], v[168:171], v[56:59]
    ds_read2_b32 v[86:87], v238 offset0:226 offset1:227
    v_mfma_f32_16x16x32_bf16 v[56:59], v[148:151], v[164:167], v[56:59]
    ds_read_b128 v[120:123], v246 offset:24576
    v_mfma_f32_16x16x32_bf16 v[56:59], v[152:155], v[160:163], v[56:59]
    ds_read2_b32 v[88:89], v239 offset0:96 offset1:97
    v_mfma_f32_16x16x32_bf16 v[60:63], v[156:159], v[160:163], v[60:63]
    ds_read2_b32 v[90:91], v239 offset0:98 offset1:99
    v_mfma_f32_16x16x32_bf16 v[60:63], v[152:155], v[164:167], v[60:63]
    s_add_u32 m0, s73, 0
    v_mfma_f32_16x16x32_bf16 v[60:63], v[148:151], v[168:171], v[60:63]
    buffer_load_dwordx4 v5, s[52:55], s14 offen offset:1024 lds
    v_mfma_f32_16x16x32_bf16 v[60:63], v[144:147], v[172:175], v[60:63]
    ds_read_b128 v[124:127], v246 offset:28672
    v_mfma_f32_16x16x32_bf16 v[60:63], v[140:143], v[176:179], v[60:63]
    ds_read2_b32 v[92:93], v239 offset0:224 offset1:225
    v_mfma_f32_16x16x32_bf16 v[60:63], v[136:139], v[180:183], v[60:63]
    v_mfma_f32_16x16x32_bf16 v[60:63], v[132:135], v[184:187], v[60:63]
    ds_read2_b32 v[94:95], v239 offset0:226 offset1:227
    v_mfma_f32_16x16x32_bf16 v[60:63], v[128:131], v[188:191], v[60:63]
    s_waitcnt lgkmcnt(12)
    v_mfma_f32_16x16x32_bf16 v[32:35], v[64:67], v[96:99], v[32:35]
    s_waitcnt vmcnt(6)
    ds_read_b128 v[160:163], v247 offset:0
    v_mfma_f32_16x16x32_bf16 v[36:39], v[68:71], v[96:99], v[36:39]
    ds_read_b64_tr_b16 a[224:225], v10 offset:16384
    s_and_b32 s4, s72, 1
    v_mfma_f32_16x16x32_bf16 v[36:39], v[64:67], v[100:103], v[36:39]
    ds_read_b128 v[164:167], v247 offset:4096
    ds_read_b128 v[168:171], v247 offset:8192
    v_mfma_f32_16x16x32_bf16 v[40:43], v[64:67], v[104:107], v[40:43]
    ds_read_b64_tr_b16 a[226:227], v10 offset:18432
    s_lshl_b32 s4, s4, 2
    v_mfma_f32_16x16x32_bf16 v[40:43], v[68:71], v[100:103], v[40:43]
    s_add_u32 m0, s73, 0
    ds_read_b64_tr_b16 a[228:229], v11 offset:16384
    ds_read_b128 v[172:175], v247 offset:12288
    v_mfma_f32_16x16x32_bf16 v[40:43], v[72:75], v[96:99], v[40:43]
    buffer_load_dwordx4 v6, s[52:55], s14 offen offset:2048 lds
    s_add_u32 s4, s4, s3
    v_mfma_f32_16x16x32_bf16 v[44:47], v[76:79], v[96:99], v[44:47]
    ds_read_b64_tr_b16 a[230:231], v11 offset:18432
    s_mul_i32 s4, s4, 18
    ds_read_b128 v[176:179], v247 offset:16384
    v_mfma_f32_16x16x32_bf16 v[44:47], v[72:75], v[100:103], v[44:47]
    ds_read_b64_tr_b16 a[232:233], v12 offset:16384
    ds_read_b128 v[180:183], v247 offset:20480
    v_mfma_f32_16x16x32_bf16 v[44:47], v[68:71], v[104:107], v[44:47]
    s_lshr_b32 s4, s4, 2
    ds_read_b128 v[184:187], v247 offset:24576
    v_mfma_f32_16x16x32_bf16 v[44:47], v[64:67], v[108:111], v[44:47]
    ds_read_b64_tr_b16 a[234:235], v12 offset:18432
    s_waitcnt lgkmcnt(13)
    v_mfma_f32_16x16x32_bf16 v[48:51], v[64:67], v[112:115], v[48:51]
    ds_read_b64_tr_b16 a[236:237], v13 offset:16384
    s_mul_i32 s4, s4, 6
    v_mfma_f32_16x16x32_bf16 v[48:51], v[68:71], v[108:111], v[48:51]
    ds_read_b64_tr_b16 a[238:239], v13 offset:18432
    ds_read_b128 v[188:191], v247 offset:28672
    v_mfma_f32_16x16x32_bf16 v[48:51], v[72:75], v[104:107], v[48:51]
    s_lshr_b32 s5, s72, 1
    ds_read2_b32 v[128:129], v236 offset0:112 offset1:113
    v_mfma_f32_16x16x32_bf16 v[48:51], v[76:79], v[100:103], v[48:51]
    s_mul_i32 s5, s5, 3
    ds_read2_b32 v[130:131], v236 offset0:114 offset1:115
    v_mfma_f32_16x16x32_bf16 v[48:51], v[80:83], v[96:99], v[48:51]
    ds_read2_b32 v[132:133], v236 offset0:240 offset1:241
    ds_read2_b32 v[134:135], v236 offset0:242 offset1:243
    v_mfma_f32_16x16x32_bf16 v[52:55], v[84:87], v[96:99], v[52:55]
    s_add_u32 m0, s73, 0
    s_lshr_b32 s5, s5, 1
    v_mfma_f32_16x16x32_bf16 v[52:55], v[80:83], v[100:103], v[52:55]
    buffer_load_dwordx4 v7, s[52:55], s14 offen offset:3072 lds
    v_mfma_f32_16x16x32_bf16 v[52:55], v[76:79], v[104:107], v[52:55]
    s_add_u32 s4, s4, s5
    ds_read2_b32 v[136:137], v237 offset0:112 offset1:113
    v_mfma_f32_16x16x32_bf16 v[52:55], v[72:75], v[108:111], v[52:55]
    v_min_u32 v28, 9, v2
    ds_read2_b32 v[138:139], v237 offset0:114 offset1:115
    v_mfma_f32_16x16x32_bf16 v[52:55], v[68:71], v[112:115], v[52:55]
    s_add_u32 s6, s12, 4767744
    ds_read2_b32 v[140:141], v237 offset0:240 offset1:241
    v_mfma_f32_16x16x32_bf16 v[52:55], v[64:67], v[116:119], v[52:55]
    v_lshrrev_b32 v29, 1, v28
    ds_read2_b32 v[142:143], v237 offset0:242 offset1:243
    v_mfma_f32_16x16x32_bf16 v[56:59], v[64:67], v[120:123], v[56:59]
    ds_read2_b32 v[144:145], v238 offset0:112 offset1:113
    v_mfma_f32_16x16x32_bf16 v[56:59], v[68:71], v[116:119], v[56:59]
    v_lshl_add_u32 v28, v29, 2, v28
    ds_read2_b32 v[146:147], v238 offset0:114 offset1:115
    v_mfma_f32_16x16x32_bf16 v[56:59], v[72:75], v[112:115], v[56:59]
    v_add_u32 v28, s4, v28
    ds_read2_b32 v[148:149], v238 offset0:240 offset1:241
    v_mfma_f32_16x16x32_bf16 v[56:59], v[76:79], v[108:111], v[56:59]
    ds_read2_b32 v[150:151], v238 offset0:242 offset1:243
    ds_read2_b32 v[152:153], v239 offset0:112 offset1:113
    v_mfma_f32_16x16x32_bf16 v[56:59], v[80:83], v[104:107], v[56:59]
    s_waitcnt lgkmcnt(14)
    s_lshl_b32 s14, s101, 17
    v_and_b32 v29, 3, v28
    v_mfma_f32_16x16x32_bf16 v[56:59], v[84:87], v[100:103], v[56:59]
    s_add_u32 m0, s73, 16384
    ds_read2_b32 v[154:155], v239 offset0:114 offset1:115
    v_mfma_f32_16x16x32_bf16 v[56:59], v[88:91], v[96:99], v[56:59]
    buffer_load_dwordx4 v4, s[52:55], s14 offen offset:0 lds
    v_lshrrev_b32 v28, 2, v28
    v_mfma_f32_16x16x32_bf16 v[60:63], v[92:95], v[96:99], v[60:63]
    ds_read2_b32 v[156:157], v239 offset0:240 offset1:241
    ds_read2_b32 v[158:159], v239 offset0:242 offset1:243
    v_mfma_f32_16x16x32_bf16 v[60:63], v[88:91], v[100:103], v[60:63]
    v_lshlrev_b32 v28, 7, v28
    v_mfma_f32_16x16x32_bf16 v[60:63], v[84:87], v[104:107], v[60:63]
    v_lshl_add_u32 v28, v29, 2, v28
    v_mfma_f32_16x16x32_bf16 v[60:63], v[80:83], v[108:111], v[60:63]
    v_mfma_f32_16x16x32_bf16 v[60:63], v[76:79], v[112:115], v[60:63]
    v_add_u32 v28, 12566528, v28
    v_mfma_f32_16x16x32_bf16 v[60:63], v[72:75], v[116:119], v[60:63]
    v_mfma_f32_16x16x32_bf16 v[60:63], v[68:71], v[120:123], v[60:63]
    v_mfma_f32_16x16x32_bf16 v[60:63], v[64:67], v[124:127], v[60:63]
    s_waitcnt lgkmcnt(0)
    v_mfma_f32_16x16x32_bf16 v[60:63], v[128:131], v[188:191], v[60:63]
    v_mfma_f32_16x16x32_bf16 v[60:63], v[132:135], v[184:187], v[60:63]
    s_add_u32 m0, s73, 16384
    v_mfma_f32_16x16x32_bf16 v[60:63], v[136:139], v[180:183], v[60:63]
    buffer_load_dwordx4 v5, s[52:55], s14 offen offset:1024 lds
    v_mfma_f32_16x16x32_bf16 v[60:63], v[140:143], v[176:179], v[60:63]
    v_mfma_f32_16x16x32_bf16 v[60:63], v[144:147], v[172:175], v[60:63]
    v_mfma_f32_16x16x32_bf16 v[60:63], v[148:151], v[168:171], v[60:63]
    v_mfma_f32_16x16x32_bf16 v[60:63], v[152:155], v[164:167], v[60:63]
    v_mfma_f32_16x16x32_bf16 v[60:63], v[156:159], v[160:163], v[60:63]
    v_mfma_f32_16x16x32_bf16 v[56:59], v[128:131], v[184:187], v[56:59]
    v_mfma_f32_16x16x32_bf16 v[56:59], v[132:135], v[180:183], v[56:59]
    v_mfma_f32_16x16x32_bf16 v[56:59], v[136:139], v[176:179], v[56:59]
    v_mfma_f32_16x16x32_bf16 v[56:59], v[140:143], v[172:175], v[56:59]
    s_add_u32 m0, s73, 16384
    v_mfma_f32_16x16x32_bf16 v[56:59], v[144:147], v[168:171], v[56:59]
    buffer_load_dwordx4 v6, s[52:55], s14 offen offset:2048 lds
    v_mfma_f32_16x16x32_bf16 v[56:59], v[148:151], v[164:167], v[56:59]
    v_cvt_pk_bf16_f32 v206, v60, v61
    v_mfma_f32_16x16x32_bf16 v[56:59], v[152:155], v[160:163], v[56:59]
    v_mfma_f32_16x16x32_bf16 v[52:55], v[128:131], v[180:183], v[52:55]
    v_mfma_f32_16x16x32_bf16 v[52:55], v[132:135], v[176:179], v[52:55]
    v_cvt_pk_bf16_f32 v207, v62, v63
    v_mfma_f32_16x16x32_bf16 v[52:55], v[136:139], v[172:175], v[52:55]
    v_mfma_f32_16x16x32_bf16 v[52:55], v[140:143], v[168:171], v[52:55]
    buffer_store_dwordx2 v[206:207], v8, s[44:47], s6 offen offset:3584 sc1
    v_mfma_f32_16x16x32_bf16 v[52:55], v[144:147], v[164:167], v[52:55]
L_pl_X_6:
    s_cbranch_execz L_wret
    v_mfma_f32_16x16x32_bf16 v[52:55], v[148:151], v[160:163], v[52:55]
    v_mfma_f32_16x16x32_bf16 v[48:51], v[128:131], v[176:179], v[48:51]
    v_cvt_pk_bf16_f32 v204, v56, v57
    v_mfma_f32_16x16x32_bf16 v[48:51], v[132:135], v[172:175], v[48:51]
    s_add_u32 m0, s73, 16384
    v_mfma_f32_16x16x32_bf16 v[48:51], v[136:139], v[168:171], v[48:51]
    buffer_load_dwordx4 v7, s[52:55], s14 offen offset:3072 lds
    v_mfma_f32_16x16x32_bf16 v[48:51], v[140:143], v[164:167], v[48:51]
    v_cvt_pk_bf16_f32 v205, v58, v59
    v_mfma_f32_16x16x32_bf16 v[48:51], v[144:147], v[160:163], v[48:51]
    v_mfma_f32_16x16x32_bf16 v[44:47], v[128:131], v[172:175], v[44:47]
    buffer_store_dwordx2 v[204:205], v8, s[44:47], s6 offen offset:3072 sc1
    v_mfma_f32_16x16x32_bf16 v[44:47], v[132:135], v[168:171], v[44:47]
    v_mfma_f32_16x16x32_bf16 v[44:47], v[136:139], v[164:167], v[44:47]
    v_mfma_f32_16x16x32_bf16 v[44:47], v[140:143], v[160:163], v[44:47]
    v_cvt_pk_bf16_f32 v202, v52, v53
    v_mfma_f32_16x16x32_bf16 v[40:43], v[128:131], v[168:171], v[40:43]
    v_mfma_f32_16x16x32_bf16 v[40:43], v[132:135], v[164:167], v[40:43]
    v_mfma_f32_16x16x32_bf16 v[40:43], v[136:139], v[160:163], v[40:43]
    v_cvt_pk_bf16_f32 v203, v54, v55
    v_mfma_f32_16x16x32_bf16 v[36:39], v[128:131], v[164:167], v[36:39]
    v_mfma_f32_16x16x32_bf16 v[36:39], v[132:135], v[160:163], v[36:39]
    buffer_store_dwordx2 v[202:203], v8, s[44:47], s6 offen offset:2560 sc1
    v_mfma_f32_16x16x32_bf16 v[32:35], v[128:131], v[160:163], v[32:35]
    buffer_load_dword v29, v28, s[44:47], 0 offen sc1
    v_cvt_pk_bf16_f32 v200, v48, v49
    v_cvt_pk_bf16_f32 v201, v50, v51
    buffer_store_dwordx2 v[200:201], v8, s[44:47], s6 offen offset:2048 sc1
    v_cvt_pk_bf16_f32 v198, v44, v45
    v_cvt_pk_bf16_f32 v199, v46, v47
    buffer_store_dwordx2 v[198:199], v8, s[44:47], s6 offen offset:1536 sc1
    v_cvt_pk_bf16_f32 v196, v40, v41
    v_cvt_pk_bf16_f32 v197, v42, v43
    buffer_store_dwordx2 v[196:197], v8, s[44:47], s6 offen offset:1024 sc1
    v_cvt_pk_bf16_f32 v194, v36, v37
    v_cvt_pk_bf16_f32 v195, v38, v39
    buffer_store_dwordx2 v[194:195], v8, s[44:47], s6 offen offset:512 sc1
    v_cvt_pk_bf16_f32 v192, v32, v33
    v_cvt_pk_bf16_f32 v193, v34, v35
    buffer_store_dwordx2 v[192:193], v8, s[44:47], s6 offen offset:0 sc1
    s_waitcnt lgkmcnt(0)
    s_barrier
L_DX:
    v_lshrrev_b32 v31, 4, v2
    v_mul_u32_u24 v24, 17408, v31
    v_and_b32 v25, 15, v2
    v_lshl_add_u32 v24, v25, 4, v24
    s_and_b32 s7, s72, 1
    s_lshl_b32 s7, s7, 2
    s_add_u32 s7, s7, s3
    s_mul_i32 s7, s7, 1253376
    s_lshr_b32 s8, s72, 1
    s_lshl_b32 s8, s8, 12
    s_add_u32 s7, s7, s8
    s_add_u32 s7, s7, 12795904
    v_add_u32 v9, s7, v24
    s_and_b32 s12, s72, 1
    s_xor_b32 s8, s12, 1
    s_lshl_b32 s8, s8, 11
    v_add_u32 v8, s8, v9
    s_lshl_b32 s11, s12, 12
    s_sub_u32 s11, s11, 2048
    s_mov_b32 s8, 12386304
    s_mul_i32 s84, s84, 69632
    s_mul_i32 s85, s85, 69632
    s_mul_i32 s86, s86, 69632
    s_mul_i32 s87, s87, 69632
    s_waitcnt vmcnt(0)
    v_cmp_ne_u32 vcc, s68, v29
    s_cbranch_vccnz L_rs_p2X
L_ok_p2X:
    buffer_load_dwordx4 v[140:143], v8, s[44:47], s84 offen offset:0 sc1
    buffer_load_dwordx4 v[144:147], v8, s[44:47], s85 offen offset:0 sc1
    buffer_load_dwordx4 v[148:151], v8, s[44:47], s84 offen offset:512 sc1
    buffer_load_dwordx4 v[152:155], v8, s[44:47], s85 offen offset:512 sc1
    buffer_load_dwordx4 v[156:159], v8, s[44:47], s84 offen offset:768 sc1
    buffer_load_dwordx4 v[160:163], v8, s[44:47], s85 offen offset:768 sc1
    buffer_load_dwordx4 v[164:167], v8, s[44:47], s84 offen offset:1024 sc1
    buffer_load_dwordx4 v[168:171], v8, s[44:47], s85 offen offset:1024 sc1
    buffer_load_dwordx4 v[172:175], v9, s[44:47], s84 offen offset:1536 sc1
    buffer_load_dwordx4 v[176:179], v9, s[44:47], s85 offen offset:1536 sc1
    s_mul_i32 s88, s88, 69632
    s_mul_i32 s89, s89, 69632
    s_mul_i32 s90, s90, 69632
    s_mul_i32 s91, s91, 69632
    s_mul_i32 s92, s92, 69632
    s_mul_i32 s93, s93, 69632
    s_mul_i32 s94, s94, 69632
    s_mul_i32 s95, s95, 69632
    s_mul_i32 s96, s96, 69632
    s_mul_i32 s97, s97, 69632
    s_mul_i32 s98, s98, 69632
    s_mul_i32 s99, s99, 69632
    s_mul_i32 s100, s100, 69632
    s_mul_i32 s101, s101, 69632
    s_mov_b32 s64, s38
    s_and_b32 s65, s39, 0xffff
    s_mov_b32 s66, 2359296
    s_mov_b32 s67, 0x20000
    s_mov_b32 s56, s16
    s_and_b32 s57, s17, 0xffff
    s_mov_b32 s58, 2359296
    s_mov_b32 s59, 0x20000
    v_add_u32 v24, 0, v2
    v_mul_u32_u24 v25, 7282, v24
    v_lshrrev_b32 v25, 16, v25
    v_mul_u32_u24 v25, 1008, v25
    v_lshl_add_u32 v14, v2, 4, v25
    v_add_u32 v24, 64, v2
    v_mul_u32_u24 v25, 7282, v24
    v_lshrrev_b32 v25, 16, v25
    v_mul_u32_u24 v25, 1008, v25
    v_lshl_add_u32 v15, v2, 4, v25
    v_add_u32 v24, 128, v2
    v_mul_u32_u24 v25, 7282, v24
    v_lshrrev_b32 v25, 16, v25
    v_mul_u32_u24 v25, 1008, v25
    v_lshl_add_u32 v16, v2, 4, v25
    v_cmp_gt_u32 vcc, 16, v2
    v_mov_b32 v25, 0x40000000
    s_nop 0
    v_cndmask_b32 v16, v25, v16, vcc
    s_and_b32 s7, s72, 1
    s_lshl_b32 s7, s7, 2
    s_add_u32 s7, s7, s3
    s_mul_i32 s7, s7, 2359296
    v_subrev_u32 v3, s7, v4
    v_and_b32 v24, 15, v2
    v_mul_u32_u24 v24, 144, v24
    v_lshrrev_b32 v25, 4, v2
    v_lshl_add_u32 v24, v25, 3, v24
    s_add_u32 s7, s73, 131072
    s_lshl_b32 s4, s12, 4
    s_add_u32 s4, s4, s7
    v_add_u32 v1, s4, v24
    s_mul_i32 s4, s12, 144
    s_sub_u32 s4, s7, s4
    v_add_u32 v24, s4, v24
    v_bfe_u32 v25, v2, 2, 3
    v_lshlrev_b32 v25, 7, v25
    v_lshrrev_b32 v31, 5, v2
    v_lshl_add_u32 v25, v31, 12, v25
    v_bfe_u32 v31, v2, 3, 2
    v_xor_b32 v31, s3, v31
    v_lshl_add_u32 v25, v31, 5, v25
    v_and_b32 v31, 3, v2
    v_lshl_add_u32 v25, v31, 3, v25
    v_add_u32 v25, 147456, v25
    buffer_load_dwordx4 v[180:183], v8, s[44:47], s86 offen offset:0 sc1
    buffer_load_dwordx4 v[184:187], v8, s[44:47], s87 offen offset:0 sc1
    buffer_load_dwordx4 v[188:191], v8, s[44:47], s86 offen offset:512 sc1
    buffer_load_dwordx4 v[192:195], v8, s[44:47], s87 offen offset:512 sc1
    buffer_load_dwordx4 v[196:199], v8, s[44:47], s86 offen offset:768 sc1
    buffer_load_dwordx4 v[200:203], v8, s[44:47], s87 offen offset:768 sc1
    buffer_load_dwordx4 v[204:207], v8, s[44:47], s86 offen offset:1024 sc1
    buffer_load_dwordx4 v[208:211], v8, s[44:47], s87 offen offset:1024 sc1
    s_lshl_b32 s7, s71, 6
    s_lshl_b32 s4, s3, 4
    s_add_u32 s7, s7, s4
    s_mul_i32 s7, s7, 1152
    s_mul_i32 s4, s72, 144
    s_add_u32 s7, s7, s4
    s_add_u32 m0, s73, 131072
    s_nop 0
    buffer_load_dwordx4 v14, s[56:59], s7 offen offset:0 lds
    buffer_load_dwordx4 v15, s[56:59], s7 offen offset:1024 lds
    buffer_load_dwordx4 v16, s[56:59], s7 offen offset:2048 lds
    buffer_load_dwordx2 v[26:27], v26, s[44:47], s8 offen sc1
    s_waitcnt vmcnt(20)
    v_mfma_f32_16x16x32_bf16 v[52:55], v[140:143], a[4:7], 0
    s_sub_u32 s4, s75, 216
    s_lshl_b32 s7, s4, 7
    v_mfma_f32_16x16x32_bf16 v[52:55], v[144:147], a[20:23], v[52:55]
    buffer_load_dwordx4 v[212:215], v9, s[44:47], s86 offen offset:1536 sc1
    v_mfma_f32_16x16x32_bf16 v[56:59], v[144:147], a[24:27], 0
    v_mfma_f32_16x16x32_bf16 v[56:59], v[140:143], a[8:11], v[56:59]
    s_lshl2_add_u32 s7, s3, s7
    s_add_u32 s7, s7, 12582912
    v_mfma_f32_16x16x32_bf16 v[60:63], v[140:143], a[12:15], 0
    buffer_load_dwordx4 v[216:219], v9, s[44:47], s87 offen offset:1536 sc1
    v_mfma_f32_16x16x32_bf16 v[60:63], v[144:147], a[28:31], v[60:63]
    v_mfma_f32_16x16x32_bf16 v[32:35], v[144:147], a[16:19], 0
    s_cmp_lt_u32 s4, 36
    s_cselect_b32 s7, s7, 0x40000000
    v_mfma_f32_16x16x32_bf16 v[32:35], v[140:143], a[0:3], v[32:35]
    s_waitcnt vmcnt(20)
    v_mfma_f32_16x16x32_bf16 v[36:39], v[148:151], a[0:3], 0
    v_mfma_f32_16x16x32_bf16 v[36:39], v[152:155], a[16:19], v[36:39]
    buffer_load_dwordx4 v[140:143], v8, s[44:47], s88 offen offset:0 sc1
    v_mfma_f32_16x16x32_bf16 v[72:75], v[152:155], a[28:31], 0
    v_min_u32 v28, 1, v2
    v_mfma_f32_16x16x32_bf16 v[72:75], v[148:151], a[12:15], v[72:75]
    v_mfma_f32_16x16x32_bf16 v[68:71], v[148:151], a[8:11], 0
    buffer_load_dwordx4 v[144:147], v8, s[44:47], s89 offen offset:0 sc1
    v_mfma_f32_16x16x32_bf16 v[68:71], v[152:155], a[24:27], v[68:71]
    v_lshlrev_b32 v28, 30, v28
    v_mfma_f32_16x16x32_bf16 v[64:67], v[152:155], a[20:23], 0
    v_mfma_f32_16x16x32_bf16 v[64:67], v[148:151], a[4:7], v[64:67]
    s_waitcnt vmcnt(20)
    v_mfma_f32_16x16x32_bf16 v[76:79], v[156:159], a[4:7], 0
    v_mov_b32 v29, s68
    v_mfma_f32_16x16x32_bf16 v[76:79], v[160:163], a[20:23], v[76:79]
    buffer_load_dwordx4 v[148:151], v8, s[44:47], s88 offen offset:512 sc1
    v_mfma_f32_16x16x32_bf16 v[80:83], v[160:163], a[24:27], 0
    buffer_store_dword v29, v28, s[44:47], s7 offen sc1
    v_mfma_f32_16x16x32_bf16 v[80:83], v[156:159], a[8:11], v[80:83]
    v_mfma_f32_16x16x32_bf16 v[84:87], v[156:159], a[12:15], 0
    buffer_load_dwordx4 v[152:155], v8, s[44:47], s89 offen offset:512 sc1
    v_mfma_f32_16x16x32_bf16 v[84:87], v[160:163], a[28:31], v[84:87]
    s_xor_b32 s7, s3, 1
    s_lshl_b32 s7, s7, 14
    v_mfma_f32_16x16x32_bf16 v[40:43], v[160:163], a[16:19], 0
    v_mfma_f32_16x16x32_bf16 v[40:43], v[156:159], a[0:3], v[40:43]
    s_waitcnt vmcnt(21)
    v_mfma_f32_16x16x32_bf16 v[44:47], v[164:167], a[0:3], 0
    s_add_u32 s7, s7, 0
    v_lshl_add_u32 v4, v2, 4, s7
    v_mfma_f32_16x16x32_bf16 v[44:47], v[168:171], a[16:19], v[44:47]
    buffer_load_dwordx4 v[156:159], v8, s[44:47], s88 offen offset:768 sc1
    v_mfma_f32_16x16x32_bf16 v[96:99], v[168:171], a[28:31], 0
    v_mfma_f32_16x16x32_bf16 v[96:99], v[164:167], a[12:15], v[96:99]
    s_xor_b32 s7, s3, 2
    s_lshl_b32 s7, s7, 14
    v_mfma_f32_16x16x32_bf16 v[92:95], v[164:167], a[8:11], 0
    buffer_load_dwordx4 v[160:163], v8, s[44:47], s89 offen offset:768 sc1
    v_mfma_f32_16x16x32_bf16 v[92:95], v[168:171], a[24:27], v[92:95]
    v_mfma_f32_16x16x32_bf16 v[88:91], v[168:171], a[20:23], 0
    s_add_u32 s7, s7, 5120
    v_lshl_add_u32 v5, v2, 4, s7
    v_mfma_f32_16x16x32_bf16 v[88:91], v[164:167], a[4:7], v[88:91]
    s_waitcnt vmcnt(21)
    v_mfma_f32_16x16x32_bf16 v[100:103], v[172:175], a[4:7], 0
    s_xor_b32 s7, s3, 3
    s_lshl_b32 s7, s7, 14
    v_mfma_f32_16x16x32_bf16 v[100:103], v[176:179], a[20:23], v[100:103]
    buffer_load_dwordx4 v[164:167], v8, s[44:47], s88 offen offset:1024 sc1
    v_mfma_f32_16x16x32_bf16 v[104:107], v[176:179], a[24:27], 0
    v_mfma_f32_16x16x32_bf16 v[104:107], v[172:175], a[8:11], v[104:107]
    s_add_u32 s7, s7, 10240
    v_lshl_add_u32 v6, v2, 4, s7
    v_mfma_f32_16x16x32_bf16 v[108:111], v[172:175], a[12:15], 0
    buffer_load_dwordx4 v[168:171], v8, s[44:47], s89 offen offset:1024 sc1
    v_mfma_f32_16x16x32_bf16 v[108:111], v[176:179], a[28:31], v[108:111]
    v_mfma_f32_16x16x32_bf16 v[48:51], v[176:179], a[16:19], 0
    s_lshl_b32 s7, s3, 14
    v_lshl_add_u32 v7, v2, 4, s7
    v_mfma_f32_16x16x32_bf16 v[48:51], v[172:175], a[0:3], v[48:51]
    s_waitcnt vmcnt(21)
    v_mfma_f32_16x16x32_bf16 v[32:35], v[180:183], a[32:35], v[32:35]
    v_mfma_f32_16x16x32_bf16 v[32:35], v[184:187], a[48:51], v[32:35]
    buffer_load_dwordx4 v[172:175], v9, s[44:47], s88 offen offset:1536 sc1
    v_mfma_f32_16x16x32_bf16 v[60:63], v[184:187], a[60:63], v[60:63]
    v_lshlrev_b32 v30, 16, v30
    v_mfma_f32_16x16x32_bf16 v[60:63], v[180:183], a[44:47], v[60:63]
    v_mfma_f32_16x16x32_bf16 v[56:59], v[180:183], a[40:43], v[56:59]
    buffer_load_dwordx4 v[176:179], v9, s[44:47], s89 offen offset:1536 sc1
    v_mfma_f32_16x16x32_bf16 v[56:59], v[184:187], a[56:59], v[56:59]
    v_mfma_f32_16x16x32_bf16 v[52:55], v[184:187], a[52:55], v[52:55]
    v_mov_b32 v112, v30
    v_mfma_f32_16x16x32_bf16 v[52:55], v[180:183], a[36:39], v[52:55]
    s_waitcnt vmcnt(21)
    v_mfma_f32_16x16x32_bf16 v[64:67], v[188:191], a[36:39], v[64:67]
    v_mfma_f32_16x16x32_bf16 v[64:67], v[192:195], a[52:55], v[64:67]
    buffer_load_dwordx4 v[180:183], v8, s[44:47], s90 offen offset:0 sc1
    v_mfma_f32_16x16x32_bf16 v[68:71], v[192:195], a[56:59], v[68:71]
    v_mov_b32 v113, v30
    v_mfma_f32_16x16x32_bf16 v[68:71], v[188:191], a[40:43], v[68:71]
    v_mfma_f32_16x16x32_bf16 v[72:75], v[188:191], a[44:47], v[72:75]
    buffer_load_dwordx4 v[184:187], v8, s[44:47], s91 offen offset:0 sc1
    v_mfma_f32_16x16x32_bf16 v[72:75], v[192:195], a[60:63], v[72:75]
    v_mfma_f32_16x16x32_bf16 v[36:39], v[192:195], a[48:51], v[36:39]
    v_mov_b32 v114, v30
    v_mfma_f32_16x16x32_bf16 v[36:39], v[188:191], a[32:35], v[36:39]
    s_waitcnt vmcnt(21)
    v_mfma_f32_16x16x32_bf16 v[40:43], v[196:199], a[32:35], v[40:43]
    v_mfma_f32_16x16x32_bf16 v[40:43], v[200:203], a[48:51], v[40:43]
    buffer_load_dwordx4 v[188:191], v8, s[44:47], s90 offen offset:512 sc1
    v_mfma_f32_16x16x32_bf16 v[84:87], v[200:203], a[60:63], v[84:87]
    v_mov_b32 v115, v30
    v_mfma_f32_16x16x32_bf16 v[84:87], v[196:199], a[44:47], v[84:87]
    v_mfma_f32_16x16x32_bf16 v[80:83], v[196:199], a[40:43], v[80:83]
    buffer_load_dwordx4 v[192:195], v8, s[44:47], s91 offen offset:512 sc1
    v_mfma_f32_16x16x32_bf16 v[80:83], v[200:203], a[56:59], v[80:83]
    v_mfma_f32_16x16x32_bf16 v[76:79], v[200:203], a[52:55], v[76:79]
    v_mfma_f32_16x16x32_bf16 v[76:79], v[196:199], a[36:39], v[76:79]
    s_waitcnt vmcnt(21)
    v_mfma_f32_16x16x32_bf16 v[88:91], v[204:207], a[36:39], v[88:91]
    v_mfma_f32_16x16x32_bf16 v[88:91], v[208:211], a[52:55], v[88:91]
    buffer_load_dwordx4 v[196:199], v8, s[44:47], s90 offen offset:768 sc1
    v_mfma_f32_16x16x32_bf16 v[92:95], v[208:211], a[56:59], v[92:95]
    v_mfma_f32_16x16x32_bf16 v[92:95], v[204:207], a[40:43], v[92:95]
    v_add_u32 v10, 131072, v10
    v_mfma_f32_16x16x32_bf16 v[96:99], v[204:207], a[44:47], v[96:99]
    buffer_load_dwordx4 v[200:203], v8, s[44:47], s91 offen offset:768 sc1
    v_mfma_f32_16x16x32_bf16 v[96:99], v[208:211], a[60:63], v[96:99]
    v_mfma_f32_16x16x32_bf16 v[44:47], v[208:211], a[48:51], v[44:47]
    v_mfma_f32_16x16x32_bf16 v[44:47], v[204:207], a[32:35], v[44:47]
    s_waitcnt vmcnt(17)
    v_mfma_f32_16x16x32_bf16 v[48:51], v[212:215], a[32:35], v[48:51]
    ds_read_b64_tr_b16 a[240:241], v10 offset:16384
    v_mfma_f32_16x16x32_bf16 v[48:51], v[216:219], a[48:51], v[48:51]
    buffer_load_dwordx4 v[204:207], v8, s[44:47], s90 offen offset:1024 sc1
    v_mfma_f32_16x16x32_bf16 v[108:111], v[216:219], a[60:63], v[108:111]
    v_mfma_f32_16x16x32_bf16 v[108:111], v[212:215], a[44:47], v[108:111]
    v_mfma_f32_16x16x32_bf16 v[104:107], v[212:215], a[40:43], v[104:107]
    buffer_load_dwordx4 v[208:211], v8, s[44:47], s91 offen offset:1024 sc1
    v_mfma_f32_16x16x32_bf16 v[104:107], v[216:219], a[56:59], v[104:107]
    ds_read_b64_tr_b16 a[242:243], v10 offset:18432
    v_mfma_f32_16x16x32_bf16 v[100:103], v[216:219], a[52:55], v[100:103]
    v_mfma_f32_16x16x32_bf16 v[100:103], v[212:215], a[36:39], v[100:103]
    s_waitcnt vmcnt(17)
    v_mfma_f32_16x16x32_bf16 v[52:55], v[140:143], a[68:71], v[52:55]
    v_mfma_f32_16x16x32_bf16 v[52:55], v[144:147], a[84:87], v[52:55]
    buffer_load_dwordx4 v[212:215], v9, s[44:47], s90 offen offset:1536 sc1
    v_mfma_f32_16x16x32_bf16 v[56:59], v[144:147], a[88:91], v[56:59]
    v_add_u32 v11, 131072, v11
    v_mfma_f32_16x16x32_bf16 v[56:59], v[140:143], a[72:75], v[56:59]
    v_mfma_f32_16x16x32_bf16 v[60:63], v[140:143], a[76:79], v[60:63]
    buffer_load_dwordx4 v[216:219], v9, s[44:47], s91 offen offset:1536 sc1
    v_mfma_f32_16x16x32_bf16 v[60:63], v[144:147], a[92:95], v[60:63]
    v_mfma_f32_16x16x32_bf16 v[32:35], v[144:147], a[80:83], v[32:35]
    v_mfma_f32_16x16x32_bf16 v[32:35], v[140:143], a[64:67], v[32:35]
    s_waitcnt vmcnt(16)
    v_mfma_f32_16x16x32_bf16 v[36:39], v[148:151], a[64:67], v[36:39]
    ds_read_b64_tr_b16 a[244:245], v11 offset:16384
    v_mfma_f32_16x16x32_bf16 v[36:39], v[152:155], a[80:83], v[36:39]
    buffer_load_dwordx4 v[140:143], v8, s[44:47], s92 offen offset:0 sc1
    v_mfma_f32_16x16x32_bf16 v[72:75], v[152:155], a[92:95], v[72:75]
    v_mfma_f32_16x16x32_bf16 v[72:75], v[148:151], a[76:79], v[72:75]
    v_mfma_f32_16x16x32_bf16 v[68:71], v[148:151], a[72:75], v[68:71]
    buffer_load_dwordx4 v[144:147], v8, s[44:47], s93 offen offset:0 sc1
    v_mfma_f32_16x16x32_bf16 v[68:71], v[152:155], a[88:91], v[68:71]
    ds_read_b64_tr_b16 a[246:247], v11 offset:18432
    v_mfma_f32_16x16x32_bf16 v[64:67], v[152:155], a[84:87], v[64:67]
    v_mfma_f32_16x16x32_bf16 v[64:67], v[148:151], a[68:71], v[64:67]
    s_waitcnt vmcnt(16)
    v_mfma_f32_16x16x32_bf16 v[76:79], v[156:159], a[68:71], v[76:79]
    v_add_u32 v12, 131072, v12
    v_mfma_f32_16x16x32_bf16 v[76:79], v[160:163], a[84:87], v[76:79]
    buffer_load_dwordx4 v[148:151], v8, s[44:47], s92 offen offset:512 sc1
    v_mfma_f32_16x16x32_bf16 v[80:83], v[160:163], a[88:91], v[80:83]
    v_mfma_f32_16x16x32_bf16 v[80:83], v[156:159], a[72:75], v[80:83]
    v_mfma_f32_16x16x32_bf16 v[84:87], v[156:159], a[76:79], v[84:87]
    buffer_load_dwordx4 v[152:155], v8, s[44:47], s93 offen offset:512 sc1
    v_mfma_f32_16x16x32_bf16 v[84:87], v[160:163], a[92:95], v[84:87]
    v_mfma_f32_16x16x32_bf16 v[40:43], v[160:163], a[80:83], v[40:43]
    ds_read_b64_tr_b16 a[248:249], v12 offset:16384
    v_mfma_f32_16x16x32_bf16 v[40:43], v[156:159], a[64:67], v[40:43]
    s_waitcnt vmcnt(16)
    v_mfma_f32_16x16x32_bf16 v[44:47], v[164:167], a[64:67], v[44:47]
    v_mfma_f32_16x16x32_bf16 v[44:47], v[168:171], a[80:83], v[44:47]
    buffer_load_dwordx4 v[156:159], v8, s[44:47], s92 offen offset:768 sc1
    v_mfma_f32_16x16x32_bf16 v[96:99], v[168:171], a[92:95], v[96:99]
    ds_read_b64_tr_b16 a[250:251], v12 offset:18432
    v_mfma_f32_16x16x32_bf16 v[96:99], v[164:167], a[76:79], v[96:99]
    v_mfma_f32_16x16x32_bf16 v[92:95], v[164:167], a[72:75], v[92:95]
    buffer_load_dwordx4 v[160:163], v8, s[44:47], s93 offen offset:768 sc1
    v_mfma_f32_16x16x32_bf16 v[92:95], v[168:171], a[88:91], v[92:95]
    v_mfma_f32_16x16x32_bf16 v[88:91], v[168:171], a[84:87], v[88:91]
    v_add_u32 v13, 131072, v13
    v_mfma_f32_16x16x32_bf16 v[88:91], v[164:167], a[68:71], v[88:91]
    s_waitcnt vmcnt(16)
    v_mfma_f32_16x16x32_bf16 v[100:103], v[172:175], a[68:71], v[100:103]
    v_mfma_f32_16x16x32_bf16 v[100:103], v[176:179], a[84:87], v[100:103]
    buffer_load_dwordx4 v[164:167], v8, s[44:47], s92 offen offset:1024 sc1
    v_mfma_f32_16x16x32_bf16 v[104:107], v[176:179], a[88:91], v[104:107]
    ds_read_b64_tr_b16 a[252:253], v13 offset:16384
    v_mfma_f32_16x16x32_bf16 v[104:107], v[172:175], a[72:75], v[104:107]
    v_mfma_f32_16x16x32_bf16 v[108:111], v[172:175], a[76:79], v[108:111]
    buffer_load_dwordx4 v[168:171], v8, s[44:47], s93 offen offset:1024 sc1
    v_mfma_f32_16x16x32_bf16 v[108:111], v[176:179], a[92:95], v[108:111]
    v_mfma_f32_16x16x32_bf16 v[48:51], v[176:179], a[80:83], v[48:51]
    ds_read_b64_tr_b16 a[254:255], v13 offset:18432
    v_mfma_f32_16x16x32_bf16 v[48:51], v[172:175], a[64:67], v[48:51]
    s_waitcnt vmcnt(16)
    v_mfma_f32_16x16x32_bf16 v[32:35], v[180:183], a[96:99], v[32:35]
    v_mfma_f32_16x16x32_bf16 v[32:35], v[184:187], a[112:115], v[32:35]
    buffer_load_dwordx4 v[172:175], v9, s[44:47], s92 offen offset:1536 sc1
    v_mfma_f32_16x16x32_bf16 v[60:63], v[184:187], a[124:127], v[60:63]
    v_mfma_f32_16x16x32_bf16 v[60:63], v[180:183], a[108:111], v[60:63]
    v_mfma_f32_16x16x32_bf16 v[56:59], v[180:183], a[104:107], v[56:59]
    buffer_load_dwordx4 v[176:179], v9, s[44:47], s93 offen offset:1536 sc1
    v_mfma_f32_16x16x32_bf16 v[56:59], v[184:187], a[120:123], v[56:59]
    ds_read_b64 v[14:15], v1 offset:0
    v_mfma_f32_16x16x32_bf16 v[52:55], v[184:187], a[116:119], v[52:55]
    ds_read_b64 v[16:17], v1 offset:32
    v_mfma_f32_16x16x32_bf16 v[52:55], v[180:183], a[100:103], v[52:55]
    s_waitcnt vmcnt(16)
    v_mfma_f32_16x16x32_bf16 v[64:67], v[188:191], a[100:103], v[64:67]
    v_add_u32 v10, -131072, v10
    v_mfma_f32_16x16x32_bf16 v[64:67], v[192:195], a[116:119], v[64:67]
    buffer_load_dwordx4 v[180:183], v8, s[44:47], s94 offen offset:0 sc1
    v_mfma_f32_16x16x32_bf16 v[68:71], v[192:195], a[120:123], v[68:71]
    v_mfma_f32_16x16x32_bf16 v[68:71], v[188:191], a[104:107], v[68:71]
    ds_read_b64 v[18:19], v1 offset:64
    v_mfma_f32_16x16x32_bf16 v[72:75], v[188:191], a[108:111], v[72:75]
    buffer_load_dwordx4 v[184:187], v8, s[44:47], s95 offen offset:0 sc1
    v_mfma_f32_16x16x32_bf16 v[72:75], v[192:195], a[124:127], v[72:75]
    ds_read_b64_tr_b16 v[220:221], v10 offset:0
    v_mfma_f32_16x16x32_bf16 v[36:39], v[192:195], a[112:115], v[36:39]
    ds_read_b64 v[20:21], v1 offset:96
    v_mfma_f32_16x16x32_bf16 v[36:39], v[188:191], a[96:99], v[36:39]
    s_waitcnt vmcnt(16)
    v_mfma_f32_16x16x32_bf16 v[40:43], v[196:199], a[96:99], v[40:43]
    ds_read_b64_tr_b16 v[222:223], v10 offset:2048
    v_mfma_f32_16x16x32_bf16 v[40:43], v[200:203], a[112:115], v[40:43]
    buffer_load_dwordx4 v[188:191], v8, s[44:47], s94 offen offset:512 sc1
    v_mfma_f32_16x16x32_bf16 v[84:87], v[200:203], a[124:127], v[84:87]
    ds_read_b64 v[22:23], v24 offset:128
    v_mfma_f32_16x16x32_bf16 v[84:87], v[196:199], a[108:111], v[84:87]
    v_mfma_f32_16x16x32_bf16 v[80:83], v[196:199], a[104:107], v[80:83]
    buffer_load_dwordx4 v[192:195], v8, s[44:47], s95 offen offset:512 sc1
    v_mfma_f32_16x16x32_bf16 v[80:83], v[200:203], a[120:123], v[80:83]
    v_mfma_f32_16x16x32_bf16 v[76:79], v[200:203], a[116:119], v[76:79]
    v_add_u32 v11, -131072, v11
    v_mfma_f32_16x16x32_bf16 v[76:79], v[196:199], a[100:103], v[76:79]
    s_waitcnt vmcnt(16)
    v_mfma_f32_16x16x32_bf16 v[88:91], v[204:207], a[100:103], v[88:91]
    v_mfma_f32_16x16x32_bf16 v[88:91], v[208:211], a[116:119], v[88:91]
    buffer_load_dwordx4 v[196:199], v8, s[44:47], s94 offen offset:768 sc1
    v_mfma_f32_16x16x32_bf16 v[92:95], v[208:211], a[120:123], v[92:95]
    v_mfma_f32_16x16x32_bf16 v[92:95], v[204:207], a[104:107], v[92:95]
    ds_read_b64_tr_b16 v[224:225], v11 offset:0
    v_mfma_f32_16x16x32_bf16 v[96:99], v[204:207], a[108:111], v[96:99]
    buffer_load_dwordx4 v[200:203], v8, s[44:47], s95 offen offset:768 sc1
    v_mfma_f32_16x16x32_bf16 v[96:99], v[208:211], a[124:127], v[96:99]
    v_mfma_f32_16x16x32_bf16 v[44:47], v[208:211], a[112:115], v[44:47]
    v_mfma_f32_16x16x32_bf16 v[44:47], v[204:207], a[96:99], v[44:47]
    s_waitcnt vmcnt(16)
    v_mfma_f32_16x16x32_bf16 v[48:51], v[212:215], a[96:99], v[48:51]
    ds_read_b64_tr_b16 v[226:227], v11 offset:2048
    v_mfma_f32_16x16x32_bf16 v[48:51], v[216:219], a[112:115], v[48:51]
    buffer_load_dwordx4 v[204:207], v8, s[44:47], s94 offen offset:1024 sc1
    v_mfma_f32_16x16x32_bf16 v[108:111], v[216:219], a[124:127], v[108:111]
    v_mfma_f32_16x16x32_bf16 v[108:111], v[212:215], a[108:111], v[108:111]
    v_mfma_f32_16x16x32_bf16 v[104:107], v[212:215], a[104:107], v[104:107]
    buffer_load_dwordx4 v[208:211], v8, s[44:47], s95 offen offset:1024 sc1
    v_mfma_f32_16x16x32_bf16 v[104:107], v[216:219], a[120:123], v[104:107]
    v_add_u32 v12, -131072, v12
    v_mfma_f32_16x16x32_bf16 v[100:103], v[216:219], a[116:119], v[100:103]
    v_mfma_f32_16x16x32_bf16 v[100:103], v[212:215], a[100:103], v[100:103]
    s_waitcnt vmcnt(16)
    v_mfma_f32_16x16x32_bf16 v[52:55], v[140:143], a[132:135], v[52:55]
    v_mfma_f32_16x16x32_bf16 v[52:55], v[144:147], a[148:151], v[52:55]
    buffer_load_dwordx4 v[212:215], v9, s[44:47], s94 offen offset:1536 sc1
    v_mfma_f32_16x16x32_bf16 v[56:59], v[144:147], a[152:155], v[56:59]
    ds_read_b64_tr_b16 v[228:229], v12 offset:0
    v_mfma_f32_16x16x32_bf16 v[56:59], v[140:143], a[136:139], v[56:59]
    v_mfma_f32_16x16x32_bf16 v[60:63], v[140:143], a[140:143], v[60:63]
    buffer_load_dwordx4 v[216:219], v9, s[44:47], s95 offen offset:1536 sc1
    v_mfma_f32_16x16x32_bf16 v[60:63], v[144:147], a[156:159], v[60:63]
    v_mfma_f32_16x16x32_bf16 v[32:35], v[144:147], a[144:147], v[32:35]
    ds_read_b64_tr_b16 v[230:231], v12 offset:2048
    v_mfma_f32_16x16x32_bf16 v[32:35], v[140:143], a[128:131], v[32:35]
    s_waitcnt vmcnt(16)
    v_mfma_f32_16x16x32_bf16 v[36:39], v[148:151], a[128:131], v[36:39]
    v_mfma_f32_16x16x32_bf16 v[36:39], v[152:155], a[144:147], v[36:39]
    buffer_load_dwordx4 v[140:143], v8, s[44:47], s96 offen offset:0 sc1
    v_mfma_f32_16x16x32_bf16 v[72:75], v[152:155], a[156:159], v[72:75]
    v_add_u32 v13, -131072, v13
    v_mfma_f32_16x16x32_bf16 v[72:75], v[148:151], a[140:143], v[72:75]
    v_mfma_f32_16x16x32_bf16 v[68:71], v[148:151], a[136:139], v[68:71]
    buffer_load_dwordx4 v[144:147], v8, s[44:47], s97 offen offset:0 sc1
    v_mfma_f32_16x16x32_bf16 v[68:71], v[152:155], a[152:155], v[68:71]
    v_mfma_f32_16x16x32_bf16 v[64:67], v[152:155], a[148:151], v[64:67]
    ds_read_b64_tr_b16 v[232:233], v13 offset:0
    v_mfma_f32_16x16x32_bf16 v[64:67], v[148:151], a[132:135], v[64:67]
    s_waitcnt vmcnt(16)
    v_mfma_f32_16x16x32_bf16 v[76:79], v[156:159], a[132:135], v[76:79]
    v_mfma_f32_16x16x32_bf16 v[76:79], v[160:163], a[148:151], v[76:79]
    buffer_load_dwordx4 v[148:151], v8, s[44:47], s96 offen offset:512 sc1
    v_mfma_f32_16x16x32_bf16 v[80:83], v[160:163], a[152:155], v[80:83]
    ds_read_b64_tr_b16 v[234:235], v13 offset:2048
    v_mfma_f32_16x16x32_bf16 v[80:83], v[156:159], a[136:139], v[80:83]
    v_mfma_f32_16x16x32_bf16 v[84:87], v[156:159], a[140:143], v[84:87]
    buffer_load_dwordx4 v[152:155], v8, s[44:47], s97 offen offset:512 sc1
    v_mfma_f32_16x16x32_bf16 v[84:87], v[160:163], a[156:159], v[84:87]
    s_mul_i32 s4, s72, 9
    s_lshr_b32 s4, s4, 1
    s_lshl_b32 s4, s4, 2
    v_min_u32 v28, 19, v2
    v_mfma_f32_16x16x32_bf16 v[40:43], v[160:163], a[144:147], v[40:43]
    v_mfma_f32_16x16x32_bf16 v[40:43], v[156:159], a[128:131], v[40:43]
    s_waitcnt vmcnt(16)
    v_mfma_f32_16x16x32_bf16 v[44:47], v[164:167], a[128:131], v[44:47]
    v_add_u32 v28, s4, v28
    v_mfma_f32_16x16x32_bf16 v[44:47], v[168:171], a[144:147], v[44:47]
    buffer_load_dwordx4 v[156:159], v8, s[44:47], s96 offen offset:768 sc1
    v_mfma_f32_16x16x32_bf16 v[96:99], v[168:171], a[156:159], v[96:99]
    v_and_b32 v29, 3, v28
    v_mfma_f32_16x16x32_bf16 v[96:99], v[164:167], a[140:143], v[96:99]
    ds_read_b64_tr_b16 v[236:237], v10 offset:16384
    v_mfma_f32_16x16x32_bf16 v[92:95], v[164:167], a[136:139], v[92:95]
    buffer_load_dwordx4 v[160:163], v8, s[44:47], s97 offen offset:768 sc1
    v_mfma_f32_16x16x32_bf16 v[92:95], v[168:171], a[152:155], v[92:95]
    v_lshrrev_b32 v28, 2, v28
    v_mfma_f32_16x16x32_bf16 v[88:91], v[168:171], a[148:151], v[88:91]
    v_lshlrev_b32 v28, 7, v28
    v_mfma_f32_16x16x32_bf16 v[88:91], v[164:167], a[132:135], v[88:91]
    s_waitcnt vmcnt(16)
    v_mfma_f32_16x16x32_bf16 v[100:103], v[172:175], a[132:135], v[100:103]
    ds_read_b64_tr_b16 v[238:239], v10 offset:18432
    v_mfma_f32_16x16x32_bf16 v[100:103], v[176:179], a[148:151], v[100:103]
    buffer_load_dwordx4 v[164:167], v8, s[44:47], s96 offen offset:1024 sc1
    v_mfma_f32_16x16x32_bf16 v[104:107], v[176:179], a[152:155], v[104:107]
    v_lshl_add_u32 v28, v29, 2, v28
    v_mfma_f32_16x16x32_bf16 v[104:107], v[172:175], a[136:139], v[104:107]
    v_add_u32 v28, 12582912, v28
    v_mfma_f32_16x16x32_bf16 v[108:111], v[172:175], a[140:143], v[108:111]
    buffer_load_dwordx4 v[168:171], v8, s[44:47], s97 offen offset:1024 sc1
    v_mfma_f32_16x16x32_bf16 v[108:111], v[176:179], a[156:159], v[108:111]
    ds_read_b64_tr_b16 v[240:241], v11 offset:16384
    v_mfma_f32_16x16x32_bf16 v[48:51], v[176:179], a[144:147], v[48:51]
    buffer_load_dword v29, v28, s[44:47], 0 offen sc1
    v_mfma_f32_16x16x32_bf16 v[48:51], v[172:175], a[128:131], v[48:51]
    s_waitcnt vmcnt(17)
    v_mfma_f32_16x16x32_bf16 v[32:35], v[180:183], a[160:163], v[32:35]
    v_mfma_f32_16x16x32_bf16 v[32:35], v[184:187], a[176:179], v[32:35]
    buffer_load_dwordx4 v[172:175], v9, s[44:47], s96 offen offset:1536 sc1
    v_mfma_f32_16x16x32_bf16 v[60:63], v[184:187], a[188:191], v[60:63]
    ds_read_b64_tr_b16 v[242:243], v11 offset:18432
    v_mfma_f32_16x16x32_bf16 v[60:63], v[180:183], a[172:175], v[60:63]
    v_mfma_f32_16x16x32_bf16 v[56:59], v[180:183], a[168:171], v[56:59]
    buffer_load_dwordx4 v[176:179], v9, s[44:47], s97 offen offset:1536 sc1
    v_mfma_f32_16x16x32_bf16 v[56:59], v[184:187], a[184:187], v[56:59]
    v_mfma_f32_16x16x32_bf16 v[52:55], v[184:187], a[180:183], v[52:55]
    ds_read_b64_tr_b16 v[244:245], v12 offset:16384
    v_mfma_f32_16x16x32_bf16 v[52:55], v[180:183], a[164:167], v[52:55]
    s_waitcnt vmcnt(17)
    v_mfma_f32_16x16x32_bf16 v[64:67], v[188:191], a[164:167], v[64:67]
    v_mfma_f32_16x16x32_bf16 v[64:67], v[192:195], a[180:183], v[64:67]
    buffer_load_dwordx4 v[180:183], v8, s[44:47], s98 offen offset:0 sc1
    v_mfma_f32_16x16x32_bf16 v[68:71], v[192:195], a[184:187], v[68:71]
    ds_read_b64_tr_b16 v[246:247], v12 offset:18432
    v_mfma_f32_16x16x32_bf16 v[68:71], v[188:191], a[168:171], v[68:71]
    v_mfma_f32_16x16x32_bf16 v[72:75], v[188:191], a[172:175], v[72:75]
    buffer_load_dwordx4 v[184:187], v8, s[44:47], s99 offen offset:0 sc1
    v_mfma_f32_16x16x32_bf16 v[72:75], v[192:195], a[188:191], v[72:75]
    v_mfma_f32_16x16x32_bf16 v[36:39], v[192:195], a[176:179], v[36:39]
    ds_read_b64_tr_b16 v[248:249], v13 offset:16384
    v_mfma_f32_16x16x32_bf16 v[36:39], v[188:191], a[160:163], v[36:39]
    s_waitcnt vmcnt(17)
    v_mfma_f32_16x16x32_bf16 v[40:43], v[196:199], a[160:163], v[40:43]
    v_mfma_f32_16x16x32_bf16 v[40:43], v[200:203], a[176:179], v[40:43]
    buffer_load_dwordx4 v[188:191], v8, s[44:47], s98 offen offset:512 sc1
    v_mfma_f32_16x16x32_bf16 v[84:87], v[200:203], a[188:191], v[84:87]
    ds_read_b64_tr_b16 v[250:251], v13 offset:18432
    v_mfma_f32_16x16x32_bf16 v[84:87], v[196:199], a[172:175], v[84:87]
    v_mfma_f32_16x16x32_bf16 v[80:83], v[196:199], a[168:171], v[80:83]
    buffer_load_dwordx4 v[192:195], v8, s[44:47], s99 offen offset:512 sc1
    v_mfma_f32_16x16x32_bf16 v[80:83], v[200:203], a[184:187], v[80:83]
    v_mfma_f32_16x16x32_bf16 v[76:79], v[200:203], a[180:183], v[76:79]
    v_mfma_f32_16x16x32_bf16 v[76:79], v[196:199], a[164:167], v[76:79]
    s_waitcnt vmcnt(17)
    v_mfma_f32_16x16x32_bf16 v[88:91], v[204:207], a[164:167], v[88:91]
    v_mfma_f32_16x16x32_bf16 v[88:91], v[208:211], a[180:183], v[88:91]
    buffer_load_dwordx4 v[196:199], v8, s[44:47], s98 offen offset:768 sc1
    v_mfma_f32_16x16x32_bf16 v[92:95], v[208:211], a[184:187], v[92:95]
    v_mfma_f32_16x16x32_bf16 v[92:95], v[204:207], a[168:171], v[92:95]
    v_mfma_f32_16x16x32_bf16 v[96:99], v[204:207], a[172:175], v[96:99]
    buffer_load_dwordx4 v[200:203], v8, s[44:47], s99 offen offset:768 sc1
    v_mfma_f32_16x16x32_bf16 v[96:99], v[208:211], a[188:191], v[96:99]
    v_mfma_f32_16x16x32_bf16 v[44:47], v[208:211], a[176:179], v[44:47]
    v_mfma_f32_16x16x32_bf16 v[44:47], v[204:207], a[160:163], v[44:47]
    s_waitcnt vmcnt(17)
    v_mfma_f32_16x16x32_bf16 v[48:51], v[212:215], a[160:163], v[48:51]
    v_mfma_f32_16x16x32_bf16 v[48:51], v[216:219], a[176:179], v[48:51]
    buffer_load_dwordx4 v[204:207], v8, s[44:47], s98 offen offset:1024 sc1
L_pl_X_7:
    s_cbranch_execz L_wret
    v_mfma_f32_16x16x32_bf16 v[108:111], v[216:219], a[188:191], v[108:111]
    v_mfma_f32_16x16x32_bf16 v[108:111], v[212:215], a[172:175], v[108:111]
    v_mfma_f32_16x16x32_bf16 v[104:107], v[212:215], a[168:171], v[104:107]
    buffer_load_dwordx4 v[208:211], v8, s[44:47], s99 offen offset:1024 sc1
    v_mfma_f32_16x16x32_bf16 v[104:107], v[216:219], a[184:187], v[104:107]
    v_mfma_f32_16x16x32_bf16 v[100:103], v[216:219], a[180:183], v[100:103]
    v_mfma_f32_16x16x32_bf16 v[100:103], v[212:215], a[164:167], v[100:103]
    s_branch L_Dc
L_idle:
    s_waitcnt vmcnt(0)
    s_barrier
    s_add_u32 m0, s73, 32768
    s_lshl_b32 s14, s84, 17
    buffer_load_dwordx4 v4, s[52:55], s14 offen offset:0 lds
    buffer_load_dwordx4 v5, s[52:55], s14 offen offset:1024 lds
    buffer_load_dwordx4 v6, s[52:55], s14 offen offset:2048 lds
    buffer_load_dwordx4 v7, s[52:55], s14 offen offset:3072 lds
    s_add_u32 m0, s73, 49152
    s_lshl_b32 s14, s85, 17
    buffer_load_dwordx4 v4, s[52:55], s14 offen offset:0 lds
    buffer_load_dwordx4 v5, s[52:55], s14 offen offset:1024 lds
    buffer_load_dwordx4 v6, s[52:55], s14 offen offset:2048 lds
    buffer_load_dwordx4 v7, s[52:55], s14 offen offset:3072 lds
    s_add_u32 m0, s73, 65536
    s_lshl_b32 s14, s86, 17
    buffer_load_dwordx4 v4, s[52:55], s14 offen offset:0 lds
    buffer_load_dwordx4 v5, s[52:55], s14 offen offset:1024 lds
    buffer_load_dwordx4 v6, s[52:55], s14 offen offset:2048 lds
    buffer_load_dwordx4 v7, s[52:55], s14 offen offset:3072 lds
    s_add_u32 m0, s73, 81920
    s_lshl_b32 s14, s87, 17
    buffer_load_dwordx4 v4, s[52:55], s14 offen offset:0 lds
    buffer_load_dwordx4 v5, s[52:55], s14 offen offset:1024 lds
    buffer_load_dwordx4 v6, s[52:55], s14 offen offset:2048 lds
    buffer_load_dwordx4 v7, s[52:55], s14 offen offset:3072 lds
    s_add_u32 m0, s73, 98304
    s_lshl_b32 s14, s88, 17
    buffer_load_dwordx4 v4, s[52:55], s14 offen offset:0 lds
    buffer_load_dwordx4 v5, s[52:55], s14 offen offset:1024 lds
    buffer_load_dwordx4 v6, s[52:55], s14 offen offset:2048 lds
    buffer_load_dwordx4 v7, s[52:55], s14 offen offset:3072 lds
    s_add_u32 m0, s73, 114688
    s_lshl_b32 s14, s89, 17
    buffer_load_dwordx4 v4, s[52:55], s14 offen offset:0 lds
    buffer_load_dwordx4 v5, s[52:55], s14 offen offset:1024 lds
    buffer_load_dwordx4 v6, s[52:55], s14 offen offset:2048 lds
    buffer_load_dwordx4 v7, s[52:55], s14 offen offset:3072 lds
    s_add_u32 m0, s73, 131072
    s_lshl_b32 s14, s90, 17
    buffer_load_dwordx4 v4, s[52:55], s14 offen offset:0 lds
    buffer_load_dwordx4 v5, s[52:55], s14 offen offset:1024 lds
    buffer_load_dwordx4 v6, s[52:55], s14 offen offset:2048 lds
    buffer_load_dwordx4 v7, s[52:55], s14 offen offset:3072 lds
    s_add_u32 m0, s73, 0
    s_lshl_b32 s14, s91, 17
    buffer_load_dwordx4 v4, s[52:55], s14 offen offset:0 lds
    buffer_load_dwordx4 v5, s[52:55], s14 offen offset:1024 lds
    buffer_load_dwordx4 v6, s[52:55], s14 offen offset:2048 lds
    buffer_load_dwordx4 v7, s[52:55], s14 offen offset:3072 lds
    s_add_u32 m0, s73, 16384
    s_lshl_b32 s14, s92, 17
    buffer_load_dwordx4 v4, s[52:55], s14 offen offset:0 lds
    buffer_load_dwordx4 v5, s[52:55], s14 offen offset:1024 lds
    buffer_load_dwordx4 v6, s[52:55], s14 offen offset:2048 lds
    buffer_load_dwordx4 v7, s[52:55], s14 offen offset:3072 lds
    s_add_u32 m0, s73, 147456
    s_lshl_b32 s14, s93, 17
    buffer_load_dwordx4 v4, s[52:55], s14 offen offset:0 lds
    buffer_load_dwordx4 v5, s[52:55], s14 offen offset:1024 lds
    buffer_load_dwordx4 v6, s[52:55], s14 offen offset:2048 lds
    buffer_load_dwordx4 v7, s[52:55], s14 offen offset:3072 lds
    s_waitcnt vmcnt(36)
    ds_read_b64_tr_b16 a[0:1], v10 offset:32768
    ds_read_b64_tr_b16 a[2:3], v10 offset:34816
    ds_read_b64_tr_b16 a[4:5], v11 offset:32768
    ds_read_b64_tr_b16 a[6:7], v11 offset:34816
    ds_read_b64_tr_b16 a[8:9], v12 offset:32768
    ds_read_b64_tr_b16 a[10:11], v12 offset:34816
    ds_read_b64_tr_b16 a[12:13], v13 offset:32768
    ds_read_b64_tr_b16 a[14:15], v13 offset:34816
    s_waitcnt vmcnt(32) lgkmcnt(0)
    ds_read_b64_tr_b16 a[16:17], v10 offset:49152
    s_add_u32 m0, s73, 32768
    s_lshl_b32 s14, s94, 17
    ds_read_b64_tr_b16 a[18:19], v10 offset:51200
    buffer_load_dwordx4 v4, s[52:55], s14 offen offset:0 lds
    ds_read_b64_tr_b16 a[20:21], v11 offset:49152
    ds_read_b64_tr_b16 a[22:23], v11 offset:51200
    buffer_load_dwordx4 v5, s[52:55], s14 offen offset:1024 lds
    ds_read_b64_tr_b16 a[24:25], v12 offset:49152
    buffer_load_dwordx4 v6, s[52:55], s14 offen offset:2048 lds
    ds_read_b64_tr_b16 a[26:27], v12 offset:51200
    ds_read_b64_tr_b16 a[28:29], v13 offset:49152
    buffer_load_dwordx4 v7, s[52:55], s14 offen offset:3072 lds
    ds_read_b64_tr_b16 a[30:31], v13 offset:51200
    s_waitcnt vmcnt(32) lgkmcnt(0)
    v_add_u32 v10, 65536, v10
    ds_read_b64_tr_b16 a[32:33], v10 offset:0
    s_add_u32 m0, s73, 49152
    s_lshl_b32 s14, s95, 17
    ds_read_b64_tr_b16 a[34:35], v10 offset:2048
    buffer_load_dwordx4 v4, s[52:55], s14 offen offset:0 lds
    v_add_u32 v11, 65536, v11
    ds_read_b64_tr_b16 a[36:37], v11 offset:0
    ds_read_b64_tr_b16 a[38:39], v11 offset:2048
    buffer_load_dwordx4 v5, s[52:55], s14 offen offset:1024 lds
    v_add_u32 v12, 65536, v12
    ds_read_b64_tr_b16 a[40:41], v12 offset:0
    buffer_load_dwordx4 v6, s[52:55], s14 offen offset:2048 lds
    ds_read_b64_tr_b16 a[42:43], v12 offset:2048
    v_add_u32 v13, 65536, v13
    ds_read_b64_tr_b16 a[44:45], v13 offset:0
    buffer_load_dwordx4 v7, s[52:55], s14 offen offset:3072 lds
    ds_read_b64_tr_b16 a[46:47], v13 offset:2048
    s_waitcnt vmcnt(32) lgkmcnt(0)
    ds_read_b64_tr_b16 a[48:49], v10 offset:16384
    s_add_u32 m0, s73, 65536
    s_lshl_b32 s14, s96, 17
    ds_read_b64_tr_b16 a[50:51], v10 offset:18432
    buffer_load_dwordx4 v4, s[52:55], s14 offen offset:0 lds
    ds_read_b64_tr_b16 a[52:53], v11 offset:16384
    ds_read_b64_tr_b16 a[54:55], v11 offset:18432
    buffer_load_dwordx4 v5, s[52:55], s14 offen offset:1024 lds
    ds_read_b64_tr_b16 a[56:57], v12 offset:16384
    buffer_load_dwordx4 v6, s[52:55], s14 offen offset:2048 lds
    ds_read_b64_tr_b16 a[58:59], v12 offset:18432
    ds_read_b64_tr_b16 a[60:61], v13 offset:16384
    buffer_load_dwordx4 v7, s[52:55], s14 offen offset:3072 lds
    ds_read_b64_tr_b16 a[62:63], v13 offset:18432
    s_waitcnt vmcnt(32) lgkmcnt(0)
    ds_read_b64_tr_b16 a[64:65], v10 offset:32768
    s_add_u32 m0, s73, 81920
    s_lshl_b32 s14, s97, 17
    ds_read_b64_tr_b16 a[66:67], v10 offset:34816
    buffer_load_dwordx4 v4, s[52:55], s14 offen offset:0 lds
    ds_read_b64_tr_b16 a[68:69], v11 offset:32768
    ds_read_b64_tr_b16 a[70:71], v11 offset:34816
    buffer_load_dwordx4 v5, s[52:55], s14 offen offset:1024 lds
    ds_read_b64_tr_b16 a[72:73], v12 offset:32768
    buffer_load_dwordx4 v6, s[52:55], s14 offen offset:2048 lds
    ds_read_b64_tr_b16 a[74:75], v12 offset:34816
    ds_read_b64_tr_b16 a[76:77], v13 offset:32768
    buffer_load_dwordx4 v7, s[52:55], s14 offen offset:3072 lds
    ds_read_b64_tr_b16 a[78:79], v13 offset:34816
    s_waitcnt vmcnt(32) lgkmcnt(0)
    ds_read_b64_tr_b16 a[80:81], v10 offset:49152
    s_add_u32 m0, s73, 98304
    s_lshl_b32 s14, s98, 17
    ds_read_b64_tr_b16 a[82:83], v10 offset:51200
    buffer_load_dwordx4 v4, s[52:55], s14 offen offset:0 lds
    ds_read_b64_tr_b16 a[84:85], v11 offset:49152
    ds_read_b64_tr_b16 a[86:87], v11 offset:51200
    buffer_load_dwordx4 v5, s[52:55], s14 offen offset:1024 lds
    ds_read_b64_tr_b16 a[88:89], v12 offset:49152
    buffer_load_dwordx4 v6, s[52:55], s14 offen offset:2048 lds
    ds_read_b64_tr_b16 a[90:91], v12 offset:51200
    ds_read_b64_tr_b16 a[92:93], v13 offset:49152
    buffer_load_dwordx4 v7, s[52:55], s14 offen offset:3072 lds
    ds_read_b64_tr_b16 a[94:95], v13 offset:51200
    s_waitcnt vmcnt(32) lgkmcnt(0)
    v_add_u32 v10, 65536, v10
    ds_read_b64_tr_b16 a[96:97], v10 offset:0
    ds_read_b64_tr_b16 a[98:99], v10 offset:2048
    v_add_u32 v11, 65536, v11
    ds_read_b64_tr_b16 a[100:101], v11 offset:0
    ds_read_b64_tr_b16 a[102:103], v11 offset:2048
    v_add_u32 v12, 65536, v12
    ds_read_b64_tr_b16 a[104:105], v12 offset:0
    ds_read_b64_tr_b16 a[106:107], v12 offset:2048
    v_add_u32 v13, 65536, v13
    ds_read_b64_tr_b16 a[108:109], v13 offset:0
    ds_read_b64_tr_b16 a[110:111], v13 offset:2048
    s_waitcnt vmcnt(28) lgkmcnt(0)
    v_add_u32 v10, -131072, v10
    ds_read_b64_tr_b16 a[112:113], v10 offset:0
    ds_read_b64_tr_b16 a[114:115], v10 offset:2048
    v_add_u32 v11, -131072, v11
    ds_read_b64_tr_b16 a[116:117], v11 offset:0
    ds_read_b64_tr_b16 a[118:119], v11 offset:2048
    v_add_u32 v12, -131072, v12
    ds_read_b64_tr_b16 a[120:121], v12 offset:0
    ds_read_b64_tr_b16 a[122:123], v12 offset:2048
    v_add_u32 v13, -131072, v13
    ds_read_b64_tr_b16 a[124:125], v13 offset:0
    ds_read_b64_tr_b16 a[126:127], v13 offset:2048
    s_waitcnt vmcnt(24) lgkmcnt(0)
    ds_read_b64_tr_b16 a[128:129], v10 offset:16384
    s_add_u32 m0, s73, 0
    s_lshl_b32 s14, s100, 17
    ds_read_b64_tr_b16 a[130:131], v10 offset:18432
    buffer_load_dwordx4 v4, s[52:55], s14 offen offset:0 lds
    ds_read_b64_tr_b16 a[132:133], v11 offset:16384
    ds_read_b64_tr_b16 a[134:135], v11 offset:18432
    buffer_load_dwordx4 v5, s[52:55], s14 offen offset:1024 lds
    ds_read_b64_tr_b16 a[136:137], v12 offset:16384
    buffer_load_dwordx4 v6, s[52:55], s14 offen offset:2048 lds
    ds_read_b64_tr_b16 a[138:139], v12 offset:18432
    ds_read_b64_tr_b16 a[140:141], v13 offset:16384
    buffer_load_dwordx4 v7, s[52:55], s14 offen offset:3072 lds
    ds_read_b64_tr_b16 a[142:143], v13 offset:18432
    s_waitcnt vmcnt(24) lgkmcnt(0)
    v_add_u32 v10, 131072, v10
    ds_read_b64_tr_b16 a[144:145], v10 offset:16384
    s_add_u32 m0, s73, 16384
    s_lshl_b32 s14, s101, 17
    ds_read_b64_tr_b16 a[146:147], v10 offset:18432
    buffer_load_dwordx4 v4, s[52:55], s14 offen offset:0 lds
    v_add_u32 v11, 131072, v11
    ds_read_b64_tr_b16 a[148:149], v11 offset:16384
    ds_read_b64_tr_b16 a[150:151], v11 offset:18432
    buffer_load_dwordx4 v5, s[52:55], s14 offen offset:1024 lds
    v_add_u32 v12, 131072, v12
    ds_read_b64_tr_b16 a[152:153], v12 offset:16384
    buffer_load_dwordx4 v6, s[52:55], s14 offen offset:2048 lds
    ds_read_b64_tr_b16 a[154:155], v12 offset:18432
    v_add_u32 v13, 131072, v13
    ds_read_b64_tr_b16 a[156:157], v13 offset:16384
    buffer_load_dwordx4 v7, s[52:55], s14 offen offset:3072 lds
    ds_read_b64_tr_b16 a[158:159], v13 offset:18432
    s_waitcnt vmcnt(24) lgkmcnt(0)
    v_add_u32 v10, -131072, v10
    ds_read_b64_tr_b16 a[160:161], v10 offset:32768
    s_add_u32 m0, s73, 147456
    s_lshl_b32 s14, s99, 17
    ds_read_b64_tr_b16 a[162:163], v10 offset:34816
    buffer_load_dwordx4 v4, s[52:55], s14 offen offset:0 lds
    v_add_u32 v11, -131072, v11
    ds_read_b64_tr_b16 a[164:165], v11 offset:32768
    ds_read_b64_tr_b16 a[166:167], v11 offset:34816
    buffer_load_dwordx4 v5, s[52:55], s14 offen offset:1024 lds
    v_add_u32 v12, -131072, v12
    ds_read_b64_tr_b16 a[168:169], v12 offset:32768
    buffer_load_dwordx4 v6, s[52:55], s14 offen offset:2048 lds
    ds_read_b64_tr_b16 a[170:171], v12 offset:34816
    v_add_u32 v13, -131072, v13
    ds_read_b64_tr_b16 a[172:173], v13 offset:32768
    buffer_load_dwordx4 v7, s[52:55], s14 offen offset:3072 lds
    ds_read_b64_tr_b16 a[174:175], v13 offset:34816
    s_waitcnt vmcnt(24)
    ds_read_b64_tr_b16 a[176:177], v10 offset:49152
    ds_read_b64_tr_b16 a[178:179], v10 offset:51200
    ds_read_b64_tr_b16 a[180:181], v11 offset:49152
    ds_read_b64_tr_b16 a[182:183], v11 offset:51200
    ds_read_b64_tr_b16 a[184:185], v12 offset:49152
    ds_read_b64_tr_b16 a[186:187], v12 offset:51200
    ds_read_b64_tr_b16 a[188:189], v13 offset:49152
    ds_read_b64_tr_b16 a[190:191], v13 offset:51200
    s_waitcnt vmcnt(20)
    v_add_u32 v10, 65536, v10
    ds_read_b64_tr_b16 a[192:193], v10 offset:0
    ds_read_b64_tr_b16 a[194:195], v10 offset:2048
    v_add_u32 v11, 65536, v11
    ds_read_b64_tr_b16 a[196:197], v11 offset:0
    ds_read_b64_tr_b16 a[198:199], v11 offset:2048
    v_add_u32 v12, 65536, v12
    ds_read_b64_tr_b16 a[200:201], v12 offset:0
    ds_read_b64_tr_b16 a[202:203], v12 offset:2048
    v_add_u32 v13, 65536, v13
    ds_read_b64_tr_b16 a[204:205], v13 offset:0
    ds_read_b64_tr_b16 a[206:207], v13 offset:2048
    s_waitcnt vmcnt(16)
    ds_read_b64_tr_b16 a[208:209], v10 offset:16384
    ds_read_b64_tr_b16 a[210:211], v10 offset:18432
    ds_read_b64_tr_b16 a[212:213], v11 offset:16384
    ds_read_b64_tr_b16 a[214:215], v11 offset:18432
    ds_read_b64_tr_b16 a[216:217], v12 offset:16384
    ds_read_b64_tr_b16 a[218:219], v12 offset:18432
    ds_read_b64_tr_b16 a[220:221], v13 offset:16384
    ds_read_b64_tr_b16 a[222:223], v13 offset:18432
    s_waitcnt vmcnt(12)
    ds_read_b64_tr_b16 a[224:225], v10 offset:32768
    ds_read_b64_tr_b16 a[226:227], v10 offset:34816
    ds_read_b64_tr_b16 a[228:229], v11 offset:32768
    ds_read_b64_tr_b16 a[230:231], v11 offset:34816
    ds_read_b64_tr_b16 a[232:233], v12 offset:32768
    ds_read_b64_tr_b16 a[234:235], v12 offset:34816
    ds_read_b64_tr_b16 a[236:237], v13 offset:32768
    ds_read_b64_tr_b16 a[238:239], v13 offset:34816
    s_waitcnt lgkmcnt(0)
    v_add_u32 v10, -65536, v10
    v_add_u32 v11, -65536, v11
    v_add_u32 v12, -65536, v12
    v_add_u32 v13, -65536, v13
    s_mov_b64 exec, 0
    s_call_b64 s[82:83], L_wc_D
    s_mov_b64 exec, -1
    s_and_b32 s4, s72, 1
    s_lshl_b32 s4, s4, 2
    s_add_u32 s4, s4, s3
    s_mul_i32 s4, s4, 18
    s_lshr_b32 s4, s4, 2
    s_mul_i32 s4, s4, 6
    s_lshr_b32 s5, s72, 1
    s_mul_i32 s5, s5, 3
    s_lshr_b32 s5, s5, 1
    s_add_u32 s4, s4, s5
    v_min_u32 v28, 9, v2
    v_lshrrev_b32 v29, 1, v28
    v_lshl_add_u32 v28, v29, 2, v28
    v_add_u32 v28, s4, v28
    v_and_b32 v29, 3, v28
    v_lshrrev_b32 v28, 2, v28
    v_lshlrev_b32 v28, 7, v28
    v_lshl_add_u32 v28, v29, 2, v28
    v_add_u32 v28, 12566528, v28
    buffer_load_dword v29, v28, s[44:47], 0 offen sc1
    s_branch L_DX
L_end:
.section .rodata,"a"
.p2align 6
.amdhsa_kernel recurrent_scan__ssm_conv_h3__mixer_token_mlp__prompt_kernel
  .amdhsa_next_free_vgpr 512
  .amdhsa_next_free_sgpr 102
  .amdhsa_accum_offset 256
  .amdhsa_group_segment_fixed_size 0
  .amdhsa_kernarg_size 112
  .amdhsa_user_sgpr_count 2
  .amdhsa_user_sgpr_kernarg_segment_ptr 1
  .amdhsa_system_sgpr_workgroup_id_x 1
  .amdhsa_float_denorm_mode_32 3
.end_amdhsa_kernel
```

```asm
; @launch grid=(256,1,1) block=(256,1,1) lds=163840
.amdgcn_target "amdgcn-amd-amdhsa--gfx950"
.text
.globl recurrent_scan__ssm_conv_h3__mixer_token_mlp__prompt_kernel
.p2align 8
.type recurrent_scan__ssm_conv_h3__mixer_token_mlp__prompt_kernel,@function
recurrent_scan__ssm_conv_h3__mixer_token_mlp__prompt_kernel:
    s_cmp_lt_u32 s2, 256
    s_cbranch_scc0 L_exit
    s_load_dwordx2 s[56:57], s[0:1], 0
    s_load_dwordx2 s[48:49], s[0:1], 8
    s_load_dwordx2 s[52:53], s[0:1], 16
    s_load_dwordx2 s[60:61], s[0:1], 24
    s_load_dwordx16 s[16:31], s[0:1], 0
    s_load_dwordx8 s[32:39], s[0:1], 64
    s_load_dwordx4 s[40:43], s[0:1], 96
    s_memrealtime s[12:13]
    v_lshrrev_b32 v1, 6, v0
    v_and_b32 v2, 63, v0
    s_getpc_b64 s[6:7]
L_pc:
    s_lshr_b32 s4, s2, 1
    s_and_b32 s4, s4, 124
    v_add_u32 v22, s4, v1
    v_lshl_add_u32 v22, v2, 7, v22
    v_lshlrev_b32 v22, 7, v22
    v_min_u32 v22, L_end-L_pc-4, v22
    s_mov_b64 exec, 15
    global_load_dword v255, v22, s[6:7]
    s_mov_b64 exec, -1
    v_readfirstlane_b32 s3, v1
    s_and_b32 s4, s2, 7
    s_lshr_b32 s5, s2, 3
    s_lshl_b32 s4, s4, 5
    s_add_u32 s68, s4, s5
    v_lshrrev_b32 v3, 5, v0
    v_and_b32 v4, 31, v0
    v_mul_u32_u24 v5, 1152, v3
    v_mad_u32_u24 v5, v4, 12, v5
    s_mul_i32 s15, s68, 9216
    s_mul_i32 s4, s3, 3072
    s_add_u32 s5, s4, s15
    s_sub_u32 s5, s5, 3456
    v_lshlrev_b32 v6, 4, v2
    v_add_u32 v7, s5, v6
    v_add_u32 v58, 1024, v7
    s_add_u32 s4, s4, 114688
    s_lshl_b32 s5, s3, 11
    s_add_u32 s11, s5, s15
    s_add_u32 s5, s5, 127360
    s_mov_b32 m0, s4
    s_mov_b32 s58, 2359296
    s_mov_b32 s59, 0x20000
    s_mov_b32 s50, 2359296
    s_mov_b32 s51, 0x20000
    s_mov_b32 s54, 2359296
    s_mov_b32 s55, 0x20000
    s_mov_b32 s62, 4608
    s_mov_b32 s63, 0x20000
    v_lshlrev_b32 v59, 3, v0
    s_movk_i32 s10, 4096
    s_waitcnt lgkmcnt(0)
    buffer_load_dwordx3 v[8:10], v5, s[56:59], s15 offen offset:0
    buffer_load_dwordx3 v[12:14], v5, s[56:59], s15 offen offset:384
    buffer_load_dwordx3 v[16:18], v5, s[56:59], s15 offen offset:768
    buffer_load_dwordx4 v7, s[48:51], 0 offen lds
    s_add_u32 m0, s4, 1024
    s_cmp_eq_u32 s3, 3
    buffer_load_dwordx4 v58, s[48:51], 0 offen lds
    buffer_load_dwordx4 v58, s[48:51], 0 offen offset:1024 lds
    s_cbranch_scc1 L_xld
L_nox:
    s_mov_b32 m0, s5
    buffer_load_dwordx2 v[98:99], v59, s[60:63], 0 offen
    buffer_load_dwordx4 v6, s[52:55], s11 offen lds
    buffer_load_dwordx4 v6, s[52:55], s11 offen offset:1024 lds
    buffer_load_dwordx2 v[100:101], v59, s[60:63], 0 offen offset:2048
    buffer_load_dwordx2 v[102:103], v59, s[60:63], s10 offen
    s_mov_b32 s64, s40
    s_and_b32 s65, s41, 0xffff
    s_mov_b32 s66, 256
    s_mov_b32 s67, 0x20000
    s_or_b32 s12, s12, 1
    v_or_b32 v22, s2, v0
    v_lshlrev_b32 v22, 8, v22
    v_mov_b32 v23, s12
    buffer_store_dword v23, v22, s[64:67], 0 offen sc1
    s_mov_b32 s44, s42
    s_and_b32 s45, s43, 0xffff
    s_mov_b32 s46, 40779776
    s_mov_b32 s47, 0x20000
    s_and_b32 s5, s2, 7
    s_lshr_b32 s6, s2, 3
    s_lshr_b32 s7, s6, 2
    s_lshr_b32 s13, s5, 1
    s_cmp_ge_u32 s7, 3
    s_addc_u32 s8, s7, 0
    s_cmp_eq_u32 s7, 7
    s_cselect_b32 s8, 3, s8
    s_lshl3_add_u32 s71, s13, s8
    s_and_b32 s7, s6, 3
    s_and_b32 s4, s5, 1
    s_lshl1_add_u32 s72, s7, s4
    s_add_u32 s7, s7, s13
    s_and_b32 s7, s7, 3
    s_mov_b32 s101, s7
    s_mul_i32 s7, s7, 9
    s_lshr_b32 s84, s7, 2
    s_lshl_b32 s73, s3, 12
    s_mov_b32 s52, s34
    s_and_b32 s53, s35, 0xffff
    s_mov_b32 s54, 18874368
    s_mov_b32 s55, 0x20000
    s_cmp_lt_u32 s6, 27
    s_cbranch_scc0 L_aux
    s_branch L_org
L_exit:
    s_endpgm
L_xld:
    s_mov_b64 exec, 0xffffff
    buffer_load_dwordx4 v58, s[48:51], 0 offen offset:2048 lds
    s_mov_b64 exec, -1
    s_mov_b32 m0, s5
    s_nop 0
    buffer_load_dwordx4 v6, s[52:55], s11 offen offset:2048 lds
    s_branch L_nox
L_nw_G:
    s_mov_b32 s5, 0
L_nl_G:
    buffer_load_dword v45, v44, s[64:67], 0 offen sc1
    s_waitcnt vmcnt(0)
    v_readfirstlane_b32 s68, v45
    s_nop 1
    s_cmp_lg_u32 s68, 0
    s_cbranch_scc1 L_ng_G
    s_add_u32 s5, s5, 1
    s_cmp_lt_u32 s5, 100000
    s_cbranch_scc1 L_nl_G
    s_branch L_ng_G
L_rs_p1G:
    s_mov_b32 s5, 0
L_rt_p1G:
    s_mov_b64 exec, vcc
    buffer_load_dword v29, v28, s[44:47], 0 offen sc1
    s_waitcnt vmcnt(0)
    v_cmp_ne_u32 vcc, s68, v29
    s_cbranch_vccz L_rx_p1G
    s_add_u32 s5, s5, 1
    s_cmp_lt_u32 s5, 100000
    s_cbranch_scc1 L_rt_p1G
L_rx_p1G:
    s_mov_b64 exec, -1
    s_branch L_ok_p1G
L_rs_p5:
    s_mov_b32 s5, 0
L_rt_p5:
    s_mov_b64 exec, vcc
    buffer_load_dword v29, v28, s[44:47], 0 offen sc1
    s_waitcnt vmcnt(0)
    v_cmp_ne_u32 vcc, s68, v29
    s_cbranch_vccz L_rx_p5
    s_add_u32 s5, s5, 1
    s_cmp_lt_u32 s5, 100000
    s_cbranch_scc1 L_rt_p5
L_rx_p5:
    s_mov_b64 exec, -1
    s_branch L_ok_p5
L_nw_X:
    s_mov_b32 s5, 0
L_nl_X:
    buffer_load_dword v45, v44, s[64:67], 0 offen sc1
    s_waitcnt vmcnt(0)
    v_readfirstlane_b32 s68, v45
    s_nop 1
    s_cmp_lg_u32 s68, 0
    s_cbranch_scc1 L_ng_X
    s_add_u32 s5, s5, 1
    s_cmp_lt_u32 s5, 100000
    s_cbranch_scc1 L_nl_X
    s_branch L_ng_X
L_rs_p1X:
    s_mov_b32 s5, 0
L_rt_p1X:
    s_mov_b64 exec, vcc
    buffer_load_dword v29, v28, s[44:47], 0 offen sc1
    s_waitcnt vmcnt(0)
    v_cmp_ne_u32 vcc, s68, v29
    s_cbranch_vccz L_rx_p1X
    s_add_u32 s5, s5, 1
    s_cmp_lt_u32 s5, 100000
    s_cbranch_scc1 L_rt_p1X
L_rx_p1X:
    s_mov_b64 exec, -1
    s_branch L_ok_p1X
L_rs_p4:
    s_mov_b32 s5, 0
L_rt_p4:
    s_mov_b64 exec, vcc
    buffer_load_dword v29, v28, s[44:47], 0 offen sc1
    s_waitcnt vmcnt(0)
    v_cmp_ne_u32 vcc, s68, v29
    s_cbranch_vccz L_rx_p4
    s_add_u32 s5, s5, 1
    s_cmp_lt_u32 s5, 100000
    s_cbranch_scc1 L_rt_p4
L_rx_p4:
    s_mov_b64 exec, -1
    s_branch L_ok_p4
L_rs_p3:
    s_mov_b32 s5, 0
L_rt_p3:
    s_mov_b64 exec, vcc
    buffer_load_dword v29, v28, s[44:47], 0 offen sc1
    s_waitcnt vmcnt(0)
    v_cmp_ne_u32 vcc, s68, v29
    s_cbranch_vccz L_rx_p3
    s_add_u32 s5, s5, 1
    s_cmp_lt_u32 s5, 100000
    s_cbranch_scc1 L_rt_p3
L_rx_p3:
    s_mov_b64 exec, -1
    s_branch L_ok_p3
L_rs_p2G:
    s_mov_b32 s5, 0
L_rt_p2G:
    s_mov_b64 exec, vcc
    buffer_load_dword v19, v18, s[44:47], 0 offen sc1
    s_waitcnt vmcnt(0)
    v_cmp_ne_u32 vcc, s68, v19
    s_cbranch_vccz L_rx_p2G
    s_add_u32 s5, s5, 1
    s_cmp_lt_u32 s5, 100000
    s_cbranch_scc1 L_rt_p2G
L_rx_p2G:
    s_mov_b64 exec, -1
    s_branch L_ok_p2G
L_rs_p2X:
    s_mov_b32 s5, 0
L_rt_p2X:
    s_mov_b64 exec, vcc
    buffer_load_dword v29, v28, s[44:47], 0 offen sc1
    s_waitcnt vmcnt(0)
    v_cmp_ne_u32 vcc, s68, v29
    s_cbranch_vccz L_rx_p2X
    s_add_u32 s5, s5, 1
    s_cmp_lt_u32 s5, 100000
    s_cbranch_scc1 L_rt_p2X
L_rx_p2X:
    s_mov_b64 exec, -1
    s_branch L_ok_p2X
L_wc_G:
    s_cmp_eq_u32 s3, 0
    s_cbranch_scc1 L_pl_G_0
    s_cmp_eq_u32 s3, 1
    s_cbranch_scc1 L_pl_G_1
    s_cmp_eq_u32 s3, 2
    s_cbranch_scc1 L_pl_G_2
    s_branch L_pl_G_3
L_wc_X:
    s_cmp_eq_u32 s3, 0
    s_cbranch_scc1 L_pl_X_0
    s_cmp_eq_u32 s3, 1
    s_cbranch_scc1 L_pl_X_1
    s_cmp_eq_u32 s3, 2
    s_cbranch_scc1 L_pl_X_2
    s_branch L_pl_X_3
L_wc_D:
    s_cmp_eq_u32 s3, 0
    s_cbranch_scc1 L_pl_D_0
    s_cmp_eq_u32 s3, 1
    s_cbranch_scc1 L_pl_D_1
    s_cmp_eq_u32 s3, 2
    s_cbranch_scc1 L_wret
    s_branch L_wret
L_wret:
    s_setpc_b64 s[82:83]
.p2align 12
L_org:
    s_mul_i32 s7, s6, 21846
    s_lshr_b32 s7, s7, 16
    s_mul_i32 s8, s7, 3
    s_sub_u32 s12, s6, s8
    s_mul_i32 s8, s13, 9
    s_add_u32 s69, s8, s7
    s_lshl1_add_u32 s70, s12, s4
    s_mul_i32 s8, s69, 6
    s_add_u32 s75, s8, s70
    s_mov_b32 s48, s30
    s_and_b32 s49, s31, 0xffff
    s_mov_b32 s50, 18874368
    s_mov_b32 s51, 0x20000
    s_add_u32 s12, s12, s7
    s_mul_i32 s8, s12, 21846
    s_lshr_b32 s8, s8, 16
    s_mul_i32 s8, s8, 3
    s_sub_u32 s12, s12, s8
    s_mul_i32 s4, s4, 1179648
    s_mul_i32 s7, s12, 65538
    s_lshr_b32 s7, s7, 16
    s_mul_i32 s7, s7, 73728
    s_add_u32 s5, s4, 0
    s_add_u32 s18, s7, s5
    s_add_u32 s8, s5, 221184
    s_add_u32 s19, s18, 73728
    s_cmp_eq_u32 s19, s8
    s_cselect_b32 s19, s5, s19
    s_add_u32 s20, s19, 73728
    s_cmp_eq_u32 s20, s8
    s_cselect_b32 s20, s5, s20
    s_mul_i32 s7, s12, 131076
    s_lshr_b32 s7, s7, 16
    s_mul_i32 s7, s7, 73728
    s_add_u32 s5, s4, 221184
    s_add_u32 s21, s7, s5
    s_add_u32 s8, s5, 442368
    s_add_u32 s22, s21, 73728
    s_cmp_eq_u32 s22, s8
    s_cselect_b32 s22, s5, s22
    s_add_u32 s23, s22, 73728
    s_cmp_eq_u32 s23, s8
    s_cselect_b32 s23, s5, s23
    s_add_u32 s24, s23, 73728
    s_cmp_eq_u32 s24, s8
    s_cselect_b32 s24, s5, s24
    s_add_u32 s25, s24, 73728
    s_cmp_eq_u32 s25, s8
    s_cselect_b32 s25, s5, s25
    s_add_u32 s26, s25, 73728
    s_cmp_eq_u32 s26, s8
    s_cselect_b32 s26, s5, s26
    s_mul_i32 s7, s12, 152922
    s_lshr_b32 s7, s7, 16
    s_mul_i32 s7, s7, 73728
    s_add_u32 s5, s4, 663552
    s_add_u32 s27, s7, s5
    s_add_u32 s8, s5, 516096
    s_add_u32 s76, s27, 73728
    s_cmp_eq_u32 s76, s8
    s_cselect_b32 s76, s5, s76
    s_add_u32 s77, s76, 73728
    s_cmp_eq_u32 s77, s8
    s_cselect_b32 s77, s5, s77
    s_add_u32 s78, s77, 73728
    s_cmp_eq_u32 s78, s8
    s_cselect_b32 s78, s5, s78
    s_add_u32 s79, s78, 73728
    s_cmp_eq_u32 s79, s8
    s_cselect_b32 s79, s5, s79
    s_add_u32 s80, s79, 73728
    s_cmp_eq_u32 s80, s8
    s_cselect_b32 s80, s5, s80
    s_add_u32 s81, s80, 73728
    s_cmp_eq_u32 s81, s8
    s_cselect_b32 s81, s5, s81
    v_lshrrev_b32 v24, 4, v2
    v_and_b32 v25, 15, v2
    v_lshlrev_b32 v26, 1, v24
    v_xor_b32 v25, v25, v26
    v_mul_u32_u24 v24, 9216, v24
    v_lshl_add_u32 v24, v25, 4, v24
    s_mul_i32 s7, s3, 147456
    s_lshl_b32 s8, s69, 8
    s_add_u32 s7, s7, s8
    v_add_u32 v148, s7, v24
    v_add_u32 v149, 35840, v148
    v_xor_b32 v24, 128, v148
    v_add_u32 v150, 71680, v24
    v_add_u32 v151, 35840, v150
    v_bfe_u32 v140, v2, 2, 2
    v_lshrrev_b32 v141, 4, v2
    v_lshl_add_u32 v142, v141, 3, v140
    v_lshlrev_b32 v142, 8, v142
    v_and_b32 v143, 3, v2
    v_lshl_add_u32 v142, v143, 3, v142
    v_and_b32 v141, 1, v141
    v_lshl_add_u32 v140, v141, 2, v140
    s_lshl_b32 s7, s3, 1
    v_xor_b32 v140, s7, v140
    v_lshl_add_u32 v152, v140, 5, v142
    v_xor_b32 v153, 32, v152
    v_add_u32 v154, 0x10000, v152
    v_add_u32 v155, 0x10000, v153
    v_and_b32 v24, 15, v2
    v_lshrrev_b32 v25, 4, v2
    v_mul_u32_u24 v26, 17408, v25
    v_lshl_add_u32 v26, v24, 4, v26
    v_mul_u32_u24 v25, 1536, v25
    v_lshl_add_u32 v25, v24, 4, v25
    v_add_u32 v159, 81920, v25
    v_add_u32 v250, 36864, v159
    s_mul_i32 s7, s3, 18432
    s_xor_b32 s8, s70, 1
    s_mul_i32 s8, s8, 1536
    s_add_u32 s7, s7, s8
    v_lshlrev_b32 v246, 4, v2
    v_add_u32 v156, s7, v246
    v_lshrrev_b32 v25, 5, v2
    v_mul_u32_u24 v25, 7680, v25
    v_add_u32 v157, v156, v25
    v_add_u32 v158, 7680, v156
    s_mul_i32 s74, s3, 3072
    s_add_u32 s74, s74, 81920
    v_mov_b32 v245, v26
    s_mov_b32 s9, 144896
    s_mov_b32 s11, 114688
    s_waitcnt vmcnt(9)
    v_and_b32 v21, 0xffff0000, v8
    s_add_u32 m0, s73, 81920
    s_lshl_b32 s14, s18, 3
    buffer_load_dwordx4 v148, s[48:51], s14 offen offset:0 lds
    v_lshlrev_b32 v20, 16, v8
    v_and_b32 v23, 0xffff0000, v9
    v_lshlrev_b32 v22, 16, v9
    v_and_b32 v25, 0xffff0000, v10
    v_lshlrev_b32 v24, 16, v10
    v_and_b32 v27, 0xffff0000, v12
    v_lshlrev_b32 v26, 16, v12
    v_and_b32 v29, 0xffff0000, v13
    v_lshlrev_b32 v28, 16, v13
    v_and_b32 v31, 0xffff0000, v14
    v_lshlrev_b32 v30, 16, v14
    v_and_b32 v33, 0xffff0000, v16
    v_lshlrev_b32 v32, 16, v16
    v_and_b32 v35, 0xffff0000, v17
    v_lshlrev_b32 v34, 16, v17
    v_and_b32 v37, 0xffff0000, v18
    v_lshlrev_b32 v36, 16, v18
    v_pk_add_f32 v[38:39], v[20:21], v[22:23]
    v_pk_add_f32 v[40:41], v[24:25], v[26:27]
    v_pk_add_f32 v[42:43], v[28:29], v[30:31]
    v_pk_add_f32 v[44:45], v[32:33], v[34:35]
    v_pk_add_f32 v[38:39], v[38:39], v[40:41]
    v_pk_add_f32 v[42:43], v[42:43], v[44:45]
    v_pk_add_f32 v[38:39], v[38:39], v[36:37]
    v_pk_add_f32 v[38:39], v[38:39], v[42:43]
    v_add_f32 v56, v38, v39
    buffer_load_dwordx4 v149, s[48:51], s14 offen offset:1024 lds
    s_nop 0
    v_add_f32_dpp v56, v56, v56 row_ror:8 row_mask:0xf bank_mask:0xf
    s_nop 1
    v_add_f32_dpp v56, v56, v56 row_ror:4 row_mask:0xf bank_mask:0xf
    s_nop 1
    v_add_f32_dpp v56, v56, v56 row_ror:2 row_mask:0xf bank_mask:0xf
    s_nop 1
    v_add_f32_dpp v56, v56, v56 row_ror:1 row_mask:0xf bank_mask:0xf
    v_mov_b32 v57, v56
    s_nop 1
    v_permlane16_swap_b32 v56, v57
    v_add_f32 v56, v56, v57
    v_mul_f32 v56, 0x3ae38e39, v56
    v_pk_add_f32 v[20:21], v[20:21], v[56:57] op_sel_hi:[1,0] neg_lo:[0,1] neg_hi:[0,1]
    v_pk_add_f32 v[22:23], v[22:23], v[56:57] op_sel_hi:[1,0] neg_lo:[0,1] neg_hi:[0,1]
    v_pk_add_f32 v[24:25], v[24:25], v[56:57] op_sel_hi:[1,0] neg_lo:[0,1] neg_hi:[0,1]
    v_pk_add_f32 v[26:27], v[26:27], v[56:57] op_sel_hi:[1,0] neg_lo:[0,1] neg_hi:[0,1]
    v_pk_add_f32 v[28:29], v[28:29], v[56:57] op_sel_hi:[1,0] neg_lo:[0,1] neg_hi:[0,1]
    v_pk_add_f32 v[30:31], v[30:31], v[56:57] op_sel_hi:[1,0] neg_lo:[0,1] neg_hi:[0,1]
    v_pk_add_f32 v[32:33], v[32:33], v[56:57] op_sel_hi:[1,0] neg_lo:[0,1] neg_hi:[0,1]
    v_pk_add_f32 v[34:35], v[34:35], v[56:57] op_sel_hi:[1,0] neg_lo:[0,1] neg_hi:[0,1]
    v_pk_add_f32 v[36:37], v[36:37], v[56:57] op_sel_hi:[1,0] neg_lo:[0,1] neg_hi:[0,1]
    v_pk_mul_f32 v[38:39], v[20:21], v[20:21]
    v_pk_mul_f32 v[40:41], v[22:23], v[22:23]
    v_pk_fma_f32 v[38:39], v[24:25], v[24:25], v[38:39]
    v_pk_fma_f32 v[40:41], v[26:27], v[26:27], v[40:41]
    v_pk_fma_f32 v[38:39], v[28:29], v[28:29], v[38:39]
    v_pk_fma_f32 v[40:41], v[30:31], v[30:31], v[40:41]
    v_pk_fma_f32 v[38:39], v[32:33], v[32:33], v[38:39]
    v_pk_fma_f32 v[40:41], v[34:35], v[34:35], v[40:41]
    v_pk_fma_f32 v[38:39], v[36:37], v[36:37], v[38:39]
    buffer_load_dwordx4 v150, s[48:51], s14 offen offset:2048 lds
    v_pk_add_f32 v[38:39], v[38:39], v[40:41]
    v_add_f32 v18, v38, v39
    s_nop 1
    v_add_f32_dpp v18, v18, v18 row_ror:8 row_mask:0xf bank_mask:0xf
    s_nop 1
    v_add_f32_dpp v18, v18, v18 row_ror:4 row_mask:0xf bank_mask:0xf
    s_nop 1
    v_add_f32_dpp v18, v18, v18 row_ror:2 row_mask:0xf bank_mask:0xf
    s_nop 1
    v_add_f32_dpp v18, v18, v18 row_ror:1 row_mask:0xf bank_mask:0xf
    v_mov_b32 v19, v18
    s_nop 1
    v_permlane16_swap_b32 v18, v19
    v_add_f32 v18, v18, v19
    v_mul_f32 v18, 0x3ae38e39, v18
    v_cvt_pk_bf16_f32 v38, v56, v18
    v_lshlrev_b32 v106, 16, v38
    v_and_b32 v38, 0xffff0000, v38
    v_add_f32 v38, 0x3727c5ac, v38
    v_sub_f32 v56, v56, v106
    v_cvt_pk_bf16_f32 v38, v38, v38
    v_lshlrev_b32 v38, 16, v38
    v_sqrt_f32 v38, v38
    s_nop 0
    v_cvt_pk_bf16_f32 v38, v38, v38
    v_lshlrev_b32 v38, 16, v38
    v_rcp_f32 v107, v38
    s_nop 0
    v_mul_f32 v56, v56, v107
    v_mul_f32 v18, v18, v107
    v_mul_f32 v18, v18, v107
    v_cvt_pk_bf16_f32 v38, v56, v18
    v_lshlrev_b32 v39, 16, v38
    buffer_load_dwordx4 v151, s[48:51], s14 offen offset:3072 lds
    v_and_b32 v38, 0xffff0000, v38
    v_add_f32 v38, 0x3727c5ac, v38
    v_sub_f32 v56, v56, v39
    v_cvt_pk_bf16_f32 v38, v38, v38
    v_lshlrev_b32 v38, 16, v38
    v_sqrt_f32 v38, v38
    s_nop 0
    v_cvt_pk_bf16_f32 v38, v38, v38
    v_lshlrev_b32 v38, 16, v38
    v_rcp_f32 v38, v38
    s_nop 0
    v_mul_f32 v18, v107, v38
    v_mul_f32 v56, v56, v38
    v_pk_fma_f32 v[20:21], v[20:21], v[18:19], v[56:57] op_sel_hi:[1,0,0]
    v_pk_fma_f32 v[22:23], v[22:23], v[18:19], v[56:57] op_sel_hi:[1,0,0]
    v_pk_fma_f32 v[24:25], v[24:25], v[18:19], v[56:57] op_sel_hi:[1,0,0]
    v_pk_fma_f32 v[26:27], v[26:27], v[18:19], v[56:57] op_sel_hi:[1,0,0]
    v_pk_fma_f32 v[28:29], v[28:29], v[18:19], v[56:57] op_sel_hi:[1,0,0]
    v_pk_fma_f32 v[30:31], v[30:31], v[18:19], v[56:57] op_sel_hi:[1,0,0]
    v_pk_fma_f32 v[32:33], v[32:33], v[18:19], v[56:57] op_sel_hi:[1,0,0]
    v_pk_fma_f32 v[34:35], v[34:35], v[18:19], v[56:57] op_sel_hi:[1,0,0]
    v_pk_fma_f32 v[36:37], v[36:37], v[18:19], v[56:57] op_sel_hi:[1,0,0]
    v_cvt_pk_bf16_f32 v8, v20, v21
    v_cvt_pk_bf16_f32 v9, v22, v23
    v_cvt_pk_bf16_f32 v10, v24, v25
    v_cvt_pk_bf16_f32 v11, v26, v27
    v_cvt_pk_bf16_f32 v12, v28, v29
    v_cvt_pk_bf16_f32 v13, v30, v31
    v_cvt_pk_bf16_f32 v14, v32, v33
    v_cvt_pk_bf16_f32 v15, v34, v35
    v_cvt_pk_bf16_f32 v16, v36, v37
    v_lshrrev_b32 v3, 5, v0
    v_and_b32 v1, 31, v0
    v_mul_u32_u24 v17, 1216, v3
    v_mad_u32_u24 v17, v1, 12, v17
    v_add_u32 v17, 144896, v17
    ds_write_b32 v17, v8 offset:0
    ds_write_b32 v17, v9 offset:4
    ds_write_b32 v17, v10 offset:8
    ds_write_b32 v17, v11 offset:384
    ds_write_b32 v17, v12 offset:388
    ds_write_b32 v17, v13 offset:392
    ds_write_b32 v17, v14 offset:768
    ds_write_b32 v17, v15 offset:772
    ds_write_b32 v17, v16 offset:776
    v_lshlrev_b32 v3, 3, v3
    s_lshl_b32 s5, s68, 6
    s_add_u32 s5, s5, 12386304
    v_cmp_eq_u32 vcc, 0, v1
    v_mov_b32 v18, 0x40000000
    s_nop 0
    v_cndmask_b32 v3, v18, v3, vcc
    buffer_store_dwordx2 v[106:107], v3, s[44:47], s5 offen sc1
    v_lshrrev_b32 v19, 4, v0
    v_and_b32 v17, 3, v2
    v_lshlrev_b32 v17, 3, v17
    v_lshl_add_u32 v19, v19, 5, v17
    v_bfe_u32 v6, v2, 2, 2
    v_mul_u32_u24 v17, 1216, v6
    v_mul_u32_u24 v6, 1152, v6
    v_add3_u32 v17, v17, v19, s9
    v_add3_u32 v6, v6, v19, s11
    v_lshlrev_b32 v19, 4, v0
    s_add_u32 s7, s15, 4096
    s_add_u32 s8, s15, 8192
    s_cmp_eq_u32 s3, 0
    s_cselect_b32 s8, s8, 0x40000000
    v_add_u32 v18, 2359296, v19
    v_mov_b32 v44, 0
    s_waitcnt vmcnt(6) lgkmcnt(0)
    s_barrier
    ds_read_b64_tr_b16 v[60:61], v6 offset:0
    ds_read_b64_tr_b16 v[62:63], v6 offset:4608
    ds_read_b64_tr_b16 v[64:65], v6 offset:9216
    ds_read_b64_tr_b16 v[66:67], v6 offset:12672
    ds_read_b64_tr_b16 v[68:69], v6 offset:17280
    ds_read_b64_tr_b16 v[20:21], v17 offset:0
    ds_read_b64_tr_b16 v[22:23], v17 offset:4864
    ds_read_b64_tr_b16 v[24:25], v17 offset:512
    ds_read_b64_tr_b16 v[26:27], v17 offset:5376
    ds_read_b64_tr_b16 v[28:29], v17 offset:1024
    ds_read_b64_tr_b16 v[30:31], v17 offset:5888
    ds_read_b64_tr_b16 v[70:71], v6 offset:512
    ds_read_b64_tr_b16 v[72:73], v6 offset:5120
    ds_read_b64_tr_b16 v[74:75], v6 offset:9728
    ds_read_b64_tr_b16 v[76:77], v6 offset:13184
    v_alignbit_b32 v114, v99, v99, 16
    v_alignbit_b32 v115, v98, v98, 16
    s_waitcnt lgkmcnt(10)
    v_alignbit_b32 v108, v61, v60, 16
    v_alignbit_b32 v109, v62, v61, 16
    v_alignbit_b32 v110, v63, v62, 16
    v_alignbit_b32 v111, v64, v63, 16
    v_alignbit_b32 v112, v65, v64, 16
    v_dot2_f32_bf16 v116, v60, v114, 0
    ds_read_b64_tr_b16 v[78:79], v6 offset:17792
    v_dot2_f32_bf16 v117, v108, v114, 0
    v_dot2_f32_bf16 v118, v61, v114, 0
    ds_read_b64_tr_b16 v[80:81], v6 offset:1024
    v_dot2_f32_bf16 v119, v109, v114, 0
    v_dot2_f32_bf16 v120, v62, v114, 0
    v_dot2_f32_bf16 v121, v110, v114, 0
    ds_read_b64_tr_b16 v[82:83], v6 offset:5632
    v_dot2_f32_bf16 v122, v63, v114, 0
    v_dot2_f32_bf16 v123, v111, v114, 0
    v_dot2_f32_bf16 v116, v61, v115, v116
    ds_read_b64_tr_b16 v[84:85], v6 offset:10240
    v_dot2_f32_bf16 v117, v109, v115, v117
    v_dot2_f32_bf16 v118, v62, v115, v118
    ds_read_b64_tr_b16 v[86:87], v6 offset:13696
    v_dot2_f32_bf16 v119, v110, v115, v119
    v_dot2_f32_bf16 v120, v63, v115, v120
    v_dot2_f32_bf16 v121, v111, v115, v121
    ds_read_b64_tr_b16 v[88:89], v6 offset:18304
    v_dot2_f32_bf16 v122, v64, v115, v122
    v_dot2_f32_bf16 v123, v112, v115, v123
    v_and_b32 v133, 0xffff0000, v66
    s_waitcnt lgkmcnt(14)
    buffer_store_dwordx4 v[20:23], v19, s[44:47], s15 offen sc1
    v_lshlrev_b32 v132, 16, v66
    v_and_b32 v135, 0xffff0000, v67
    s_waitcnt lgkmcnt(12)
    buffer_store_dwordx4 v[24:27], v19, s[44:47], s7 offen sc1
    v_lshlrev_b32 v134, 16, v67
    v_and_b32 v137, 0xffff0000, v68
    v_lshlrev_b32 v136, 16, v68
    s_waitcnt lgkmcnt(10)
    buffer_store_dwordx4 v[28:31], v19, s[44:47], s8 offen sc1
    v_and_b32 v139, 0xffff0000, v69
    v_lshlrev_b32 v138, 16, v69
    v_pk_mul_f32 v[116:117], v[116:117], v[132:133]
    v_pk_mul_f32 v[118:119], v[118:119], v[134:135]
    v_pk_mul_f32 v[120:121], v[120:121], v[136:137]
    v_pk_mul_f32 v[122:123], v[122:123], v[138:139]
    v_cvt_pk_bf16_f32 v160, v123, v122
    v_cvt_pk_bf16_f32 v161, v121, v120
    v_cvt_pk_bf16_f32 v162, v119, v118
    v_cvt_pk_bf16_f32 v163, v117, v116
    buffer_store_dwordx4 v[160:163], v18, s[44:47], s15 offen sc1
    v_alignbit_b32 v114, v101, v101, 16
    v_alignbit_b32 v115, v100, v100, 16
    s_waitcnt lgkmcnt(5)
    v_alignbit_b32 v108, v71, v70, 16
    v_alignbit_b32 v109, v72, v71, 16
    v_alignbit_b32 v110, v73, v72, 16
    v_alignbit_b32 v111, v74, v73, 16
    v_alignbit_b32 v112, v75, v74, 16
    v_dot2_f32_bf16 v124, v70, v114, 0
    v_dot2_f32_bf16 v125, v108, v114, 0
    v_dot2_f32_bf16 v126, v71, v114, 0
    v_dot2_f32_bf16 v127, v109, v114, 0
    v_dot2_f32_bf16 v128, v72, v114, 0
    v_dot2_f32_bf16 v129, v110, v114, 0
    v_dot2_f32_bf16 v130, v73, v114, 0
    v_dot2_f32_bf16 v131, v111, v114, 0
    v_dot2_f32_bf16 v124, v71, v115, v124
    v_dot2_f32_bf16 v125, v109, v115, v125
    v_dot2_f32_bf16 v126, v72, v115, v126
    v_dot2_f32_bf16 v127, v110, v115, v127
    v_dot2_f32_bf16 v128, v73, v115, v128
    v_dot2_f32_bf16 v129, v111, v115, v129
    v_dot2_f32_bf16 v130, v74, v115, v130
    v_dot2_f32_bf16 v131, v112, v115, v131
    v_and_b32 v133, 0xffff0000, v76
    v_lshlrev_b32 v132, 16, v76
    v_and_b32 v135, 0xffff0000, v77
    v_lshlrev_b32 v134, 16, v77
    v_and_b32 v137, 0xffff0000, v78
    v_lshlrev_b32 v136, 16, v78
    v_and_b32 v139, 0xffff0000, v79
    v_lshlrev_b32 v138, 16, v79
    v_pk_mul_f32 v[124:125], v[124:125], v[132:133]
    v_pk_mul_f32 v[126:127], v[126:127], v[134:135]
    v_pk_mul_f32 v[128:129], v[128:129], v[136:137]
    v_pk_mul_f32 v[130:131], v[130:131], v[138:139]
    v_cvt_pk_bf16_f32 v164, v131, v130
    v_cvt_pk_bf16_f32 v165, v129, v128
    v_cvt_pk_bf16_f32 v166, v127, v126
    v_cvt_pk_bf16_f32 v167, v125, v124
    buffer_store_dwordx4 v[164:167], v18, s[44:47], s7 offen sc1
    v_alignbit_b32 v114, v103, v103, 16
    v_alignbit_b32 v115, v102, v102, 16
    s_waitcnt lgkmcnt(0)
    v_alignbit_b32 v108, v81, v80, 16
    v_alignbit_b32 v109, v82, v81, 16
    v_alignbit_b32 v110, v83, v82, 16
    v_alignbit_b32 v111, v84, v83, 16
    v_alignbit_b32 v112, v85, v84, 16
    v_dot2_f32_bf16 v116, v80, v114, 0
    v_dot2_f32_bf16 v117, v108, v114, 0
    v_dot2_f32_bf16 v118, v81, v114, 0
    v_dot2_f32_bf16 v119, v109, v114, 0
    v_dot2_f32_bf16 v120, v82, v114, 0
    v_dot2_f32_bf16 v121, v110, v114, 0
    v_dot2_f32_bf16 v122, v83, v114, 0
    v_dot2_f32_bf16 v123, v111, v114, 0
    v_dot2_f32_bf16 v116, v81, v115, v116
    v_dot2_f32_bf16 v117, v109, v115, v117
    v_dot2_f32_bf16 v118, v82, v115, v118
    v_dot2_f32_bf16 v119, v110, v115, v119
    v_dot2_f32_bf16 v120, v83, v115, v120
    v_dot2_f32_bf16 v121, v111, v115, v121
    v_dot2_f32_bf16 v122, v84, v115, v122
    v_dot2_f32_bf16 v123, v112, v115, v123
    v_and_b32 v133, 0xffff0000, v86
    v_lshlrev_b32 v132, 16, v86
    v_and_b32 v135, 0xffff0000, v87
    v_lshlrev_b32 v134, 16, v87
    v_and_b32 v137, 0xffff0000, v88
    v_lshlrev_b32 v136, 16, v88
    v_and_b32 v139, 0xffff0000, v89
    v_lshlrev_b32 v138, 16, v89
    v_pk_mul_f32 v[116:117], v[116:117], v[132:133]
    v_pk_mul_f32 v[118:119], v[118:119], v[134:135]
    v_pk_mul_f32 v[120:121], v[120:121], v[136:137]
    v_pk_mul_f32 v[122:123], v[122:123], v[138:139]
    v_cvt_pk_bf16_f32 v168, v123, v122
    v_cvt_pk_bf16_f32 v169, v121, v120
    v_cvt_pk_bf16_f32 v170, v119, v118
    v_cvt_pk_bf16_f32 v171, v117, v116
    buffer_store_dwordx4 v[168:171], v18, s[44:47], s8 offen sc1
    buffer_load_dword v45, v44, s[64:67], 0 offen sc1
    s_add_u32 m0, s73, 98304
    s_lshl_b32 s14, s19, 3
    buffer_load_dwordx4 v148, s[48:51], s14 offen offset:0 lds
    buffer_load_dwordx4 v149, s[48:51], s14 offen offset:1024 lds
    buffer_load_dwordx4 v150, s[48:51], s14 offen offset:2048 lds
    buffer_load_dwordx4 v151, s[48:51], s14 offen offset:3072 lds
    s_add_u32 m0, s73, 0
    s_lshl_b32 s14, s20, 3
    buffer_load_dwordx4 v148, s[48:51], s14 offen offset:0 lds
    buffer_load_dwordx4 v149, s[48:51], s14 offen offset:1024 lds
    buffer_load_dwordx4 v150, s[48:51], s14 offen offset:2048 lds
    buffer_load_dwordx4 v151, s[48:51], s14 offen offset:3072 lds
    s_add_u32 m0, s73, 16384
    s_lshl_b32 s14, s21, 3
    buffer_load_dwordx4 v148, s[48:51], s14 offen offset:0 lds
    buffer_load_dwordx4 v149, s[48:51], s14 offen offset:1024 lds
    s_bfe_u32 s6, s68, 0x20001
    s_lshl_b32 s6, s6, 6
    s_lshr_b32 s7, s68, 3
    s_lshl_b32 s7, s7, 1
    s_add_u32 s6, s6, s7
    s_and_b32 s7, s68, 1
    s_add_u32 s6, s6, s7
    s_lshr_b32 s4, s6, 2
    s_lshl_b32 s4, s4, 7
    s_and_b32 s5, s6, 3
    s_lshl2_add_u32 s4, s5, s4
    s_add_u32 s4, s4, 12533760
    v_min_u32 v1, 1, v0
    v_lshlrev_b32 v1, 30, v1
    v_add_u32 v1, s4, v1
    s_waitcnt vmcnt(10)
    v_readfirstlane_b32 s68, v45
    s_nop 1
    s_cmp_eq_u32 s68, 0
    s_cbranch_scc1 L_nw_G
L_ng_G:
    s_barrier
    v_mov_b32 v3, s68
    buffer_store_dword v3, v1, s[44:47], 0 offen sc1
L_segG:
L_pl_G_0:
    s_cbranch_execz L_pl_G_4
    buffer_load_dwordx4 v150, s[48:51], s14 offen offset:2048 lds
    buffer_load_dwordx4 v151, s[48:51], s14 offen offset:3072 lds
    s_add_u32 m0, s73, 32768
    s_lshl_b32 s14, s22, 3
    buffer_load_dwordx4 v148, s[48:51], s14 offen offset:0 lds
    buffer_load_dwordx4 v149, s[48:51], s14 offen offset:1024 lds
    buffer_load_dwordx4 v150, s[48:51], s14 offen offset:2048 lds
    buffer_load_dwordx4 v151, s[48:51], s14 offen offset:3072 lds
    s_add_u32 m0, s73, 49152
    s_lshl_b32 s14, s23, 3
    buffer_load_dwordx4 v148, s[48:51], s14 offen offset:0 lds
    buffer_load_dwordx4 v149, s[48:51], s14 offen offset:1024 lds
    buffer_load_dwordx4 v150, s[48:51], s14 offen offset:2048 lds
    buffer_load_dwordx4 v151, s[48:51], s14 offen offset:3072 lds
    s_add_u32 m0, s73, 65536
    s_lshl_b32 s14, s24, 3
    buffer_load_dwordx4 v148, s[48:51], s14 offen offset:0 lds
    buffer_load_dwordx4 v149, s[48:51], s14 offen offset:1024 lds
    buffer_load_dwordx4 v150, s[48:51], s14 offen offset:2048 lds
    buffer_load_dwordx4 v151, s[48:51], s14 offen offset:3072 lds
    s_mov_b64 exec, 0
    s_call_b64 s[82:83], L_wc_G
    s_mov_b64 exec, -1
    s_mov_b64 exec, 0
    s_call_b64 s[82:83], L_wc_D
    s_mov_b64 exec, -1
    s_mov_b32 s56, s32
    s_and_b32 s57, s33, 0xffff
    s_mov_b32 s58, 9216
    s_mov_b32 s59, 0x20000
    s_mov_b32 s60, s36
    s_and_b32 s61, s37, 0xffff
    s_mov_b32 s62, 4096
    s_mov_b32 s63, 0x20000
    s_waitcnt lgkmcnt(0)
    s_barrier
    ds_read_b64_tr_b16 a[0:1], v154 offset:16384
    ds_read_b64_tr_b16 a[2:3], v154 offset:17408
    ds_read_b64_tr_b16 a[4:5], v155 offset:16384
    ds_read_b64_tr_b16 a[6:7], v155 offset:17408
    ds_read_b64_tr_b16 a[8:9], v154 offset:24576
    ds_read_b64_tr_b16 a[10:11], v154 offset:25600
    ds_read_b64_tr_b16 a[12:13], v155 offset:24576
    ds_read_b64_tr_b16 a[14:15], v155 offset:25600
    s_and_b32 s4, s70, 1
    s_lshl1_add_u32 s4, s3, s4
    s_lshl_b32 s4, s4, 5
    v_min_u32 v28, 31, v2
    v_add_u32 v28, s4, v28
    v_and_b32 v29, 3, v28
    v_lshrrev_b32 v28, 2, v28
    v_lshlrev_b32 v28, 7, v28
    v_lshl_add_u32 v28, v29, 2, v28
    v_add_u32 v28, 12533760, v28
    s_waitcnt vmcnt(21) lgkmcnt(0)
    s_barrier
    ds_read_b64_tr_b16 a[16:17], v154 offset:32768
    ds_read_b64_tr_b16 a[18:19], v154 offset:33792
    ds_read_b64_tr_b16 a[20:21], v155 offset:32768
    ds_read_b64_tr_b16 a[22:23], v155 offset:33792
    ds_read_b64_tr_b16 a[24:25], v154 offset:40960
    ds_read_b64_tr_b16 a[26:27], v154 offset:41984
    ds_read_b64_tr_b16 a[28:29], v155 offset:40960
    ds_read_b64_tr_b16 a[30:31], v155 offset:41984
    v_lshrrev_b32 v24, 4, v2
    v_lshlrev_b32 v25, 3, v24
    s_lshl_b32 s7, s69, 8
    s_lshl_b32 s8, s3, 6
    s_add_u32 s7, s7, s8
    buffer_load_dwordx2 v[144:145], v25, s[56:59], s7 offen
    buffer_load_dwordx2 v[146:147], v25, s[56:59], s7 offen offset:32
    s_waitcnt vmcnt(19) lgkmcnt(0)
    s_barrier
    ds_read_b64_tr_b16 a[32:33], v152 offset:0
    ds_read_b64_tr_b16 a[34:35], v152 offset:1024
    ds_read_b64_tr_b16 a[36:37], v153 offset:0
    ds_read_b64_tr_b16 a[38:39], v153 offset:1024
    ds_read_b64_tr_b16 a[40:41], v152 offset:8192
    ds_read_b64_tr_b16 a[42:43], v152 offset:9216
    ds_read_b64_tr_b16 a[44:45], v153 offset:8192
    ds_read_b64_tr_b16 a[46:47], v153 offset:9216
    s_waitcnt vmcnt(14) lgkmcnt(0)
    s_barrier
    ds_read_b64_tr_b16 a[48:49], v152 offset:16384
    s_add_u32 m0, s73, 0
    s_lshl_b32 s14, s25, 3
    ds_read_b64_tr_b16 a[50:51], v152 offset:17408
    buffer_load_dwordx4 v148, s[48:51], s14 offen offset:0 lds
    ds_read_b64_tr_b16 a[52:53], v153 offset:16384
    ds_read_b64_tr_b16 a[54:55], v153 offset:17408
    buffer_load_dwordx4 v149, s[48:51], s14 offen offset:1024 lds
    ds_read_b64_tr_b16 a[56:57], v152 offset:24576
    buffer_load_dwordx4 v150, s[48:51], s14 offen offset:2048 lds
    ds_read_b64_tr_b16 a[58:59], v152 offset:25600
    ds_read_b64_tr_b16 a[60:61], v153 offset:24576
    buffer_load_dwordx4 v151, s[48:51], s14 offen offset:3072 lds
    ds_read_b64_tr_b16 a[62:63], v153 offset:25600
    buffer_load_dword v29, v28, s[44:47], 0 offen sc1
    s_waitcnt vmcnt(15) lgkmcnt(0)
    s_barrier
    ds_read_b64_tr_b16 a[64:65], v152 offset:32768
    s_add_u32 m0, s73, 16384
    s_lshl_b32 s14, s26, 3
    ds_read_b64_tr_b16 a[66:67], v152 offset:33792
    buffer_load_dwordx4 v148, s[48:51], s14 offen offset:0 lds
    ds_read_b64_tr_b16 a[68:69], v153 offset:32768
    ds_read_b64_tr_b16 a[70:71], v153 offset:33792
    buffer_load_dwordx4 v149, s[48:51], s14 offen offset:1024 lds
    ds_read_b64_tr_b16 a[72:73], v152 offset:40960
    buffer_load_dwordx4 v150, s[48:51], s14 offen offset:2048 lds
    ds_read_b64_tr_b16 a[74:75], v152 offset:41984
    ds_read_b64_tr_b16 a[76:77], v153 offset:40960
    buffer_load_dwordx4 v151, s[48:51], s14 offen offset:3072 lds
    ds_read_b64_tr_b16 a[78:79], v153 offset:41984
    s_waitcnt vmcnt(4)
    v_cmp_ne_u32 vcc, s68, v29
    s_cbranch_vccnz L_rs_p1G
L_ok_p1G:
    s_add_u32 m0, s74, 0
    s_nop 0
    buffer_load_dwordx4 v156, s[44:47], s18 offen offset:0 sc1 lds
    buffer_load_dwordx4 v157, s[44:47], s18 offen offset:1024 sc1 lds
    buffer_load_dwordx4 v158, s[44:47], s18 offen offset:2048 sc1 lds
    s_add_u32 m0, s74, 12288
    s_nop 0
    buffer_load_dwordx4 v156, s[44:47], s19 offen offset:0 sc1 lds
    buffer_load_dwordx4 v157, s[44:47], s19 offen offset:1024 sc1 lds
    buffer_load_dwordx4 v158, s[44:47], s19 offen offset:2048 sc1 lds
    s_add_u32 m0, s74, 24576
    s_nop 0
    buffer_load_dwordx4 v156, s[44:47], s20 offen offset:0 sc1 lds
    buffer_load_dwordx4 v157, s[44:47], s20 offen offset:1024 sc1 lds
    buffer_load_dwordx4 v158, s[44:47], s20 offen offset:2048 sc1 lds
    s_add_u32 m0, s74, 36864
    s_nop 0
    buffer_load_dwordx4 v156, s[44:47], s21 offen offset:0 sc1 lds
    buffer_load_dwordx4 v157, s[44:47], s21 offen offset:1024 sc1 lds
    buffer_load_dwordx4 v158, s[44:47], s21 offen offset:2048 sc1 lds
L_pl_G_1:
    s_cbranch_execz L_pl_G_5
    s_waitcnt vmcnt(9) lgkmcnt(0)
    s_barrier
    ds_read_b128 v[80:83], v159 offset:0
    ds_read_b128 v[84:87], v159 offset:6144
    ds_read_b128 v[88:91], v159 offset:256
    ds_read_b128 v[92:95], v159 offset:6400
    ds_read_b128 v[96:99], v159 offset:512
    ds_read_b128 v[100:103], v159 offset:6656
    s_waitcnt lgkmcnt(0)
    v_mfma_f32_16x16x32_bf16 v[192:195], a[0:3], v[80:83], 0
    v_mfma_f32_16x16x32_bf16 v[192:195], a[8:11], v[84:87], v[192:195]
    ds_read_b128 v[104:107], v159 offset:768
    v_mfma_f32_16x16x32_bf16 v[196:199], a[12:15], v[84:87], 0
    ds_read_b128 v[108:111], v159 offset:6912
    v_mfma_f32_16x16x32_bf16 v[196:199], a[4:7], v[80:83], v[196:199]
    ds_read_b128 v[112:115], v159 offset:1024
    v_mfma_f32_16x16x32_bf16 v[204:207], a[4:7], v[88:91], 0
    ds_read_b128 v[116:119], v159 offset:7168
    v_mfma_f32_16x16x32_bf16 v[204:207], a[12:15], v[92:95], v[204:207]
    ds_read_b128 v[120:123], v159 offset:1280
    v_mfma_f32_16x16x32_bf16 v[200:203], a[8:11], v[92:95], 0
    ds_read_b128 v[124:127], v159 offset:7424
    v_and_b32 v24, 15, v2
    s_lshl_b32 s7, s71, 6
    s_lshl_b32 s8, s3, 4
    s_add_u32 s7, s7, s8
    v_add_u32 v24, s7, v24
    v_mul_u32_u24 v25, 1152, v24
    v_lshrrev_b32 v31, 4, v2
    v_lshl_add_u32 v25, v31, 3, v25
    s_mul_i32 s8, s72, 144
    v_add_u32 v25, s8, v25
    s_and_b32 s7, s72, 1
    s_lshl_b32 s8, s7, 4
    v_add_u32 v252, s8, v25
    s_mul_i32 s8, s7, 144
    s_sub_u32 s8, 128, s8
    v_add_u32 v25, s8, v25
    v_lshrrev_b32 v31, 5, v2
    v_cmp_eq_u32 vcc, s7, v31
    v_mov_b32 v31, 0x40000000
    s_nop 0
    v_cndmask_b32 v253, v31, v25, vcc
    v_lshlrev_b32 v25, 1, v24
    v_lshlrev_b32 v26, 3, v24
    v_mfma_f32_16x16x32_bf16 v[200:203], a[0:3], v[88:91], v[200:203]
    v_mfma_f32_16x16x32_bf16 v[208:211], a[0:3], v[96:99], 0
    v_mfma_f32_16x16x32_bf16 v[208:211], a[8:11], v[100:103], v[208:211]
    v_mfma_f32_16x16x32_bf16 v[212:215], a[12:15], v[100:103], 0
    v_mfma_f32_16x16x32_bf16 v[212:215], a[4:7], v[96:99], v[212:215]
    s_waitcnt lgkmcnt(0)
    v_mfma_f32_16x16x32_bf16 v[220:223], a[4:7], v[104:107], 0
    s_waitcnt vmcnt(6)
    s_barrier
    v_mfma_f32_16x16x32_bf16 v[220:223], a[12:15], v[108:111], v[220:223]
    ds_read_b128 v[80:83], v159 offset:12288
    s_add_u32 m0, s74, 49152
    v_mfma_f32_16x16x32_bf16 v[216:219], a[8:11], v[108:111], 0
    ds_read_b128 v[84:87], v159 offset:18432
    v_mfma_f32_16x16x32_bf16 v[216:219], a[0:3], v[104:107], v[216:219]
    ds_read_b128 v[88:91], v159 offset:12544
    buffer_load_dwordx4 v156, s[44:47], s22 offen offset:0 sc1 lds
    v_mfma_f32_16x16x32_bf16 v[224:227], a[0:3], v[112:115], 0
    ds_read_b128 v[92:95], v159 offset:18688
    v_mfma_f32_16x16x32_bf16 v[224:227], a[8:11], v[116:119], v[224:227]
    ds_read_b128 v[96:99], v159 offset:12800
    v_mfma_f32_16x16x32_bf16 v[228:231], a[12:15], v[116:119], 0
    ds_read_b128 v[100:103], v159 offset:18944
    buffer_load_dwordx4 v157, s[44:47], s22 offen offset:1024 sc1 lds
    buffer_load_ushort v30, v25, s[60:63], 0 offen
    v_lshrrev_b32 v24, 3, v2
    v_and_b32 v25, 7, v2
    v_bfe_u32 v31, v2, 4, 2
    v_lshlrev_b32 v31, 1, v31
    v_xor_b32 v25, v25, v31
    v_lshlrev_b32 v24, 12, v24
    v_lshl_add_u32 v24, v25, 4, v24
    s_and_b32 s7, s72, 1
    s_lshl_b32 s7, s7, 2
    s_add_u32 s7, s7, s3
    s_mul_i32 s7, s7, 2359296
    s_lshl_b32 s8, s71, 7
    s_add_u32 s7, s7, s8
    v_add_u32 v4, s7, v24
    v_add_u32 v5, 31744, v4
    v_add_u32 v6, 31744, v5
    v_add_u32 v7, 31744, v6
    v_lshrrev_b32 v24, 2, v2
    v_lshlrev_b32 v24, 7, v24
    v_and_b32 v25, 3, v2
    v_lshl_add_u32 v24, v25, 3, v24
    v_add_u32 v24, s73, v24
    v_mfma_f32_16x16x32_bf16 v[228:231], a[4:7], v[112:115], v[228:231]
    ds_read_b64_tr_b16 a[80:81], v152 offset:49152
    v_mfma_f32_16x16x32_bf16 v[236:239], a[4:7], v[120:123], 0
    ds_read_b64_tr_b16 a[82:83], v152 offset:50176
    v_mfma_f32_16x16x32_bf16 v[236:239], a[12:15], v[124:127], v[236:239]
    ds_read_b64_tr_b16 a[84:85], v153 offset:49152
    buffer_load_dwordx4 v158, s[44:47], s22 offen offset:2048 sc1 lds
    v_mfma_f32_16x16x32_bf16 v[232:235], a[8:11], v[124:127], 0
    ds_read_b64_tr_b16 a[86:87], v153 offset:50176
    v_mfma_f32_16x16x32_bf16 v[232:235], a[0:3], v[120:123], v[232:235]
    s_waitcnt lgkmcnt(4)
    v_mfma_f32_16x16x32_bf16 v[192:195], a[16:19], v[80:83], v[192:195]
    s_add_u32 m0, s74, 61440
    v_mfma_f32_16x16x32_bf16 v[192:195], a[24:27], v[84:87], v[192:195]
    ds_read_b128 v[104:107], v159 offset:13056
    v_mfma_f32_16x16x32_bf16 v[196:199], a[28:31], v[84:87], v[196:199]
    ds_read_b128 v[108:111], v159 offset:19200
    v_mfma_f32_16x16x32_bf16 v[196:199], a[20:23], v[80:83], v[196:199]
    ds_read_b128 v[112:115], v159 offset:13312
    buffer_load_dwordx4 v156, s[44:47], s23 offen offset:0 sc1 lds
    v_mfma_f32_16x16x32_bf16 v[204:207], a[20:23], v[88:91], v[204:207]
    ds_read_b128 v[116:119], v159 offset:19456
    v_mfma_f32_16x16x32_bf16 v[204:207], a[28:31], v[92:95], v[204:207]
    ds_read_b128 v[120:123], v159 offset:13568
    v_mfma_f32_16x16x32_bf16 v[200:203], a[24:27], v[92:95], v[200:203]
    ds_read_b128 v[124:127], v159 offset:19712
    buffer_load_dwordx4 v157, s[44:47], s23 offen offset:1024 sc1 lds
    v_bfe_u32 v31, v2, 3, 2
    v_xor_b32 v31, s3, v31
    v_xor_b32 v25, 0, v31
    v_lshl_add_u32 v10, v25, 5, v24
    v_xor_b32 v25, 1, v31
    v_lshl_add_u32 v11, v25, 5, v24
    v_xor_b32 v25, 2, v31
    v_lshl_add_u32 v12, v25, 5, v24
    v_xor_b32 v25, 3, v31
    v_lshl_add_u32 v13, v25, 5, v24
    s_mul_i32 s84, s101, 16
    s_lshr_b32 s84, s84, 2
    s_add_u32 s84, s84, 0
    s_add_u32 s85, s84, 1
    s_cmp_eq_u32 s85, 16
    s_cselect_b32 s85, 0, s85
    s_add_u32 s86, s85, 1
    s_cmp_eq_u32 s86, 16
    s_cselect_b32 s86, 0, s86
    s_add_u32 s87, s86, 1
    s_cmp_eq_u32 s87, 16
    s_cselect_b32 s87, 0, s87
    s_add_u32 s88, s87, 1
    s_cmp_eq_u32 s88, 16
    s_cselect_b32 s88, 0, s88
    s_add_u32 s89, s88, 1
    s_cmp_eq_u32 s89, 16
    s_cselect_b32 s89, 0, s89
    s_add_u32 s90, s89, 1
    s_cmp_eq_u32 s90, 16
    s_cselect_b32 s90, 0, s90
    s_add_u32 s91, s90, 1
    s_cmp_eq_u32 s91, 16
    s_cselect_b32 s91, 0, s91
    s_add_u32 s92, s91, 1
    s_cmp_eq_u32 s92, 16
    s_cselect_b32 s92, 0, s92
    s_add_u32 s93, s92, 1
    s_cmp_eq_u32 s93, 16
    s_cselect_b32 s93, 0, s93
    s_add_u32 s94, s93, 1
    s_cmp_eq_u32 s94, 16
    s_cselect_b32 s94, 0, s94
    s_add_u32 s95, s94, 1
    s_cmp_eq_u32 s95, 16
    s_cselect_b32 s95, 0, s95
    v_mfma_f32_16x16x32_bf16 v[200:203], a[16:19], v[88:91], v[200:203]
    ds_read_b64_tr_b16 a[88:89], v152 offset:57344
    v_mfma_f32_16x16x32_bf16 v[208:211], a[16:19], v[96:99], v[208:211]
    ds_read_b64_tr_b16 a[90:91], v152 offset:58368
    v_mfma_f32_16x16x32_bf16 v[208:211], a[24:27], v[100:103], v[208:211]
    ds_read_b64_tr_b16 a[92:93], v153 offset:57344
    buffer_load_dwordx4 v158, s[44:47], s23 offen offset:2048 sc1 lds
    v_mfma_f32_16x16x32_bf16 v[212:215], a[28:31], v[100:103], v[212:215]
    ds_read_b64_tr_b16 a[94:95], v153 offset:58368
    v_mfma_f32_16x16x32_bf16 v[212:215], a[20:23], v[96:99], v[212:215]
    s_waitcnt lgkmcnt(4)
    v_mfma_f32_16x16x32_bf16 v[220:223], a[20:23], v[104:107], v[220:223]
    s_waitcnt vmcnt(10)
    s_barrier
    v_mfma_f32_16x16x32_bf16 v[220:223], a[28:31], v[108:111], v[220:223]
    ds_read_b128 v[80:83], v159 offset:24576
    s_add_u32 m0, s74, 0
    v_mfma_f32_16x16x32_bf16 v[216:219], a[24:27], v[108:111], v[216:219]
    ds_read_b128 v[84:87], v159 offset:30720
    v_mfma_f32_16x16x32_bf16 v[216:219], a[16:19], v[104:107], v[216:219]
    ds_read_b128 v[88:91], v159 offset:24832
    buffer_load_dwordx4 v156, s[44:47], s24 offen offset:0 sc1 lds
    v_mfma_f32_16x16x32_bf16 v[224:227], a[16:19], v[112:115], v[224:227]
    ds_read_b128 v[92:95], v159 offset:30976
    v_mfma_f32_16x16x32_bf16 v[224:227], a[24:27], v[116:119], v[224:227]
    ds_read_b128 v[96:99], v159 offset:25088
    v_mfma_f32_16x16x32_bf16 v[228:231], a[28:31], v[116:119], v[228:231]
    ds_read_b128 v[100:103], v159 offset:31232
    buffer_load_dwordx4 v157, s[44:47], s24 offen offset:1024 sc1 lds
    s_add_u32 s96, s95, 1
    s_cmp_eq_u32 s96, 16
    s_cselect_b32 s96, 0, s96
    s_add_u32 s97, s96, 1
    s_cmp_eq_u32 s97, 16
    s_cselect_b32 s97, 0, s97
    s_add_u32 s98, s97, 1
    s_cmp_eq_u32 s98, 16
    s_cselect_b32 s98, 0, s98
    s_add_u32 s99, s98, 1
    s_cmp_eq_u32 s99, 16
    s_cselect_b32 s99, 0, s99
    s_mul_i32 s100, s101, 2
    s_lshr_b32 s100, s100, 2
    s_add_u32 s100, s100, 16
    s_add_u32 s101, s100, 1
    s_cmp_eq_u32 s101, 18
    s_cselect_b32 s101, 16, s101
    s_mul_i32 s7, s70, 6
    s_add_u32 s7, s7, 0
    s_mul_i32 s8, s7, 7282
    s_lshr_b32 s8, s8, 16
    s_mul_i32 s5, s8, 9
    s_sub_u32 s7, s7, s5
    s_lshl_b32 s7, s7, 2
    s_mov_b32 s4, 0xba864320
    s_mov_b32 s5, 12
    s_lshr_b64 s[4:5], s[4:5], s7
    s_and_b32 s4, s4, 15
    s_lshl4_add_u32 s4, s8, s4
    v_lshl_add_u32 v240, s4, 8, v245
    s_mul_i32 s7, s70, 6
    s_add_u32 s7, s7, 1
    s_mul_i32 s8, s7, 7282
    s_lshr_b32 s8, s8, 16
    v_mfma_f32_16x16x32_bf16 v[228:231], a[20:23], v[112:115], v[228:231]
    ds_read_b64_tr_b16 a[96:97], v154 offset:0
    v_mfma_f32_16x16x32_bf16 v[236:239], a[20:23], v[120:123], v[236:239]
    ds_read_b64_tr_b16 a[98:99], v154 offset:1024
    v_mfma_f32_16x16x32_bf16 v[236:239], a[28:31], v[124:127], v[236:239]
    ds_read_b64_tr_b16 a[100:101], v155 offset:0
    buffer_load_dwordx4 v158, s[44:47], s24 offen offset:2048 sc1 lds
    v_mfma_f32_16x16x32_bf16 v[232:235], a[24:27], v[124:127], v[232:235]
    ds_read_b64_tr_b16 a[102:103], v155 offset:1024
    v_mfma_f32_16x16x32_bf16 v[232:235], a[16:19], v[120:123], v[232:235]
    s_waitcnt lgkmcnt(4)
    v_mfma_f32_16x16x32_bf16 v[192:195], a[32:35], v[80:83], v[192:195]
    s_add_u32 m0, s74, 12288
    v_mfma_f32_16x16x32_bf16 v[192:195], a[40:43], v[84:87], v[192:195]
    ds_read_b128 v[104:107], v159 offset:25344
    v_mfma_f32_16x16x32_bf16 v[196:199], a[44:47], v[84:87], v[196:199]
    ds_read_b128 v[108:111], v159 offset:31488
    v_mfma_f32_16x16x32_bf16 v[196:199], a[36:39], v[80:83], v[196:199]
    ds_read_b128 v[112:115], v159 offset:25600
    buffer_load_dwordx4 v156, s[44:47], s25 offen offset:0 sc1 lds
    v_mfma_f32_16x16x32_bf16 v[204:207], a[36:39], v[88:91], v[204:207]
    ds_read_b128 v[116:119], v159 offset:31744
    v_mfma_f32_16x16x32_bf16 v[204:207], a[44:47], v[92:95], v[204:207]
    ds_read_b128 v[120:123], v159 offset:25856
    v_mfma_f32_16x16x32_bf16 v[200:203], a[40:43], v[92:95], v[200:203]
    ds_read_b128 v[124:127], v159 offset:32000
    buffer_load_dwordx4 v157, s[44:47], s25 offen offset:1024 sc1 lds
    s_mul_i32 s5, s8, 9
    s_sub_u32 s7, s7, s5
    s_lshl_b32 s7, s7, 2
    s_mov_b32 s4, 0xba864320
    s_mov_b32 s5, 12
    s_lshr_b64 s[4:5], s[4:5], s7
    s_and_b32 s4, s4, 15
    s_lshl4_add_u32 s4, s8, s4
    v_lshl_add_u32 v241, s4, 8, v245
    s_mul_i32 s7, s70, 6
    s_add_u32 s7, s7, 2
    s_mul_i32 s8, s7, 7282
    s_lshr_b32 s8, s8, 16
    s_mul_i32 s5, s8, 9
    s_sub_u32 s7, s7, s5
    s_lshl_b32 s7, s7, 2
    s_mov_b32 s4, 0xba864320
    s_mov_b32 s5, 12
    s_lshr_b64 s[4:5], s[4:5], s7
    s_and_b32 s4, s4, 15
    s_lshl4_add_u32 s4, s8, s4
    v_lshl_add_u32 v242, s4, 8, v245
    v_mfma_f32_16x16x32_bf16 v[200:203], a[32:35], v[88:91], v[200:203]
    ds_read_b64_tr_b16 a[104:105], v154 offset:8192
    v_mfma_f32_16x16x32_bf16 v[208:211], a[32:35], v[96:99], v[208:211]
    ds_read_b64_tr_b16 a[106:107], v154 offset:9216
    v_mfma_f32_16x16x32_bf16 v[208:211], a[40:43], v[100:103], v[208:211]
    ds_read_b64_tr_b16 a[108:109], v155 offset:8192
    buffer_load_dwordx4 v158, s[44:47], s25 offen offset:2048 sc1 lds
    v_mfma_f32_16x16x32_bf16 v[212:215], a[44:47], v[100:103], v[212:215]
    ds_read_b64_tr_b16 a[110:111], v155 offset:9216
    v_mfma_f32_16x16x32_bf16 v[212:215], a[36:39], v[96:99], v[212:215]
    s_waitcnt lgkmcnt(4)
    v_mfma_f32_16x16x32_bf16 v[220:223], a[36:39], v[104:107], v[220:223]
    s_waitcnt vmcnt(13)
    s_barrier
    v_mfma_f32_16x16x32_bf16 v[220:223], a[44:47], v[108:111], v[220:223]
    ds_read_b128 v[80:83], v250 offset:0
    s_add_u32 m0, s74, 24576
    v_mfma_f32_16x16x32_bf16 v[216:219], a[40:43], v[108:111], v[216:219]
    ds_read_b128 v[84:87], v250 offset:6144
    v_mfma_f32_16x16x32_bf16 v[216:219], a[32:35], v[104:107], v[216:219]
    ds_read_b128 v[88:91], v250 offset:256
    buffer_load_dwordx4 v156, s[44:47], s26 offen offset:0 sc1 lds
    v_mfma_f32_16x16x32_bf16 v[224:227], a[32:35], v[112:115], v[224:227]
    ds_read_b128 v[92:95], v250 offset:6400
    v_mfma_f32_16x16x32_bf16 v[224:227], a[40:43], v[116:119], v[224:227]
    ds_read_b128 v[96:99], v250 offset:512
    v_mfma_f32_16x16x32_bf16 v[228:231], a[44:47], v[116:119], v[228:231]
    ds_read_b128 v[100:103], v250 offset:6656
    buffer_load_dwordx4 v157, s[44:47], s26 offen offset:1024 sc1 lds
    s_mul_i32 s7, s70, 6
    s_add_u32 s7, s7, 3
    s_mul_i32 s8, s7, 7282
    s_lshr_b32 s8, s8, 16
    s_mul_i32 s5, s8, 9
    s_sub_u32 s7, s7, s5
    s_lshl_b32 s7, s7, 2
    s_mov_b32 s4, 0xba864320
    s_mov_b32 s5, 12
    s_lshr_b64 s[4:5], s[4:5], s7
    s_and_b32 s4, s4, 15
    s_lshl4_add_u32 s4, s8, s4
    v_lshl_add_u32 v243, s4, 8, v245
    s_mul_i32 s7, s70, 6
    s_add_u32 s7, s7, 4
    s_mul_i32 s8, s7, 7282
    s_lshr_b32 s8, s8, 16
    s_mul_i32 s5, s8, 9
    s_sub_u32 s7, s7, s5
    s_lshl_b32 s7, s7, 2
    s_mov_b32 s4, 0xba864320
    s_mov_b32 s5, 12
    v_mfma_f32_16x16x32_bf16 v[228:231], a[36:39], v[112:115], v[228:231]
    ds_read_b64_tr_b16 a[112:113], v152 offset:0
    v_mfma_f32_16x16x32_bf16 v[236:239], a[36:39], v[120:123], v[236:239]
    ds_read_b64_tr_b16 a[114:115], v152 offset:1024
    v_mfma_f32_16x16x32_bf16 v[236:239], a[44:47], v[124:127], v[236:239]
    ds_read_b64_tr_b16 a[116:117], v153 offset:0
    buffer_load_dwordx4 v158, s[44:47], s26 offen offset:2048 sc1 lds
    v_mfma_f32_16x16x32_bf16 v[232:235], a[40:43], v[124:127], v[232:235]
    ds_read_b64_tr_b16 a[118:119], v153 offset:1024
    v_mfma_f32_16x16x32_bf16 v[232:235], a[32:35], v[120:123], v[232:235]
    s_waitcnt lgkmcnt(4)
    v_mfma_f32_16x16x32_bf16 v[192:195], a[48:51], v[80:83], v[192:195]
    s_add_u32 m0, s73, 32768
    s_lshl_b32 s14, s27, 3
    v_mfma_f32_16x16x32_bf16 v[192:195], a[56:59], v[84:87], v[192:195]
    ds_read_b128 v[104:107], v250 offset:768
    v_mfma_f32_16x16x32_bf16 v[196:199], a[60:63], v[84:87], v[196:199]
    ds_read_b128 v[108:111], v250 offset:6912
    buffer_load_dwordx4 v148, s[48:51], s14 offen offset:0 lds
    v_mfma_f32_16x16x32_bf16 v[196:199], a[52:55], v[80:83], v[196:199]
    ds_read_b128 v[112:115], v250 offset:1024
    v_mfma_f32_16x16x32_bf16 v[204:207], a[52:55], v[88:91], v[204:207]
    ds_read_b128 v[116:119], v250 offset:7168
    buffer_load_dwordx4 v149, s[48:51], s14 offen offset:1024 lds
    v_mfma_f32_16x16x32_bf16 v[204:207], a[60:63], v[92:95], v[204:207]
    ds_read_b128 v[120:123], v250 offset:1280
    v_mfma_f32_16x16x32_bf16 v[200:203], a[56:59], v[92:95], v[200:203]
    ds_read_b128 v[124:127], v250 offset:7424
    s_lshr_b64 s[4:5], s[4:5], s7
    s_and_b32 s4, s4, 15
    s_lshl4_add_u32 s4, s8, s4
    v_lshl_add_u32 v244, s4, 8, v245
    s_mul_i32 s7, s70, 6
    s_add_u32 s7, s7, 5
    s_mul_i32 s8, s7, 7282
    s_lshr_b32 s8, s8, 16
    s_mul_i32 s5, s8, 9
    s_sub_u32 s7, s7, s5
    s_lshl_b32 s7, s7, 2
    s_mov_b32 s4, 0xba864320
    s_mov_b32 s5, 12
    s_lshr_b64 s[4:5], s[4:5], s7
    s_and_b32 s4, s4, 15
    s_lshl4_add_u32 s4, s8, s4
    v_lshl_add_u32 v245, s4, 8, v245
    s_xor_b32 s7, s75, 1
    s_lshl2_add_u32 s7, s7, s3
    s_mul_i32 s9, s7, 6144
    s_add_u32 s9, s9, 28065792
    s_lshl_b32 s7, s7, 7
    s_add_u32 s6, s7, 33374208
    s_lshl2_add_u32 s7, s75, s3
    s_mul_i32 s10, s7, 6144
    s_add_u32 s10, s10, 28065792
    s_lshl_b32 s7, s7, 7
    s_add_u32 s7, s7, 33374208
    v_mov_b32 v28, s7
    v_mfma_f32_16x16x32_bf16 v[200:203], a[48:51], v[88:91], v[200:203]
    ds_read_b64_tr_b16 a[120:121], v152 offset:8192
    buffer_load_dwordx4 v150, s[48:51], s14 offen offset:2048 lds
    v_mfma_f32_16x16x32_bf16 v[208:211], a[48:51], v[96:99], v[208:211]
    ds_read_b64_tr_b16 a[122:123], v152 offset:9216
    v_mfma_f32_16x16x32_bf16 v[208:211], a[56:59], v[100:103], v[208:211]
    ds_read_b64_tr_b16 a[124:125], v153 offset:8192
    buffer_load_dwordx4 v151, s[48:51], s14 offen offset:3072 lds
    v_mfma_f32_16x16x32_bf16 v[212:215], a[60:63], v[100:103], v[212:215]
    ds_read_b64_tr_b16 a[126:127], v153 offset:9216
    v_mfma_f32_16x16x32_bf16 v[212:215], a[52:55], v[96:99], v[212:215]
    s_waitcnt lgkmcnt(4)
    v_mfma_f32_16x16x32_bf16 v[220:223], a[52:55], v[104:107], v[220:223]
    s_waitcnt vmcnt(16)
    s_barrier
    v_mfma_f32_16x16x32_bf16 v[220:223], a[60:63], v[108:111], v[220:223]
    ds_read_b128 v[80:83], v250 offset:12288
    s_add_u32 m0, s74, 36864
    v_mfma_f32_16x16x32_bf16 v[216:219], a[56:59], v[108:111], v[216:219]
    ds_read_b128 v[84:87], v250 offset:18432
    v_mfma_f32_16x16x32_bf16 v[216:219], a[48:51], v[104:107], v[216:219]
    ds_read_b128 v[88:91], v250 offset:12544
    buffer_load_dwordx4 v156, s[44:47], s27 offen offset:0 sc1 lds
    v_mfma_f32_16x16x32_bf16 v[224:227], a[48:51], v[112:115], v[224:227]
    ds_read_b128 v[92:95], v250 offset:18688
    v_mfma_f32_16x16x32_bf16 v[224:227], a[56:59], v[116:119], v[224:227]
    ds_read_b128 v[96:99], v250 offset:12800
    v_mfma_f32_16x16x32_bf16 v[228:231], a[60:63], v[116:119], v[228:231]
    ds_read_b128 v[100:103], v250 offset:18944
    buffer_load_dwordx4 v157, s[44:47], s27 offen offset:1024 sc1 lds
    v_add_u32 v247, 3072, v246
    v_cmp_eq_u32 vcc, 0, v2
    v_mov_b32 v248, 0x40000000
    s_nop 0
    v_cndmask_b32 v248, v248, 0, vcc
    v_mov_b32 v249, s68
    v_and_b32 v129, 0xffff0000, v144
    v_lshlrev_b32 v128, 16, v144
    v_and_b32 v131, 0xffff0000, v145
    v_lshlrev_b32 v130, 16, v145
    v_and_b32 v133, 0xffff0000, v146
    v_lshlrev_b32 v132, 16, v146
    v_and_b32 v135, 0xffff0000, v147
    v_lshlrev_b32 v134, 16, v147
    s_lshr_b32 s4, s75, 2
    s_lshl_b32 s4, s4, 7
    s_and_b32 s5, s75, 3
    s_lshl2_add_u32 s4, s5, s4
    s_add_u32 s4, s4, 12566528
    v_min_u32 v17, 1, v0
    v_lshlrev_b32 v17, 30, v17
    v_add_u32 v17, s4, v17
    v_mfma_f32_16x16x32_bf16 v[228:231], a[52:55], v[112:115], v[228:231]
    ds_read_b64_tr_b16 a[128:129], v152 offset:16384
    v_mfma_f32_16x16x32_bf16 v[236:239], a[52:55], v[120:123], v[236:239]
    ds_read_b64_tr_b16 a[130:131], v152 offset:17408
    v_mfma_f32_16x16x32_bf16 v[236:239], a[60:63], v[124:127], v[236:239]
    ds_read_b64_tr_b16 a[132:133], v153 offset:16384
    buffer_load_dwordx4 v158, s[44:47], s27 offen offset:2048 sc1 lds
    v_mfma_f32_16x16x32_bf16 v[232:235], a[56:59], v[124:127], v[232:235]
    ds_read_b64_tr_b16 a[134:135], v153 offset:17408
    v_mfma_f32_16x16x32_bf16 v[232:235], a[48:51], v[120:123], v[232:235]
    s_waitcnt lgkmcnt(4)
    v_mfma_f32_16x16x32_bf16 v[192:195], a[64:67], v[80:83], v[192:195]
    s_add_u32 m0, s73, 49152
    s_lshl_b32 s14, s76, 3
    v_mfma_f32_16x16x32_bf16 v[192:195], a[72:75], v[84:87], v[192:195]
    ds_read_b128 v[104:107], v250 offset:13056
    v_mfma_f32_16x16x32_bf16 v[196:199], a[76:79], v[84:87], v[196:199]
    ds_read_b128 v[108:111], v250 offset:19200
    buffer_load_dwordx4 v148, s[48:51], s14 offen offset:0 lds
    v_mfma_f32_16x16x32_bf16 v[196:199], a[68:71], v[80:83], v[196:199]
    ds_read_b128 v[112:115], v250 offset:13312
    v_mfma_f32_16x16x32_bf16 v[204:207], a[68:71], v[88:91], v[204:207]
    ds_read_b128 v[116:119], v250 offset:19456
    buffer_load_dwordx4 v149, s[48:51], s14 offen offset:1024 lds
    v_mfma_f32_16x16x32_bf16 v[204:207], a[76:79], v[92:95], v[204:207]
    ds_read_b128 v[120:123], v250 offset:13568
    v_mfma_f32_16x16x32_bf16 v[200:203], a[72:75], v[92:95], v[200:203]
    ds_read_b128 v[124:127], v250 offset:19712
    s_and_b32 s4, s72, 1
    s_lshl_b32 s4, s4, 2
    s_add_u32 s4, s4, s3
    s_mul_i32 s4, s4, 18
    s_lshr_b32 s4, s4, 2
    s_mul_i32 s4, s4, 6
    s_lshr_b32 s5, s72, 1
    s_mul_i32 s5, s5, 3
    s_lshr_b32 s5, s5, 1
    s_add_u32 s4, s4, s5
    v_min_u32 v18, 9, v2
    v_lshrrev_b32 v19, 1, v18
    v_lshl_add_u32 v18, v19, 2, v18
    v_add_u32 v18, s4, v18
    v_and_b32 v19, 3, v18
    v_lshrrev_b32 v18, 2, v18
    v_lshlrev_b32 v18, 7, v18
    v_lshl_add_u32 v18, v19, 2, v18
    v_add_u32 v18, 12566528, v18
    v_lshrrev_b32 v31, 4, v2
    v_mul_u32_u24 v24, 17408, v31
    v_and_b32 v25, 15, v2
    v_lshl_add_u32 v24, v25, 4, v24
    v_mfma_f32_16x16x32_bf16 v[200:203], a[64:67], v[88:91], v[200:203]
    ds_read_b64_tr_b16 a[136:137], v152 offset:24576
    buffer_load_dwordx4 v150, s[48:51], s14 offen offset:2048 lds
    v_mfma_f32_16x16x32_bf16 v[208:211], a[64:67], v[96:99], v[208:211]
    ds_read_b64_tr_b16 a[138:139], v152 offset:25600
    v_mfma_f32_16x16x32_bf16 v[208:211], a[72:75], v[100:103], v[208:211]
    ds_read_b64_tr_b16 a[140:141], v153 offset:24576
    buffer_load_dwordx4 v151, s[48:51], s14 offen offset:3072 lds
    v_mfma_f32_16x16x32_bf16 v[212:215], a[76:79], v[100:103], v[212:215]
    ds_read_b64_tr_b16 a[142:143], v153 offset:25600
    v_mfma_f32_16x16x32_bf16 v[212:215], a[68:71], v[96:99], v[212:215]
    s_waitcnt lgkmcnt(4)
    v_mfma_f32_16x16x32_bf16 v[220:223], a[68:71], v[104:107], v[220:223]
    s_waitcnt vmcnt(20)
    s_barrier
    v_mfma_f32_16x16x32_bf16 v[220:223], a[76:79], v[108:111], v[220:223]
    ds_read_b128 v[80:83], v250 offset:24576
    s_add_u32 m0, s74, 49152
    v_mfma_f32_16x16x32_bf16 v[216:219], a[72:75], v[108:111], v[216:219]
    ds_read_b128 v[84:87], v250 offset:30720
    v_mfma_f32_16x16x32_bf16 v[216:219], a[64:67], v[104:107], v[216:219]
    ds_read_b128 v[88:91], v250 offset:24832
    buffer_load_dwordx4 v156, s[44:47], s76 offen offset:0 sc1 lds
    v_mfma_f32_16x16x32_bf16 v[224:227], a[64:67], v[112:115], v[224:227]
    ds_read_b128 v[92:95], v250 offset:30976
    v_mfma_f32_16x16x32_bf16 v[224:227], a[72:75], v[116:119], v[224:227]
    ds_read_b128 v[96:99], v250 offset:25088
    v_mfma_f32_16x16x32_bf16 v[228:231], a[76:79], v[116:119], v[228:231]
    ds_read_b128 v[100:103], v250 offset:31232
    buffer_load_dwordx4 v157, s[44:47], s76 offen offset:1024 sc1 lds
    s_and_b32 s7, s72, 1
    s_lshl_b32 s7, s7, 2
    s_add_u32 s7, s7, s3
    s_mul_i32 s7, s7, 1253376
    s_lshr_b32 s8, s72, 1
    s_lshl_b32 s8, s8, 12
    s_add_u32 s7, s7, s8
    s_add_u32 s7, s7, 12795904
    v_add_u32 v9, s7, v24
    s_and_b32 s12, s72, 1
    s_xor_b32 s8, s12, 1
    s_lshl_b32 s8, s8, 11
    v_add_u32 v8, s8, v9
    s_lshl_b32 s11, s12, 12
    s_sub_u32 s11, s11, 2048
    s_mov_b32 s64, s38
    s_and_b32 s65, s39, 0xffff
    s_mov_b32 s66, 2359296
    s_mov_b32 s67, 0x20000
    s_mov_b32 s56, s16
    s_and_b32 s57, s17, 0xffff
    s_mov_b32 s58, 2359296
    v_mfma_f32_16x16x32_bf16 v[228:231], a[68:71], v[112:115], v[228:231]
    v_mfma_f32_16x16x32_bf16 v[236:239], a[68:71], v[120:123], v[236:239]
    v_mfma_f32_16x16x32_bf16 v[236:239], a[76:79], v[124:127], v[236:239]
    buffer_load_dwordx4 v158, s[44:47], s76 offen offset:2048 sc1 lds
    v_mfma_f32_16x16x32_bf16 v[232:235], a[72:75], v[124:127], v[232:235]
    v_mfma_f32_16x16x32_bf16 v[232:235], a[64:67], v[120:123], v[232:235]
    s_waitcnt lgkmcnt(0)
    v_mfma_f32_16x16x32_bf16 v[192:195], a[80:83], v[80:83], v[192:195]
    s_add_u32 m0, s73, 65536
    s_lshl_b32 s14, s77, 3
    v_mfma_f32_16x16x32_bf16 v[192:195], a[88:91], v[84:87], v[192:195]
    ds_read_b128 v[104:107], v250 offset:25344
    v_mfma_f32_16x16x32_bf16 v[196:199], a[92:95], v[84:87], v[196:199]
    ds_read_b128 v[108:111], v250 offset:31488
    buffer_load_dwordx4 v148, s[48:51], s14 offen offset:0 lds
    v_mfma_f32_16x16x32_bf16 v[196:199], a[84:87], v[80:83], v[196:199]
    ds_read_b128 v[112:115], v250 offset:25600
    v_mfma_f32_16x16x32_bf16 v[204:207], a[84:87], v[88:91], v[204:207]
    ds_read_b128 v[116:119], v250 offset:31744
    buffer_load_dwordx4 v149, s[48:51], s14 offen offset:1024 lds
    v_mfma_f32_16x16x32_bf16 v[204:207], a[92:95], v[92:95], v[204:207]
    ds_read_b128 v[120:123], v250 offset:25856
    v_mfma_f32_16x16x32_bf16 v[200:203], a[88:91], v[92:95], v[200:203]
    ds_read_b128 v[124:127], v250 offset:32000
    s_mov_b32 s59, 0x20000
    v_add_u32 v24, 0, v2
    v_mul_u32_u24 v25, 7282, v24
    v_lshrrev_b32 v25, 16, v25
    v_mul_u32_u24 v25, 1008, v25
    v_lshl_add_u32 v14, v2, 4, v25
    v_add_u32 v24, 64, v2
    v_mul_u32_u24 v25, 7282, v24
    v_lshrrev_b32 v25, 16, v25
    v_mul_u32_u24 v25, 1008, v25
    v_lshl_add_u32 v15, v2, 4, v25
    v_add_u32 v24, 128, v2
    v_mul_u32_u24 v25, 7282, v24
    v_lshrrev_b32 v25, 16, v25
    v_mul_u32_u24 v25, 1008, v25
    v_lshl_add_u32 v16, v2, 4, v25
    v_cmp_gt_u32 vcc, 16, v2
    v_mov_b32 v25, 0x40000000
    s_nop 0
    v_cndmask_b32 v16, v25, v16, vcc
    s_and_b32 s7, s72, 1
    s_lshl_b32 s7, s7, 2
    s_add_u32 s7, s7, s3
    s_mul_i32 s7, s7, 2359296
    v_mfma_f32_16x16x32_bf16 v[200:203], a[80:83], v[88:91], v[200:203]
    buffer_load_dwordx4 v150, s[48:51], s14 offen offset:2048 lds
    v_mfma_f32_16x16x32_bf16 v[208:211], a[80:83], v[96:99], v[208:211]
    v_mfma_f32_16x16x32_bf16 v[208:211], a[88:91], v[100:103], v[208:211]
    buffer_load_dwordx4 v151, s[48:51], s14 offen offset:3072 lds
    v_mfma_f32_16x16x32_bf16 v[212:215], a[92:95], v[100:103], v[212:215]
    v_mfma_f32_16x16x32_bf16 v[212:215], a[84:87], v[96:99], v[212:215]
    s_waitcnt lgkmcnt(0)
    v_mfma_f32_16x16x32_bf16 v[220:223], a[84:87], v[104:107], v[220:223]
    s_waitcnt vmcnt(14)
    s_barrier
    v_mfma_f32_16x16x32_bf16 v[220:223], a[92:95], v[108:111], v[220:223]
    ds_read_b128 v[80:83], v159 offset:0
    s_add_u32 m0, s74, 61440
    v_mfma_f32_16x16x32_bf16 v[216:219], a[88:91], v[108:111], v[216:219]
    ds_read_b128 v[84:87], v159 offset:6144
    v_mfma_f32_16x16x32_bf16 v[216:219], a[80:83], v[104:107], v[216:219]
    ds_read_b128 v[88:91], v159 offset:256
    buffer_load_dwordx4 v156, s[44:47], s77 offen offset:0 sc1 lds
    v_mfma_f32_16x16x32_bf16 v[224:227], a[80:83], v[112:115], v[224:227]
    ds_read_b128 v[92:95], v159 offset:6400
    v_mfma_f32_16x16x32_bf16 v[224:227], a[88:91], v[116:119], v[224:227]
    ds_read_b128 v[96:99], v159 offset:512
    v_mfma_f32_16x16x32_bf16 v[228:231], a[92:95], v[116:119], v[228:231]
    ds_read_b128 v[100:103], v159 offset:6656
    buffer_load_dwordx4 v157, s[44:47], s77 offen offset:1024 sc1 lds
    v_subrev_u32 v3, s7, v4
    v_and_b32 v24, 15, v2
    v_mul_u32_u24 v24, 144, v24
    v_lshrrev_b32 v25, 4, v2
    v_lshl_add_u32 v24, v25, 3, v24
    s_add_u32 s7, s73, 131072
    s_lshl_b32 s4, s12, 4
    s_add_u32 s4, s4, s7
    v_add_u32 v1, s4, v24
    s_mul_i32 s4, s12, 144
    s_sub_u32 s4, s7, s4
    v_add_u32 v24, s4, v24
    v_bfe_u32 v25, v2, 2, 3
    v_lshlrev_b32 v25, 7, v25
    v_lshrrev_b32 v31, 5, v2
    v_lshl_add_u32 v25, v31, 12, v25
    v_bfe_u32 v31, v2, 3, 2
    v_xor_b32 v31, s3, v31
    v_lshl_add_u32 v25, v31, 5, v25
    v_and_b32 v31, 3, v2
    v_lshl_add_u32 v25, v31, 3, v25
    v_add_u32 v25, 147456, v25
    v_mfma_f32_16x16x32_bf16 v[228:231], a[84:87], v[112:115], v[228:231]
    ds_read_b64_tr_b16 a[144:145], v152 offset:32768
    v_mfma_f32_16x16x32_bf16 v[236:239], a[84:87], v[120:123], v[236:239]
    ds_read_b64_tr_b16 a[146:147], v152 offset:33792
L_pl_G_2:
    s_cbranch_execz L_pl_G_6
    v_mfma_f32_16x16x32_bf16 v[236:239], a[92:95], v[124:127], v[236:239]
    ds_read_b64_tr_b16 a[148:149], v153 offset:32768
    buffer_load_dwordx4 v158, s[44:47], s77 offen offset:2048 sc1 lds
    v_mfma_f32_16x16x32_bf16 v[232:235], a[88:91], v[124:127], v[232:235]
    ds_read_b64_tr_b16 a[150:151], v153 offset:33792
    v_mfma_f32_16x16x32_bf16 v[232:235], a[80:83], v[120:123], v[232:235]
    s_waitcnt lgkmcnt(4)
    v_mfma_f32_16x16x32_bf16 v[192:195], a[96:99], v[80:83], v[192:195]
    s_add_u32 m0, s73, 0
    s_lshl_b32 s14, s78, 3
    v_mfma_f32_16x16x32_bf16 v[192:195], a[104:107], v[84:87], v[192:195]
    ds_read_b128 v[104:107], v159 offset:768
    v_mfma_f32_16x16x32_bf16 v[196:199], a[108:111], v[84:87], v[196:199]
    ds_read_b128 v[108:111], v159 offset:6912
    buffer_load_dwordx4 v148, s[48:51], s14 offen offset:0 lds
    v_mfma_f32_16x16x32_bf16 v[196:199], a[100:103], v[80:83], v[196:199]
    ds_read_b128 v[112:115], v159 offset:1024
    v_mfma_f32_16x16x32_bf16 v[204:207], a[100:103], v[88:91], v[204:207]
    ds_read_b128 v[116:119], v159 offset:7168
    buffer_load_dwordx4 v149, s[48:51], s14 offen offset:1024 lds
    v_mfma_f32_16x16x32_bf16 v[204:207], a[108:111], v[92:95], v[204:207]
    ds_read_b128 v[120:123], v159 offset:1280
    v_mfma_f32_16x16x32_bf16 v[200:203], a[104:107], v[92:95], v[200:203]
    ds_read_b128 v[124:127], v159 offset:7424
    v_mfma_f32_16x16x32_bf16 v[200:203], a[96:99], v[88:91], v[200:203]
    ds_read_b64_tr_b16 a[152:153], v152 offset:40960
    buffer_load_dwordx4 v150, s[48:51], s14 offen offset:2048 lds
    v_mfma_f32_16x16x32_bf16 v[208:211], a[96:99], v[96:99], v[208:211]
    ds_read_b64_tr_b16 a[154:155], v152 offset:41984
    v_mfma_f32_16x16x32_bf16 v[208:211], a[104:107], v[100:103], v[208:211]
    ds_read_b64_tr_b16 a[156:157], v153 offset:40960
    buffer_load_dwordx4 v151, s[48:51], s14 offen offset:3072 lds
    v_mfma_f32_16x16x32_bf16 v[212:215], a[108:111], v[100:103], v[212:215]
    ds_read_b64_tr_b16 a[158:159], v153 offset:41984
    v_mfma_f32_16x16x32_bf16 v[212:215], a[100:103], v[96:99], v[212:215]
    s_waitcnt lgkmcnt(4)
    v_mfma_f32_16x16x32_bf16 v[220:223], a[100:103], v[104:107], v[220:223]
    s_waitcnt vmcnt(14)
    s_barrier
    v_mfma_f32_16x16x32_bf16 v[220:223], a[108:111], v[108:111], v[220:223]
    ds_read_b128 v[80:83], v159 offset:12288
    s_add_u32 m0, s74, 0
    v_mfma_f32_16x16x32_bf16 v[216:219], a[104:107], v[108:111], v[216:219]
    ds_read_b128 v[84:87], v159 offset:18432
    v_mfma_f32_16x16x32_bf16 v[216:219], a[96:99], v[104:107], v[216:219]
    ds_read_b128 v[88:91], v159 offset:12544
    buffer_load_dwordx4 v156, s[44:47], s78 offen offset:0 sc1 lds
    v_mfma_f32_16x16x32_bf16 v[224:227], a[96:99], v[112:115], v[224:227]
    ds_read_b128 v[92:95], v159 offset:18688
    v_mfma_f32_16x16x32_bf16 v[224:227], a[104:107], v[116:119], v[224:227]
    ds_read_b128 v[96:99], v159 offset:12800
    v_mfma_f32_16x16x32_bf16 v[228:231], a[108:111], v[116:119], v[228:231]
    ds_read_b128 v[100:103], v159 offset:18944
    buffer_load_dwordx4 v157, s[44:47], s78 offen offset:1024 sc1 lds
    v_mfma_f32_16x16x32_bf16 v[228:231], a[100:103], v[112:115], v[228:231]
    ds_read_b64_tr_b16 a[160:161], v152 offset:49152
    v_mfma_f32_16x16x32_bf16 v[236:239], a[100:103], v[120:123], v[236:239]
    ds_read_b64_tr_b16 a[162:163], v152 offset:50176
    v_mfma_f32_16x16x32_bf16 v[236:239], a[108:111], v[124:127], v[236:239]
    ds_read_b64_tr_b16 a[164:165], v153 offset:49152
    buffer_load_dwordx4 v158, s[44:47], s78 offen offset:2048 sc1 lds
    v_mfma_f32_16x16x32_bf16 v[232:235], a[104:107], v[124:127], v[232:235]
    ds_read_b64_tr_b16 a[166:167], v153 offset:50176
    v_mfma_f32_16x16x32_bf16 v[232:235], a[96:99], v[120:123], v[232:235]
    s_waitcnt lgkmcnt(4)
    v_mfma_f32_16x16x32_bf16 v[192:195], a[112:115], v[80:83], v[192:195]
    s_add_u32 m0, s73, 16384
    s_lshl_b32 s14, s79, 3
    v_mfma_f32_16x16x32_bf16 v[192:195], a[120:123], v[84:87], v[192:195]
    ds_read_b128 v[104:107], v159 offset:13056
    v_mfma_f32_16x16x32_bf16 v[196:199], a[124:127], v[84:87], v[196:199]
    ds_read_b128 v[108:111], v159 offset:19200
    buffer_load_dwordx4 v148, s[48:51], s14 offen offset:0 lds
    v_mfma_f32_16x16x32_bf16 v[196:199], a[116:119], v[80:83], v[196:199]
    ds_read_b128 v[112:115], v159 offset:13312
    v_mfma_f32_16x16x32_bf16 v[204:207], a[116:119], v[88:91], v[204:207]
    ds_read_b128 v[116:119], v159 offset:19456
    buffer_load_dwordx4 v149, s[48:51], s14 offen offset:1024 lds
    v_mfma_f32_16x16x32_bf16 v[204:207], a[124:127], v[92:95], v[204:207]
    ds_read_b128 v[120:123], v159 offset:13568
    v_mfma_f32_16x16x32_bf16 v[200:203], a[120:123], v[92:95], v[200:203]
    ds_read_b128 v[124:127], v159 offset:19712
    v_mfma_f32_16x16x32_bf16 v[200:203], a[112:115], v[88:91], v[200:203]
    ds_read_b64_tr_b16 a[168:169], v152 offset:57344
    buffer_load_dwordx4 v150, s[48:51], s14 offen offset:2048 lds
    v_mfma_f32_16x16x32_bf16 v[208:211], a[112:115], v[96:99], v[208:211]
    ds_read_b64_tr_b16 a[170:171], v152 offset:58368
    v_mfma_f32_16x16x32_bf16 v[208:211], a[120:123], v[100:103], v[208:211]
    ds_read_b64_tr_b16 a[172:173], v153 offset:57344
    buffer_load_dwordx4 v151, s[48:51], s14 offen offset:3072 lds
    v_mfma_f32_16x16x32_bf16 v[212:215], a[124:127], v[100:103], v[212:215]
    ds_read_b64_tr_b16 a[174:175], v153 offset:58368
    v_mfma_f32_16x16x32_bf16 v[212:215], a[116:119], v[96:99], v[212:215]
    s_waitcnt lgkmcnt(4)
    v_mfma_f32_16x16x32_bf16 v[220:223], a[116:119], v[104:107], v[220:223]
    s_waitcnt vmcnt(14)
    s_barrier
    v_mfma_f32_16x16x32_bf16 v[220:223], a[124:127], v[108:111], v[220:223]
    ds_read_b128 v[80:83], v159 offset:24576
    s_add_u32 m0, s74, 12288
    v_mfma_f32_16x16x32_bf16 v[216:219], a[120:123], v[108:111], v[216:219]
    ds_read_b128 v[84:87], v159 offset:30720
    v_mfma_f32_16x16x32_bf16 v[216:219], a[112:115], v[104:107], v[216:219]
    ds_read_b128 v[88:91], v159 offset:24832
    buffer_load_dwordx4 v156, s[44:47], s79 offen offset:0 sc1 lds
    v_mfma_f32_16x16x32_bf16 v[224:227], a[112:115], v[112:115], v[224:227]
    ds_read_b128 v[92:95], v159 offset:30976
    v_mfma_f32_16x16x32_bf16 v[224:227], a[120:123], v[116:119], v[224:227]
    ds_read_b128 v[96:99], v159 offset:25088
    v_mfma_f32_16x16x32_bf16 v[228:231], a[124:127], v[116:119], v[228:231]
    ds_read_b128 v[100:103], v159 offset:31232
    buffer_load_dwordx4 v157, s[44:47], s79 offen offset:1024 sc1 lds
    v_mfma_f32_16x16x32_bf16 v[228:231], a[116:119], v[112:115], v[228:231]
    ds_read_b64_tr_b16 a[176:177], v154 offset:0
    v_mfma_f32_16x16x32_bf16 v[236:239], a[116:119], v[120:123], v[236:239]
    ds_read_b64_tr_b16 a[178:179], v154 offset:1024
    v_mfma_f32_16x16x32_bf16 v[236:239], a[124:127], v[124:127], v[236:239]
    ds_read_b64_tr_b16 a[180:181], v155 offset:0
    buffer_load_dwordx4 v158, s[44:47], s79 offen offset:2048 sc1 lds
    v_mfma_f32_16x16x32_bf16 v[232:235], a[120:123], v[124:127], v[232:235]
    ds_read_b64_tr_b16 a[182:183], v155 offset:1024
    v_mfma_f32_16x16x32_bf16 v[232:235], a[112:115], v[120:123], v[232:235]
    s_waitcnt lgkmcnt(4)
    v_mfma_f32_16x16x32_bf16 v[192:195], a[128:131], v[80:83], v[192:195]
    s_add_u32 m0, s73, 32768
    s_lshl_b32 s14, s80, 3
    v_mfma_f32_16x16x32_bf16 v[192:195], a[136:139], v[84:87], v[192:195]
    ds_read_b128 v[104:107], v159 offset:25344
    v_mfma_f32_16x16x32_bf16 v[196:199], a[140:143], v[84:87], v[196:199]
    ds_read_b128 v[108:111], v159 offset:31488
    buffer_load_dwordx4 v148, s[48:51], s14 offen offset:0 lds
    v_mfma_f32_16x16x32_bf16 v[196:199], a[132:135], v[80:83], v[196:199]
    ds_read_b128 v[112:115], v159 offset:25600
    v_mfma_f32_16x16x32_bf16 v[204:207], a[132:135], v[88:91], v[204:207]
    ds_read_b128 v[116:119], v159 offset:31744
    buffer_load_dwordx4 v149, s[48:51], s14 offen offset:1024 lds
    v_mfma_f32_16x16x32_bf16 v[204:207], a[140:143], v[92:95], v[204:207]
    ds_read_b128 v[120:123], v159 offset:25856
    v_mfma_f32_16x16x32_bf16 v[200:203], a[136:139], v[92:95], v[200:203]
    ds_read_b128 v[124:127], v159 offset:32000
    v_mfma_f32_16x16x32_bf16 v[200:203], a[128:131], v[88:91], v[200:203]
    ds_read_b64_tr_b16 a[184:185], v154 offset:8192
    buffer_load_dwordx4 v150, s[48:51], s14 offen offset:2048 lds
    v_mfma_f32_16x16x32_bf16 v[208:211], a[128:131], v[96:99], v[208:211]
    ds_read_b64_tr_b16 a[186:187], v154 offset:9216
    v_mfma_f32_16x16x32_bf16 v[208:211], a[136:139], v[100:103], v[208:211]
    ds_read_b64_tr_b16 a[188:189], v155 offset:8192
    buffer_load_dwordx4 v151, s[48:51], s14 offen offset:3072 lds
    v_mfma_f32_16x16x32_bf16 v[212:215], a[140:143], v[100:103], v[212:215]
    ds_read_b64_tr_b16 a[190:191], v155 offset:9216
    v_mfma_f32_16x16x32_bf16 v[212:215], a[132:135], v[96:99], v[212:215]
    s_waitcnt lgkmcnt(4)
    v_mfma_f32_16x16x32_bf16 v[220:223], a[132:135], v[104:107], v[220:223]
    s_waitcnt vmcnt(14)
    s_barrier
    v_mfma_f32_16x16x32_bf16 v[220:223], a[140:143], v[108:111], v[220:223]
    ds_read_b128 v[80:83], v250 offset:0
    s_add_u32 m0, s74, 24576
    v_mfma_f32_16x16x32_bf16 v[216:219], a[136:139], v[108:111], v[216:219]
    ds_read_b128 v[84:87], v250 offset:6144
    v_mfma_f32_16x16x32_bf16 v[216:219], a[128:131], v[104:107], v[216:219]
    ds_read_b128 v[88:91], v250 offset:256
    buffer_load_dwordx4 v156, s[44:47], s80 offen offset:0 sc1 lds
    v_mfma_f32_16x16x32_bf16 v[224:227], a[128:131], v[112:115], v[224:227]
    ds_read_b128 v[92:95], v250 offset:6400
    v_mfma_f32_16x16x32_bf16 v[224:227], a[136:139], v[116:119], v[224:227]
    ds_read_b128 v[96:99], v250 offset:512
    v_mfma_f32_16x16x32_bf16 v[228:231], a[140:143], v[116:119], v[228:231]
    ds_read_b128 v[100:103], v250 offset:6656
    buffer_load_dwordx4 v157, s[44:47], s80 offen offset:1024 sc1 lds
    v_mfma_f32_16x16x32_bf16 v[228:231], a[132:135], v[112:115], v[228:231]
    ds_read_b64_tr_b16 a[192:193], v152 offset:0
    v_mfma_f32_16x16x32_bf16 v[236:239], a[132:135], v[120:123], v[236:239]
    ds_read_b64_tr_b16 a[194:195], v152 offset:1024
    v_mfma_f32_16x16x32_bf16 v[236:239], a[140:143], v[124:127], v[236:239]
    ds_read_b64_tr_b16 a[196:197], v153 offset:0
    buffer_load_dwordx4 v158, s[44:47], s80 offen offset:2048 sc1 lds
    v_mfma_f32_16x16x32_bf16 v[232:235], a[136:139], v[124:127], v[232:235]
    ds_read_b64_tr_b16 a[198:199], v153 offset:1024
    v_mfma_f32_16x16x32_bf16 v[232:235], a[128:131], v[120:123], v[232:235]
    s_waitcnt lgkmcnt(4)
    v_mfma_f32_16x16x32_bf16 v[192:195], a[144:147], v[80:83], v[192:195]
    s_add_u32 m0, s73, 49152
    s_lshl_b32 s14, s81, 3
    v_mfma_f32_16x16x32_bf16 v[192:195], a[152:155], v[84:87], v[192:195]
    ds_read_b128 v[104:107], v250 offset:768
    v_mfma_f32_16x16x32_bf16 v[196:199], a[156:159], v[84:87], v[196:199]
    ds_read_b128 v[108:111], v250 offset:6912
    buffer_load_dwordx4 v148, s[48:51], s14 offen offset:0 lds
    v_mfma_f32_16x16x32_bf16 v[196:199], a[148:151], v[80:83], v[196:199]
    ds_read_b128 v[112:115], v250 offset:1024
    v_mfma_f32_16x16x32_bf16 v[204:207], a[148:151], v[88:91], v[204:207]
    ds_read_b128 v[116:119], v250 offset:7168
    buffer_load_dwordx4 v149, s[48:51], s14 offen offset:1024 lds
    v_mfma_f32_16x16x32_bf16 v[204:207], a[156:159], v[92:95], v[204:207]
    ds_read_b128 v[120:123], v250 offset:1280
    v_mfma_f32_16x16x32_bf16 v[200:203], a[152:155], v[92:95], v[200:203]
    ds_read_b128 v[124:127], v250 offset:7424
    v_mfma_f32_16x16x32_bf16 v[200:203], a[144:147], v[88:91], v[200:203]
    ds_read_b64_tr_b16 a[200:201], v152 offset:8192
    buffer_load_dwordx4 v150, s[48:51], s14 offen offset:2048 lds
    v_mfma_f32_16x16x32_bf16 v[208:211], a[144:147], v[96:99], v[208:211]
    ds_read_b64_tr_b16 a[202:203], v152 offset:9216
    v_mfma_f32_16x16x32_bf16 v[208:211], a[152:155], v[100:103], v[208:211]
    ds_read_b64_tr_b16 a[204:205], v153 offset:8192
    buffer_load_dwordx4 v151, s[48:51], s14 offen offset:3072 lds
    v_mfma_f32_16x16x32_bf16 v[212:215], a[156:159], v[100:103], v[212:215]
    ds_read_b64_tr_b16 a[206:207], v153 offset:9216
    v_mfma_f32_16x16x32_bf16 v[212:215], a[148:151], v[96:99], v[212:215]
    s_waitcnt lgkmcnt(4)
    v_mfma_f32_16x16x32_bf16 v[220:223], a[148:151], v[104:107], v[220:223]
    s_waitcnt vmcnt(14)
    s_barrier
    v_mfma_f32_16x16x32_bf16 v[220:223], a[156:159], v[108:111], v[220:223]
    ds_read_b128 v[80:83], v250 offset:12288
    s_add_u32 m0, s74, 36864
    v_mfma_f32_16x16x32_bf16 v[216:219], a[152:155], v[108:111], v[216:219]
    ds_read_b128 v[84:87], v250 offset:18432
    v_mfma_f32_16x16x32_bf16 v[216:219], a[144:147], v[104:107], v[216:219]
    ds_read_b128 v[88:91], v250 offset:12544
    buffer_load_dwordx4 v156, s[44:47], s81 offen offset:0 sc1 lds
    v_mfma_f32_16x16x32_bf16 v[224:227], a[144:147], v[112:115], v[224:227]
    ds_read_b128 v[92:95], v250 offset:18688
    v_mfma_f32_16x16x32_bf16 v[224:227], a[152:155], v[116:119], v[224:227]
    ds_read_b128 v[96:99], v250 offset:12800
    v_mfma_f32_16x16x32_bf16 v[228:231], a[156:159], v[116:119], v[228:231]
    ds_read_b128 v[100:103], v250 offset:18944
    buffer_load_dwordx4 v157, s[44:47], s81 offen offset:1024 sc1 lds
    v_mfma_f32_16x16x32_bf16 v[228:231], a[148:151], v[112:115], v[228:231]
    ds_read_b64_tr_b16 a[208:209], v152 offset:16384
    v_mfma_f32_16x16x32_bf16 v[236:239], a[148:151], v[120:123], v[236:239]
    ds_read_b64_tr_b16 a[210:211], v152 offset:17408
    v_mfma_f32_16x16x32_bf16 v[236:239], a[156:159], v[124:127], v[236:239]
    ds_read_b64_tr_b16 a[212:213], v153 offset:16384
    buffer_load_dwordx4 v158, s[44:47], s81 offen offset:2048 sc1 lds
    v_mfma_f32_16x16x32_bf16 v[232:235], a[152:155], v[124:127], v[232:235]
    ds_read_b64_tr_b16 a[214:215], v153 offset:17408
    v_mfma_f32_16x16x32_bf16 v[232:235], a[144:147], v[120:123], v[232:235]
    s_waitcnt lgkmcnt(4)
    v_mfma_f32_16x16x32_bf16 v[192:195], a[160:163], v[80:83], v[192:195]
    s_add_u32 m0, s73, 65536
    s_lshl_b32 s14, s84, 17
    v_mfma_f32_16x16x32_bf16 v[192:195], a[168:171], v[84:87], v[192:195]
    ds_read_b128 v[104:107], v250 offset:13056
    v_mfma_f32_16x16x32_bf16 v[196:199], a[172:175], v[84:87], v[196:199]
    ds_read_b128 v[108:111], v250 offset:19200
    buffer_load_dwordx4 v4, s[52:55], s14 offen offset:0 lds
    v_mfma_f32_16x16x32_bf16 v[196:199], a[164:167], v[80:83], v[196:199]
    ds_read_b128 v[112:115], v250 offset:13312
    v_mfma_f32_16x16x32_bf16 v[204:207], a[164:167], v[88:91], v[204:207]
    ds_read_b128 v[116:119], v250 offset:19456
    buffer_load_dwordx4 v5, s[52:55], s14 offen offset:1024 lds
    v_mfma_f32_16x16x32_bf16 v[204:207], a[172:175], v[92:95], v[204:207]
    ds_read_b128 v[120:123], v250 offset:13568
    v_mfma_f32_16x16x32_bf16 v[200:203], a[168:171], v[92:95], v[200:203]
    ds_read_b128 v[124:127], v250 offset:19712
    v_mfma_f32_16x16x32_bf16 v[200:203], a[160:163], v[88:91], v[200:203]
    ds_read_b64_tr_b16 a[216:217], v152 offset:24576
    buffer_load_dwordx4 v6, s[52:55], s14 offen offset:2048 lds
    v_mfma_f32_16x16x32_bf16 v[208:211], a[160:163], v[96:99], v[208:211]
    ds_read_b64_tr_b16 a[218:219], v152 offset:25600
    v_mfma_f32_16x16x32_bf16 v[208:211], a[168:171], v[100:103], v[208:211]
    ds_read_b64_tr_b16 a[220:221], v153 offset:24576
    buffer_load_dwordx4 v7, s[52:55], s14 offen offset:3072 lds
    v_mfma_f32_16x16x32_bf16 v[212:215], a[172:175], v[100:103], v[212:215]
    ds_read_b64_tr_b16 a[222:223], v153 offset:25600
    v_mfma_f32_16x16x32_bf16 v[212:215], a[164:167], v[96:99], v[212:215]
    s_waitcnt lgkmcnt(4)
    v_mfma_f32_16x16x32_bf16 v[220:223], a[164:167], v[104:107], v[220:223]
    s_waitcnt vmcnt(14)
    s_barrier
    v_mfma_f32_16x16x32_bf16 v[220:223], a[172:175], v[108:111], v[220:223]
    ds_read_b128 v[80:83], v250 offset:24576
    v_mfma_f32_16x16x32_bf16 v[216:219], a[168:171], v[108:111], v[216:219]
    ds_read_b128 v[84:87], v250 offset:30720
    v_mfma_f32_16x16x32_bf16 v[216:219], a[160:163], v[104:107], v[216:219]
    ds_read_b128 v[88:91], v250 offset:24832
    v_mfma_f32_16x16x32_bf16 v[224:227], a[160:163], v[112:115], v[224:227]
    ds_read_b128 v[92:95], v250 offset:30976
    v_mfma_f32_16x16x32_bf16 v[224:227], a[168:171], v[116:119], v[224:227]
    ds_read_b128 v[96:99], v250 offset:25088
    v_mfma_f32_16x16x32_bf16 v[228:231], a[172:175], v[116:119], v[228:231]
    ds_read_b128 v[100:103], v250 offset:31232
    v_mfma_f32_16x16x32_bf16 v[228:231], a[164:167], v[112:115], v[228:231]
    ds_read_b64_tr_b16 a[224:225], v152 offset:32768
    v_mfma_f32_16x16x32_bf16 v[236:239], a[164:167], v[120:123], v[236:239]
    ds_read_b64_tr_b16 a[226:227], v152 offset:33792
    v_mfma_f32_16x16x32_bf16 v[236:239], a[172:175], v[124:127], v[236:239]
    ds_read_b64_tr_b16 a[228:229], v153 offset:32768
    v_mfma_f32_16x16x32_bf16 v[232:235], a[168:171], v[124:127], v[232:235]
    ds_read_b64_tr_b16 a[230:231], v153 offset:33792
    v_mfma_f32_16x16x32_bf16 v[232:235], a[160:163], v[120:123], v[232:235]
    s_waitcnt lgkmcnt(4)
    v_mfma_f32_16x16x32_bf16 v[192:195], a[176:179], v[80:83], v[192:195]
    v_mfma_f32_16x16x32_bf16 v[192:195], a[184:187], v[84:87], v[192:195]
    ds_read_b128 v[104:107], v250 offset:25344
    v_mfma_f32_16x16x32_bf16 v[196:199], a[188:191], v[84:87], v[196:199]
    ds_read_b128 v[108:111], v250 offset:31488
    v_mfma_f32_16x16x32_bf16 v[196:199], a[180:183], v[80:83], v[196:199]
    ds_read_b128 v[112:115], v250 offset:25600
    v_mfma_f32_16x16x32_bf16 v[204:207], a[180:183], v[88:91], v[204:207]
    ds_read_b128 v[116:119], v250 offset:31744
    v_mfma_f32_16x16x32_bf16 v[204:207], a[188:191], v[92:95], v[204:207]
    ds_read_b128 v[120:123], v250 offset:25856
    v_mfma_f32_16x16x32_bf16 v[200:203], a[184:187], v[92:95], v[200:203]
    ds_read_b128 v[124:127], v250 offset:32000
    v_mfma_f32_16x16x32_bf16 v[200:203], a[176:179], v[88:91], v[200:203]
    ds_read_b64_tr_b16 a[232:233], v152 offset:40960
    v_mfma_f32_16x16x32_bf16 v[208:211], a[176:179], v[96:99], v[208:211]
    ds_read_b64_tr_b16 a[234:235], v152 offset:41984
    v_mfma_f32_16x16x32_bf16 v[208:211], a[184:187], v[100:103], v[208:211]
    ds_read_b64_tr_b16 a[236:237], v153 offset:40960
    v_mfma_f32_16x16x32_bf16 v[212:215], a[188:191], v[100:103], v[212:215]
    ds_read_b64_tr_b16 a[238:239], v153 offset:41984
    v_mfma_f32_16x16x32_bf16 v[212:215], a[180:183], v[96:99], v[212:215]
    s_waitcnt lgkmcnt(4)
    v_mfma_f32_16x16x32_bf16 v[220:223], a[180:183], v[104:107], v[220:223]
    s_waitcnt vmcnt(7)
    s_barrier
    v_mfma_f32_16x16x32_bf16 v[220:223], a[188:191], v[108:111], v[220:223]
    ds_read_b128 v[80:83], v159 offset:0
    v_mfma_f32_16x16x32_bf16 v[216:219], a[184:187], v[108:111], v[216:219]
    ds_read_b128 v[84:87], v159 offset:6144
    v_mfma_f32_16x16x32_bf16 v[216:219], a[176:179], v[104:107], v[216:219]
    ds_read_b128 v[88:91], v159 offset:256
    v_mfma_f32_16x16x32_bf16 v[224:227], a[176:179], v[112:115], v[224:227]
    ds_read_b128 v[92:95], v159 offset:6400
    v_mfma_f32_16x16x32_bf16 v[224:227], a[184:187], v[116:119], v[224:227]
    ds_read_b128 v[96:99], v159 offset:512
    v_mfma_f32_16x16x32_bf16 v[228:231], a[188:191], v[116:119], v[228:231]
    ds_read_b128 v[100:103], v159 offset:6656
    v_mfma_f32_16x16x32_bf16 v[228:231], a[180:183], v[112:115], v[228:231]
    ds_read_b64_tr_b16 a[240:241], v152 offset:49152
    v_mfma_f32_16x16x32_bf16 v[236:239], a[180:183], v[120:123], v[236:239]
    ds_read_b64_tr_b16 a[242:243], v152 offset:50176
    v_mfma_f32_16x16x32_bf16 v[236:239], a[188:191], v[124:127], v[236:239]
    ds_read_b64_tr_b16 a[244:245], v153 offset:49152
    v_mfma_f32_16x16x32_bf16 v[232:235], a[184:187], v[124:127], v[232:235]
    ds_read_b64_tr_b16 a[246:247], v153 offset:50176
    v_mfma_f32_16x16x32_bf16 v[232:235], a[176:179], v[120:123], v[232:235]
    s_waitcnt lgkmcnt(4)
    v_mfma_f32_16x16x32_bf16 v[192:195], a[192:195], v[80:83], v[192:195]
    v_mfma_f32_16x16x32_bf16 v[192:195], a[200:203], v[84:87], v[192:195]
    ds_read_b128 v[104:107], v159 offset:768
    v_mfma_f32_16x16x32_bf16 v[196:199], a[204:207], v[84:87], v[196:199]
    ds_read_b128 v[108:111], v159 offset:6912
    v_mfma_f32_16x16x32_bf16 v[196:199], a[196:199], v[80:83], v[196:199]
    ds_read_b128 v[112:115], v159 offset:1024
    v_mfma_f32_16x16x32_bf16 v[204:207], a[196:199], v[88:91], v[204:207]
    ds_read_b128 v[116:119], v159 offset:7168
    v_mfma_f32_16x16x32_bf16 v[204:207], a[204:207], v[92:95], v[204:207]
    ds_read_b128 v[120:123], v159 offset:1280
    v_mfma_f32_16x16x32_bf16 v[200:203], a[200:203], v[92:95], v[200:203]
    ds_read_b128 v[124:127], v159 offset:7424
    v_mfma_f32_16x16x32_bf16 v[200:203], a[192:195], v[88:91], v[200:203]
    ds_read_b64_tr_b16 a[248:249], v152 offset:57344
    v_mfma_f32_16x16x32_bf16 v[208:211], a[192:195], v[96:99], v[208:211]
    ds_read_b64_tr_b16 a[250:251], v152 offset:58368
    v_mfma_f32_16x16x32_bf16 v[208:211], a[200:203], v[100:103], v[208:211]
    ds_read_b64_tr_b16 a[252:253], v153 offset:57344
    v_mfma_f32_16x16x32_bf16 v[212:215], a[204:207], v[100:103], v[212:215]
    ds_read_b64_tr_b16 a[254:255], v153 offset:58368
    v_mfma_f32_16x16x32_bf16 v[212:215], a[196:199], v[96:99], v[212:215]
    s_waitcnt lgkmcnt(4)
    v_mfma_f32_16x16x32_bf16 v[220:223], a[196:199], v[104:107], v[220:223]
    s_barrier
    v_mfma_f32_16x16x32_bf16 v[220:223], a[204:207], v[108:111], v[220:223]
    ds_read_b128 v[80:83], v159 offset:12288
    s_and_b32 s13, s70, 1
    s_mul_i32 s13, s13, 3072
    v_mfma_f32_16x16x32_bf16 v[216:219], a[200:203], v[108:111], v[216:219]
    ds_read_b128 v[84:87], v159 offset:18432
    s_sub_u32 s13, s13, 1536
    v_mfma_f32_16x16x32_bf16 v[216:219], a[192:195], v[104:107], v[216:219]
    ds_read_b128 v[88:91], v159 offset:12544
    v_add_u32 v156, s13, v156
    v_mfma_f32_16x16x32_bf16 v[224:227], a[192:195], v[112:115], v[224:227]
    ds_read_b128 v[92:95], v159 offset:18688
    v_add_u32 v157, s13, v157
    v_mfma_f32_16x16x32_bf16 v[224:227], a[200:203], v[116:119], v[224:227]
    ds_read_b128 v[96:99], v159 offset:12800
    v_add_u32 v158, s13, v158
    v_mfma_f32_16x16x32_bf16 v[228:231], a[204:207], v[116:119], v[228:231]
    ds_read_b128 v[100:103], v159 offset:18944
    v_mfma_f32_16x16x32_bf16 v[228:231], a[196:199], v[112:115], v[228:231]
    s_add_u32 m0, s74, 49152
    v_mfma_f32_16x16x32_bf16 v[236:239], a[196:199], v[120:123], v[236:239]
    buffer_load_dwordx4 v156, s[44:47], s18 offen offset:0 sc1 lds
    v_mfma_f32_16x16x32_bf16 v[236:239], a[204:207], v[124:127], v[236:239]
    buffer_load_dwordx4 v157, s[44:47], s18 offen offset:1024 sc1 lds
    v_mfma_f32_16x16x32_bf16 v[232:235], a[200:203], v[124:127], v[232:235]
    buffer_load_dwordx4 v158, s[44:47], s18 offen offset:2048 sc1 lds
    v_mfma_f32_16x16x32_bf16 v[232:235], a[192:195], v[120:123], v[232:235]
    s_waitcnt lgkmcnt(0)
    v_mfma_f32_16x16x32_bf16 v[192:195], a[208:211], v[80:83], v[192:195]
    s_add_u32 m0, s74, 61440
    v_mfma_f32_16x16x32_bf16 v[192:195], a[216:219], v[84:87], v[192:195]
    ds_read_b128 v[104:107], v159 offset:13056
    v_mfma_f32_16x16x32_bf16 v[196:199], a[220:223], v[84:87], v[196:199]
    ds_read_b128 v[108:111], v159 offset:19200
    v_mfma_f32_16x16x32_bf16 v[196:199], a[212:215], v[80:83], v[196:199]
    ds_read_b128 v[112:115], v159 offset:13312
    buffer_load_dwordx4 v156, s[44:47], s19 offen offset:0 sc1 lds
    v_mfma_f32_16x16x32_bf16 v[204:207], a[212:215], v[88:91], v[204:207]
    ds_read_b128 v[116:119], v159 offset:19456
    v_mfma_f32_16x16x32_bf16 v[204:207], a[220:223], v[92:95], v[204:207]
    ds_read_b128 v[120:123], v159 offset:13568
    v_mfma_f32_16x16x32_bf16 v[200:203], a[216:219], v[92:95], v[200:203]
    ds_read_b128 v[124:127], v159 offset:19712
    buffer_load_dwordx4 v157, s[44:47], s19 offen offset:1024 sc1 lds
    v_mfma_f32_16x16x32_bf16 v[200:203], a[208:211], v[88:91], v[200:203]
    v_mfma_f32_16x16x32_bf16 v[208:211], a[208:211], v[96:99], v[208:211]
    v_mfma_f32_16x16x32_bf16 v[208:211], a[216:219], v[100:103], v[208:211]
    buffer_load_dwordx4 v158, s[44:47], s19 offen offset:2048 sc1 lds
    v_mfma_f32_16x16x32_bf16 v[212:215], a[220:223], v[100:103], v[212:215]
    v_mfma_f32_16x16x32_bf16 v[212:215], a[212:215], v[96:99], v[212:215]
    s_waitcnt lgkmcnt(0)
    v_mfma_f32_16x16x32_bf16 v[220:223], a[212:215], v[104:107], v[220:223]
    s_barrier
    v_mfma_f32_16x16x32_bf16 v[220:223], a[220:223], v[108:111], v[220:223]
    ds_read_b128 v[80:83], v159 offset:24576
    s_add_u32 m0, s74, 0
    v_mfma_f32_16x16x32_bf16 v[216:219], a[216:219], v[108:111], v[216:219]
    ds_read_b128 v[84:87], v159 offset:30720
    v_mfma_f32_16x16x32_bf16 v[216:219], a[208:211], v[104:107], v[216:219]
    ds_read_b128 v[88:91], v159 offset:24832
    buffer_load_dwordx4 v156, s[44:47], s20 offen offset:0 sc1 lds
    v_mfma_f32_16x16x32_bf16 v[224:227], a[208:211], v[112:115], v[224:227]
    ds_read_b128 v[92:95], v159 offset:30976
    v_mfma_f32_16x16x32_bf16 v[224:227], a[216:219], v[116:119], v[224:227]
    ds_read_b128 v[96:99], v159 offset:25088
    v_mfma_f32_16x16x32_bf16 v[228:231], a[220:223], v[116:119], v[228:231]
    ds_read_b128 v[100:103], v159 offset:31232
    buffer_load_dwordx4 v157, s[44:47], s20 offen offset:1024 sc1 lds
    v_mfma_f32_16x16x32_bf16 v[228:231], a[212:215], v[112:115], v[228:231]
    v_mfma_f32_16x16x32_bf16 v[236:239], a[212:215], v[120:123], v[236:239]
    v_mfma_f32_16x16x32_bf16 v[236:239], a[220:223], v[124:127], v[236:239]
    buffer_load_dwordx4 v158, s[44:47], s20 offen offset:2048 sc1 lds
    v_mfma_f32_16x16x32_bf16 v[232:235], a[216:219], v[124:127], v[232:235]
    v_mfma_f32_16x16x32_bf16 v[232:235], a[208:211], v[120:123], v[232:235]
    s_waitcnt lgkmcnt(0)
    v_mfma_f32_16x16x32_bf16 v[192:195], a[224:227], v[80:83], v[192:195]
    s_add_u32 m0, s74, 12288
    v_mfma_f32_16x16x32_bf16 v[192:195], a[232:235], v[84:87], v[192:195]
    ds_read_b128 v[104:107], v159 offset:25344
    v_mfma_f32_16x16x32_bf16 v[196:199], a[236:239], v[84:87], v[196:199]
    ds_read_b128 v[108:111], v159 offset:31488
    v_mfma_f32_16x16x32_bf16 v[196:199], a[228:231], v[80:83], v[196:199]
    ds_read_b128 v[112:115], v159 offset:25600
    buffer_load_dwordx4 v156, s[44:47], s21 offen offset:0 sc1 lds
    v_mfma_f32_16x16x32_bf16 v[204:207], a[228:231], v[88:91], v[204:207]
    ds_read_b128 v[116:119], v159 offset:31744
    v_mfma_f32_16x16x32_bf16 v[204:207], a[236:239], v[92:95], v[204:207]
    ds_read_b128 v[120:123], v159 offset:25856
    v_mfma_f32_16x16x32_bf16 v[200:203], a[232:235], v[92:95], v[200:203]
    ds_read_b128 v[124:127], v159 offset:32000
    buffer_load_dwordx4 v157, s[44:47], s21 offen offset:1024 sc1 lds
    v_mfma_f32_16x16x32_bf16 v[200:203], a[224:227], v[88:91], v[200:203]
    v_mfma_f32_16x16x32_bf16 v[208:211], a[224:227], v[96:99], v[208:211]
    v_mfma_f32_16x16x32_bf16 v[208:211], a[232:235], v[100:103], v[208:211]
    buffer_load_dwordx4 v158, s[44:47], s21 offen offset:2048 sc1 lds
    v_mfma_f32_16x16x32_bf16 v[212:215], a[236:239], v[100:103], v[212:215]
    v_mfma_f32_16x16x32_bf16 v[212:215], a[228:231], v[96:99], v[212:215]
    s_waitcnt lgkmcnt(0)
    v_mfma_f32_16x16x32_bf16 v[220:223], a[228:231], v[104:107], v[220:223]
    s_waitcnt vmcnt(16)
    s_barrier
    v_mfma_f32_16x16x32_bf16 v[220:223], a[236:239], v[108:111], v[220:223]
    ds_read_b128 v[80:83], v250 offset:0
    s_add_u32 m0, s74, 24576
    v_mfma_f32_16x16x32_bf16 v[216:219], a[232:235], v[108:111], v[216:219]
    ds_read_b128 v[84:87], v250 offset:6144
    v_mfma_f32_16x16x32_bf16 v[216:219], a[224:227], v[104:107], v[216:219]
    ds_read_b128 v[88:91], v250 offset:256
    buffer_load_dwordx4 v156, s[44:47], s22 offen offset:0 sc1 lds
    v_mfma_f32_16x16x32_bf16 v[224:227], a[224:227], v[112:115], v[224:227]
    ds_read_b128 v[92:95], v250 offset:6400
    v_mfma_f32_16x16x32_bf16 v[224:227], a[232:235], v[116:119], v[224:227]
    ds_read_b128 v[96:99], v250 offset:512
    v_mfma_f32_16x16x32_bf16 v[228:231], a[236:239], v[116:119], v[228:231]
    ds_read_b128 v[100:103], v250 offset:6656
    buffer_load_dwordx4 v157, s[44:47], s22 offen offset:1024 sc1 lds
    v_mfma_f32_16x16x32_bf16 v[228:231], a[228:231], v[112:115], v[228:231]
    v_mfma_f32_16x16x32_bf16 v[236:239], a[228:231], v[120:123], v[236:239]
    v_mfma_f32_16x16x32_bf16 v[236:239], a[236:239], v[124:127], v[236:239]
    buffer_load_dwordx4 v158, s[44:47], s22 offen offset:2048 sc1 lds
    v_mfma_f32_16x16x32_bf16 v[232:235], a[232:235], v[124:127], v[232:235]
    v_mfma_f32_16x16x32_bf16 v[232:235], a[224:227], v[120:123], v[232:235]
    s_waitcnt lgkmcnt(0)
    v_mfma_f32_16x16x32_bf16 v[192:195], a[240:243], v[80:83], v[192:195]
    s_add_u32 m0, s73, 0
    s_lshl_b32 s14, s85, 17
    v_mfma_f32_16x16x32_bf16 v[192:195], a[248:251], v[84:87], v[192:195]
    ds_read_b128 v[104:107], v250 offset:768
    v_mfma_f32_16x16x32_bf16 v[196:199], a[252:255], v[84:87], v[196:199]
    ds_read_b128 v[108:111], v250 offset:6912
    buffer_load_dwordx4 v4, s[52:55], s14 offen offset:0 lds
    v_mfma_f32_16x16x32_bf16 v[196:199], a[244:247], v[80:83], v[196:199]
    ds_read_b128 v[112:115], v250 offset:1024
    v_mfma_f32_16x16x32_bf16 v[204:207], a[244:247], v[88:91], v[204:207]
    ds_read_b128 v[116:119], v250 offset:7168
    buffer_load_dwordx4 v5, s[52:55], s14 offen offset:1024 lds
    v_mfma_f32_16x16x32_bf16 v[204:207], a[252:255], v[92:95], v[204:207]
    ds_read_b128 v[120:123], v250 offset:1280
    v_mfma_f32_16x16x32_bf16 v[200:203], a[248:251], v[92:95], v[200:203]
    ds_read_b128 v[124:127], v250 offset:7424
    v_mfma_f32_16x16x32_bf16 v[200:203], a[240:243], v[88:91], v[200:203]
    buffer_load_dwordx4 v6, s[52:55], s14 offen offset:2048 lds
    v_mfma_f32_16x16x32_bf16 v[208:211], a[240:243], v[96:99], v[208:211]
    v_mfma_f32_16x16x32_bf16 v[208:211], a[248:251], v[100:103], v[208:211]
    buffer_load_dwordx4 v7, s[52:55], s14 offen offset:3072 lds
    v_mfma_f32_16x16x32_bf16 v[212:215], a[252:255], v[100:103], v[212:215]
    v_mfma_f32_16x16x32_bf16 v[212:215], a[244:247], v[96:99], v[212:215]
    s_waitcnt lgkmcnt(0)
    v_mfma_f32_16x16x32_bf16 v[220:223], a[244:247], v[104:107], v[220:223]
    s_waitcnt vmcnt(16)
    s_barrier
    v_mfma_f32_16x16x32_bf16 v[220:223], a[252:255], v[108:111], v[220:223]
    ds_read_b128 v[80:83], v250 offset:12288
    v_mfma_f32_16x16x32_bf16 v[216:219], a[248:251], v[108:111], v[216:219]
    ds_read_b128 v[84:87], v250 offset:18432
    v_mfma_f32_16x16x32_bf16 v[216:219], a[240:243], v[104:107], v[216:219]
    ds_read_b128 v[88:91], v250 offset:12544
    v_mfma_f32_16x16x32_bf16 v[224:227], a[240:243], v[112:115], v[224:227]
    ds_read_b128 v[92:95], v250 offset:18688
    v_mfma_f32_16x16x32_bf16 v[224:227], a[248:251], v[116:119], v[224:227]
    ds_read_b128 v[96:99], v250 offset:12800
    v_mfma_f32_16x16x32_bf16 v[228:231], a[252:255], v[116:119], v[228:231]
    ds_read_b128 v[100:103], v250 offset:18944
    v_mfma_f32_16x16x32_bf16 v[228:231], a[244:247], v[112:115], v[228:231]
    v_mfma_f32_16x16x32_bf16 v[236:239], a[244:247], v[120:123], v[236:239]
    v_mfma_f32_16x16x32_bf16 v[236:239], a[252:255], v[124:127], v[236:239]
    v_mfma_f32_16x16x32_bf16 v[232:235], a[248:251], v[124:127], v[232:235]
    v_mfma_f32_16x16x32_bf16 v[232:235], a[240:243], v[120:123], v[232:235]
    s_waitcnt lgkmcnt(0)
    v_mfma_f32_16x16x32_bf16 v[32:35], a[0:3], v[80:83], v[128:131]
    v_mfma_f32_16x16x32_bf16 v[32:35], a[8:11], v[84:87], v[32:35]
    ds_read_b128 v[104:107], v250 offset:13056
L_pl_G_3:
    s_cbranch_execz L_wret
    v_mfma_f32_16x16x32_bf16 v[36:39], a[12:15], v[84:87], v[132:135]
    ds_read_b128 v[108:111], v250 offset:19200
    v_mfma_f32_16x16x32_bf16 v[36:39], a[4:7], v[80:83], v[36:39]
    ds_read_b128 v[112:115], v250 offset:13312
    v_mfma_f32_16x16x32_bf16 v[44:47], a[4:7], v[88:91], v[132:135]
    ds_read_b128 v[116:119], v250 offset:19456
    v_mfma_f32_16x16x32_bf16 v[44:47], a[12:15], v[92:95], v[44:47]
    ds_read_b128 v[120:123], v250 offset:13568
    v_mfma_f32_16x16x32_bf16 v[40:43], a[8:11], v[92:95], v[128:131]
    ds_read_b128 v[124:127], v250 offset:19712
    v_mfma_f32_16x16x32_bf16 v[40:43], a[0:3], v[88:91], v[40:43]
    v_mfma_f32_16x16x32_bf16 v[48:51], a[0:3], v[96:99], v[128:131]
    v_mfma_f32_16x16x32_bf16 v[48:51], a[8:11], v[100:103], v[48:51]
    v_mfma_f32_16x16x32_bf16 v[52:55], a[12:15], v[100:103], v[132:135]
    v_mfma_f32_16x16x32_bf16 v[52:55], a[4:7], v[96:99], v[52:55]
    s_waitcnt lgkmcnt(0)
    v_mfma_f32_16x16x32_bf16 v[60:63], a[4:7], v[104:107], v[132:135]
    s_waitcnt vmcnt(13)
    s_barrier
    v_mfma_f32_16x16x32_bf16 v[60:63], a[12:15], v[108:111], v[60:63]
    ds_read_b128 v[80:83], v250 offset:24576
    v_mfma_f32_16x16x32_bf16 v[56:59], a[8:11], v[108:111], v[128:131]
    ds_read_b128 v[84:87], v250 offset:30720
    v_mfma_f32_16x16x32_bf16 v[56:59], a[0:3], v[104:107], v[56:59]
    ds_read_b128 v[88:91], v250 offset:24832
    v_mfma_f32_16x16x32_bf16 v[64:67], a[0:3], v[112:115], v[128:131]
    ds_read_b128 v[92:95], v250 offset:30976
    v_mfma_f32_16x16x32_bf16 v[64:67], a[8:11], v[116:119], v[64:67]
    ds_read_b128 v[96:99], v250 offset:25088
    v_mfma_f32_16x16x32_bf16 v[68:71], a[12:15], v[116:119], v[132:135]
    ds_read_b128 v[100:103], v250 offset:31232
    v_mfma_f32_16x16x32_bf16 v[68:71], a[4:7], v[112:115], v[68:71]
    v_cvt_pk_bf16_f32 v192, v192, v193
    v_cvt_pk_bf16_f32 v193, v194, v195
    v_mfma_f32_16x16x32_bf16 v[76:79], a[4:7], v[120:123], v[132:135]
    v_cvt_pk_bf16_f32 v194, v196, v197
    v_mfma_f32_16x16x32_bf16 v[76:79], a[12:15], v[124:127], v[76:79]
    v_cvt_pk_bf16_f32 v195, v198, v199
    v_mfma_f32_16x16x32_bf16 v[72:75], a[8:11], v[124:127], v[128:131]
    buffer_store_dwordx4 v[192:195], v246, s[44:47], s9 offen offset:0 sc1
    v_mfma_f32_16x16x32_bf16 v[72:75], a[0:3], v[120:123], v[72:75]
    s_waitcnt lgkmcnt(0)
    v_mfma_f32_16x16x32_bf16 v[32:35], a[16:19], v[80:83], v[32:35]
    v_cvt_pk_bf16_f32 v200, v200, v201
    v_mfma_f32_16x16x32_bf16 v[32:35], a[24:27], v[84:87], v[32:35]
    ds_read_b128 v[104:107], v250 offset:25344
    v_mfma_f32_16x16x32_bf16 v[36:39], a[28:31], v[84:87], v[36:39]
    ds_read_b128 v[108:111], v250 offset:31488
    v_mfma_f32_16x16x32_bf16 v[36:39], a[20:23], v[80:83], v[36:39]
    ds_read_b128 v[112:115], v250 offset:25600
    v_mfma_f32_16x16x32_bf16 v[44:47], a[20:23], v[88:91], v[44:47]
    ds_read_b128 v[116:119], v250 offset:31744
    v_mfma_f32_16x16x32_bf16 v[44:47], a[28:31], v[92:95], v[44:47]
    ds_read_b128 v[120:123], v250 offset:25856
    v_mfma_f32_16x16x32_bf16 v[40:43], a[24:27], v[92:95], v[40:43]
    ds_read_b128 v[124:127], v250 offset:32000
    v_mfma_f32_16x16x32_bf16 v[40:43], a[16:19], v[88:91], v[40:43]
    v_cvt_pk_bf16_f32 v201, v202, v203
    v_mfma_f32_16x16x32_bf16 v[48:51], a[16:19], v[96:99], v[48:51]
    v_cvt_pk_bf16_f32 v202, v204, v205
    v_mfma_f32_16x16x32_bf16 v[48:51], a[24:27], v[100:103], v[48:51]
    v_cvt_pk_bf16_f32 v203, v206, v207
    v_mfma_f32_16x16x32_bf16 v[52:55], a[28:31], v[100:103], v[52:55]
    buffer_store_dwordx4 v[200:203], v246, s[44:47], s9 offen offset:1024 sc1
    v_mfma_f32_16x16x32_bf16 v[52:55], a[20:23], v[96:99], v[52:55]
    s_waitcnt lgkmcnt(0)
    v_mfma_f32_16x16x32_bf16 v[60:63], a[20:23], v[104:107], v[60:63]
    s_waitcnt vmcnt(12)
    s_barrier
    v_mfma_f32_16x16x32_bf16 v[60:63], a[28:31], v[108:111], v[60:63]
    ds_read_b128 v[80:83], v159 offset:0
    s_add_u32 m0, s74, 36864
    v_mfma_f32_16x16x32_bf16 v[56:59], a[24:27], v[108:111], v[56:59]
    ds_read_b128 v[84:87], v159 offset:6144
    v_cvt_pk_bf16_f32 v208, v208, v209
    v_mfma_f32_16x16x32_bf16 v[56:59], a[16:19], v[104:107], v[56:59]
    ds_read_b128 v[88:91], v159 offset:256
    buffer_load_dwordx4 v156, s[44:47], s23 offen offset:0 sc1 lds
    v_mfma_f32_16x16x32_bf16 v[64:67], a[16:19], v[112:115], v[64:67]
    ds_read_b128 v[92:95], v159 offset:6400
    v_cvt_pk_bf16_f32 v209, v210, v211
    v_mfma_f32_16x16x32_bf16 v[64:67], a[24:27], v[116:119], v[64:67]
    ds_read_b128 v[96:99], v159 offset:512
    v_cvt_pk_bf16_f32 v210, v212, v213
    v_mfma_f32_16x16x32_bf16 v[68:71], a[28:31], v[116:119], v[68:71]
    ds_read_b128 v[100:103], v159 offset:6656
    buffer_load_dwordx4 v157, s[44:47], s23 offen offset:1024 sc1 lds
    v_mfma_f32_16x16x32_bf16 v[68:71], a[20:23], v[112:115], v[68:71]
    v_add_u32 v10, 65536, v10
    ds_read_b64_tr_b16 a[0:1], v10 offset:0
    v_mfma_f32_16x16x32_bf16 v[76:79], a[20:23], v[120:123], v[76:79]
    ds_read_b64_tr_b16 a[2:3], v10 offset:2048
    v_cvt_pk_bf16_f32 v211, v214, v215
    v_mfma_f32_16x16x32_bf16 v[76:79], a[28:31], v[124:127], v[76:79]
    v_add_u32 v11, 65536, v11
    ds_read_b64_tr_b16 a[4:5], v11 offset:0
    buffer_load_dwordx4 v158, s[44:47], s23 offen offset:2048 sc1 lds
    v_mfma_f32_16x16x32_bf16 v[72:75], a[24:27], v[124:127], v[72:75]
    ds_read_b64_tr_b16 a[6:7], v11 offset:2048
    v_mfma_f32_16x16x32_bf16 v[72:75], a[16:19], v[120:123], v[72:75]
    buffer_store_dwordx4 v[208:211], v246, s[44:47], s9 offen offset:2048 sc1
    s_waitcnt lgkmcnt(4)
    v_mfma_f32_16x16x32_bf16 v[32:35], a[32:35], v[80:83], v[32:35]
    s_add_u32 m0, s74, 49152
    v_cvt_pk_bf16_f32 v216, v216, v217
    v_mfma_f32_16x16x32_bf16 v[32:35], a[40:43], v[84:87], v[32:35]
    ds_read_b128 v[104:107], v159 offset:768
    v_mfma_f32_16x16x32_bf16 v[36:39], a[44:47], v[84:87], v[36:39]
    ds_read_b128 v[108:111], v159 offset:6912
    v_mfma_f32_16x16x32_bf16 v[36:39], a[36:39], v[80:83], v[36:39]
    ds_read_b128 v[112:115], v159 offset:1024
    buffer_load_dwordx4 v156, s[44:47], s24 offen offset:0 sc1 lds
    v_mfma_f32_16x16x32_bf16 v[44:47], a[36:39], v[88:91], v[44:47]
    ds_read_b128 v[116:119], v159 offset:7168
    v_cvt_pk_bf16_f32 v217, v218, v219
    v_mfma_f32_16x16x32_bf16 v[44:47], a[44:47], v[92:95], v[44:47]
    ds_read_b128 v[120:123], v159 offset:1280
    v_cvt_pk_bf16_f32 v218, v220, v221
    v_mfma_f32_16x16x32_bf16 v[40:43], a[40:43], v[92:95], v[40:43]
    ds_read_b128 v[124:127], v159 offset:7424
    buffer_load_dwordx4 v157, s[44:47], s24 offen offset:1024 sc1 lds
    v_mfma_f32_16x16x32_bf16 v[40:43], a[32:35], v[88:91], v[40:43]
    v_add_u32 v12, 65536, v12
    ds_read_b64_tr_b16 a[8:9], v12 offset:0
    v_mfma_f32_16x16x32_bf16 v[48:51], a[32:35], v[96:99], v[48:51]
    ds_read_b64_tr_b16 a[10:11], v12 offset:2048
    v_cvt_pk_bf16_f32 v219, v222, v223
    v_mfma_f32_16x16x32_bf16 v[48:51], a[40:43], v[100:103], v[48:51]
    v_add_u32 v13, 65536, v13
    ds_read_b64_tr_b16 a[12:13], v13 offset:0
    buffer_load_dwordx4 v158, s[44:47], s24 offen offset:2048 sc1 lds
    v_mfma_f32_16x16x32_bf16 v[52:55], a[44:47], v[100:103], v[52:55]
    ds_read_b64_tr_b16 a[14:15], v13 offset:2048
    v_mfma_f32_16x16x32_bf16 v[52:55], a[36:39], v[96:99], v[52:55]
    buffer_store_dwordx4 v[216:219], v247, s[44:47], s9 offen offset:0 sc1
    s_waitcnt lgkmcnt(4)
    v_mfma_f32_16x16x32_bf16 v[60:63], a[36:39], v[104:107], v[60:63]
    s_waitcnt vmcnt(17)
    s_barrier
    v_mfma_f32_16x16x32_bf16 v[60:63], a[44:47], v[108:111], v[60:63]
    ds_read_b128 v[80:83], v159 offset:12288
    s_add_u32 m0, s74, 61440
    v_mfma_f32_16x16x32_bf16 v[56:59], a[40:43], v[108:111], v[56:59]
    ds_read_b128 v[84:87], v159 offset:18432
    v_cvt_pk_bf16_f32 v224, v224, v225
    v_mfma_f32_16x16x32_bf16 v[56:59], a[32:35], v[104:107], v[56:59]
    ds_read_b128 v[88:91], v159 offset:12544
    buffer_load_dwordx4 v156, s[44:47], s25 offen offset:0 sc1 lds
    v_mfma_f32_16x16x32_bf16 v[64:67], a[32:35], v[112:115], v[64:67]
    ds_read_b128 v[92:95], v159 offset:18688
    v_mfma_f32_16x16x32_bf16 v[64:67], a[40:43], v[116:119], v[64:67]
    ds_read_b128 v[96:99], v159 offset:12800
    v_mfma_f32_16x16x32_bf16 v[68:71], a[44:47], v[116:119], v[68:71]
    ds_read_b128 v[100:103], v159 offset:18944
    buffer_load_dwordx4 v157, s[44:47], s25 offen offset:1024 sc1 lds
    v_mfma_f32_16x16x32_bf16 v[68:71], a[36:39], v[112:115], v[68:71]
    v_cvt_pk_bf16_f32 v225, v226, v227
    v_cvt_pk_bf16_f32 v226, v228, v229
    v_mfma_f32_16x16x32_bf16 v[76:79], a[36:39], v[120:123], v[76:79]
    v_cvt_pk_bf16_f32 v227, v230, v231
    v_mfma_f32_16x16x32_bf16 v[76:79], a[44:47], v[124:127], v[76:79]
    buffer_load_dwordx4 v158, s[44:47], s25 offen offset:2048 sc1 lds
    v_mfma_f32_16x16x32_bf16 v[72:75], a[40:43], v[124:127], v[72:75]
    buffer_store_dwordx4 v[224:227], v247, s[44:47], s9 offen offset:1024 sc1
    v_mfma_f32_16x16x32_bf16 v[72:75], a[32:35], v[120:123], v[72:75]
    s_waitcnt lgkmcnt(0)
    v_mfma_f32_16x16x32_bf16 v[32:35], a[48:51], v[80:83], v[32:35]
    s_add_u32 m0, s74, 0
    v_cvt_pk_bf16_f32 v232, v232, v233
    v_mfma_f32_16x16x32_bf16 v[32:35], a[56:59], v[84:87], v[32:35]
    ds_read_b128 v[104:107], v159 offset:13056
    v_mfma_f32_16x16x32_bf16 v[36:39], a[60:63], v[84:87], v[36:39]
    ds_read_b128 v[108:111], v159 offset:19200
    v_mfma_f32_16x16x32_bf16 v[36:39], a[52:55], v[80:83], v[36:39]
    ds_read_b128 v[112:115], v159 offset:13312
    buffer_load_dwordx4 v156, s[44:47], s26 offen offset:0 sc1 lds
    v_mfma_f32_16x16x32_bf16 v[44:47], a[52:55], v[88:91], v[44:47]
    ds_read_b128 v[116:119], v159 offset:19456
    v_mfma_f32_16x16x32_bf16 v[44:47], a[60:63], v[92:95], v[44:47]
    ds_read_b128 v[120:123], v159 offset:13568
    v_mfma_f32_16x16x32_bf16 v[40:43], a[56:59], v[92:95], v[40:43]
    ds_read_b128 v[124:127], v159 offset:19712
    buffer_load_dwordx4 v157, s[44:47], s26 offen offset:1024 sc1 lds
    v_mfma_f32_16x16x32_bf16 v[40:43], a[48:51], v[88:91], v[40:43]
    v_cvt_pk_bf16_f32 v233, v234, v235
    v_cvt_pk_bf16_f32 v234, v236, v237
    v_mfma_f32_16x16x32_bf16 v[48:51], a[48:51], v[96:99], v[48:51]
    v_cvt_pk_bf16_f32 v235, v238, v239
    v_mfma_f32_16x16x32_bf16 v[48:51], a[56:59], v[100:103], v[48:51]
    buffer_load_dwordx4 v158, s[44:47], s26 offen offset:2048 sc1 lds
    v_mfma_f32_16x16x32_bf16 v[52:55], a[60:63], v[100:103], v[52:55]
    buffer_store_dwordx4 v[232:235], v247, s[44:47], s9 offen offset:2048 sc1
    v_mfma_f32_16x16x32_bf16 v[52:55], a[52:55], v[96:99], v[52:55]
    s_waitcnt lgkmcnt(0)
    v_mfma_f32_16x16x32_bf16 v[60:63], a[52:55], v[104:107], v[60:63]
    s_waitcnt vmcnt(18)
    s_barrier
    v_mfma_f32_16x16x32_bf16 v[60:63], a[60:63], v[108:111], v[60:63]
    ds_read_b128 v[80:83], v159 offset:24576
    s_add_u32 m0, s74, 12288
    v_mfma_f32_16x16x32_bf16 v[56:59], a[56:59], v[108:111], v[56:59]
    ds_read_b128 v[84:87], v159 offset:30720
    v_mfma_f32_16x16x32_bf16 v[56:59], a[48:51], v[104:107], v[56:59]
    ds_read_b128 v[88:91], v159 offset:24832
    buffer_load_dwordx4 v156, s[44:47], s27 offen offset:0 sc1 lds
    v_mfma_f32_16x16x32_bf16 v[64:67], a[48:51], v[112:115], v[64:67]
    ds_read_b128 v[92:95], v159 offset:30976
    v_mfma_f32_16x16x32_bf16 v[64:67], a[56:59], v[116:119], v[64:67]
    ds_read_b128 v[96:99], v159 offset:25088
    v_mfma_f32_16x16x32_bf16 v[68:71], a[60:63], v[116:119], v[68:71]
    ds_read_b128 v[100:103], v159 offset:31232
    buffer_load_dwordx4 v157, s[44:47], s27 offen offset:1024 sc1 lds
    v_mfma_f32_16x16x32_bf16 v[68:71], a[52:55], v[112:115], v[68:71]
    v_add_u32 v10, -65536, v10
    ds_read_b64_tr_b16 a[16:17], v10 offset:0
    v_mfma_f32_16x16x32_bf16 v[76:79], a[52:55], v[120:123], v[76:79]
    ds_read_b64_tr_b16 a[18:19], v10 offset:2048
    v_mfma_f32_16x16x32_bf16 v[76:79], a[60:63], v[124:127], v[76:79]
    v_add_u32 v11, -65536, v11
    ds_read_b64_tr_b16 a[20:21], v11 offset:0
    buffer_load_dwordx4 v158, s[44:47], s27 offen offset:2048 sc1 lds
    v_mfma_f32_16x16x32_bf16 v[72:75], a[56:59], v[124:127], v[72:75]
    ds_read_b64_tr_b16 a[22:23], v11 offset:2048
    v_mfma_f32_16x16x32_bf16 v[72:75], a[48:51], v[120:123], v[72:75]
    s_waitcnt lgkmcnt(4)
    v_mfma_f32_16x16x32_bf16 v[32:35], a[64:67], v[80:83], v[32:35]
    s_add_u32 m0, s73, 16384
    s_lshl_b32 s14, s86, 17
    v_mfma_f32_16x16x32_bf16 v[32:35], a[72:75], v[84:87], v[32:35]
    ds_read_b128 v[104:107], v159 offset:25344
    v_mfma_f32_16x16x32_bf16 v[36:39], a[76:79], v[84:87], v[36:39]
    ds_read_b128 v[108:111], v159 offset:31488
    buffer_load_dwordx4 v4, s[52:55], s14 offen offset:0 lds
    v_mfma_f32_16x16x32_bf16 v[36:39], a[68:71], v[80:83], v[36:39]
    ds_read_b128 v[112:115], v159 offset:25600
    v_mfma_f32_16x16x32_bf16 v[44:47], a[68:71], v[88:91], v[44:47]
    ds_read_b128 v[116:119], v159 offset:31744
    buffer_load_dwordx4 v5, s[52:55], s14 offen offset:1024 lds
    v_mfma_f32_16x16x32_bf16 v[44:47], a[76:79], v[92:95], v[44:47]
    ds_read_b128 v[120:123], v159 offset:25856
    v_mfma_f32_16x16x32_bf16 v[40:43], a[72:75], v[92:95], v[40:43]
    ds_read_b128 v[124:127], v159 offset:32000
    v_mfma_f32_16x16x32_bf16 v[40:43], a[64:67], v[88:91], v[40:43]
    v_add_u32 v12, -65536, v12
    ds_read_b64_tr_b16 a[24:25], v12 offset:0
    buffer_load_dwordx4 v6, s[52:55], s14 offen offset:2048 lds
    v_mfma_f32_16x16x32_bf16 v[48:51], a[64:67], v[96:99], v[48:51]
    ds_read_b64_tr_b16 a[26:27], v12 offset:2048
    v_mfma_f32_16x16x32_bf16 v[48:51], a[72:75], v[100:103], v[48:51]
    v_add_u32 v13, -65536, v13
    ds_read_b64_tr_b16 a[28:29], v13 offset:0
    buffer_load_dwordx4 v7, s[52:55], s14 offen offset:3072 lds
    v_mfma_f32_16x16x32_bf16 v[52:55], a[76:79], v[100:103], v[52:55]
    ds_read_b64_tr_b16 a[30:31], v13 offset:2048
    v_mfma_f32_16x16x32_bf16 v[52:55], a[68:71], v[96:99], v[52:55]
    s_waitcnt lgkmcnt(4)
    v_mfma_f32_16x16x32_bf16 v[60:63], a[68:71], v[104:107], v[60:63]
    s_waitcnt vmcnt(20)
    s_barrier
    v_mfma_f32_16x16x32_bf16 v[60:63], a[76:79], v[108:111], v[60:63]
    ds_read_b128 v[80:83], v250 offset:0
    v_mfma_f32_16x16x32_bf16 v[56:59], a[72:75], v[108:111], v[56:59]
    ds_read_b128 v[84:87], v250 offset:6144
    v_mfma_f32_16x16x32_bf16 v[56:59], a[64:67], v[104:107], v[56:59]
    ds_read_b128 v[88:91], v250 offset:256
    v_mfma_f32_16x16x32_bf16 v[64:67], a[64:67], v[112:115], v[64:67]
    ds_read_b128 v[92:95], v250 offset:6400
    v_mfma_f32_16x16x32_bf16 v[64:67], a[72:75], v[116:119], v[64:67]
    ds_read_b128 v[96:99], v250 offset:512
    v_mfma_f32_16x16x32_bf16 v[68:71], a[76:79], v[116:119], v[68:71]
    ds_read_b128 v[100:103], v250 offset:6656
    v_mfma_f32_16x16x32_bf16 v[68:71], a[68:71], v[112:115], v[68:71]
    v_mfma_f32_16x16x32_bf16 v[76:79], a[68:71], v[120:123], v[76:79]
    v_mfma_f32_16x16x32_bf16 v[76:79], a[76:79], v[124:127], v[76:79]
    v_mfma_f32_16x16x32_bf16 v[72:75], a[72:75], v[124:127], v[72:75]
    v_mfma_f32_16x16x32_bf16 v[72:75], a[64:67], v[120:123], v[72:75]
    s_waitcnt lgkmcnt(0)
    v_mfma_f32_16x16x32_bf16 v[32:35], a[80:83], v[80:83], v[32:35]
    v_mfma_f32_16x16x32_bf16 v[32:35], a[88:91], v[84:87], v[32:35]
    ds_read_b128 v[104:107], v250 offset:768
    v_mfma_f32_16x16x32_bf16 v[36:39], a[92:95], v[84:87], v[36:39]
    ds_read_b128 v[108:111], v250 offset:6912
    v_mfma_f32_16x16x32_bf16 v[36:39], a[84:87], v[80:83], v[36:39]
    ds_read_b128 v[112:115], v250 offset:1024
    v_mfma_f32_16x16x32_bf16 v[44:47], a[84:87], v[88:91], v[44:47]
    ds_read_b128 v[116:119], v250 offset:7168
    v_mfma_f32_16x16x32_bf16 v[44:47], a[92:95], v[92:95], v[44:47]
    ds_read_b128 v[120:123], v250 offset:1280
    v_mfma_f32_16x16x32_bf16 v[40:43], a[88:91], v[92:95], v[40:43]
    ds_read_b128 v[124:127], v250 offset:7424
    v_mfma_f32_16x16x32_bf16 v[40:43], a[80:83], v[88:91], v[40:43]
    v_mfma_f32_16x16x32_bf16 v[48:51], a[80:83], v[96:99], v[48:51]
    v_mfma_f32_16x16x32_bf16 v[48:51], a[88:91], v[100:103], v[48:51]
    v_mfma_f32_16x16x32_bf16 v[52:55], a[92:95], v[100:103], v[52:55]
    v_mfma_f32_16x16x32_bf16 v[52:55], a[84:87], v[96:99], v[52:55]
    s_waitcnt lgkmcnt(0)
    v_mfma_f32_16x16x32_bf16 v[60:63], a[84:87], v[104:107], v[60:63]
    s_waitcnt vmcnt(16)
    s_barrier
    v_mfma_f32_16x16x32_bf16 v[60:63], a[92:95], v[108:111], v[60:63]
    ds_read_b128 v[80:83], v250 offset:12288
    v_mfma_f32_16x16x32_bf16 v[56:59], a[88:91], v[108:111], v[56:59]
    ds_read_b128 v[84:87], v250 offset:18432
    v_mfma_f32_16x16x32_bf16 v[56:59], a[80:83], v[104:107], v[56:59]
    ds_read_b128 v[88:91], v250 offset:12544
    v_mfma_f32_16x16x32_bf16 v[64:67], a[80:83], v[112:115], v[64:67]
    ds_read_b128 v[92:95], v250 offset:18688
    v_mfma_f32_16x16x32_bf16 v[64:67], a[88:91], v[116:119], v[64:67]
    ds_read_b128 v[96:99], v250 offset:12800
    v_mfma_f32_16x16x32_bf16 v[68:71], a[92:95], v[116:119], v[68:71]
    ds_read_b128 v[100:103], v250 offset:18944
    v_mfma_f32_16x16x32_bf16 v[68:71], a[84:87], v[112:115], v[68:71]
    v_mfma_f32_16x16x32_bf16 v[76:79], a[84:87], v[120:123], v[76:79]
    v_mfma_f32_16x16x32_bf16 v[76:79], a[92:95], v[124:127], v[76:79]
    v_mfma_f32_16x16x32_bf16 v[72:75], a[88:91], v[124:127], v[72:75]
    v_mfma_f32_16x16x32_bf16 v[72:75], a[80:83], v[120:123], v[72:75]
    s_waitcnt lgkmcnt(0)
    v_mfma_f32_16x16x32_bf16 v[32:35], a[96:99], v[80:83], v[32:35]
    v_mfma_f32_16x16x32_bf16 v[32:35], a[104:107], v[84:87], v[32:35]
    ds_read_b128 v[104:107], v250 offset:13056
    v_mfma_f32_16x16x32_bf16 v[36:39], a[108:111], v[84:87], v[36:39]
    ds_read_b128 v[108:111], v250 offset:19200
    v_mfma_f32_16x16x32_bf16 v[36:39], a[100:103], v[80:83], v[36:39]
    ds_read_b128 v[112:115], v250 offset:13312
    v_mfma_f32_16x16x32_bf16 v[44:47], a[100:103], v[88:91], v[44:47]
    ds_read_b128 v[116:119], v250 offset:19456
    v_mfma_f32_16x16x32_bf16 v[44:47], a[108:111], v[92:95], v[44:47]
    ds_read_b128 v[120:123], v250 offset:13568
    v_mfma_f32_16x16x32_bf16 v[40:43], a[104:107], v[92:95], v[40:43]
    ds_read_b128 v[124:127], v250 offset:19712
    v_mfma_f32_16x16x32_bf16 v[40:43], a[96:99], v[88:91], v[40:43]
    s_waitcnt vmcnt(7)
    buffer_store_dword v249, v248, s[44:47], s6 offen sc1
    v_mfma_f32_16x16x32_bf16 v[48:51], a[96:99], v[96:99], v[48:51]
    v_mfma_f32_16x16x32_bf16 v[48:51], a[104:107], v[100:103], v[48:51]
    v_mfma_f32_16x16x32_bf16 v[52:55], a[108:111], v[100:103], v[52:55]
    v_mfma_f32_16x16x32_bf16 v[52:55], a[100:103], v[96:99], v[52:55]
    s_waitcnt lgkmcnt(0)
    v_mfma_f32_16x16x32_bf16 v[60:63], a[100:103], v[104:107], v[60:63]
    s_barrier
    v_mfma_f32_16x16x32_bf16 v[60:63], a[108:111], v[108:111], v[60:63]
    ds_read_b128 v[80:83], v250 offset:24576
    s_add_u32 m0, s74, 24576
    v_mfma_f32_16x16x32_bf16 v[56:59], a[104:107], v[108:111], v[56:59]
    ds_read_b128 v[84:87], v250 offset:30720
    v_mfma_f32_16x16x32_bf16 v[56:59], a[96:99], v[104:107], v[56:59]
    ds_read_b128 v[88:91], v250 offset:24832
    buffer_load_dwordx4 v156, s[44:47], s76 offen offset:0 sc1 lds
    v_mfma_f32_16x16x32_bf16 v[64:67], a[96:99], v[112:115], v[64:67]
    ds_read_b128 v[92:95], v250 offset:30976
    v_mfma_f32_16x16x32_bf16 v[64:67], a[104:107], v[116:119], v[64:67]
    ds_read_b128 v[96:99], v250 offset:25088
    v_mfma_f32_16x16x32_bf16 v[68:71], a[108:111], v[116:119], v[68:71]
    ds_read_b128 v[100:103], v250 offset:31232
    buffer_load_dwordx4 v157, s[44:47], s76 offen offset:1024 sc1 lds
    v_mfma_f32_16x16x32_bf16 v[68:71], a[100:103], v[112:115], v[68:71]
    v_mfma_f32_16x16x32_bf16 v[76:79], a[100:103], v[120:123], v[76:79]
    v_mfma_f32_16x16x32_bf16 v[76:79], a[108:111], v[124:127], v[76:79]
    buffer_load_dwordx4 v158, s[44:47], s76 offen offset:2048 sc1 lds
    v_mfma_f32_16x16x32_bf16 v[72:75], a[104:107], v[124:127], v[72:75]
    v_mfma_f32_16x16x32_bf16 v[72:75], a[96:99], v[120:123], v[72:75]
    s_waitcnt lgkmcnt(0)
    v_mfma_f32_16x16x32_bf16 v[32:35], a[112:115], v[80:83], v[32:35]
    s_add_u32 m0, s74, 36864
    v_mfma_f32_16x16x32_bf16 v[32:35], a[120:123], v[84:87], v[32:35]
    ds_read_b128 v[104:107], v250 offset:25344
    v_mfma_f32_16x16x32_bf16 v[36:39], a[124:127], v[84:87], v[36:39]
    ds_read_b128 v[108:111], v250 offset:31488
    v_mfma_f32_16x16x32_bf16 v[36:39], a[116:119], v[80:83], v[36:39]
    ds_read_b128 v[112:115], v250 offset:25600
    buffer_load_dwordx4 v156, s[44:47], s77 offen offset:0 sc1 lds
    v_mfma_f32_16x16x32_bf16 v[44:47], a[116:119], v[88:91], v[44:47]
    ds_read_b128 v[116:119], v250 offset:31744
    v_mfma_f32_16x16x32_bf16 v[44:47], a[124:127], v[92:95], v[44:47]
    ds_read_b128 v[120:123], v250 offset:25856
    v_mfma_f32_16x16x32_bf16 v[40:43], a[120:123], v[92:95], v[40:43]
    ds_read_b128 v[124:127], v250 offset:32000
    buffer_load_dwordx4 v157, s[44:47], s77 offen offset:1024 sc1 lds
    v_mfma_f32_16x16x32_bf16 v[40:43], a[112:115], v[88:91], v[40:43]
    v_mfma_f32_16x16x32_bf16 v[48:51], a[112:115], v[96:99], v[48:51]
    v_mfma_f32_16x16x32_bf16 v[48:51], a[120:123], v[100:103], v[48:51]
    buffer_load_dwordx4 v158, s[44:47], s77 offen offset:2048 sc1 lds
    v_mfma_f32_16x16x32_bf16 v[52:55], a[124:127], v[100:103], v[52:55]
    v_mfma_f32_16x16x32_bf16 v[52:55], a[116:119], v[96:99], v[52:55]
    s_waitcnt lgkmcnt(0)
    v_mfma_f32_16x16x32_bf16 v[60:63], a[116:119], v[104:107], v[60:63]
    s_barrier
    v_mfma_f32_16x16x32_bf16 v[60:63], a[124:127], v[108:111], v[60:63]
    ds_read_b128 v[80:83], v159 offset:0
    s_add_u32 m0, s74, 49152
    v_mfma_f32_16x16x32_bf16 v[56:59], a[120:123], v[108:111], v[56:59]
    ds_read_b128 v[84:87], v159 offset:6144
    v_mfma_f32_16x16x32_bf16 v[56:59], a[112:115], v[104:107], v[56:59]
    ds_read_b128 v[88:91], v159 offset:256
    buffer_load_dwordx4 v156, s[44:47], s78 offen offset:0 sc1 lds
    v_mfma_f32_16x16x32_bf16 v[64:67], a[112:115], v[112:115], v[64:67]
    ds_read_b128 v[92:95], v159 offset:6400
    v_mfma_f32_16x16x32_bf16 v[64:67], a[120:123], v[116:119], v[64:67]
    ds_read_b128 v[96:99], v159 offset:512
    v_mfma_f32_16x16x32_bf16 v[68:71], a[124:127], v[116:119], v[68:71]
    ds_read_b128 v[100:103], v159 offset:6656
    buffer_load_dwordx4 v157, s[44:47], s78 offen offset:1024 sc1 lds
    v_mfma_f32_16x16x32_bf16 v[68:71], a[116:119], v[112:115], v[68:71]
    v_mfma_f32_16x16x32_bf16 v[76:79], a[116:119], v[120:123], v[76:79]
    v_mfma_f32_16x16x32_bf16 v[76:79], a[124:127], v[124:127], v[76:79]
    buffer_load_dwordx4 v158, s[44:47], s78 offen offset:2048 sc1 lds
    v_mfma_f32_16x16x32_bf16 v[72:75], a[120:123], v[124:127], v[72:75]
    v_mfma_f32_16x16x32_bf16 v[72:75], a[112:115], v[120:123], v[72:75]
    s_waitcnt lgkmcnt(0)
    v_mfma_f32_16x16x32_bf16 v[32:35], a[128:131], v[80:83], v[32:35]
    s_add_u32 m0, s74, 61440
    v_mfma_f32_16x16x32_bf16 v[32:35], a[136:139], v[84:87], v[32:35]
    ds_read_b128 v[104:107], v159 offset:768
    v_mfma_f32_16x16x32_bf16 v[36:39], a[140:143], v[84:87], v[36:39]
    ds_read_b128 v[108:111], v159 offset:6912
    v_mfma_f32_16x16x32_bf16 v[36:39], a[132:135], v[80:83], v[36:39]
    ds_read_b128 v[112:115], v159 offset:1024
    buffer_load_dwordx4 v156, s[44:47], s79 offen offset:0 sc1 lds
    v_mfma_f32_16x16x32_bf16 v[44:47], a[132:135], v[88:91], v[44:47]
    ds_read_b128 v[116:119], v159 offset:7168
    v_mfma_f32_16x16x32_bf16 v[44:47], a[140:143], v[92:95], v[44:47]
    ds_read_b128 v[120:123], v159 offset:1280
    v_mfma_f32_16x16x32_bf16 v[40:43], a[136:139], v[92:95], v[40:43]
    ds_read_b128 v[124:127], v159 offset:7424
    buffer_load_dwordx4 v157, s[44:47], s79 offen offset:1024 sc1 lds
    v_mfma_f32_16x16x32_bf16 v[40:43], a[128:131], v[88:91], v[40:43]
    v_mfma_f32_16x16x32_bf16 v[48:51], a[128:131], v[96:99], v[48:51]
    v_mfma_f32_16x16x32_bf16 v[48:51], a[136:139], v[100:103], v[48:51]
    buffer_load_dwordx4 v158, s[44:47], s79 offen offset:2048 sc1 lds
    v_mfma_f32_16x16x32_bf16 v[52:55], a[140:143], v[100:103], v[52:55]
    v_mfma_f32_16x16x32_bf16 v[52:55], a[132:135], v[96:99], v[52:55]
    s_waitcnt lgkmcnt(0)
    v_mfma_f32_16x16x32_bf16 v[60:63], a[132:135], v[104:107], v[60:63]
    s_waitcnt vmcnt(13)
    s_barrier
    v_mfma_f32_16x16x32_bf16 v[60:63], a[140:143], v[108:111], v[60:63]
    ds_read_b128 v[80:83], v159 offset:12288
    s_add_u32 m0, s74, 0
    v_mfma_f32_16x16x32_bf16 v[56:59], a[136:139], v[108:111], v[56:59]
    ds_read_b128 v[84:87], v159 offset:18432
    v_mfma_f32_16x16x32_bf16 v[56:59], a[128:131], v[104:107], v[56:59]
    ds_read_b128 v[88:91], v159 offset:12544
    buffer_load_dwordx4 v156, s[44:47], s80 offen offset:0 sc1 lds
    v_mfma_f32_16x16x32_bf16 v[64:67], a[128:131], v[112:115], v[64:67]
    ds_read_b128 v[92:95], v159 offset:18688
    v_mfma_f32_16x16x32_bf16 v[64:67], a[136:139], v[116:119], v[64:67]
    ds_read_b128 v[96:99], v159 offset:12800
    v_mfma_f32_16x16x32_bf16 v[68:71], a[140:143], v[116:119], v[68:71]
    ds_read_b128 v[100:103], v159 offset:18944
    buffer_load_dwordx4 v157, s[44:47], s80 offen offset:1024 sc1 lds
    v_mfma_f32_16x16x32_bf16 v[68:71], a[132:135], v[112:115], v[68:71]
    ds_read_b64_tr_b16 a[32:33], v10 offset:16384
    v_mfma_f32_16x16x32_bf16 v[76:79], a[132:135], v[120:123], v[76:79]
    ds_read_b64_tr_b16 a[34:35], v10 offset:18432
    v_mfma_f32_16x16x32_bf16 v[76:79], a[140:143], v[124:127], v[76:79]
    ds_read_b64_tr_b16 a[36:37], v11 offset:16384
    buffer_load_dwordx4 v158, s[44:47], s80 offen offset:2048 sc1 lds
    v_mfma_f32_16x16x32_bf16 v[72:75], a[136:139], v[124:127], v[72:75]
    ds_read_b64_tr_b16 a[38:39], v11 offset:18432
    v_mfma_f32_16x16x32_bf16 v[72:75], a[128:131], v[120:123], v[72:75]
    buffer_load_dword v29, v28, s[44:47], 0 offen sc1
    s_waitcnt lgkmcnt(4)
    v_mfma_f32_16x16x32_bf16 v[32:35], a[144:147], v[80:83], v[32:35]
    s_add_u32 m0, s73, 32768
    s_lshl_b32 s14, s87, 17
    v_mfma_f32_16x16x32_bf16 v[32:35], a[152:155], v[84:87], v[32:35]
    ds_read_b128 v[104:107], v159 offset:13056
    v_mfma_f32_16x16x32_bf16 v[36:39], a[156:159], v[84:87], v[36:39]
    ds_read_b128 v[108:111], v159 offset:19200
    buffer_load_dwordx4 v4, s[52:55], s14 offen offset:0 lds
    v_mfma_f32_16x16x32_bf16 v[36:39], a[148:151], v[80:83], v[36:39]
    ds_read_b128 v[112:115], v159 offset:13312
    v_mfma_f32_16x16x32_bf16 v[44:47], a[148:151], v[88:91], v[44:47]
    ds_read_b128 v[116:119], v159 offset:19456
    buffer_load_dwordx4 v5, s[52:55], s14 offen offset:1024 lds
    v_mfma_f32_16x16x32_bf16 v[44:47], a[156:159], v[92:95], v[44:47]
    ds_read_b128 v[120:123], v159 offset:13568
    v_mfma_f32_16x16x32_bf16 v[40:43], a[152:155], v[92:95], v[40:43]
    ds_read_b128 v[124:127], v159 offset:19712
    v_mfma_f32_16x16x32_bf16 v[40:43], a[144:147], v[88:91], v[40:43]
    ds_read_b64_tr_b16 a[40:41], v12 offset:16384
    buffer_load_dwordx4 v6, s[52:55], s14 offen offset:2048 lds
    v_mfma_f32_16x16x32_bf16 v[48:51], a[144:147], v[96:99], v[48:51]
    ds_read_b64_tr_b16 a[42:43], v12 offset:18432
    v_mfma_f32_16x16x32_bf16 v[48:51], a[152:155], v[100:103], v[48:51]
    ds_read_b64_tr_b16 a[44:45], v13 offset:16384
    buffer_load_dwordx4 v7, s[52:55], s14 offen offset:3072 lds
    v_mfma_f32_16x16x32_bf16 v[52:55], a[156:159], v[100:103], v[52:55]
    ds_read_b64_tr_b16 a[46:47], v13 offset:18432
    v_mfma_f32_16x16x32_bf16 v[52:55], a[148:151], v[96:99], v[52:55]
    s_waitcnt lgkmcnt(4)
    v_mfma_f32_16x16x32_bf16 v[60:63], a[148:151], v[104:107], v[60:63]
    s_waitcnt vmcnt(17)
    s_barrier
    v_mfma_f32_16x16x32_bf16 v[60:63], a[156:159], v[108:111], v[60:63]
    ds_read_b128 v[80:83], v159 offset:24576
    v_mfma_f32_16x16x32_bf16 v[56:59], a[152:155], v[108:111], v[56:59]
    ds_read_b128 v[84:87], v159 offset:30720
    v_mfma_f32_16x16x32_bf16 v[56:59], a[144:147], v[104:107], v[56:59]
    ds_read_b128 v[88:91], v159 offset:24832
    v_mfma_f32_16x16x32_bf16 v[64:67], a[144:147], v[112:115], v[64:67]
    ds_read_b128 v[92:95], v159 offset:30976
    v_mfma_f32_16x16x32_bf16 v[64:67], a[152:155], v[116:119], v[64:67]
    ds_read_b128 v[96:99], v159 offset:25088
    v_mfma_f32_16x16x32_bf16 v[68:71], a[156:159], v[116:119], v[68:71]
    ds_read_b128 v[100:103], v159 offset:31232
    v_mfma_f32_16x16x32_bf16 v[68:71], a[148:151], v[112:115], v[68:71]
    v_mfma_f32_16x16x32_bf16 v[76:79], a[148:151], v[120:123], v[76:79]
    v_mfma_f32_16x16x32_bf16 v[76:79], a[156:159], v[124:127], v[76:79]
    v_mfma_f32_16x16x32_bf16 v[72:75], a[152:155], v[124:127], v[72:75]
    v_mfma_f32_16x16x32_bf16 v[72:75], a[144:147], v[120:123], v[72:75]
    s_waitcnt lgkmcnt(0)
    v_mfma_f32_16x16x32_bf16 v[32:35], a[160:163], v[80:83], v[32:35]
    v_mfma_f32_16x16x32_bf16 v[32:35], a[168:171], v[84:87], v[32:35]
    ds_read_b128 v[104:107], v159 offset:25344
    v_mfma_f32_16x16x32_bf16 v[36:39], a[172:175], v[84:87], v[36:39]
    ds_read_b128 v[108:111], v159 offset:31488
    v_mfma_f32_16x16x32_bf16 v[36:39], a[164:167], v[80:83], v[36:39]
    ds_read_b128 v[112:115], v159 offset:25600
    v_mfma_f32_16x16x32_bf16 v[44:47], a[164:167], v[88:91], v[44:47]
    ds_read_b128 v[116:119], v159 offset:31744
    v_mfma_f32_16x16x32_bf16 v[44:47], a[172:175], v[92:95], v[44:47]
    ds_read_b128 v[120:123], v159 offset:25856
    v_mfma_f32_16x16x32_bf16 v[40:43], a[168:171], v[92:95], v[40:43]
    ds_read_b128 v[124:127], v159 offset:32000
    v_mfma_f32_16x16x32_bf16 v[40:43], a[160:163], v[88:91], v[40:43]
    v_mfma_f32_16x16x32_bf16 v[48:51], a[160:163], v[96:99], v[48:51]
    v_mfma_f32_16x16x32_bf16 v[48:51], a[168:171], v[100:103], v[48:51]
    v_mfma_f32_16x16x32_bf16 v[52:55], a[172:175], v[100:103], v[52:55]
    v_mfma_f32_16x16x32_bf16 v[52:55], a[164:167], v[96:99], v[52:55]
    s_waitcnt lgkmcnt(0)
    v_mfma_f32_16x16x32_bf16 v[60:63], a[164:167], v[104:107], v[60:63]
    s_waitcnt vmcnt(14)
    s_barrier
    v_mfma_f32_16x16x32_bf16 v[60:63], a[172:175], v[108:111], v[60:63]
L_pl_G_4:
    s_cbranch_execz L_wret
    ds_read_b128 v[80:83], v250 offset:0
    v_mfma_f32_16x16x32_bf16 v[56:59], a[168:171], v[108:111], v[56:59]
    ds_read_b128 v[84:87], v250 offset:6144
    v_mfma_f32_16x16x32_bf16 v[56:59], a[160:163], v[104:107], v[56:59]
    ds_read_b128 v[88:91], v250 offset:256
    v_mfma_f32_16x16x32_bf16 v[64:67], a[160:163], v[112:115], v[64:67]
    ds_read_b128 v[92:95], v250 offset:6400
    v_mfma_f32_16x16x32_bf16 v[64:67], a[168:171], v[116:119], v[64:67]
    ds_read_b128 v[96:99], v250 offset:512
    v_mfma_f32_16x16x32_bf16 v[68:71], a[172:175], v[116:119], v[68:71]
    ds_read_b128 v[100:103], v250 offset:6656
    v_mfma_f32_16x16x32_bf16 v[68:71], a[164:167], v[112:115], v[68:71]
    s_waitcnt vmcnt(4)
    v_cmp_ne_u32 vcc, s68, v29
    s_cbranch_vccnz L_rs_p5
L_ok_p5:
    v_mfma_f32_16x16x32_bf16 v[76:79], a[164:167], v[120:123], v[76:79]
    buffer_load_dwordx4 v[160:163], v246, s[44:47], s10 offen offset:0 sc1
    v_mfma_f32_16x16x32_bf16 v[76:79], a[172:175], v[124:127], v[76:79]
    buffer_load_dwordx4 v[164:167], v246, s[44:47], s10 offen offset:1024 sc1
    v_mfma_f32_16x16x32_bf16 v[72:75], a[168:171], v[124:127], v[72:75]
    buffer_load_dwordx4 v[168:171], v246, s[44:47], s10 offen offset:2048 sc1
    v_mfma_f32_16x16x32_bf16 v[72:75], a[160:163], v[120:123], v[72:75]
    s_waitcnt lgkmcnt(0)
    v_mfma_f32_16x16x32_bf16 v[32:35], a[176:179], v[80:83], v[32:35]
    buffer_load_dwordx4 v[172:175], v247, s[44:47], s10 offen offset:0 sc1
    v_mfma_f32_16x16x32_bf16 v[32:35], a[184:187], v[84:87], v[32:35]
    ds_read_b128 v[104:107], v250 offset:768
    v_mfma_f32_16x16x32_bf16 v[36:39], a[188:191], v[84:87], v[36:39]
    ds_read_b128 v[108:111], v250 offset:6912
    v_mfma_f32_16x16x32_bf16 v[36:39], a[180:183], v[80:83], v[36:39]
    ds_read_b128 v[112:115], v250 offset:1024
    v_mfma_f32_16x16x32_bf16 v[44:47], a[180:183], v[88:91], v[44:47]
    ds_read_b128 v[116:119], v250 offset:7168
    v_mfma_f32_16x16x32_bf16 v[44:47], a[188:191], v[92:95], v[44:47]
    ds_read_b128 v[120:123], v250 offset:1280
    v_mfma_f32_16x16x32_bf16 v[40:43], a[184:187], v[92:95], v[40:43]
    ds_read_b128 v[124:127], v250 offset:7424
    v_mfma_f32_16x16x32_bf16 v[40:43], a[176:179], v[88:91], v[40:43]
    buffer_load_dwordx4 v[176:179], v247, s[44:47], s10 offen offset:1024 sc1
    v_mfma_f32_16x16x32_bf16 v[48:51], a[176:179], v[96:99], v[48:51]
    v_mfma_f32_16x16x32_bf16 v[48:51], a[184:187], v[100:103], v[48:51]
    v_mfma_f32_16x16x32_bf16 v[52:55], a[188:191], v[100:103], v[52:55]
    buffer_load_dwordx4 v[180:183], v247, s[44:47], s10 offen offset:2048 sc1
    v_mfma_f32_16x16x32_bf16 v[52:55], a[180:183], v[96:99], v[52:55]
    s_waitcnt lgkmcnt(0)
    v_mfma_f32_16x16x32_bf16 v[60:63], a[180:183], v[104:107], v[60:63]
    s_barrier
    v_mfma_f32_16x16x32_bf16 v[60:63], a[188:191], v[108:111], v[60:63]
    ds_read_b128 v[80:83], v250 offset:12288
    s_add_u32 m0, s74, 12288
    v_mfma_f32_16x16x32_bf16 v[56:59], a[184:187], v[108:111], v[56:59]
    ds_read_b128 v[84:87], v250 offset:18432
    v_mfma_f32_16x16x32_bf16 v[56:59], a[176:179], v[104:107], v[56:59]
    ds_read_b128 v[88:91], v250 offset:12544
    buffer_load_dwordx4 v156, s[44:47], s81 offen offset:0 sc1 lds
    v_mfma_f32_16x16x32_bf16 v[64:67], a[176:179], v[112:115], v[64:67]
    ds_read_b128 v[92:95], v250 offset:18688
    v_mfma_f32_16x16x32_bf16 v[64:67], a[184:187], v[116:119], v[64:67]
    ds_read_b128 v[96:99], v250 offset:12800
    v_mfma_f32_16x16x32_bf16 v[68:71], a[188:191], v[116:119], v[68:71]
    ds_read_b128 v[100:103], v250 offset:18944
    buffer_load_dwordx4 v157, s[44:47], s81 offen offset:1024 sc1 lds
    v_mfma_f32_16x16x32_bf16 v[68:71], a[180:183], v[112:115], v[68:71]
    v_mfma_f32_16x16x32_bf16 v[76:79], a[180:183], v[120:123], v[76:79]
    v_mfma_f32_16x16x32_bf16 v[76:79], a[188:191], v[124:127], v[76:79]
    buffer_load_dwordx4 v158, s[44:47], s81 offen offset:2048 sc1 lds
    v_mfma_f32_16x16x32_bf16 v[72:75], a[184:187], v[124:127], v[72:75]
    v_mfma_f32_16x16x32_bf16 v[72:75], a[176:179], v[120:123], v[72:75]
    s_waitcnt lgkmcnt(0)
    v_mfma_f32_16x16x32_bf16 v[32:35], a[192:195], v[80:83], v[32:35]
    s_add_u32 m0, s73, 49152
    s_lshl_b32 s14, s88, 17
    v_mfma_f32_16x16x32_bf16 v[32:35], a[200:203], v[84:87], v[32:35]
    ds_read_b128 v[104:107], v250 offset:13056
    v_mfma_f32_16x16x32_bf16 v[36:39], a[204:207], v[84:87], v[36:39]
    ds_read_b128 v[108:111], v250 offset:19200
    buffer_load_dwordx4 v4, s[52:55], s14 offen offset:0 lds
    v_mfma_f32_16x16x32_bf16 v[36:39], a[196:199], v[80:83], v[36:39]
    ds_read_b128 v[112:115], v250 offset:13312
    v_mfma_f32_16x16x32_bf16 v[44:47], a[196:199], v[88:91], v[44:47]
    ds_read_b128 v[116:119], v250 offset:19456
    buffer_load_dwordx4 v5, s[52:55], s14 offen offset:1024 lds
    v_mfma_f32_16x16x32_bf16 v[44:47], a[204:207], v[92:95], v[44:47]
    ds_read_b128 v[120:123], v250 offset:13568
    v_mfma_f32_16x16x32_bf16 v[40:43], a[200:203], v[92:95], v[40:43]
    ds_read_b128 v[124:127], v250 offset:19712
    v_mfma_f32_16x16x32_bf16 v[40:43], a[192:195], v[88:91], v[40:43]
    buffer_load_dwordx4 v6, s[52:55], s14 offen offset:2048 lds
    v_mfma_f32_16x16x32_bf16 v[48:51], a[192:195], v[96:99], v[48:51]
    v_mfma_f32_16x16x32_bf16 v[48:51], a[200:203], v[100:103], v[48:51]
    buffer_load_dwordx4 v7, s[52:55], s14 offen offset:3072 lds
    v_mfma_f32_16x16x32_bf16 v[52:55], a[204:207], v[100:103], v[52:55]
    v_mfma_f32_16x16x32_bf16 v[52:55], a[196:199], v[96:99], v[52:55]
    s_waitcnt lgkmcnt(0)
    v_mfma_f32_16x16x32_bf16 v[60:63], a[196:199], v[104:107], v[60:63]
    s_barrier
    v_mfma_f32_16x16x32_bf16 v[60:63], a[204:207], v[108:111], v[60:63]
    ds_read_b128 v[80:83], v250 offset:24576
    v_mfma_f32_16x16x32_bf16 v[56:59], a[200:203], v[108:111], v[56:59]
    ds_read_b128 v[84:87], v250 offset:30720
    v_mfma_f32_16x16x32_bf16 v[56:59], a[192:195], v[104:107], v[56:59]
    ds_read_b128 v[88:91], v250 offset:24832
    v_mfma_f32_16x16x32_bf16 v[64:67], a[192:195], v[112:115], v[64:67]
    ds_read_b128 v[92:95], v250 offset:30976
    v_mfma_f32_16x16x32_bf16 v[64:67], a[200:203], v[116:119], v[64:67]
    ds_read_b128 v[96:99], v250 offset:25088
    v_mfma_f32_16x16x32_bf16 v[68:71], a[204:207], v[116:119], v[68:71]
    ds_read_b128 v[100:103], v250 offset:31232
    v_mfma_f32_16x16x32_bf16 v[68:71], a[196:199], v[112:115], v[68:71]
    s_waitcnt vmcnt(7)
    v_mfma_f32_16x16x32_bf16 v[76:79], a[196:199], v[120:123], v[76:79]
    v_mfma_f32_16x16x32_bf16 v[76:79], a[204:207], v[124:127], v[76:79]
    v_mfma_f32_16x16x32_bf16 v[72:75], a[200:203], v[124:127], v[72:75]
    v_mfma_f32_16x16x32_bf16 v[72:75], a[192:195], v[120:123], v[72:75]
    s_waitcnt lgkmcnt(0)
    v_mfma_f32_16x16x32_bf16 v[32:35], a[208:211], v[80:83], v[32:35]
    s_add_u32 m0, s73, 65536
    s_lshl_b32 s14, s89, 17
    v_mfma_f32_16x16x32_bf16 v[32:35], a[216:219], v[84:87], v[32:35]
    ds_read_b128 v[104:107], v250 offset:25344
    v_mfma_f32_16x16x32_bf16 v[36:39], a[220:223], v[84:87], v[36:39]
    ds_read_b128 v[108:111], v250 offset:31488
    buffer_load_dwordx4 v4, s[52:55], s14 offen offset:0 lds
    v_mfma_f32_16x16x32_bf16 v[36:39], a[212:215], v[80:83], v[36:39]
    ds_read_b128 v[112:115], v250 offset:25600
    v_and_b32 v193, 0xffff0000, v172
    v_lshlrev_b32 v192, 16, v172
    v_mfma_f32_16x16x32_bf16 v[44:47], a[212:215], v[88:91], v[44:47]
    ds_read_b128 v[116:119], v250 offset:31744
    buffer_load_dwordx4 v5, s[52:55], s14 offen offset:1024 lds
    v_mfma_f32_16x16x32_bf16 v[44:47], a[220:223], v[92:95], v[44:47]
    ds_read_b128 v[120:123], v250 offset:25856
    v_and_b32 v195, 0xffff0000, v173
    v_lshlrev_b32 v194, 16, v173
    v_mfma_f32_16x16x32_bf16 v[40:43], a[216:219], v[92:95], v[40:43]
    ds_read_b128 v[124:127], v250 offset:32000
    v_add_f32 v56, v56, v192
    v_add_f32 v57, v57, v193
    v_mfma_f32_16x16x32_bf16 v[40:43], a[208:211], v[88:91], v[40:43]
    buffer_load_dwordx4 v6, s[52:55], s14 offen offset:2048 lds
    v_add_f32 v58, v58, v194
    v_add_f32 v59, v59, v195
    v_mfma_f32_16x16x32_bf16 v[48:51], a[208:211], v[96:99], v[48:51]
    v_and_b32 v197, 0xffff0000, v174
    v_lshlrev_b32 v196, 16, v174
    v_and_b32 v199, 0xffff0000, v175
    v_mfma_f32_16x16x32_bf16 v[48:51], a[216:219], v[100:103], v[48:51]
    buffer_load_dwordx4 v7, s[52:55], s14 offen offset:3072 lds
    v_lshlrev_b32 v198, 16, v175
    v_add_f32 v60, v60, v196
    v_mfma_f32_16x16x32_bf16 v[52:55], a[220:223], v[100:103], v[52:55]
    v_add_f32 v61, v61, v197
    v_add_f32 v62, v62, v198
    v_add_f32 v63, v63, v199
    v_mfma_f32_16x16x32_bf16 v[52:55], a[212:215], v[96:99], v[52:55]
    s_waitcnt lgkmcnt(0)
    v_mfma_f32_16x16x32_bf16 v[60:63], a[212:215], v[104:107], v[60:63]
    s_barrier
    v_mfma_f32_16x16x32_bf16 v[60:63], a[220:223], v[108:111], v[60:63]
    ds_read_b128 v[80:83], v159 offset:0
    v_mfma_f32_16x16x32_bf16 v[56:59], a[216:219], v[108:111], v[56:59]
    ds_read_b128 v[84:87], v159 offset:6144
    v_and_b32 v193, 0xffff0000, v160
    v_lshlrev_b32 v192, 16, v160
    v_mfma_f32_16x16x32_bf16 v[56:59], a[208:211], v[104:107], v[56:59]
    ds_read_b128 v[88:91], v159 offset:256
    v_and_b32 v195, 0xffff0000, v161
    v_lshlrev_b32 v194, 16, v161
    v_mfma_f32_16x16x32_bf16 v[64:67], a[208:211], v[112:115], v[64:67]
    ds_read_b128 v[92:95], v159 offset:6400
    v_add_f32 v32, v32, v192
    v_mfma_f32_16x16x32_bf16 v[64:67], a[216:219], v[116:119], v[64:67]
    ds_read_b128 v[96:99], v159 offset:512
    v_add_f32 v33, v33, v193
    v_add_f32 v34, v34, v194
    v_mfma_f32_16x16x32_bf16 v[68:71], a[220:223], v[116:119], v[68:71]
    ds_read_b128 v[100:103], v159 offset:6656
    v_add_f32 v35, v35, v195
    v_and_b32 v197, 0xffff0000, v162
    v_mfma_f32_16x16x32_bf16 v[68:71], a[212:215], v[112:115], v[68:71]
    ds_read_b64_tr_b16 a[48:49], v10 offset:32768
    v_lshlrev_b32 v196, 16, v162
    v_and_b32 v199, 0xffff0000, v163
    v_mfma_f32_16x16x32_bf16 v[76:79], a[212:215], v[120:123], v[76:79]
    ds_read_b64_tr_b16 a[50:51], v10 offset:34816
    v_lshlrev_b32 v198, 16, v163
    v_mfma_f32_16x16x32_bf16 v[76:79], a[220:223], v[124:127], v[76:79]
    ds_read_b64_tr_b16 a[52:53], v11 offset:32768
    v_add_f32 v36, v36, v196
    v_add_f32 v37, v37, v197
    v_mfma_f32_16x16x32_bf16 v[72:75], a[216:219], v[124:127], v[72:75]
    ds_read_b64_tr_b16 a[54:55], v11 offset:34816
    v_add_f32 v38, v38, v198
    v_add_f32 v39, v39, v199
    v_mfma_f32_16x16x32_bf16 v[72:75], a[208:211], v[120:123], v[72:75]
    s_waitcnt lgkmcnt(4)
    v_mfma_f32_16x16x32_bf16 v[32:35], a[224:227], v[80:83], v[32:35]
    s_add_u32 m0, s73, 0
    s_lshl_b32 s14, s90, 17
    v_mfma_f32_16x16x32_bf16 v[32:35], a[232:235], v[84:87], v[32:35]
    ds_read_b128 v[104:107], v159 offset:768
    v_mfma_f32_16x16x32_bf16 v[36:39], a[236:239], v[84:87], v[36:39]
    ds_read_b128 v[108:111], v159 offset:6912
    buffer_load_dwordx4 v4, s[52:55], s14 offen offset:0 lds
    v_and_b32 v193, 0xffff0000, v176
    v_mfma_f32_16x16x32_bf16 v[36:39], a[228:231], v[80:83], v[36:39]
    ds_read_b128 v[112:115], v159 offset:1024
    v_lshlrev_b32 v192, 16, v176
    v_and_b32 v195, 0xffff0000, v177
    v_lshlrev_b32 v194, 16, v177
    v_mfma_f32_16x16x32_bf16 v[44:47], a[228:231], v[88:91], v[44:47]
    ds_read_b128 v[116:119], v159 offset:7168
    buffer_load_dwordx4 v5, s[52:55], s14 offen offset:1024 lds
    v_add_f32 v64, v64, v192
    v_mfma_f32_16x16x32_bf16 v[44:47], a[236:239], v[92:95], v[44:47]
    ds_read_b128 v[120:123], v159 offset:1280
    v_add_f32 v65, v65, v193
    v_add_f32 v66, v66, v194
    v_mfma_f32_16x16x32_bf16 v[40:43], a[232:235], v[92:95], v[40:43]
    ds_read_b128 v[124:127], v159 offset:7424
    v_add_f32 v67, v67, v195
    v_and_b32 v197, 0xffff0000, v178
    v_mfma_f32_16x16x32_bf16 v[40:43], a[224:227], v[88:91], v[40:43]
    ds_read_b64_tr_b16 a[56:57], v12 offset:32768
    buffer_load_dwordx4 v6, s[52:55], s14 offen offset:2048 lds
    v_lshlrev_b32 v196, 16, v178
    v_mfma_f32_16x16x32_bf16 v[48:51], a[224:227], v[96:99], v[48:51]
    ds_read_b64_tr_b16 a[58:59], v12 offset:34816
    v_and_b32 v199, 0xffff0000, v179
    v_lshlrev_b32 v198, 16, v179
    v_add_f32 v68, v68, v196
    v_mfma_f32_16x16x32_bf16 v[48:51], a[232:235], v[100:103], v[48:51]
    ds_read_b64_tr_b16 a[60:61], v13 offset:32768
    buffer_load_dwordx4 v7, s[52:55], s14 offen offset:3072 lds
    v_add_f32 v69, v69, v197
    v_mfma_f32_16x16x32_bf16 v[52:55], a[236:239], v[100:103], v[52:55]
    ds_read_b64_tr_b16 a[62:63], v13 offset:34816
    v_add_f32 v70, v70, v198
    v_add_f32 v71, v71, v199
    v_mfma_f32_16x16x32_bf16 v[52:55], a[228:231], v[96:99], v[52:55]
    s_waitcnt lgkmcnt(4)
    v_mfma_f32_16x16x32_bf16 v[60:63], a[228:231], v[104:107], v[60:63]
    s_waitcnt vmcnt(12)
    s_barrier
    v_mfma_f32_16x16x32_bf16 v[60:63], a[236:239], v[108:111], v[60:63]
    ds_read_b128 v[80:83], v159 offset:12288
    v_mfma_f32_16x16x32_bf16 v[56:59], a[232:235], v[108:111], v[56:59]
    ds_read_b128 v[84:87], v159 offset:18432
    v_and_b32 v193, 0xffff0000, v164
    v_mfma_f32_16x16x32_bf16 v[56:59], a[224:227], v[104:107], v[56:59]
    ds_read_b128 v[88:91], v159 offset:12544
    v_lshlrev_b32 v192, 16, v164
    v_mfma_f32_16x16x32_bf16 v[64:67], a[224:227], v[112:115], v[64:67]
    ds_read_b128 v[92:95], v159 offset:18688
    v_and_b32 v195, 0xffff0000, v165
    v_mfma_f32_16x16x32_bf16 v[64:67], a[232:235], v[116:119], v[64:67]
    ds_read_b128 v[96:99], v159 offset:12800
    v_lshlrev_b32 v194, 16, v165
    v_mfma_f32_16x16x32_bf16 v[68:71], a[236:239], v[116:119], v[68:71]
    ds_read_b128 v[100:103], v159 offset:18944
    v_add_f32 v40, v40, v192
    v_mfma_f32_16x16x32_bf16 v[68:71], a[228:231], v[112:115], v[68:71]
    v_add_f32 v41, v41, v193
    v_add_f32 v42, v42, v194
    v_add_f32 v43, v43, v195
    v_mfma_f32_16x16x32_bf16 v[76:79], a[228:231], v[120:123], v[76:79]
    v_and_b32 v197, 0xffff0000, v166
    v_lshlrev_b32 v196, 16, v166
    v_and_b32 v199, 0xffff0000, v167
    v_mfma_f32_16x16x32_bf16 v[76:79], a[236:239], v[124:127], v[76:79]
    v_lshlrev_b32 v198, 16, v167
    v_add_f32 v44, v44, v196
    v_add_f32 v45, v45, v197
    v_mfma_f32_16x16x32_bf16 v[72:75], a[232:235], v[124:127], v[72:75]
    v_add_f32 v46, v46, v198
    v_add_f32 v47, v47, v199
    v_mfma_f32_16x16x32_bf16 v[72:75], a[224:227], v[120:123], v[72:75]
    s_waitcnt lgkmcnt(0)
    v_mfma_f32_16x16x32_bf16 v[32:35], a[240:243], v[80:83], v[32:35]
    s_add_u32 m0, s73, 16384
    s_lshl_b32 s14, s91, 17
    v_mfma_f32_16x16x32_bf16 v[32:35], a[248:251], v[84:87], v[32:35]
    ds_read_b128 v[104:107], v159 offset:13056
    v_mfma_f32_16x16x32_bf16 v[36:39], a[252:255], v[84:87], v[36:39]
    ds_read_b128 v[108:111], v159 offset:19200
    buffer_load_dwordx4 v4, s[52:55], s14 offen offset:0 lds
    v_mfma_f32_16x16x32_bf16 v[36:39], a[244:247], v[80:83], v[36:39]
    ds_read_b128 v[112:115], v159 offset:13312
    v_and_b32 v193, 0xffff0000, v180
    v_lshlrev_b32 v192, 16, v180
    v_mfma_f32_16x16x32_bf16 v[44:47], a[244:247], v[88:91], v[44:47]
    ds_read_b128 v[116:119], v159 offset:19456
    buffer_load_dwordx4 v5, s[52:55], s14 offen offset:1024 lds
    v_mfma_f32_16x16x32_bf16 v[44:47], a[252:255], v[92:95], v[44:47]
    ds_read_b128 v[120:123], v159 offset:13568
    v_and_b32 v195, 0xffff0000, v181
    v_lshlrev_b32 v194, 16, v181
    v_mfma_f32_16x16x32_bf16 v[40:43], a[248:251], v[92:95], v[40:43]
    ds_read_b128 v[124:127], v159 offset:19712
    v_add_f32 v72, v72, v192
    v_add_f32 v73, v73, v193
    v_mfma_f32_16x16x32_bf16 v[40:43], a[240:243], v[88:91], v[40:43]
    buffer_load_dwordx4 v6, s[52:55], s14 offen offset:2048 lds
    v_add_f32 v74, v74, v194
    v_add_f32 v75, v75, v195
    v_mfma_f32_16x16x32_bf16 v[48:51], a[240:243], v[96:99], v[48:51]
    v_and_b32 v197, 0xffff0000, v182
    v_lshlrev_b32 v196, 16, v182
    v_and_b32 v199, 0xffff0000, v183
    v_mfma_f32_16x16x32_bf16 v[48:51], a[248:251], v[100:103], v[48:51]
    buffer_load_dwordx4 v7, s[52:55], s14 offen offset:3072 lds
    v_lshlrev_b32 v198, 16, v183
    v_add_f32 v76, v76, v196
    v_mfma_f32_16x16x32_bf16 v[52:55], a[252:255], v[100:103], v[52:55]
    v_add_f32 v77, v77, v197
    v_add_f32 v78, v78, v198
    v_add_f32 v79, v79, v199
    v_mfma_f32_16x16x32_bf16 v[52:55], a[244:247], v[96:99], v[52:55]
    s_waitcnt lgkmcnt(0)
    v_mfma_f32_16x16x32_bf16 v[60:63], a[244:247], v[104:107], v[60:63]
    s_barrier
    v_mfma_f32_16x16x32_bf16 v[60:63], a[252:255], v[108:111], v[60:63]
    s_add_u32 m0, s73, 131072
    s_lshl_b32 s14, s92, 17
    v_mfma_f32_16x16x32_bf16 v[56:59], a[248:251], v[108:111], v[56:59]
    v_and_b32 v193, 0xffff0000, v168
    v_lshlrev_b32 v192, 16, v168
    v_mfma_f32_16x16x32_bf16 v[56:59], a[240:243], v[104:107], v[56:59]
    buffer_load_dwordx4 v4, s[52:55], s14 offen offset:0 lds
    v_and_b32 v195, 0xffff0000, v169
    v_mfma_f32_16x16x32_bf16 v[64:67], a[240:243], v[112:115], v[64:67]
    v_lshlrev_b32 v194, 16, v169
    v_add_f32 v48, v48, v192
    v_add_f32 v49, v49, v193
    v_mfma_f32_16x16x32_bf16 v[64:67], a[248:251], v[116:119], v[64:67]
    buffer_load_dwordx4 v5, s[52:55], s14 offen offset:1024 lds
    v_add_f32 v50, v50, v194
    v_mfma_f32_16x16x32_bf16 v[68:71], a[252:255], v[116:119], v[68:71]
    v_add_f32 v51, v51, v195
    v_and_b32 v197, 0xffff0000, v170
    v_mfma_f32_16x16x32_bf16 v[68:71], a[244:247], v[112:115], v[68:71]
    buffer_load_dwordx4 v6, s[52:55], s14 offen offset:2048 lds
    v_lshlrev_b32 v196, 16, v170
    v_mfma_f32_16x16x32_bf16 v[76:79], a[244:247], v[120:123], v[76:79]
    v_and_b32 v199, 0xffff0000, v171
    v_lshlrev_b32 v198, 16, v171
    v_add_f32 v52, v52, v196
    v_mfma_f32_16x16x32_bf16 v[76:79], a[252:255], v[124:127], v[76:79]
    buffer_load_dwordx4 v7, s[52:55], s14 offen offset:3072 lds
    v_add_f32 v53, v53, v197
    v_mfma_f32_16x16x32_bf16 v[72:75], a[248:251], v[124:127], v[72:75]
    v_add_f32 v54, v54, v198
    v_add_f32 v55, v55, v199
    v_mfma_f32_16x16x32_bf16 v[72:75], a[240:243], v[120:123], v[72:75]
    s_waitcnt lgkmcnt(0)
    v_mov_b32 v88, 0xc0135761
    s_mov_b32 s10, 0xbdd2d3e8
    s_lshl_b32 s9, s69, 2
    s_add_u32 s9, s9, s3
    s_mul_i32 s9, s9, 69632
    s_add_u32 s9, s9, 12795904
    v_pk_mul_f32 v[160:161], v[32:33], v[32:33]
    v_pk_mul_f32 v[162:163], v[34:35], v[34:35]
    v_pk_mul_f32 v[164:165], v[36:37], v[36:37]
    v_pk_mul_f32 v[166:167], v[38:39], v[38:39]
    v_pk_mul_f32 v[168:169], v[40:41], v[40:41]
    v_pk_mul_f32 v[170:171], v[42:43], v[42:43]
    v_pk_mul_f32 v[172:173], v[44:45], v[44:45]
    v_pk_mul_f32 v[174:175], v[46:47], v[46:47]
    v_pk_fma_f32 v[160:161], v[160:161], s[10:11], v[88:89] op_sel_hi:[1,0,0]
    v_pk_fma_f32 v[162:163], v[162:163], s[10:11], v[88:89] op_sel_hi:[1,0,0]
    v_pk_fma_f32 v[164:165], v[164:165], s[10:11], v[88:89] op_sel_hi:[1,0,0]
    v_pk_fma_f32 v[166:167], v[166:167], s[10:11], v[88:89] op_sel_hi:[1,0,0]
    v_pk_fma_f32 v[168:169], v[168:169], s[10:11], v[88:89] op_sel_hi:[1,0,0]
    v_pk_fma_f32 v[170:171], v[170:171], s[10:11], v[88:89] op_sel_hi:[1,0,0]
    v_pk_fma_f32 v[172:173], v[172:173], s[10:11], v[88:89] op_sel_hi:[1,0,0]
    v_pk_fma_f32 v[174:175], v[174:175], s[10:11], v[88:89] op_sel_hi:[1,0,0]
    v_pk_mul_f32 v[160:161], v[160:161], v[32:33]
    v_pk_mul_f32 v[162:163], v[162:163], v[34:35]
    v_pk_mul_f32 v[164:165], v[164:165], v[36:37]
    v_pk_mul_f32 v[166:167], v[166:167], v[38:39]
    v_pk_mul_f32 v[168:169], v[168:169], v[40:41]
    v_pk_mul_f32 v[170:171], v[170:171], v[42:43]
    v_pk_mul_f32 v[172:173], v[172:173], v[44:45]
    v_pk_mul_f32 v[174:175], v[174:175], v[46:47]
    v_exp_f32 v160, v160
    v_exp_f32 v161, v161
    v_exp_f32 v162, v162
    v_exp_f32 v163, v163
    v_exp_f32 v164, v164
    v_exp_f32 v165, v165
    v_exp_f32 v166, v166
    v_exp_f32 v167, v167
    v_exp_f32 v168, v168
    v_exp_f32 v169, v169
    v_exp_f32 v170, v170
    v_exp_f32 v171, v171
    v_exp_f32 v172, v172
    v_exp_f32 v173, v173
    v_exp_f32 v174, v174
    v_exp_f32 v175, v175
    v_pk_add_f32 v[160:161], v[160:161], 1.0 op_sel_hi:[1,0]
    v_pk_add_f32 v[162:163], v[162:163], 1.0 op_sel_hi:[1,0]
    v_pk_add_f32 v[164:165], v[164:165], 1.0 op_sel_hi:[1,0]
    v_pk_add_f32 v[166:167], v[166:167], 1.0 op_sel_hi:[1,0]
    v_pk_add_f32 v[168:169], v[168:169], 1.0 op_sel_hi:[1,0]
    v_pk_add_f32 v[170:171], v[170:171], 1.0 op_sel_hi:[1,0]
    v_pk_add_f32 v[172:173], v[172:173], 1.0 op_sel_hi:[1,0]
    v_pk_add_f32 v[174:175], v[174:175], 1.0 op_sel_hi:[1,0]
    v_rcp_f32 v160, v160
    v_rcp_f32 v161, v161
    v_rcp_f32 v162, v162
    v_rcp_f32 v163, v163
    v_rcp_f32 v164, v164
    v_rcp_f32 v165, v165
    v_rcp_f32 v166, v166
    v_rcp_f32 v167, v167
    v_rcp_f32 v168, v168
    v_rcp_f32 v169, v169
    v_rcp_f32 v170, v170
    v_rcp_f32 v171, v171
    v_rcp_f32 v172, v172
    v_rcp_f32 v173, v173
    v_rcp_f32 v174, v174
    v_rcp_f32 v175, v175
    v_pk_mul_f32 v[32:33], v[32:33], v[160:161]
    v_pk_mul_f32 v[34:35], v[34:35], v[162:163]
    v_pk_mul_f32 v[36:37], v[36:37], v[164:165]
    v_pk_mul_f32 v[38:39], v[38:39], v[166:167]
    v_pk_mul_f32 v[40:41], v[40:41], v[168:169]
    v_pk_mul_f32 v[42:43], v[42:43], v[170:171]
    v_pk_mul_f32 v[44:45], v[44:45], v[172:173]
    v_pk_mul_f32 v[46:47], v[46:47], v[174:175]
    v_cvt_pk_bf16_f32 v96, v32, v33
    v_cvt_pk_bf16_f32 v97, v34, v35
    v_cvt_pk_bf16_f32 v98, v36, v37
    v_cvt_pk_bf16_f32 v99, v38, v39
    v_cvt_pk_bf16_f32 v100, v40, v41
    v_cvt_pk_bf16_f32 v101, v42, v43
    v_cvt_pk_bf16_f32 v102, v44, v45
    v_cvt_pk_bf16_f32 v103, v46, v47
    buffer_store_dwordx4 v[96:99], v240, s[44:47], s9 offen sc1
    buffer_store_dwordx4 v[100:103], v241, s[44:47], s9 offen sc1
    v_pk_mul_f32 v[160:161], v[48:49], v[48:49]
    v_pk_mul_f32 v[162:163], v[50:51], v[50:51]
    v_pk_mul_f32 v[164:165], v[52:53], v[52:53]
    v_pk_mul_f32 v[166:167], v[54:55], v[54:55]
    v_pk_mul_f32 v[168:169], v[56:57], v[56:57]
    v_pk_mul_f32 v[170:171], v[58:59], v[58:59]
    v_pk_mul_f32 v[172:173], v[60:61], v[60:61]
    v_pk_mul_f32 v[174:175], v[62:63], v[62:63]
    v_pk_fma_f32 v[160:161], v[160:161], s[10:11], v[88:89] op_sel_hi:[1,0,0]
    v_pk_fma_f32 v[162:163], v[162:163], s[10:11], v[88:89] op_sel_hi:[1,0,0]
    v_pk_fma_f32 v[164:165], v[164:165], s[10:11], v[88:89] op_sel_hi:[1,0,0]
    v_pk_fma_f32 v[166:167], v[166:167], s[10:11], v[88:89] op_sel_hi:[1,0,0]
    v_pk_fma_f32 v[168:169], v[168:169], s[10:11], v[88:89] op_sel_hi:[1,0,0]
    v_pk_fma_f32 v[170:171], v[170:171], s[10:11], v[88:89] op_sel_hi:[1,0,0]
    v_pk_fma_f32 v[172:173], v[172:173], s[10:11], v[88:89] op_sel_hi:[1,0,0]
    v_pk_fma_f32 v[174:175], v[174:175], s[10:11], v[88:89] op_sel_hi:[1,0,0]
    v_pk_mul_f32 v[160:161], v[160:161], v[48:49]
    v_pk_mul_f32 v[162:163], v[162:163], v[50:51]
    v_pk_mul_f32 v[164:165], v[164:165], v[52:53]
    v_pk_mul_f32 v[166:167], v[166:167], v[54:55]
    v_pk_mul_f32 v[168:169], v[168:169], v[56:57]
    v_pk_mul_f32 v[170:171], v[170:171], v[58:59]
    v_pk_mul_f32 v[172:173], v[172:173], v[60:61]
    v_pk_mul_f32 v[174:175], v[174:175], v[62:63]
    v_exp_f32 v160, v160
    v_exp_f32 v161, v161
    v_exp_f32 v162, v162
    v_exp_f32 v163, v163
    v_exp_f32 v164, v164
    v_exp_f32 v165, v165
    v_exp_f32 v166, v166
    v_exp_f32 v167, v167
    v_exp_f32 v168, v168
    v_exp_f32 v169, v169
    v_exp_f32 v170, v170
    v_exp_f32 v171, v171
    v_exp_f32 v172, v172
    v_exp_f32 v173, v173
    v_exp_f32 v174, v174
    v_exp_f32 v175, v175
    v_pk_add_f32 v[160:161], v[160:161], 1.0 op_sel_hi:[1,0]
    v_pk_add_f32 v[162:163], v[162:163], 1.0 op_sel_hi:[1,0]
    v_pk_add_f32 v[164:165], v[164:165], 1.0 op_sel_hi:[1,0]
    v_pk_add_f32 v[166:167], v[166:167], 1.0 op_sel_hi:[1,0]
    v_pk_add_f32 v[168:169], v[168:169], 1.0 op_sel_hi:[1,0]
    v_pk_add_f32 v[170:171], v[170:171], 1.0 op_sel_hi:[1,0]
    v_pk_add_f32 v[172:173], v[172:173], 1.0 op_sel_hi:[1,0]
    v_pk_add_f32 v[174:175], v[174:175], 1.0 op_sel_hi:[1,0]
    v_rcp_f32 v160, v160
    v_rcp_f32 v161, v161
    v_rcp_f32 v162, v162
    v_rcp_f32 v163, v163
    v_rcp_f32 v164, v164
    v_rcp_f32 v165, v165
    v_rcp_f32 v166, v166
    v_rcp_f32 v167, v167
    v_rcp_f32 v168, v168
    v_rcp_f32 v169, v169
    v_rcp_f32 v170, v170
    v_rcp_f32 v171, v171
    v_rcp_f32 v172, v172
    v_rcp_f32 v173, v173
    v_rcp_f32 v174, v174
    v_rcp_f32 v175, v175
    v_pk_mul_f32 v[48:49], v[48:49], v[160:161]
    v_pk_mul_f32 v[50:51], v[50:51], v[162:163]
    v_pk_mul_f32 v[52:53], v[52:53], v[164:165]
    v_pk_mul_f32 v[54:55], v[54:55], v[166:167]
    v_pk_mul_f32 v[56:57], v[56:57], v[168:169]
    v_pk_mul_f32 v[58:59], v[58:59], v[170:171]
    v_pk_mul_f32 v[60:61], v[60:61], v[172:173]
    v_pk_mul_f32 v[62:63], v[62:63], v[174:175]
    v_cvt_pk_bf16_f32 v104, v48, v49
    v_cvt_pk_bf16_f32 v105, v50, v51
    v_cvt_pk_bf16_f32 v106, v52, v53
    v_cvt_pk_bf16_f32 v107, v54, v55
    v_cvt_pk_bf16_f32 v108, v56, v57
    v_cvt_pk_bf16_f32 v109, v58, v59
    v_cvt_pk_bf16_f32 v110, v60, v61
    v_cvt_pk_bf16_f32 v111, v62, v63
    buffer_store_dwordx4 v[104:107], v242, s[44:47], s9 offen sc1
    buffer_store_dwordx4 v[108:111], v243, s[44:47], s9 offen sc1
    v_pk_mul_f32 v[160:161], v[64:65], v[64:65]
    v_pk_mul_f32 v[162:163], v[66:67], v[66:67]
    v_pk_mul_f32 v[164:165], v[68:69], v[68:69]
    v_pk_mul_f32 v[166:167], v[70:71], v[70:71]
    v_pk_mul_f32 v[168:169], v[72:73], v[72:73]
    v_pk_mul_f32 v[170:171], v[74:75], v[74:75]
    v_pk_mul_f32 v[172:173], v[76:77], v[76:77]
    v_pk_mul_f32 v[174:175], v[78:79], v[78:79]
    v_pk_fma_f32 v[160:161], v[160:161], s[10:11], v[88:89] op_sel_hi:[1,0,0]
    v_pk_fma_f32 v[162:163], v[162:163], s[10:11], v[88:89] op_sel_hi:[1,0,0]
    v_pk_fma_f32 v[164:165], v[164:165], s[10:11], v[88:89] op_sel_hi:[1,0,0]
    v_pk_fma_f32 v[166:167], v[166:167], s[10:11], v[88:89] op_sel_hi:[1,0,0]
    v_pk_fma_f32 v[168:169], v[168:169], s[10:11], v[88:89] op_sel_hi:[1,0,0]
    v_pk_fma_f32 v[170:171], v[170:171], s[10:11], v[88:89] op_sel_hi:[1,0,0]
    v_pk_fma_f32 v[172:173], v[172:173], s[10:11], v[88:89] op_sel_hi:[1,0,0]
    v_pk_fma_f32 v[174:175], v[174:175], s[10:11], v[88:89] op_sel_hi:[1,0,0]
    v_pk_mul_f32 v[160:161], v[160:161], v[64:65]
    v_pk_mul_f32 v[162:163], v[162:163], v[66:67]
    v_pk_mul_f32 v[164:165], v[164:165], v[68:69]
    v_pk_mul_f32 v[166:167], v[166:167], v[70:71]
    v_pk_mul_f32 v[168:169], v[168:169], v[72:73]
    v_pk_mul_f32 v[170:171], v[170:171], v[74:75]
    v_pk_mul_f32 v[172:173], v[172:173], v[76:77]
    v_pk_mul_f32 v[174:175], v[174:175], v[78:79]
    v_exp_f32 v160, v160
    v_exp_f32 v161, v161
    v_exp_f32 v162, v162
    v_exp_f32 v163, v163
    v_exp_f32 v164, v164
    v_exp_f32 v165, v165
    v_exp_f32 v166, v166
    v_exp_f32 v167, v167
    v_exp_f32 v168, v168
    v_exp_f32 v169, v169
    v_exp_f32 v170, v170
    v_exp_f32 v171, v171
    v_exp_f32 v172, v172
    v_exp_f32 v173, v173
    v_exp_f32 v174, v174
    v_exp_f32 v175, v175
    v_pk_add_f32 v[160:161], v[160:161], 1.0 op_sel_hi:[1,0]
    v_pk_add_f32 v[162:163], v[162:163], 1.0 op_sel_hi:[1,0]
    v_pk_add_f32 v[164:165], v[164:165], 1.0 op_sel_hi:[1,0]
    v_pk_add_f32 v[166:167], v[166:167], 1.0 op_sel_hi:[1,0]
    v_pk_add_f32 v[168:169], v[168:169], 1.0 op_sel_hi:[1,0]
    v_pk_add_f32 v[170:171], v[170:171], 1.0 op_sel_hi:[1,0]
    v_pk_add_f32 v[172:173], v[172:173], 1.0 op_sel_hi:[1,0]
    v_pk_add_f32 v[174:175], v[174:175], 1.0 op_sel_hi:[1,0]
    v_rcp_f32 v160, v160
    v_rcp_f32 v161, v161
    v_rcp_f32 v162, v162
    v_rcp_f32 v163, v163
    v_rcp_f32 v164, v164
    v_rcp_f32 v165, v165
    v_rcp_f32 v166, v166
    v_rcp_f32 v167, v167
    v_rcp_f32 v168, v168
    v_rcp_f32 v169, v169
    v_rcp_f32 v170, v170
    v_rcp_f32 v171, v171
    v_rcp_f32 v172, v172
    v_rcp_f32 v173, v173
    v_rcp_f32 v174, v174
    v_rcp_f32 v175, v175
    v_pk_mul_f32 v[64:65], v[64:65], v[160:161]
    v_pk_mul_f32 v[66:67], v[66:67], v[162:163]
    v_pk_mul_f32 v[68:69], v[68:69], v[164:165]
    v_pk_mul_f32 v[70:71], v[70:71], v[166:167]
    v_pk_mul_f32 v[72:73], v[72:73], v[168:169]
    v_pk_mul_f32 v[74:75], v[74:75], v[170:171]
    v_pk_mul_f32 v[76:77], v[76:77], v[172:173]
    v_pk_mul_f32 v[78:79], v[78:79], v[174:175]
    v_cvt_pk_bf16_f32 v112, v64, v65
    v_cvt_pk_bf16_f32 v113, v66, v67
    v_cvt_pk_bf16_f32 v114, v68, v69
    v_cvt_pk_bf16_f32 v115, v70, v71
    v_cvt_pk_bf16_f32 v116, v72, v73
    v_cvt_pk_bf16_f32 v117, v74, v75
    v_cvt_pk_bf16_f32 v118, v76, v77
    v_cvt_pk_bf16_f32 v119, v78, v79
    buffer_store_dwordx4 v[112:115], v244, s[44:47], s9 offen sc1
    buffer_store_dwordx4 v[116:119], v245, s[44:47], s9 offen sc1
    s_waitcnt vmcnt(0)
    s_barrier
    buffer_store_dword v249, v17, s[44:47], 0 offen sc1
    s_add_u32 m0, s73, 81920
L_pl_G_5:
    s_cbranch_execz L_wret
    s_lshl_b32 s14, s93, 17
    buffer_load_dwordx4 v4, s[52:55], s14 offen offset:0 lds
    buffer_load_dwordx4 v5, s[52:55], s14 offen offset:1024 lds
    buffer_load_dwordx4 v6, s[52:55], s14 offen offset:2048 lds
    buffer_load_dwordx4 v7, s[52:55], s14 offen offset:3072 lds
    s_add_u32 m0, s73, 98304
    s_lshl_b32 s14, s94, 17
    buffer_load_dwordx4 v4, s[52:55], s14 offen offset:0 lds
    buffer_load_dwordx4 v5, s[52:55], s14 offen offset:1024 lds
    buffer_load_dwordx4 v6, s[52:55], s14 offen offset:2048 lds
    buffer_load_dwordx4 v7, s[52:55], s14 offen offset:3072 lds
    s_add_u32 m0, s73, 114688
    s_lshl_b32 s14, s95, 17
    buffer_load_dwordx4 v4, s[52:55], s14 offen offset:0 lds
    buffer_load_dwordx4 v5, s[52:55], s14 offen offset:1024 lds
    buffer_load_dwordx4 v6, s[52:55], s14 offen offset:2048 lds
    buffer_load_dwordx4 v7, s[52:55], s14 offen offset:3072 lds
    s_add_u32 m0, s73, 147456
    s_lshl_b32 s14, s96, 17
    buffer_load_dwordx4 v4, s[52:55], s14 offen offset:0 lds
    buffer_load_dwordx4 v5, s[52:55], s14 offen offset:1024 lds
    buffer_load_dwordx4 v6, s[52:55], s14 offen offset:2048 lds
    buffer_load_dwordx4 v7, s[52:55], s14 offen offset:3072 lds
    s_add_u32 m0, s73, 32768
    s_lshl_b32 s14, s97, 17
    buffer_load_dwordx4 v4, s[52:55], s14 offen offset:0 lds
    buffer_load_dwordx4 v5, s[52:55], s14 offen offset:1024 lds
    buffer_load_dwordx4 v6, s[52:55], s14 offen offset:2048 lds
    buffer_load_dwordx4 v7, s[52:55], s14 offen offset:3072 lds
    ds_read_b64_tr_b16 a[64:65], v10 offset:49152
    ds_read_b64_tr_b16 a[66:67], v10 offset:51200
    ds_read_b64_tr_b16 a[68:69], v11 offset:49152
    ds_read_b64_tr_b16 a[70:71], v11 offset:51200
    ds_read_b64_tr_b16 a[72:73], v12 offset:49152
    ds_read_b64_tr_b16 a[74:75], v12 offset:51200
    ds_read_b64_tr_b16 a[76:77], v13 offset:49152
    ds_read_b64_tr_b16 a[78:79], v13 offset:51200
    s_waitcnt lgkmcnt(0)
    v_add_u32 v10, 65536, v10
    ds_read_b64_tr_b16 a[80:81], v10 offset:0
    s_add_u32 m0, s73, 49152
    s_lshl_b32 s14, s98, 17
    ds_read_b64_tr_b16 a[82:83], v10 offset:2048
    buffer_load_dwordx4 v4, s[52:55], s14 offen offset:0 lds
    v_add_u32 v11, 65536, v11
    ds_read_b64_tr_b16 a[84:85], v11 offset:0
    ds_read_b64_tr_b16 a[86:87], v11 offset:2048
    buffer_load_dwordx4 v5, s[52:55], s14 offen offset:1024 lds
    v_add_u32 v12, 65536, v12
    ds_read_b64_tr_b16 a[88:89], v12 offset:0
    buffer_load_dwordx4 v6, s[52:55], s14 offen offset:2048 lds
    ds_read_b64_tr_b16 a[90:91], v12 offset:2048
    v_add_u32 v13, 65536, v13
    ds_read_b64_tr_b16 a[92:93], v13 offset:0
    buffer_load_dwordx4 v7, s[52:55], s14 offen offset:3072 lds
    ds_read_b64_tr_b16 a[94:95], v13 offset:2048
    s_waitcnt lgkmcnt(0)
    v_add_u32 v10, -65536, v10
    ds_read_b64_tr_b16 a[96:97], v10 offset:0
    s_add_u32 m0, s73, 65536
    s_lshl_b32 s14, s99, 17
    ds_read_b64_tr_b16 a[98:99], v10 offset:2048
    buffer_load_dwordx4 v4, s[52:55], s14 offen offset:0 lds
    v_add_u32 v11, -65536, v11
    ds_read_b64_tr_b16 a[100:101], v11 offset:0
    ds_read_b64_tr_b16 a[102:103], v11 offset:2048
    buffer_load_dwordx4 v5, s[52:55], s14 offen offset:1024 lds
    v_add_u32 v12, -65536, v12
    ds_read_b64_tr_b16 a[104:105], v12 offset:0
    buffer_load_dwordx4 v6, s[52:55], s14 offen offset:2048 lds
    ds_read_b64_tr_b16 a[106:107], v12 offset:2048
    v_add_u32 v13, -65536, v13
    ds_read_b64_tr_b16 a[108:109], v13 offset:0
    buffer_load_dwordx4 v7, s[52:55], s14 offen offset:3072 lds
    ds_read_b64_tr_b16 a[110:111], v13 offset:2048
    s_waitcnt lgkmcnt(0)
    ds_read_b64_tr_b16 a[112:113], v10 offset:16384
    s_add_u32 m0, s73, 0
    s_lshl_b32 s14, s100, 17
    ds_read_b64_tr_b16 a[114:115], v10 offset:18432
    buffer_load_dwordx4 v4, s[52:55], s14 offen offset:0 lds
    ds_read_b64_tr_b16 a[116:117], v11 offset:16384
    ds_read_b64_tr_b16 a[118:119], v11 offset:18432
    buffer_load_dwordx4 v5, s[52:55], s14 offen offset:1024 lds
    ds_read_b64_tr_b16 a[120:121], v12 offset:16384
    buffer_load_dwordx4 v6, s[52:55], s14 offen offset:2048 lds
    ds_read_b64_tr_b16 a[122:123], v12 offset:18432
    ds_read_b64_tr_b16 a[124:125], v13 offset:16384
    buffer_load_dwordx4 v7, s[52:55], s14 offen offset:3072 lds
    ds_read_b64_tr_b16 a[126:127], v13 offset:18432
    s_waitcnt lgkmcnt(0)
    v_add_u32 v10, 131072, v10
    ds_read_b64_tr_b16 a[128:129], v10 offset:0
    s_add_u32 m0, s73, 16384
    s_lshl_b32 s14, s101, 17
    ds_read_b64_tr_b16 a[130:131], v10 offset:2048
    buffer_load_dwordx4 v4, s[52:55], s14 offen offset:0 lds
    v_add_u32 v11, 131072, v11
    ds_read_b64_tr_b16 a[132:133], v11 offset:0
    ds_read_b64_tr_b16 a[134:135], v11 offset:2048
    buffer_load_dwordx4 v5, s[52:55], s14 offen offset:1024 lds
    v_add_u32 v12, 131072, v12
    ds_read_b64_tr_b16 a[136:137], v12 offset:0
    buffer_load_dwordx4 v6, s[52:55], s14 offen offset:2048 lds
    ds_read_b64_tr_b16 a[138:139], v12 offset:2048
    v_add_u32 v13, 131072, v13
    ds_read_b64_tr_b16 a[140:141], v13 offset:0
    buffer_load_dwordx4 v7, s[52:55], s14 offen offset:3072 lds
    ds_read_b64_tr_b16 a[142:143], v13 offset:2048
    s_waitcnt vmcnt(32)
    v_add_u32 v10, -65536, v10
    ds_read_b64_tr_b16 a[144:145], v10 offset:16384
    ds_read_b64_tr_b16 a[146:147], v10 offset:18432
    v_add_u32 v11, -65536, v11
    ds_read_b64_tr_b16 a[148:149], v11 offset:16384
    ds_read_b64_tr_b16 a[150:151], v11 offset:18432
    v_add_u32 v12, -65536, v12
    ds_read_b64_tr_b16 a[152:153], v12 offset:16384
    ds_read_b64_tr_b16 a[154:155], v12 offset:18432
    v_add_u32 v13, -65536, v13
    ds_read_b64_tr_b16 a[156:157], v13 offset:16384
    ds_read_b64_tr_b16 a[158:159], v13 offset:18432
    s_waitcnt vmcnt(28)
    ds_read_b64_tr_b16 a[160:161], v10 offset:32768
    ds_read_b64_tr_b16 a[162:163], v10 offset:34816
    ds_read_b64_tr_b16 a[164:165], v11 offset:32768
    ds_read_b64_tr_b16 a[166:167], v11 offset:34816
    ds_read_b64_tr_b16 a[168:169], v12 offset:32768
    ds_read_b64_tr_b16 a[170:171], v12 offset:34816
    ds_read_b64_tr_b16 a[172:173], v13 offset:32768
    ds_read_b64_tr_b16 a[174:175], v13 offset:34816
    s_waitcnt vmcnt(24)
    ds_read_b64_tr_b16 a[176:177], v10 offset:49152
    ds_read_b64_tr_b16 a[178:179], v10 offset:51200
    ds_read_b64_tr_b16 a[180:181], v11 offset:49152
    ds_read_b64_tr_b16 a[182:183], v11 offset:51200
    ds_read_b64_tr_b16 a[184:185], v12 offset:49152
    ds_read_b64_tr_b16 a[186:187], v12 offset:51200
    ds_read_b64_tr_b16 a[188:189], v13 offset:49152
    ds_read_b64_tr_b16 a[190:191], v13 offset:51200
    s_waitcnt vmcnt(20)
    v_add_u32 v10, 65536, v10
    ds_read_b64_tr_b16 a[192:193], v10 offset:16384
    ds_read_b64_tr_b16 a[194:195], v10 offset:18432
    v_add_u32 v11, 65536, v11
    ds_read_b64_tr_b16 a[196:197], v11 offset:16384
    ds_read_b64_tr_b16 a[198:199], v11 offset:18432
    v_add_u32 v12, 65536, v12
    ds_read_b64_tr_b16 a[200:201], v12 offset:16384
    ds_read_b64_tr_b16 a[202:203], v12 offset:18432
    v_add_u32 v13, 65536, v13
    ds_read_b64_tr_b16 a[204:205], v13 offset:16384
    ds_read_b64_tr_b16 a[206:207], v13 offset:18432
    buffer_load_dword v19, v18, s[44:47], 0 offen sc1
    s_waitcnt vmcnt(17)
    v_add_u32 v10, -131072, v10
    ds_read_b64_tr_b16 a[208:209], v10 offset:32768
    ds_read_b64_tr_b16 a[210:211], v10 offset:34816
    v_add_u32 v11, -131072, v11
    ds_read_b64_tr_b16 a[212:213], v11 offset:32768
    ds_read_b64_tr_b16 a[214:215], v11 offset:34816
    v_add_u32 v12, -131072, v12
    ds_read_b64_tr_b16 a[216:217], v12 offset:32768
    ds_read_b64_tr_b16 a[218:219], v12 offset:34816
    v_add_u32 v13, -131072, v13
    ds_read_b64_tr_b16 a[220:221], v13 offset:32768
    ds_read_b64_tr_b16 a[222:223], v13 offset:34816
    s_waitcnt lgkmcnt(0)
L_DG:
    s_mov_b32 s8, 12386304
    s_lshl_b32 s7, s71, 6
    s_lshl_b32 s4, s3, 4
    s_add_u32 s7, s7, s4
    s_mul_i32 s7, s7, 1152
    s_mul_i32 s4, s72, 144
    s_add_u32 s7, s7, s4
    s_add_u32 m0, s73, 131072
    s_nop 0
    buffer_load_dwordx4 v14, s[56:59], s7 offen offset:0 lds
    buffer_load_dwordx4 v15, s[56:59], s7 offen offset:1024 lds
    buffer_load_dwordx4 v16, s[56:59], s7 offen offset:2048 lds
    buffer_load_dwordx2 v[26:27], v26, s[44:47], s8 offen sc1
    s_mul_i32 s84, s84, 69632
    s_mul_i32 s85, s85, 69632
    s_mul_i32 s86, s86, 69632
    s_mul_i32 s87, s87, 69632
    s_mul_i32 s88, s88, 69632
    s_mul_i32 s89, s89, 69632
    s_mul_i32 s90, s90, 69632
    s_mul_i32 s91, s91, 69632
    s_mul_i32 s92, s92, 69632
    s_mul_i32 s93, s93, 69632
    s_mul_i32 s94, s94, 69632
    s_mul_i32 s95, s95, 69632
    s_mul_i32 s96, s96, 69632
    s_mul_i32 s97, s97, 69632
    s_mul_i32 s98, s98, 69632
    s_mul_i32 s99, s99, 69632
    s_mul_i32 s100, s100, 69632
    s_mul_i32 s101, s101, 69632
    s_waitcnt vmcnt(4)
    v_cmp_ne_u32 vcc, s68, v19
    s_cbranch_vccnz L_rs_p2G
L_ok_p2G:
    buffer_load_dwordx4 v[140:143], v8, s[44:47], s84 offen offset:0 sc1
    buffer_load_dwordx4 v[144:147], v8, s[44:47], s85 offen offset:0 sc1
    buffer_load_dwordx4 v[148:151], v8, s[44:47], s84 offen offset:512 sc1
    buffer_load_dwordx4 v[152:155], v8, s[44:47], s85 offen offset:512 sc1
    buffer_load_dwordx4 v[156:159], v8, s[44:47], s84 offen offset:768 sc1
    buffer_load_dwordx4 v[160:163], v8, s[44:47], s85 offen offset:768 sc1
    buffer_load_dwordx4 v[164:167], v8, s[44:47], s84 offen offset:1024 sc1
    buffer_load_dwordx4 v[168:171], v8, s[44:47], s85 offen offset:1024 sc1
    buffer_load_dwordx4 v[172:175], v9, s[44:47], s84 offen offset:1536 sc1
    buffer_load_dwordx4 v[176:179], v9, s[44:47], s85 offen offset:1536 sc1
    buffer_load_dwordx4 v[180:183], v8, s[44:47], s86 offen offset:0 sc1
    buffer_load_dwordx4 v[184:187], v8, s[44:47], s87 offen offset:0 sc1
    buffer_load_dwordx4 v[188:191], v8, s[44:47], s86 offen offset:512 sc1
    buffer_load_dwordx4 v[192:195], v8, s[44:47], s87 offen offset:512 sc1
    buffer_load_dwordx4 v[196:199], v8, s[44:47], s86 offen offset:768 sc1
    buffer_load_dwordx4 v[200:203], v8, s[44:47], s87 offen offset:768 sc1
    buffer_load_dwordx4 v[204:207], v8, s[44:47], s86 offen offset:1024 sc1
    buffer_load_dwordx4 v[208:211], v8, s[44:47], s87 offen offset:1024 sc1
    s_waitcnt vmcnt(16)
    v_mfma_f32_16x16x32_bf16 v[52:55], v[140:143], a[4:7], 0
    v_mfma_f32_16x16x32_bf16 v[52:55], v[144:147], a[20:23], v[52:55]
    buffer_load_dwordx4 v[212:215], v9, s[44:47], s86 offen offset:1536 sc1
    v_mfma_f32_16x16x32_bf16 v[56:59], v[144:147], a[24:27], 0
    v_mfma_f32_16x16x32_bf16 v[56:59], v[140:143], a[8:11], v[56:59]
    v_mfma_f32_16x16x32_bf16 v[60:63], v[140:143], a[12:15], 0
    buffer_load_dwordx4 v[216:219], v9, s[44:47], s87 offen offset:1536 sc1
    v_mfma_f32_16x16x32_bf16 v[60:63], v[144:147], a[28:31], v[60:63]
    v_mfma_f32_16x16x32_bf16 v[32:35], v[144:147], a[16:19], 0
    v_mfma_f32_16x16x32_bf16 v[32:35], v[140:143], a[0:3], v[32:35]
    s_waitcnt vmcnt(16)
    v_mfma_f32_16x16x32_bf16 v[36:39], v[148:151], a[0:3], 0
    v_mfma_f32_16x16x32_bf16 v[36:39], v[152:155], a[16:19], v[36:39]
    buffer_load_dwordx4 v[140:143], v8, s[44:47], s88 offen offset:0 sc1
    v_mfma_f32_16x16x32_bf16 v[72:75], v[152:155], a[28:31], 0
    v_mfma_f32_16x16x32_bf16 v[72:75], v[148:151], a[12:15], v[72:75]
    v_mfma_f32_16x16x32_bf16 v[68:71], v[148:151], a[8:11], 0
    buffer_load_dwordx4 v[144:147], v8, s[44:47], s89 offen offset:0 sc1
    v_mfma_f32_16x16x32_bf16 v[68:71], v[152:155], a[24:27], v[68:71]
    v_mfma_f32_16x16x32_bf16 v[64:67], v[152:155], a[20:23], 0
    v_mfma_f32_16x16x32_bf16 v[64:67], v[148:151], a[4:7], v[64:67]
    s_waitcnt vmcnt(16)
    v_mfma_f32_16x16x32_bf16 v[76:79], v[156:159], a[4:7], 0
    v_mfma_f32_16x16x32_bf16 v[76:79], v[160:163], a[20:23], v[76:79]
    buffer_load_dwordx4 v[148:151], v8, s[44:47], s88 offen offset:512 sc1
    v_mfma_f32_16x16x32_bf16 v[80:83], v[160:163], a[24:27], 0
    v_mfma_f32_16x16x32_bf16 v[80:83], v[156:159], a[8:11], v[80:83]
    v_mfma_f32_16x16x32_bf16 v[84:87], v[156:159], a[12:15], 0
    buffer_load_dwordx4 v[152:155], v8, s[44:47], s89 offen offset:512 sc1
    v_mfma_f32_16x16x32_bf16 v[84:87], v[160:163], a[28:31], v[84:87]
    s_xor_b32 s7, s3, 1
    s_lshl_b32 s7, s7, 14
    v_mfma_f32_16x16x32_bf16 v[40:43], v[160:163], a[16:19], 0
    v_mfma_f32_16x16x32_bf16 v[40:43], v[156:159], a[0:3], v[40:43]
    s_waitcnt vmcnt(16)
    v_mfma_f32_16x16x32_bf16 v[44:47], v[164:167], a[0:3], 0
    s_add_u32 s7, s7, 0
    v_lshl_add_u32 v4, v2, 4, s7
    v_mfma_f32_16x16x32_bf16 v[44:47], v[168:171], a[16:19], v[44:47]
    buffer_load_dwordx4 v[156:159], v8, s[44:47], s88 offen offset:768 sc1
    v_mfma_f32_16x16x32_bf16 v[96:99], v[168:171], a[28:31], 0
    v_mfma_f32_16x16x32_bf16 v[96:99], v[164:167], a[12:15], v[96:99]
    s_xor_b32 s7, s3, 2
    s_lshl_b32 s7, s7, 14
    v_mfma_f32_16x16x32_bf16 v[92:95], v[164:167], a[8:11], 0
    buffer_load_dwordx4 v[160:163], v8, s[44:47], s89 offen offset:768 sc1
    v_mfma_f32_16x16x32_bf16 v[92:95], v[168:171], a[24:27], v[92:95]
    v_mfma_f32_16x16x32_bf16 v[88:91], v[168:171], a[20:23], 0
    s_add_u32 s7, s7, 5120
    v_lshl_add_u32 v5, v2, 4, s7
    v_mfma_f32_16x16x32_bf16 v[88:91], v[164:167], a[4:7], v[88:91]
    s_waitcnt vmcnt(16)
    v_mfma_f32_16x16x32_bf16 v[100:103], v[172:175], a[4:7], 0
    s_xor_b32 s7, s3, 3
    s_lshl_b32 s7, s7, 14
    v_mfma_f32_16x16x32_bf16 v[100:103], v[176:179], a[20:23], v[100:103]
    buffer_load_dwordx4 v[164:167], v8, s[44:47], s88 offen offset:1024 sc1
    v_mfma_f32_16x16x32_bf16 v[104:107], v[176:179], a[24:27], 0
    v_mfma_f32_16x16x32_bf16 v[104:107], v[172:175], a[8:11], v[104:107]
    s_add_u32 s7, s7, 10240
    v_lshl_add_u32 v6, v2, 4, s7
    v_mfma_f32_16x16x32_bf16 v[108:111], v[172:175], a[12:15], 0
    buffer_load_dwordx4 v[168:171], v8, s[44:47], s89 offen offset:1024 sc1
    v_mfma_f32_16x16x32_bf16 v[108:111], v[176:179], a[28:31], v[108:111]
    v_mfma_f32_16x16x32_bf16 v[48:51], v[176:179], a[16:19], 0
    s_lshl_b32 s7, s3, 14
    v_lshl_add_u32 v7, v2, 4, s7
    v_mfma_f32_16x16x32_bf16 v[48:51], v[172:175], a[0:3], v[48:51]
    s_waitcnt vmcnt(16)
    v_mfma_f32_16x16x32_bf16 v[32:35], v[180:183], a[32:35], v[32:35]
    v_mfma_f32_16x16x32_bf16 v[32:35], v[184:187], a[48:51], v[32:35]
    buffer_load_dwordx4 v[172:175], v9, s[44:47], s88 offen offset:1536 sc1
    v_mfma_f32_16x16x32_bf16 v[60:63], v[184:187], a[60:63], v[60:63]
    v_lshlrev_b32 v30, 16, v30
    v_mfma_f32_16x16x32_bf16 v[60:63], v[180:183], a[44:47], v[60:63]
    v_mfma_f32_16x16x32_bf16 v[56:59], v[180:183], a[40:43], v[56:59]
    buffer_load_dwordx4 v[176:179], v9, s[44:47], s89 offen offset:1536 sc1
    v_mfma_f32_16x16x32_bf16 v[56:59], v[184:187], a[56:59], v[56:59]
    v_mfma_f32_16x16x32_bf16 v[52:55], v[184:187], a[52:55], v[52:55]
    v_mov_b32 v112, v30
    v_mfma_f32_16x16x32_bf16 v[52:55], v[180:183], a[36:39], v[52:55]
    s_waitcnt vmcnt(16)
    v_mfma_f32_16x16x32_bf16 v[64:67], v[188:191], a[36:39], v[64:67]
    v_mfma_f32_16x16x32_bf16 v[64:67], v[192:195], a[52:55], v[64:67]
    buffer_load_dwordx4 v[180:183], v8, s[44:47], s90 offen offset:0 sc1
    v_mfma_f32_16x16x32_bf16 v[68:71], v[192:195], a[56:59], v[68:71]
    v_mov_b32 v113, v30
    v_mfma_f32_16x16x32_bf16 v[68:71], v[188:191], a[40:43], v[68:71]
    v_mfma_f32_16x16x32_bf16 v[72:75], v[188:191], a[44:47], v[72:75]
    buffer_load_dwordx4 v[184:187], v8, s[44:47], s91 offen offset:0 sc1
    v_mfma_f32_16x16x32_bf16 v[72:75], v[192:195], a[60:63], v[72:75]
    v_mfma_f32_16x16x32_bf16 v[36:39], v[192:195], a[48:51], v[36:39]
    v_mov_b32 v114, v30
    v_mfma_f32_16x16x32_bf16 v[36:39], v[188:191], a[32:35], v[36:39]
    s_waitcnt vmcnt(16)
    v_mfma_f32_16x16x32_bf16 v[40:43], v[196:199], a[32:35], v[40:43]
    v_mfma_f32_16x16x32_bf16 v[40:43], v[200:203], a[48:51], v[40:43]
    buffer_load_dwordx4 v[188:191], v8, s[44:47], s90 offen offset:512 sc1
    v_mfma_f32_16x16x32_bf16 v[84:87], v[200:203], a[60:63], v[84:87]
    v_mov_b32 v115, v30
    v_mfma_f32_16x16x32_bf16 v[84:87], v[196:199], a[44:47], v[84:87]
    v_mfma_f32_16x16x32_bf16 v[80:83], v[196:199], a[40:43], v[80:83]
    buffer_load_dwordx4 v[192:195], v8, s[44:47], s91 offen offset:512 sc1
    v_mfma_f32_16x16x32_bf16 v[80:83], v[200:203], a[56:59], v[80:83]
    v_mfma_f32_16x16x32_bf16 v[76:79], v[200:203], a[52:55], v[76:79]
    v_mfma_f32_16x16x32_bf16 v[76:79], v[196:199], a[36:39], v[76:79]
    s_waitcnt vmcnt(16)
    v_mfma_f32_16x16x32_bf16 v[88:91], v[204:207], a[36:39], v[88:91]
    v_mfma_f32_16x16x32_bf16 v[88:91], v[208:211], a[52:55], v[88:91]
    buffer_load_dwordx4 v[196:199], v8, s[44:47], s90 offen offset:768 sc1
    v_mfma_f32_16x16x32_bf16 v[92:95], v[208:211], a[56:59], v[92:95]
    ds_read_b64_tr_b16 a[224:225], v10 offset:49152
    v_mfma_f32_16x16x32_bf16 v[92:95], v[204:207], a[40:43], v[92:95]
    v_mfma_f32_16x16x32_bf16 v[96:99], v[204:207], a[44:47], v[96:99]
    buffer_load_dwordx4 v[200:203], v8, s[44:47], s91 offen offset:768 sc1
    v_mfma_f32_16x16x32_bf16 v[96:99], v[208:211], a[60:63], v[96:99]
    v_mfma_f32_16x16x32_bf16 v[44:47], v[208:211], a[48:51], v[44:47]
    ds_read_b64_tr_b16 a[226:227], v10 offset:51200
    v_mfma_f32_16x16x32_bf16 v[44:47], v[204:207], a[32:35], v[44:47]
    s_waitcnt vmcnt(16)
    v_mfma_f32_16x16x32_bf16 v[48:51], v[212:215], a[32:35], v[48:51]
    v_mfma_f32_16x16x32_bf16 v[48:51], v[216:219], a[48:51], v[48:51]
    buffer_load_dwordx4 v[204:207], v8, s[44:47], s90 offen offset:1024 sc1
    v_mfma_f32_16x16x32_bf16 v[108:111], v[216:219], a[60:63], v[108:111]
    ds_read_b64_tr_b16 a[228:229], v11 offset:49152
    v_mfma_f32_16x16x32_bf16 v[108:111], v[212:215], a[44:47], v[108:111]
    v_mfma_f32_16x16x32_bf16 v[104:107], v[212:215], a[40:43], v[104:107]
    buffer_load_dwordx4 v[208:211], v8, s[44:47], s91 offen offset:1024 sc1
    v_mfma_f32_16x16x32_bf16 v[104:107], v[216:219], a[56:59], v[104:107]
    v_mfma_f32_16x16x32_bf16 v[100:103], v[216:219], a[52:55], v[100:103]
    ds_read_b64_tr_b16 a[230:231], v11 offset:51200
    v_mfma_f32_16x16x32_bf16 v[100:103], v[212:215], a[36:39], v[100:103]
    s_waitcnt vmcnt(16)
    v_mfma_f32_16x16x32_bf16 v[52:55], v[140:143], a[68:71], v[52:55]
    v_mfma_f32_16x16x32_bf16 v[52:55], v[144:147], a[84:87], v[52:55]
    buffer_load_dwordx4 v[212:215], v9, s[44:47], s90 offen offset:1536 sc1
    v_mfma_f32_16x16x32_bf16 v[56:59], v[144:147], a[88:91], v[56:59]
    ds_read_b64_tr_b16 a[232:233], v12 offset:49152
    v_mfma_f32_16x16x32_bf16 v[56:59], v[140:143], a[72:75], v[56:59]
    v_mfma_f32_16x16x32_bf16 v[60:63], v[140:143], a[76:79], v[60:63]
    buffer_load_dwordx4 v[216:219], v9, s[44:47], s91 offen offset:1536 sc1
    v_mfma_f32_16x16x32_bf16 v[60:63], v[144:147], a[92:95], v[60:63]
    ds_read_b64_tr_b16 a[234:235], v12 offset:51200
    v_mfma_f32_16x16x32_bf16 v[32:35], v[144:147], a[80:83], v[32:35]
    v_mfma_f32_16x16x32_bf16 v[32:35], v[140:143], a[64:67], v[32:35]
    s_waitcnt vmcnt(16)
    v_mfma_f32_16x16x32_bf16 v[36:39], v[148:151], a[64:67], v[36:39]
    ds_read_b64_tr_b16 a[236:237], v13 offset:49152
    v_mfma_f32_16x16x32_bf16 v[36:39], v[152:155], a[80:83], v[36:39]
    buffer_load_dwordx4 v[140:143], v8, s[44:47], s92 offen offset:0 sc1
    v_mfma_f32_16x16x32_bf16 v[72:75], v[152:155], a[92:95], v[72:75]
    v_mfma_f32_16x16x32_bf16 v[72:75], v[148:151], a[76:79], v[72:75]
    ds_read_b64_tr_b16 a[238:239], v13 offset:51200
    v_mfma_f32_16x16x32_bf16 v[68:71], v[148:151], a[72:75], v[68:71]
    buffer_load_dwordx4 v[144:147], v8, s[44:47], s93 offen offset:0 sc1
    v_mfma_f32_16x16x32_bf16 v[68:71], v[152:155], a[88:91], v[68:71]
    v_mfma_f32_16x16x32_bf16 v[64:67], v[152:155], a[84:87], v[64:67]
    v_mfma_f32_16x16x32_bf16 v[64:67], v[148:151], a[68:71], v[64:67]
    s_waitcnt vmcnt(16)
    v_mfma_f32_16x16x32_bf16 v[76:79], v[156:159], a[68:71], v[76:79]
    v_mfma_f32_16x16x32_bf16 v[76:79], v[160:163], a[84:87], v[76:79]
    buffer_load_dwordx4 v[148:151], v8, s[44:47], s92 offen offset:512 sc1
    v_mfma_f32_16x16x32_bf16 v[80:83], v[160:163], a[88:91], v[80:83]
    v_add_u32 v10, 65536, v10
    v_mfma_f32_16x16x32_bf16 v[80:83], v[156:159], a[72:75], v[80:83]
    v_mfma_f32_16x16x32_bf16 v[84:87], v[156:159], a[76:79], v[84:87]
    buffer_load_dwordx4 v[152:155], v8, s[44:47], s93 offen offset:512 sc1
    v_mfma_f32_16x16x32_bf16 v[84:87], v[160:163], a[92:95], v[84:87]
    v_mfma_f32_16x16x32_bf16 v[40:43], v[160:163], a[80:83], v[40:43]
    ds_read_b64_tr_b16 a[240:241], v10 offset:0
    v_mfma_f32_16x16x32_bf16 v[40:43], v[156:159], a[64:67], v[40:43]
    s_waitcnt vmcnt(16)
    v_mfma_f32_16x16x32_bf16 v[44:47], v[164:167], a[64:67], v[44:47]
    v_mfma_f32_16x16x32_bf16 v[44:47], v[168:171], a[80:83], v[44:47]
    buffer_load_dwordx4 v[156:159], v8, s[44:47], s92 offen offset:768 sc1
    v_mfma_f32_16x16x32_bf16 v[96:99], v[168:171], a[92:95], v[96:99]
    ds_read_b64_tr_b16 a[242:243], v10 offset:2048
    v_mfma_f32_16x16x32_bf16 v[96:99], v[164:167], a[76:79], v[96:99]
    v_mfma_f32_16x16x32_bf16 v[92:95], v[164:167], a[72:75], v[92:95]
    buffer_load_dwordx4 v[160:163], v8, s[44:47], s93 offen offset:768 sc1
    v_mfma_f32_16x16x32_bf16 v[92:95], v[168:171], a[88:91], v[92:95]
    v_mfma_f32_16x16x32_bf16 v[88:91], v[168:171], a[84:87], v[88:91]
    v_add_u32 v11, 65536, v11
    v_mfma_f32_16x16x32_bf16 v[88:91], v[164:167], a[68:71], v[88:91]
    s_waitcnt vmcnt(16)
    v_mfma_f32_16x16x32_bf16 v[100:103], v[172:175], a[68:71], v[100:103]
    v_mfma_f32_16x16x32_bf16 v[100:103], v[176:179], a[84:87], v[100:103]
    buffer_load_dwordx4 v[164:167], v8, s[44:47], s92 offen offset:1024 sc1
    v_mfma_f32_16x16x32_bf16 v[104:107], v[176:179], a[88:91], v[104:107]
    ds_read_b64_tr_b16 a[244:245], v11 offset:0
    v_mfma_f32_16x16x32_bf16 v[104:107], v[172:175], a[72:75], v[104:107]
    v_mfma_f32_16x16x32_bf16 v[108:111], v[172:175], a[76:79], v[108:111]
    buffer_load_dwordx4 v[168:171], v8, s[44:47], s93 offen offset:1024 sc1
    v_mfma_f32_16x16x32_bf16 v[108:111], v[176:179], a[92:95], v[108:111]
    v_mfma_f32_16x16x32_bf16 v[48:51], v[176:179], a[80:83], v[48:51]
    ds_read_b64_tr_b16 a[246:247], v11 offset:2048
    v_mfma_f32_16x16x32_bf16 v[48:51], v[172:175], a[64:67], v[48:51]
    s_waitcnt vmcnt(16)
    v_mfma_f32_16x16x32_bf16 v[32:35], v[180:183], a[96:99], v[32:35]
    v_mfma_f32_16x16x32_bf16 v[32:35], v[184:187], a[112:115], v[32:35]
    buffer_load_dwordx4 v[172:175], v9, s[44:47], s92 offen offset:1536 sc1
    v_mfma_f32_16x16x32_bf16 v[60:63], v[184:187], a[124:127], v[60:63]
    v_add_u32 v12, 65536, v12
    v_mfma_f32_16x16x32_bf16 v[60:63], v[180:183], a[108:111], v[60:63]
    ds_read_b64 v[14:15], v1 offset:0
    v_mfma_f32_16x16x32_bf16 v[56:59], v[180:183], a[104:107], v[56:59]
    buffer_load_dwordx4 v[176:179], v9, s[44:47], s93 offen offset:1536 sc1
    v_mfma_f32_16x16x32_bf16 v[56:59], v[184:187], a[120:123], v[56:59]
    ds_read_b64_tr_b16 a[248:249], v12 offset:0
    v_mfma_f32_16x16x32_bf16 v[52:55], v[184:187], a[116:119], v[52:55]
    ds_read_b64 v[16:17], v1 offset:32
    v_mfma_f32_16x16x32_bf16 v[52:55], v[180:183], a[100:103], v[52:55]
    s_waitcnt vmcnt(16)
    v_mfma_f32_16x16x32_bf16 v[64:67], v[188:191], a[100:103], v[64:67]
    ds_read_b64_tr_b16 a[250:251], v12 offset:2048
    v_mfma_f32_16x16x32_bf16 v[64:67], v[192:195], a[116:119], v[64:67]
    buffer_load_dwordx4 v[180:183], v8, s[44:47], s94 offen offset:0 sc1
    v_mfma_f32_16x16x32_bf16 v[68:71], v[192:195], a[120:123], v[68:71]
    ds_read_b64 v[18:19], v1 offset:64
    v_mfma_f32_16x16x32_bf16 v[68:71], v[188:191], a[104:107], v[68:71]
    v_add_u32 v13, 65536, v13
    v_mfma_f32_16x16x32_bf16 v[72:75], v[188:191], a[108:111], v[72:75]
    buffer_load_dwordx4 v[184:187], v8, s[44:47], s95 offen offset:0 sc1
    v_mfma_f32_16x16x32_bf16 v[72:75], v[192:195], a[124:127], v[72:75]
    v_mfma_f32_16x16x32_bf16 v[36:39], v[192:195], a[112:115], v[36:39]
    ds_read_b64_tr_b16 a[252:253], v13 offset:0
    v_mfma_f32_16x16x32_bf16 v[36:39], v[188:191], a[96:99], v[36:39]
    s_waitcnt vmcnt(16)
    v_mfma_f32_16x16x32_bf16 v[40:43], v[196:199], a[96:99], v[40:43]
    ds_read_b64 v[20:21], v1 offset:96
    v_mfma_f32_16x16x32_bf16 v[40:43], v[200:203], a[112:115], v[40:43]
    buffer_load_dwordx4 v[188:191], v8, s[44:47], s94 offen offset:512 sc1
    v_mfma_f32_16x16x32_bf16 v[84:87], v[200:203], a[124:127], v[84:87]
    ds_read_b64_tr_b16 a[254:255], v13 offset:2048
    v_mfma_f32_16x16x32_bf16 v[84:87], v[196:199], a[108:111], v[84:87]
    ds_read_b64 v[22:23], v24 offset:128
    v_mfma_f32_16x16x32_bf16 v[80:83], v[196:199], a[104:107], v[80:83]
    buffer_load_dwordx4 v[192:195], v8, s[44:47], s95 offen offset:512 sc1
    v_mfma_f32_16x16x32_bf16 v[80:83], v[200:203], a[120:123], v[80:83]
    v_mfma_f32_16x16x32_bf16 v[76:79], v[200:203], a[116:119], v[76:79]
    v_mfma_f32_16x16x32_bf16 v[76:79], v[196:199], a[100:103], v[76:79]
    s_waitcnt vmcnt(16)
    v_mfma_f32_16x16x32_bf16 v[88:91], v[204:207], a[100:103], v[88:91]
    v_mfma_f32_16x16x32_bf16 v[88:91], v[208:211], a[116:119], v[88:91]
    buffer_load_dwordx4 v[196:199], v8, s[44:47], s94 offen offset:768 sc1
    v_mfma_f32_16x16x32_bf16 v[92:95], v[208:211], a[120:123], v[92:95]
    v_add_u32 v10, -65536, v10
    v_mfma_f32_16x16x32_bf16 v[92:95], v[204:207], a[104:107], v[92:95]
    v_mfma_f32_16x16x32_bf16 v[96:99], v[204:207], a[108:111], v[96:99]
    buffer_load_dwordx4 v[200:203], v8, s[44:47], s95 offen offset:768 sc1
    v_mfma_f32_16x16x32_bf16 v[96:99], v[208:211], a[124:127], v[96:99]
    v_mfma_f32_16x16x32_bf16 v[44:47], v[208:211], a[112:115], v[44:47]
    ds_read_b64_tr_b16 v[220:221], v10 offset:0
    v_mfma_f32_16x16x32_bf16 v[44:47], v[204:207], a[96:99], v[44:47]
    s_waitcnt vmcnt(16)
    v_mfma_f32_16x16x32_bf16 v[48:51], v[212:215], a[96:99], v[48:51]
    v_mfma_f32_16x16x32_bf16 v[48:51], v[216:219], a[112:115], v[48:51]
    buffer_load_dwordx4 v[204:207], v8, s[44:47], s94 offen offset:1024 sc1
    v_mfma_f32_16x16x32_bf16 v[108:111], v[216:219], a[124:127], v[108:111]
    ds_read_b64_tr_b16 v[222:223], v10 offset:2048
    v_mfma_f32_16x16x32_bf16 v[108:111], v[212:215], a[108:111], v[108:111]
    v_mfma_f32_16x16x32_bf16 v[104:107], v[212:215], a[104:107], v[104:107]
    buffer_load_dwordx4 v[208:211], v8, s[44:47], s95 offen offset:1024 sc1
    v_mfma_f32_16x16x32_bf16 v[104:107], v[216:219], a[120:123], v[104:107]
    v_mfma_f32_16x16x32_bf16 v[100:103], v[216:219], a[116:119], v[100:103]
    v_add_u32 v11, -65536, v11
    v_mfma_f32_16x16x32_bf16 v[100:103], v[212:215], a[100:103], v[100:103]
    s_waitcnt vmcnt(16)
    v_mfma_f32_16x16x32_bf16 v[52:55], v[140:143], a[132:135], v[52:55]
    v_mfma_f32_16x16x32_bf16 v[52:55], v[144:147], a[148:151], v[52:55]
    buffer_load_dwordx4 v[212:215], v9, s[44:47], s94 offen offset:1536 sc1
    v_mfma_f32_16x16x32_bf16 v[56:59], v[144:147], a[152:155], v[56:59]
    ds_read_b64_tr_b16 v[224:225], v11 offset:0
    v_mfma_f32_16x16x32_bf16 v[56:59], v[140:143], a[136:139], v[56:59]
    v_mfma_f32_16x16x32_bf16 v[60:63], v[140:143], a[140:143], v[60:63]
    buffer_load_dwordx4 v[216:219], v9, s[44:47], s95 offen offset:1536 sc1
    v_mfma_f32_16x16x32_bf16 v[60:63], v[144:147], a[156:159], v[60:63]
    ds_read_b64_tr_b16 v[226:227], v11 offset:2048
    v_mfma_f32_16x16x32_bf16 v[32:35], v[144:147], a[144:147], v[32:35]
    v_mfma_f32_16x16x32_bf16 v[32:35], v[140:143], a[128:131], v[32:35]
    s_waitcnt vmcnt(16)
    v_mfma_f32_16x16x32_bf16 v[36:39], v[148:151], a[128:131], v[36:39]
    v_add_u32 v12, -65536, v12
    v_mfma_f32_16x16x32_bf16 v[36:39], v[152:155], a[144:147], v[36:39]
    buffer_load_dwordx4 v[140:143], v8, s[44:47], s96 offen offset:0 sc1
    v_mfma_f32_16x16x32_bf16 v[72:75], v[152:155], a[156:159], v[72:75]
    v_mfma_f32_16x16x32_bf16 v[72:75], v[148:151], a[140:143], v[72:75]
    ds_read_b64_tr_b16 v[228:229], v12 offset:0
    v_mfma_f32_16x16x32_bf16 v[68:71], v[148:151], a[136:139], v[68:71]
    buffer_load_dwordx4 v[144:147], v8, s[44:47], s97 offen offset:0 sc1
    v_mfma_f32_16x16x32_bf16 v[68:71], v[152:155], a[152:155], v[68:71]
    v_mfma_f32_16x16x32_bf16 v[64:67], v[152:155], a[148:151], v[64:67]
    ds_read_b64_tr_b16 v[230:231], v12 offset:2048
    v_mfma_f32_16x16x32_bf16 v[64:67], v[148:151], a[132:135], v[64:67]
    s_waitcnt vmcnt(16)
    v_mfma_f32_16x16x32_bf16 v[76:79], v[156:159], a[132:135], v[76:79]
    v_mfma_f32_16x16x32_bf16 v[76:79], v[160:163], a[148:151], v[76:79]
    buffer_load_dwordx4 v[148:151], v8, s[44:47], s96 offen offset:512 sc1
    v_mfma_f32_16x16x32_bf16 v[80:83], v[160:163], a[152:155], v[80:83]
    v_add_u32 v13, -65536, v13
    v_mfma_f32_16x16x32_bf16 v[80:83], v[156:159], a[136:139], v[80:83]
    v_mfma_f32_16x16x32_bf16 v[84:87], v[156:159], a[140:143], v[84:87]
    buffer_load_dwordx4 v[152:155], v8, s[44:47], s97 offen offset:512 sc1
    v_mfma_f32_16x16x32_bf16 v[84:87], v[160:163], a[156:159], v[84:87]
    s_mul_i32 s4, s72, 9
    s_lshr_b32 s4, s4, 1
    s_lshl_b32 s4, s4, 2
    v_min_u32 v28, 19, v2
    v_mfma_f32_16x16x32_bf16 v[40:43], v[160:163], a[144:147], v[40:43]
    ds_read_b64_tr_b16 v[232:233], v13 offset:0
    v_mfma_f32_16x16x32_bf16 v[40:43], v[156:159], a[128:131], v[40:43]
    s_waitcnt vmcnt(16)
    v_mfma_f32_16x16x32_bf16 v[44:47], v[164:167], a[128:131], v[44:47]
    v_add_u32 v28, s4, v28
    v_mfma_f32_16x16x32_bf16 v[44:47], v[168:171], a[144:147], v[44:47]
    buffer_load_dwordx4 v[156:159], v8, s[44:47], s96 offen offset:768 sc1
    v_mfma_f32_16x16x32_bf16 v[96:99], v[168:171], a[156:159], v[96:99]
    ds_read_b64_tr_b16 v[234:235], v13 offset:2048
    v_mfma_f32_16x16x32_bf16 v[96:99], v[164:167], a[140:143], v[96:99]
    v_and_b32 v29, 3, v28
    v_mfma_f32_16x16x32_bf16 v[92:95], v[164:167], a[136:139], v[92:95]
    buffer_load_dwordx4 v[160:163], v8, s[44:47], s97 offen offset:768 sc1
    v_mfma_f32_16x16x32_bf16 v[92:95], v[168:171], a[152:155], v[92:95]
    v_lshrrev_b32 v28, 2, v28
    v_mfma_f32_16x16x32_bf16 v[88:91], v[168:171], a[148:151], v[88:91]
    v_mfma_f32_16x16x32_bf16 v[88:91], v[164:167], a[132:135], v[88:91]
L_pl_G_6:
    s_cbranch_execz L_wret
    v_lshlrev_b32 v28, 7, v28
    s_waitcnt vmcnt(16)
    v_mfma_f32_16x16x32_bf16 v[100:103], v[172:175], a[132:135], v[100:103]
    v_lshl_add_u32 v28, v29, 2, v28
    v_mfma_f32_16x16x32_bf16 v[100:103], v[176:179], a[148:151], v[100:103]
    buffer_load_dwordx4 v[164:167], v8, s[44:47], s96 offen offset:1024 sc1
    v_mfma_f32_16x16x32_bf16 v[104:107], v[176:179], a[152:155], v[104:107]
    ds_read_b64_tr_b16 v[236:237], v10 offset:16384
    v_mfma_f32_16x16x32_bf16 v[104:107], v[172:175], a[136:139], v[104:107]
    v_add_u32 v28, 12582912, v28
    v_mfma_f32_16x16x32_bf16 v[108:111], v[172:175], a[140:143], v[108:111]
    buffer_load_dwordx4 v[168:171], v8, s[44:47], s97 offen offset:1024 sc1
    v_mfma_f32_16x16x32_bf16 v[108:111], v[176:179], a[156:159], v[108:111]
    buffer_load_dword v29, v28, s[44:47], 0 offen sc1
    v_mfma_f32_16x16x32_bf16 v[48:51], v[176:179], a[144:147], v[48:51]
    ds_read_b64_tr_b16 v[238:239], v10 offset:18432
    v_mfma_f32_16x16x32_bf16 v[48:51], v[172:175], a[128:131], v[48:51]
    s_waitcnt vmcnt(17)
    v_mfma_f32_16x16x32_bf16 v[32:35], v[180:183], a[160:163], v[32:35]
    v_mfma_f32_16x16x32_bf16 v[32:35], v[184:187], a[176:179], v[32:35]
    buffer_load_dwordx4 v[172:175], v9, s[44:47], s96 offen offset:1536 sc1
    v_mfma_f32_16x16x32_bf16 v[60:63], v[184:187], a[188:191], v[60:63]
    ds_read_b64_tr_b16 v[240:241], v11 offset:16384
    v_mfma_f32_16x16x32_bf16 v[60:63], v[180:183], a[172:175], v[60:63]
    v_mfma_f32_16x16x32_bf16 v[56:59], v[180:183], a[168:171], v[56:59]
    buffer_load_dwordx4 v[176:179], v9, s[44:47], s97 offen offset:1536 sc1
    v_mfma_f32_16x16x32_bf16 v[56:59], v[184:187], a[184:187], v[56:59]
    ds_read_b64_tr_b16 v[242:243], v11 offset:18432
    v_mfma_f32_16x16x32_bf16 v[52:55], v[184:187], a[180:183], v[52:55]
    v_mfma_f32_16x16x32_bf16 v[52:55], v[180:183], a[164:167], v[52:55]
    s_waitcnt vmcnt(17)
    v_mfma_f32_16x16x32_bf16 v[64:67], v[188:191], a[164:167], v[64:67]
    ds_read_b64_tr_b16 v[244:245], v12 offset:16384
    v_mfma_f32_16x16x32_bf16 v[64:67], v[192:195], a[180:183], v[64:67]
    buffer_load_dwordx4 v[180:183], v8, s[44:47], s98 offen offset:0 sc1
    v_mfma_f32_16x16x32_bf16 v[68:71], v[192:195], a[184:187], v[68:71]
    v_mfma_f32_16x16x32_bf16 v[68:71], v[188:191], a[168:171], v[68:71]
    ds_read_b64_tr_b16 v[246:247], v12 offset:18432
    v_mfma_f32_16x16x32_bf16 v[72:75], v[188:191], a[172:175], v[72:75]
    buffer_load_dwordx4 v[184:187], v8, s[44:47], s99 offen offset:0 sc1
    v_mfma_f32_16x16x32_bf16 v[72:75], v[192:195], a[188:191], v[72:75]
    v_mfma_f32_16x16x32_bf16 v[36:39], v[192:195], a[176:179], v[36:39]
    ds_read_b64_tr_b16 v[248:249], v13 offset:16384
    v_mfma_f32_16x16x32_bf16 v[36:39], v[188:191], a[160:163], v[36:39]
    s_waitcnt vmcnt(17)
    v_mfma_f32_16x16x32_bf16 v[40:43], v[196:199], a[160:163], v[40:43]
    v_mfma_f32_16x16x32_bf16 v[40:43], v[200:203], a[176:179], v[40:43]
    buffer_load_dwordx4 v[188:191], v8, s[44:47], s98 offen offset:512 sc1
    v_mfma_f32_16x16x32_bf16 v[84:87], v[200:203], a[188:191], v[84:87]
    ds_read_b64_tr_b16 v[250:251], v13 offset:18432
    v_mfma_f32_16x16x32_bf16 v[84:87], v[196:199], a[172:175], v[84:87]
    v_mfma_f32_16x16x32_bf16 v[80:83], v[196:199], a[168:171], v[80:83]
    buffer_load_dwordx4 v[192:195], v8, s[44:47], s99 offen offset:512 sc1
    v_mfma_f32_16x16x32_bf16 v[80:83], v[200:203], a[184:187], v[80:83]
    v_mfma_f32_16x16x32_bf16 v[76:79], v[200:203], a[180:183], v[76:79]
    v_mfma_f32_16x16x32_bf16 v[76:79], v[196:199], a[164:167], v[76:79]
    s_waitcnt vmcnt(17)
    v_mfma_f32_16x16x32_bf16 v[88:91], v[204:207], a[164:167], v[88:91]
    v_mfma_f32_16x16x32_bf16 v[88:91], v[208:211], a[180:183], v[88:91]
    buffer_load_dwordx4 v[196:199], v8, s[44:47], s98 offen offset:768 sc1
    v_mfma_f32_16x16x32_bf16 v[92:95], v[208:211], a[184:187], v[92:95]
    v_mfma_f32_16x16x32_bf16 v[92:95], v[204:207], a[168:171], v[92:95]
    v_mfma_f32_16x16x32_bf16 v[96:99], v[204:207], a[172:175], v[96:99]
    buffer_load_dwordx4 v[200:203], v8, s[44:47], s99 offen offset:768 sc1
    v_mfma_f32_16x16x32_bf16 v[96:99], v[208:211], a[188:191], v[96:99]
    v_mfma_f32_16x16x32_bf16 v[44:47], v[208:211], a[176:179], v[44:47]
    v_mfma_f32_16x16x32_bf16 v[44:47], v[204:207], a[160:163], v[44:47]
    s_waitcnt vmcnt(17)
    v_mfma_f32_16x16x32_bf16 v[48:51], v[212:215], a[160:163], v[48:51]
    v_mfma_f32_16x16x32_bf16 v[48:51], v[216:219], a[176:179], v[48:51]
    buffer_load_dwordx4 v[204:207], v8, s[44:47], s98 offen offset:1024 sc1
    v_mfma_f32_16x16x32_bf16 v[108:111], v[216:219], a[188:191], v[108:111]
    v_mfma_f32_16x16x32_bf16 v[108:111], v[212:215], a[172:175], v[108:111]
    v_mfma_f32_16x16x32_bf16 v[104:107], v[212:215], a[168:171], v[104:107]
    buffer_load_dwordx4 v[208:211], v8, s[44:47], s99 offen offset:1024 sc1
    v_mfma_f32_16x16x32_bf16 v[104:107], v[216:219], a[184:187], v[104:107]
    v_mfma_f32_16x16x32_bf16 v[100:103], v[216:219], a[180:183], v[100:103]
    v_mfma_f32_16x16x32_bf16 v[100:103], v[212:215], a[164:167], v[100:103]
L_Dc:
L_pl_D_0:
    s_cbranch_execz L_wret
    s_waitcnt vmcnt(17) lgkmcnt(0)
    v_mfma_f32_16x16x32_bf16 v[52:55], v[140:143], a[196:199], v[52:55]
    s_lshr_b32 s7, s72, 1
    s_lshl_b32 s7, s7, 5
    v_mfma_f32_16x16x32_bf16 v[52:55], v[144:147], a[212:215], v[52:55]
    buffer_load_dwordx4 v[212:215], v9, s[44:47], s98 offen offset:1536 sc1
    v_mfma_f32_16x16x32_bf16 v[56:59], v[144:147], a[216:219], v[56:59]
    v_mfma_f32_16x16x32_bf16 v[56:59], v[140:143], a[200:203], v[56:59]
    s_add_u32 s7, s7, s71
    s_lshl_b32 s7, s7, 1
    v_mfma_f32_16x16x32_bf16 v[60:63], v[140:143], a[204:207], v[60:63]
    buffer_load_dwordx4 v[216:219], v9, s[44:47], s99 offen offset:1536 sc1
    v_mfma_f32_16x16x32_bf16 v[60:63], v[144:147], a[220:223], v[60:63]
    s_add_u32 s15, s7, s12
    s_xor_b32 s6, s15, 1
    v_mfma_f32_16x16x32_bf16 v[32:35], v[144:147], a[208:211], v[32:35]
    v_mfma_f32_16x16x32_bf16 v[32:35], v[140:143], a[192:195], v[32:35]
    s_waitcnt vmcnt(17)
    v_mfma_f32_16x16x32_bf16 v[36:39], v[148:151], a[192:195], v[36:39]
    s_lshl_b32 s7, s6, 2
    s_add_u32 s7, s7, s3
    v_mfma_f32_16x16x32_bf16 v[36:39], v[152:155], a[208:211], v[36:39]
    buffer_load_dwordx4 v[140:143], v8, s[44:47], s100 offen offset:0 sc1
    v_mfma_f32_16x16x32_bf16 v[72:75], v[152:155], a[220:223], v[72:75]
    s_mul_i32 s9, s7, 5120
    s_add_u32 s9, s9, 22822912
    v_mfma_f32_16x16x32_bf16 v[72:75], v[148:151], a[204:207], v[72:75]
    s_lshl_b32 s7, s15, 2
    s_add_u32 s7, s7, s3
    v_mfma_f32_16x16x32_bf16 v[68:71], v[148:151], a[200:203], v[68:71]
    buffer_load_dwordx4 v[144:147], v8, s[44:47], s101 offen offset:0 sc1
    v_mfma_f32_16x16x32_bf16 v[68:71], v[152:155], a[216:219], v[68:71]
    v_mfma_f32_16x16x32_bf16 v[64:67], v[152:155], a[212:215], v[64:67]
    s_mul_i32 s10, s7, 5120
    s_add_u32 s10, s10, 22822912
    v_mfma_f32_16x16x32_bf16 v[64:67], v[148:151], a[196:199], v[64:67]
    s_waitcnt vmcnt(17)
    v_mfma_f32_16x16x32_bf16 v[76:79], v[156:159], a[196:199], v[76:79]
    v_lshlrev_b32 v10, 4, v2
    v_mfma_f32_16x16x32_bf16 v[76:79], v[160:163], a[212:215], v[76:79]
    buffer_load_dwordx4 v[148:151], v8, s[44:47], s100 offen offset:512 sc1
    v_mfma_f32_16x16x32_bf16 v[80:83], v[160:163], a[216:219], v[80:83]
    v_lshlrev_b32 v11, 3, v2
    v_mfma_f32_16x16x32_bf16 v[80:83], v[156:159], a[200:203], v[80:83]
    v_mfma_f32_16x16x32_bf16 v[84:87], v[156:159], a[204:207], v[84:87]
    buffer_load_dwordx4 v[152:155], v8, s[44:47], s101 offen offset:512 sc1
    v_mfma_f32_16x16x32_bf16 v[84:87], v[160:163], a[220:223], v[84:87]
    s_waitcnt vmcnt(16)
    v_cmp_ne_u32 vcc, s68, v29
    s_cbranch_vccnz L_rs_p3
L_ok_p3:
    v_mfma_f32_16x16x32_bf16 v[40:43], v[160:163], a[208:211], v[40:43]
    s_mul_i32 s7, s72, 294912
    s_add_u32 s7, s7, 4718592
    v_mfma_f32_16x16x32_bf16 v[40:43], v[156:159], a[192:195], v[40:43]
    v_mfma_f32_16x16x32_bf16 v[44:47], v[164:167], a[192:195], v[44:47]
    s_add_u32 s4, s3, s12
    s_lshl_b32 s4, s4, 15
    v_mfma_f32_16x16x32_bf16 v[44:47], v[168:171], a[208:211], v[44:47]
    buffer_load_dwordx4 v[156:159], v8, s[44:47], s100 offen offset:768 sc1
    v_mfma_f32_16x16x32_bf16 v[96:99], v[168:171], a[220:223], v[96:99]
    s_add_u32 m0, s73, 147456
    s_add_u32 s4, s4, s7
    v_mfma_f32_16x16x32_bf16 v[96:99], v[164:167], a[204:207], v[96:99]
    buffer_load_dwordx4 v3, s[44:47], s4 offen sc1 lds
    v_mfma_f32_16x16x32_bf16 v[92:95], v[164:167], a[200:203], v[92:95]
    buffer_load_dwordx4 v[160:163], v8, s[44:47], s101 offen offset:768 sc1
    v_mfma_f32_16x16x32_bf16 v[92:95], v[168:171], a[216:219], v[92:95]
    v_mfma_f32_16x16x32_bf16 v[88:91], v[168:171], a[212:215], v[88:91]
    s_add_u32 m0, s73, 148480
    s_add_u32 s4, s4, 131072
    v_mfma_f32_16x16x32_bf16 v[88:91], v[164:167], a[196:199], v[88:91]
    s_waitcnt vmcnt(17)
    v_mfma_f32_16x16x32_bf16 v[100:103], v[172:175], a[196:199], v[100:103]
    buffer_load_dwordx4 v3, s[44:47], s4 offen sc1 lds
    v_mfma_f32_16x16x32_bf16 v[100:103], v[176:179], a[212:215], v[100:103]
    buffer_load_dwordx4 v[164:167], v8, s[44:47], s100 offen offset:1024 sc1
    v_mfma_f32_16x16x32_bf16 v[104:107], v[176:179], a[216:219], v[104:107]
    s_xor_b32 s4, s12, 1
    s_lshl_b32 s4, s4, 18
    v_mfma_f32_16x16x32_bf16 v[104:107], v[172:175], a[200:203], v[104:107]
    s_add_u32 s4, s4, s7
    s_add_u32 m0, s73, 149504
    v_mfma_f32_16x16x32_bf16 v[108:111], v[172:175], a[204:207], v[108:111]
    buffer_load_dwordx4 v[168:171], v8, s[44:47], s101 offen offset:1024 sc1
    v_mfma_f32_16x16x32_bf16 v[108:111], v[176:179], a[220:223], v[108:111]
    s_cmp_lt_u32 s3, 2
    s_cselect_b32 s4, s4, 0x40000000
    v_mfma_f32_16x16x32_bf16 v[48:51], v[176:179], a[208:211], v[48:51]
    buffer_load_dwordx4 v3, s[44:47], s4 offen sc1 lds
    v_mfma_f32_16x16x32_bf16 v[48:51], v[172:175], a[192:195], v[48:51]
    s_waitcnt vmcnt(19)
    v_mfma_f32_16x16x32_bf16 v[32:35], v[180:183], a[224:227], v[32:35]
    s_barrier
    v_mfma_f32_16x16x32_bf16 v[32:35], v[184:187], a[240:243], v[32:35]
    buffer_load_dwordx4 v[172:175], v9, s[44:47], s100 offen offset:1536 sc1
    v_mfma_f32_16x16x32_bf16 v[60:63], v[184:187], a[252:255], v[60:63]
    v_mfma_f32_16x16x32_bf16 v[60:63], v[180:183], a[236:239], v[60:63]
    s_lshl_b32 s7, s6, 9
    s_lshl_b32 s4, s3, 7
    v_mfma_f32_16x16x32_bf16 v[56:59], v[180:183], a[232:235], v[56:59]
    buffer_load_dwordx4 v[176:179], v9, s[44:47], s101 offen offset:1536 sc1
    v_mfma_f32_16x16x32_bf16 v[56:59], v[184:187], a[248:251], v[56:59]
    v_mfma_f32_16x16x32_bf16 v[52:55], v[184:187], a[244:247], v[52:55]
    s_add_u32 s7, s7, s4
    s_add_u32 s14, s7, 12599296
    v_mfma_f32_16x16x32_bf16 v[52:55], v[180:183], a[228:231], v[52:55]
    s_waitcnt vmcnt(19)
    v_mfma_f32_16x16x32_bf16 v[64:67], v[188:191], a[228:231], v[64:67]
    v_mfma_f32_16x16x32_bf16 v[64:67], v[192:195], a[244:247], v[64:67]
    v_add_u32 v8, s11, v8
    buffer_load_dwordx4 v[180:183], v8, s[44:47], s100 offen offset:0 sc1
    v_mfma_f32_16x16x32_bf16 v[68:71], v[192:195], a[248:251], v[68:71]
    v_cmp_eq_u32 vcc, 0, v2
    v_mfma_f32_16x16x32_bf16 v[68:71], v[188:191], a[232:235], v[68:71]
    v_mfma_f32_16x16x32_bf16 v[72:75], v[188:191], a[236:239], v[72:75]
    buffer_load_dwordx4 v[184:187], v8, s[44:47], s101 offen offset:0 sc1
    v_mfma_f32_16x16x32_bf16 v[72:75], v[192:195], a[252:255], v[72:75]
    v_mov_b32 v12, 0x40000000
    v_mfma_f32_16x16x32_bf16 v[36:39], v[192:195], a[240:243], v[36:39]
    v_mfma_f32_16x16x32_bf16 v[36:39], v[188:191], a[224:227], v[36:39]
    s_waitcnt vmcnt(19)
    v_mfma_f32_16x16x32_bf16 v[40:43], v[196:199], a[224:227], v[40:43]
    v_cndmask_b32 v12, v12, 0, vcc
    v_mfma_f32_16x16x32_bf16 v[40:43], v[200:203], a[240:243], v[40:43]
    buffer_load_dwordx4 v[188:191], v8, s[44:47], s100 offen offset:512 sc1
    v_mfma_f32_16x16x32_bf16 v[84:87], v[200:203], a[252:255], v[84:87]
    v_mov_b32 v13, s68
    v_mfma_f32_16x16x32_bf16 v[84:87], v[196:199], a[236:239], v[84:87]
    v_mfma_f32_16x16x32_bf16 v[80:83], v[196:199], a[232:235], v[80:83]
    buffer_load_dwordx4 v[192:195], v8, s[44:47], s101 offen offset:512 sc1
    v_mfma_f32_16x16x32_bf16 v[80:83], v[200:203], a[248:251], v[80:83]
    v_mfma_f32_16x16x32_bf16 v[76:79], v[200:203], a[244:247], v[76:79]
    v_mfma_f32_16x16x32_bf16 v[76:79], v[196:199], a[228:231], v[76:79]
    s_waitcnt vmcnt(19)
    v_mfma_f32_16x16x32_bf16 v[88:91], v[204:207], a[228:231], v[88:91]
    v_mfma_f32_16x16x32_bf16 v[88:91], v[208:211], a[244:247], v[88:91]
    buffer_load_dwordx4 v[196:199], v8, s[44:47], s100 offen offset:768 sc1
    v_mfma_f32_16x16x32_bf16 v[92:95], v[208:211], a[248:251], v[92:95]
    v_mfma_f32_16x16x32_bf16 v[92:95], v[204:207], a[232:235], v[92:95]
    v_mfma_f32_16x16x32_bf16 v[96:99], v[204:207], a[236:239], v[96:99]
    buffer_load_dwordx4 v[200:203], v8, s[44:47], s101 offen offset:768 sc1
    v_mfma_f32_16x16x32_bf16 v[96:99], v[208:211], a[252:255], v[96:99]
    v_mfma_f32_16x16x32_bf16 v[44:47], v[208:211], a[240:243], v[44:47]
    v_mfma_f32_16x16x32_bf16 v[44:47], v[204:207], a[224:227], v[44:47]
    s_waitcnt vmcnt(19)
    v_mfma_f32_16x16x32_bf16 v[48:51], v[212:215], a[224:227], v[48:51]
    v_mfma_f32_16x16x32_bf16 v[48:51], v[216:219], a[240:243], v[48:51]
    buffer_load_dwordx4 v[204:207], v8, s[44:47], s100 offen offset:1024 sc1
    v_mfma_f32_16x16x32_bf16 v[108:111], v[216:219], a[252:255], v[108:111]
    v_mfma_f32_16x16x32_bf16 v[108:111], v[212:215], a[236:239], v[108:111]
    v_mfma_f32_16x16x32_bf16 v[104:107], v[212:215], a[232:235], v[104:107]
    buffer_load_dwordx4 v[208:211], v8, s[44:47], s101 offen offset:1024 sc1
    v_mfma_f32_16x16x32_bf16 v[104:107], v[216:219], a[248:251], v[104:107]
    v_mfma_f32_16x16x32_bf16 v[100:103], v[216:219], a[244:247], v[100:103]
    v_mfma_f32_16x16x32_bf16 v[100:103], v[212:215], a[228:231], v[100:103]
    s_waitcnt vmcnt(19)
    v_mfma_f32_16x16x32_bf16 v[52:55], v[140:143], v[224:227], v[52:55]
    v_mfma_f32_16x16x32_bf16 v[52:55], v[144:147], v[240:243], v[52:55]
    buffer_load_dwordx4 v[212:215], v8, s[44:47], s84 offen offset:0 sc1
    v_mfma_f32_16x16x32_bf16 v[56:59], v[144:147], v[244:247], v[56:59]
    v_mfma_f32_16x16x32_bf16 v[56:59], v[140:143], v[228:231], v[56:59]
    v_mfma_f32_16x16x32_bf16 v[60:63], v[140:143], v[232:235], v[60:63]
    buffer_load_dwordx4 v[216:219], v8, s[44:47], s85 offen offset:0 sc1
    v_mfma_f32_16x16x32_bf16 v[60:63], v[144:147], v[248:251], v[60:63]
    v_mfma_f32_16x16x32_bf16 v[32:35], v[144:147], v[236:239], v[32:35]
    v_mfma_f32_16x16x32_bf16 v[32:35], v[140:143], v[220:223], v[32:35]
    s_waitcnt vmcnt(19)
    v_mfma_f32_16x16x32_bf16 v[36:39], v[148:151], v[220:223], v[36:39]
    v_mfma_f32_16x16x32_bf16 v[36:39], v[152:155], v[236:239], v[36:39]
    buffer_load_dwordx4 v[140:143], v8, s[44:47], s84 offen offset:512 sc1
    v_mfma_f32_16x16x32_bf16 v[72:75], v[152:155], v[248:251], v[72:75]
    ds_write_b128 v4, v[52:55] offset:0
    v_mfma_f32_16x16x32_bf16 v[72:75], v[148:151], v[232:235], v[72:75]
    v_mfma_f32_16x16x32_bf16 v[68:71], v[148:151], v[228:231], v[68:71]
    ds_write_b128 v5, v[56:59] offset:0
    buffer_load_dwordx4 v[144:147], v8, s[44:47], s85 offen offset:512 sc1
    v_mfma_f32_16x16x32_bf16 v[68:71], v[152:155], v[244:247], v[68:71]
    v_mfma_f32_16x16x32_bf16 v[64:67], v[152:155], v[240:243], v[64:67]
    ds_write_b128 v6, v[60:63] offset:0
    v_mfma_f32_16x16x32_bf16 v[64:67], v[148:151], v[224:227], v[64:67]
    s_waitcnt vmcnt(18)
    v_mfma_f32_16x16x32_bf16 v[76:79], v[156:159], v[224:227], v[76:79]
    v_mfma_f32_16x16x32_bf16 v[76:79], v[160:163], v[240:243], v[76:79]
    buffer_load_dwordx4 v[148:151], v8, s[44:47], s84 offen offset:768 sc1
    v_mfma_f32_16x16x32_bf16 v[80:83], v[160:163], v[244:247], v[80:83]
    ds_write_b128 v6, v[72:75] offset:1024
    v_mfma_f32_16x16x32_bf16 v[80:83], v[156:159], v[228:231], v[80:83]
    v_mfma_f32_16x16x32_bf16 v[84:87], v[156:159], v[232:235], v[84:87]
    ds_write_b128 v5, v[68:71] offset:1024
    buffer_load_dwordx4 v[152:155], v8, s[44:47], s85 offen offset:768 sc1
    v_mfma_f32_16x16x32_bf16 v[84:87], v[160:163], v[248:251], v[84:87]
    v_mfma_f32_16x16x32_bf16 v[40:43], v[160:163], v[236:239], v[40:43]
    ds_write_b128 v4, v[64:67] offset:1024
    v_mfma_f32_16x16x32_bf16 v[40:43], v[156:159], v[220:223], v[40:43]
    s_waitcnt vmcnt(17)
    v_mfma_f32_16x16x32_bf16 v[44:47], v[164:167], v[220:223], v[44:47]
    v_mfma_f32_16x16x32_bf16 v[44:47], v[168:171], v[236:239], v[44:47]
    buffer_load_dwordx4 v[156:159], v8, s[44:47], s84 offen offset:1024 sc1
    v_mfma_f32_16x16x32_bf16 v[96:99], v[168:171], v[248:251], v[96:99]
    ds_write_b128 v4, v[76:79] offset:2048
    v_mfma_f32_16x16x32_bf16 v[96:99], v[164:167], v[232:235], v[96:99]
    v_mfma_f32_16x16x32_bf16 v[92:95], v[164:167], v[228:231], v[92:95]
    ds_write_b128 v5, v[80:83] offset:2048
    buffer_load_dwordx4 v[160:163], v8, s[44:47], s85 offen offset:1024 sc1
    v_mfma_f32_16x16x32_bf16 v[92:95], v[168:171], v[244:247], v[92:95]
    v_mfma_f32_16x16x32_bf16 v[88:91], v[168:171], v[240:243], v[88:91]
    ds_write_b128 v6, v[84:87] offset:2048
    v_mfma_f32_16x16x32_bf16 v[88:91], v[164:167], v[224:227], v[88:91]
    s_waitcnt vmcnt(16)
    v_mfma_f32_16x16x32_bf16 v[100:103], v[172:175], v[224:227], v[100:103]
    v_mfma_f32_16x16x32_bf16 v[100:103], v[176:179], v[240:243], v[100:103]
    buffer_load_dwordx4 v[164:167], v8, s[44:47], s86 offen offset:0 sc1
    v_mfma_f32_16x16x32_bf16 v[104:107], v[176:179], v[244:247], v[104:107]
    ds_write_b128 v6, v[96:99] offset:3072
    v_mfma_f32_16x16x32_bf16 v[104:107], v[172:175], v[228:231], v[104:107]
    v_mfma_f32_16x16x32_bf16 v[108:111], v[172:175], v[232:235], v[108:111]
    ds_write_b128 v5, v[92:95] offset:3072
    buffer_load_dwordx4 v[168:171], v8, s[44:47], s87 offen offset:0 sc1
    v_mfma_f32_16x16x32_bf16 v[108:111], v[176:179], v[248:251], v[108:111]
    v_mfma_f32_16x16x32_bf16 v[48:51], v[176:179], v[236:239], v[48:51]
    ds_write_b128 v4, v[88:91] offset:3072
    v_mfma_f32_16x16x32_bf16 v[48:51], v[172:175], v[220:223], v[48:51]
    ds_write_b128 v4, v[100:103] offset:4096
    s_waitcnt vmcnt(16) lgkmcnt(7)
    v_mfma_f32_16x16x32_bf16 v[64:67], v[180:183], v[220:223], v[112:115]
    v_mfma_f32_16x16x32_bf16 v[64:67], v[184:187], v[236:239], v[64:67]
    ds_write_b128 v5, v[104:107] offset:4096
    buffer_load_dwordx4 v[172:175], v8, s[44:47], s86 offen offset:512 sc1
    v_mfma_f32_16x16x32_bf16 v[60:63], v[184:187], v[248:251], 0
    v_mfma_f32_16x16x32_bf16 v[60:63], v[180:183], v[232:235], v[60:63]
    ds_write_b128 v6, v[108:111] offset:4096
    v_mfma_f32_16x16x32_bf16 v[56:59], v[180:183], v[228:231], 0
    buffer_load_dwordx4 v[176:179], v8, s[44:47], s87 offen offset:512 sc1
    v_mfma_f32_16x16x32_bf16 v[56:59], v[184:187], v[244:247], v[56:59]
    v_mfma_f32_16x16x32_bf16 v[52:55], v[184:187], v[240:243], 0
    v_mfma_f32_16x16x32_bf16 v[52:55], v[180:183], v[224:227], v[52:55]
    s_waitcnt vmcnt(16) lgkmcnt(6)
    v_mfma_f32_16x16x32_bf16 v[68:71], v[188:191], v[224:227], 0
    v_mfma_f32_16x16x32_bf16 v[68:71], v[192:195], v[240:243], v[68:71]
    buffer_load_dwordx4 v[180:183], v8, s[44:47], s86 offen offset:768 sc1
    v_mfma_f32_16x16x32_bf16 v[72:75], v[192:195], v[244:247], 0
    v_mfma_f32_16x16x32_bf16 v[72:75], v[188:191], v[228:231], v[72:75]
    v_mfma_f32_16x16x32_bf16 v[76:79], v[188:191], v[232:235], 0
    buffer_load_dwordx4 v[184:187], v8, s[44:47], s87 offen offset:768 sc1
    v_mfma_f32_16x16x32_bf16 v[76:79], v[192:195], v[248:251], v[76:79]
    v_mfma_f32_16x16x32_bf16 v[80:83], v[192:195], v[236:239], v[112:115]
    v_mfma_f32_16x16x32_bf16 v[80:83], v[188:191], v[220:223], v[80:83]
    s_waitcnt vmcnt(16) lgkmcnt(3)
    v_mfma_f32_16x16x32_bf16 v[96:99], v[196:199], v[220:223], v[112:115]
    v_mfma_f32_16x16x32_bf16 v[96:99], v[200:203], v[236:239], v[96:99]
    buffer_load_dwordx4 v[188:191], v8, s[44:47], s86 offen offset:1024 sc1
    v_mfma_f32_16x16x32_bf16 v[92:95], v[200:203], v[248:251], 0
    v_mfma_f32_16x16x32_bf16 v[92:95], v[196:199], v[232:235], v[92:95]
    v_mfma_f32_16x16x32_bf16 v[88:91], v[196:199], v[228:231], 0
    buffer_load_dwordx4 v[192:195], v8, s[44:47], s87 offen offset:1024 sc1
    v_mfma_f32_16x16x32_bf16 v[88:91], v[200:203], v[244:247], v[88:91]
    v_mfma_f32_16x16x32_bf16 v[84:87], v[200:203], v[240:243], 0
    v_mfma_f32_16x16x32_bf16 v[84:87], v[196:199], v[224:227], v[84:87]
    s_waitcnt vmcnt(16) lgkmcnt(0)
    v_mfma_f32_16x16x32_bf16 v[100:103], v[204:207], v[224:227], 0
    v_mfma_f32_16x16x32_bf16 v[100:103], v[208:211], v[240:243], v[100:103]
    buffer_load_dwordx4 v[196:199], v8, s[44:47], s88 offen offset:0 sc1
    v_mfma_f32_16x16x32_bf16 v[104:107], v[208:211], v[244:247], 0
    v_mfma_f32_16x16x32_bf16 v[104:107], v[204:207], v[228:231], v[104:107]
    v_mfma_f32_16x16x32_bf16 v[108:111], v[204:207], v[232:235], 0
    buffer_load_dwordx4 v[200:203], v8, s[44:47], s89 offen offset:0 sc1
    v_mfma_f32_16x16x32_bf16 v[108:111], v[208:211], v[248:251], v[108:111]
    v_mfma_f32_16x16x32_bf16 v[112:115], v[208:211], v[236:239], v[112:115]
    v_mfma_f32_16x16x32_bf16 v[112:115], v[204:207], v[220:223], v[112:115]
    s_waitcnt vmcnt(16)
    v_mfma_f32_16x16x32_bf16 v[64:67], v[212:215], a[0:3], v[64:67]
    s_barrier
    v_mfma_f32_16x16x32_bf16 v[64:67], v[216:219], a[16:19], v[64:67]
    buffer_load_dwordx4 v[204:207], v8, s[44:47], s88 offen offset:512 sc1
    ds_read_b128 v[116:119], v7 offset:0
    v_mfma_f32_16x16x32_bf16 v[60:63], v[216:219], a[28:31], v[60:63]
    ds_read_b128 v[120:123], v7 offset:5120
    ds_read_b128 v[124:127], v7 offset:10240
    v_mfma_f32_16x16x32_bf16 v[60:63], v[212:215], a[12:15], v[60:63]
    ds_read_b128 v[128:131], v7 offset:1024
    ds_read_b128 v[132:135], v7 offset:6144
    v_mfma_f32_16x16x32_bf16 v[56:59], v[212:215], a[8:11], v[56:59]
    buffer_load_dwordx4 v[208:211], v8, s[44:47], s89 offen offset:512 sc1
    ds_read_b128 v[136:139], v7 offset:11264
    v_mfma_f32_16x16x32_bf16 v[56:59], v[216:219], a[24:27], v[56:59]
    s_waitcnt lgkmcnt(3)
    v_add_f32 v32, v32, v116
    v_add_f32 v33, v33, v117
    v_mfma_f32_16x16x32_bf16 v[52:55], v[216:219], a[20:23], v[52:55]
    v_add_f32 v34, v34, v118
    v_add_f32 v35, v35, v119
    v_add_f32 v120, v120, v124
    v_mfma_f32_16x16x32_bf16 v[52:55], v[212:215], a[4:7], v[52:55]
    v_add_f32 v121, v121, v125
    v_add_f32 v122, v122, v126
    s_waitcnt vmcnt(16)
    v_mfma_f32_16x16x32_bf16 v[68:71], v[140:143], a[4:7], v[68:71]
    v_add_f32 v123, v123, v127
    v_add_f32 v32, v32, v120
    v_add_f32 v33, v33, v121
    v_mfma_f32_16x16x32_bf16 v[68:71], v[144:147], a[20:23], v[68:71]
    buffer_load_dwordx4 v[212:215], v8, s[44:47], s88 offen offset:768 sc1
    v_add_f32 v34, v34, v122
    v_mfma_f32_16x16x32_bf16 v[72:75], v[144:147], a[24:27], v[72:75]
    v_add_f32 v35, v35, v123
    v_cvt_pk_bf16_f32 v32, v32, v33
    v_cvt_pk_bf16_f32 v33, v34, v35
    v_mfma_f32_16x16x32_bf16 v[72:75], v[140:143], a[8:11], v[72:75]
    ds_read_b128 v[116:119], v7 offset:2048
    ds_read_b128 v[120:123], v7 offset:7168
    v_mfma_f32_16x16x32_bf16 v[76:79], v[140:143], a[12:15], v[76:79]
    buffer_load_dwordx4 v[216:219], v8, s[44:47], s89 offen offset:768 sc1
    ds_read_b128 v[124:127], v7 offset:12288
    v_mfma_f32_16x16x32_bf16 v[76:79], v[144:147], a[28:31], v[76:79]
    s_waitcnt lgkmcnt(3)
    v_add_f32 v36, v36, v128
    v_add_f32 v37, v37, v129
    v_mfma_f32_16x16x32_bf16 v[80:83], v[144:147], a[16:19], v[80:83]
    v_add_f32 v38, v38, v130
    v_add_f32 v39, v39, v131
    v_mfma_f32_16x16x32_bf16 v[80:83], v[140:143], a[0:3], v[80:83]
    v_add_f32 v132, v132, v136
    v_add_f32 v133, v133, v137
    s_waitcnt vmcnt(16)
    v_mfma_f32_16x16x32_bf16 v[96:99], v[148:151], a[0:3], v[96:99]
    v_add_f32 v134, v134, v138
    v_add_f32 v135, v135, v139
    v_add_f32 v36, v36, v132
    v_mfma_f32_16x16x32_bf16 v[96:99], v[152:155], a[16:19], v[96:99]
    buffer_load_dwordx4 v[140:143], v8, s[44:47], s88 offen offset:1024 sc1
    v_add_f32 v37, v37, v133
    v_mfma_f32_16x16x32_bf16 v[92:95], v[152:155], a[28:31], v[92:95]
    v_add_f32 v38, v38, v134
    v_add_f32 v39, v39, v135
    v_cvt_pk_bf16_f32 v34, v36, v37
    v_mfma_f32_16x16x32_bf16 v[92:95], v[148:151], a[12:15], v[92:95]
    v_cvt_pk_bf16_f32 v35, v38, v39
    buffer_store_dwordx4 v[32:35], v10, s[44:47], s9 offen offset:0 sc1
    v_mfma_f32_16x16x32_bf16 v[88:91], v[148:151], a[8:11], v[88:91]
    buffer_load_dwordx4 v[144:147], v8, s[44:47], s89 offen offset:1024 sc1
    ds_read_b128 v[128:131], v7 offset:3072
    v_mfma_f32_16x16x32_bf16 v[88:91], v[152:155], a[24:27], v[88:91]
    ds_read_b128 v[132:135], v7 offset:8192
    ds_read_b128 v[136:139], v7 offset:13312
    v_mfma_f32_16x16x32_bf16 v[84:87], v[152:155], a[20:23], v[84:87]
    s_waitcnt lgkmcnt(3)
    v_add_f32 v40, v40, v116
    v_mfma_f32_16x16x32_bf16 v[84:87], v[148:151], a[4:7], v[84:87]
    v_add_f32 v41, v41, v117
    s_waitcnt vmcnt(17)
    v_mfma_f32_16x16x32_bf16 v[100:103], v[156:159], a[4:7], v[100:103]
    v_add_f32 v42, v42, v118
    v_add_f32 v43, v43, v119
    v_add_f32 v120, v120, v124
    v_mfma_f32_16x16x32_bf16 v[100:103], v[160:163], a[20:23], v[100:103]
    buffer_load_dwordx4 v[148:151], v8, s[44:47], s90 offen offset:0 sc1
    v_add_f32 v121, v121, v125
    v_mfma_f32_16x16x32_bf16 v[104:107], v[160:163], a[24:27], v[104:107]
    v_add_f32 v122, v122, v126
    v_add_f32 v123, v123, v127
    v_add_f32 v40, v40, v120
    v_mfma_f32_16x16x32_bf16 v[104:107], v[156:159], a[8:11], v[104:107]
    v_add_f32 v41, v41, v121
    v_add_f32 v42, v42, v122
    v_add_f32 v43, v43, v123
    v_mfma_f32_16x16x32_bf16 v[108:111], v[156:159], a[12:15], v[108:111]
    buffer_load_dwordx4 v[152:155], v8, s[44:47], s91 offen offset:0 sc1
    v_cvt_pk_bf16_f32 v36, v40, v41
    v_mfma_f32_16x16x32_bf16 v[108:111], v[160:163], a[28:31], v[108:111]
    v_cvt_pk_bf16_f32 v37, v42, v43
    ds_read_b128 v[116:119], v7 offset:4096
    v_mfma_f32_16x16x32_bf16 v[112:115], v[160:163], a[16:19], v[112:115]
    ds_read_b128 v[120:123], v7 offset:9216
    ds_read_b128 v[124:127], v7 offset:14336
    v_mfma_f32_16x16x32_bf16 v[112:115], v[156:159], a[0:3], v[112:115]
    s_waitcnt lgkmcnt(3)
    s_waitcnt vmcnt(17)
    v_mfma_f32_16x16x32_bf16 v[64:67], v[164:167], a[32:35], v[64:67]
    v_add_f32 v44, v44, v128
    v_add_f32 v45, v45, v129
    v_mfma_f32_16x16x32_bf16 v[64:67], v[168:171], a[48:51], v[64:67]
    buffer_load_dwordx4 v[156:159], v8, s[44:47], s90 offen offset:512 sc1
    v_add_f32 v46, v46, v130
    v_mfma_f32_16x16x32_bf16 v[60:63], v[168:171], a[60:63], v[60:63]
    v_add_f32 v47, v47, v131
    v_add_f32 v132, v132, v136
    v_add_f32 v133, v133, v137
    v_mfma_f32_16x16x32_bf16 v[60:63], v[164:167], a[44:47], v[60:63]
    v_add_f32 v134, v134, v138
    v_add_f32 v135, v135, v139
    v_mfma_f32_16x16x32_bf16 v[56:59], v[164:167], a[40:43], v[56:59]
    buffer_load_dwordx4 v[160:163], v8, s[44:47], s91 offen offset:512 sc1
    v_add_f32 v44, v44, v132
    v_mfma_f32_16x16x32_bf16 v[56:59], v[168:171], a[56:59], v[56:59]
    v_add_f32 v45, v45, v133
    v_add_f32 v46, v46, v134
    v_add_f32 v47, v47, v135
    v_mfma_f32_16x16x32_bf16 v[52:55], v[168:171], a[52:55], v[52:55]
    v_cvt_pk_bf16_f32 v38, v44, v45
    v_cvt_pk_bf16_f32 v39, v46, v47
    v_mfma_f32_16x16x32_bf16 v[52:55], v[164:167], a[36:39], v[52:55]
    buffer_store_dwordx4 v[36:39], v10, s[44:47], s9 offen offset:1024 sc1
    s_waitcnt vmcnt(18)
    v_mfma_f32_16x16x32_bf16 v[68:71], v[172:175], a[36:39], v[68:71]
    s_waitcnt lgkmcnt(0)
    v_add_f32 v48, v48, v116
    v_add_f32 v49, v49, v117
    v_mfma_f32_16x16x32_bf16 v[68:71], v[176:179], a[52:55], v[68:71]
    buffer_load_dwordx4 v[164:167], v8, s[44:47], s90 offen offset:768 sc1
    v_add_f32 v50, v50, v118
    v_mfma_f32_16x16x32_bf16 v[72:75], v[176:179], a[56:59], v[72:75]
    v_add_f32 v51, v51, v119
    v_add_f32 v120, v120, v124
    v_mfma_f32_16x16x32_bf16 v[72:75], v[172:175], a[40:43], v[72:75]
    v_add_f32 v121, v121, v125
    v_add_f32 v122, v122, v126
    v_add_f32 v123, v123, v127
    v_mfma_f32_16x16x32_bf16 v[76:79], v[172:175], a[44:47], v[76:79]
    buffer_load_dwordx4 v[168:171], v8, s[44:47], s91 offen offset:768 sc1
    v_add_f32 v48, v48, v120
    v_mfma_f32_16x16x32_bf16 v[76:79], v[176:179], a[60:63], v[76:79]
    v_add_f32 v49, v49, v121
    v_add_f32 v50, v50, v122
    v_mfma_f32_16x16x32_bf16 v[80:83], v[176:179], a[48:51], v[80:83]
    v_add_f32 v51, v51, v123
    v_cvt_pk_bf16_f32 v40, v48, v49
    v_cvt_pk_bf16_f32 v41, v50, v51
    v_mfma_f32_16x16x32_bf16 v[80:83], v[172:175], a[32:35], v[80:83]
    buffer_store_dwordx2 v[40:41], v11, s[44:47], s9 offen offset:2048 sc1
    s_waitcnt vmcnt(19)
    v_mfma_f32_16x16x32_bf16 v[96:99], v[180:183], a[32:35], v[96:99]
    v_mfma_f32_16x16x32_bf16 v[96:99], v[184:187], a[48:51], v[96:99]
    buffer_load_dwordx4 v[172:175], v8, s[44:47], s90 offen offset:1024 sc1
    v_mfma_f32_16x16x32_bf16 v[92:95], v[184:187], a[60:63], v[92:95]
    v_and_b32 v221, 0xffff0000, v14
    v_mfma_f32_16x16x32_bf16 v[92:95], v[180:183], a[44:47], v[92:95]
    v_lshlrev_b32 v220, 16, v14
    v_mfma_f32_16x16x32_bf16 v[88:91], v[180:183], a[40:43], v[88:91]
    buffer_load_dwordx4 v[176:179], v8, s[44:47], s91 offen offset:1024 sc1
    v_mfma_f32_16x16x32_bf16 v[88:91], v[184:187], a[56:59], v[88:91]
    v_mfma_f32_16x16x32_bf16 v[84:87], v[184:187], a[52:55], v[84:87]
    v_and_b32 v223, 0xffff0000, v15
    v_mfma_f32_16x16x32_bf16 v[84:87], v[180:183], a[36:39], v[84:87]
    s_waitcnt vmcnt(19)
    v_mfma_f32_16x16x32_bf16 v[100:103], v[188:191], a[36:39], v[100:103]
    v_lshlrev_b32 v222, 16, v15
    v_mfma_f32_16x16x32_bf16 v[100:103], v[192:195], a[52:55], v[100:103]
    buffer_load_dwordx4 v[180:183], v8, s[44:47], s92 offen offset:0 sc1
    v_mfma_f32_16x16x32_bf16 v[104:107], v[192:195], a[56:59], v[104:107]
    v_and_b32 v225, 0xffff0000, v16
    v_mfma_f32_16x16x32_bf16 v[104:107], v[188:191], a[40:43], v[104:107]
    v_lshlrev_b32 v224, 16, v16
    v_mfma_f32_16x16x32_bf16 v[108:111], v[188:191], a[44:47], v[108:111]
    buffer_load_dwordx4 v[184:187], v8, s[44:47], s93 offen offset:0 sc1
    v_mfma_f32_16x16x32_bf16 v[108:111], v[192:195], a[60:63], v[108:111]
    v_and_b32 v227, 0xffff0000, v17
    v_mfma_f32_16x16x32_bf16 v[112:115], v[192:195], a[48:51], v[112:115]
    v_lshlrev_b32 v226, 16, v17
    v_mfma_f32_16x16x32_bf16 v[112:115], v[188:191], a[32:35], v[112:115]
    s_waitcnt vmcnt(19)
    v_mfma_f32_16x16x32_bf16 v[64:67], v[196:199], a[64:67], v[64:67]
    v_and_b32 v229, 0xffff0000, v18
    v_mfma_f32_16x16x32_bf16 v[64:67], v[200:203], a[80:83], v[64:67]
    buffer_load_dwordx4 v[188:191], v8, s[44:47], s92 offen offset:512 sc1
    v_mfma_f32_16x16x32_bf16 v[60:63], v[200:203], a[92:95], v[60:63]
    v_lshlrev_b32 v228, 16, v18
    v_mfma_f32_16x16x32_bf16 v[60:63], v[196:199], a[76:79], v[60:63]
    v_and_b32 v231, 0xffff0000, v19
    v_mfma_f32_16x16x32_bf16 v[56:59], v[196:199], a[72:75], v[56:59]
    buffer_load_dwordx4 v[192:195], v8, s[44:47], s93 offen offset:512 sc1
    v_mfma_f32_16x16x32_bf16 v[56:59], v[200:203], a[88:91], v[56:59]
    v_mfma_f32_16x16x32_bf16 v[52:55], v[200:203], a[84:87], v[52:55]
    v_lshlrev_b32 v230, 16, v19
    v_mfma_f32_16x16x32_bf16 v[52:55], v[196:199], a[68:71], v[52:55]
    s_waitcnt vmcnt(19)
    v_mfma_f32_16x16x32_bf16 v[68:71], v[204:207], a[68:71], v[68:71]
    v_and_b32 v233, 0xffff0000, v20
    v_mfma_f32_16x16x32_bf16 v[68:71], v[208:211], a[84:87], v[68:71]
    buffer_load_dwordx4 v[196:199], v8, s[44:47], s92 offen offset:768 sc1
    v_mfma_f32_16x16x32_bf16 v[72:75], v[208:211], a[88:91], v[72:75]
    v_lshlrev_b32 v232, 16, v20
    v_mfma_f32_16x16x32_bf16 v[72:75], v[204:207], a[72:75], v[72:75]
    v_and_b32 v235, 0xffff0000, v21
    v_mfma_f32_16x16x32_bf16 v[76:79], v[204:207], a[76:79], v[76:79]
    buffer_load_dwordx4 v[200:203], v8, s[44:47], s93 offen offset:768 sc1
    v_mfma_f32_16x16x32_bf16 v[76:79], v[208:211], a[92:95], v[76:79]
    v_lshlrev_b32 v234, 16, v21
    v_mfma_f32_16x16x32_bf16 v[80:83], v[208:211], a[80:83], v[80:83]
    v_and_b32 v237, 0xffff0000, v22
    v_mfma_f32_16x16x32_bf16 v[80:83], v[204:207], a[64:67], v[80:83]
    s_waitcnt vmcnt(19)
    v_mfma_f32_16x16x32_bf16 v[96:99], v[212:215], a[64:67], v[96:99]
    s_waitcnt vmcnt(8)
    buffer_store_dword v13, v12, s[44:47], s14 offen sc1
    v_mfma_f32_16x16x32_bf16 v[96:99], v[216:219], a[80:83], v[96:99]
    buffer_load_dwordx4 v[204:207], v8, s[44:47], s92 offen offset:1024 sc1
    v_mfma_f32_16x16x32_bf16 v[92:95], v[216:219], a[92:95], v[92:95]
    v_lshlrev_b32 v236, 16, v22
    v_mfma_f32_16x16x32_bf16 v[92:95], v[212:215], a[76:79], v[92:95]
    v_and_b32 v239, 0xffff0000, v23
    v_mfma_f32_16x16x32_bf16 v[88:91], v[212:215], a[72:75], v[88:91]
    buffer_load_dwordx4 v[208:211], v8, s[44:47], s93 offen offset:1024 sc1
    v_mfma_f32_16x16x32_bf16 v[88:91], v[216:219], a[88:91], v[88:91]
    v_lshlrev_b32 v238, 16, v23
    v_mfma_f32_16x16x32_bf16 v[84:87], v[216:219], a[84:87], v[84:87]
L_pl_D_1:
    s_cbranch_execz L_wret
    v_mul_f32 v26, v26, v27
    v_mfma_f32_16x16x32_bf16 v[84:87], v[212:215], a[68:71], v[84:87]
    v_mfma_f32_16x16x32_bf16 v[100:103], v[140:143], a[68:71], v[100:103]
    s_barrier
    v_mfma_f32_16x16x32_bf16 v[100:103], v[144:147], a[84:87], v[100:103]
    buffer_load_dwordx4 v[212:215], v8, s[44:47], s94 offen offset:0 sc1
    v_mfma_f32_16x16x32_bf16 v[104:107], v[144:147], a[88:91], v[104:107]
    ds_read_b64_tr_b16 v[14:15], v25 offset:0
    v_mfma_f32_16x16x32_bf16 v[104:107], v[140:143], a[72:75], v[104:107]
    ds_read_b64_tr_b16 v[16:17], v25 offset:8192
    v_mfma_f32_16x16x32_bf16 v[108:111], v[140:143], a[76:79], v[108:111]
    buffer_load_dwordx4 v[216:219], v8, s[44:47], s95 offen offset:0 sc1
    v_mfma_f32_16x16x32_bf16 v[108:111], v[144:147], a[92:95], v[108:111]
    ds_read_b64_tr_b16 v[18:19], v25 offset:1024
    v_mfma_f32_16x16x32_bf16 v[112:115], v[144:147], a[80:83], v[112:115]
    ds_read_b64_tr_b16 v[20:21], v25 offset:9216
    v_mfma_f32_16x16x32_bf16 v[112:115], v[140:143], a[64:67], v[112:115]
    v_mfma_f32_16x16x32_bf16 v[64:67], v[148:151], a[96:99], v[64:67]
    ds_read_b64_tr_b16 v[22:23], v25 offset:2048
    v_mfma_f32_16x16x32_bf16 v[64:67], v[152:155], a[112:115], v[64:67]
    buffer_load_dwordx4 v[140:143], v8, s[44:47], s94 offen offset:512 sc1
    v_mfma_f32_16x16x32_bf16 v[60:63], v[152:155], a[124:127], v[60:63]
    v_fma_f32 v116, v220, v27, -v26
    v_mfma_f32_16x16x32_bf16 v[60:63], v[148:151], a[108:111], v[60:63]
    v_fma_f32 v117, v221, v27, -v26
    v_mfma_f32_16x16x32_bf16 v[56:59], v[148:151], a[104:107], v[56:59]
    buffer_load_dwordx4 v[144:147], v8, s[44:47], s95 offen offset:512 sc1
    v_mfma_f32_16x16x32_bf16 v[56:59], v[152:155], a[120:123], v[56:59]
    v_mfma_f32_16x16x32_bf16 v[52:55], v[152:155], a[116:119], v[52:55]
    v_fma_f32 v118, v222, v27, -v26
    v_mfma_f32_16x16x32_bf16 v[52:55], v[148:151], a[100:103], v[52:55]
    v_mfma_f32_16x16x32_bf16 v[68:71], v[156:159], a[100:103], v[68:71]
    v_fma_f32 v119, v223, v27, -v26
    v_mfma_f32_16x16x32_bf16 v[68:71], v[160:163], a[116:119], v[68:71]
    buffer_load_dwordx4 v[148:151], v8, s[44:47], s94 offen offset:768 sc1
    v_mfma_f32_16x16x32_bf16 v[72:75], v[160:163], a[120:123], v[72:75]
    v_fma_f32 v120, v224, v27, -v26
    v_mfma_f32_16x16x32_bf16 v[72:75], v[156:159], a[104:107], v[72:75]
    v_fma_f32 v121, v225, v27, -v26
    v_mfma_f32_16x16x32_bf16 v[76:79], v[156:159], a[108:111], v[76:79]
    buffer_load_dwordx4 v[152:155], v8, s[44:47], s95 offen offset:768 sc1
    v_mfma_f32_16x16x32_bf16 v[76:79], v[160:163], a[124:127], v[76:79]
    v_fma_f32 v122, v226, v27, -v26
    v_mfma_f32_16x16x32_bf16 v[80:83], v[160:163], a[112:115], v[80:83]
    v_fma_f32 v123, v227, v27, -v26
    v_mfma_f32_16x16x32_bf16 v[80:83], v[156:159], a[96:99], v[80:83]
    v_mfma_f32_16x16x32_bf16 v[96:99], v[164:167], a[96:99], v[96:99]
    v_fma_f32 v124, v228, v27, -v26
    v_mfma_f32_16x16x32_bf16 v[96:99], v[168:171], a[112:115], v[96:99]
    buffer_load_dwordx4 v[156:159], v8, s[44:47], s94 offen offset:1024 sc1
    v_mfma_f32_16x16x32_bf16 v[92:95], v[168:171], a[124:127], v[92:95]
    v_fma_f32 v125, v229, v27, -v26
    v_mfma_f32_16x16x32_bf16 v[92:95], v[164:167], a[108:111], v[92:95]
    v_fma_f32 v126, v230, v27, -v26
    v_mfma_f32_16x16x32_bf16 v[88:91], v[164:167], a[104:107], v[88:91]
    buffer_load_dwordx4 v[160:163], v8, s[44:47], s95 offen offset:1024 sc1
    v_mfma_f32_16x16x32_bf16 v[88:91], v[168:171], a[120:123], v[88:91]
    v_mfma_f32_16x16x32_bf16 v[84:87], v[168:171], a[116:119], v[84:87]
    v_fma_f32 v127, v231, v27, -v26
    v_mfma_f32_16x16x32_bf16 v[84:87], v[164:167], a[100:103], v[84:87]
    s_waitcnt vmcnt(17)
    v_mfma_f32_16x16x32_bf16 v[100:103], v[172:175], a[100:103], v[100:103]
    v_fma_f32 v128, v232, v27, -v26
    v_mfma_f32_16x16x32_bf16 v[100:103], v[176:179], a[116:119], v[100:103]
    buffer_load_dwordx4 v[164:167], v8, s[44:47], s96 offen offset:0 sc1
    v_mfma_f32_16x16x32_bf16 v[104:107], v[176:179], a[120:123], v[104:107]
    v_fma_f32 v129, v233, v27, -v26
    v_mfma_f32_16x16x32_bf16 v[104:107], v[172:175], a[104:107], v[104:107]
    v_fma_f32 v130, v234, v27, -v26
    v_mfma_f32_16x16x32_bf16 v[108:111], v[172:175], a[108:111], v[108:111]
    buffer_load_dwordx4 v[168:171], v8, s[44:47], s97 offen offset:0 sc1
    v_mfma_f32_16x16x32_bf16 v[108:111], v[176:179], a[124:127], v[108:111]
    v_fma_f32 v131, v235, v27, -v26
    v_mfma_f32_16x16x32_bf16 v[112:115], v[176:179], a[112:115], v[112:115]
    v_fma_f32 v132, v236, v27, -v26
    v_mfma_f32_16x16x32_bf16 v[112:115], v[172:175], a[96:99], v[112:115]
    s_waitcnt vmcnt(17)
    v_mfma_f32_16x16x32_bf16 v[64:67], v[180:183], a[128:131], v[64:67]
    v_fma_f32 v133, v237, v27, -v26
    v_mfma_f32_16x16x32_bf16 v[64:67], v[184:187], a[144:147], v[64:67]
    buffer_load_dwordx4 v[172:175], v8, s[44:47], s96 offen offset:512 sc1
    v_mfma_f32_16x16x32_bf16 v[60:63], v[184:187], a[156:159], v[60:63]
    v_fma_f32 v134, v238, v27, -v26
    v_mfma_f32_16x16x32_bf16 v[60:63], v[180:183], a[140:143], v[60:63]
    v_fma_f32 v135, v239, v27, -v26
    v_mfma_f32_16x16x32_bf16 v[56:59], v[180:183], a[136:139], v[56:59]
    buffer_load_dwordx4 v[176:179], v8, s[44:47], s97 offen offset:512 sc1
    v_mfma_f32_16x16x32_bf16 v[56:59], v[184:187], a[152:155], v[56:59]
    v_mfma_f32_16x16x32_bf16 v[52:55], v[184:187], a[148:151], v[52:55]
    s_waitcnt lgkmcnt(0)
    v_mfma_f32_16x16x32_bf16 v[52:55], v[180:183], a[132:135], v[52:55]
    s_waitcnt vmcnt(17)
    v_mfma_f32_16x16x32_bf16 v[68:71], v[188:191], a[132:135], v[68:71]
    v_and_b32 v241, 0xffff0000, v14
    v_mfma_f32_16x16x32_bf16 v[68:71], v[192:195], a[148:151], v[68:71]
    buffer_load_dwordx4 v[180:183], v8, s[44:47], s96 offen offset:768 sc1
    v_mfma_f32_16x16x32_bf16 v[72:75], v[192:195], a[152:155], v[72:75]
    v_lshlrev_b32 v240, 16, v14
    v_mfma_f32_16x16x32_bf16 v[72:75], v[188:191], a[136:139], v[72:75]
    v_mul_f32 v117, v117, v241
    v_mfma_f32_16x16x32_bf16 v[76:79], v[188:191], a[140:143], v[76:79]
    buffer_load_dwordx4 v[184:187], v8, s[44:47], s97 offen offset:768 sc1
    v_mfma_f32_16x16x32_bf16 v[76:79], v[192:195], a[156:159], v[76:79]
    v_mul_f32 v116, v116, v240
    v_mfma_f32_16x16x32_bf16 v[80:83], v[192:195], a[144:147], v[80:83]
    v_and_b32 v243, 0xffff0000, v15
    v_mfma_f32_16x16x32_bf16 v[80:83], v[188:191], a[128:131], v[80:83]
    s_waitcnt vmcnt(17)
    v_mfma_f32_16x16x32_bf16 v[96:99], v[196:199], a[128:131], v[96:99]
    s_lshl_b32 s7, s15, 9
    s_lshl_b32 s4, s3, 7
    v_mfma_f32_16x16x32_bf16 v[96:99], v[200:203], a[144:147], v[96:99]
    buffer_load_dwordx4 v[188:191], v8, s[44:47], s96 offen offset:1024 sc1
    v_mfma_f32_16x16x32_bf16 v[92:95], v[200:203], a[156:159], v[92:95]
    s_add_u32 s7, s7, s4
    s_add_u32 s7, s7, 12599296
    v_mfma_f32_16x16x32_bf16 v[92:95], v[196:199], a[140:143], v[92:95]
    v_mov_b32 v28, s7
    v_mfma_f32_16x16x32_bf16 v[88:91], v[196:199], a[136:139], v[88:91]
    buffer_load_dwordx4 v[192:195], v8, s[44:47], s97 offen offset:1024 sc1
    v_mfma_f32_16x16x32_bf16 v[88:91], v[200:203], a[152:155], v[88:91]
    buffer_load_dword v29, v28, s[44:47], 0 offen sc1
    v_mfma_f32_16x16x32_bf16 v[84:87], v[200:203], a[148:151], v[84:87]
    v_lshlrev_b32 v242, 16, v15
    v_mul_f32 v119, v119, v243
    v_mfma_f32_16x16x32_bf16 v[84:87], v[196:199], a[132:135], v[84:87]
    s_waitcnt vmcnt(17)
    v_mfma_f32_16x16x32_bf16 v[100:103], v[204:207], a[132:135], v[100:103]
    v_mul_f32 v118, v118, v242
    v_and_b32 v245, 0xffff0000, v16
    v_mfma_f32_16x16x32_bf16 v[100:103], v[208:211], a[148:151], v[100:103]
    buffer_load_dwordx4 v[196:199], v8, s[44:47], s98 offen offset:0 sc1
    v_mfma_f32_16x16x32_bf16 v[104:107], v[208:211], a[152:155], v[104:107]
    v_lshlrev_b32 v244, 16, v16
    v_mfma_f32_16x16x32_bf16 v[104:107], v[204:207], a[136:139], v[104:107]
    v_mul_f32 v121, v121, v245
    v_mfma_f32_16x16x32_bf16 v[108:111], v[204:207], a[140:143], v[108:111]
    buffer_load_dwordx4 v[200:203], v8, s[44:47], s99 offen offset:0 sc1
    v_mfma_f32_16x16x32_bf16 v[108:111], v[208:211], a[156:159], v[108:111]
    v_mul_f32 v120, v120, v244
    v_mfma_f32_16x16x32_bf16 v[112:115], v[208:211], a[144:147], v[112:115]
    v_and_b32 v247, 0xffff0000, v17
    v_mfma_f32_16x16x32_bf16 v[112:115], v[204:207], a[128:131], v[112:115]
    v_lshlrev_b32 v246, 16, v17
    s_waitcnt vmcnt(17)
    v_mfma_f32_16x16x32_bf16 v[64:67], v[212:215], a[160:163], v[64:67]
    v_mul_f32 v123, v123, v247
    v_mfma_f32_16x16x32_bf16 v[64:67], v[216:219], a[176:179], v[64:67]
    buffer_load_dwordx4 v[204:207], v8, s[44:47], s98 offen offset:512 sc1
    v_mfma_f32_16x16x32_bf16 v[60:63], v[216:219], a[188:191], v[60:63]
    v_mul_f32 v122, v122, v246
    v_mfma_f32_16x16x32_bf16 v[60:63], v[212:215], a[172:175], v[60:63]
    v_and_b32 v241, 0xffff0000, v18
    v_mfma_f32_16x16x32_bf16 v[56:59], v[212:215], a[168:171], v[56:59]
    buffer_load_dwordx4 v[208:211], v8, s[44:47], s99 offen offset:512 sc1
    v_mfma_f32_16x16x32_bf16 v[56:59], v[216:219], a[184:187], v[56:59]
    v_mfma_f32_16x16x32_bf16 v[52:55], v[216:219], a[180:183], v[52:55]
    v_lshlrev_b32 v240, 16, v18
    v_mfma_f32_16x16x32_bf16 v[52:55], v[212:215], a[164:167], v[52:55]
    s_waitcnt vmcnt(17)
    v_mfma_f32_16x16x32_bf16 v[68:71], v[140:143], a[164:167], v[68:71]
    v_mul_f32 v125, v125, v241
    v_mfma_f32_16x16x32_bf16 v[68:71], v[144:147], a[180:183], v[68:71]
    buffer_load_dwordx4 v[212:215], v8, s[44:47], s98 offen offset:768 sc1
    v_mfma_f32_16x16x32_bf16 v[72:75], v[144:147], a[184:187], v[72:75]
    v_mul_f32 v124, v124, v240
    v_mfma_f32_16x16x32_bf16 v[72:75], v[140:143], a[168:171], v[72:75]
    v_and_b32 v243, 0xffff0000, v19
    v_mfma_f32_16x16x32_bf16 v[76:79], v[140:143], a[172:175], v[76:79]
    buffer_load_dwordx4 v[216:219], v8, s[44:47], s99 offen offset:768 sc1
    v_mfma_f32_16x16x32_bf16 v[76:79], v[144:147], a[188:191], v[76:79]
    v_lshlrev_b32 v242, 16, v19
    v_mfma_f32_16x16x32_bf16 v[80:83], v[144:147], a[176:179], v[80:83]
    v_mul_f32 v127, v127, v243
    v_mfma_f32_16x16x32_bf16 v[80:83], v[140:143], a[160:163], v[80:83]
    s_waitcnt vmcnt(17)
    v_mfma_f32_16x16x32_bf16 v[96:99], v[148:151], a[160:163], v[96:99]
    v_mul_f32 v126, v126, v242
    v_mfma_f32_16x16x32_bf16 v[96:99], v[152:155], a[176:179], v[96:99]
    buffer_load_dwordx4 v[140:143], v8, s[44:47], s98 offen offset:1024 sc1
    v_mfma_f32_16x16x32_bf16 v[92:95], v[152:155], a[188:191], v[92:95]
    v_and_b32 v245, 0xffff0000, v20
    v_mfma_f32_16x16x32_bf16 v[92:95], v[148:151], a[172:175], v[92:95]
    v_lshlrev_b32 v244, 16, v20
    v_mfma_f32_16x16x32_bf16 v[88:91], v[148:151], a[168:171], v[88:91]
    buffer_load_dwordx4 v[144:147], v8, s[44:47], s99 offen offset:1024 sc1
    v_mfma_f32_16x16x32_bf16 v[88:91], v[152:155], a[184:187], v[88:91]
    v_mfma_f32_16x16x32_bf16 v[84:87], v[152:155], a[180:183], v[84:87]
    v_mul_f32 v129, v129, v245
    v_mfma_f32_16x16x32_bf16 v[84:87], v[148:151], a[164:167], v[84:87]
    s_waitcnt vmcnt(17)
    v_mfma_f32_16x16x32_bf16 v[100:103], v[156:159], a[164:167], v[100:103]
    v_mul_f32 v128, v128, v244
    v_mfma_f32_16x16x32_bf16 v[100:103], v[160:163], a[180:183], v[100:103]
    v_and_b32 v247, 0xffff0000, v21
    v_mfma_f32_16x16x32_bf16 v[104:107], v[160:163], a[184:187], v[104:107]
    v_mfma_f32_16x16x32_bf16 v[104:107], v[156:159], a[168:171], v[104:107]
    v_lshlrev_b32 v246, 16, v21
    v_mfma_f32_16x16x32_bf16 v[108:111], v[156:159], a[172:175], v[108:111]
    v_mfma_f32_16x16x32_bf16 v[108:111], v[160:163], a[188:191], v[108:111]
    v_mul_f32 v131, v131, v247
    v_mfma_f32_16x16x32_bf16 v[112:115], v[160:163], a[176:179], v[112:115]
    v_mul_f32 v130, v130, v246
    v_mfma_f32_16x16x32_bf16 v[112:115], v[156:159], a[160:163], v[112:115]
    s_waitcnt vmcnt(15)
    v_mfma_f32_16x16x32_bf16 v[64:67], v[164:167], a[192:195], v[64:67]
    v_and_b32 v241, 0xffff0000, v22
    v_mfma_f32_16x16x32_bf16 v[64:67], v[168:171], a[208:211], v[64:67]
    v_mfma_f32_16x16x32_bf16 v[60:63], v[168:171], a[220:223], v[60:63]
    v_lshlrev_b32 v240, 16, v22
    v_mfma_f32_16x16x32_bf16 v[60:63], v[164:167], a[204:207], v[60:63]
    v_mfma_f32_16x16x32_bf16 v[56:59], v[164:167], a[200:203], v[56:59]
    v_mul_f32 v133, v133, v241
    v_mfma_f32_16x16x32_bf16 v[56:59], v[168:171], a[216:219], v[56:59]
    v_mfma_f32_16x16x32_bf16 v[52:55], v[168:171], a[212:215], v[52:55]
    v_mul_f32 v132, v132, v240
    v_mfma_f32_16x16x32_bf16 v[52:55], v[164:167], a[196:199], v[52:55]
    s_waitcnt vmcnt(13)
    v_mfma_f32_16x16x32_bf16 v[68:71], v[172:175], a[196:199], v[68:71]
    v_and_b32 v243, 0xffff0000, v23
    v_mfma_f32_16x16x32_bf16 v[68:71], v[176:179], a[212:215], v[68:71]
    v_lshlrev_b32 v242, 16, v23
    v_mfma_f32_16x16x32_bf16 v[72:75], v[176:179], a[216:219], v[72:75]
    v_mfma_f32_16x16x32_bf16 v[72:75], v[172:175], a[200:203], v[72:75]
    v_mul_f32 v135, v135, v243
    v_mfma_f32_16x16x32_bf16 v[76:79], v[172:175], a[204:207], v[76:79]
    v_mfma_f32_16x16x32_bf16 v[76:79], v[176:179], a[220:223], v[76:79]
    v_mul_f32 v134, v134, v242
    v_mfma_f32_16x16x32_bf16 v[80:83], v[176:179], a[208:211], v[80:83]
    v_add_u32 v4, 0x10000, v4
    v_mfma_f32_16x16x32_bf16 v[80:83], v[172:175], a[192:195], v[80:83]
    s_waitcnt vmcnt(11)
    v_mfma_f32_16x16x32_bf16 v[96:99], v[180:183], a[192:195], v[96:99]
    v_add_u32 v5, 0x10000, v5
    v_mfma_f32_16x16x32_bf16 v[96:99], v[184:187], a[208:211], v[96:99]
    v_mfma_f32_16x16x32_bf16 v[92:95], v[184:187], a[220:223], v[92:95]
    v_add_u32 v6, 0x10000, v6
    v_mfma_f32_16x16x32_bf16 v[92:95], v[180:183], a[204:207], v[92:95]
    v_mfma_f32_16x16x32_bf16 v[88:91], v[180:183], a[200:203], v[88:91]
    v_add_u32 v7, 0x10000, v7
    v_mfma_f32_16x16x32_bf16 v[88:91], v[184:187], a[216:219], v[88:91]
    s_mov_b32 s8, 0xbfb8aa3b
    v_mfma_f32_16x16x32_bf16 v[84:87], v[184:187], a[212:215], v[84:87]
    v_add_f32 v48, v48, v30
    v_mfma_f32_16x16x32_bf16 v[84:87], v[180:183], a[196:199], v[84:87]
    s_waitcnt vmcnt(9)
    v_mfma_f32_16x16x32_bf16 v[100:103], v[188:191], a[196:199], v[100:103]
    v_add_f32 v49, v49, v30
    v_mfma_f32_16x16x32_bf16 v[100:103], v[192:195], a[212:215], v[100:103]
    v_mfma_f32_16x16x32_bf16 v[104:107], v[192:195], a[216:219], v[104:107]
    v_add_f32 v50, v50, v30
    v_mfma_f32_16x16x32_bf16 v[104:107], v[188:191], a[200:203], v[104:107]
    v_mfma_f32_16x16x32_bf16 v[108:111], v[188:191], a[204:207], v[108:111]
    v_add_f32 v51, v51, v30
    v_mfma_f32_16x16x32_bf16 v[108:111], v[192:195], a[220:223], v[108:111]
    v_bfe_u32 v31, v2, 4, 1
    v_mfma_f32_16x16x32_bf16 v[112:115], v[192:195], a[208:211], v[112:115]
    v_mad_u32_u24 v252, v31, 24, v252
    v_mfma_f32_16x16x32_bf16 v[112:115], v[188:191], a[192:195], v[112:115]
    s_waitcnt vmcnt(6)
    v_mfma_f32_16x16x32_bf16 v[64:67], v[196:199], a[224:227], v[64:67]
    v_mfma_f32_16x16x32_bf16 v[64:67], v[200:203], a[240:243], v[64:67]
    v_mfma_f32_16x16x32_bf16 v[60:63], v[200:203], a[252:255], v[60:63]
    v_cmp_ne_u32 vcc, s68, v29
    s_cbranch_vccnz L_rs_p4
L_ok_p4:
    v_mfma_f32_16x16x32_bf16 v[60:63], v[196:199], a[236:239], v[60:63]
    v_mfma_f32_16x16x32_bf16 v[56:59], v[196:199], a[232:235], v[56:59]
    v_mfma_f32_16x16x32_bf16 v[56:59], v[200:203], a[248:251], v[56:59]
    v_mfma_f32_16x16x32_bf16 v[52:55], v[200:203], a[244:247], v[52:55]
    buffer_load_dwordx4 v[240:243], v10, s[44:47], s10 offen offset:0 sc1
    v_mfma_f32_16x16x32_bf16 v[52:55], v[196:199], a[228:231], v[52:55]
    s_waitcnt vmcnt(5)
    v_mfma_f32_16x16x32_bf16 v[68:71], v[204:207], a[228:231], v[68:71]
    v_mfma_f32_16x16x32_bf16 v[68:71], v[208:211], a[244:247], v[68:71]
    buffer_load_dwordx4 v[244:247], v10, s[44:47], s10 offen offset:1024 sc1
    v_mfma_f32_16x16x32_bf16 v[72:75], v[208:211], a[248:251], v[72:75]
    ds_write_b128 v6, v[60:63] offset:0
    v_mfma_f32_16x16x32_bf16 v[72:75], v[204:207], a[232:235], v[72:75]
    v_mfma_f32_16x16x32_bf16 v[76:79], v[204:207], a[236:239], v[76:79]
    ds_write_b128 v5, v[56:59] offset:0
    v_mfma_f32_16x16x32_bf16 v[76:79], v[208:211], a[252:255], v[76:79]
    buffer_load_dwordx2 v[248:249], v11, s[44:47], s10 offen offset:2048 sc1
    v_mfma_f32_16x16x32_bf16 v[80:83], v[208:211], a[240:243], v[80:83]
    ds_write_b128 v4, v[52:55] offset:0
    v_mfma_f32_16x16x32_bf16 v[80:83], v[204:207], a[224:227], v[80:83]
    s_waitcnt vmcnt(5)
    v_mfma_f32_16x16x32_bf16 v[96:99], v[212:215], a[224:227], v[96:99]
    v_mfma_f32_16x16x32_bf16 v[96:99], v[216:219], a[240:243], v[96:99]
    v_mfma_f32_16x16x32_bf16 v[92:95], v[216:219], a[252:255], v[92:95]
    ds_write_b128 v4, v[68:71] offset:1024
    v_mfma_f32_16x16x32_bf16 v[92:95], v[212:215], a[236:239], v[92:95]
    v_mfma_f32_16x16x32_bf16 v[88:91], v[212:215], a[232:235], v[88:91]
    ds_write_b128 v5, v[72:75] offset:1024
    v_mfma_f32_16x16x32_bf16 v[88:91], v[216:219], a[248:251], v[88:91]
    v_mfma_f32_16x16x32_bf16 v[84:87], v[216:219], a[244:247], v[84:87]
    ds_write_b128 v6, v[76:79] offset:1024
    v_mfma_f32_16x16x32_bf16 v[84:87], v[212:215], a[228:231], v[84:87]
    s_waitcnt vmcnt(3)
    v_mfma_f32_16x16x32_bf16 v[100:103], v[140:143], a[228:231], v[100:103]
    v_mfma_f32_16x16x32_bf16 v[100:103], v[144:147], a[244:247], v[100:103]
    v_mfma_f32_16x16x32_bf16 v[104:107], v[144:147], a[248:251], v[104:107]
    ds_write_b128 v6, v[92:95] offset:2048
    v_mfma_f32_16x16x32_bf16 v[104:107], v[140:143], a[232:235], v[104:107]
    v_mfma_f32_16x16x32_bf16 v[108:111], v[140:143], a[236:239], v[108:111]
    ds_write_b128 v5, v[88:91] offset:2048
    v_mfma_f32_16x16x32_bf16 v[108:111], v[144:147], a[252:255], v[108:111]
    v_mfma_f32_16x16x32_bf16 v[112:115], v[144:147], a[240:243], v[112:115]
    ds_write_b128 v4, v[84:87] offset:2048
    v_mfma_f32_16x16x32_bf16 v[112:115], v[140:143], a[224:227], v[112:115]
    ds_write_b128 v4, v[100:103] offset:3072
    s_nop 0
    ds_write_b128 v5, v[104:107] offset:3072
    s_nop 1
    ds_write_b128 v6, v[108:111] offset:3072
    s_waitcnt lgkmcnt(0)
    s_barrier
    ds_read_b128 v[52:55], v7 offset:0
    ds_read_b128 v[56:59], v7 offset:5120
    ds_read_b128 v[60:63], v7 offset:10240
    ds_read_b128 v[68:71], v7 offset:1024
    ds_read_b128 v[72:75], v7 offset:6144
    ds_read_b128 v[76:79], v7 offset:11264
    ds_read_b128 v[84:87], v7 offset:2048
    ds_read_b128 v[88:91], v7 offset:7168
    ds_read_b128 v[92:95], v7 offset:12288
    ds_read_b128 v[100:103], v7 offset:3072
    ds_read_b128 v[104:107], v7 offset:8192
    ds_read_b128 v[108:111], v7 offset:13312
    s_waitcnt vmcnt(0)
    v_and_b32 v33, 0xffff0000, v240
    v_lshlrev_b32 v32, 16, v240
    v_and_b32 v35, 0xffff0000, v241
    v_lshlrev_b32 v34, 16, v241
    v_and_b32 v37, 0xffff0000, v242
    v_lshlrev_b32 v36, 16, v242
    v_and_b32 v39, 0xffff0000, v243
    v_lshlrev_b32 v38, 16, v243
    v_and_b32 v41, 0xffff0000, v244
    v_lshlrev_b32 v40, 16, v244
    v_and_b32 v43, 0xffff0000, v245
    v_lshlrev_b32 v42, 16, v245
    v_and_b32 v45, 0xffff0000, v246
    v_lshlrev_b32 v44, 16, v246
    v_and_b32 v47, 0xffff0000, v247
    v_lshlrev_b32 v46, 16, v247
    v_and_b32 v137, 0xffff0000, v248
    v_lshlrev_b32 v136, 16, v248
    v_and_b32 v139, 0xffff0000, v249
    v_lshlrev_b32 v138, 16, v249
    v_add_f32 v48, v48, v136
    v_add_f32 v49, v49, v137
    v_add_f32 v50, v50, v138
    v_add_f32 v51, v51, v139
    v_mul_f32 v136, s8, v48
    v_mul_f32 v137, s8, v49
    v_mul_f32 v138, s8, v50
    v_mul_f32 v139, s8, v51
    v_exp_f32 v136, v136
    v_exp_f32 v137, v137
    v_exp_f32 v138, v138
    v_exp_f32 v139, v139
    v_mul_f32 v132, v132, v48
    v_mul_f32 v133, v133, v49
    v_mul_f32 v134, v134, v50
    v_mul_f32 v135, v135, v51
    v_add_f32 v136, 1.0, v136
    v_add_f32 v137, 1.0, v137
    v_add_f32 v138, 1.0, v138
    v_add_f32 v139, 1.0, v139
    v_rcp_f32 v136, v136
    v_rcp_f32 v137, v137
    v_rcp_f32 v138, v138
    v_rcp_f32 v139, v139
    v_fma_f32 v132, v132, v136, v236
    v_fma_f32 v133, v133, v137, v237
    v_fma_f32 v134, v134, v138, v238
    v_fma_f32 v135, v135, v139, v239
    v_cvt_pk_bf16_f32 v48, v132, v133
    v_cvt_pk_bf16_f32 v49, v134, v135
    buffer_store_dwordx2 v[48:49], v253, s[64:67], 0 offen sc1
    v_pk_add_f32 v[32:33], v[32:33], v[64:65]
    v_pk_add_f32 v[34:35], v[34:35], v[66:67]
    v_pk_add_f32 v[36:37], v[36:37], v[80:81]
    v_pk_add_f32 v[38:39], v[38:39], v[82:83]
    v_pk_add_f32 v[40:41], v[40:41], v[96:97]
    v_pk_add_f32 v[42:43], v[42:43], v[98:99]
    v_pk_add_f32 v[44:45], v[44:45], v[112:113]
    v_pk_add_f32 v[46:47], v[46:47], v[114:115]
    s_waitcnt lgkmcnt(9)
    v_pk_add_f32 v[32:33], v[32:33], v[52:53]
    v_pk_add_f32 v[34:35], v[34:35], v[54:55]
    v_pk_add_f32 v[56:57], v[56:57], v[60:61]
    v_pk_add_f32 v[58:59], v[58:59], v[62:63]
    v_pk_add_f32 v[32:33], v[32:33], v[56:57]
    v_pk_add_f32 v[34:35], v[34:35], v[58:59]
    s_waitcnt lgkmcnt(6)
    v_pk_add_f32 v[36:37], v[36:37], v[68:69]
    v_pk_add_f32 v[38:39], v[38:39], v[70:71]
    v_pk_add_f32 v[72:73], v[72:73], v[76:77]
    v_pk_add_f32 v[74:75], v[74:75], v[78:79]
    v_pk_add_f32 v[36:37], v[36:37], v[72:73]
    v_pk_add_f32 v[38:39], v[38:39], v[74:75]
    v_pk_mul_f32 v[52:53], v[32:33], s[8:9] op_sel_hi:[1,0]
    v_pk_mul_f32 v[54:55], v[34:35], s[8:9] op_sel_hi:[1,0]
    v_pk_mul_f32 v[68:69], v[36:37], s[8:9] op_sel_hi:[1,0]
    v_pk_mul_f32 v[70:71], v[38:39], s[8:9] op_sel_hi:[1,0]
    v_exp_f32 v52, v52
    v_exp_f32 v53, v53
    v_exp_f32 v54, v54
    v_exp_f32 v55, v55
    v_exp_f32 v68, v68
    v_exp_f32 v69, v69
    v_exp_f32 v70, v70
    v_exp_f32 v71, v71
    v_pk_mul_f32 v[116:117], v[116:117], v[32:33]
    v_pk_mul_f32 v[118:119], v[118:119], v[34:35]
    v_pk_mul_f32 v[120:121], v[120:121], v[36:37]
    v_pk_mul_f32 v[122:123], v[122:123], v[38:39]
    v_pk_add_f32 v[52:53], v[52:53], 1.0 op_sel_hi:[1,0]
    v_pk_add_f32 v[54:55], v[54:55], 1.0 op_sel_hi:[1,0]
    v_pk_add_f32 v[68:69], v[68:69], 1.0 op_sel_hi:[1,0]
    v_pk_add_f32 v[70:71], v[70:71], 1.0 op_sel_hi:[1,0]
    v_rcp_f32 v52, v52
    v_rcp_f32 v53, v53
    v_rcp_f32 v54, v54
    v_rcp_f32 v55, v55
    v_rcp_f32 v68, v68
    v_rcp_f32 v69, v69
    v_rcp_f32 v70, v70
    v_rcp_f32 v71, v71
    v_pk_fma_f32 v[116:117], v[116:117], v[52:53], v[220:221]
    v_pk_fma_f32 v[118:119], v[118:119], v[54:55], v[222:223]
    v_pk_fma_f32 v[120:121], v[120:121], v[68:69], v[224:225]
    v_pk_fma_f32 v[122:123], v[122:123], v[70:71], v[226:227]
    v_cvt_pk_bf16_f32 v32, v116, v117
    v_cvt_pk_bf16_f32 v34, v120, v121
    v_cvt_pk_bf16_f32 v33, v118, v119
    v_cvt_pk_bf16_f32 v35, v122, v123
    v_permlane16_swap_b32 v32, v34
    s_nop 0
    v_permlane16_swap_b32 v33, v35
    buffer_store_dwordx4 v[32:35], v252, s[64:67], 0 offen offset:0 sc1
    s_waitcnt lgkmcnt(3)
    v_pk_add_f32 v[40:41], v[40:41], v[84:85]
    v_pk_add_f32 v[42:43], v[42:43], v[86:87]
    v_pk_add_f32 v[88:89], v[88:89], v[92:93]
    v_pk_add_f32 v[90:91], v[90:91], v[94:95]
    v_pk_add_f32 v[40:41], v[40:41], v[88:89]
    v_pk_add_f32 v[42:43], v[42:43], v[90:91]
    s_waitcnt lgkmcnt(0)
    v_pk_add_f32 v[44:45], v[44:45], v[100:101]
    v_pk_add_f32 v[46:47], v[46:47], v[102:103]
    v_pk_add_f32 v[104:105], v[104:105], v[108:109]
    v_pk_add_f32 v[106:107], v[106:107], v[110:111]
    v_pk_add_f32 v[44:45], v[44:45], v[104:105]
    v_pk_add_f32 v[46:47], v[46:47], v[106:107]
    v_pk_mul_f32 v[84:85], v[40:41], s[8:9] op_sel_hi:[1,0]
    v_pk_mul_f32 v[86:87], v[42:43], s[8:9] op_sel_hi:[1,0]
    v_pk_mul_f32 v[100:101], v[44:45], s[8:9] op_sel_hi:[1,0]
    v_pk_mul_f32 v[102:103], v[46:47], s[8:9] op_sel_hi:[1,0]
    v_exp_f32 v84, v84
    v_exp_f32 v85, v85
    v_exp_f32 v86, v86
    v_exp_f32 v87, v87
    v_exp_f32 v100, v100
    v_exp_f32 v101, v101
    v_exp_f32 v102, v102
    v_exp_f32 v103, v103
    v_pk_mul_f32 v[124:125], v[124:125], v[40:41]
    v_pk_mul_f32 v[126:127], v[126:127], v[42:43]
    v_pk_mul_f32 v[128:129], v[128:129], v[44:45]
    v_pk_mul_f32 v[130:131], v[130:131], v[46:47]
    v_pk_add_f32 v[84:85], v[84:85], 1.0 op_sel_hi:[1,0]
    v_pk_add_f32 v[86:87], v[86:87], 1.0 op_sel_hi:[1,0]
    v_pk_add_f32 v[100:101], v[100:101], 1.0 op_sel_hi:[1,0]
    v_pk_add_f32 v[102:103], v[102:103], 1.0 op_sel_hi:[1,0]
    v_rcp_f32 v84, v84
    v_rcp_f32 v85, v85
    v_rcp_f32 v86, v86
    v_rcp_f32 v87, v87
    v_rcp_f32 v100, v100
    v_rcp_f32 v101, v101
    v_rcp_f32 v102, v102
    v_rcp_f32 v103, v103
    v_pk_fma_f32 v[124:125], v[124:125], v[84:85], v[228:229]
    v_pk_fma_f32 v[126:127], v[126:127], v[86:87], v[230:231]
    v_pk_fma_f32 v[128:129], v[128:129], v[100:101], v[232:233]
    v_pk_fma_f32 v[130:131], v[130:131], v[102:103], v[234:235]
    v_cvt_pk_bf16_f32 v40, v124, v125
    v_cvt_pk_bf16_f32 v42, v128, v129
    v_cvt_pk_bf16_f32 v41, v126, v127
    v_cvt_pk_bf16_f32 v43, v130, v131
    v_permlane16_swap_b32 v40, v42
    s_nop 0
    v_permlane16_swap_b32 v41, v43
    buffer_store_dwordx4 v[40:43], v252, s[64:67], 0 offen offset:64 sc1
    s_endpgm
L_segE:
.p2align 12
L_aux:
    s_mul_i32 s84, s101, 16
    s_lshr_b32 s84, s84, 2
    s_add_u32 s84, s84, 0
    s_add_u32 s85, s84, 1
    s_cmp_eq_u32 s85, 16
    s_cselect_b32 s85, 0, s85
    s_add_u32 s86, s85, 1
    s_cmp_eq_u32 s86, 16
    s_cselect_b32 s86, 0, s86
    s_add_u32 s87, s86, 1
    s_cmp_eq_u32 s87, 16
    s_cselect_b32 s87, 0, s87
    s_add_u32 s88, s87, 1
    s_cmp_eq_u32 s88, 16
    s_cselect_b32 s88, 0, s88
    s_add_u32 s89, s88, 1
    s_cmp_eq_u32 s89, 16
    s_cselect_b32 s89, 0, s89
    s_add_u32 s90, s89, 1
    s_cmp_eq_u32 s90, 16
    s_cselect_b32 s90, 0, s90
    s_add_u32 s91, s90, 1
    s_cmp_eq_u32 s91, 16
    s_cselect_b32 s91, 0, s91
    s_add_u32 s92, s91, 1
    s_cmp_eq_u32 s92, 16
    s_cselect_b32 s92, 0, s92
    s_add_u32 s93, s92, 1
    s_cmp_eq_u32 s93, 16
    s_cselect_b32 s93, 0, s93
    s_add_u32 s94, s93, 1
    s_cmp_eq_u32 s94, 16
    s_cselect_b32 s94, 0, s94
    s_add_u32 s95, s94, 1
    s_cmp_eq_u32 s95, 16
    s_cselect_b32 s95, 0, s95
    s_add_u32 s96, s95, 1
    s_cmp_eq_u32 s96, 16
    s_cselect_b32 s96, 0, s96
    s_add_u32 s97, s96, 1
    s_cmp_eq_u32 s97, 16
    s_cselect_b32 s97, 0, s97
    s_add_u32 s98, s97, 1
    s_cmp_eq_u32 s98, 16
    s_cselect_b32 s98, 0, s98
    s_add_u32 s99, s98, 1
    s_cmp_eq_u32 s99, 16
    s_cselect_b32 s99, 0, s99
    s_mul_i32 s100, s101, 2
    s_lshr_b32 s100, s100, 2
    s_add_u32 s100, s100, 16
    s_add_u32 s101, s100, 1
    s_cmp_eq_u32 s101, 18
    s_cselect_b32 s101, 16, s101
    s_lshl2_add_u32 s7, s5, s6
    s_add_u32 s7, s7, 188
    s_add_u32 s8, s5, 248
    s_cmp_eq_u32 s6, 27
    s_cselect_b32 s75, s8, s7
    s_mov_b32 s48, s24
    s_and_b32 s49, s25, 0xffff
    s_mov_b32 s50, 2359296
    s_mov_b32 s51, 0x20000
    v_lshlrev_b32 v240, 4, v2
    s_mul_i32 s74, s3, 16640
    s_add_u32 s74, s74, 73728
    s_sub_u32 s69, s75, 216
    s_lshl_b32 s70, s69, 4
    s_add_u32 s70, s70, s3
    s_lshl_b32 s12, s70, 12
    s_lshl_b32 s70, s70, 1
    s_and_b32 s7, s72, 1
    s_lshl_b32 s7, s7, 2
    s_add_u32 s7, s7, s3
    s_mul_i32 s7, s7, 576
    s_lshr_b32 s8, s72, 1
    s_mul_i32 s8, s8, 144
    s_add_u32 s7, s7, s8
    v_min_u32 v241, 47, v2
    v_add_u32 v241, s7, v241
    v_lshlrev_b32 v241, 12, v241
    s_lshl_b32 s7, s71, 7
    v_add_u32 v241, s7, v241
    v_lshrrev_b32 v242, 5, v2
    v_and_b32 v243, 31, v2
    v_lshlrev_b32 v242, 14, v242
    v_lshl_add_u32 v242, v243, 7, v242
    s_add_u32 s13, s12, 32768
    s_mov_b32 s9, 144896
    s_mov_b32 s11, 114688
    s_waitcnt vmcnt(9)
    v_and_b32 v21, 0xffff0000, v8
    v_lshlrev_b32 v20, 16, v8
    v_and_b32 v23, 0xffff0000, v9
    v_lshlrev_b32 v22, 16, v9
    v_and_b32 v25, 0xffff0000, v10
    v_lshlrev_b32 v24, 16, v10
    v_and_b32 v27, 0xffff0000, v12
    v_lshlrev_b32 v26, 16, v12
    v_and_b32 v29, 0xffff0000, v13
    v_lshlrev_b32 v28, 16, v13
    v_and_b32 v31, 0xffff0000, v14
    v_lshlrev_b32 v30, 16, v14
    v_and_b32 v33, 0xffff0000, v16
    v_lshlrev_b32 v32, 16, v16
    v_and_b32 v35, 0xffff0000, v17
    v_lshlrev_b32 v34, 16, v17
    v_and_b32 v37, 0xffff0000, v18
    v_lshlrev_b32 v36, 16, v18
    v_pk_add_f32 v[38:39], v[20:21], v[22:23]
    v_pk_add_f32 v[40:41], v[24:25], v[26:27]
    v_pk_add_f32 v[42:43], v[28:29], v[30:31]
    v_pk_add_f32 v[44:45], v[32:33], v[34:35]
    v_pk_add_f32 v[38:39], v[38:39], v[40:41]
    v_pk_add_f32 v[42:43], v[42:43], v[44:45]
    v_pk_add_f32 v[38:39], v[38:39], v[36:37]
    v_pk_add_f32 v[38:39], v[38:39], v[42:43]
    v_add_f32 v56, v38, v39
    s_nop 1
    v_add_f32_dpp v56, v56, v56 row_ror:8 row_mask:0xf bank_mask:0xf
    s_nop 1
    v_add_f32_dpp v56, v56, v56 row_ror:4 row_mask:0xf bank_mask:0xf
    s_nop 1
    v_add_f32_dpp v56, v56, v56 row_ror:2 row_mask:0xf bank_mask:0xf
    s_nop 1
    v_add_f32_dpp v56, v56, v56 row_ror:1 row_mask:0xf bank_mask:0xf
    v_mov_b32 v57, v56
    s_nop 1
    v_permlane16_swap_b32 v56, v57
    v_add_f32 v56, v56, v57
    v_mul_f32 v56, 0x3ae38e39, v56
    v_pk_add_f32 v[20:21], v[20:21], v[56:57] op_sel_hi:[1,0] neg_lo:[0,1] neg_hi:[0,1]
    v_pk_add_f32 v[22:23], v[22:23], v[56:57] op_sel_hi:[1,0] neg_lo:[0,1] neg_hi:[0,1]
    v_pk_add_f32 v[24:25], v[24:25], v[56:57] op_sel_hi:[1,0] neg_lo:[0,1] neg_hi:[0,1]
    v_pk_add_f32 v[26:27], v[26:27], v[56:57] op_sel_hi:[1,0] neg_lo:[0,1] neg_hi:[0,1]
    v_pk_add_f32 v[28:29], v[28:29], v[56:57] op_sel_hi:[1,0] neg_lo:[0,1] neg_hi:[0,1]
    v_pk_add_f32 v[30:31], v[30:31], v[56:57] op_sel_hi:[1,0] neg_lo:[0,1] neg_hi:[0,1]
    v_pk_add_f32 v[32:33], v[32:33], v[56:57] op_sel_hi:[1,0] neg_lo:[0,1] neg_hi:[0,1]
    v_pk_add_f32 v[34:35], v[34:35], v[56:57] op_sel_hi:[1,0] neg_lo:[0,1] neg_hi:[0,1]
    v_pk_add_f32 v[36:37], v[36:37], v[56:57] op_sel_hi:[1,0] neg_lo:[0,1] neg_hi:[0,1]
    v_pk_mul_f32 v[38:39], v[20:21], v[20:21]
    v_pk_mul_f32 v[40:41], v[22:23], v[22:23]
    v_pk_fma_f32 v[38:39], v[24:25], v[24:25], v[38:39]
    v_pk_fma_f32 v[40:41], v[26:27], v[26:27], v[40:41]
    v_pk_fma_f32 v[38:39], v[28:29], v[28:29], v[38:39]
    v_pk_fma_f32 v[40:41], v[30:31], v[30:31], v[40:41]
    v_pk_fma_f32 v[38:39], v[32:33], v[32:33], v[38:39]
    v_pk_fma_f32 v[40:41], v[34:35], v[34:35], v[40:41]
    v_pk_fma_f32 v[38:39], v[36:37], v[36:37], v[38:39]
    v_pk_add_f32 v[38:39], v[38:39], v[40:41]
    v_add_f32 v18, v38, v39
    s_nop 1
    v_add_f32_dpp v18, v18, v18 row_ror:8 row_mask:0xf bank_mask:0xf
    s_nop 1
    v_add_f32_dpp v18, v18, v18 row_ror:4 row_mask:0xf bank_mask:0xf
    s_nop 1
    v_add_f32_dpp v18, v18, v18 row_ror:2 row_mask:0xf bank_mask:0xf
    s_nop 1
    v_add_f32_dpp v18, v18, v18 row_ror:1 row_mask:0xf bank_mask:0xf
    v_mov_b32 v19, v18
    s_nop 1
    v_permlane16_swap_b32 v18, v19
    v_add_f32 v18, v18, v19
    v_mul_f32 v18, 0x3ae38e39, v18
    v_cvt_pk_bf16_f32 v38, v56, v18
    v_lshlrev_b32 v106, 16, v38
    v_and_b32 v38, 0xffff0000, v38
    v_add_f32 v38, 0x3727c5ac, v38
    v_sub_f32 v56, v56, v106
    v_cvt_pk_bf16_f32 v38, v38, v38
    v_lshlrev_b32 v38, 16, v38
    v_sqrt_f32 v38, v38
    s_nop 0
    v_cvt_pk_bf16_f32 v38, v38, v38
    v_lshlrev_b32 v38, 16, v38
    v_rcp_f32 v107, v38
    s_nop 0
    v_mul_f32 v56, v56, v107
    v_mul_f32 v18, v18, v107
    v_mul_f32 v18, v18, v107
    v_cvt_pk_bf16_f32 v38, v56, v18
    v_lshlrev_b32 v39, 16, v38
    v_and_b32 v38, 0xffff0000, v38
    v_add_f32 v38, 0x3727c5ac, v38
    v_sub_f32 v56, v56, v39
    v_cvt_pk_bf16_f32 v38, v38, v38
    v_lshlrev_b32 v38, 16, v38
    v_sqrt_f32 v38, v38
    s_nop 0
    v_cvt_pk_bf16_f32 v38, v38, v38
    v_lshlrev_b32 v38, 16, v38
    v_rcp_f32 v38, v38
    s_nop 0
    v_mul_f32 v18, v107, v38
    v_mul_f32 v56, v56, v38
    v_pk_fma_f32 v[20:21], v[20:21], v[18:19], v[56:57] op_sel_hi:[1,0,0]
    v_pk_fma_f32 v[22:23], v[22:23], v[18:19], v[56:57] op_sel_hi:[1,0,0]
    v_pk_fma_f32 v[24:25], v[24:25], v[18:19], v[56:57] op_sel_hi:[1,0,0]
    v_pk_fma_f32 v[26:27], v[26:27], v[18:19], v[56:57] op_sel_hi:[1,0,0]
    v_pk_fma_f32 v[28:29], v[28:29], v[18:19], v[56:57] op_sel_hi:[1,0,0]
    v_pk_fma_f32 v[30:31], v[30:31], v[18:19], v[56:57] op_sel_hi:[1,0,0]
    v_pk_fma_f32 v[32:33], v[32:33], v[18:19], v[56:57] op_sel_hi:[1,0,0]
    v_pk_fma_f32 v[34:35], v[34:35], v[18:19], v[56:57] op_sel_hi:[1,0,0]
    v_pk_fma_f32 v[36:37], v[36:37], v[18:19], v[56:57] op_sel_hi:[1,0,0]
    v_cvt_pk_bf16_f32 v8, v20, v21
    v_cvt_pk_bf16_f32 v9, v22, v23
    v_cvt_pk_bf16_f32 v10, v24, v25
    v_cvt_pk_bf16_f32 v11, v26, v27
    v_cvt_pk_bf16_f32 v12, v28, v29
    v_cvt_pk_bf16_f32 v13, v30, v31
    v_cvt_pk_bf16_f32 v14, v32, v33
    v_cvt_pk_bf16_f32 v15, v34, v35
    v_cvt_pk_bf16_f32 v16, v36, v37
    v_lshrrev_b32 v3, 5, v0
    v_and_b32 v1, 31, v0
    v_mul_u32_u24 v17, 1216, v3
    v_mad_u32_u24 v17, v1, 12, v17
    v_add_u32 v17, 144896, v17
    ds_write_b32 v17, v8 offset:0
    ds_write_b32 v17, v9 offset:4
    ds_write_b32 v17, v10 offset:8
    ds_write_b32 v17, v11 offset:384
    ds_write_b32 v17, v12 offset:388
    ds_write_b32 v17, v13 offset:392
    ds_write_b32 v17, v14 offset:768
    ds_write_b32 v17, v15 offset:772
    ds_write_b32 v17, v16 offset:776
    v_lshlrev_b32 v3, 3, v3
    s_lshl_b32 s5, s68, 6
    s_add_u32 s5, s5, 12386304
    v_cmp_eq_u32 vcc, 0, v1
    v_mov_b32 v18, 0x40000000
    s_nop 0
    v_cndmask_b32 v3, v18, v3, vcc
    buffer_store_dwordx2 v[106:107], v3, s[44:47], s5 offen sc1
    v_lshrrev_b32 v19, 4, v0
    v_and_b32 v17, 3, v2
    v_lshlrev_b32 v17, 3, v17
    v_lshl_add_u32 v19, v19, 5, v17
    v_bfe_u32 v6, v2, 2, 2
    v_mul_u32_u24 v17, 1216, v6
    v_mul_u32_u24 v6, 1152, v6
    v_add3_u32 v17, v17, v19, s9
    v_add3_u32 v6, v6, v19, s11
    v_lshlrev_b32 v19, 4, v0
    s_add_u32 s7, s15, 4096
    s_add_u32 s8, s15, 8192
    s_cmp_eq_u32 s3, 0
    s_cselect_b32 s8, s8, 0x40000000
    v_add_u32 v18, 2359296, v19
    v_mov_b32 v44, 0
    s_waitcnt vmcnt(2) lgkmcnt(0)
    s_barrier
    ds_read_b64_tr_b16 v[60:61], v6 offset:0
    ds_read_b64_tr_b16 v[62:63], v6 offset:4608
    ds_read_b64_tr_b16 v[64:65], v6 offset:9216
    ds_read_b64_tr_b16 v[66:67], v6 offset:12672
    ds_read_b64_tr_b16 v[68:69], v6 offset:17280
    ds_read_b64_tr_b16 v[20:21], v17 offset:0
    ds_read_b64_tr_b16 v[22:23], v17 offset:4864
    ds_read_b64_tr_b16 v[24:25], v17 offset:512
    ds_read_b64_tr_b16 v[26:27], v17 offset:5376
    ds_read_b64_tr_b16 v[28:29], v17 offset:1024
    ds_read_b64_tr_b16 v[30:31], v17 offset:5888
    ds_read_b64_tr_b16 v[70:71], v6 offset:512
    ds_read_b64_tr_b16 v[72:73], v6 offset:5120
    ds_read_b64_tr_b16 v[74:75], v6 offset:9728
    ds_read_b64_tr_b16 v[76:77], v6 offset:13184
    v_alignbit_b32 v114, v99, v99, 16
    v_alignbit_b32 v115, v98, v98, 16
    s_waitcnt lgkmcnt(10)
    v_alignbit_b32 v108, v61, v60, 16
    v_alignbit_b32 v109, v62, v61, 16
    v_alignbit_b32 v110, v63, v62, 16
    v_alignbit_b32 v111, v64, v63, 16
    v_alignbit_b32 v112, v65, v64, 16
    v_dot2_f32_bf16 v116, v60, v114, 0
    ds_read_b64_tr_b16 v[78:79], v6 offset:17792
    v_dot2_f32_bf16 v117, v108, v114, 0
    v_dot2_f32_bf16 v118, v61, v114, 0
    ds_read_b64_tr_b16 v[80:81], v6 offset:1024
    v_dot2_f32_bf16 v119, v109, v114, 0
    v_dot2_f32_bf16 v120, v62, v114, 0
    v_dot2_f32_bf16 v121, v110, v114, 0
    ds_read_b64_tr_b16 v[82:83], v6 offset:5632
    v_dot2_f32_bf16 v122, v63, v114, 0
    v_dot2_f32_bf16 v123, v111, v114, 0
    v_dot2_f32_bf16 v116, v61, v115, v116
    ds_read_b64_tr_b16 v[84:85], v6 offset:10240
    v_dot2_f32_bf16 v117, v109, v115, v117
    v_dot2_f32_bf16 v118, v62, v115, v118
    ds_read_b64_tr_b16 v[86:87], v6 offset:13696
    v_dot2_f32_bf16 v119, v110, v115, v119
    v_dot2_f32_bf16 v120, v63, v115, v120
    v_dot2_f32_bf16 v121, v111, v115, v121
    ds_read_b64_tr_b16 v[88:89], v6 offset:18304
    v_dot2_f32_bf16 v122, v64, v115, v122
    v_dot2_f32_bf16 v123, v112, v115, v123
    v_and_b32 v133, 0xffff0000, v66
    s_waitcnt lgkmcnt(14)
    buffer_store_dwordx4 v[20:23], v19, s[44:47], s15 offen sc1
    v_lshlrev_b32 v132, 16, v66
    v_and_b32 v135, 0xffff0000, v67
    s_waitcnt lgkmcnt(12)
    buffer_store_dwordx4 v[24:27], v19, s[44:47], s7 offen sc1
    v_lshlrev_b32 v134, 16, v67
    v_and_b32 v137, 0xffff0000, v68
    v_lshlrev_b32 v136, 16, v68
    s_waitcnt lgkmcnt(10)
    buffer_store_dwordx4 v[28:31], v19, s[44:47], s8 offen sc1
    v_and_b32 v139, 0xffff0000, v69
    v_lshlrev_b32 v138, 16, v69
    v_pk_mul_f32 v[116:117], v[116:117], v[132:133]
    v_pk_mul_f32 v[118:119], v[118:119], v[134:135]
    v_pk_mul_f32 v[120:121], v[120:121], v[136:137]
    v_pk_mul_f32 v[122:123], v[122:123], v[138:139]
    v_cvt_pk_bf16_f32 v160, v123, v122
    v_cvt_pk_bf16_f32 v161, v121, v120
    v_cvt_pk_bf16_f32 v162, v119, v118
    v_cvt_pk_bf16_f32 v163, v117, v116
    buffer_store_dwordx4 v[160:163], v18, s[44:47], s15 offen sc1
    v_alignbit_b32 v114, v101, v101, 16
    v_alignbit_b32 v115, v100, v100, 16
    s_waitcnt lgkmcnt(5)
    v_alignbit_b32 v108, v71, v70, 16
    v_alignbit_b32 v109, v72, v71, 16
    v_alignbit_b32 v110, v73, v72, 16
    v_alignbit_b32 v111, v74, v73, 16
    v_alignbit_b32 v112, v75, v74, 16
    v_dot2_f32_bf16 v124, v70, v114, 0
    v_dot2_f32_bf16 v125, v108, v114, 0
    v_dot2_f32_bf16 v126, v71, v114, 0
    v_dot2_f32_bf16 v127, v109, v114, 0
    v_dot2_f32_bf16 v128, v72, v114, 0
    v_dot2_f32_bf16 v129, v110, v114, 0
    v_dot2_f32_bf16 v130, v73, v114, 0
    v_dot2_f32_bf16 v131, v111, v114, 0
    v_dot2_f32_bf16 v124, v71, v115, v124
    v_dot2_f32_bf16 v125, v109, v115, v125
    v_dot2_f32_bf16 v126, v72, v115, v126
    v_dot2_f32_bf16 v127, v110, v115, v127
    v_dot2_f32_bf16 v128, v73, v115, v128
    v_dot2_f32_bf16 v129, v111, v115, v129
    v_dot2_f32_bf16 v130, v74, v115, v130
    v_dot2_f32_bf16 v131, v112, v115, v131
    v_and_b32 v133, 0xffff0000, v76
    v_lshlrev_b32 v132, 16, v76
    v_and_b32 v135, 0xffff0000, v77
    v_lshlrev_b32 v134, 16, v77
    v_and_b32 v137, 0xffff0000, v78
    v_lshlrev_b32 v136, 16, v78
    v_and_b32 v139, 0xffff0000, v79
    v_lshlrev_b32 v138, 16, v79
    v_pk_mul_f32 v[124:125], v[124:125], v[132:133]
    v_pk_mul_f32 v[126:127], v[126:127], v[134:135]
    v_pk_mul_f32 v[128:129], v[128:129], v[136:137]
    v_pk_mul_f32 v[130:131], v[130:131], v[138:139]
    v_cvt_pk_bf16_f32 v164, v131, v130
    v_cvt_pk_bf16_f32 v165, v129, v128
    v_cvt_pk_bf16_f32 v166, v127, v126
    v_cvt_pk_bf16_f32 v167, v125, v124
    buffer_store_dwordx4 v[164:167], v18, s[44:47], s7 offen sc1
    v_alignbit_b32 v114, v103, v103, 16
    v_alignbit_b32 v115, v102, v102, 16
    s_waitcnt lgkmcnt(0)
    v_alignbit_b32 v108, v81, v80, 16
    v_alignbit_b32 v109, v82, v81, 16
    v_alignbit_b32 v110, v83, v82, 16
    v_alignbit_b32 v111, v84, v83, 16
    v_alignbit_b32 v112, v85, v84, 16
    v_dot2_f32_bf16 v116, v80, v114, 0
    v_dot2_f32_bf16 v117, v108, v114, 0
    v_dot2_f32_bf16 v118, v81, v114, 0
    v_dot2_f32_bf16 v119, v109, v114, 0
    v_dot2_f32_bf16 v120, v82, v114, 0
    v_dot2_f32_bf16 v121, v110, v114, 0
    v_dot2_f32_bf16 v122, v83, v114, 0
    v_dot2_f32_bf16 v123, v111, v114, 0
    v_dot2_f32_bf16 v116, v81, v115, v116
    v_dot2_f32_bf16 v117, v109, v115, v117
    v_dot2_f32_bf16 v118, v82, v115, v118
    v_dot2_f32_bf16 v119, v110, v115, v119
    v_dot2_f32_bf16 v120, v83, v115, v120
    v_dot2_f32_bf16 v121, v111, v115, v121
    v_dot2_f32_bf16 v122, v84, v115, v122
    v_dot2_f32_bf16 v123, v112, v115, v123
    v_and_b32 v133, 0xffff0000, v86
    v_lshlrev_b32 v132, 16, v86
    v_and_b32 v135, 0xffff0000, v87
    v_lshlrev_b32 v134, 16, v87
    v_and_b32 v137, 0xffff0000, v88
    v_lshlrev_b32 v136, 16, v88
    v_and_b32 v139, 0xffff0000, v89
    v_lshlrev_b32 v138, 16, v89
    v_pk_mul_f32 v[116:117], v[116:117], v[132:133]
    v_pk_mul_f32 v[118:119], v[118:119], v[134:135]
    v_pk_mul_f32 v[120:121], v[120:121], v[136:137]
    v_pk_mul_f32 v[122:123], v[122:123], v[138:139]
    v_cvt_pk_bf16_f32 v168, v123, v122
    v_cvt_pk_bf16_f32 v169, v121, v120
    v_cvt_pk_bf16_f32 v170, v119, v118
    v_cvt_pk_bf16_f32 v171, v117, v116
    buffer_store_dwordx4 v[168:171], v18, s[44:47], s8 offen sc1
    buffer_load_dword v45, v44, s[64:67], 0 offen sc1
    s_mov_b64 exec, 0
    s_call_b64 s[82:83], L_wc_X
    s_mov_b64 exec, -1
    s_bfe_u32 s6, s68, 0x20001
    s_lshl_b32 s6, s6, 6
    s_lshr_b32 s7, s68, 3
    s_lshl_b32 s7, s7, 1
    s_add_u32 s6, s6, s7
    s_and_b32 s7, s68, 1
    s_add_u32 s6, s6, s7
    s_lshr_b32 s4, s6, 2
    s_lshl_b32 s4, s4, 7
    s_and_b32 s5, s6, 3
    s_lshl2_add_u32 s4, s5, s4
    s_add_u32 s4, s4, 12533760
    v_min_u32 v1, 1, v0
    v_lshlrev_b32 v1, 30, v1
    v_add_u32 v1, s4, v1
    s_waitcnt vmcnt(0)
    v_readfirstlane_b32 s68, v45
    s_nop 1
    s_cmp_eq_u32 s68, 0
    s_cbranch_scc1 L_nw_X
L_ng_X:
    s_barrier
    v_mov_b32 v3, s68
    buffer_store_dword v3, v1, s[44:47], 0 offen sc1
    s_mov_b64 exec, 0
    s_call_b64 s[82:83], L_wc_D
    s_mov_b64 exec, -1
L_segX:
L_pl_X_0:
    s_cbranch_execz L_pl_X_4
    s_add_u32 m0, s74, 32
    s_add_u32 s13, s12, 0
    buffer_load_dwordx4 v240, s[48:51], s13 offen offset:0 lds
    buffer_load_dwordx4 v240, s[48:51], s13 offen offset:1024 lds
    buffer_load_dwordx4 v240, s[48:51], s13 offen offset:2048 lds
    buffer_load_dwordx4 v240, s[48:51], s13 offen offset:3072 lds
    s_mov_b32 s60, s36
    s_and_b32 s61, s37, 0xffff
    s_mov_b32 s62, 4096
    s_mov_b32 s63, 0x20000
    v_and_b32 v24, 15, v2
    s_lshl_b32 s7, s71, 6
    s_lshl_b32 s8, s3, 4
    s_add_u32 s7, s7, s8
    v_add_u32 v24, s7, v24
    v_mul_u32_u24 v25, 1152, v24
    v_lshrrev_b32 v31, 4, v2
    v_lshl_add_u32 v25, v31, 3, v25
    s_mul_i32 s8, s72, 144
    v_add_u32 v25, s8, v25
    s_and_b32 s7, s72, 1
    s_lshl_b32 s8, s7, 4
    v_add_u32 v252, s8, v25
    s_mul_i32 s8, s7, 144
    s_sub_u32 s8, 128, s8
    v_add_u32 v25, s8, v25
    v_lshrrev_b32 v31, 5, v2
    v_cmp_eq_u32 vcc, s7, v31
    v_mov_b32 v31, 0x40000000
    s_nop 0
    v_cndmask_b32 v253, v31, v25, vcc
    v_lshlrev_b32 v25, 1, v24
    v_lshlrev_b32 v26, 3, v24
    buffer_load_ushort v30, v25, s[60:63], 0 offen
    v_lshrrev_b32 v24, 3, v2
    v_and_b32 v25, 7, v2
    v_bfe_u32 v31, v2, 4, 2
    v_lshlrev_b32 v31, 1, v31
    v_xor_b32 v25, v25, v31
    v_lshlrev_b32 v24, 12, v24
    v_lshl_add_u32 v24, v25, 4, v24
    s_and_b32 s7, s72, 1
    s_lshl_b32 s7, s7, 2
    s_add_u32 s7, s7, s3
    s_mul_i32 s7, s7, 2359296
    s_lshl_b32 s8, s71, 7
    s_add_u32 s7, s7, s8
    v_add_u32 v4, s7, v24
    v_add_u32 v5, 31744, v4
    v_add_u32 v6, 31744, v5
    v_add_u32 v7, 31744, v6
    v_lshrrev_b32 v24, 2, v2
    v_lshlrev_b32 v24, 7, v24
    v_and_b32 v25, 3, v2
    v_lshl_add_u32 v24, v25, 3, v24
    v_add_u32 v24, s73, v24
    v_bfe_u32 v31, v2, 3, 2
    v_xor_b32 v31, s3, v31
    v_xor_b32 v25, 0, v31
    v_lshl_add_u32 v10, v25, 5, v24
    v_xor_b32 v25, 1, v31
    v_lshl_add_u32 v11, v25, 5, v24
    v_xor_b32 v25, 2, v31
    v_lshl_add_u32 v12, v25, 5, v24
    v_xor_b32 v25, 3, v31
    v_lshl_add_u32 v13, v25, 5, v24
    s_cmp_lt_u32 s75, 252
    s_cbranch_scc0 L_idle
    s_mov_b32 s56, s26
    s_and_b32 s57, s27, 0xffff
    s_mov_b32 s58, 1152
    s_mov_b32 s59, 0x20000
    v_mov_b32 v9, 0
    buffer_load_ushort v9, v9, s[56:59], s70 offen
    v_and_b32 v196, 15, v2
    v_lshrrev_b32 v197, 4, v2
    v_lshlrev_b32 v197, 3, v197
    v_add_u32 v196, v196, v197
    v_sub_u32 v196, 15, v196
    v_and_b32 v197, 1, v196
    v_lshlrev_b32 v197, 4, v197
    v_mov_b32 v198, 0xffff
    v_lshlrev_b32 v197, v197, v198
    v_ashrrev_i32 v196, 1, v196
    v_cmp_eq_u32 vcc, 0, v196
    s_nop 1
    v_cndmask_b32 v208, 0, v197, vcc
    v_cmp_eq_u32 vcc, 1, v196
    s_nop 1
    v_cndmask_b32 v209, 0, v197, vcc
    v_cmp_eq_u32 vcc, 2, v196
    s_nop 1
    v_cndmask_b32 v210, 0, v197, vcc
    v_cmp_eq_u32 vcc, 3, v196
    s_nop 1
    v_cndmask_b32 v211, 0, v197, vcc
    s_lshl_b32 s4, s3, 6
    v_min_u32 v28, 63, v2
    v_add_u32 v28, s4, v28
    v_and_b32 v29, 3, v28
    v_lshrrev_b32 v28, 2, v28
    v_lshlrev_b32 v28, 7, v28
    v_lshl_add_u32 v28, v29, 2, v28
    v_add_u32 v28, 12533760, v28
    v_add_u32 v241, s74, v240
    v_cmp_eq_u32 vcc, 0, v2
    v_mov_b32 v196, 4136
    s_nop 0
    v_cndmask_b32 v196, v196, 30, vcc
    v_add_u32 v242, s74, v196
    v_bfe_u32 v196, v2, 3, 2
    v_mul_u32_u24 v196, 4160, v196
    v_and_b32 v197, 7, v2
    v_lshl_add_u32 v196, v197, 2, v196
    v_add_u32 v200, s74, v196
    v_mov_b32 v196, 0
    v_mov_b32 v197, 0
    v_mov_b32 v198, 0
    v_mov_b32 v199, 0
    ds_write_b32 v200, v196
    v_lshlrev_b32 v201, 4, v0
    ds_write_b128 v201, v[196:199]
    ds_write_b128 v201, v[196:199] offset:36864
    s_waitcnt vmcnt(2)
    ds_read_b128 v[212:215], v241 offset:32
    ds_read_b32 v216, v241 offset:48
    ds_read_b128 v[218:221], v241 offset:1056
    ds_read_b32 v222, v241 offset:1072
    ds_read_b128 v[224:227], v241 offset:2080
    ds_read_b32 v228, v241 offset:2096
    ds_read_b128 v[230:233], v241 offset:3104
    ds_read_b32 v234, v241 offset:3120
    v_lshrrev_b32 v202, 3, v2
    v_and_b32 v203, 7, v2
    v_lshrrev_b32 v204, 1, v202
    v_xor_b32 v203, v203, v204
    v_mul_u32_u24 v202, 9216, v202
    v_lshl_add_u32 v24, v203, 4, v202
    v_xor_b32 v25, 64, v24
    v_and_b32 v202, 15, v2
    v_add_u32 v202, 1, v202
    v_and_b32 v203, 1, v202
    v_mul_u32_u24 v203, 4160, v203
    v_lshrrev_b32 v202, 1, v202
    v_lshl_add_u32 v203, v202, 2, v203
    v_lshrrev_b32 v204, 4, v2
    v_lshl_add_u32 v203, v204, 4, v203
    v_add_u32 v236, s74, v203
    v_add_u32 v237, 1024, v236
    v_add_u32 v238, 1024, v237
    v_add_u32 v239, 1024, v238
    s_waitcnt lgkmcnt(0)
    ds_write_b16 v242, v212 offset:4160
    v_alignbit_b32 v212, v213, v212, 16
    v_alignbit_b32 v213, v214, v213, 16
    v_alignbit_b32 v214, v215, v214, 16
    v_alignbit_b32 v215, v216, v215, 16
    ds_write_b128 v241, v[212:215] offset:4192
    v_alignbit_b32 v218, v219, v218, 16
    v_alignbit_b32 v219, v220, v219, 16
    v_alignbit_b32 v220, v221, v220, 16
    v_alignbit_b32 v221, v222, v221, 16
    ds_write_b128 v241, v[218:221] offset:5216
    v_alignbit_b32 v224, v225, v224, 16
    v_alignbit_b32 v225, v226, v225, 16
    v_alignbit_b32 v226, v227, v226, 16
    v_alignbit_b32 v227, v228, v227, 16
    ds_write_b128 v241, v[224:227] offset:6240
    v_alignbit_b32 v230, v231, v230, 16
    v_alignbit_b32 v231, v232, v231, 16
    v_alignbit_b32 v232, v233, v232, 16
    v_alignbit_b32 v233, v234, v233, 16
    ds_write_b128 v241, v[230:233] offset:7264
    v_and_b32 v202, 15, v2
    v_lshlrev_b32 v202, 1, v202
    v_sub_u32 v202, v202, v204
    v_add_u32 v202, 17, v202
    v_bfe_u32 v203, v202, 1, 3
    v_xor_b32 v203, s3, v203
    v_lshlrev_b32 v203, 4, v203
    v_lshl_add_u32 v244, v202, 7, v203
    v_and_b32 v202, 15, v2
    v_lshlrev_b32 v202, 1, v202
    v_sub_u32 v202, v202, v204
    v_add_u32 v202, 13, v202
    v_bfe_u32 v203, v202, 1, 3
    v_xor_b32 v203, s3, v203
    v_lshlrev_b32 v203, 4, v203
    v_lshl_add_u32 v245, v202, 7, v203
    v_and_b32 v202, 15, v2
    v_lshlrev_b32 v202, 1, v202
    v_sub_u32 v202, v202, v204
    v_add_u32 v202, 9, v202
    v_bfe_u32 v203, v202, 1, 3
    v_xor_b32 v203, s3, v203
    v_lshlrev_b32 v203, 4, v203
    v_lshl_add_u32 v246, v202, 7, v203
    v_and_b32 v202, 15, v2
    v_lshlrev_b32 v202, 1, v202
    v_sub_u32 v202, v202, v204
    v_add_u32 v202, 5, v202
    v_bfe_u32 v203, v202, 1, 3
    v_xor_b32 v203, s3, v203
    v_lshlrev_b32 v203, 4, v203
    v_lshl_add_u32 v247, v202, 7, v203
    v_and_b32 v202, 15, v2
    v_lshlrev_b32 v202, 5, v202
    v_lshl_add_u32 v8, v204, 3, v202
    s_mul_i32 s7, s3, 589824
    s_lshl_b32 s8, s69, 8
    s_add_u32 s7, s7, s8
    s_add_u32 s7, s7, 2359296
    s_lshl_b32 s9, s3, 13
    s_add_u32 s9, s9, 4096
    ds_read2_b32 v[64:65], v236 offset0:0 offset1:1
    ds_read2_b32 v[66:67], v236 offset0:2 offset1:3
    ds_read2_b32 v[68:69], v236 offset0:128 offset1:129
    ds_read2_b32 v[70:71], v236 offset0:130 offset1:131
    ds_read2_b32 v[72:73], v237 offset0:0 offset1:1
    ds_read2_b32 v[74:75], v237 offset0:2 offset1:3
    ds_read2_b32 v[76:77], v237 offset0:128 offset1:129
    ds_read2_b32 v[78:79], v237 offset0:130 offset1:131
    ds_read2_b32 v[80:81], v238 offset0:0 offset1:1
    ds_read2_b32 v[82:83], v238 offset0:2 offset1:3
    ds_read2_b32 v[84:85], v238 offset0:128 offset1:129
    ds_read2_b32 v[86:87], v238 offset0:130 offset1:131
    ds_read2_b32 v[88:89], v239 offset0:0 offset1:1
    ds_read2_b32 v[90:91], v239 offset0:2 offset1:3
    ds_read2_b32 v[92:93], v239 offset0:128 offset1:129
    ds_read2_b32 v[94:95], v239 offset0:130 offset1:131
    buffer_load_dword v29, v28, s[44:47], 0 offen sc1
    s_waitcnt vmcnt(1)
    v_lshl_or_b32 v9, v9, 16, v9
    v_and_b32 v248, v9, v208
    v_and_b32 v249, v9, v209
L_pl_X_1:
    s_cbranch_execz L_pl_X_5
    v_and_b32 v250, v9, v210
    v_and_b32 v251, v9, v211
    v_add_u32 v10, 131072, v10
    v_add_u32 v11, 131072, v11
    v_add_u32 v12, 131072, v12
    v_add_u32 v13, 131072, v13
    s_waitcnt vmcnt(0)
    v_cmp_ne_u32 vcc, s68, v29
    s_cbranch_vccnz L_rs_p1X
L_ok_p1X:
    s_barrier
    s_add_u32 m0, s9, 0
    s_add_u32 s13, s7, 0
    buffer_load_dwordx4 v24, s[44:47], s13 offen sc1 lds
    s_add_u32 m0, s9, 1024
    s_add_u32 s13, s7, 73728
    buffer_load_dwordx4 v25, s[44:47], s13 offen sc1 lds
    s_add_u32 m0, s9, 2048
    s_add_u32 s13, s7, 147456
    buffer_load_dwordx4 v24, s[44:47], s13 offen sc1 lds
    s_add_u32 m0, s9, 3072
    s_add_u32 s13, s7, 221184
    buffer_load_dwordx4 v25, s[44:47], s13 offen sc1 lds
    s_add_u32 m0, s9, 4096
    s_add_u32 s13, s7, 294912
    buffer_load_dwordx4 v24, s[44:47], s13 offen sc1 lds
    s_add_u32 m0, s9, 5120
    s_add_u32 s13, s7, 368640
    buffer_load_dwordx4 v25, s[44:47], s13 offen sc1 lds
    s_add_u32 m0, s9, 6144
    s_add_u32 s13, s7, 442368
    buffer_load_dwordx4 v24, s[44:47], s13 offen sc1 lds
    s_add_u32 m0, s9, 7168
    s_add_u32 s13, s7, 516096
    buffer_load_dwordx4 v25, s[44:47], s13 offen sc1 lds
    s_waitcnt vmcnt(0) lgkmcnt(0)
    s_barrier
    ds_read_b128 v[96:99], v244 offset:2048
    ds_read_b128 v[100:103], v244 offset:6144
    ds_read_b128 v[104:107], v244 offset:10240
    ds_read_b128 v[108:111], v244 offset:14336
    ds_read_b128 v[112:115], v244 offset:18432
    ds_read_b128 v[116:119], v244 offset:22528
    ds_read_b128 v[120:123], v244 offset:26624
    ds_read_b128 v[124:127], v244 offset:30720
    s_waitcnt lgkmcnt(0)
    v_mfma_f32_16x16x32_bf16 v[32:35], v[248:251], v[96:99], 0
    s_lshl_b32 s14, s84, 17
    v_mfma_f32_16x16x32_bf16 v[32:35], v[64:67], v[96:99], v[32:35]
    s_add_u32 m0, s73, 147456
    v_mfma_f32_16x16x32_bf16 v[36:39], v[248:251], v[100:103], 0
    buffer_load_dwordx4 v4, s[52:55], s14 offen offset:0 lds
    v_mfma_f32_16x16x32_bf16 v[36:39], v[68:71], v[96:99], v[36:39]
    ds_read_b128 v[160:163], v245 offset:2048
    v_mfma_f32_16x16x32_bf16 v[36:39], v[64:67], v[100:103], v[36:39]
    ds_read2_b32 v[128:129], v236 offset0:16 offset1:17
    v_mfma_f32_16x16x32_bf16 v[40:43], v[248:251], v[104:107], 0
    ds_read2_b32 v[130:131], v236 offset0:18 offset1:19
    v_mfma_f32_16x16x32_bf16 v[40:43], v[64:67], v[104:107], v[40:43]
    ds_read_b128 v[164:167], v245 offset:6144
    v_mfma_f32_16x16x32_bf16 v[40:43], v[68:71], v[100:103], v[40:43]
    v_mfma_f32_16x16x32_bf16 v[40:43], v[72:75], v[96:99], v[40:43]
    ds_read2_b32 v[132:133], v236 offset0:144 offset1:145
    v_mfma_f32_16x16x32_bf16 v[44:47], v[248:251], v[108:111], 0
    ds_read2_b32 v[134:135], v236 offset0:146 offset1:147
    v_mfma_f32_16x16x32_bf16 v[44:47], v[76:79], v[96:99], v[44:47]
    v_mfma_f32_16x16x32_bf16 v[44:47], v[72:75], v[100:103], v[44:47]
    ds_read_b128 v[168:171], v245 offset:10240
    v_mfma_f32_16x16x32_bf16 v[44:47], v[68:71], v[104:107], v[44:47]
    ds_read2_b32 v[136:137], v237 offset0:16 offset1:17
    v_mfma_f32_16x16x32_bf16 v[44:47], v[64:67], v[108:111], v[44:47]
    v_mfma_f32_16x16x32_bf16 v[48:51], v[248:251], v[112:115], 0
    v_mfma_f32_16x16x32_bf16 v[48:51], v[64:67], v[112:115], v[48:51]
    ds_read2_b32 v[138:139], v237 offset0:18 offset1:19
    v_mfma_f32_16x16x32_bf16 v[48:51], v[68:71], v[108:111], v[48:51]
    v_mfma_f32_16x16x32_bf16 v[48:51], v[72:75], v[104:107], v[48:51]
    ds_read_b128 v[172:175], v245 offset:14336
    v_mfma_f32_16x16x32_bf16 v[48:51], v[76:79], v[100:103], v[48:51]
    ds_read2_b32 v[140:141], v237 offset0:144 offset1:145
    v_mfma_f32_16x16x32_bf16 v[48:51], v[80:83], v[96:99], v[48:51]
    v_mfma_f32_16x16x32_bf16 v[52:55], v[248:251], v[116:119], 0
    ds_read2_b32 v[142:143], v237 offset0:146 offset1:147
    v_mfma_f32_16x16x32_bf16 v[52:55], v[84:87], v[96:99], v[52:55]
    v_mfma_f32_16x16x32_bf16 v[52:55], v[80:83], v[100:103], v[52:55]
    ds_read_b128 v[176:179], v245 offset:18432
    v_mfma_f32_16x16x32_bf16 v[52:55], v[76:79], v[104:107], v[52:55]
    s_add_u32 m0, s73, 147456
    v_mfma_f32_16x16x32_bf16 v[52:55], v[72:75], v[108:111], v[52:55]
    buffer_load_dwordx4 v5, s[52:55], s14 offen offset:1024 lds
    v_mfma_f32_16x16x32_bf16 v[52:55], v[68:71], v[112:115], v[52:55]
    ds_read2_b32 v[144:145], v238 offset0:16 offset1:17
    v_mfma_f32_16x16x32_bf16 v[52:55], v[64:67], v[116:119], v[52:55]
    ds_read2_b32 v[146:147], v238 offset0:18 offset1:19
    v_mfma_f32_16x16x32_bf16 v[56:59], v[248:251], v[120:123], 0
    ds_read_b128 v[180:183], v245 offset:22528
    v_mfma_f32_16x16x32_bf16 v[56:59], v[64:67], v[120:123], v[56:59]
    v_mfma_f32_16x16x32_bf16 v[56:59], v[68:71], v[116:119], v[56:59]
    ds_read2_b32 v[148:149], v238 offset0:144 offset1:145
    v_mfma_f32_16x16x32_bf16 v[56:59], v[72:75], v[112:115], v[56:59]
    v_mfma_f32_16x16x32_bf16 v[56:59], v[76:79], v[108:111], v[56:59]
    ds_read2_b32 v[150:151], v238 offset0:146 offset1:147
    v_mfma_f32_16x16x32_bf16 v[56:59], v[80:83], v[104:107], v[56:59]
    v_mfma_f32_16x16x32_bf16 v[56:59], v[84:87], v[100:103], v[56:59]
    ds_read_b128 v[184:187], v245 offset:26624
    v_mfma_f32_16x16x32_bf16 v[56:59], v[88:91], v[96:99], v[56:59]
    ds_read2_b32 v[152:153], v239 offset0:16 offset1:17
    v_mfma_f32_16x16x32_bf16 v[60:63], v[248:251], v[124:127], 0
    v_mfma_f32_16x16x32_bf16 v[60:63], v[92:95], v[96:99], v[60:63]
    ds_read2_b32 v[154:155], v239 offset0:18 offset1:19
    v_mfma_f32_16x16x32_bf16 v[60:63], v[88:91], v[100:103], v[60:63]
    v_mfma_f32_16x16x32_bf16 v[60:63], v[84:87], v[104:107], v[60:63]
    ds_read_b128 v[188:191], v245 offset:30720
    v_mfma_f32_16x16x32_bf16 v[60:63], v[80:83], v[108:111], v[60:63]
    v_mfma_f32_16x16x32_bf16 v[60:63], v[76:79], v[112:115], v[60:63]
    ds_read2_b32 v[156:157], v239 offset0:144 offset1:145
    v_mfma_f32_16x16x32_bf16 v[60:63], v[72:75], v[116:119], v[60:63]
    v_mfma_f32_16x16x32_bf16 v[60:63], v[68:71], v[120:123], v[60:63]
    ds_read2_b32 v[158:159], v239 offset0:146 offset1:147
    v_mfma_f32_16x16x32_bf16 v[60:63], v[64:67], v[124:127], v[60:63]
    s_waitcnt lgkmcnt(12)
    v_mfma_f32_16x16x32_bf16 v[32:35], v[128:131], v[160:163], v[32:35]
    ds_read_b128 v[96:99], v246 offset:2048
    v_mfma_f32_16x16x32_bf16 v[36:39], v[132:135], v[160:163], v[36:39]
    s_add_u32 m0, s73, 147456
    ds_read2_b32 v[64:65], v236 offset0:32 offset1:33
    v_mfma_f32_16x16x32_bf16 v[36:39], v[128:131], v[164:167], v[36:39]
    buffer_load_dwordx4 v6, s[52:55], s14 offen offset:2048 lds
    v_mfma_f32_16x16x32_bf16 v[40:43], v[128:131], v[168:171], v[40:43]
    s_add_u32 s13, s12, 16384
    ds_read2_b32 v[66:67], v236 offset0:34 offset1:35
    v_mfma_f32_16x16x32_bf16 v[40:43], v[132:135], v[164:167], v[40:43]
    ds_read_b128 v[100:103], v246 offset:6144
    v_mfma_f32_16x16x32_bf16 v[40:43], v[136:139], v[160:163], v[40:43]
    s_add_u32 m0, s74, 8352
    v_mfma_f32_16x16x32_bf16 v[44:47], v[140:143], v[160:163], v[44:47]
    buffer_load_dwordx4 v240, s[48:51], s13 offen offset:0 lds
    v_mfma_f32_16x16x32_bf16 v[44:47], v[136:139], v[164:167], v[44:47]
    ds_read2_b32 v[68:69], v236 offset0:160 offset1:161
    v_mfma_f32_16x16x32_bf16 v[44:47], v[132:135], v[168:171], v[44:47]
    ds_read2_b32 v[70:71], v236 offset0:162 offset1:163
    v_mfma_f32_16x16x32_bf16 v[44:47], v[128:131], v[172:175], v[44:47]
    s_waitcnt lgkmcnt(6)
    v_mfma_f32_16x16x32_bf16 v[48:51], v[128:131], v[176:179], v[48:51]
    ds_read_b128 v[104:107], v246 offset:10240
    v_mfma_f32_16x16x32_bf16 v[48:51], v[132:135], v[172:175], v[48:51]
    ds_read2_b32 v[72:73], v237 offset0:32 offset1:33
    v_mfma_f32_16x16x32_bf16 v[48:51], v[136:139], v[168:171], v[48:51]
    ds_read2_b32 v[74:75], v237 offset0:34 offset1:35
    v_mfma_f32_16x16x32_bf16 v[48:51], v[140:143], v[164:167], v[48:51]
    s_add_u32 m0, s74, 8352
    ds_read_b128 v[108:111], v246 offset:14336
    v_mfma_f32_16x16x32_bf16 v[48:51], v[144:147], v[160:163], v[48:51]
    buffer_load_dwordx4 v240, s[48:51], s13 offen offset:1024 lds
    v_mfma_f32_16x16x32_bf16 v[52:55], v[148:151], v[160:163], v[52:55]
    ds_read2_b32 v[76:77], v237 offset0:160 offset1:161
    v_mfma_f32_16x16x32_bf16 v[52:55], v[144:147], v[164:167], v[52:55]
    ds_read2_b32 v[78:79], v237 offset0:162 offset1:163
    v_mfma_f32_16x16x32_bf16 v[52:55], v[140:143], v[168:171], v[52:55]
    ds_read_b128 v[112:115], v246 offset:18432
    v_mfma_f32_16x16x32_bf16 v[52:55], v[136:139], v[172:175], v[52:55]
    ds_read2_b32 v[80:81], v238 offset0:32 offset1:33
    v_mfma_f32_16x16x32_bf16 v[52:55], v[132:135], v[176:179], v[52:55]
    s_add_u32 m0, s73, 147456
    v_mfma_f32_16x16x32_bf16 v[52:55], v[128:131], v[180:183], v[52:55]
    buffer_load_dwordx4 v7, s[52:55], s14 offen offset:3072 lds
    v_mfma_f32_16x16x32_bf16 v[56:59], v[128:131], v[184:187], v[56:59]
    s_add_u32 m0, s74, 8352
    v_mfma_f32_16x16x32_bf16 v[56:59], v[132:135], v[180:183], v[56:59]
    buffer_load_dwordx4 v240, s[48:51], s13 offen offset:2048 lds
    v_mfma_f32_16x16x32_bf16 v[56:59], v[136:139], v[176:179], v[56:59]
    ds_read2_b32 v[82:83], v238 offset0:34 offset1:35
    v_mfma_f32_16x16x32_bf16 v[56:59], v[140:143], v[172:175], v[56:59]
    ds_read_b128 v[116:119], v246 offset:22528
    v_mfma_f32_16x16x32_bf16 v[56:59], v[144:147], v[168:171], v[56:59]
    ds_read2_b32 v[84:85], v238 offset0:160 offset1:161
    v_mfma_f32_16x16x32_bf16 v[56:59], v[148:151], v[164:167], v[56:59]
    ds_read2_b32 v[86:87], v238 offset0:162 offset1:163
    v_mfma_f32_16x16x32_bf16 v[56:59], v[152:155], v[160:163], v[56:59]
    ds_read_b128 v[120:123], v246 offset:26624
    v_mfma_f32_16x16x32_bf16 v[60:63], v[156:159], v[160:163], v[60:63]
    ds_read2_b32 v[88:89], v239 offset0:32 offset1:33
    v_mfma_f32_16x16x32_bf16 v[60:63], v[152:155], v[164:167], v[60:63]
    s_add_u32 m0, s74, 8352
    v_mfma_f32_16x16x32_bf16 v[60:63], v[148:151], v[168:171], v[60:63]
    buffer_load_dwordx4 v240, s[48:51], s13 offen offset:3072 lds
    v_mfma_f32_16x16x32_bf16 v[60:63], v[144:147], v[172:175], v[60:63]
    ds_read2_b32 v[90:91], v239 offset0:34 offset1:35
    v_mfma_f32_16x16x32_bf16 v[60:63], v[140:143], v[176:179], v[60:63]
    ds_read_b128 v[124:127], v246 offset:30720
    v_mfma_f32_16x16x32_bf16 v[60:63], v[136:139], v[180:183], v[60:63]
    ds_read2_b32 v[92:93], v239 offset0:160 offset1:161
    v_mfma_f32_16x16x32_bf16 v[60:63], v[132:135], v[184:187], v[60:63]
    ds_read2_b32 v[94:95], v239 offset0:162 offset1:163
    v_mfma_f32_16x16x32_bf16 v[60:63], v[128:131], v[188:191], v[60:63]
    s_waitcnt lgkmcnt(12)
    v_mfma_f32_16x16x32_bf16 v[32:35], v[64:67], v[96:99], v[32:35]
    s_lshl_b32 s14, s85, 17
    v_mfma_f32_16x16x32_bf16 v[36:39], v[68:71], v[96:99], v[36:39]
    s_add_u32 m0, s73, 49152
    v_mfma_f32_16x16x32_bf16 v[36:39], v[64:67], v[100:103], v[36:39]
    buffer_load_dwordx4 v4, s[52:55], s14 offen offset:0 lds
    v_mfma_f32_16x16x32_bf16 v[40:43], v[64:67], v[104:107], v[40:43]
    ds_read_b128 v[160:163], v247 offset:2048
    v_mfma_f32_16x16x32_bf16 v[40:43], v[68:71], v[100:103], v[40:43]
    ds_read2_b32 v[128:129], v236 offset0:48 offset1:49
    v_mfma_f32_16x16x32_bf16 v[40:43], v[72:75], v[96:99], v[40:43]
    ds_read2_b32 v[130:131], v236 offset0:50 offset1:51
    v_mfma_f32_16x16x32_bf16 v[44:47], v[76:79], v[96:99], v[44:47]
    ds_read_b128 v[164:167], v247 offset:6144
    v_mfma_f32_16x16x32_bf16 v[44:47], v[72:75], v[100:103], v[44:47]
    ds_read2_b32 v[132:133], v236 offset0:176 offset1:177
    v_mfma_f32_16x16x32_bf16 v[44:47], v[68:71], v[104:107], v[44:47]
    ds_read2_b32 v[134:135], v236 offset0:178 offset1:179
    v_mfma_f32_16x16x32_bf16 v[44:47], v[64:67], v[108:111], v[44:47]
    v_mov_b32 v9, 8
    buffer_load_ushort v9, v9, s[56:59], s70 offen
    s_waitcnt lgkmcnt(6)
    v_mfma_f32_16x16x32_bf16 v[48:51], v[64:67], v[112:115], v[48:51]
    ds_read_b128 v[168:171], v247 offset:10240
    v_mfma_f32_16x16x32_bf16 v[48:51], v[68:71], v[108:111], v[48:51]
    ds_read2_b32 v[136:137], v237 offset0:48 offset1:49
    v_mfma_f32_16x16x32_bf16 v[48:51], v[72:75], v[104:107], v[48:51]
    ds_read2_b32 v[138:139], v237 offset0:50 offset1:51
    v_mfma_f32_16x16x32_bf16 v[48:51], v[76:79], v[100:103], v[48:51]
    ds_read_b128 v[172:175], v247 offset:14336
    v_mfma_f32_16x16x32_bf16 v[48:51], v[80:83], v[96:99], v[48:51]
    v_mfma_f32_16x16x32_bf16 v[52:55], v[84:87], v[96:99], v[52:55]
    ds_read2_b32 v[140:141], v237 offset0:176 offset1:177
    v_mfma_f32_16x16x32_bf16 v[52:55], v[80:83], v[100:103], v[52:55]
    ds_read2_b32 v[142:143], v237 offset0:178 offset1:179
    v_mfma_f32_16x16x32_bf16 v[52:55], v[76:79], v[104:107], v[52:55]
    ds_read_b128 v[176:179], v247 offset:18432
    v_mfma_f32_16x16x32_bf16 v[52:55], v[72:75], v[108:111], v[52:55]
    ds_read2_b32 v[144:145], v238 offset0:48 offset1:49
    v_mfma_f32_16x16x32_bf16 v[52:55], v[68:71], v[112:115], v[52:55]
    s_add_u32 m0, s73, 49152
    v_mfma_f32_16x16x32_bf16 v[52:55], v[64:67], v[116:119], v[52:55]
    buffer_load_dwordx4 v5, s[52:55], s14 offen offset:1024 lds
    v_mfma_f32_16x16x32_bf16 v[56:59], v[64:67], v[120:123], v[56:59]
    ds_read2_b32 v[146:147], v238 offset0:50 offset1:51
    v_mfma_f32_16x16x32_bf16 v[56:59], v[68:71], v[116:119], v[56:59]
    ds_read_b128 v[180:183], v247 offset:22528
    v_mfma_f32_16x16x32_bf16 v[56:59], v[72:75], v[112:115], v[56:59]
    v_mfma_f32_16x16x32_bf16 v[56:59], v[76:79], v[108:111], v[56:59]
    ds_read2_b32 v[148:149], v238 offset0:176 offset1:177
    v_mfma_f32_16x16x32_bf16 v[56:59], v[80:83], v[104:107], v[56:59]
    ds_read2_b32 v[150:151], v238 offset0:178 offset1:179
    v_mfma_f32_16x16x32_bf16 v[56:59], v[84:87], v[100:103], v[56:59]
    ds_read_b128 v[184:187], v247 offset:26624
    v_mfma_f32_16x16x32_bf16 v[56:59], v[88:91], v[96:99], v[56:59]
    v_mfma_f32_16x16x32_bf16 v[60:63], v[92:95], v[96:99], v[60:63]
    ds_read2_b32 v[152:153], v239 offset0:48 offset1:49
    v_mfma_f32_16x16x32_bf16 v[60:63], v[88:91], v[100:103], v[60:63]
    ds_read2_b32 v[154:155], v239 offset0:50 offset1:51
    v_mfma_f32_16x16x32_bf16 v[60:63], v[84:87], v[104:107], v[60:63]
    v_mfma_f32_16x16x32_bf16 v[60:63], v[80:83], v[108:111], v[60:63]
    ds_read_b128 v[188:191], v247 offset:30720
    v_mfma_f32_16x16x32_bf16 v[60:63], v[76:79], v[112:115], v[60:63]
    ds_read2_b32 v[156:157], v239 offset0:176 offset1:177
    v_mfma_f32_16x16x32_bf16 v[60:63], v[72:75], v[116:119], v[60:63]
    v_mfma_f32_16x16x32_bf16 v[60:63], v[68:71], v[120:123], v[60:63]
    ds_read2_b32 v[158:159], v239 offset0:178 offset1:179
    v_mfma_f32_16x16x32_bf16 v[60:63], v[64:67], v[124:127], v[60:63]
    s_waitcnt lgkmcnt(12)
    v_mfma_f32_16x16x32_bf16 v[32:35], v[128:131], v[160:163], v[32:35]
    ds_read_b128 v[96:99], v244 offset:0
    v_mfma_f32_16x16x32_bf16 v[36:39], v[132:135], v[160:163], v[36:39]
    s_add_u32 m0, s73, 49152
    v_mfma_f32_16x16x32_bf16 v[36:39], v[128:131], v[164:167], v[36:39]
    buffer_load_dwordx4 v6, s[52:55], s14 offen offset:2048 lds
    v_mfma_f32_16x16x32_bf16 v[40:43], v[128:131], v[168:171], v[40:43]
    ds_read2_b32 v[64:65], v236 offset0:64 offset1:65
    v_mfma_f32_16x16x32_bf16 v[40:43], v[132:135], v[164:167], v[40:43]
    ds_read2_b32 v[66:67], v236 offset0:66 offset1:67
    v_mfma_f32_16x16x32_bf16 v[40:43], v[136:139], v[160:163], v[40:43]
    ds_read_b128 v[100:103], v244 offset:4096
    v_mfma_f32_16x16x32_bf16 v[44:47], v[140:143], v[160:163], v[44:47]
    ds_read2_b32 v[68:69], v236 offset0:192 offset1:193
    v_mfma_f32_16x16x32_bf16 v[44:47], v[136:139], v[164:167], v[44:47]
    ds_read2_b32 v[70:71], v236 offset0:194 offset1:195
    v_mfma_f32_16x16x32_bf16 v[44:47], v[132:135], v[168:171], v[44:47]
    ds_read_b128 v[104:107], v244 offset:8192
    v_mfma_f32_16x16x32_bf16 v[44:47], v[128:131], v[172:175], v[44:47]
    s_waitcnt lgkmcnt(7)
    v_mfma_f32_16x16x32_bf16 v[48:51], v[128:131], v[176:179], v[48:51]
    ds_read2_b32 v[72:73], v237 offset0:64 offset1:65
    v_mfma_f32_16x16x32_bf16 v[48:51], v[132:135], v[172:175], v[48:51]
    ds_read2_b32 v[74:75], v237 offset0:66 offset1:67
    v_mfma_f32_16x16x32_bf16 v[48:51], v[136:139], v[168:171], v[48:51]
    ds_read_b128 v[108:111], v244 offset:12288
    v_mfma_f32_16x16x32_bf16 v[48:51], v[140:143], v[164:167], v[48:51]
    ds_read2_b32 v[76:77], v237 offset0:192 offset1:193
    v_mfma_f32_16x16x32_bf16 v[48:51], v[144:147], v[160:163], v[48:51]
    ds_read2_b32 v[78:79], v237 offset0:194 offset1:195
    v_mfma_f32_16x16x32_bf16 v[52:55], v[148:151], v[160:163], v[52:55]
    ds_read_b128 v[112:115], v244 offset:16384
    v_mfma_f32_16x16x32_bf16 v[52:55], v[144:147], v[164:167], v[52:55]
    s_waitcnt vmcnt(4)
    ds_read2_b32 v[80:81], v238 offset0:64 offset1:65
    v_mfma_f32_16x16x32_bf16 v[52:55], v[140:143], v[168:171], v[52:55]
    ds_read_b128 v[212:215], v241 offset:8352
    v_mfma_f32_16x16x32_bf16 v[52:55], v[136:139], v[172:175], v[52:55]
    ds_read_b32 v216, v241 offset:8368
    v_mfma_f32_16x16x32_bf16 v[52:55], v[132:135], v[176:179], v[52:55]
    s_add_u32 m0, s73, 49152
    ds_read2_b32 v[82:83], v238 offset0:66 offset1:67
    v_mfma_f32_16x16x32_bf16 v[52:55], v[128:131], v[180:183], v[52:55]
    buffer_load_dwordx4 v7, s[52:55], s14 offen offset:3072 lds
    v_mfma_f32_16x16x32_bf16 v[56:59], v[128:131], v[184:187], v[56:59]
    ds_read_b128 v[116:119], v244 offset:20480
    v_mfma_f32_16x16x32_bf16 v[56:59], v[132:135], v[180:183], v[56:59]
    ds_read_b128 v[218:221], v241 offset:9376
    v_mfma_f32_16x16x32_bf16 v[56:59], v[136:139], v[176:179], v[56:59]
    ds_read_b64_tr_b16 a[0:1], v10 offset:16384
    v_mfma_f32_16x16x32_bf16 v[56:59], v[140:143], v[172:175], v[56:59]
    ds_read_b64_tr_b16 a[2:3], v10 offset:18432
    ds_read2_b32 v[84:85], v238 offset0:192 offset1:193
    v_mfma_f32_16x16x32_bf16 v[56:59], v[144:147], v[168:171], v[56:59]
    ds_read_b64_tr_b16 a[4:5], v11 offset:16384
    ds_read2_b32 v[86:87], v238 offset0:194 offset1:195
    v_mfma_f32_16x16x32_bf16 v[56:59], v[148:151], v[164:167], v[56:59]
    ds_read_b32 v222, v241 offset:9392
    ds_read_b128 v[120:123], v244 offset:24576
    v_mfma_f32_16x16x32_bf16 v[56:59], v[152:155], v[160:163], v[56:59]
    ds_read_b64_tr_b16 a[6:7], v11 offset:18432
    v_mfma_f32_16x16x32_bf16 v[60:63], v[156:159], v[160:163], v[60:63]
    ds_read_b64_tr_b16 a[8:9], v12 offset:16384
    ds_read2_b32 v[88:89], v239 offset0:64 offset1:65
    v_mfma_f32_16x16x32_bf16 v[60:63], v[152:155], v[164:167], v[60:63]
    ds_read_b128 v[224:227], v241 offset:10400
    ds_read2_b32 v[90:91], v239 offset0:66 offset1:67
    v_mfma_f32_16x16x32_bf16 v[60:63], v[148:151], v[168:171], v[60:63]
    ds_read_b64_tr_b16 a[10:11], v12 offset:18432
    v_mfma_f32_16x16x32_bf16 v[60:63], v[144:147], v[172:175], v[60:63]
    ds_read_b64_tr_b16 a[12:13], v13 offset:16384
    ds_read_b128 v[124:127], v244 offset:28672
    v_mfma_f32_16x16x32_bf16 v[60:63], v[140:143], v[176:179], v[60:63]
    ds_read_b32 v228, v241 offset:10416
    ds_read2_b32 v[92:93], v239 offset0:192 offset1:193
    v_mfma_f32_16x16x32_bf16 v[60:63], v[136:139], v[180:183], v[60:63]
    ds_read_b64_tr_b16 a[14:15], v13 offset:18432
    v_mfma_f32_16x16x32_bf16 v[60:63], v[132:135], v[184:187], v[60:63]
    ds_read_b128 v[230:233], v241 offset:11424
    ds_read2_b32 v[94:95], v239 offset0:194 offset1:195
    v_mfma_f32_16x16x32_bf16 v[60:63], v[128:131], v[188:191], v[60:63]
    ds_read_b32 v234, v241 offset:11440
    s_waitcnt lgkmcnt(15)
    v_mfma_f32_16x16x32_bf16 v[32:35], v[64:67], v[96:99], v[32:35]
    s_waitcnt lgkmcnt(3)
    s_lshl_b32 s14, s86, 17
    v_mfma_f32_16x16x32_bf16 v[36:39], v[68:71], v[96:99], v[36:39]
    s_add_u32 m0, s73, 147456
    ds_read_b128 v[160:163], v245 offset:0
    v_mfma_f32_16x16x32_bf16 v[36:39], v[64:67], v[100:103], v[36:39]
    buffer_load_dwordx4 v4, s[52:55], s14 offen offset:0 lds
    v_mfma_f32_16x16x32_bf16 v[40:43], v[64:67], v[104:107], v[40:43]
    ds_read2_b32 v[128:129], v236 offset0:80 offset1:81
    v_mfma_f32_16x16x32_bf16 v[40:43], v[68:71], v[100:103], v[40:43]
    ds_read2_b32 v[130:131], v236 offset0:82 offset1:83
    v_mfma_f32_16x16x32_bf16 v[40:43], v[72:75], v[96:99], v[40:43]
    s_waitcnt lgkmcnt(3)
    ds_read_b128 v[164:167], v245 offset:4096
    v_mfma_f32_16x16x32_bf16 v[44:47], v[76:79], v[96:99], v[44:47]
    ds_read2_b32 v[132:133], v236 offset0:208 offset1:209
    v_mfma_f32_16x16x32_bf16 v[44:47], v[72:75], v[100:103], v[44:47]
    ds_read2_b32 v[134:135], v236 offset0:210 offset1:211
    v_mfma_f32_16x16x32_bf16 v[44:47], v[68:71], v[104:107], v[44:47]
    ds_write_b16 v242, v212 offset:12480
    v_mfma_f32_16x16x32_bf16 v[44:47], v[64:67], v[108:111], v[44:47]
    ds_read_b128 v[168:171], v245 offset:8192
    v_mfma_f32_16x16x32_bf16 v[48:51], v[64:67], v[112:115], v[48:51]
    v_alignbit_b32 v212, v213, v212, 16
    v_mfma_f32_16x16x32_bf16 v[48:51], v[68:71], v[108:111], v[48:51]
    ds_read2_b32 v[136:137], v237 offset0:80 offset1:81
    v_mfma_f32_16x16x32_bf16 v[48:51], v[72:75], v[104:107], v[48:51]
    ds_read2_b32 v[138:139], v237 offset0:82 offset1:83
    v_mfma_f32_16x16x32_bf16 v[48:51], v[76:79], v[100:103], v[48:51]
    v_alignbit_b32 v213, v214, v213, 16
    v_mfma_f32_16x16x32_bf16 v[48:51], v[80:83], v[96:99], v[48:51]
    ds_read_b128 v[172:175], v245 offset:12288
    v_mfma_f32_16x16x32_bf16 v[52:55], v[84:87], v[96:99], v[52:55]
    ds_read2_b32 v[140:141], v237 offset0:208 offset1:209
    v_mfma_f32_16x16x32_bf16 v[52:55], v[80:83], v[100:103], v[52:55]
    v_alignbit_b32 v214, v215, v214, 16
    v_mfma_f32_16x16x32_bf16 v[52:55], v[76:79], v[104:107], v[52:55]
    ds_read2_b32 v[142:143], v237 offset0:210 offset1:211
    v_mfma_f32_16x16x32_bf16 v[52:55], v[72:75], v[108:111], v[52:55]
    v_alignbit_b32 v215, v216, v215, 16
    ds_read_b128 v[176:179], v245 offset:16384
    v_mfma_f32_16x16x32_bf16 v[52:55], v[68:71], v[112:115], v[52:55]
    s_add_u32 m0, s73, 147456
    ds_read2_b32 v[144:145], v238 offset0:80 offset1:81
    v_mfma_f32_16x16x32_bf16 v[52:55], v[64:67], v[116:119], v[52:55]
    buffer_load_dwordx4 v5, s[52:55], s14 offen offset:1024 lds
    v_mfma_f32_16x16x32_bf16 v[56:59], v[64:67], v[120:123], v[56:59]
    ds_write_b128 v241, v[212:215] offset:12512
    v_mfma_f32_16x16x32_bf16 v[56:59], v[68:71], v[116:119], v[56:59]
    ds_read2_b32 v[146:147], v238 offset0:82 offset1:83
    v_mfma_f32_16x16x32_bf16 v[56:59], v[72:75], v[112:115], v[56:59]
    ds_read_b128 v[180:183], v245 offset:20480
    v_mfma_f32_16x16x32_bf16 v[56:59], v[76:79], v[108:111], v[56:59]
    v_alignbit_b32 v218, v219, v218, 16
    ds_read2_b32 v[148:149], v238 offset0:208 offset1:209
    v_mfma_f32_16x16x32_bf16 v[56:59], v[80:83], v[104:107], v[56:59]
    ds_read2_b32 v[150:151], v238 offset0:210 offset1:211
    v_mfma_f32_16x16x32_bf16 v[56:59], v[84:87], v[100:103], v[56:59]
    v_alignbit_b32 v219, v220, v219, 16
    v_mfma_f32_16x16x32_bf16 v[56:59], v[88:91], v[96:99], v[56:59]
    ds_read_b128 v[184:187], v245 offset:24576
    v_mfma_f32_16x16x32_bf16 v[60:63], v[92:95], v[96:99], v[60:63]
    ds_read2_b32 v[152:153], v239 offset0:80 offset1:81
    v_mfma_f32_16x16x32_bf16 v[60:63], v[88:91], v[100:103], v[60:63]
    v_alignbit_b32 v220, v221, v220, 16
    v_mfma_f32_16x16x32_bf16 v[60:63], v[84:87], v[104:107], v[60:63]
    ds_read2_b32 v[154:155], v239 offset0:82 offset1:83
    v_mfma_f32_16x16x32_bf16 v[60:63], v[80:83], v[108:111], v[60:63]
    ds_read_b128 v[188:191], v245 offset:28672
    v_mfma_f32_16x16x32_bf16 v[60:63], v[76:79], v[112:115], v[60:63]
    v_alignbit_b32 v221, v222, v221, 16
    ds_read2_b32 v[156:157], v239 offset0:208 offset1:209
    v_mfma_f32_16x16x32_bf16 v[60:63], v[72:75], v[116:119], v[60:63]
    ds_read2_b32 v[158:159], v239 offset0:210 offset1:211
    v_mfma_f32_16x16x32_bf16 v[60:63], v[68:71], v[120:123], v[60:63]
    ds_write_b128 v241, v[218:221] offset:13536
    v_mfma_f32_16x16x32_bf16 v[60:63], v[64:67], v[124:127], v[60:63]
    s_waitcnt lgkmcnt(14)
    v_mfma_f32_16x16x32_bf16 v[32:35], v[128:131], v[160:163], v[32:35]
    v_alignbit_b32 v224, v225, v224, 16
    ds_read_b128 v[96:99], v246 offset:0
    v_mfma_f32_16x16x32_bf16 v[36:39], v[132:135], v[160:163], v[36:39]
    s_add_u32 m0, s73, 147456
    ds_read2_b32 v[64:65], v236 offset0:96 offset1:97
    v_mfma_f32_16x16x32_bf16 v[36:39], v[128:131], v[164:167], v[36:39]
    buffer_load_dwordx4 v6, s[52:55], s14 offen offset:2048 lds
    v_mfma_f32_16x16x32_bf16 v[40:43], v[128:131], v[168:171], v[40:43]
    v_alignbit_b32 v225, v226, v225, 16
    ds_read2_b32 v[66:67], v236 offset0:98 offset1:99
    v_mfma_f32_16x16x32_bf16 v[40:43], v[132:135], v[164:167], v[40:43]
    ds_read_b128 v[100:103], v246 offset:4096
    v_mfma_f32_16x16x32_bf16 v[40:43], v[136:139], v[160:163], v[40:43]
    v_alignbit_b32 v226, v227, v226, 16
    v_mfma_f32_16x16x32_bf16 v[44:47], v[140:143], v[160:163], v[44:47]
    ds_read2_b32 v[68:69], v236 offset0:224 offset1:225
    v_mfma_f32_16x16x32_bf16 v[44:47], v[136:139], v[164:167], v[44:47]
    v_alignbit_b32 v227, v228, v227, 16
    ds_read2_b32 v[70:71], v236 offset0:226 offset1:227
    v_mfma_f32_16x16x32_bf16 v[44:47], v[132:135], v[168:171], v[44:47]
    ds_read_b128 v[104:107], v246 offset:8192
    v_mfma_f32_16x16x32_bf16 v[44:47], v[128:131], v[172:175], v[44:47]
    ds_read2_b32 v[72:73], v237 offset0:96 offset1:97
    s_waitcnt lgkmcnt(9)
    v_mfma_f32_16x16x32_bf16 v[48:51], v[128:131], v[176:179], v[48:51]
    ds_write_b128 v241, v[224:227] offset:14560
    v_mfma_f32_16x16x32_bf16 v[48:51], v[132:135], v[172:175], v[48:51]
    v_alignbit_b32 v230, v231, v230, 16
    ds_read2_b32 v[74:75], v237 offset0:98 offset1:99
    v_mfma_f32_16x16x32_bf16 v[48:51], v[136:139], v[168:171], v[48:51]
    v_alignbit_b32 v231, v232, v231, 16
    ds_read_b128 v[108:111], v246 offset:12288
    v_mfma_f32_16x16x32_bf16 v[48:51], v[140:143], v[164:167], v[48:51]
    v_alignbit_b32 v232, v233, v232, 16
    ds_read2_b32 v[76:77], v237 offset0:224 offset1:225
    v_mfma_f32_16x16x32_bf16 v[48:51], v[144:147], v[160:163], v[48:51]
    v_alignbit_b32 v233, v234, v233, 16
    ds_read2_b32 v[78:79], v237 offset0:226 offset1:227
    v_mfma_f32_16x16x32_bf16 v[52:55], v[148:151], v[160:163], v[52:55]
    ds_write_b128 v241, v[230:233] offset:15584
    v_mfma_f32_16x16x32_bf16 v[52:55], v[144:147], v[164:167], v[52:55]
    s_waitcnt vmcnt(6)
    ds_read_b128 v[112:115], v246 offset:16384
    v_mfma_f32_16x16x32_bf16 v[52:55], v[140:143], v[168:171], v[52:55]
    v_lshl_or_b32 v9, v9, 16, v9
    ds_read2_b32 v[80:81], v238 offset0:96 offset1:97
    v_mfma_f32_16x16x32_bf16 v[52:55], v[136:139], v[172:175], v[52:55]
    v_and_b32 v248, v9, v208
    ds_read2_b32 v[82:83], v238 offset0:98 offset1:99
    v_mfma_f32_16x16x32_bf16 v[52:55], v[132:135], v[176:179], v[52:55]
    s_add_u32 m0, s73, 147456
    ds_read_b128 v[116:119], v246 offset:20480
    v_mfma_f32_16x16x32_bf16 v[52:55], v[128:131], v[180:183], v[52:55]
    buffer_load_dwordx4 v7, s[52:55], s14 offen offset:3072 lds
    v_mfma_f32_16x16x32_bf16 v[56:59], v[128:131], v[184:187], v[56:59]
    s_waitcnt vmcnt(4)
    ds_read2_b32 v[84:85], v238 offset0:224 offset1:225
    v_mfma_f32_16x16x32_bf16 v[56:59], v[132:135], v[180:183], v[56:59]
    v_add_u32 v10, -131072, v10
    ds_read2_b32 v[86:87], v238 offset0:226 offset1:227
    v_mfma_f32_16x16x32_bf16 v[56:59], v[136:139], v[176:179], v[56:59]
    ds_read_b64_tr_b16 a[16:17], v10 offset:49152
    v_mfma_f32_16x16x32_bf16 v[56:59], v[140:143], v[172:175], v[56:59]
    ds_read_b64_tr_b16 a[18:19], v10 offset:51200
    v_mfma_f32_16x16x32_bf16 v[56:59], v[144:147], v[168:171], v[56:59]
    v_add_u32 v11, -131072, v11
    ds_read_b128 v[120:123], v246 offset:24576
    v_mfma_f32_16x16x32_bf16 v[56:59], v[148:151], v[164:167], v[56:59]
    ds_read_b64_tr_b16 a[20:21], v11 offset:49152
    v_mfma_f32_16x16x32_bf16 v[56:59], v[152:155], v[160:163], v[56:59]
    ds_read_b64_tr_b16 a[22:23], v11 offset:51200
    v_mfma_f32_16x16x32_bf16 v[60:63], v[156:159], v[160:163], v[60:63]
    v_add_u32 v12, -131072, v12
    ds_read2_b32 v[88:89], v239 offset0:96 offset1:97
    v_mfma_f32_16x16x32_bf16 v[60:63], v[152:155], v[164:167], v[60:63]
    ds_read_b64_tr_b16 a[24:25], v12 offset:49152
    ds_read2_b32 v[90:91], v239 offset0:98 offset1:99
    v_mfma_f32_16x16x32_bf16 v[60:63], v[148:151], v[168:171], v[60:63]
    ds_read_b64_tr_b16 a[26:27], v12 offset:51200
    ds_read_b128 v[124:127], v246 offset:28672
    v_mfma_f32_16x16x32_bf16 v[60:63], v[144:147], v[172:175], v[60:63]
    v_add_u32 v13, -131072, v13
    v_and_b32 v249, v9, v209
    v_mfma_f32_16x16x32_bf16 v[60:63], v[140:143], v[176:179], v[60:63]
    ds_read_b64_tr_b16 a[28:29], v13 offset:49152
    ds_read2_b32 v[92:93], v239 offset0:224 offset1:225
    v_mfma_f32_16x16x32_bf16 v[60:63], v[136:139], v[180:183], v[60:63]
    ds_read_b64_tr_b16 a[30:31], v13 offset:51200
    ds_read2_b32 v[94:95], v239 offset0:226 offset1:227
    v_mfma_f32_16x16x32_bf16 v[60:63], v[132:135], v[184:187], v[60:63]
    v_and_b32 v250, v9, v210
    v_and_b32 v251, v9, v211
    v_mfma_f32_16x16x32_bf16 v[60:63], v[128:131], v[188:191], v[60:63]
    s_waitcnt lgkmcnt(15)
    v_mfma_f32_16x16x32_bf16 v[32:35], v[64:67], v[96:99], v[32:35]
    s_waitcnt lgkmcnt(1)
    s_lshl_b32 s14, s87, 17
    v_mfma_f32_16x16x32_bf16 v[36:39], v[68:71], v[96:99], v[36:39]
    s_add_u32 m0, s73, 49152
    v_mfma_f32_16x16x32_bf16 v[36:39], v[64:67], v[100:103], v[36:39]
    buffer_load_dwordx4 v4, s[52:55], s14 offen offset:0 lds
    v_mfma_f32_16x16x32_bf16 v[40:43], v[64:67], v[104:107], v[40:43]
    ds_read_b128 v[160:163], v247 offset:0
    v_mfma_f32_16x16x32_bf16 v[40:43], v[68:71], v[100:103], v[40:43]
L_pl_X_2:
    s_cbranch_execz L_pl_X_6
    ds_read_b128 v[164:167], v247 offset:4096
    v_mfma_f32_16x16x32_bf16 v[40:43], v[72:75], v[96:99], v[40:43]
    ds_read_b128 v[168:171], v247 offset:8192
    v_mfma_f32_16x16x32_bf16 v[44:47], v[76:79], v[96:99], v[44:47]
    ds_read_b128 v[172:175], v247 offset:12288
    v_mfma_f32_16x16x32_bf16 v[44:47], v[72:75], v[100:103], v[44:47]
    ds_read_b128 v[176:179], v247 offset:16384
    v_mfma_f32_16x16x32_bf16 v[44:47], v[68:71], v[104:107], v[44:47]
    ds_read_b128 v[180:183], v247 offset:20480
    v_mfma_f32_16x16x32_bf16 v[44:47], v[64:67], v[108:111], v[44:47]
    s_waitcnt lgkmcnt(6)
    v_mfma_f32_16x16x32_bf16 v[48:51], v[64:67], v[112:115], v[48:51]
    ds_read_b128 v[184:187], v247 offset:24576
    v_mfma_f32_16x16x32_bf16 v[48:51], v[68:71], v[108:111], v[48:51]
    ds_read_b128 v[188:191], v247 offset:28672
    v_mfma_f32_16x16x32_bf16 v[48:51], v[72:75], v[104:107], v[48:51]
    ds_read2_b32 v[128:129], v236 offset0:112 offset1:113
    v_mfma_f32_16x16x32_bf16 v[48:51], v[76:79], v[100:103], v[48:51]
    ds_read2_b32 v[130:131], v236 offset0:114 offset1:115
    v_mfma_f32_16x16x32_bf16 v[48:51], v[80:83], v[96:99], v[48:51]
    ds_read2_b32 v[132:133], v236 offset0:240 offset1:241
    v_mfma_f32_16x16x32_bf16 v[52:55], v[84:87], v[96:99], v[52:55]
    ds_read2_b32 v[134:135], v236 offset0:242 offset1:243
    v_mfma_f32_16x16x32_bf16 v[52:55], v[80:83], v[100:103], v[52:55]
    ds_read2_b32 v[136:137], v237 offset0:112 offset1:113
    v_mfma_f32_16x16x32_bf16 v[52:55], v[76:79], v[104:107], v[52:55]
    ds_read2_b32 v[138:139], v237 offset0:114 offset1:115
    v_mfma_f32_16x16x32_bf16 v[52:55], v[72:75], v[108:111], v[52:55]
    s_add_u32 s6, s12, 4718592
    ds_read2_b32 v[140:141], v237 offset0:240 offset1:241
    v_mfma_f32_16x16x32_bf16 v[52:55], v[68:71], v[112:115], v[52:55]
    s_add_u32 m0, s73, 49152
    ds_read2_b32 v[142:143], v237 offset0:242 offset1:243
    v_mfma_f32_16x16x32_bf16 v[52:55], v[64:67], v[116:119], v[52:55]
    buffer_load_dwordx4 v5, s[52:55], s14 offen offset:1024 lds
    v_mfma_f32_16x16x32_bf16 v[56:59], v[64:67], v[120:123], v[56:59]
    v_xor_b32 v244, 64, v244
    ds_read2_b32 v[144:145], v238 offset0:112 offset1:113
    v_mfma_f32_16x16x32_bf16 v[56:59], v[68:71], v[116:119], v[56:59]
    ds_read2_b32 v[146:147], v238 offset0:114 offset1:115
    v_mfma_f32_16x16x32_bf16 v[56:59], v[72:75], v[112:115], v[56:59]
    ds_read2_b32 v[148:149], v238 offset0:240 offset1:241
    v_mfma_f32_16x16x32_bf16 v[56:59], v[76:79], v[108:111], v[56:59]
    v_xor_b32 v245, 64, v245
    ds_read2_b32 v[150:151], v238 offset0:242 offset1:243
    v_mfma_f32_16x16x32_bf16 v[56:59], v[80:83], v[104:107], v[56:59]
    ds_read2_b32 v[152:153], v239 offset0:112 offset1:113
    v_mfma_f32_16x16x32_bf16 v[56:59], v[84:87], v[100:103], v[56:59]
    ds_read2_b32 v[154:155], v239 offset0:114 offset1:115
    v_mfma_f32_16x16x32_bf16 v[56:59], v[88:91], v[96:99], v[56:59]
    ds_read2_b32 v[156:157], v239 offset0:240 offset1:241
    v_mfma_f32_16x16x32_bf16 v[60:63], v[92:95], v[96:99], v[60:63]
    ds_read2_b32 v[158:159], v239 offset0:242 offset1:243
    v_mfma_f32_16x16x32_bf16 v[60:63], v[88:91], v[100:103], v[60:63]
    v_xor_b32 v246, 64, v246
    v_mfma_f32_16x16x32_bf16 v[60:63], v[84:87], v[104:107], v[60:63]
    v_add_u32 v236, 8320, v236
    v_mfma_f32_16x16x32_bf16 v[60:63], v[80:83], v[108:111], v[60:63]
    v_add_u32 v237, 8320, v237
    v_mfma_f32_16x16x32_bf16 v[60:63], v[76:79], v[112:115], v[60:63]
    v_add_u32 v238, 8320, v238
    v_mfma_f32_16x16x32_bf16 v[60:63], v[72:75], v[116:119], v[60:63]
    v_xor_b32 v247, 64, v247
    v_mfma_f32_16x16x32_bf16 v[60:63], v[68:71], v[120:123], v[60:63]
    v_add_u32 v239, 8320, v239
    v_mfma_f32_16x16x32_bf16 v[60:63], v[64:67], v[124:127], v[60:63]
    s_waitcnt lgkmcnt(0)
    v_mfma_f32_16x16x32_bf16 v[60:63], v[128:131], v[188:191], v[60:63]
    ds_read_b128 v[96:99], v244 offset:2048
    v_mfma_f32_16x16x32_bf16 v[60:63], v[132:135], v[184:187], v[60:63]
    s_add_u32 m0, s73, 49152
    ds_read2_b32 v[64:65], v236 offset0:0 offset1:1
    v_mfma_f32_16x16x32_bf16 v[60:63], v[136:139], v[180:183], v[60:63]
    buffer_load_dwordx4 v6, s[52:55], s14 offen offset:2048 lds
    v_mfma_f32_16x16x32_bf16 v[60:63], v[140:143], v[176:179], v[60:63]
    ds_read2_b32 v[66:67], v236 offset0:2 offset1:3
    v_mfma_f32_16x16x32_bf16 v[60:63], v[144:147], v[172:175], v[60:63]
    ds_read_b128 v[100:103], v244 offset:6144
    v_mfma_f32_16x16x32_bf16 v[60:63], v[148:151], v[168:171], v[60:63]
    ds_read2_b32 v[68:69], v236 offset0:128 offset1:129
    v_mfma_f32_16x16x32_bf16 v[60:63], v[152:155], v[164:167], v[60:63]
    ds_read2_b32 v[70:71], v236 offset0:130 offset1:131
    v_mfma_f32_16x16x32_bf16 v[60:63], v[156:159], v[160:163], v[60:63]
    ds_read_b128 v[104:107], v244 offset:10240
    v_mfma_f32_16x16x32_bf16 v[56:59], v[128:131], v[184:187], v[56:59]
    ds_read2_b32 v[72:73], v237 offset0:0 offset1:1
    v_mfma_f32_16x16x32_bf16 v[56:59], v[132:135], v[180:183], v[56:59]
    ds_read2_b32 v[74:75], v237 offset0:2 offset1:3
    v_mfma_f32_16x16x32_bf16 v[56:59], v[136:139], v[176:179], v[56:59]
    ds_read_b128 v[108:111], v244 offset:14336
    v_mfma_f32_16x16x32_bf16 v[56:59], v[140:143], v[172:175], v[56:59]
    ds_read2_b32 v[76:77], v237 offset0:128 offset1:129
    v_mfma_f32_16x16x32_bf16 v[56:59], v[144:147], v[168:171], v[56:59]
    ds_read2_b32 v[78:79], v237 offset0:130 offset1:131
    v_mfma_f32_16x16x32_bf16 v[56:59], v[148:151], v[164:167], v[56:59]
    v_cvt_pk_bf16_f32 v206, v60, v61
    ds_read_b128 v[112:115], v244 offset:18432
    v_mfma_f32_16x16x32_bf16 v[56:59], v[152:155], v[160:163], v[56:59]
    ds_read2_b32 v[80:81], v238 offset0:0 offset1:1
    v_mfma_f32_16x16x32_bf16 v[52:55], v[128:131], v[180:183], v[52:55]
    ds_read2_b32 v[82:83], v238 offset0:2 offset1:3
    ds_read_b128 v[116:119], v244 offset:22528
    v_mfma_f32_16x16x32_bf16 v[52:55], v[132:135], v[176:179], v[52:55]
    v_cvt_pk_bf16_f32 v207, v62, v63
    ds_read2_b32 v[84:85], v238 offset0:128 offset1:129
    v_mfma_f32_16x16x32_bf16 v[52:55], v[136:139], v[172:175], v[52:55]
    ds_read2_b32 v[86:87], v238 offset0:130 offset1:131
    ds_read_b128 v[120:123], v244 offset:26624
    v_mfma_f32_16x16x32_bf16 v[52:55], v[140:143], v[168:171], v[52:55]
    buffer_store_dwordx2 v[206:207], v8, s[44:47], s6 offen offset:3584 sc1
    v_mfma_f32_16x16x32_bf16 v[52:55], v[144:147], v[164:167], v[52:55]
    s_add_u32 m0, s73, 49152
    ds_read2_b32 v[88:89], v239 offset0:0 offset1:1
    v_mfma_f32_16x16x32_bf16 v[52:55], v[148:151], v[160:163], v[52:55]
    buffer_load_dwordx4 v7, s[52:55], s14 offen offset:3072 lds
    v_mfma_f32_16x16x32_bf16 v[48:51], v[128:131], v[176:179], v[48:51]
    s_waitcnt vmcnt(5)
    v_cvt_pk_bf16_f32 v204, v56, v57
    v_mfma_f32_16x16x32_bf16 v[48:51], v[132:135], v[172:175], v[48:51]
    v_add_u32 v10, 131072, v10
    v_cvt_pk_bf16_f32 v205, v58, v59
    v_mfma_f32_16x16x32_bf16 v[48:51], v[136:139], v[168:171], v[48:51]
    ds_read_b64_tr_b16 a[32:33], v10 offset:16384
    ds_read2_b32 v[90:91], v239 offset0:2 offset1:3
    v_mfma_f32_16x16x32_bf16 v[48:51], v[140:143], v[164:167], v[48:51]
    ds_read_b64_tr_b16 a[34:35], v10 offset:18432
    ds_read_b128 v[124:127], v244 offset:30720
    v_mfma_f32_16x16x32_bf16 v[48:51], v[144:147], v[160:163], v[48:51]
    v_add_u32 v11, 131072, v11
    buffer_store_dwordx2 v[204:205], v8, s[44:47], s6 offen offset:3072 sc1
    v_mfma_f32_16x16x32_bf16 v[44:47], v[128:131], v[172:175], v[44:47]
    ds_read_b64_tr_b16 a[36:37], v11 offset:16384
    ds_read2_b32 v[92:93], v239 offset0:128 offset1:129
    v_mfma_f32_16x16x32_bf16 v[44:47], v[132:135], v[168:171], v[44:47]
    ds_read_b64_tr_b16 a[38:39], v11 offset:18432
    ds_read2_b32 v[94:95], v239 offset0:130 offset1:131
    v_mfma_f32_16x16x32_bf16 v[44:47], v[136:139], v[164:167], v[44:47]
    v_add_u32 v12, 131072, v12
    v_cvt_pk_bf16_f32 v202, v52, v53
    v_mfma_f32_16x16x32_bf16 v[44:47], v[140:143], v[160:163], v[44:47]
    ds_read_b64_tr_b16 a[40:41], v12 offset:16384
    v_mfma_f32_16x16x32_bf16 v[40:43], v[128:131], v[168:171], v[40:43]
    ds_read_b64_tr_b16 a[42:43], v12 offset:18432
    v_mfma_f32_16x16x32_bf16 v[40:43], v[132:135], v[164:167], v[40:43]
    v_add_u32 v13, 131072, v13
    v_cvt_pk_bf16_f32 v203, v54, v55
    v_mfma_f32_16x16x32_bf16 v[40:43], v[136:139], v[160:163], v[40:43]
    ds_read_b64_tr_b16 a[44:45], v13 offset:16384
    v_mfma_f32_16x16x32_bf16 v[36:39], v[128:131], v[164:167], v[36:39]
    ds_read_b64_tr_b16 a[46:47], v13 offset:18432
    v_mfma_f32_16x16x32_bf16 v[36:39], v[132:135], v[160:163], v[36:39]
    buffer_store_dwordx2 v[202:203], v8, s[44:47], s6 offen offset:2560 sc1
    v_mfma_f32_16x16x32_bf16 v[32:35], v[128:131], v[160:163], v[32:35]
    s_waitcnt lgkmcnt(4)
    v_mfma_f32_16x16x32_bf16 v[60:63], v[248:251], v[124:127], 0
    s_waitcnt lgkmcnt(0)
    s_lshl_b32 s14, s88, 17
    v_mfma_f32_16x16x32_bf16 v[60:63], v[64:67], v[124:127], v[60:63]
    s_add_u32 m0, s73, 147456
    ds_read_b128 v[160:163], v245 offset:2048
    v_mfma_f32_16x16x32_bf16 v[60:63], v[68:71], v[120:123], v[60:63]
    buffer_load_dwordx4 v4, s[52:55], s14 offen offset:0 lds
    v_mfma_f32_16x16x32_bf16 v[60:63], v[72:75], v[116:119], v[60:63]
    v_cvt_pk_bf16_f32 v200, v48, v49
    v_mfma_f32_16x16x32_bf16 v[60:63], v[76:79], v[112:115], v[60:63]
    v_cvt_pk_bf16_f32 v201, v50, v51
    v_mfma_f32_16x16x32_bf16 v[60:63], v[80:83], v[108:111], v[60:63]
    ds_read2_b32 v[128:129], v236 offset0:16 offset1:17
    v_mfma_f32_16x16x32_bf16 v[60:63], v[84:87], v[104:107], v[60:63]
    buffer_store_dwordx2 v[200:201], v8, s[44:47], s6 offen offset:2048 sc1
    v_mfma_f32_16x16x32_bf16 v[60:63], v[88:91], v[100:103], v[60:63]
    ds_read2_b32 v[130:131], v236 offset0:18 offset1:19
    v_mfma_f32_16x16x32_bf16 v[60:63], v[92:95], v[96:99], v[60:63]
    v_cvt_pk_bf16_f32 v198, v44, v45
    v_mfma_f32_16x16x32_bf16 v[56:59], v[248:251], v[120:123], 0
    ds_read_b128 v[164:167], v245 offset:6144
    v_mfma_f32_16x16x32_bf16 v[56:59], v[64:67], v[120:123], v[56:59]
    ds_read2_b32 v[132:133], v236 offset0:144 offset1:145
    v_mfma_f32_16x16x32_bf16 v[56:59], v[68:71], v[116:119], v[56:59]
    v_cvt_pk_bf16_f32 v199, v46, v47
    v_mfma_f32_16x16x32_bf16 v[56:59], v[72:75], v[112:115], v[56:59]
    ds_read2_b32 v[134:135], v236 offset0:146 offset1:147
    v_mfma_f32_16x16x32_bf16 v[56:59], v[76:79], v[108:111], v[56:59]
    ds_read_b128 v[168:171], v245 offset:10240
    v_mfma_f32_16x16x32_bf16 v[56:59], v[80:83], v[104:107], v[56:59]
    buffer_store_dwordx2 v[198:199], v8, s[44:47], s6 offen offset:1536 sc1
    v_mfma_f32_16x16x32_bf16 v[56:59], v[84:87], v[100:103], v[56:59]
    ds_read2_b32 v[136:137], v237 offset0:16 offset1:17
    v_mfma_f32_16x16x32_bf16 v[56:59], v[88:91], v[96:99], v[56:59]
    v_cvt_pk_bf16_f32 v196, v40, v41
    v_mfma_f32_16x16x32_bf16 v[52:55], v[248:251], v[116:119], 0
    ds_read2_b32 v[138:139], v237 offset0:18 offset1:19
    v_mfma_f32_16x16x32_bf16 v[52:55], v[64:67], v[116:119], v[52:55]
    ds_read_b128 v[172:175], v245 offset:14336
    v_mfma_f32_16x16x32_bf16 v[52:55], v[68:71], v[112:115], v[52:55]
    v_cvt_pk_bf16_f32 v197, v42, v43
    v_mfma_f32_16x16x32_bf16 v[52:55], v[72:75], v[108:111], v[52:55]
    ds_read2_b32 v[140:141], v237 offset0:144 offset1:145
    v_mfma_f32_16x16x32_bf16 v[52:55], v[76:79], v[104:107], v[52:55]
    buffer_store_dwordx2 v[196:197], v8, s[44:47], s6 offen offset:1024 sc1
    v_mfma_f32_16x16x32_bf16 v[52:55], v[80:83], v[100:103], v[52:55]
    ds_read2_b32 v[142:143], v237 offset0:146 offset1:147
    v_mfma_f32_16x16x32_bf16 v[52:55], v[84:87], v[96:99], v[52:55]
    s_add_u32 m0, s73, 147456
    v_mfma_f32_16x16x32_bf16 v[48:51], v[248:251], v[112:115], 0
    buffer_load_dwordx4 v5, s[52:55], s14 offen offset:1024 lds
    v_mfma_f32_16x16x32_bf16 v[48:51], v[64:67], v[112:115], v[48:51]
    v_cvt_pk_bf16_f32 v194, v36, v37
    v_mfma_f32_16x16x32_bf16 v[48:51], v[68:71], v[108:111], v[48:51]
    v_cvt_pk_bf16_f32 v195, v38, v39
    v_mfma_f32_16x16x32_bf16 v[48:51], v[72:75], v[104:107], v[48:51]
    ds_read_b128 v[176:179], v245 offset:18432
    v_mfma_f32_16x16x32_bf16 v[48:51], v[76:79], v[100:103], v[48:51]
    ds_read2_b32 v[144:145], v238 offset0:16 offset1:17
    v_mfma_f32_16x16x32_bf16 v[48:51], v[80:83], v[96:99], v[48:51]
    buffer_store_dwordx2 v[194:195], v8, s[44:47], s6 offen offset:512 sc1
    v_mfma_f32_16x16x32_bf16 v[44:47], v[248:251], v[108:111], 0
    ds_read2_b32 v[146:147], v238 offset0:18 offset1:19
    v_mfma_f32_16x16x32_bf16 v[44:47], v[64:67], v[108:111], v[44:47]
    v_cvt_pk_bf16_f32 v192, v32, v33
    v_mfma_f32_16x16x32_bf16 v[44:47], v[68:71], v[104:107], v[44:47]
    ds_read_b128 v[180:183], v245 offset:22528
    v_mfma_f32_16x16x32_bf16 v[44:47], v[72:75], v[100:103], v[44:47]
    ds_read2_b32 v[148:149], v238 offset0:144 offset1:145
    v_mfma_f32_16x16x32_bf16 v[44:47], v[76:79], v[96:99], v[44:47]
    v_cvt_pk_bf16_f32 v193, v34, v35
    v_mfma_f32_16x16x32_bf16 v[40:43], v[248:251], v[104:107], 0
    ds_read2_b32 v[150:151], v238 offset0:146 offset1:147
    v_mfma_f32_16x16x32_bf16 v[40:43], v[64:67], v[104:107], v[40:43]
    buffer_store_dwordx2 v[192:193], v8, s[44:47], s6 offen offset:0 sc1
    v_mfma_f32_16x16x32_bf16 v[40:43], v[68:71], v[100:103], v[40:43]
    ds_read_b128 v[184:187], v245 offset:26624
    v_mfma_f32_16x16x32_bf16 v[40:43], v[72:75], v[96:99], v[40:43]
    ds_read2_b32 v[152:153], v239 offset0:16 offset1:17
    v_mfma_f32_16x16x32_bf16 v[36:39], v[248:251], v[100:103], 0
    ds_read2_b32 v[154:155], v239 offset0:18 offset1:19
    v_mfma_f32_16x16x32_bf16 v[36:39], v[64:67], v[100:103], v[36:39]
    ds_read_b128 v[188:191], v245 offset:30720
    v_mfma_f32_16x16x32_bf16 v[36:39], v[68:71], v[96:99], v[36:39]
    ds_read2_b32 v[156:157], v239 offset0:144 offset1:145
    v_mfma_f32_16x16x32_bf16 v[32:35], v[248:251], v[96:99], 0
    ds_read2_b32 v[158:159], v239 offset0:146 offset1:147
    v_mfma_f32_16x16x32_bf16 v[32:35], v[64:67], v[96:99], v[32:35]
    s_waitcnt lgkmcnt(12)
    v_mfma_f32_16x16x32_bf16 v[32:35], v[128:131], v[160:163], v[32:35]
    ds_read_b128 v[96:99], v246 offset:2048
    v_mfma_f32_16x16x32_bf16 v[36:39], v[132:135], v[160:163], v[36:39]
    s_add_u32 m0, s73, 147456
    ds_read2_b32 v[64:65], v236 offset0:32 offset1:33
    v_mfma_f32_16x16x32_bf16 v[36:39], v[128:131], v[164:167], v[36:39]
    buffer_load_dwordx4 v6, s[52:55], s14 offen offset:2048 lds
    v_mfma_f32_16x16x32_bf16 v[40:43], v[128:131], v[168:171], v[40:43]
    s_add_u32 s13, s12, 32768
    ds_read2_b32 v[66:67], v236 offset0:34 offset1:35
    v_mfma_f32_16x16x32_bf16 v[40:43], v[132:135], v[164:167], v[40:43]
    ds_read_b128 v[100:103], v246 offset:6144
    v_mfma_f32_16x16x32_bf16 v[40:43], v[136:139], v[160:163], v[40:43]
    s_add_u32 m0, s74, 32
    ds_read2_b32 v[68:69], v236 offset0:160 offset1:161
    v_mfma_f32_16x16x32_bf16 v[44:47], v[140:143], v[160:163], v[44:47]
    buffer_load_dwordx4 v240, s[48:51], s13 offen offset:0 lds
    v_mfma_f32_16x16x32_bf16 v[44:47], v[136:139], v[164:167], v[44:47]
    ds_read2_b32 v[70:71], v236 offset0:162 offset1:163
    v_mfma_f32_16x16x32_bf16 v[44:47], v[132:135], v[168:171], v[44:47]
    ds_read_b128 v[104:107], v246 offset:10240
    v_mfma_f32_16x16x32_bf16 v[44:47], v[128:131], v[172:175], v[44:47]
    ds_read2_b32 v[72:73], v237 offset0:32 offset1:33
    s_waitcnt lgkmcnt(8)
    v_mfma_f32_16x16x32_bf16 v[48:51], v[128:131], v[176:179], v[48:51]
    ds_read2_b32 v[74:75], v237 offset0:34 offset1:35
    v_mfma_f32_16x16x32_bf16 v[48:51], v[132:135], v[172:175], v[48:51]
    ds_read_b128 v[108:111], v246 offset:14336
    v_mfma_f32_16x16x32_bf16 v[48:51], v[136:139], v[168:171], v[48:51]
    ds_read2_b32 v[76:77], v237 offset0:160 offset1:161
    v_mfma_f32_16x16x32_bf16 v[48:51], v[140:143], v[164:167], v[48:51]
    s_add_u32 m0, s74, 32
    ds_read2_b32 v[78:79], v237 offset0:162 offset1:163
    v_mfma_f32_16x16x32_bf16 v[48:51], v[144:147], v[160:163], v[48:51]
    s_waitcnt vmcnt(11)
    buffer_load_dwordx4 v240, s[48:51], s13 offen offset:1024 lds
    v_mfma_f32_16x16x32_bf16 v[52:55], v[148:151], v[160:163], v[52:55]
    v_add_u32 v10, -131072, v10
    ds_read_b128 v[112:115], v246 offset:18432
    v_mfma_f32_16x16x32_bf16 v[52:55], v[144:147], v[164:167], v[52:55]
    ds_read_b64_tr_b16 a[48:49], v10 offset:49152
    v_mfma_f32_16x16x32_bf16 v[52:55], v[140:143], v[168:171], v[52:55]
    ds_read_b64_tr_b16 a[50:51], v10 offset:51200
    v_mfma_f32_16x16x32_bf16 v[52:55], v[136:139], v[172:175], v[52:55]
    v_add_u32 v11, -131072, v11
    ds_read2_b32 v[80:81], v238 offset0:32 offset1:33
    v_mfma_f32_16x16x32_bf16 v[52:55], v[132:135], v[176:179], v[52:55]
    s_add_u32 m0, s73, 147456
    ds_read_b64_tr_b16 a[52:53], v11 offset:49152
    v_mfma_f32_16x16x32_bf16 v[52:55], v[128:131], v[180:183], v[52:55]
    buffer_load_dwordx4 v7, s[52:55], s14 offen offset:3072 lds
    ds_read_b64_tr_b16 a[54:55], v11 offset:51200
    v_mfma_f32_16x16x32_bf16 v[56:59], v[128:131], v[184:187], v[56:59]
    v_add_u32 v12, -131072, v12
    s_add_u32 m0, s74, 32
    v_mfma_f32_16x16x32_bf16 v[56:59], v[132:135], v[180:183], v[56:59]
    ds_read_b64_tr_b16 a[56:57], v12 offset:49152
    buffer_load_dwordx4 v240, s[48:51], s13 offen offset:2048 lds
    v_mfma_f32_16x16x32_bf16 v[56:59], v[136:139], v[176:179], v[56:59]
    ds_read_b64_tr_b16 a[58:59], v12 offset:51200
    ds_read2_b32 v[82:83], v238 offset0:34 offset1:35
    v_mfma_f32_16x16x32_bf16 v[56:59], v[140:143], v[172:175], v[56:59]
    v_add_u32 v13, -131072, v13
    ds_read_b128 v[116:119], v246 offset:22528
    v_mfma_f32_16x16x32_bf16 v[56:59], v[144:147], v[168:171], v[56:59]
    ds_read_b64_tr_b16 a[60:61], v13 offset:49152
    ds_read2_b32 v[84:85], v238 offset0:160 offset1:161
    v_mfma_f32_16x16x32_bf16 v[56:59], v[148:151], v[164:167], v[56:59]
    ds_read_b64_tr_b16 a[62:63], v13 offset:51200
    v_mfma_f32_16x16x32_bf16 v[56:59], v[152:155], v[160:163], v[56:59]
    ds_read2_b32 v[86:87], v238 offset0:162 offset1:163
    v_mfma_f32_16x16x32_bf16 v[60:63], v[156:159], v[160:163], v[60:63]
    ds_read_b128 v[120:123], v246 offset:26624
    v_mfma_f32_16x16x32_bf16 v[60:63], v[152:155], v[164:167], v[60:63]
    s_add_u32 m0, s74, 32
    ds_read2_b32 v[88:89], v239 offset0:32 offset1:33
    v_mfma_f32_16x16x32_bf16 v[60:63], v[148:151], v[168:171], v[60:63]
    buffer_load_dwordx4 v240, s[48:51], s13 offen offset:3072 lds
    v_mfma_f32_16x16x32_bf16 v[60:63], v[144:147], v[172:175], v[60:63]
    ds_read2_b32 v[90:91], v239 offset0:34 offset1:35
    v_mfma_f32_16x16x32_bf16 v[60:63], v[140:143], v[176:179], v[60:63]
    ds_read_b128 v[124:127], v246 offset:30720
    v_mfma_f32_16x16x32_bf16 v[60:63], v[136:139], v[180:183], v[60:63]
    ds_read2_b32 v[92:93], v239 offset0:160 offset1:161
    v_mfma_f32_16x16x32_bf16 v[60:63], v[132:135], v[184:187], v[60:63]
    ds_read2_b32 v[94:95], v239 offset0:162 offset1:163
    v_mfma_f32_16x16x32_bf16 v[60:63], v[128:131], v[188:191], v[60:63]
    s_waitcnt lgkmcnt(15)
    v_mfma_f32_16x16x32_bf16 v[32:35], v[64:67], v[96:99], v[32:35]
    ds_read_b128 v[160:163], v247 offset:2048
    v_mfma_f32_16x16x32_bf16 v[36:39], v[68:71], v[96:99], v[36:39]
    v_mfma_f32_16x16x32_bf16 v[36:39], v[64:67], v[100:103], v[36:39]
    ds_read2_b32 v[128:129], v236 offset0:48 offset1:49
    v_mfma_f32_16x16x32_bf16 v[40:43], v[64:67], v[104:107], v[40:43]
    ds_read2_b32 v[130:131], v236 offset0:50 offset1:51
    v_mfma_f32_16x16x32_bf16 v[40:43], v[68:71], v[100:103], v[40:43]
    v_mfma_f32_16x16x32_bf16 v[40:43], v[72:75], v[96:99], v[40:43]
    ds_read_b128 v[164:167], v247 offset:6144
    v_mfma_f32_16x16x32_bf16 v[44:47], v[76:79], v[96:99], v[44:47]
    s_waitcnt lgkmcnt(11)
    s_barrier
    v_mfma_f32_16x16x32_bf16 v[44:47], v[72:75], v[100:103], v[44:47]
    ds_read2_b32 v[132:133], v236 offset0:176 offset1:177
    v_mfma_f32_16x16x32_bf16 v[44:47], v[68:71], v[104:107], v[44:47]
    ds_read2_b32 v[134:135], v236 offset0:178 offset1:179
    v_mfma_f32_16x16x32_bf16 v[44:47], v[64:67], v[108:111], v[44:47]
    v_mov_b32 v9, 16
    buffer_load_ushort v9, v9, s[56:59], s70 offen
    s_waitcnt lgkmcnt(6)
    v_mfma_f32_16x16x32_bf16 v[48:51], v[64:67], v[112:115], v[48:51]
    ds_read_b128 v[168:171], v247 offset:10240
    v_mfma_f32_16x16x32_bf16 v[48:51], v[68:71], v[108:111], v[48:51]
    ds_read2_b32 v[136:137], v237 offset0:48 offset1:49
    v_mfma_f32_16x16x32_bf16 v[48:51], v[72:75], v[104:107], v[48:51]
    ds_read2_b32 v[138:139], v237 offset0:50 offset1:51
    v_mfma_f32_16x16x32_bf16 v[48:51], v[76:79], v[100:103], v[48:51]
    ds_read_b128 v[172:175], v247 offset:14336
    v_mfma_f32_16x16x32_bf16 v[48:51], v[80:83], v[96:99], v[48:51]
    v_mfma_f32_16x16x32_bf16 v[52:55], v[84:87], v[96:99], v[52:55]
    ds_read2_b32 v[140:141], v237 offset0:176 offset1:177
    v_mfma_f32_16x16x32_bf16 v[52:55], v[80:83], v[100:103], v[52:55]
    ds_read2_b32 v[142:143], v237 offset0:178 offset1:179
    v_mfma_f32_16x16x32_bf16 v[52:55], v[76:79], v[104:107], v[52:55]
    v_mfma_f32_16x16x32_bf16 v[52:55], v[72:75], v[108:111], v[52:55]
    ds_read_b128 v[176:179], v247 offset:18432
    v_mfma_f32_16x16x32_bf16 v[52:55], v[68:71], v[112:115], v[52:55]
    ds_read2_b32 v[144:145], v238 offset0:48 offset1:49
    v_mfma_f32_16x16x32_bf16 v[52:55], v[64:67], v[116:119], v[52:55]
    v_mfma_f32_16x16x32_bf16 v[56:59], v[64:67], v[120:123], v[56:59]
    ds_read2_b32 v[146:147], v238 offset0:50 offset1:51
    v_mfma_f32_16x16x32_bf16 v[56:59], v[68:71], v[116:119], v[56:59]
    ds_read_b128 v[180:183], v247 offset:22528
    v_mfma_f32_16x16x32_bf16 v[56:59], v[72:75], v[112:115], v[56:59]
    v_mfma_f32_16x16x32_bf16 v[56:59], v[76:79], v[108:111], v[56:59]
    ds_read2_b32 v[148:149], v238 offset0:176 offset1:177
    v_mfma_f32_16x16x32_bf16 v[56:59], v[80:83], v[104:107], v[56:59]
    ds_read2_b32 v[150:151], v238 offset0:178 offset1:179
    v_mfma_f32_16x16x32_bf16 v[56:59], v[84:87], v[100:103], v[56:59]
    ds_read_b128 v[184:187], v247 offset:26624
    v_mfma_f32_16x16x32_bf16 v[56:59], v[88:91], v[96:99], v[56:59]
    v_mfma_f32_16x16x32_bf16 v[60:63], v[92:95], v[96:99], v[60:63]
    ds_read2_b32 v[152:153], v239 offset0:48 offset1:49
    v_mfma_f32_16x16x32_bf16 v[60:63], v[88:91], v[100:103], v[60:63]
    ds_read2_b32 v[154:155], v239 offset0:50 offset1:51
    v_mfma_f32_16x16x32_bf16 v[60:63], v[84:87], v[104:107], v[60:63]
    v_mfma_f32_16x16x32_bf16 v[60:63], v[80:83], v[108:111], v[60:63]
    ds_read_b128 v[188:191], v247 offset:30720
    v_mfma_f32_16x16x32_bf16 v[60:63], v[76:79], v[112:115], v[60:63]
    ds_read2_b32 v[156:157], v239 offset0:176 offset1:177
    v_mfma_f32_16x16x32_bf16 v[60:63], v[72:75], v[116:119], v[60:63]
    v_mfma_f32_16x16x32_bf16 v[60:63], v[68:71], v[120:123], v[60:63]
    ds_read2_b32 v[158:159], v239 offset0:178 offset1:179
    v_mfma_f32_16x16x32_bf16 v[60:63], v[64:67], v[124:127], v[60:63]
    s_waitcnt lgkmcnt(12)
    v_mfma_f32_16x16x32_bf16 v[32:35], v[128:131], v[160:163], v[32:35]
    ds_read_b128 v[96:99], v244 offset:0
    v_mfma_f32_16x16x32_bf16 v[36:39], v[132:135], v[160:163], v[36:39]
    ds_read2_b32 v[64:65], v236 offset0:64 offset1:65
    v_mfma_f32_16x16x32_bf16 v[36:39], v[128:131], v[164:167], v[36:39]
    ds_read2_b32 v[66:67], v236 offset0:66 offset1:67
    v_mfma_f32_16x16x32_bf16 v[40:43], v[128:131], v[168:171], v[40:43]
    ds_read_b128 v[100:103], v244 offset:4096
    v_mfma_f32_16x16x32_bf16 v[40:43], v[132:135], v[164:167], v[40:43]
    ds_read2_b32 v[68:69], v236 offset0:192 offset1:193
    v_mfma_f32_16x16x32_bf16 v[40:43], v[136:139], v[160:163], v[40:43]
    ds_read2_b32 v[70:71], v236 offset0:194 offset1:195
    v_mfma_f32_16x16x32_bf16 v[44:47], v[140:143], v[160:163], v[44:47]
    ds_read_b128 v[104:107], v244 offset:8192
    v_mfma_f32_16x16x32_bf16 v[44:47], v[136:139], v[164:167], v[44:47]
    s_add_u32 m0, s9, 36864
    s_add_u32 s13, s7, 128
    v_mfma_f32_16x16x32_bf16 v[44:47], v[132:135], v[168:171], v[44:47]
    buffer_load_dwordx4 v24, s[44:47], s13 offen sc1 lds
    v_mfma_f32_16x16x32_bf16 v[44:47], v[128:131], v[172:175], v[44:47]
    ds_read2_b32 v[72:73], v237 offset0:64 offset1:65
    s_waitcnt lgkmcnt(8)
    v_mfma_f32_16x16x32_bf16 v[48:51], v[128:131], v[176:179], v[48:51]
    ds_read2_b32 v[74:75], v237 offset0:66 offset1:67
    v_mfma_f32_16x16x32_bf16 v[48:51], v[132:135], v[172:175], v[48:51]
    ds_read_b128 v[108:111], v244 offset:12288
    v_mfma_f32_16x16x32_bf16 v[48:51], v[136:139], v[168:171], v[48:51]
    ds_read2_b32 v[76:77], v237 offset0:192 offset1:193
    v_mfma_f32_16x16x32_bf16 v[48:51], v[140:143], v[164:167], v[48:51]
    ds_read2_b32 v[78:79], v237 offset0:194 offset1:195
    v_mfma_f32_16x16x32_bf16 v[48:51], v[144:147], v[160:163], v[48:51]
    ds_read_b128 v[112:115], v244 offset:16384
    ds_read2_b32 v[80:81], v238 offset0:64 offset1:65
    v_mfma_f32_16x16x32_bf16 v[52:55], v[148:151], v[160:163], v[52:55]
    ds_read2_b32 v[82:83], v238 offset0:66 offset1:67
    ds_read_b128 v[116:119], v244 offset:20480
    v_mfma_f32_16x16x32_bf16 v[52:55], v[144:147], v[164:167], v[52:55]
    s_add_u32 m0, s9, 37888
    s_add_u32 s13, s7, 73856
    v_mfma_f32_16x16x32_bf16 v[52:55], v[140:143], v[168:171], v[52:55]
    buffer_load_dwordx4 v25, s[44:47], s13 offen sc1 lds
    v_mfma_f32_16x16x32_bf16 v[52:55], v[136:139], v[172:175], v[52:55]
    s_waitcnt vmcnt(3)
    ds_read_b128 v[212:215], v241 offset:32
    v_mfma_f32_16x16x32_bf16 v[52:55], v[132:135], v[176:179], v[52:55]
    ds_read_b32 v216, v241 offset:48
    ds_read2_b32 v[84:85], v238 offset0:192 offset1:193
    v_mfma_f32_16x16x32_bf16 v[52:55], v[128:131], v[180:183], v[52:55]
    ds_read_b128 v[218:221], v241 offset:1056
    ds_read2_b32 v[86:87], v238 offset0:194 offset1:195
    v_mfma_f32_16x16x32_bf16 v[56:59], v[128:131], v[184:187], v[56:59]
    ds_read_b32 v222, v241 offset:1072
    v_mfma_f32_16x16x32_bf16 v[56:59], v[132:135], v[180:183], v[56:59]
    v_add_u32 v10, 131072, v10
    ds_read_b128 v[224:227], v241 offset:2080
    v_mfma_f32_16x16x32_bf16 v[56:59], v[136:139], v[176:179], v[56:59]
    ds_read_b64_tr_b16 a[64:65], v10 offset:16384
    ds_read_b128 v[120:123], v244 offset:24576
    v_mfma_f32_16x16x32_bf16 v[56:59], v[140:143], v[172:175], v[56:59]
    ds_read_b64_tr_b16 a[66:67], v10 offset:18432
    ds_read2_b32 v[88:89], v239 offset0:64 offset1:65
    v_mfma_f32_16x16x32_bf16 v[56:59], v[144:147], v[168:171], v[56:59]
    v_add_u32 v11, 131072, v11
    s_add_u32 m0, s9, 38912
    s_add_u32 s13, s7, 147584
    v_mfma_f32_16x16x32_bf16 v[56:59], v[148:151], v[164:167], v[56:59]
    ds_read_b64_tr_b16 a[68:69], v11 offset:16384
    buffer_load_dwordx4 v24, s[44:47], s13 offen sc1 lds
    v_mfma_f32_16x16x32_bf16 v[56:59], v[152:155], v[160:163], v[56:59]
    ds_read_b64_tr_b16 a[70:71], v11 offset:18432
    ds_read2_b32 v[90:91], v239 offset0:66 offset1:67
    v_mfma_f32_16x16x32_bf16 v[60:63], v[156:159], v[160:163], v[60:63]
    v_add_u32 v12, 131072, v12
    ds_read_b32 v228, v241 offset:2096
    v_mfma_f32_16x16x32_bf16 v[60:63], v[152:155], v[164:167], v[60:63]
    ds_read_b64_tr_b16 a[72:73], v12 offset:16384
    ds_read_b128 v[124:127], v244 offset:28672
    v_mfma_f32_16x16x32_bf16 v[60:63], v[148:151], v[168:171], v[60:63]
    ds_read_b64_tr_b16 a[74:75], v12 offset:18432
    ds_read2_b32 v[92:93], v239 offset0:192 offset1:193
    v_mfma_f32_16x16x32_bf16 v[60:63], v[144:147], v[172:175], v[60:63]
    v_add_u32 v13, 131072, v13
    ds_read_b128 v[230:233], v241 offset:3104
    v_mfma_f32_16x16x32_bf16 v[60:63], v[140:143], v[176:179], v[60:63]
    ds_read_b64_tr_b16 a[76:77], v13 offset:16384
    ds_read2_b32 v[94:95], v239 offset0:194 offset1:195
    v_mfma_f32_16x16x32_bf16 v[60:63], v[136:139], v[180:183], v[60:63]
    ds_read_b64_tr_b16 a[78:79], v13 offset:18432
    ds_read_b32 v234, v241 offset:3120
    v_mfma_f32_16x16x32_bf16 v[60:63], v[132:135], v[184:187], v[60:63]
    s_add_u32 m0, s9, 39936
    s_add_u32 s13, s7, 221312
    v_mfma_f32_16x16x32_bf16 v[60:63], v[128:131], v[188:191], v[60:63]
    buffer_load_dwordx4 v25, s[44:47], s13 offen sc1 lds
    s_waitcnt lgkmcnt(15)
    v_mfma_f32_16x16x32_bf16 v[32:35], v[64:67], v[96:99], v[32:35]
    s_waitcnt lgkmcnt(1)
    s_lshl_b32 s14, s89, 17
    v_mfma_f32_16x16x32_bf16 v[36:39], v[68:71], v[96:99], v[36:39]
    s_add_u32 m0, s73, 147456
    ds_read_b128 v[160:163], v245 offset:0
    v_mfma_f32_16x16x32_bf16 v[36:39], v[64:67], v[100:103], v[36:39]
    buffer_load_dwordx4 v4, s[52:55], s14 offen offset:0 lds
    v_mfma_f32_16x16x32_bf16 v[40:43], v[64:67], v[104:107], v[40:43]
    ds_read2_b32 v[128:129], v236 offset0:80 offset1:81
    v_mfma_f32_16x16x32_bf16 v[40:43], v[68:71], v[100:103], v[40:43]
    ds_read2_b32 v[130:131], v236 offset0:82 offset1:83
    v_mfma_f32_16x16x32_bf16 v[40:43], v[72:75], v[96:99], v[40:43]
    s_waitcnt lgkmcnt(3)
    ds_read_b128 v[164:167], v245 offset:4096
    v_mfma_f32_16x16x32_bf16 v[44:47], v[76:79], v[96:99], v[44:47]
    ds_write_b16 v242, v212 offset:4160
    ds_read2_b32 v[132:133], v236 offset0:208 offset1:209
    v_mfma_f32_16x16x32_bf16 v[44:47], v[72:75], v[100:103], v[44:47]
    s_add_u32 m0, s9, 40960
    s_add_u32 s13, s7, 295040
    v_mfma_f32_16x16x32_bf16 v[44:47], v[68:71], v[104:107], v[44:47]
    buffer_load_dwordx4 v24, s[44:47], s13 offen sc1 lds
    v_mfma_f32_16x16x32_bf16 v[44:47], v[64:67], v[108:111], v[44:47]
    ds_read2_b32 v[134:135], v236 offset0:210 offset1:211
    v_mfma_f32_16x16x32_bf16 v[48:51], v[64:67], v[112:115], v[48:51]
    v_alignbit_b32 v212, v213, v212, 16
    ds_read_b128 v[168:171], v245 offset:8192
    v_mfma_f32_16x16x32_bf16 v[48:51], v[68:71], v[108:111], v[48:51]
    ds_read2_b32 v[136:137], v237 offset0:80 offset1:81
    v_mfma_f32_16x16x32_bf16 v[48:51], v[72:75], v[104:107], v[48:51]
    ds_read2_b32 v[138:139], v237 offset0:82 offset1:83
    v_mfma_f32_16x16x32_bf16 v[48:51], v[76:79], v[100:103], v[48:51]
L_pl_X_3:
    s_cbranch_execz L_pl_X_7
    v_alignbit_b32 v213, v214, v213, 16
    ds_read_b128 v[172:175], v245 offset:12288
    v_mfma_f32_16x16x32_bf16 v[48:51], v[80:83], v[96:99], v[48:51]
    ds_read2_b32 v[140:141], v237 offset0:208 offset1:209
    v_mfma_f32_16x16x32_bf16 v[52:55], v[84:87], v[96:99], v[52:55]
    v_alignbit_b32 v214, v215, v214, 16
    ds_read2_b32 v[142:143], v237 offset0:210 offset1:211
    v_mfma_f32_16x16x32_bf16 v[52:55], v[80:83], v[100:103], v[52:55]
    s_add_u32 m0, s9, 41984
    s_add_u32 s13, s7, 368768
    v_mfma_f32_16x16x32_bf16 v[52:55], v[76:79], v[104:107], v[52:55]
    buffer_load_dwordx4 v25, s[44:47], s13 offen sc1 lds
    v_mfma_f32_16x16x32_bf16 v[52:55], v[72:75], v[108:111], v[52:55]
    v_alignbit_b32 v215, v216, v215, 16
    ds_read_b128 v[176:179], v245 offset:16384
    v_mfma_f32_16x16x32_bf16 v[52:55], v[68:71], v[112:115], v[52:55]
    s_add_u32 m0, s73, 147456
    ds_read2_b32 v[144:145], v238 offset0:80 offset1:81
    v_mfma_f32_16x16x32_bf16 v[52:55], v[64:67], v[116:119], v[52:55]
    buffer_load_dwordx4 v5, s[52:55], s14 offen offset:1024 lds
    v_mfma_f32_16x16x32_bf16 v[56:59], v[64:67], v[120:123], v[56:59]
    ds_write_b128 v241, v[212:215] offset:4192
    v_mfma_f32_16x16x32_bf16 v[56:59], v[68:71], v[116:119], v[56:59]
    ds_read2_b32 v[146:147], v238 offset0:82 offset1:83
    ds_read_b128 v[180:183], v245 offset:20480
    v_mfma_f32_16x16x32_bf16 v[56:59], v[72:75], v[112:115], v[56:59]
    ds_read2_b32 v[148:149], v238 offset0:208 offset1:209
    v_mfma_f32_16x16x32_bf16 v[56:59], v[76:79], v[108:111], v[56:59]
    v_alignbit_b32 v218, v219, v218, 16
    ds_read2_b32 v[150:151], v238 offset0:210 offset1:211
    v_mfma_f32_16x16x32_bf16 v[56:59], v[80:83], v[104:107], v[56:59]
    s_add_u32 m0, s9, 43008
    s_add_u32 s13, s7, 442496
    v_mfma_f32_16x16x32_bf16 v[56:59], v[84:87], v[100:103], v[56:59]
    buffer_load_dwordx4 v24, s[44:47], s13 offen sc1 lds
    v_mfma_f32_16x16x32_bf16 v[56:59], v[88:91], v[96:99], v[56:59]
    v_alignbit_b32 v219, v220, v219, 16
    ds_read_b128 v[184:187], v245 offset:24576
    v_mfma_f32_16x16x32_bf16 v[60:63], v[92:95], v[96:99], v[60:63]
    ds_read2_b32 v[152:153], v239 offset0:80 offset1:81
    v_mfma_f32_16x16x32_bf16 v[60:63], v[88:91], v[100:103], v[60:63]
    v_alignbit_b32 v220, v221, v220, 16
    ds_read2_b32 v[154:155], v239 offset0:82 offset1:83
    v_mfma_f32_16x16x32_bf16 v[60:63], v[84:87], v[104:107], v[60:63]
    ds_read_b128 v[188:191], v245 offset:28672
    v_mfma_f32_16x16x32_bf16 v[60:63], v[80:83], v[108:111], v[60:63]
    ds_read2_b32 v[156:157], v239 offset0:208 offset1:209
    v_mfma_f32_16x16x32_bf16 v[60:63], v[76:79], v[112:115], v[60:63]
    v_alignbit_b32 v221, v222, v221, 16
    ds_read2_b32 v[158:159], v239 offset0:210 offset1:211
    v_mfma_f32_16x16x32_bf16 v[60:63], v[72:75], v[116:119], v[60:63]
    ds_write_b128 v241, v[218:221] offset:5216
    v_mfma_f32_16x16x32_bf16 v[60:63], v[68:71], v[120:123], v[60:63]
    s_add_u32 m0, s9, 44032
    s_add_u32 s13, s7, 516224
    v_mfma_f32_16x16x32_bf16 v[60:63], v[64:67], v[124:127], v[60:63]
    buffer_load_dwordx4 v25, s[44:47], s13 offen sc1 lds
    s_waitcnt lgkmcnt(14)
    v_mfma_f32_16x16x32_bf16 v[32:35], v[128:131], v[160:163], v[32:35]
    v_alignbit_b32 v224, v225, v224, 16
    ds_read_b128 v[96:99], v246 offset:0
    v_mfma_f32_16x16x32_bf16 v[36:39], v[132:135], v[160:163], v[36:39]
    s_add_u32 m0, s73, 147456
    ds_read2_b32 v[64:65], v236 offset0:96 offset1:97
    v_mfma_f32_16x16x32_bf16 v[36:39], v[128:131], v[164:167], v[36:39]
    buffer_load_dwordx4 v6, s[52:55], s14 offen offset:2048 lds
    v_mfma_f32_16x16x32_bf16 v[40:43], v[128:131], v[168:171], v[40:43]
    v_alignbit_b32 v225, v226, v225, 16
    ds_read2_b32 v[66:67], v236 offset0:98 offset1:99
    v_mfma_f32_16x16x32_bf16 v[40:43], v[132:135], v[164:167], v[40:43]
    ds_read_b128 v[100:103], v246 offset:4096
    v_mfma_f32_16x16x32_bf16 v[40:43], v[136:139], v[160:163], v[40:43]
    v_alignbit_b32 v226, v227, v226, 16
    v_mfma_f32_16x16x32_bf16 v[44:47], v[140:143], v[160:163], v[44:47]
    ds_read2_b32 v[68:69], v236 offset0:224 offset1:225
    v_mfma_f32_16x16x32_bf16 v[44:47], v[136:139], v[164:167], v[44:47]
    v_alignbit_b32 v227, v228, v227, 16
    v_mfma_f32_16x16x32_bf16 v[44:47], v[132:135], v[168:171], v[44:47]
    ds_read2_b32 v[70:71], v236 offset0:226 offset1:227
    v_mfma_f32_16x16x32_bf16 v[44:47], v[128:131], v[172:175], v[44:47]
    ds_read_b128 v[104:107], v246 offset:8192
    s_waitcnt lgkmcnt(8)
    v_mfma_f32_16x16x32_bf16 v[48:51], v[128:131], v[176:179], v[48:51]
    ds_write_b128 v241, v[224:227] offset:6240
    v_mfma_f32_16x16x32_bf16 v[48:51], v[132:135], v[172:175], v[48:51]
    ds_read2_b32 v[72:73], v237 offset0:96 offset1:97
    v_mfma_f32_16x16x32_bf16 v[48:51], v[136:139], v[168:171], v[48:51]
    v_alignbit_b32 v230, v231, v230, 16
    ds_read2_b32 v[74:75], v237 offset0:98 offset1:99
    v_mfma_f32_16x16x32_bf16 v[48:51], v[140:143], v[164:167], v[48:51]
    ds_read_b128 v[108:111], v246 offset:12288
    v_mfma_f32_16x16x32_bf16 v[48:51], v[144:147], v[160:163], v[48:51]
    v_alignbit_b32 v231, v232, v231, 16
    v_mfma_f32_16x16x32_bf16 v[52:55], v[148:151], v[160:163], v[52:55]
    ds_read2_b32 v[76:77], v237 offset0:224 offset1:225
    v_mfma_f32_16x16x32_bf16 v[52:55], v[144:147], v[164:167], v[52:55]
    v_alignbit_b32 v232, v233, v232, 16
    v_mfma_f32_16x16x32_bf16 v[52:55], v[140:143], v[168:171], v[52:55]
    ds_read2_b32 v[78:79], v237 offset0:226 offset1:227
    v_mfma_f32_16x16x32_bf16 v[52:55], v[136:139], v[172:175], v[52:55]
    v_alignbit_b32 v233, v234, v233, 16
    ds_read_b128 v[112:115], v246 offset:16384
    v_mfma_f32_16x16x32_bf16 v[52:55], v[132:135], v[176:179], v[52:55]
    s_add_u32 m0, s73, 147456
    ds_read2_b32 v[80:81], v238 offset0:96 offset1:97
    v_mfma_f32_16x16x32_bf16 v[52:55], v[128:131], v[180:183], v[52:55]
    buffer_load_dwordx4 v7, s[52:55], s14 offen offset:3072 lds
    v_mfma_f32_16x16x32_bf16 v[56:59], v[128:131], v[184:187], v[56:59]
    ds_write_b128 v241, v[230:233] offset:7264
    v_mfma_f32_16x16x32_bf16 v[56:59], v[132:135], v[180:183], v[56:59]
    ds_read2_b32 v[82:83], v238 offset0:98 offset1:99
    v_mfma_f32_16x16x32_bf16 v[56:59], v[136:139], v[176:179], v[56:59]
    s_waitcnt vmcnt(12)
    ds_read_b128 v[116:119], v246 offset:20480
    v_mfma_f32_16x16x32_bf16 v[56:59], v[140:143], v[172:175], v[56:59]
    ds_read2_b32 v[84:85], v238 offset0:224 offset1:225
    v_mfma_f32_16x16x32_bf16 v[56:59], v[144:147], v[168:171], v[56:59]
    v_lshl_or_b32 v9, v9, 16, v9
    ds_read2_b32 v[86:87], v238 offset0:226 offset1:227
    v_mfma_f32_16x16x32_bf16 v[56:59], v[148:151], v[164:167], v[56:59]
    ds_read_b128 v[120:123], v246 offset:24576
    v_mfma_f32_16x16x32_bf16 v[56:59], v[152:155], v[160:163], v[56:59]
    ds_read2_b32 v[88:89], v239 offset0:96 offset1:97
    v_mfma_f32_16x16x32_bf16 v[60:63], v[156:159], v[160:163], v[60:63]
    v_and_b32 v248, v9, v208
    v_mfma_f32_16x16x32_bf16 v[60:63], v[152:155], v[164:167], v[60:63]
    ds_read2_b32 v[90:91], v239 offset0:98 offset1:99
    v_mfma_f32_16x16x32_bf16 v[60:63], v[148:151], v[168:171], v[60:63]
    v_and_b32 v249, v9, v209
    v_mfma_f32_16x16x32_bf16 v[60:63], v[144:147], v[172:175], v[60:63]
    ds_read_b128 v[124:127], v246 offset:28672
    v_mfma_f32_16x16x32_bf16 v[60:63], v[140:143], v[176:179], v[60:63]
    v_and_b32 v250, v9, v210
    v_mfma_f32_16x16x32_bf16 v[60:63], v[136:139], v[180:183], v[60:63]
    ds_read2_b32 v[92:93], v239 offset0:224 offset1:225
    v_mfma_f32_16x16x32_bf16 v[60:63], v[132:135], v[184:187], v[60:63]
    v_and_b32 v251, v9, v211
    ds_read2_b32 v[94:95], v239 offset0:226 offset1:227
    v_mfma_f32_16x16x32_bf16 v[60:63], v[128:131], v[188:191], v[60:63]
    s_waitcnt lgkmcnt(13)
    v_mfma_f32_16x16x32_bf16 v[32:35], v[64:67], v[96:99], v[32:35]
    ds_read_b128 v[160:163], v247 offset:0
    v_mfma_f32_16x16x32_bf16 v[36:39], v[68:71], v[96:99], v[36:39]
    v_mfma_f32_16x16x32_bf16 v[36:39], v[64:67], v[100:103], v[36:39]
    ds_read_b128 v[164:167], v247 offset:4096
    v_mfma_f32_16x16x32_bf16 v[40:43], v[64:67], v[104:107], v[40:43]
    ds_read_b128 v[168:171], v247 offset:8192
    v_mfma_f32_16x16x32_bf16 v[40:43], v[68:71], v[100:103], v[40:43]
    ds_read_b128 v[172:175], v247 offset:12288
    v_mfma_f32_16x16x32_bf16 v[40:43], v[72:75], v[96:99], v[40:43]
    v_mfma_f32_16x16x32_bf16 v[44:47], v[76:79], v[96:99], v[44:47]
    ds_read_b128 v[176:179], v247 offset:16384
    v_mfma_f32_16x16x32_bf16 v[44:47], v[72:75], v[100:103], v[44:47]
    ds_read_b128 v[180:183], v247 offset:20480
    v_mfma_f32_16x16x32_bf16 v[44:47], v[68:71], v[104:107], v[44:47]
    ds_read_b128 v[184:187], v247 offset:24576
    v_mfma_f32_16x16x32_bf16 v[44:47], v[64:67], v[108:111], v[44:47]
    s_waitcnt lgkmcnt(7)
    v_mfma_f32_16x16x32_bf16 v[48:51], v[64:67], v[112:115], v[48:51]
    ds_read_b128 v[188:191], v247 offset:28672
    v_mfma_f32_16x16x32_bf16 v[48:51], v[68:71], v[108:111], v[48:51]
    ds_read2_b32 v[128:129], v236 offset0:112 offset1:113
    v_mfma_f32_16x16x32_bf16 v[48:51], v[72:75], v[104:107], v[48:51]
    v_mfma_f32_16x16x32_bf16 v[48:51], v[76:79], v[100:103], v[48:51]
    ds_read2_b32 v[130:131], v236 offset0:114 offset1:115
    v_mfma_f32_16x16x32_bf16 v[48:51], v[80:83], v[96:99], v[48:51]
    ds_read2_b32 v[132:133], v236 offset0:240 offset1:241
    v_mfma_f32_16x16x32_bf16 v[52:55], v[84:87], v[96:99], v[52:55]
    ds_read2_b32 v[134:135], v236 offset0:242 offset1:243
    v_mfma_f32_16x16x32_bf16 v[52:55], v[80:83], v[100:103], v[52:55]
    ds_read2_b32 v[136:137], v237 offset0:112 offset1:113
    v_mfma_f32_16x16x32_bf16 v[52:55], v[76:79], v[104:107], v[52:55]
    ds_read2_b32 v[138:139], v237 offset0:114 offset1:115
    v_mfma_f32_16x16x32_bf16 v[52:55], v[72:75], v[108:111], v[52:55]
    s_add_u32 s6, s12, 4734976
    ds_read2_b32 v[140:141], v237 offset0:240 offset1:241
    v_mfma_f32_16x16x32_bf16 v[52:55], v[68:71], v[112:115], v[52:55]
    v_xor_b32 v244, 64, v244
    ds_read2_b32 v[142:143], v237 offset0:242 offset1:243
    v_mfma_f32_16x16x32_bf16 v[52:55], v[64:67], v[116:119], v[52:55]
    ds_read2_b32 v[144:145], v238 offset0:112 offset1:113
    v_mfma_f32_16x16x32_bf16 v[56:59], v[64:67], v[120:123], v[56:59]
    v_xor_b32 v245, 64, v245
    v_mfma_f32_16x16x32_bf16 v[56:59], v[68:71], v[116:119], v[56:59]
    ds_read2_b32 v[146:147], v238 offset0:114 offset1:115
    v_mfma_f32_16x16x32_bf16 v[56:59], v[72:75], v[112:115], v[56:59]
    v_xor_b32 v246, 64, v246
    ds_read2_b32 v[148:149], v238 offset0:240 offset1:241
    v_mfma_f32_16x16x32_bf16 v[56:59], v[76:79], v[108:111], v[56:59]
    ds_read2_b32 v[150:151], v238 offset0:242 offset1:243
    v_mfma_f32_16x16x32_bf16 v[56:59], v[80:83], v[104:107], v[56:59]
    v_xor_b32 v247, 64, v247
    ds_read2_b32 v[152:153], v239 offset0:112 offset1:113
    v_mfma_f32_16x16x32_bf16 v[56:59], v[84:87], v[100:103], v[56:59]
    ds_read2_b32 v[154:155], v239 offset0:114 offset1:115
    v_mfma_f32_16x16x32_bf16 v[56:59], v[88:91], v[96:99], v[56:59]
    ds_read2_b32 v[156:157], v239 offset0:240 offset1:241
    v_mfma_f32_16x16x32_bf16 v[60:63], v[92:95], v[96:99], v[60:63]
    v_add_u32 v244, 36864, v244
    ds_read2_b32 v[158:159], v239 offset0:242 offset1:243
    v_mfma_f32_16x16x32_bf16 v[60:63], v[88:91], v[100:103], v[60:63]
    v_add_u32 v236, -8320, v236
    v_mfma_f32_16x16x32_bf16 v[60:63], v[84:87], v[104:107], v[60:63]
    v_add_u32 v245, 36864, v245
    v_mfma_f32_16x16x32_bf16 v[60:63], v[80:83], v[108:111], v[60:63]
    v_add_u32 v237, -8320, v237
    v_add_u32 v238, -8320, v238
    v_mfma_f32_16x16x32_bf16 v[60:63], v[76:79], v[112:115], v[60:63]
    v_add_u32 v246, 36864, v246
    v_add_u32 v239, -8320, v239
    v_mfma_f32_16x16x32_bf16 v[60:63], v[72:75], v[116:119], v[60:63]
    s_waitcnt vmcnt(2)
    s_barrier
    v_mfma_f32_16x16x32_bf16 v[60:63], v[68:71], v[120:123], v[60:63]
    v_add_u32 v247, 36864, v247
    v_mfma_f32_16x16x32_bf16 v[60:63], v[64:67], v[124:127], v[60:63]
    s_waitcnt lgkmcnt(0)
    v_mfma_f32_16x16x32_bf16 v[60:63], v[128:131], v[188:191], v[60:63]
    ds_read_b128 v[96:99], v244 offset:2048
    v_mfma_f32_16x16x32_bf16 v[60:63], v[132:135], v[184:187], v[60:63]
    ds_read2_b32 v[64:65], v236 offset0:0 offset1:1
    v_mfma_f32_16x16x32_bf16 v[60:63], v[136:139], v[180:183], v[60:63]
    ds_read2_b32 v[66:67], v236 offset0:2 offset1:3
    v_mfma_f32_16x16x32_bf16 v[60:63], v[140:143], v[176:179], v[60:63]
    ds_read_b128 v[100:103], v244 offset:6144
    v_mfma_f32_16x16x32_bf16 v[60:63], v[144:147], v[172:175], v[60:63]
    ds_read2_b32 v[68:69], v236 offset0:128 offset1:129
    v_mfma_f32_16x16x32_bf16 v[60:63], v[148:151], v[168:171], v[60:63]
    ds_read2_b32 v[70:71], v236 offset0:130 offset1:131
    v_mfma_f32_16x16x32_bf16 v[60:63], v[152:155], v[164:167], v[60:63]
    ds_read_b128 v[104:107], v244 offset:10240
    v_mfma_f32_16x16x32_bf16 v[60:63], v[156:159], v[160:163], v[60:63]
    ds_read2_b32 v[72:73], v237 offset0:0 offset1:1
    v_mfma_f32_16x16x32_bf16 v[56:59], v[128:131], v[184:187], v[56:59]
    ds_read2_b32 v[74:75], v237 offset0:2 offset1:3
    v_mfma_f32_16x16x32_bf16 v[56:59], v[132:135], v[180:183], v[56:59]
    ds_read_b128 v[108:111], v244 offset:14336
    v_mfma_f32_16x16x32_bf16 v[56:59], v[136:139], v[176:179], v[56:59]
    ds_read2_b32 v[76:77], v237 offset0:128 offset1:129
    v_mfma_f32_16x16x32_bf16 v[56:59], v[140:143], v[172:175], v[56:59]
    ds_read2_b32 v[78:79], v237 offset0:130 offset1:131
    v_mfma_f32_16x16x32_bf16 v[56:59], v[144:147], v[168:171], v[56:59]
    ds_read_b128 v[112:115], v244 offset:18432
    v_mfma_f32_16x16x32_bf16 v[56:59], v[148:151], v[164:167], v[56:59]
    v_cvt_pk_bf16_f32 v206, v60, v61
    ds_read2_b32 v[80:81], v238 offset0:0 offset1:1
    v_mfma_f32_16x16x32_bf16 v[56:59], v[152:155], v[160:163], v[56:59]
    ds_read2_b32 v[82:83], v238 offset0:2 offset1:3
    v_mfma_f32_16x16x32_bf16 v[52:55], v[128:131], v[180:183], v[52:55]
    ds_read_b128 v[116:119], v244 offset:22528
    v_mfma_f32_16x16x32_bf16 v[52:55], v[132:135], v[176:179], v[52:55]
    v_cvt_pk_bf16_f32 v207, v62, v63
    ds_read2_b32 v[84:85], v238 offset0:128 offset1:129
    v_mfma_f32_16x16x32_bf16 v[52:55], v[136:139], v[172:175], v[52:55]
    ds_read2_b32 v[86:87], v238 offset0:130 offset1:131
    v_mfma_f32_16x16x32_bf16 v[52:55], v[140:143], v[168:171], v[52:55]
    buffer_store_dwordx2 v[206:207], v8, s[44:47], s6 offen offset:3584 sc1
    v_mfma_f32_16x16x32_bf16 v[52:55], v[144:147], v[164:167], v[52:55]
    ds_read_b128 v[120:123], v244 offset:26624
    v_mfma_f32_16x16x32_bf16 v[52:55], v[148:151], v[160:163], v[52:55]
    v_cvt_pk_bf16_f32 v204, v56, v57
    ds_read2_b32 v[88:89], v239 offset0:0 offset1:1
    v_mfma_f32_16x16x32_bf16 v[48:51], v[128:131], v[176:179], v[48:51]
    s_waitcnt vmcnt(1)
    ds_read2_b32 v[90:91], v239 offset0:2 offset1:3
    v_mfma_f32_16x16x32_bf16 v[48:51], v[132:135], v[172:175], v[48:51]
    v_cvt_pk_bf16_f32 v205, v58, v59
    ds_read_b128 v[124:127], v244 offset:30720
    v_mfma_f32_16x16x32_bf16 v[48:51], v[136:139], v[168:171], v[48:51]
    ds_read_b64_tr_b16 a[80:81], v10 offset:16384
    v_mfma_f32_16x16x32_bf16 v[48:51], v[140:143], v[164:167], v[48:51]
    ds_read_b64_tr_b16 a[82:83], v10 offset:18432
    v_mfma_f32_16x16x32_bf16 v[48:51], v[144:147], v[160:163], v[48:51]
    ds_read_b64_tr_b16 a[84:85], v11 offset:16384
    v_mfma_f32_16x16x32_bf16 v[44:47], v[128:131], v[172:175], v[44:47]
    buffer_store_dwordx2 v[204:205], v8, s[44:47], s6 offen offset:3072 sc1
    v_mfma_f32_16x16x32_bf16 v[44:47], v[132:135], v[168:171], v[44:47]
    ds_read_b64_tr_b16 a[86:87], v11 offset:18432
    ds_read2_b32 v[92:93], v239 offset0:128 offset1:129
    v_mfma_f32_16x16x32_bf16 v[44:47], v[136:139], v[164:167], v[44:47]
    ds_read_b64_tr_b16 a[88:89], v12 offset:16384
    ds_read2_b32 v[94:95], v239 offset0:130 offset1:131
    v_mfma_f32_16x16x32_bf16 v[44:47], v[140:143], v[160:163], v[44:47]
    v_cvt_pk_bf16_f32 v202, v52, v53
    v_mfma_f32_16x16x32_bf16 v[40:43], v[128:131], v[168:171], v[40:43]
    ds_read_b64_tr_b16 a[90:91], v12 offset:18432
    v_mfma_f32_16x16x32_bf16 v[40:43], v[132:135], v[164:167], v[40:43]
    ds_read_b64_tr_b16 a[92:93], v13 offset:16384
    v_mfma_f32_16x16x32_bf16 v[40:43], v[136:139], v[160:163], v[40:43]
    v_cvt_pk_bf16_f32 v203, v54, v55
    v_mfma_f32_16x16x32_bf16 v[36:39], v[128:131], v[164:167], v[36:39]
    ds_read_b64_tr_b16 a[94:95], v13 offset:18432
    v_mfma_f32_16x16x32_bf16 v[36:39], v[132:135], v[160:163], v[36:39]
    buffer_store_dwordx2 v[202:203], v8, s[44:47], s6 offen offset:2560 sc1
    v_mfma_f32_16x16x32_bf16 v[32:35], v[128:131], v[160:163], v[32:35]
    s_waitcnt lgkmcnt(3)
    v_mfma_f32_16x16x32_bf16 v[60:63], v[248:251], v[124:127], 0
    s_waitcnt lgkmcnt(0)
    s_lshl_b32 s14, s90, 17
    v_mfma_f32_16x16x32_bf16 v[60:63], v[64:67], v[124:127], v[60:63]
    s_add_u32 m0, s73, 147456
    ds_read_b128 v[160:163], v245 offset:2048
    v_mfma_f32_16x16x32_bf16 v[60:63], v[68:71], v[120:123], v[60:63]
    buffer_load_dwordx4 v4, s[52:55], s14 offen offset:0 lds
    v_mfma_f32_16x16x32_bf16 v[60:63], v[72:75], v[116:119], v[60:63]
    v_cvt_pk_bf16_f32 v200, v48, v49
    ds_read2_b32 v[128:129], v236 offset0:16 offset1:17
    v_mfma_f32_16x16x32_bf16 v[60:63], v[76:79], v[112:115], v[60:63]
    v_cvt_pk_bf16_f32 v201, v50, v51
    v_mfma_f32_16x16x32_bf16 v[60:63], v[80:83], v[108:111], v[60:63]
    ds_read2_b32 v[130:131], v236 offset0:18 offset1:19
    v_mfma_f32_16x16x32_bf16 v[60:63], v[84:87], v[104:107], v[60:63]
    buffer_store_dwordx2 v[200:201], v8, s[44:47], s6 offen offset:2048 sc1
    v_mfma_f32_16x16x32_bf16 v[60:63], v[88:91], v[100:103], v[60:63]
    ds_read_b128 v[164:167], v245 offset:6144
    v_mfma_f32_16x16x32_bf16 v[60:63], v[92:95], v[96:99], v[60:63]
    v_cvt_pk_bf16_f32 v198, v44, v45
    v_mfma_f32_16x16x32_bf16 v[56:59], v[248:251], v[120:123], 0
    ds_read2_b32 v[132:133], v236 offset0:144 offset1:145
    v_mfma_f32_16x16x32_bf16 v[56:59], v[64:67], v[120:123], v[56:59]
    ds_read2_b32 v[134:135], v236 offset0:146 offset1:147
    v_mfma_f32_16x16x32_bf16 v[56:59], v[68:71], v[116:119], v[56:59]
    v_cvt_pk_bf16_f32 v199, v46, v47
    v_mfma_f32_16x16x32_bf16 v[56:59], v[72:75], v[112:115], v[56:59]
    ds_read_b128 v[168:171], v245 offset:10240
    v_mfma_f32_16x16x32_bf16 v[56:59], v[76:79], v[108:111], v[56:59]
    ds_read2_b32 v[136:137], v237 offset0:16 offset1:17
    v_mfma_f32_16x16x32_bf16 v[56:59], v[80:83], v[104:107], v[56:59]
    buffer_store_dwordx2 v[198:199], v8, s[44:47], s6 offen offset:1536 sc1
    v_mfma_f32_16x16x32_bf16 v[56:59], v[84:87], v[100:103], v[56:59]
    ds_read2_b32 v[138:139], v237 offset0:18 offset1:19
    v_mfma_f32_16x16x32_bf16 v[56:59], v[88:91], v[96:99], v[56:59]
    v_cvt_pk_bf16_f32 v196, v40, v41
    v_mfma_f32_16x16x32_bf16 v[52:55], v[248:251], v[116:119], 0
    s_add_u32 m0, s73, 147456
    ds_read_b128 v[172:175], v245 offset:14336
    v_mfma_f32_16x16x32_bf16 v[52:55], v[64:67], v[116:119], v[52:55]
    buffer_load_dwordx4 v5, s[52:55], s14 offen offset:1024 lds
    v_mfma_f32_16x16x32_bf16 v[52:55], v[68:71], v[112:115], v[52:55]
    v_cvt_pk_bf16_f32 v197, v42, v43
    v_mfma_f32_16x16x32_bf16 v[52:55], v[72:75], v[108:111], v[52:55]
    ds_read2_b32 v[140:141], v237 offset0:144 offset1:145
    v_mfma_f32_16x16x32_bf16 v[52:55], v[76:79], v[104:107], v[52:55]
    buffer_store_dwordx2 v[196:197], v8, s[44:47], s6 offen offset:1024 sc1
    v_mfma_f32_16x16x32_bf16 v[52:55], v[80:83], v[100:103], v[52:55]
    ds_read2_b32 v[142:143], v237 offset0:146 offset1:147
    v_mfma_f32_16x16x32_bf16 v[52:55], v[84:87], v[96:99], v[52:55]
    ds_read_b128 v[176:179], v245 offset:18432
    v_mfma_f32_16x16x32_bf16 v[48:51], v[248:251], v[112:115], 0
    v_cvt_pk_bf16_f32 v194, v36, v37
    v_mfma_f32_16x16x32_bf16 v[48:51], v[64:67], v[112:115], v[48:51]
    ds_read2_b32 v[144:145], v238 offset0:16 offset1:17
    v_mfma_f32_16x16x32_bf16 v[48:51], v[68:71], v[108:111], v[48:51]
    v_cvt_pk_bf16_f32 v195, v38, v39
    v_mfma_f32_16x16x32_bf16 v[48:51], v[72:75], v[104:107], v[48:51]
    ds_read2_b32 v[146:147], v238 offset0:18 offset1:19
    v_mfma_f32_16x16x32_bf16 v[48:51], v[76:79], v[100:103], v[48:51]
    ds_read_b128 v[180:183], v245 offset:22528
    v_mfma_f32_16x16x32_bf16 v[48:51], v[80:83], v[96:99], v[48:51]
    buffer_store_dwordx2 v[194:195], v8, s[44:47], s6 offen offset:512 sc1
    v_mfma_f32_16x16x32_bf16 v[44:47], v[248:251], v[108:111], 0
    ds_read2_b32 v[148:149], v238 offset0:144 offset1:145
    v_mfma_f32_16x16x32_bf16 v[44:47], v[64:67], v[108:111], v[44:47]
    v_cvt_pk_bf16_f32 v192, v32, v33
    v_mfma_f32_16x16x32_bf16 v[44:47], v[68:71], v[104:107], v[44:47]
    ds_read2_b32 v[150:151], v238 offset0:146 offset1:147
    v_mfma_f32_16x16x32_bf16 v[44:47], v[72:75], v[100:103], v[44:47]
    v_cvt_pk_bf16_f32 v193, v34, v35
    v_mfma_f32_16x16x32_bf16 v[44:47], v[76:79], v[96:99], v[44:47]
    s_add_u32 m0, s73, 147456
    v_mfma_f32_16x16x32_bf16 v[40:43], v[248:251], v[104:107], 0
    buffer_load_dwordx4 v6, s[52:55], s14 offen offset:2048 lds
    v_mfma_f32_16x16x32_bf16 v[40:43], v[64:67], v[104:107], v[40:43]
    buffer_store_dwordx2 v[192:193], v8, s[44:47], s6 offen offset:0 sc1
    v_mfma_f32_16x16x32_bf16 v[40:43], v[68:71], v[100:103], v[40:43]
    ds_read_b128 v[184:187], v245 offset:26624
    v_mfma_f32_16x16x32_bf16 v[40:43], v[72:75], v[96:99], v[40:43]
    ds_read2_b32 v[152:153], v239 offset0:16 offset1:17
    v_mfma_f32_16x16x32_bf16 v[36:39], v[248:251], v[100:103], 0
    ds_read2_b32 v[154:155], v239 offset0:18 offset1:19
    v_mfma_f32_16x16x32_bf16 v[36:39], v[64:67], v[100:103], v[36:39]
    ds_read_b128 v[188:191], v245 offset:30720
    v_mfma_f32_16x16x32_bf16 v[36:39], v[68:71], v[96:99], v[36:39]
    ds_read2_b32 v[156:157], v239 offset0:144 offset1:145
    v_mfma_f32_16x16x32_bf16 v[32:35], v[248:251], v[96:99], 0
    ds_read2_b32 v[158:159], v239 offset0:146 offset1:147
    v_mfma_f32_16x16x32_bf16 v[32:35], v[64:67], v[96:99], v[32:35]
    s_waitcnt lgkmcnt(12)
    v_mfma_f32_16x16x32_bf16 v[32:35], v[128:131], v[160:163], v[32:35]
    ds_read_b128 v[96:99], v246 offset:2048
    v_mfma_f32_16x16x32_bf16 v[36:39], v[132:135], v[160:163], v[36:39]
    ds_read2_b32 v[64:65], v236 offset0:32 offset1:33
    v_mfma_f32_16x16x32_bf16 v[36:39], v[128:131], v[164:167], v[36:39]
    s_barrier
    v_mfma_f32_16x16x32_bf16 v[40:43], v[128:131], v[168:171], v[40:43]
    s_add_u32 s13, s12, 49152
    ds_read2_b32 v[66:67], v236 offset0:34 offset1:35
    v_mfma_f32_16x16x32_bf16 v[40:43], v[132:135], v[164:167], v[40:43]
    ds_read_b128 v[100:103], v246 offset:6144
    v_mfma_f32_16x16x32_bf16 v[40:43], v[136:139], v[160:163], v[40:43]
    s_add_u32 m0, s73, 147456
    ds_read2_b32 v[68:69], v236 offset0:160 offset1:161
    v_mfma_f32_16x16x32_bf16 v[44:47], v[140:143], v[160:163], v[44:47]
    buffer_load_dwordx4 v7, s[52:55], s14 offen offset:3072 lds
    v_mfma_f32_16x16x32_bf16 v[44:47], v[136:139], v[164:167], v[44:47]
    s_add_u32 m0, s74, 8352
    ds_read2_b32 v[70:71], v236 offset0:162 offset1:163
    v_mfma_f32_16x16x32_bf16 v[44:47], v[132:135], v[168:171], v[44:47]
    buffer_load_dwordx4 v240, s[48:51], s13 offen offset:0 lds
    v_mfma_f32_16x16x32_bf16 v[44:47], v[128:131], v[172:175], v[44:47]
    s_waitcnt lgkmcnt(6)
    v_mfma_f32_16x16x32_bf16 v[48:51], v[128:131], v[176:179], v[48:51]
    ds_read_b128 v[104:107], v246 offset:10240
    v_mfma_f32_16x16x32_bf16 v[48:51], v[132:135], v[172:175], v[48:51]
    ds_read2_b32 v[72:73], v237 offset0:32 offset1:33
    v_mfma_f32_16x16x32_bf16 v[48:51], v[136:139], v[168:171], v[48:51]
    ds_read2_b32 v[74:75], v237 offset0:34 offset1:35
    v_mfma_f32_16x16x32_bf16 v[48:51], v[140:143], v[164:167], v[48:51]
    s_add_u32 m0, s74, 8352
    ds_read_b128 v[108:111], v246 offset:14336
    v_mfma_f32_16x16x32_bf16 v[48:51], v[144:147], v[160:163], v[48:51]
    buffer_load_dwordx4 v240, s[48:51], s13 offen offset:1024 lds
    v_mfma_f32_16x16x32_bf16 v[52:55], v[148:151], v[160:163], v[52:55]
    ds_read2_b32 v[76:77], v237 offset0:160 offset1:161
    v_mfma_f32_16x16x32_bf16 v[52:55], v[144:147], v[164:167], v[52:55]
    ds_read2_b32 v[78:79], v237 offset0:162 offset1:163
    v_mfma_f32_16x16x32_bf16 v[52:55], v[140:143], v[168:171], v[52:55]
    ds_read_b128 v[112:115], v246 offset:18432
    v_mfma_f32_16x16x32_bf16 v[52:55], v[136:139], v[172:175], v[52:55]
    s_lshl_b32 s14, s91, 17
    v_mfma_f32_16x16x32_bf16 v[52:55], v[132:135], v[176:179], v[52:55]
    s_add_u32 m0, s73, 0
    ds_read2_b32 v[80:81], v238 offset0:32 offset1:33
    v_mfma_f32_16x16x32_bf16 v[52:55], v[128:131], v[180:183], v[52:55]
    buffer_load_dwordx4 v4, s[52:55], s14 offen offset:0 lds
    v_mfma_f32_16x16x32_bf16 v[56:59], v[128:131], v[184:187], v[56:59]
    s_add_u32 m0, s74, 8352
    ds_read2_b32 v[82:83], v238 offset0:34 offset1:35
    v_mfma_f32_16x16x32_bf16 v[56:59], v[132:135], v[180:183], v[56:59]
    buffer_load_dwordx4 v240, s[48:51], s13 offen offset:2048 lds
    v_mfma_f32_16x16x32_bf16 v[56:59], v[136:139], v[176:179], v[56:59]
    ds_read_b128 v[116:119], v246 offset:22528
    v_mfma_f32_16x16x32_bf16 v[56:59], v[140:143], v[172:175], v[56:59]
    ds_read2_b32 v[84:85], v238 offset0:160 offset1:161
    v_mfma_f32_16x16x32_bf16 v[56:59], v[144:147], v[168:171], v[56:59]
    ds_read2_b32 v[86:87], v238 offset0:162 offset1:163
    v_mfma_f32_16x16x32_bf16 v[56:59], v[148:151], v[164:167], v[56:59]
    ds_read_b128 v[120:123], v246 offset:26624
    v_mfma_f32_16x16x32_bf16 v[56:59], v[152:155], v[160:163], v[56:59]
    ds_read2_b32 v[88:89], v239 offset0:32 offset1:33
    v_mfma_f32_16x16x32_bf16 v[60:63], v[156:159], v[160:163], v[60:63]
    ds_read2_b32 v[90:91], v239 offset0:34 offset1:35
    v_mfma_f32_16x16x32_bf16 v[60:63], v[152:155], v[164:167], v[60:63]
    s_add_u32 m0, s74, 8352
    v_mfma_f32_16x16x32_bf16 v[60:63], v[148:151], v[168:171], v[60:63]
    buffer_load_dwordx4 v240, s[48:51], s13 offen offset:3072 lds
    v_mfma_f32_16x16x32_bf16 v[60:63], v[144:147], v[172:175], v[60:63]
    s_add_u32 m0, s73, 0
    ds_read_b128 v[124:127], v246 offset:30720
    v_mfma_f32_16x16x32_bf16 v[60:63], v[140:143], v[176:179], v[60:63]
    buffer_load_dwordx4 v5, s[52:55], s14 offen offset:1024 lds
    v_mfma_f32_16x16x32_bf16 v[60:63], v[136:139], v[180:183], v[60:63]
    ds_read2_b32 v[92:93], v239 offset0:160 offset1:161
    v_mfma_f32_16x16x32_bf16 v[60:63], v[132:135], v[184:187], v[60:63]
    ds_read2_b32 v[94:95], v239 offset0:162 offset1:163
    v_mfma_f32_16x16x32_bf16 v[60:63], v[128:131], v[188:191], v[60:63]
    s_waitcnt lgkmcnt(12)
    v_mfma_f32_16x16x32_bf16 v[32:35], v[64:67], v[96:99], v[32:35]
    ds_read_b128 v[160:163], v247 offset:2048
    v_mfma_f32_16x16x32_bf16 v[36:39], v[68:71], v[96:99], v[36:39]
    v_mfma_f32_16x16x32_bf16 v[36:39], v[64:67], v[100:103], v[36:39]
    ds_read2_b32 v[128:129], v236 offset0:48 offset1:49
    v_mfma_f32_16x16x32_bf16 v[40:43], v[64:67], v[104:107], v[40:43]
    ds_read2_b32 v[130:131], v236 offset0:50 offset1:51
    v_mfma_f32_16x16x32_bf16 v[40:43], v[68:71], v[100:103], v[40:43]
    ds_read_b128 v[164:167], v247 offset:6144
    v_mfma_f32_16x16x32_bf16 v[40:43], v[72:75], v[96:99], v[40:43]
    ds_read2_b32 v[132:133], v236 offset0:176 offset1:177
    v_mfma_f32_16x16x32_bf16 v[44:47], v[76:79], v[96:99], v[44:47]
    ds_read2_b32 v[134:135], v236 offset0:178 offset1:179
    v_mfma_f32_16x16x32_bf16 v[44:47], v[72:75], v[100:103], v[44:47]
    s_add_u32 m0, s73, 0
    v_mfma_f32_16x16x32_bf16 v[44:47], v[68:71], v[104:107], v[44:47]
    buffer_load_dwordx4 v6, s[52:55], s14 offen offset:2048 lds
    v_mfma_f32_16x16x32_bf16 v[44:47], v[64:67], v[108:111], v[44:47]
    v_mov_b32 v9, 24
    buffer_load_ushort v9, v9, s[56:59], s70 offen
    s_waitcnt lgkmcnt(6)
    v_mfma_f32_16x16x32_bf16 v[48:51], v[64:67], v[112:115], v[48:51]
    ds_read_b128 v[168:171], v247 offset:10240
    v_mfma_f32_16x16x32_bf16 v[48:51], v[68:71], v[108:111], v[48:51]
    ds_read2_b32 v[136:137], v237 offset0:48 offset1:49
    v_mfma_f32_16x16x32_bf16 v[48:51], v[72:75], v[104:107], v[48:51]
    ds_read2_b32 v[138:139], v237 offset0:50 offset1:51
    v_mfma_f32_16x16x32_bf16 v[48:51], v[76:79], v[100:103], v[48:51]
    ds_read_b128 v[172:175], v247 offset:14336
    v_mfma_f32_16x16x32_bf16 v[48:51], v[80:83], v[96:99], v[48:51]
    v_mfma_f32_16x16x32_bf16 v[52:55], v[84:87], v[96:99], v[52:55]
    ds_read2_b32 v[140:141], v237 offset0:176 offset1:177
    v_mfma_f32_16x16x32_bf16 v[52:55], v[80:83], v[100:103], v[52:55]
    ds_read2_b32 v[142:143], v237 offset0:178 offset1:179
    v_mfma_f32_16x16x32_bf16 v[52:55], v[76:79], v[104:107], v[52:55]
    ds_read_b128 v[176:179], v247 offset:18432
    v_mfma_f32_16x16x32_bf16 v[52:55], v[72:75], v[108:111], v[52:55]
    s_add_u32 m0, s73, 0
    v_mfma_f32_16x16x32_bf16 v[52:55], v[68:71], v[112:115], v[52:55]
    buffer_load_dwordx4 v7, s[52:55], s14 offen offset:3072 lds
    v_mfma_f32_16x16x32_bf16 v[52:55], v[64:67], v[116:119], v[52:55]
    ds_read2_b32 v[144:145], v238 offset0:48 offset1:49
    v_mfma_f32_16x16x32_bf16 v[56:59], v[64:67], v[120:123], v[56:59]
    ds_read2_b32 v[146:147], v238 offset0:50 offset1:51
    v_mfma_f32_16x16x32_bf16 v[56:59], v[68:71], v[116:119], v[56:59]
    ds_read_b128 v[180:183], v247 offset:22528
    v_mfma_f32_16x16x32_bf16 v[56:59], v[72:75], v[112:115], v[56:59]
    v_mfma_f32_16x16x32_bf16 v[56:59], v[76:79], v[108:111], v[56:59]
    ds_read2_b32 v[148:149], v238 offset0:176 offset1:177
    v_mfma_f32_16x16x32_bf16 v[56:59], v[80:83], v[104:107], v[56:59]
    ds_read2_b32 v[150:151], v238 offset0:178 offset1:179
    v_mfma_f32_16x16x32_bf16 v[56:59], v[84:87], v[100:103], v[56:59]
    ds_read_b128 v[184:187], v247 offset:26624
    v_mfma_f32_16x16x32_bf16 v[56:59], v[88:91], v[96:99], v[56:59]
    ds_read2_b32 v[152:153], v239 offset0:48 offset1:49
    v_mfma_f32_16x16x32_bf16 v[60:63], v[92:95], v[96:99], v[60:63]
    ds_read2_b32 v[154:155], v239 offset0:50 offset1:51
    v_mfma_f32_16x16x32_bf16 v[60:63], v[88:91], v[100:103], v[60:63]
    s_lshl_b32 s14, s92, 17
    v_mfma_f32_16x16x32_bf16 v[60:63], v[84:87], v[104:107], v[60:63]
L_pl_X_4:
    s_cbranch_execz L_wret
    s_add_u32 m0, s73, 16384
    v_mfma_f32_16x16x32_bf16 v[60:63], v[80:83], v[108:111], v[60:63]
    buffer_load_dwordx4 v4, s[52:55], s14 offen offset:0 lds
    v_mfma_f32_16x16x32_bf16 v[60:63], v[76:79], v[112:115], v[60:63]
    ds_read_b128 v[188:191], v247 offset:30720
    v_mfma_f32_16x16x32_bf16 v[60:63], v[72:75], v[116:119], v[60:63]
    ds_read2_b32 v[156:157], v239 offset0:176 offset1:177
    v_mfma_f32_16x16x32_bf16 v[60:63], v[68:71], v[120:123], v[60:63]
    ds_read2_b32 v[158:159], v239 offset0:178 offset1:179
    v_mfma_f32_16x16x32_bf16 v[60:63], v[64:67], v[124:127], v[60:63]
    s_waitcnt lgkmcnt(12)
    v_mfma_f32_16x16x32_bf16 v[32:35], v[128:131], v[160:163], v[32:35]
    ds_read_b128 v[96:99], v244 offset:0
    v_mfma_f32_16x16x32_bf16 v[36:39], v[132:135], v[160:163], v[36:39]
    ds_read2_b32 v[64:65], v236 offset0:64 offset1:65
    v_mfma_f32_16x16x32_bf16 v[36:39], v[128:131], v[164:167], v[36:39]
    ds_read2_b32 v[66:67], v236 offset0:66 offset1:67
    v_mfma_f32_16x16x32_bf16 v[40:43], v[128:131], v[168:171], v[40:43]
    ds_read_b128 v[100:103], v244 offset:4096
    v_mfma_f32_16x16x32_bf16 v[40:43], v[132:135], v[164:167], v[40:43]
    ds_read2_b32 v[68:69], v236 offset0:192 offset1:193
    v_mfma_f32_16x16x32_bf16 v[40:43], v[136:139], v[160:163], v[40:43]
    ds_read2_b32 v[70:71], v236 offset0:194 offset1:195
    v_mfma_f32_16x16x32_bf16 v[44:47], v[140:143], v[160:163], v[44:47]
    s_add_u32 m0, s73, 16384
    ds_read_b128 v[104:107], v244 offset:8192
    v_mfma_f32_16x16x32_bf16 v[44:47], v[136:139], v[164:167], v[44:47]
    buffer_load_dwordx4 v5, s[52:55], s14 offen offset:1024 lds
    s_waitcnt vmcnt(11)
    v_mfma_f32_16x16x32_bf16 v[44:47], v[132:135], v[168:171], v[44:47]
    ds_read_b64_tr_b16 a[96:97], v10 offset:16384
    v_mfma_f32_16x16x32_bf16 v[44:47], v[128:131], v[172:175], v[44:47]
    ds_read2_b32 v[72:73], v237 offset0:64 offset1:65
    s_waitcnt lgkmcnt(9)
    v_mfma_f32_16x16x32_bf16 v[48:51], v[128:131], v[176:179], v[48:51]
    ds_read_b64_tr_b16 a[98:99], v10 offset:18432
    v_mfma_f32_16x16x32_bf16 v[48:51], v[132:135], v[172:175], v[48:51]
    ds_read_b64_tr_b16 a[100:101], v11 offset:16384
    v_mfma_f32_16x16x32_bf16 v[48:51], v[136:139], v[168:171], v[48:51]
    ds_read_b64_tr_b16 a[102:103], v11 offset:18432
    ds_read2_b32 v[74:75], v237 offset0:66 offset1:67
    v_mfma_f32_16x16x32_bf16 v[48:51], v[140:143], v[164:167], v[48:51]
    ds_read_b128 v[108:111], v244 offset:12288
    v_mfma_f32_16x16x32_bf16 v[48:51], v[144:147], v[160:163], v[48:51]
    ds_read_b64_tr_b16 a[104:105], v12 offset:16384
    v_mfma_f32_16x16x32_bf16 v[52:55], v[148:151], v[160:163], v[52:55]
    ds_read_b64_tr_b16 a[106:107], v12 offset:18432
    ds_read2_b32 v[76:77], v237 offset0:192 offset1:193
    v_mfma_f32_16x16x32_bf16 v[52:55], v[144:147], v[164:167], v[52:55]
    s_waitcnt vmcnt(6)
    ds_read2_b32 v[78:79], v237 offset0:194 offset1:195
    v_mfma_f32_16x16x32_bf16 v[52:55], v[140:143], v[168:171], v[52:55]
    ds_read_b64_tr_b16 a[108:109], v13 offset:16384
    ds_read_b128 v[112:115], v244 offset:16384
    v_mfma_f32_16x16x32_bf16 v[52:55], v[136:139], v[172:175], v[52:55]
    s_add_u32 m0, s73, 16384
    ds_read_b64_tr_b16 a[110:111], v13 offset:18432
    v_mfma_f32_16x16x32_bf16 v[52:55], v[132:135], v[176:179], v[52:55]
    buffer_load_dwordx4 v6, s[52:55], s14 offen offset:2048 lds
    v_mfma_f32_16x16x32_bf16 v[52:55], v[128:131], v[180:183], v[52:55]
    ds_read_b128 v[212:215], v241 offset:8352
    ds_read2_b32 v[80:81], v238 offset0:64 offset1:65
    v_mfma_f32_16x16x32_bf16 v[56:59], v[128:131], v[184:187], v[56:59]
    ds_read_b32 v216, v241 offset:8368
    ds_read2_b32 v[82:83], v238 offset0:66 offset1:67
    v_mfma_f32_16x16x32_bf16 v[56:59], v[132:135], v[180:183], v[56:59]
    ds_read_b128 v[116:119], v244 offset:20480
    v_mfma_f32_16x16x32_bf16 v[56:59], v[136:139], v[176:179], v[56:59]
    ds_read_b128 v[218:221], v241 offset:9376
    v_mfma_f32_16x16x32_bf16 v[56:59], v[140:143], v[172:175], v[56:59]
    ds_read2_b32 v[84:85], v238 offset0:192 offset1:193
    v_mfma_f32_16x16x32_bf16 v[56:59], v[144:147], v[168:171], v[56:59]
    ds_read2_b32 v[86:87], v238 offset0:194 offset1:195
    v_mfma_f32_16x16x32_bf16 v[56:59], v[148:151], v[164:167], v[56:59]
    ds_read_b32 v222, v241 offset:9392
    v_mfma_f32_16x16x32_bf16 v[56:59], v[152:155], v[160:163], v[56:59]
    ds_read_b128 v[120:123], v244 offset:24576
    v_mfma_f32_16x16x32_bf16 v[60:63], v[156:159], v[160:163], v[60:63]
    ds_read_b128 v[224:227], v241 offset:10400
    ds_read2_b32 v[88:89], v239 offset0:64 offset1:65
    v_mfma_f32_16x16x32_bf16 v[60:63], v[152:155], v[164:167], v[60:63]
    ds_read_b32 v228, v241 offset:10416
    ds_read2_b32 v[90:91], v239 offset0:66 offset1:67
    v_mfma_f32_16x16x32_bf16 v[60:63], v[148:151], v[168:171], v[60:63]
    s_add_u32 m0, s73, 16384
    ds_read_b128 v[124:127], v244 offset:28672
    v_mfma_f32_16x16x32_bf16 v[60:63], v[144:147], v[172:175], v[60:63]
    buffer_load_dwordx4 v7, s[52:55], s14 offen offset:3072 lds
    v_mfma_f32_16x16x32_bf16 v[60:63], v[140:143], v[176:179], v[60:63]
    ds_read_b128 v[230:233], v241 offset:11424
    v_mfma_f32_16x16x32_bf16 v[60:63], v[136:139], v[180:183], v[60:63]
    ds_read2_b32 v[92:93], v239 offset0:192 offset1:193
    v_mfma_f32_16x16x32_bf16 v[60:63], v[132:135], v[184:187], v[60:63]
    ds_read_b32 v234, v241 offset:11440
    ds_read2_b32 v[94:95], v239 offset0:194 offset1:195
    v_mfma_f32_16x16x32_bf16 v[60:63], v[128:131], v[188:191], v[60:63]
    s_waitcnt lgkmcnt(15)
    v_mfma_f32_16x16x32_bf16 v[32:35], v[64:67], v[96:99], v[32:35]
    ds_read_b128 v[160:163], v245 offset:0
    v_mfma_f32_16x16x32_bf16 v[36:39], v[68:71], v[96:99], v[36:39]
    ds_read2_b32 v[128:129], v236 offset0:80 offset1:81
    v_mfma_f32_16x16x32_bf16 v[36:39], v[64:67], v[100:103], v[36:39]
    ds_read2_b32 v[130:131], v236 offset0:82 offset1:83
    v_mfma_f32_16x16x32_bf16 v[40:43], v[64:67], v[104:107], v[40:43]
    ds_read_b128 v[164:167], v245 offset:4096
    v_mfma_f32_16x16x32_bf16 v[40:43], v[68:71], v[100:103], v[40:43]
    s_waitcnt lgkmcnt(5)
    v_mfma_f32_16x16x32_bf16 v[40:43], v[72:75], v[96:99], v[40:43]
    s_lshl_b32 s14, s93, 17
    v_mfma_f32_16x16x32_bf16 v[44:47], v[76:79], v[96:99], v[44:47]
    s_add_u32 m0, s73, 147456
    ds_read2_b32 v[132:133], v236 offset0:208 offset1:209
    v_mfma_f32_16x16x32_bf16 v[44:47], v[72:75], v[100:103], v[44:47]
    buffer_load_dwordx4 v4, s[52:55], s14 offen offset:0 lds
    v_mfma_f32_16x16x32_bf16 v[44:47], v[68:71], v[104:107], v[44:47]
    ds_write_b16 v242, v212 offset:12480
    v_mfma_f32_16x16x32_bf16 v[44:47], v[64:67], v[108:111], v[44:47]
    ds_read2_b32 v[134:135], v236 offset0:210 offset1:211
    s_waitcnt lgkmcnt(7)
    v_mfma_f32_16x16x32_bf16 v[48:51], v[64:67], v[112:115], v[48:51]
    v_alignbit_b32 v212, v213, v212, 16
    ds_read_b128 v[168:171], v245 offset:8192
    v_mfma_f32_16x16x32_bf16 v[48:51], v[68:71], v[108:111], v[48:51]
    ds_read2_b32 v[136:137], v237 offset0:80 offset1:81
    v_mfma_f32_16x16x32_bf16 v[48:51], v[72:75], v[104:107], v[48:51]
    ds_read2_b32 v[138:139], v237 offset0:82 offset1:83
    v_mfma_f32_16x16x32_bf16 v[48:51], v[76:79], v[100:103], v[48:51]
    v_alignbit_b32 v213, v214, v213, 16
    ds_read_b128 v[172:175], v245 offset:12288
    v_mfma_f32_16x16x32_bf16 v[48:51], v[80:83], v[96:99], v[48:51]
    ds_read2_b32 v[140:141], v237 offset0:208 offset1:209
    v_mfma_f32_16x16x32_bf16 v[52:55], v[84:87], v[96:99], v[52:55]
    v_alignbit_b32 v214, v215, v214, 16
    ds_read2_b32 v[142:143], v237 offset0:210 offset1:211
    v_mfma_f32_16x16x32_bf16 v[52:55], v[80:83], v[100:103], v[52:55]
    v_alignbit_b32 v215, v216, v215, 16
    ds_read_b128 v[176:179], v245 offset:16384
    v_mfma_f32_16x16x32_bf16 v[52:55], v[76:79], v[104:107], v[52:55]
    ds_write_b128 v241, v[212:215] offset:12512
    v_mfma_f32_16x16x32_bf16 v[52:55], v[72:75], v[108:111], v[52:55]
    s_add_u32 m0, s73, 147456
    ds_read2_b32 v[144:145], v238 offset0:80 offset1:81
    v_mfma_f32_16x16x32_bf16 v[52:55], v[68:71], v[112:115], v[52:55]
    buffer_load_dwordx4 v5, s[52:55], s14 offen offset:1024 lds
    v_mfma_f32_16x16x32_bf16 v[52:55], v[64:67], v[116:119], v[52:55]
    v_alignbit_b32 v218, v219, v218, 16
    ds_read2_b32 v[146:147], v238 offset0:82 offset1:83
    v_mfma_f32_16x16x32_bf16 v[56:59], v[64:67], v[120:123], v[56:59]
    v_alignbit_b32 v219, v220, v219, 16
    ds_read_b128 v[180:183], v245 offset:20480
    v_mfma_f32_16x16x32_bf16 v[56:59], v[68:71], v[116:119], v[56:59]
    v_alignbit_b32 v220, v221, v220, 16
    ds_read2_b32 v[148:149], v238 offset0:208 offset1:209
    v_mfma_f32_16x16x32_bf16 v[56:59], v[72:75], v[112:115], v[56:59]
    v_alignbit_b32 v221, v222, v221, 16
    ds_read2_b32 v[150:151], v238 offset0:210 offset1:211
    v_mfma_f32_16x16x32_bf16 v[56:59], v[76:79], v[108:111], v[56:59]
    ds_write_b128 v241, v[218:221] offset:13536
    v_mfma_f32_16x16x32_bf16 v[56:59], v[80:83], v[104:107], v[56:59]
    s_waitcnt vmcnt(6)
    ds_read_b128 v[184:187], v245 offset:24576
    v_mfma_f32_16x16x32_bf16 v[56:59], v[84:87], v[100:103], v[56:59]
    v_add_u32 v10, -131072, v10
    ds_read2_b32 v[152:153], v239 offset0:80 offset1:81
    v_mfma_f32_16x16x32_bf16 v[56:59], v[88:91], v[96:99], v[56:59]
    ds_read_b64_tr_b16 a[112:113], v10 offset:0
    v_mfma_f32_16x16x32_bf16 v[60:63], v[92:95], v[96:99], v[60:63]
    ds_read_b64_tr_b16 a[114:115], v10 offset:2048
    v_mfma_f32_16x16x32_bf16 v[60:63], v[88:91], v[100:103], v[60:63]
    v_add_u32 v11, -131072, v11
    ds_read2_b32 v[154:155], v239 offset0:82 offset1:83
    v_mfma_f32_16x16x32_bf16 v[60:63], v[84:87], v[104:107], v[60:63]
    s_add_u32 m0, s73, 147456
    ds_read_b64_tr_b16 a[116:117], v11 offset:0
    v_mfma_f32_16x16x32_bf16 v[60:63], v[80:83], v[108:111], v[60:63]
    buffer_load_dwordx4 v6, s[52:55], s14 offen offset:2048 lds
    ds_read_b64_tr_b16 a[118:119], v11 offset:2048
    v_mfma_f32_16x16x32_bf16 v[60:63], v[76:79], v[112:115], v[60:63]
    v_add_u32 v12, -131072, v12
    ds_read_b128 v[188:191], v245 offset:28672
    v_mfma_f32_16x16x32_bf16 v[60:63], v[72:75], v[116:119], v[60:63]
    ds_read_b64_tr_b16 a[120:121], v12 offset:0
    ds_read2_b32 v[156:157], v239 offset0:208 offset1:209
    v_mfma_f32_16x16x32_bf16 v[60:63], v[68:71], v[120:123], v[60:63]
    ds_read_b64_tr_b16 a[122:123], v12 offset:2048
    ds_read2_b32 v[158:159], v239 offset0:210 offset1:211
    v_mfma_f32_16x16x32_bf16 v[60:63], v[64:67], v[124:127], v[60:63]
    v_add_u32 v13, -131072, v13
    s_waitcnt lgkmcnt(15)
    v_mfma_f32_16x16x32_bf16 v[32:35], v[128:131], v[160:163], v[32:35]
    ds_read_b64_tr_b16 a[124:125], v13 offset:0
    v_mfma_f32_16x16x32_bf16 v[36:39], v[132:135], v[160:163], v[36:39]
    ds_read_b64_tr_b16 a[126:127], v13 offset:2048
    v_mfma_f32_16x16x32_bf16 v[36:39], v[128:131], v[164:167], v[36:39]
    v_alignbit_b32 v224, v225, v224, 16
    ds_read_b128 v[96:99], v246 offset:0
    v_mfma_f32_16x16x32_bf16 v[40:43], v[128:131], v[168:171], v[40:43]
    v_alignbit_b32 v225, v226, v225, 16
    ds_read2_b32 v[64:65], v236 offset0:96 offset1:97
    v_mfma_f32_16x16x32_bf16 v[40:43], v[132:135], v[164:167], v[40:43]
    ds_read2_b32 v[66:67], v236 offset0:98 offset1:99
    v_mfma_f32_16x16x32_bf16 v[40:43], v[136:139], v[160:163], v[40:43]
    v_alignbit_b32 v226, v227, v226, 16
    ds_read_b128 v[100:103], v246 offset:4096
    v_mfma_f32_16x16x32_bf16 v[44:47], v[140:143], v[160:163], v[44:47]
    s_add_u32 m0, s73, 147456
    ds_read2_b32 v[68:69], v236 offset0:224 offset1:225
    v_mfma_f32_16x16x32_bf16 v[44:47], v[136:139], v[164:167], v[44:47]
    buffer_load_dwordx4 v7, s[52:55], s14 offen offset:3072 lds
    v_mfma_f32_16x16x32_bf16 v[44:47], v[132:135], v[168:171], v[44:47]
    v_alignbit_b32 v227, v228, v227, 16
    ds_read2_b32 v[70:71], v236 offset0:226 offset1:227
    v_mfma_f32_16x16x32_bf16 v[44:47], v[128:131], v[172:175], v[44:47]
    ds_read_b128 v[104:107], v246 offset:8192
    s_waitcnt lgkmcnt(9)
    v_mfma_f32_16x16x32_bf16 v[48:51], v[128:131], v[176:179], v[48:51]
    ds_write_b128 v241, v[224:227] offset:14560
    v_mfma_f32_16x16x32_bf16 v[48:51], v[132:135], v[172:175], v[48:51]
    ds_read2_b32 v[72:73], v237 offset0:96 offset1:97
    v_mfma_f32_16x16x32_bf16 v[48:51], v[136:139], v[168:171], v[48:51]
    v_alignbit_b32 v230, v231, v230, 16
    ds_read2_b32 v[74:75], v237 offset0:98 offset1:99
    v_mfma_f32_16x16x32_bf16 v[48:51], v[140:143], v[164:167], v[48:51]
    ds_read_b128 v[108:111], v246 offset:12288
    v_mfma_f32_16x16x32_bf16 v[48:51], v[144:147], v[160:163], v[48:51]
    v_alignbit_b32 v231, v232, v231, 16
    v_mfma_f32_16x16x32_bf16 v[52:55], v[148:151], v[160:163], v[52:55]
    ds_read2_b32 v[76:77], v237 offset0:224 offset1:225
    v_mfma_f32_16x16x32_bf16 v[52:55], v[144:147], v[164:167], v[52:55]
    v_alignbit_b32 v232, v233, v232, 16
    ds_read2_b32 v[78:79], v237 offset0:226 offset1:227
    v_mfma_f32_16x16x32_bf16 v[52:55], v[140:143], v[168:171], v[52:55]
    s_waitcnt lgkmcnt(13)
    s_lshl_b32 s14, s94, 17
    v_mfma_f32_16x16x32_bf16 v[52:55], v[136:139], v[172:175], v[52:55]
    s_add_u32 m0, s73, 0
    ds_read_b128 v[112:115], v246 offset:16384
    v_mfma_f32_16x16x32_bf16 v[52:55], v[132:135], v[176:179], v[52:55]
    buffer_load_dwordx4 v4, s[52:55], s14 offen offset:0 lds
    v_mfma_f32_16x16x32_bf16 v[52:55], v[128:131], v[180:183], v[52:55]
    v_alignbit_b32 v233, v234, v233, 16
    ds_read2_b32 v[80:81], v238 offset0:96 offset1:97
    v_mfma_f32_16x16x32_bf16 v[56:59], v[128:131], v[184:187], v[56:59]
    ds_write_b128 v241, v[230:233] offset:15584
    v_mfma_f32_16x16x32_bf16 v[56:59], v[132:135], v[180:183], v[56:59]
    ds_read2_b32 v[82:83], v238 offset0:98 offset1:99
    v_mfma_f32_16x16x32_bf16 v[56:59], v[136:139], v[176:179], v[56:59]
    ds_read_b128 v[116:119], v246 offset:20480
    v_mfma_f32_16x16x32_bf16 v[56:59], v[140:143], v[172:175], v[56:59]
    ds_read2_b32 v[84:85], v238 offset0:224 offset1:225
    v_mfma_f32_16x16x32_bf16 v[56:59], v[144:147], v[168:171], v[56:59]
    v_lshl_or_b32 v9, v9, 16, v9
    ds_read2_b32 v[86:87], v238 offset0:226 offset1:227
    v_mfma_f32_16x16x32_bf16 v[56:59], v[148:151], v[164:167], v[56:59]
    ds_read_b128 v[120:123], v246 offset:24576
    v_mfma_f32_16x16x32_bf16 v[56:59], v[152:155], v[160:163], v[56:59]
    ds_read2_b32 v[88:89], v239 offset0:96 offset1:97
    v_mfma_f32_16x16x32_bf16 v[60:63], v[156:159], v[160:163], v[60:63]
    v_and_b32 v248, v9, v208
    v_mfma_f32_16x16x32_bf16 v[60:63], v[152:155], v[164:167], v[60:63]
    v_and_b32 v249, v9, v209
    ds_read2_b32 v[90:91], v239 offset0:98 offset1:99
    v_mfma_f32_16x16x32_bf16 v[60:63], v[148:151], v[168:171], v[60:63]
    s_add_u32 m0, s73, 0
    ds_read_b128 v[124:127], v246 offset:28672
    v_mfma_f32_16x16x32_bf16 v[60:63], v[144:147], v[172:175], v[60:63]
    buffer_load_dwordx4 v5, s[52:55], s14 offen offset:1024 lds
    v_mfma_f32_16x16x32_bf16 v[60:63], v[140:143], v[176:179], v[60:63]
    v_and_b32 v250, v9, v210
    v_mfma_f32_16x16x32_bf16 v[60:63], v[136:139], v[180:183], v[60:63]
    ds_read2_b32 v[92:93], v239 offset0:224 offset1:225
    v_mfma_f32_16x16x32_bf16 v[60:63], v[132:135], v[184:187], v[60:63]
    v_and_b32 v251, v9, v211
    ds_read2_b32 v[94:95], v239 offset0:226 offset1:227
    v_mfma_f32_16x16x32_bf16 v[60:63], v[128:131], v[188:191], v[60:63]
    s_waitcnt lgkmcnt(13)
    v_mfma_f32_16x16x32_bf16 v[32:35], v[64:67], v[96:99], v[32:35]
    ds_read_b128 v[160:163], v247 offset:0
    v_mfma_f32_16x16x32_bf16 v[36:39], v[68:71], v[96:99], v[36:39]
    s_waitcnt vmcnt(6)
    ds_read_b128 v[164:167], v247 offset:4096
    v_mfma_f32_16x16x32_bf16 v[36:39], v[64:67], v[100:103], v[36:39]
    ds_read_b64_tr_b16 a[128:129], v10 offset:16384
    v_mfma_f32_16x16x32_bf16 v[40:43], v[64:67], v[104:107], v[40:43]
    ds_read_b64_tr_b16 a[130:131], v10 offset:18432
    ds_read_b128 v[168:171], v247 offset:8192
    v_mfma_f32_16x16x32_bf16 v[40:43], v[68:71], v[100:103], v[40:43]
    ds_read_b128 v[172:175], v247 offset:12288
    v_mfma_f32_16x16x32_bf16 v[40:43], v[72:75], v[96:99], v[40:43]
    ds_read_b64_tr_b16 a[132:133], v11 offset:16384
    ds_read_b128 v[176:179], v247 offset:16384
    v_mfma_f32_16x16x32_bf16 v[44:47], v[76:79], v[96:99], v[44:47]
    s_add_u32 m0, s73, 0
    ds_read_b64_tr_b16 a[134:135], v11 offset:18432
    v_mfma_f32_16x16x32_bf16 v[44:47], v[72:75], v[100:103], v[44:47]
    buffer_load_dwordx4 v6, s[52:55], s14 offen offset:2048 lds
    v_mfma_f32_16x16x32_bf16 v[44:47], v[68:71], v[104:107], v[44:47]
    ds_read_b64_tr_b16 a[136:137], v12 offset:16384
    ds_read_b128 v[180:183], v247 offset:20480
    v_mfma_f32_16x16x32_bf16 v[44:47], v[64:67], v[108:111], v[44:47]
    ds_read_b64_tr_b16 a[138:139], v12 offset:18432
    s_waitcnt lgkmcnt(12)
    v_mfma_f32_16x16x32_bf16 v[48:51], v[64:67], v[112:115], v[48:51]
    ds_read_b128 v[184:187], v247 offset:24576
    ds_read_b128 v[188:191], v247 offset:28672
    v_mfma_f32_16x16x32_bf16 v[48:51], v[68:71], v[108:111], v[48:51]
    ds_read_b64_tr_b16 a[140:141], v13 offset:16384
    ds_read2_b32 v[128:129], v236 offset0:112 offset1:113
    v_mfma_f32_16x16x32_bf16 v[48:51], v[72:75], v[104:107], v[48:51]
    ds_read_b64_tr_b16 a[142:143], v13 offset:18432
    v_mfma_f32_16x16x32_bf16 v[48:51], v[76:79], v[100:103], v[48:51]
    ds_read2_b32 v[130:131], v236 offset0:114 offset1:115
    v_mfma_f32_16x16x32_bf16 v[48:51], v[80:83], v[96:99], v[48:51]
    ds_read2_b32 v[132:133], v236 offset0:240 offset1:241
    v_mfma_f32_16x16x32_bf16 v[52:55], v[84:87], v[96:99], v[52:55]
    ds_read2_b32 v[134:135], v236 offset0:242 offset1:243
    v_mfma_f32_16x16x32_bf16 v[52:55], v[80:83], v[100:103], v[52:55]
    ds_read2_b32 v[136:137], v237 offset0:112 offset1:113
    v_mfma_f32_16x16x32_bf16 v[52:55], v[76:79], v[104:107], v[52:55]
    s_add_u32 s6, s12, 4751360
    ds_read2_b32 v[138:139], v237 offset0:114 offset1:115
    v_mfma_f32_16x16x32_bf16 v[52:55], v[72:75], v[108:111], v[52:55]
    s_add_u32 m0, s73, 0
    ds_read2_b32 v[140:141], v237 offset0:240 offset1:241
    v_mfma_f32_16x16x32_bf16 v[52:55], v[68:71], v[112:115], v[52:55]
    buffer_load_dwordx4 v7, s[52:55], s14 offen offset:3072 lds
    v_mfma_f32_16x16x32_bf16 v[52:55], v[64:67], v[116:119], v[52:55]
    v_xor_b32 v244, 64, v244
    ds_read2_b32 v[142:143], v237 offset0:242 offset1:243
    v_mfma_f32_16x16x32_bf16 v[56:59], v[64:67], v[120:123], v[56:59]
    ds_read2_b32 v[144:145], v238 offset0:112 offset1:113
    v_mfma_f32_16x16x32_bf16 v[56:59], v[68:71], v[116:119], v[56:59]
    ds_read2_b32 v[146:147], v238 offset0:114 offset1:115
    v_mfma_f32_16x16x32_bf16 v[56:59], v[72:75], v[112:115], v[56:59]
    ds_read2_b32 v[148:149], v238 offset0:240 offset1:241
    v_mfma_f32_16x16x32_bf16 v[56:59], v[76:79], v[108:111], v[56:59]
    v_xor_b32 v245, 64, v245
    ds_read2_b32 v[150:151], v238 offset0:242 offset1:243
    v_mfma_f32_16x16x32_bf16 v[56:59], v[80:83], v[104:107], v[56:59]
    ds_read2_b32 v[152:153], v239 offset0:112 offset1:113
    v_mfma_f32_16x16x32_bf16 v[56:59], v[84:87], v[100:103], v[56:59]
    ds_read2_b32 v[154:155], v239 offset0:114 offset1:115
    v_mfma_f32_16x16x32_bf16 v[56:59], v[88:91], v[96:99], v[56:59]
    ds_read2_b32 v[156:157], v239 offset0:240 offset1:241
    v_mfma_f32_16x16x32_bf16 v[60:63], v[92:95], v[96:99], v[60:63]
    v_xor_b32 v246, 64, v246
    ds_read2_b32 v[158:159], v239 offset0:242 offset1:243
    v_mfma_f32_16x16x32_bf16 v[60:63], v[88:91], v[100:103], v[60:63]
    s_waitcnt lgkmcnt(15)
    s_lshl_b32 s14, s95, 17
    v_mfma_f32_16x16x32_bf16 v[60:63], v[84:87], v[104:107], v[60:63]
    s_add_u32 m0, s73, 16384
    v_add_u32 v236, 8320, v236
    v_mfma_f32_16x16x32_bf16 v[60:63], v[80:83], v[108:111], v[60:63]
    buffer_load_dwordx4 v4, s[52:55], s14 offen offset:0 lds
    v_mfma_f32_16x16x32_bf16 v[60:63], v[76:79], v[112:115], v[60:63]
    v_add_u32 v237, 8320, v237
    v_mfma_f32_16x16x32_bf16 v[60:63], v[72:75], v[116:119], v[60:63]
    v_xor_b32 v247, 64, v247
    v_add_u32 v238, 8320, v238
    v_mfma_f32_16x16x32_bf16 v[60:63], v[68:71], v[120:123], v[60:63]
    v_add_u32 v239, 8320, v239
    v_mfma_f32_16x16x32_bf16 v[60:63], v[64:67], v[124:127], v[60:63]
    s_waitcnt lgkmcnt(0)
    v_mfma_f32_16x16x32_bf16 v[60:63], v[128:131], v[188:191], v[60:63]
    ds_read_b128 v[96:99], v244 offset:2048
    v_mfma_f32_16x16x32_bf16 v[60:63], v[132:135], v[184:187], v[60:63]
    ds_read2_b32 v[64:65], v236 offset0:0 offset1:1
    v_mfma_f32_16x16x32_bf16 v[60:63], v[136:139], v[180:183], v[60:63]
    ds_read2_b32 v[66:67], v236 offset0:2 offset1:3
    v_mfma_f32_16x16x32_bf16 v[60:63], v[140:143], v[176:179], v[60:63]
    ds_read_b128 v[100:103], v244 offset:6144
    v_mfma_f32_16x16x32_bf16 v[60:63], v[144:147], v[172:175], v[60:63]
    ds_read2_b32 v[68:69], v236 offset0:128 offset1:129
    v_mfma_f32_16x16x32_bf16 v[60:63], v[148:151], v[168:171], v[60:63]
    ds_read2_b32 v[70:71], v236 offset0:130 offset1:131
    v_mfma_f32_16x16x32_bf16 v[60:63], v[152:155], v[164:167], v[60:63]
    s_add_u32 m0, s73, 16384
    ds_read_b128 v[104:107], v244 offset:10240
    v_mfma_f32_16x16x32_bf16 v[60:63], v[156:159], v[160:163], v[60:63]
    buffer_load_dwordx4 v5, s[52:55], s14 offen offset:1024 lds
    v_mfma_f32_16x16x32_bf16 v[56:59], v[128:131], v[184:187], v[56:59]
    ds_read2_b32 v[72:73], v237 offset0:0 offset1:1
    v_mfma_f32_16x16x32_bf16 v[56:59], v[132:135], v[180:183], v[56:59]
    ds_read2_b32 v[74:75], v237 offset0:2 offset1:3
    v_mfma_f32_16x16x32_bf16 v[56:59], v[136:139], v[176:179], v[56:59]
    ds_read_b128 v[108:111], v244 offset:14336
    v_mfma_f32_16x16x32_bf16 v[56:59], v[140:143], v[172:175], v[56:59]
    ds_read2_b32 v[76:77], v237 offset0:128 offset1:129
    ds_read2_b32 v[78:79], v237 offset0:130 offset1:131
    v_mfma_f32_16x16x32_bf16 v[56:59], v[144:147], v[168:171], v[56:59]
    s_waitcnt vmcnt(6)
    v_cvt_pk_bf16_f32 v206, v60, v61
    v_mfma_f32_16x16x32_bf16 v[56:59], v[148:151], v[164:167], v[56:59]
    v_add_u32 v10, 131072, v10
    v_cvt_pk_bf16_f32 v207, v62, v63
    v_mfma_f32_16x16x32_bf16 v[56:59], v[152:155], v[160:163], v[56:59]
    ds_read_b64_tr_b16 a[144:145], v10 offset:16384
    ds_read_b128 v[112:115], v244 offset:18432
    v_mfma_f32_16x16x32_bf16 v[52:55], v[128:131], v[180:183], v[52:55]
    ds_read_b64_tr_b16 a[146:147], v10 offset:18432
    ds_read2_b32 v[80:81], v238 offset0:0 offset1:1
    v_mfma_f32_16x16x32_bf16 v[52:55], v[132:135], v[176:179], v[52:55]
    v_add_u32 v11, 131072, v11
    buffer_store_dwordx2 v[206:207], v8, s[44:47], s6 offen offset:3584 sc1
    v_mfma_f32_16x16x32_bf16 v[52:55], v[136:139], v[172:175], v[52:55]
    ds_read_b64_tr_b16 a[148:149], v11 offset:16384
    ds_read2_b32 v[82:83], v238 offset0:2 offset1:3
    v_mfma_f32_16x16x32_bf16 v[52:55], v[140:143], v[168:171], v[52:55]
    s_add_u32 m0, s73, 16384
    ds_read_b64_tr_b16 a[150:151], v11 offset:18432
    v_mfma_f32_16x16x32_bf16 v[52:55], v[144:147], v[164:167], v[52:55]
    buffer_load_dwordx4 v6, s[52:55], s14 offen offset:2048 lds
    v_add_u32 v12, 131072, v12
    v_mfma_f32_16x16x32_bf16 v[52:55], v[148:151], v[160:163], v[52:55]
    ds_read_b64_tr_b16 a[152:153], v12 offset:16384
    ds_read_b128 v[116:119], v244 offset:22528
    v_mfma_f32_16x16x32_bf16 v[48:51], v[128:131], v[176:179], v[48:51]
    ds_read_b64_tr_b16 a[154:155], v12 offset:18432
    ds_read2_b32 v[84:85], v238 offset0:128 offset1:129
    v_mfma_f32_16x16x32_bf16 v[48:51], v[132:135], v[172:175], v[48:51]
    v_add_u32 v13, 131072, v13
    ds_read2_b32 v[86:87], v238 offset0:130 offset1:131
    v_mfma_f32_16x16x32_bf16 v[48:51], v[136:139], v[168:171], v[48:51]
    ds_read_b64_tr_b16 a[156:157], v13 offset:16384
    ds_read_b128 v[120:123], v244 offset:26624
    v_mfma_f32_16x16x32_bf16 v[48:51], v[140:143], v[164:167], v[48:51]
    ds_read_b64_tr_b16 a[158:159], v13 offset:18432
    ds_read2_b32 v[88:89], v239 offset0:0 offset1:1
    v_mfma_f32_16x16x32_bf16 v[48:51], v[144:147], v[160:163], v[48:51]
    v_cvt_pk_bf16_f32 v204, v56, v57
    ds_read2_b32 v[90:91], v239 offset0:2 offset1:3
    v_mfma_f32_16x16x32_bf16 v[44:47], v[128:131], v[172:175], v[44:47]
    v_cvt_pk_bf16_f32 v205, v58, v59
    ds_read_b128 v[124:127], v244 offset:30720
    v_mfma_f32_16x16x32_bf16 v[44:47], v[132:135], v[168:171], v[44:47]
    buffer_store_dwordx2 v[204:205], v8, s[44:47], s6 offen offset:3072 sc1
    v_mfma_f32_16x16x32_bf16 v[44:47], v[136:139], v[164:167], v[44:47]
    ds_read2_b32 v[92:93], v239 offset0:128 offset1:129
    ds_read2_b32 v[94:95], v239 offset0:130 offset1:131
    v_mfma_f32_16x16x32_bf16 v[44:47], v[140:143], v[160:163], v[44:47]
    v_cvt_pk_bf16_f32 v202, v52, v53
    v_mfma_f32_16x16x32_bf16 v[40:43], v[128:131], v[168:171], v[40:43]
    s_add_u32 m0, s73, 16384
    v_mfma_f32_16x16x32_bf16 v[40:43], v[132:135], v[164:167], v[40:43]
    buffer_load_dwordx4 v7, s[52:55], s14 offen offset:3072 lds
    v_mfma_f32_16x16x32_bf16 v[40:43], v[136:139], v[160:163], v[40:43]
    v_cvt_pk_bf16_f32 v203, v54, v55
    v_mfma_f32_16x16x32_bf16 v[36:39], v[128:131], v[164:167], v[36:39]
    v_mfma_f32_16x16x32_bf16 v[36:39], v[132:135], v[160:163], v[36:39]
    buffer_store_dwordx2 v[202:203], v8, s[44:47], s6 offen offset:2560 sc1
    v_mfma_f32_16x16x32_bf16 v[32:35], v[128:131], v[160:163], v[32:35]
    s_waitcnt lgkmcnt(0)
    v_mfma_f32_16x16x32_bf16 v[60:63], v[248:251], v[124:127], 0
    ds_read_b128 v[160:163], v245 offset:2048
    v_mfma_f32_16x16x32_bf16 v[60:63], v[64:67], v[124:127], v[60:63]
    v_cvt_pk_bf16_f32 v200, v48, v49
    v_mfma_f32_16x16x32_bf16 v[60:63], v[68:71], v[120:123], v[60:63]
    ds_read2_b32 v[128:129], v236 offset0:16 offset1:17
    v_mfma_f32_16x16x32_bf16 v[60:63], v[72:75], v[116:119], v[60:63]
    v_cvt_pk_bf16_f32 v201, v50, v51
    v_mfma_f32_16x16x32_bf16 v[60:63], v[76:79], v[112:115], v[60:63]
    ds_read2_b32 v[130:131], v236 offset0:18 offset1:19
    v_mfma_f32_16x16x32_bf16 v[60:63], v[80:83], v[108:111], v[60:63]
    buffer_store_dwordx2 v[200:201], v8, s[44:47], s6 offen offset:2048 sc1
    v_mfma_f32_16x16x32_bf16 v[60:63], v[84:87], v[104:107], v[60:63]
    s_lshl_b32 s14, s96, 17
    v_mfma_f32_16x16x32_bf16 v[60:63], v[88:91], v[100:103], v[60:63]
    s_add_u32 m0, s73, 147456
    ds_read_b128 v[164:167], v245 offset:6144
    v_mfma_f32_16x16x32_bf16 v[60:63], v[92:95], v[96:99], v[60:63]
    buffer_load_dwordx4 v4, s[52:55], s14 offen offset:0 lds
    v_mfma_f32_16x16x32_bf16 v[56:59], v[248:251], v[120:123], 0
    v_cvt_pk_bf16_f32 v198, v44, v45
    ds_read2_b32 v[132:133], v236 offset0:144 offset1:145
    v_mfma_f32_16x16x32_bf16 v[56:59], v[64:67], v[120:123], v[56:59]
    ds_read2_b32 v[134:135], v236 offset0:146 offset1:147
    v_mfma_f32_16x16x32_bf16 v[56:59], v[68:71], v[116:119], v[56:59]
    v_cvt_pk_bf16_f32 v199, v46, v47
    v_mfma_f32_16x16x32_bf16 v[56:59], v[72:75], v[112:115], v[56:59]
    ds_read_b128 v[168:171], v245 offset:10240
    v_mfma_f32_16x16x32_bf16 v[56:59], v[76:79], v[108:111], v[56:59]
    ds_read2_b32 v[136:137], v237 offset0:16 offset1:17
    v_mfma_f32_16x16x32_bf16 v[56:59], v[80:83], v[104:107], v[56:59]
    buffer_store_dwordx2 v[198:199], v8, s[44:47], s6 offen offset:1536 sc1
    v_mfma_f32_16x16x32_bf16 v[56:59], v[84:87], v[100:103], v[56:59]
    ds_read2_b32 v[138:139], v237 offset0:18 offset1:19
    v_mfma_f32_16x16x32_bf16 v[56:59], v[88:91], v[96:99], v[56:59]
    v_cvt_pk_bf16_f32 v196, v40, v41
    v_mfma_f32_16x16x32_bf16 v[52:55], v[248:251], v[116:119], 0
    ds_read_b128 v[172:175], v245 offset:14336
    v_mfma_f32_16x16x32_bf16 v[52:55], v[64:67], v[116:119], v[52:55]
    ds_read2_b32 v[140:141], v237 offset0:144 offset1:145
    v_mfma_f32_16x16x32_bf16 v[52:55], v[68:71], v[112:115], v[52:55]
    v_cvt_pk_bf16_f32 v197, v42, v43
    v_mfma_f32_16x16x32_bf16 v[52:55], v[72:75], v[108:111], v[52:55]
    ds_read2_b32 v[142:143], v237 offset0:146 offset1:147
    v_mfma_f32_16x16x32_bf16 v[52:55], v[76:79], v[104:107], v[52:55]
    buffer_store_dwordx2 v[196:197], v8, s[44:47], s6 offen offset:1024 sc1
    v_mfma_f32_16x16x32_bf16 v[52:55], v[80:83], v[100:103], v[52:55]
    s_add_u32 m0, s73, 147456
    ds_read_b128 v[176:179], v245 offset:18432
    v_mfma_f32_16x16x32_bf16 v[52:55], v[84:87], v[96:99], v[52:55]
    buffer_load_dwordx4 v5, s[52:55], s14 offen offset:1024 lds
    v_mfma_f32_16x16x32_bf16 v[48:51], v[248:251], v[112:115], 0
    v_cvt_pk_bf16_f32 v194, v36, v37
    ds_read2_b32 v[144:145], v238 offset0:16 offset1:17
    v_mfma_f32_16x16x32_bf16 v[48:51], v[64:67], v[112:115], v[48:51]
    ds_read2_b32 v[146:147], v238 offset0:18 offset1:19
    v_mfma_f32_16x16x32_bf16 v[48:51], v[68:71], v[108:111], v[48:51]
    v_cvt_pk_bf16_f32 v195, v38, v39
    ds_read_b128 v[180:183], v245 offset:22528
    v_mfma_f32_16x16x32_bf16 v[48:51], v[72:75], v[104:107], v[48:51]
    buffer_store_dwordx2 v[194:195], v8, s[44:47], s6 offen offset:512 sc1
    v_mfma_f32_16x16x32_bf16 v[48:51], v[76:79], v[100:103], v[48:51]
    v_cvt_pk_bf16_f32 v192, v32, v33
    ds_read2_b32 v[148:149], v238 offset0:144 offset1:145
    v_mfma_f32_16x16x32_bf16 v[48:51], v[80:83], v[96:99], v[48:51]
    v_cvt_pk_bf16_f32 v193, v34, v35
    ds_read2_b32 v[150:151], v238 offset0:146 offset1:147
    v_mfma_f32_16x16x32_bf16 v[44:47], v[248:251], v[108:111], 0
    s_waitcnt vmcnt(13)
    ds_read_b128 v[184:187], v245 offset:26624
    v_mfma_f32_16x16x32_bf16 v[44:47], v[64:67], v[108:111], v[44:47]
    v_add_u32 v10, -131072, v10
    ds_read2_b32 v[152:153], v239 offset0:16 offset1:17
    v_mfma_f32_16x16x32_bf16 v[44:47], v[68:71], v[104:107], v[44:47]
    ds_read_b64_tr_b16 a[160:161], v10 offset:0
    v_mfma_f32_16x16x32_bf16 v[44:47], v[72:75], v[100:103], v[44:47]
L_pl_X_5:
    s_cbranch_execz L_wret
    buffer_store_dwordx2 v[192:193], v8, s[44:47], s6 offen offset:0 sc1
    v_mfma_f32_16x16x32_bf16 v[44:47], v[76:79], v[96:99], v[44:47]
    ds_read_b64_tr_b16 a[162:163], v10 offset:2048
    v_mfma_f32_16x16x32_bf16 v[40:43], v[248:251], v[104:107], 0
    v_add_u32 v11, -131072, v11
    ds_read2_b32 v[154:155], v239 offset0:18 offset1:19
    v_mfma_f32_16x16x32_bf16 v[40:43], v[64:67], v[104:107], v[40:43]
    ds_read_b64_tr_b16 a[164:165], v11 offset:0
    v_mfma_f32_16x16x32_bf16 v[40:43], v[68:71], v[100:103], v[40:43]
    s_add_u32 m0, s73, 147456
    ds_read_b64_tr_b16 a[166:167], v11 offset:2048
    v_mfma_f32_16x16x32_bf16 v[40:43], v[72:75], v[96:99], v[40:43]
    buffer_load_dwordx4 v6, s[52:55], s14 offen offset:2048 lds
    v_add_u32 v12, -131072, v12
    v_mfma_f32_16x16x32_bf16 v[36:39], v[248:251], v[100:103], 0
    ds_read_b128 v[188:191], v245 offset:30720
    v_mfma_f32_16x16x32_bf16 v[36:39], v[64:67], v[100:103], v[36:39]
    ds_read_b64_tr_b16 a[168:169], v12 offset:0
    ds_read2_b32 v[156:157], v239 offset0:144 offset1:145
    v_mfma_f32_16x16x32_bf16 v[36:39], v[68:71], v[96:99], v[36:39]
    ds_read_b64_tr_b16 a[170:171], v12 offset:2048
    v_mfma_f32_16x16x32_bf16 v[32:35], v[248:251], v[96:99], 0
    v_add_u32 v13, -131072, v13
    ds_read2_b32 v[158:159], v239 offset0:146 offset1:147
    v_mfma_f32_16x16x32_bf16 v[32:35], v[64:67], v[96:99], v[32:35]
    ds_read_b64_tr_b16 a[172:173], v13 offset:0
    s_waitcnt lgkmcnt(15)
    v_mfma_f32_16x16x32_bf16 v[32:35], v[128:131], v[160:163], v[32:35]
    ds_read_b64_tr_b16 a[174:175], v13 offset:2048
    v_mfma_f32_16x16x32_bf16 v[36:39], v[132:135], v[160:163], v[36:39]
    ds_read_b128 v[96:99], v246 offset:2048
    v_mfma_f32_16x16x32_bf16 v[36:39], v[128:131], v[164:167], v[36:39]
    ds_read2_b32 v[64:65], v236 offset0:32 offset1:33
    v_mfma_f32_16x16x32_bf16 v[40:43], v[128:131], v[168:171], v[40:43]
    ds_read2_b32 v[66:67], v236 offset0:34 offset1:35
    v_mfma_f32_16x16x32_bf16 v[40:43], v[132:135], v[164:167], v[40:43]
    ds_read_b128 v[100:103], v246 offset:6144
    v_mfma_f32_16x16x32_bf16 v[40:43], v[136:139], v[160:163], v[40:43]
    ds_read2_b32 v[68:69], v236 offset0:160 offset1:161
    v_mfma_f32_16x16x32_bf16 v[44:47], v[140:143], v[160:163], v[44:47]
    s_add_u32 m0, s73, 147456
    v_mfma_f32_16x16x32_bf16 v[44:47], v[136:139], v[164:167], v[44:47]
    buffer_load_dwordx4 v7, s[52:55], s14 offen offset:3072 lds
    v_mfma_f32_16x16x32_bf16 v[44:47], v[132:135], v[168:171], v[44:47]
    ds_read2_b32 v[70:71], v236 offset0:162 offset1:163
    v_mfma_f32_16x16x32_bf16 v[44:47], v[128:131], v[172:175], v[44:47]
    s_waitcnt lgkmcnt(8)
    v_mfma_f32_16x16x32_bf16 v[48:51], v[128:131], v[176:179], v[48:51]
    ds_read_b128 v[104:107], v246 offset:10240
    v_mfma_f32_16x16x32_bf16 v[48:51], v[132:135], v[172:175], v[48:51]
    ds_read2_b32 v[72:73], v237 offset0:32 offset1:33
    v_mfma_f32_16x16x32_bf16 v[48:51], v[136:139], v[168:171], v[48:51]
    ds_read2_b32 v[74:75], v237 offset0:34 offset1:35
    v_mfma_f32_16x16x32_bf16 v[48:51], v[140:143], v[164:167], v[48:51]
    ds_read_b128 v[108:111], v246 offset:14336
    v_mfma_f32_16x16x32_bf16 v[48:51], v[144:147], v[160:163], v[48:51]
    ds_read2_b32 v[76:77], v237 offset0:160 offset1:161
    v_mfma_f32_16x16x32_bf16 v[52:55], v[148:151], v[160:163], v[52:55]
    ds_read2_b32 v[78:79], v237 offset0:162 offset1:163
    v_mfma_f32_16x16x32_bf16 v[52:55], v[144:147], v[164:167], v[52:55]
    ds_read_b128 v[112:115], v246 offset:18432
    v_mfma_f32_16x16x32_bf16 v[52:55], v[140:143], v[168:171], v[52:55]
    s_waitcnt lgkmcnt(13)
    s_lshl_b32 s14, s97, 17
    v_mfma_f32_16x16x32_bf16 v[52:55], v[136:139], v[172:175], v[52:55]
    s_add_u32 m0, s73, 0
    v_mfma_f32_16x16x32_bf16 v[52:55], v[132:135], v[176:179], v[52:55]
    buffer_load_dwordx4 v4, s[52:55], s14 offen offset:0 lds
    v_mfma_f32_16x16x32_bf16 v[52:55], v[128:131], v[180:183], v[52:55]
    ds_read2_b32 v[80:81], v238 offset0:32 offset1:33
    v_mfma_f32_16x16x32_bf16 v[56:59], v[128:131], v[184:187], v[56:59]
    ds_read2_b32 v[82:83], v238 offset0:34 offset1:35
    v_mfma_f32_16x16x32_bf16 v[56:59], v[132:135], v[180:183], v[56:59]
    ds_read_b128 v[116:119], v246 offset:22528
    v_mfma_f32_16x16x32_bf16 v[56:59], v[136:139], v[176:179], v[56:59]
    v_mfma_f32_16x16x32_bf16 v[56:59], v[140:143], v[172:175], v[56:59]
    ds_read2_b32 v[84:85], v238 offset0:160 offset1:161
    v_mfma_f32_16x16x32_bf16 v[56:59], v[144:147], v[168:171], v[56:59]
    ds_read2_b32 v[86:87], v238 offset0:162 offset1:163
    v_mfma_f32_16x16x32_bf16 v[56:59], v[148:151], v[164:167], v[56:59]
    ds_read_b128 v[120:123], v246 offset:26624
    v_mfma_f32_16x16x32_bf16 v[56:59], v[152:155], v[160:163], v[56:59]
    v_mfma_f32_16x16x32_bf16 v[60:63], v[156:159], v[160:163], v[60:63]
    ds_read2_b32 v[88:89], v239 offset0:32 offset1:33
    v_mfma_f32_16x16x32_bf16 v[60:63], v[152:155], v[164:167], v[60:63]
    ds_read2_b32 v[90:91], v239 offset0:34 offset1:35
    v_mfma_f32_16x16x32_bf16 v[60:63], v[148:151], v[168:171], v[60:63]
    s_add_u32 m0, s73, 0
    v_mfma_f32_16x16x32_bf16 v[60:63], v[144:147], v[172:175], v[60:63]
    buffer_load_dwordx4 v5, s[52:55], s14 offen offset:1024 lds
    v_mfma_f32_16x16x32_bf16 v[60:63], v[140:143], v[176:179], v[60:63]
    ds_read_b128 v[124:127], v246 offset:30720
    v_mfma_f32_16x16x32_bf16 v[60:63], v[136:139], v[180:183], v[60:63]
    ds_read2_b32 v[92:93], v239 offset0:160 offset1:161
    v_mfma_f32_16x16x32_bf16 v[60:63], v[132:135], v[184:187], v[60:63]
    ds_read2_b32 v[94:95], v239 offset0:162 offset1:163
    v_mfma_f32_16x16x32_bf16 v[60:63], v[128:131], v[188:191], v[60:63]
    s_waitcnt lgkmcnt(12)
    v_mfma_f32_16x16x32_bf16 v[32:35], v[64:67], v[96:99], v[32:35]
    s_waitcnt vmcnt(12)
    ds_read_b128 v[160:163], v247 offset:2048
    v_mfma_f32_16x16x32_bf16 v[36:39], v[68:71], v[96:99], v[36:39]
    ds_read2_b32 v[128:129], v236 offset0:48 offset1:49
    v_mfma_f32_16x16x32_bf16 v[36:39], v[64:67], v[100:103], v[36:39]
    ds_read_b64_tr_b16 a[176:177], v10 offset:16384
    v_mfma_f32_16x16x32_bf16 v[40:43], v[64:67], v[104:107], v[40:43]
    ds_read_b64_tr_b16 a[178:179], v10 offset:18432
    ds_read2_b32 v[130:131], v236 offset0:50 offset1:51
    v_mfma_f32_16x16x32_bf16 v[40:43], v[68:71], v[100:103], v[40:43]
    ds_read_b128 v[164:167], v247 offset:6144
    v_mfma_f32_16x16x32_bf16 v[40:43], v[72:75], v[96:99], v[40:43]
    ds_read_b64_tr_b16 a[180:181], v11 offset:16384
    v_mfma_f32_16x16x32_bf16 v[44:47], v[76:79], v[96:99], v[44:47]
    s_add_u32 m0, s73, 0
    ds_read_b64_tr_b16 a[182:183], v11 offset:18432
    v_mfma_f32_16x16x32_bf16 v[44:47], v[72:75], v[100:103], v[44:47]
    buffer_load_dwordx4 v6, s[52:55], s14 offen offset:2048 lds
    ds_read_b64_tr_b16 a[184:185], v12 offset:16384
    v_mfma_f32_16x16x32_bf16 v[44:47], v[68:71], v[104:107], v[44:47]
    ds_read2_b32 v[132:133], v236 offset0:176 offset1:177
    v_mfma_f32_16x16x32_bf16 v[44:47], v[64:67], v[108:111], v[44:47]
    ds_read_b64_tr_b16 a[186:187], v12 offset:18432
    s_waitcnt lgkmcnt(11)
    v_mfma_f32_16x16x32_bf16 v[48:51], v[64:67], v[112:115], v[48:51]
    ds_read_b64_tr_b16 a[188:189], v13 offset:16384
    v_mfma_f32_16x16x32_bf16 v[48:51], v[68:71], v[108:111], v[48:51]
    ds_read2_b32 v[134:135], v236 offset0:178 offset1:179
    v_mfma_f32_16x16x32_bf16 v[48:51], v[72:75], v[104:107], v[48:51]
    ds_read_b64_tr_b16 a[190:191], v13 offset:18432
    v_mfma_f32_16x16x32_bf16 v[48:51], v[76:79], v[100:103], v[48:51]
    ds_read_b128 v[168:171], v247 offset:10240
    v_mfma_f32_16x16x32_bf16 v[48:51], v[80:83], v[96:99], v[48:51]
    ds_read2_b32 v[136:137], v237 offset0:48 offset1:49
    v_mfma_f32_16x16x32_bf16 v[52:55], v[84:87], v[96:99], v[52:55]
    ds_read2_b32 v[138:139], v237 offset0:50 offset1:51
    v_mfma_f32_16x16x32_bf16 v[52:55], v[80:83], v[100:103], v[52:55]
    ds_read_b128 v[172:175], v247 offset:14336
    v_mfma_f32_16x16x32_bf16 v[52:55], v[76:79], v[104:107], v[52:55]
    ds_read2_b32 v[140:141], v237 offset0:176 offset1:177
    v_mfma_f32_16x16x32_bf16 v[52:55], v[72:75], v[108:111], v[52:55]
    s_add_u32 m0, s73, 0
    ds_read2_b32 v[142:143], v237 offset0:178 offset1:179
    v_mfma_f32_16x16x32_bf16 v[52:55], v[68:71], v[112:115], v[52:55]
    buffer_load_dwordx4 v7, s[52:55], s14 offen offset:3072 lds
    v_mfma_f32_16x16x32_bf16 v[52:55], v[64:67], v[116:119], v[52:55]
    ds_read_b128 v[176:179], v247 offset:18432
    v_mfma_f32_16x16x32_bf16 v[56:59], v[64:67], v[120:123], v[56:59]
    ds_read2_b32 v[144:145], v238 offset0:48 offset1:49
    v_mfma_f32_16x16x32_bf16 v[56:59], v[68:71], v[116:119], v[56:59]
    ds_read2_b32 v[146:147], v238 offset0:50 offset1:51
    v_mfma_f32_16x16x32_bf16 v[56:59], v[72:75], v[112:115], v[56:59]
    ds_read_b128 v[180:183], v247 offset:22528
    v_mfma_f32_16x16x32_bf16 v[56:59], v[76:79], v[108:111], v[56:59]
    ds_read2_b32 v[148:149], v238 offset0:176 offset1:177
    v_mfma_f32_16x16x32_bf16 v[56:59], v[80:83], v[104:107], v[56:59]
    ds_read2_b32 v[150:151], v238 offset0:178 offset1:179
    v_mfma_f32_16x16x32_bf16 v[56:59], v[84:87], v[100:103], v[56:59]
    ds_read_b128 v[184:187], v247 offset:26624
    v_mfma_f32_16x16x32_bf16 v[56:59], v[88:91], v[96:99], v[56:59]
    ds_read2_b32 v[152:153], v239 offset0:48 offset1:49
    v_mfma_f32_16x16x32_bf16 v[60:63], v[92:95], v[96:99], v[60:63]
    ds_read2_b32 v[154:155], v239 offset0:50 offset1:51
    v_mfma_f32_16x16x32_bf16 v[60:63], v[88:91], v[100:103], v[60:63]
    s_waitcnt lgkmcnt(15)
    s_lshl_b32 s14, s98, 17
    v_mfma_f32_16x16x32_bf16 v[60:63], v[84:87], v[104:107], v[60:63]
    s_add_u32 m0, s73, 16384
    v_mfma_f32_16x16x32_bf16 v[60:63], v[80:83], v[108:111], v[60:63]
    buffer_load_dwordx4 v4, s[52:55], s14 offen offset:0 lds
    v_mfma_f32_16x16x32_bf16 v[60:63], v[76:79], v[112:115], v[60:63]
    ds_read_b128 v[188:191], v247 offset:30720
    v_mfma_f32_16x16x32_bf16 v[60:63], v[72:75], v[116:119], v[60:63]
    ds_read2_b32 v[156:157], v239 offset0:176 offset1:177
    v_mfma_f32_16x16x32_bf16 v[60:63], v[68:71], v[120:123], v[60:63]
    ds_read2_b32 v[158:159], v239 offset0:178 offset1:179
    v_mfma_f32_16x16x32_bf16 v[60:63], v[64:67], v[124:127], v[60:63]
    s_waitcnt lgkmcnt(12)
    v_mfma_f32_16x16x32_bf16 v[32:35], v[128:131], v[160:163], v[32:35]
    ds_read_b128 v[96:99], v244 offset:0
    v_mfma_f32_16x16x32_bf16 v[36:39], v[132:135], v[160:163], v[36:39]
    ds_read2_b32 v[64:65], v236 offset0:64 offset1:65
    v_mfma_f32_16x16x32_bf16 v[36:39], v[128:131], v[164:167], v[36:39]
    ds_read2_b32 v[66:67], v236 offset0:66 offset1:67
    v_mfma_f32_16x16x32_bf16 v[40:43], v[128:131], v[168:171], v[40:43]
    ds_read_b128 v[100:103], v244 offset:4096
    v_mfma_f32_16x16x32_bf16 v[40:43], v[132:135], v[164:167], v[40:43]
    ds_read2_b32 v[68:69], v236 offset0:192 offset1:193
    v_mfma_f32_16x16x32_bf16 v[40:43], v[136:139], v[160:163], v[40:43]
    ds_read2_b32 v[70:71], v236 offset0:194 offset1:195
    v_mfma_f32_16x16x32_bf16 v[44:47], v[140:143], v[160:163], v[44:47]
    s_add_u32 m0, s73, 16384
    v_mfma_f32_16x16x32_bf16 v[44:47], v[136:139], v[164:167], v[44:47]
    buffer_load_dwordx4 v5, s[52:55], s14 offen offset:1024 lds
    v_mfma_f32_16x16x32_bf16 v[44:47], v[132:135], v[168:171], v[44:47]
    ds_read_b128 v[104:107], v244 offset:8192
    v_mfma_f32_16x16x32_bf16 v[44:47], v[128:131], v[172:175], v[44:47]
    ds_read2_b32 v[72:73], v237 offset0:64 offset1:65
    s_waitcnt lgkmcnt(8)
    v_mfma_f32_16x16x32_bf16 v[48:51], v[128:131], v[176:179], v[48:51]
    ds_read2_b32 v[74:75], v237 offset0:66 offset1:67
    v_mfma_f32_16x16x32_bf16 v[48:51], v[132:135], v[172:175], v[48:51]
    ds_read_b128 v[108:111], v244 offset:12288
    v_mfma_f32_16x16x32_bf16 v[48:51], v[136:139], v[168:171], v[48:51]
    s_waitcnt vmcnt(6)
    ds_read2_b32 v[76:77], v237 offset0:192 offset1:193
    v_mfma_f32_16x16x32_bf16 v[48:51], v[140:143], v[164:167], v[48:51]
    v_add_u32 v10, 131072, v10
    ds_read2_b32 v[78:79], v237 offset0:194 offset1:195
    v_mfma_f32_16x16x32_bf16 v[48:51], v[144:147], v[160:163], v[48:51]
    ds_read_b64_tr_b16 a[192:193], v10 offset:16384
    v_mfma_f32_16x16x32_bf16 v[52:55], v[148:151], v[160:163], v[52:55]
    ds_read_b64_tr_b16 a[194:195], v10 offset:18432
    v_mfma_f32_16x16x32_bf16 v[52:55], v[144:147], v[164:167], v[52:55]
    v_add_u32 v11, 131072, v11
    ds_read_b128 v[112:115], v244 offset:16384
    v_mfma_f32_16x16x32_bf16 v[52:55], v[140:143], v[168:171], v[52:55]
    ds_read_b64_tr_b16 a[196:197], v11 offset:16384
    v_mfma_f32_16x16x32_bf16 v[52:55], v[136:139], v[172:175], v[52:55]
    s_add_u32 m0, s73, 16384
    ds_read_b64_tr_b16 a[198:199], v11 offset:18432
    v_mfma_f32_16x16x32_bf16 v[52:55], v[132:135], v[176:179], v[52:55]
    buffer_load_dwordx4 v6, s[52:55], s14 offen offset:2048 lds
    v_add_u32 v12, 131072, v12
    v_mfma_f32_16x16x32_bf16 v[52:55], v[128:131], v[180:183], v[52:55]
    ds_read_b64_tr_b16 a[200:201], v12 offset:16384
    ds_read2_b32 v[80:81], v238 offset0:64 offset1:65
    v_mfma_f32_16x16x32_bf16 v[56:59], v[128:131], v[184:187], v[56:59]
    ds_read_b64_tr_b16 a[202:203], v12 offset:18432
    v_mfma_f32_16x16x32_bf16 v[56:59], v[132:135], v[180:183], v[56:59]
    v_add_u32 v13, 131072, v13
    ds_read2_b32 v[82:83], v238 offset0:66 offset1:67
    v_mfma_f32_16x16x32_bf16 v[56:59], v[136:139], v[176:179], v[56:59]
    ds_read_b64_tr_b16 a[204:205], v13 offset:16384
    v_mfma_f32_16x16x32_bf16 v[56:59], v[140:143], v[172:175], v[56:59]
    ds_read_b64_tr_b16 a[206:207], v13 offset:18432
    v_mfma_f32_16x16x32_bf16 v[56:59], v[144:147], v[168:171], v[56:59]
    ds_read_b128 v[116:119], v244 offset:20480
    v_mfma_f32_16x16x32_bf16 v[56:59], v[148:151], v[164:167], v[56:59]
    ds_read2_b32 v[84:85], v238 offset0:192 offset1:193
    v_mfma_f32_16x16x32_bf16 v[56:59], v[152:155], v[160:163], v[56:59]
    ds_read2_b32 v[86:87], v238 offset0:194 offset1:195
    v_mfma_f32_16x16x32_bf16 v[60:63], v[156:159], v[160:163], v[60:63]
    ds_read_b128 v[120:123], v244 offset:24576
    v_mfma_f32_16x16x32_bf16 v[60:63], v[152:155], v[164:167], v[60:63]
    ds_read2_b32 v[88:89], v239 offset0:64 offset1:65
    v_mfma_f32_16x16x32_bf16 v[60:63], v[148:151], v[168:171], v[60:63]
    s_add_u32 m0, s73, 16384
    ds_read2_b32 v[90:91], v239 offset0:66 offset1:67
    v_mfma_f32_16x16x32_bf16 v[60:63], v[144:147], v[172:175], v[60:63]
    buffer_load_dwordx4 v7, s[52:55], s14 offen offset:3072 lds
    v_mfma_f32_16x16x32_bf16 v[60:63], v[140:143], v[176:179], v[60:63]
    ds_read_b128 v[124:127], v244 offset:28672
    v_mfma_f32_16x16x32_bf16 v[60:63], v[136:139], v[180:183], v[60:63]
    ds_read2_b32 v[92:93], v239 offset0:192 offset1:193
    v_mfma_f32_16x16x32_bf16 v[60:63], v[132:135], v[184:187], v[60:63]
    ds_read2_b32 v[94:95], v239 offset0:194 offset1:195
    v_mfma_f32_16x16x32_bf16 v[60:63], v[128:131], v[188:191], v[60:63]
    s_waitcnt lgkmcnt(15)
    v_mfma_f32_16x16x32_bf16 v[32:35], v[64:67], v[96:99], v[32:35]
    ds_read_b128 v[160:163], v245 offset:0
    v_mfma_f32_16x16x32_bf16 v[36:39], v[68:71], v[96:99], v[36:39]
    ds_read2_b32 v[128:129], v236 offset0:80 offset1:81
    v_mfma_f32_16x16x32_bf16 v[36:39], v[64:67], v[100:103], v[36:39]
    ds_read2_b32 v[130:131], v236 offset0:82 offset1:83
    v_mfma_f32_16x16x32_bf16 v[40:43], v[64:67], v[104:107], v[40:43]
    ds_read_b128 v[164:167], v245 offset:4096
    v_mfma_f32_16x16x32_bf16 v[40:43], v[68:71], v[100:103], v[40:43]
    ds_read2_b32 v[132:133], v236 offset0:208 offset1:209
    v_mfma_f32_16x16x32_bf16 v[40:43], v[72:75], v[96:99], v[40:43]
    s_waitcnt lgkmcnt(14)
    s_lshl_b32 s14, s99, 17
    v_mfma_f32_16x16x32_bf16 v[44:47], v[76:79], v[96:99], v[44:47]
    s_add_u32 m0, s73, 147456
    v_mfma_f32_16x16x32_bf16 v[44:47], v[72:75], v[100:103], v[44:47]
    buffer_load_dwordx4 v4, s[52:55], s14 offen offset:0 lds
    v_mfma_f32_16x16x32_bf16 v[44:47], v[68:71], v[104:107], v[44:47]
    ds_read2_b32 v[134:135], v236 offset0:210 offset1:211
    v_mfma_f32_16x16x32_bf16 v[44:47], v[64:67], v[108:111], v[44:47]
    s_waitcnt lgkmcnt(6)
    v_mfma_f32_16x16x32_bf16 v[48:51], v[64:67], v[112:115], v[48:51]
    ds_read_b128 v[168:171], v245 offset:8192
    v_mfma_f32_16x16x32_bf16 v[48:51], v[68:71], v[108:111], v[48:51]
    ds_read2_b32 v[136:137], v237 offset0:80 offset1:81
    v_mfma_f32_16x16x32_bf16 v[48:51], v[72:75], v[104:107], v[48:51]
    ds_read2_b32 v[138:139], v237 offset0:82 offset1:83
    v_mfma_f32_16x16x32_bf16 v[48:51], v[76:79], v[100:103], v[48:51]
    ds_read_b128 v[172:175], v245 offset:12288
    v_mfma_f32_16x16x32_bf16 v[48:51], v[80:83], v[96:99], v[48:51]
    ds_read2_b32 v[140:141], v237 offset0:208 offset1:209
    v_mfma_f32_16x16x32_bf16 v[52:55], v[84:87], v[96:99], v[52:55]
    ds_read2_b32 v[142:143], v237 offset0:210 offset1:211
    v_mfma_f32_16x16x32_bf16 v[52:55], v[80:83], v[100:103], v[52:55]
    ds_read_b128 v[176:179], v245 offset:16384
    v_mfma_f32_16x16x32_bf16 v[52:55], v[76:79], v[104:107], v[52:55]
    ds_read2_b32 v[144:145], v238 offset0:80 offset1:81
    v_mfma_f32_16x16x32_bf16 v[52:55], v[72:75], v[108:111], v[52:55]
    s_add_u32 m0, s73, 147456
    ds_read2_b32 v[146:147], v238 offset0:82 offset1:83
    v_mfma_f32_16x16x32_bf16 v[52:55], v[68:71], v[112:115], v[52:55]
    buffer_load_dwordx4 v5, s[52:55], s14 offen offset:1024 lds
    v_mfma_f32_16x16x32_bf16 v[52:55], v[64:67], v[116:119], v[52:55]
    ds_read_b128 v[180:183], v245 offset:20480
    v_mfma_f32_16x16x32_bf16 v[56:59], v[64:67], v[120:123], v[56:59]
    ds_read2_b32 v[148:149], v238 offset0:208 offset1:209
    v_mfma_f32_16x16x32_bf16 v[56:59], v[68:71], v[116:119], v[56:59]
    ds_read2_b32 v[150:151], v238 offset0:210 offset1:211
    v_mfma_f32_16x16x32_bf16 v[56:59], v[72:75], v[112:115], v[56:59]
    ds_read_b128 v[184:187], v245 offset:24576
    v_mfma_f32_16x16x32_bf16 v[56:59], v[76:79], v[108:111], v[56:59]
    s_waitcnt vmcnt(6)
    ds_read2_b32 v[152:153], v239 offset0:80 offset1:81
    v_mfma_f32_16x16x32_bf16 v[56:59], v[80:83], v[104:107], v[56:59]
    v_add_u32 v10, -131072, v10
    ds_read2_b32 v[154:155], v239 offset0:82 offset1:83
    v_mfma_f32_16x16x32_bf16 v[56:59], v[84:87], v[100:103], v[56:59]
    ds_read_b64_tr_b16 a[208:209], v10 offset:0
    v_mfma_f32_16x16x32_bf16 v[56:59], v[88:91], v[96:99], v[56:59]
    ds_read_b64_tr_b16 a[210:211], v10 offset:2048
    v_mfma_f32_16x16x32_bf16 v[60:63], v[92:95], v[96:99], v[60:63]
    v_add_u32 v11, -131072, v11
    ds_read_b128 v[188:191], v245 offset:28672
    v_mfma_f32_16x16x32_bf16 v[60:63], v[88:91], v[100:103], v[60:63]
    ds_read_b64_tr_b16 a[212:213], v11 offset:0
    v_mfma_f32_16x16x32_bf16 v[60:63], v[84:87], v[104:107], v[60:63]
    s_add_u32 m0, s73, 147456
    ds_read_b64_tr_b16 a[214:215], v11 offset:2048
    v_mfma_f32_16x16x32_bf16 v[60:63], v[80:83], v[108:111], v[60:63]
    buffer_load_dwordx4 v6, s[52:55], s14 offen offset:2048 lds
    v_add_u32 v12, -131072, v12
    v_mfma_f32_16x16x32_bf16 v[60:63], v[76:79], v[112:115], v[60:63]
    ds_read_b64_tr_b16 a[216:217], v12 offset:0
    ds_read2_b32 v[156:157], v239 offset0:208 offset1:209
    v_mfma_f32_16x16x32_bf16 v[60:63], v[72:75], v[116:119], v[60:63]
    ds_read_b64_tr_b16 a[218:219], v12 offset:2048
    v_mfma_f32_16x16x32_bf16 v[60:63], v[68:71], v[120:123], v[60:63]
    v_add_u32 v13, -131072, v13
    ds_read2_b32 v[158:159], v239 offset0:210 offset1:211
    v_mfma_f32_16x16x32_bf16 v[60:63], v[64:67], v[124:127], v[60:63]
    ds_read_b64_tr_b16 a[220:221], v13 offset:0
    s_waitcnt lgkmcnt(15)
    v_mfma_f32_16x16x32_bf16 v[32:35], v[128:131], v[160:163], v[32:35]
    ds_read_b64_tr_b16 a[222:223], v13 offset:2048
    v_mfma_f32_16x16x32_bf16 v[36:39], v[132:135], v[160:163], v[36:39]
    ds_read_b128 v[96:99], v246 offset:0
    v_mfma_f32_16x16x32_bf16 v[36:39], v[128:131], v[164:167], v[36:39]
    ds_read2_b32 v[64:65], v236 offset0:96 offset1:97
    v_mfma_f32_16x16x32_bf16 v[40:43], v[128:131], v[168:171], v[40:43]
    ds_read2_b32 v[66:67], v236 offset0:98 offset1:99
    v_mfma_f32_16x16x32_bf16 v[40:43], v[132:135], v[164:167], v[40:43]
    ds_read_b128 v[100:103], v246 offset:4096
    v_mfma_f32_16x16x32_bf16 v[40:43], v[136:139], v[160:163], v[40:43]
    ds_read2_b32 v[68:69], v236 offset0:224 offset1:225
    v_mfma_f32_16x16x32_bf16 v[44:47], v[140:143], v[160:163], v[44:47]
    s_add_u32 m0, s73, 147456
    v_mfma_f32_16x16x32_bf16 v[44:47], v[136:139], v[164:167], v[44:47]
    buffer_load_dwordx4 v7, s[52:55], s14 offen offset:3072 lds
    v_mfma_f32_16x16x32_bf16 v[44:47], v[132:135], v[168:171], v[44:47]
    ds_read2_b32 v[70:71], v236 offset0:226 offset1:227
    v_mfma_f32_16x16x32_bf16 v[44:47], v[128:131], v[172:175], v[44:47]
    s_waitcnt lgkmcnt(8)
    v_mfma_f32_16x16x32_bf16 v[48:51], v[128:131], v[176:179], v[48:51]
    ds_read_b128 v[104:107], v246 offset:8192
    v_mfma_f32_16x16x32_bf16 v[48:51], v[132:135], v[172:175], v[48:51]
    ds_read2_b32 v[72:73], v237 offset0:96 offset1:97
    v_mfma_f32_16x16x32_bf16 v[48:51], v[136:139], v[168:171], v[48:51]
    ds_read2_b32 v[74:75], v237 offset0:98 offset1:99
    v_mfma_f32_16x16x32_bf16 v[48:51], v[140:143], v[164:167], v[48:51]
    ds_read_b128 v[108:111], v246 offset:12288
    v_mfma_f32_16x16x32_bf16 v[48:51], v[144:147], v[160:163], v[48:51]
    v_mfma_f32_16x16x32_bf16 v[52:55], v[148:151], v[160:163], v[52:55]
    ds_read2_b32 v[76:77], v237 offset0:224 offset1:225
    v_mfma_f32_16x16x32_bf16 v[52:55], v[144:147], v[164:167], v[52:55]
    ds_read2_b32 v[78:79], v237 offset0:226 offset1:227
    v_mfma_f32_16x16x32_bf16 v[52:55], v[140:143], v[168:171], v[52:55]
    ds_read_b128 v[112:115], v246 offset:16384
    v_mfma_f32_16x16x32_bf16 v[52:55], v[136:139], v[172:175], v[52:55]
    s_waitcnt lgkmcnt(13)
    s_lshl_b32 s14, s100, 17
    v_mfma_f32_16x16x32_bf16 v[52:55], v[132:135], v[176:179], v[52:55]
    s_add_u32 m0, s73, 0
    v_mfma_f32_16x16x32_bf16 v[52:55], v[128:131], v[180:183], v[52:55]
    buffer_load_dwordx4 v4, s[52:55], s14 offen offset:0 lds
    v_mfma_f32_16x16x32_bf16 v[56:59], v[128:131], v[184:187], v[56:59]
    ds_read2_b32 v[80:81], v238 offset0:96 offset1:97
    v_mfma_f32_16x16x32_bf16 v[56:59], v[132:135], v[180:183], v[56:59]
    ds_read2_b32 v[82:83], v238 offset0:98 offset1:99
    v_mfma_f32_16x16x32_bf16 v[56:59], v[136:139], v[176:179], v[56:59]
    ds_read_b128 v[116:119], v246 offset:20480
    v_mfma_f32_16x16x32_bf16 v[56:59], v[140:143], v[172:175], v[56:59]
    ds_read2_b32 v[84:85], v238 offset0:224 offset1:225
    v_mfma_f32_16x16x32_bf16 v[56:59], v[144:147], v[168:171], v[56:59]
    ds_read2_b32 v[86:87], v238 offset0:226 offset1:227
    v_mfma_f32_16x16x32_bf16 v[56:59], v[148:151], v[164:167], v[56:59]
    ds_read_b128 v[120:123], v246 offset:24576
    v_mfma_f32_16x16x32_bf16 v[56:59], v[152:155], v[160:163], v[56:59]
    ds_read2_b32 v[88:89], v239 offset0:96 offset1:97
    v_mfma_f32_16x16x32_bf16 v[60:63], v[156:159], v[160:163], v[60:63]
    ds_read2_b32 v[90:91], v239 offset0:98 offset1:99
    v_mfma_f32_16x16x32_bf16 v[60:63], v[152:155], v[164:167], v[60:63]
    s_add_u32 m0, s73, 0
    v_mfma_f32_16x16x32_bf16 v[60:63], v[148:151], v[168:171], v[60:63]
    buffer_load_dwordx4 v5, s[52:55], s14 offen offset:1024 lds
    v_mfma_f32_16x16x32_bf16 v[60:63], v[144:147], v[172:175], v[60:63]
    ds_read_b128 v[124:127], v246 offset:28672
    v_mfma_f32_16x16x32_bf16 v[60:63], v[140:143], v[176:179], v[60:63]
    ds_read2_b32 v[92:93], v239 offset0:224 offset1:225
    v_mfma_f32_16x16x32_bf16 v[60:63], v[136:139], v[180:183], v[60:63]
    v_mfma_f32_16x16x32_bf16 v[60:63], v[132:135], v[184:187], v[60:63]
    ds_read2_b32 v[94:95], v239 offset0:226 offset1:227
    v_mfma_f32_16x16x32_bf16 v[60:63], v[128:131], v[188:191], v[60:63]
    s_waitcnt lgkmcnt(12)
    v_mfma_f32_16x16x32_bf16 v[32:35], v[64:67], v[96:99], v[32:35]
    s_waitcnt vmcnt(6)
    ds_read_b128 v[160:163], v247 offset:0
    v_mfma_f32_16x16x32_bf16 v[36:39], v[68:71], v[96:99], v[36:39]
    ds_read_b64_tr_b16 a[224:225], v10 offset:16384
    s_and_b32 s4, s72, 1
    v_mfma_f32_16x16x32_bf16 v[36:39], v[64:67], v[100:103], v[36:39]
    ds_read_b128 v[164:167], v247 offset:4096
    ds_read_b128 v[168:171], v247 offset:8192
    v_mfma_f32_16x16x32_bf16 v[40:43], v[64:67], v[104:107], v[40:43]
    ds_read_b64_tr_b16 a[226:227], v10 offset:18432
    s_lshl_b32 s4, s4, 2
    v_mfma_f32_16x16x32_bf16 v[40:43], v[68:71], v[100:103], v[40:43]
    s_add_u32 m0, s73, 0
    ds_read_b64_tr_b16 a[228:229], v11 offset:16384
    ds_read_b128 v[172:175], v247 offset:12288
    v_mfma_f32_16x16x32_bf16 v[40:43], v[72:75], v[96:99], v[40:43]
    buffer_load_dwordx4 v6, s[52:55], s14 offen offset:2048 lds
    s_add_u32 s4, s4, s3
    v_mfma_f32_16x16x32_bf16 v[44:47], v[76:79], v[96:99], v[44:47]
    ds_read_b64_tr_b16 a[230:231], v11 offset:18432
    s_mul_i32 s4, s4, 18
    ds_read_b128 v[176:179], v247 offset:16384
    v_mfma_f32_16x16x32_bf16 v[44:47], v[72:75], v[100:103], v[44:47]
    ds_read_b64_tr_b16 a[232:233], v12 offset:16384
    ds_read_b128 v[180:183], v247 offset:20480
    v_mfma_f32_16x16x32_bf16 v[44:47], v[68:71], v[104:107], v[44:47]
    s_lshr_b32 s4, s4, 2
    ds_read_b128 v[184:187], v247 offset:24576
    v_mfma_f32_16x16x32_bf16 v[44:47], v[64:67], v[108:111], v[44:47]
    ds_read_b64_tr_b16 a[234:235], v12 offset:18432
    s_waitcnt lgkmcnt(13)
    v_mfma_f32_16x16x32_bf16 v[48:51], v[64:67], v[112:115], v[48:51]
    ds_read_b64_tr_b16 a[236:237], v13 offset:16384
    s_mul_i32 s4, s4, 6
    v_mfma_f32_16x16x32_bf16 v[48:51], v[68:71], v[108:111], v[48:51]
    ds_read_b64_tr_b16 a[238:239], v13 offset:18432
    ds_read_b128 v[188:191], v247 offset:28672
    v_mfma_f32_16x16x32_bf16 v[48:51], v[72:75], v[104:107], v[48:51]
    s_lshr_b32 s5, s72, 1
    ds_read2_b32 v[128:129], v236 offset0:112 offset1:113
    v_mfma_f32_16x16x32_bf16 v[48:51], v[76:79], v[100:103], v[48:51]
    s_mul_i32 s5, s5, 3
    ds_read2_b32 v[130:131], v236 offset0:114 offset1:115
    v_mfma_f32_16x16x32_bf16 v[48:51], v[80:83], v[96:99], v[48:51]
    ds_read2_b32 v[132:133], v236 offset0:240 offset1:241
    ds_read2_b32 v[134:135], v236 offset0:242 offset1:243
    v_mfma_f32_16x16x32_bf16 v[52:55], v[84:87], v[96:99], v[52:55]
    s_add_u32 m0, s73, 0
    s_lshr_b32 s5, s5, 1
    v_mfma_f32_16x16x32_bf16 v[52:55], v[80:83], v[100:103], v[52:55]
    buffer_load_dwordx4 v7, s[52:55], s14 offen offset:3072 lds
    v_mfma_f32_16x16x32_bf16 v[52:55], v[76:79], v[104:107], v[52:55]
    s_add_u32 s4, s4, s5
    ds_read2_b32 v[136:137], v237 offset0:112 offset1:113
    v_mfma_f32_16x16x32_bf16 v[52:55], v[72:75], v[108:111], v[52:55]
    v_min_u32 v28, 9, v2
    ds_read2_b32 v[138:139], v237 offset0:114 offset1:115
    v_mfma_f32_16x16x32_bf16 v[52:55], v[68:71], v[112:115], v[52:55]
    s_add_u32 s6, s12, 4767744
    ds_read2_b32 v[140:141], v237 offset0:240 offset1:241
    v_mfma_f32_16x16x32_bf16 v[52:55], v[64:67], v[116:119], v[52:55]
    v_lshrrev_b32 v29, 1, v28
    ds_read2_b32 v[142:143], v237 offset0:242 offset1:243
    v_mfma_f32_16x16x32_bf16 v[56:59], v[64:67], v[120:123], v[56:59]
    ds_read2_b32 v[144:145], v238 offset0:112 offset1:113
    v_mfma_f32_16x16x32_bf16 v[56:59], v[68:71], v[116:119], v[56:59]
    v_lshl_add_u32 v28, v29, 2, v28
    ds_read2_b32 v[146:147], v238 offset0:114 offset1:115
    v_mfma_f32_16x16x32_bf16 v[56:59], v[72:75], v[112:115], v[56:59]
    v_add_u32 v28, s4, v28
    ds_read2_b32 v[148:149], v238 offset0:240 offset1:241
    v_mfma_f32_16x16x32_bf16 v[56:59], v[76:79], v[108:111], v[56:59]
    ds_read2_b32 v[150:151], v238 offset0:242 offset1:243
    ds_read2_b32 v[152:153], v239 offset0:112 offset1:113
    v_mfma_f32_16x16x32_bf16 v[56:59], v[80:83], v[104:107], v[56:59]
    s_waitcnt lgkmcnt(14)
    s_lshl_b32 s14, s101, 17
    v_and_b32 v29, 3, v28
    v_mfma_f32_16x16x32_bf16 v[56:59], v[84:87], v[100:103], v[56:59]
    s_add_u32 m0, s73, 16384
    ds_read2_b32 v[154:155], v239 offset0:114 offset1:115
    v_mfma_f32_16x16x32_bf16 v[56:59], v[88:91], v[96:99], v[56:59]
    buffer_load_dwordx4 v4, s[52:55], s14 offen offset:0 lds
    v_lshrrev_b32 v28, 2, v28
    v_mfma_f32_16x16x32_bf16 v[60:63], v[92:95], v[96:99], v[60:63]
    ds_read2_b32 v[156:157], v239 offset0:240 offset1:241
    ds_read2_b32 v[158:159], v239 offset0:242 offset1:243
    v_mfma_f32_16x16x32_bf16 v[60:63], v[88:91], v[100:103], v[60:63]
    v_lshlrev_b32 v28, 7, v28
    v_mfma_f32_16x16x32_bf16 v[60:63], v[84:87], v[104:107], v[60:63]
    v_lshl_add_u32 v28, v29, 2, v28
    v_mfma_f32_16x16x32_bf16 v[60:63], v[80:83], v[108:111], v[60:63]
    v_mfma_f32_16x16x32_bf16 v[60:63], v[76:79], v[112:115], v[60:63]
    v_add_u32 v28, 12566528, v28
    v_mfma_f32_16x16x32_bf16 v[60:63], v[72:75], v[116:119], v[60:63]
    v_mfma_f32_16x16x32_bf16 v[60:63], v[68:71], v[120:123], v[60:63]
    v_mfma_f32_16x16x32_bf16 v[60:63], v[64:67], v[124:127], v[60:63]
    s_waitcnt lgkmcnt(0)
    v_mfma_f32_16x16x32_bf16 v[60:63], v[128:131], v[188:191], v[60:63]
    v_mfma_f32_16x16x32_bf16 v[60:63], v[132:135], v[184:187], v[60:63]
    s_add_u32 m0, s73, 16384
    v_mfma_f32_16x16x32_bf16 v[60:63], v[136:139], v[180:183], v[60:63]
    buffer_load_dwordx4 v5, s[52:55], s14 offen offset:1024 lds
    v_mfma_f32_16x16x32_bf16 v[60:63], v[140:143], v[176:179], v[60:63]
    v_mfma_f32_16x16x32_bf16 v[60:63], v[144:147], v[172:175], v[60:63]
    v_mfma_f32_16x16x32_bf16 v[60:63], v[148:151], v[168:171], v[60:63]
    v_mfma_f32_16x16x32_bf16 v[60:63], v[152:155], v[164:167], v[60:63]
    v_mfma_f32_16x16x32_bf16 v[60:63], v[156:159], v[160:163], v[60:63]
    v_mfma_f32_16x16x32_bf16 v[56:59], v[128:131], v[184:187], v[56:59]
    v_mfma_f32_16x16x32_bf16 v[56:59], v[132:135], v[180:183], v[56:59]
    v_mfma_f32_16x16x32_bf16 v[56:59], v[136:139], v[176:179], v[56:59]
    v_mfma_f32_16x16x32_bf16 v[56:59], v[140:143], v[172:175], v[56:59]
    s_add_u32 m0, s73, 16384
    v_mfma_f32_16x16x32_bf16 v[56:59], v[144:147], v[168:171], v[56:59]
    buffer_load_dwordx4 v6, s[52:55], s14 offen offset:2048 lds
    v_mfma_f32_16x16x32_bf16 v[56:59], v[148:151], v[164:167], v[56:59]
    v_cvt_pk_bf16_f32 v206, v60, v61
    v_mfma_f32_16x16x32_bf16 v[56:59], v[152:155], v[160:163], v[56:59]
    v_mfma_f32_16x16x32_bf16 v[52:55], v[128:131], v[180:183], v[52:55]
    v_mfma_f32_16x16x32_bf16 v[52:55], v[132:135], v[176:179], v[52:55]
    v_cvt_pk_bf16_f32 v207, v62, v63
    v_mfma_f32_16x16x32_bf16 v[52:55], v[136:139], v[172:175], v[52:55]
    v_mfma_f32_16x16x32_bf16 v[52:55], v[140:143], v[168:171], v[52:55]
    buffer_store_dwordx2 v[206:207], v8, s[44:47], s6 offen offset:3584 sc1
    v_mfma_f32_16x16x32_bf16 v[52:55], v[144:147], v[164:167], v[52:55]
L_pl_X_6:
    s_cbranch_execz L_wret
    v_mfma_f32_16x16x32_bf16 v[52:55], v[148:151], v[160:163], v[52:55]
    v_mfma_f32_16x16x32_bf16 v[48:51], v[128:131], v[176:179], v[48:51]
    v_cvt_pk_bf16_f32 v204, v56, v57
    v_mfma_f32_16x16x32_bf16 v[48:51], v[132:135], v[172:175], v[48:51]
    s_add_u32 m0, s73, 16384
    v_mfma_f32_16x16x32_bf16 v[48:51], v[136:139], v[168:171], v[48:51]
    buffer_load_dwordx4 v7, s[52:55], s14 offen offset:3072 lds
    v_mfma_f32_16x16x32_bf16 v[48:51], v[140:143], v[164:167], v[48:51]
    v_cvt_pk_bf16_f32 v205, v58, v59
    v_mfma_f32_16x16x32_bf16 v[48:51], v[144:147], v[160:163], v[48:51]
    v_mfma_f32_16x16x32_bf16 v[44:47], v[128:131], v[172:175], v[44:47]
    buffer_store_dwordx2 v[204:205], v8, s[44:47], s6 offen offset:3072 sc1
    v_mfma_f32_16x16x32_bf16 v[44:47], v[132:135], v[168:171], v[44:47]
    v_mfma_f32_16x16x32_bf16 v[44:47], v[136:139], v[164:167], v[44:47]
    v_mfma_f32_16x16x32_bf16 v[44:47], v[140:143], v[160:163], v[44:47]
    v_cvt_pk_bf16_f32 v202, v52, v53
    v_mfma_f32_16x16x32_bf16 v[40:43], v[128:131], v[168:171], v[40:43]
    v_mfma_f32_16x16x32_bf16 v[40:43], v[132:135], v[164:167], v[40:43]
    v_mfma_f32_16x16x32_bf16 v[40:43], v[136:139], v[160:163], v[40:43]
    v_cvt_pk_bf16_f32 v203, v54, v55
    v_mfma_f32_16x16x32_bf16 v[36:39], v[128:131], v[164:167], v[36:39]
    v_mfma_f32_16x16x32_bf16 v[36:39], v[132:135], v[160:163], v[36:39]
    buffer_store_dwordx2 v[202:203], v8, s[44:47], s6 offen offset:2560 sc1
    v_mfma_f32_16x16x32_bf16 v[32:35], v[128:131], v[160:163], v[32:35]
    buffer_load_dword v29, v28, s[44:47], 0 offen sc1
    v_cvt_pk_bf16_f32 v200, v48, v49
    v_cvt_pk_bf16_f32 v201, v50, v51
    buffer_store_dwordx2 v[200:201], v8, s[44:47], s6 offen offset:2048 sc1
    v_cvt_pk_bf16_f32 v198, v44, v45
    v_cvt_pk_bf16_f32 v199, v46, v47
    buffer_store_dwordx2 v[198:199], v8, s[44:47], s6 offen offset:1536 sc1
    v_cvt_pk_bf16_f32 v196, v40, v41
    v_cvt_pk_bf16_f32 v197, v42, v43
    buffer_store_dwordx2 v[196:197], v8, s[44:47], s6 offen offset:1024 sc1
    v_cvt_pk_bf16_f32 v194, v36, v37
    v_cvt_pk_bf16_f32 v195, v38, v39
    buffer_store_dwordx2 v[194:195], v8, s[44:47], s6 offen offset:512 sc1
    v_cvt_pk_bf16_f32 v192, v32, v33
    v_cvt_pk_bf16_f32 v193, v34, v35
    buffer_store_dwordx2 v[192:193], v8, s[44:47], s6 offen offset:0 sc1
    s_waitcnt lgkmcnt(0)
    s_barrier
L_DX:
    v_lshrrev_b32 v31, 4, v2
    v_mul_u32_u24 v24, 17408, v31
    v_and_b32 v25, 15, v2
    v_lshl_add_u32 v24, v25, 4, v24
    s_and_b32 s7, s72, 1
    s_lshl_b32 s7, s7, 2
    s_add_u32 s7, s7, s3
    s_mul_i32 s7, s7, 1253376
    s_lshr_b32 s8, s72, 1
    s_lshl_b32 s8, s8, 12
    s_add_u32 s7, s7, s8
    s_add_u32 s7, s7, 12795904
    v_add_u32 v9, s7, v24
    s_and_b32 s12, s72, 1
    s_xor_b32 s8, s12, 1
    s_lshl_b32 s8, s8, 11
    v_add_u32 v8, s8, v9
    s_lshl_b32 s11, s12, 12
    s_sub_u32 s11, s11, 2048
    s_mov_b32 s8, 12386304
    s_mul_i32 s84, s84, 69632
    s_mul_i32 s85, s85, 69632
    s_mul_i32 s86, s86, 69632
    s_mul_i32 s87, s87, 69632
    s_waitcnt vmcnt(0)
    v_cmp_ne_u32 vcc, s68, v29
    s_cbranch_vccnz L_rs_p2X
L_ok_p2X:
    buffer_load_dwordx4 v[140:143], v8, s[44:47], s84 offen offset:0 sc1
    buffer_load_dwordx4 v[144:147], v8, s[44:47], s85 offen offset:0 sc1
    buffer_load_dwordx4 v[148:151], v8, s[44:47], s84 offen offset:512 sc1
    buffer_load_dwordx4 v[152:155], v8, s[44:47], s85 offen offset:512 sc1
    buffer_load_dwordx4 v[156:159], v8, s[44:47], s84 offen offset:768 sc1
    buffer_load_dwordx4 v[160:163], v8, s[44:47], s85 offen offset:768 sc1
    buffer_load_dwordx4 v[164:167], v8, s[44:47], s84 offen offset:1024 sc1
    buffer_load_dwordx4 v[168:171], v8, s[44:47], s85 offen offset:1024 sc1
    buffer_load_dwordx4 v[172:175], v9, s[44:47], s84 offen offset:1536 sc1
    buffer_load_dwordx4 v[176:179], v9, s[44:47], s85 offen offset:1536 sc1
    s_mul_i32 s88, s88, 69632
    s_mul_i32 s89, s89, 69632
    s_mul_i32 s90, s90, 69632
    s_mul_i32 s91, s91, 69632
    s_mul_i32 s92, s92, 69632
    s_mul_i32 s93, s93, 69632
    s_mul_i32 s94, s94, 69632
    s_mul_i32 s95, s95, 69632
    s_mul_i32 s96, s96, 69632
    s_mul_i32 s97, s97, 69632
    s_mul_i32 s98, s98, 69632
    s_mul_i32 s99, s99, 69632
    s_mul_i32 s100, s100, 69632
    s_mul_i32 s101, s101, 69632
    s_mov_b32 s64, s38
    s_and_b32 s65, s39, 0xffff
    s_mov_b32 s66, 2359296
    s_mov_b32 s67, 0x20000
    s_mov_b32 s56, s16
    s_and_b32 s57, s17, 0xffff
    s_mov_b32 s58, 2359296
    s_mov_b32 s59, 0x20000
    v_add_u32 v24, 0, v2
    v_mul_u32_u24 v25, 7282, v24
    v_lshrrev_b32 v25, 16, v25
    v_mul_u32_u24 v25, 1008, v25
    v_lshl_add_u32 v14, v2, 4, v25
    v_add_u32 v24, 64, v2
    v_mul_u32_u24 v25, 7282, v24
    v_lshrrev_b32 v25, 16, v25
    v_mul_u32_u24 v25, 1008, v25
    v_lshl_add_u32 v15, v2, 4, v25
    v_add_u32 v24, 128, v2
    v_mul_u32_u24 v25, 7282, v24
    v_lshrrev_b32 v25, 16, v25
    v_mul_u32_u24 v25, 1008, v25
    v_lshl_add_u32 v16, v2, 4, v25
    v_cmp_gt_u32 vcc, 16, v2
    v_mov_b32 v25, 0x40000000
    s_nop 0
    v_cndmask_b32 v16, v25, v16, vcc
    s_and_b32 s7, s72, 1
    s_lshl_b32 s7, s7, 2
    s_add_u32 s7, s7, s3
    s_mul_i32 s7, s7, 2359296
    v_subrev_u32 v3, s7, v4
    v_and_b32 v24, 15, v2
    v_mul_u32_u24 v24, 144, v24
    v_lshrrev_b32 v25, 4, v2
    v_lshl_add_u32 v24, v25, 3, v24
    s_add_u32 s7, s73, 131072
    s_lshl_b32 s4, s12, 4
    s_add_u32 s4, s4, s7
    v_add_u32 v1, s4, v24
    s_mul_i32 s4, s12, 144
    s_sub_u32 s4, s7, s4
    v_add_u32 v24, s4, v24
    v_bfe_u32 v25, v2, 2, 3
    v_lshlrev_b32 v25, 7, v25
    v_lshrrev_b32 v31, 5, v2
    v_lshl_add_u32 v25, v31, 12, v25
    v_bfe_u32 v31, v2, 3, 2
    v_xor_b32 v31, s3, v31
    v_lshl_add_u32 v25, v31, 5, v25
    v_and_b32 v31, 3, v2
    v_lshl_add_u32 v25, v31, 3, v25
    v_add_u32 v25, 147456, v25
    buffer_load_dwordx4 v[180:183], v8, s[44:47], s86 offen offset:0 sc1
    buffer_load_dwordx4 v[184:187], v8, s[44:47], s87 offen offset:0 sc1
    buffer_load_dwordx4 v[188:191], v8, s[44:47], s86 offen offset:512 sc1
    buffer_load_dwordx4 v[192:195], v8, s[44:47], s87 offen offset:512 sc1
    buffer_load_dwordx4 v[196:199], v8, s[44:47], s86 offen offset:768 sc1
    buffer_load_dwordx4 v[200:203], v8, s[44:47], s87 offen offset:768 sc1
    buffer_load_dwordx4 v[204:207], v8, s[44:47], s86 offen offset:1024 sc1
    buffer_load_dwordx4 v[208:211], v8, s[44:47], s87 offen offset:1024 sc1
    s_lshl_b32 s7, s71, 6
    s_lshl_b32 s4, s3, 4
    s_add_u32 s7, s7, s4
    s_mul_i32 s7, s7, 1152
    s_mul_i32 s4, s72, 144
    s_add_u32 s7, s7, s4
    s_add_u32 m0, s73, 131072
    s_nop 0
    buffer_load_dwordx4 v14, s[56:59], s7 offen offset:0 lds
    buffer_load_dwordx4 v15, s[56:59], s7 offen offset:1024 lds
    buffer_load_dwordx4 v16, s[56:59], s7 offen offset:2048 lds
    buffer_load_dwordx2 v[26:27], v26, s[44:47], s8 offen sc1
    s_waitcnt vmcnt(20)
    v_mfma_f32_16x16x32_bf16 v[52:55], v[140:143], a[4:7], 0
    s_sub_u32 s4, s75, 216
    s_lshl_b32 s7, s4, 7
    v_mfma_f32_16x16x32_bf16 v[52:55], v[144:147], a[20:23], v[52:55]
    buffer_load_dwordx4 v[212:215], v9, s[44:47], s86 offen offset:1536 sc1
    v_mfma_f32_16x16x32_bf16 v[56:59], v[144:147], a[24:27], 0
    v_mfma_f32_16x16x32_bf16 v[56:59], v[140:143], a[8:11], v[56:59]
    s_lshl2_add_u32 s7, s3, s7
    s_add_u32 s7, s7, 12582912
    v_mfma_f32_16x16x32_bf16 v[60:63], v[140:143], a[12:15], 0
    buffer_load_dwordx4 v[216:219], v9, s[44:47], s87 offen offset:1536 sc1
    v_mfma_f32_16x16x32_bf16 v[60:63], v[144:147], a[28:31], v[60:63]
    v_mfma_f32_16x16x32_bf16 v[32:35], v[144:147], a[16:19], 0
    s_cmp_lt_u32 s4, 36
    s_cselect_b32 s7, s7, 0x40000000
    v_mfma_f32_16x16x32_bf16 v[32:35], v[140:143], a[0:3], v[32:35]
    s_waitcnt vmcnt(20)
    v_mfma_f32_16x16x32_bf16 v[36:39], v[148:151], a[0:3], 0
    v_mfma_f32_16x16x32_bf16 v[36:39], v[152:155], a[16:19], v[36:39]
    buffer_load_dwordx4 v[140:143], v8, s[44:47], s88 offen offset:0 sc1
    v_mfma_f32_16x16x32_bf16 v[72:75], v[152:155], a[28:31], 0
    v_min_u32 v28, 1, v2
    v_mfma_f32_16x16x32_bf16 v[72:75], v[148:151], a[12:15], v[72:75]
    v_mfma_f32_16x16x32_bf16 v[68:71], v[148:151], a[8:11], 0
    buffer_load_dwordx4 v[144:147], v8, s[44:47], s89 offen offset:0 sc1
    v_mfma_f32_16x16x32_bf16 v[68:71], v[152:155], a[24:27], v[68:71]
    v_lshlrev_b32 v28, 30, v28
    v_mfma_f32_16x16x32_bf16 v[64:67], v[152:155], a[20:23], 0
    v_mfma_f32_16x16x32_bf16 v[64:67], v[148:151], a[4:7], v[64:67]
    s_waitcnt vmcnt(20)
    v_mfma_f32_16x16x32_bf16 v[76:79], v[156:159], a[4:7], 0
    v_mov_b32 v29, s68
    v_mfma_f32_16x16x32_bf16 v[76:79], v[160:163], a[20:23], v[76:79]
    buffer_load_dwordx4 v[148:151], v8, s[44:47], s88 offen offset:512 sc1
    v_mfma_f32_16x16x32_bf16 v[80:83], v[160:163], a[24:27], 0
    buffer_store_dword v29, v28, s[44:47], s7 offen sc1
    v_mfma_f32_16x16x32_bf16 v[80:83], v[156:159], a[8:11], v[80:83]
    v_mfma_f32_16x16x32_bf16 v[84:87], v[156:159], a[12:15], 0
    buffer_load_dwordx4 v[152:155], v8, s[44:47], s89 offen offset:512 sc1
    v_mfma_f32_16x16x32_bf16 v[84:87], v[160:163], a[28:31], v[84:87]
    s_xor_b32 s7, s3, 1
    s_lshl_b32 s7, s7, 14
    v_mfma_f32_16x16x32_bf16 v[40:43], v[160:163], a[16:19], 0
    v_mfma_f32_16x16x32_bf16 v[40:43], v[156:159], a[0:3], v[40:43]
    s_waitcnt vmcnt(21)
    v_mfma_f32_16x16x32_bf16 v[44:47], v[164:167], a[0:3], 0
    s_add_u32 s7, s7, 0
    v_lshl_add_u32 v4, v2, 4, s7
    v_mfma_f32_16x16x32_bf16 v[44:47], v[168:171], a[16:19], v[44:47]
    buffer_load_dwordx4 v[156:159], v8, s[44:47], s88 offen offset:768 sc1
    v_mfma_f32_16x16x32_bf16 v[96:99], v[168:171], a[28:31], 0
    v_mfma_f32_16x16x32_bf16 v[96:99], v[164:167], a[12:15], v[96:99]
    s_xor_b32 s7, s3, 2
    s_lshl_b32 s7, s7, 14
    v_mfma_f32_16x16x32_bf16 v[92:95], v[164:167], a[8:11], 0
    buffer_load_dwordx4 v[160:163], v8, s[44:47], s89 offen offset:768 sc1
    v_mfma_f32_16x16x32_bf16 v[92:95], v[168:171], a[24:27], v[92:95]
    v_mfma_f32_16x16x32_bf16 v[88:91], v[168:171], a[20:23], 0
    s_add_u32 s7, s7, 5120
    v_lshl_add_u32 v5, v2, 4, s7
    v_mfma_f32_16x16x32_bf16 v[88:91], v[164:167], a[4:7], v[88:91]
    s_waitcnt vmcnt(21)
    v_mfma_f32_16x16x32_bf16 v[100:103], v[172:175], a[4:7], 0
    s_xor_b32 s7, s3, 3
    s_lshl_b32 s7, s7, 14
    v_mfma_f32_16x16x32_bf16 v[100:103], v[176:179], a[20:23], v[100:103]
    buffer_load_dwordx4 v[164:167], v8, s[44:47], s88 offen offset:1024 sc1
    v_mfma_f32_16x16x32_bf16 v[104:107], v[176:179], a[24:27], 0
    v_mfma_f32_16x16x32_bf16 v[104:107], v[172:175], a[8:11], v[104:107]
    s_add_u32 s7, s7, 10240
    v_lshl_add_u32 v6, v2, 4, s7
    v_mfma_f32_16x16x32_bf16 v[108:111], v[172:175], a[12:15], 0
    buffer_load_dwordx4 v[168:171], v8, s[44:47], s89 offen offset:1024 sc1
    v_mfma_f32_16x16x32_bf16 v[108:111], v[176:179], a[28:31], v[108:111]
    v_mfma_f32_16x16x32_bf16 v[48:51], v[176:179], a[16:19], 0
    s_lshl_b32 s7, s3, 14
    v_lshl_add_u32 v7, v2, 4, s7
    v_mfma_f32_16x16x32_bf16 v[48:51], v[172:175], a[0:3], v[48:51]
    s_waitcnt vmcnt(21)
    v_mfma_f32_16x16x32_bf16 v[32:35], v[180:183], a[32:35], v[32:35]
    v_mfma_f32_16x16x32_bf16 v[32:35], v[184:187], a[48:51], v[32:35]
    buffer_load_dwordx4 v[172:175], v9, s[44:47], s88 offen offset:1536 sc1
    v_mfma_f32_16x16x32_bf16 v[60:63], v[184:187], a[60:63], v[60:63]
    v_lshlrev_b32 v30, 16, v30
    v_mfma_f32_16x16x32_bf16 v[60:63], v[180:183], a[44:47], v[60:63]
    v_mfma_f32_16x16x32_bf16 v[56:59], v[180:183], a[40:43], v[56:59]
    buffer_load_dwordx4 v[176:179], v9, s[44:47], s89 offen offset:1536 sc1
    v_mfma_f32_16x16x32_bf16 v[56:59], v[184:187], a[56:59], v[56:59]
    v_mfma_f32_16x16x32_bf16 v[52:55], v[184:187], a[52:55], v[52:55]
    v_mov_b32 v112, v30
    v_mfma_f32_16x16x32_bf16 v[52:55], v[180:183], a[36:39], v[52:55]
    s_waitcnt vmcnt(21)
    v_mfma_f32_16x16x32_bf16 v[64:67], v[188:191], a[36:39], v[64:67]
    v_mfma_f32_16x16x32_bf16 v[64:67], v[192:195], a[52:55], v[64:67]
    buffer_load_dwordx4 v[180:183], v8, s[44:47], s90 offen offset:0 sc1
    v_mfma_f32_16x16x32_bf16 v[68:71], v[192:195], a[56:59], v[68:71]
    v_mov_b32 v113, v30
    v_mfma_f32_16x16x32_bf16 v[68:71], v[188:191], a[40:43], v[68:71]
    v_mfma_f32_16x16x32_bf16 v[72:75], v[188:191], a[44:47], v[72:75]
    buffer_load_dwordx4 v[184:187], v8, s[44:47], s91 offen offset:0 sc1
    v_mfma_f32_16x16x32_bf16 v[72:75], v[192:195], a[60:63], v[72:75]
    v_mfma_f32_16x16x32_bf16 v[36:39], v[192:195], a[48:51], v[36:39]
    v_mov_b32 v114, v30
    v_mfma_f32_16x16x32_bf16 v[36:39], v[188:191], a[32:35], v[36:39]
    s_waitcnt vmcnt(21)
    v_mfma_f32_16x16x32_bf16 v[40:43], v[196:199], a[32:35], v[40:43]
    v_mfma_f32_16x16x32_bf16 v[40:43], v[200:203], a[48:51], v[40:43]
    buffer_load_dwordx4 v[188:191], v8, s[44:47], s90 offen offset:512 sc1
    v_mfma_f32_16x16x32_bf16 v[84:87], v[200:203], a[60:63], v[84:87]
    v_mov_b32 v115, v30
    v_mfma_f32_16x16x32_bf16 v[84:87], v[196:199], a[44:47], v[84:87]
    v_mfma_f32_16x16x32_bf16 v[80:83], v[196:199], a[40:43], v[80:83]
    buffer_load_dwordx4 v[192:195], v8, s[44:47], s91 offen offset:512 sc1
    v_mfma_f32_16x16x32_bf16 v[80:83], v[200:203], a[56:59], v[80:83]
    v_mfma_f32_16x16x32_bf16 v[76:79], v[200:203], a[52:55], v[76:79]
    v_mfma_f32_16x16x32_bf16 v[76:79], v[196:199], a[36:39], v[76:79]
    s_waitcnt vmcnt(21)
    v_mfma_f32_16x16x32_bf16 v[88:91], v[204:207], a[36:39], v[88:91]
    v_mfma_f32_16x16x32_bf16 v[88:91], v[208:211], a[52:55], v[88:91]
    buffer_load_dwordx4 v[196:199], v8, s[44:47], s90 offen offset:768 sc1
    v_mfma_f32_16x16x32_bf16 v[92:95], v[208:211], a[56:59], v[92:95]
    v_mfma_f32_16x16x32_bf16 v[92:95], v[204:207], a[40:43], v[92:95]
    v_add_u32 v10, 131072, v10
    v_mfma_f32_16x16x32_bf16 v[96:99], v[204:207], a[44:47], v[96:99]
    buffer_load_dwordx4 v[200:203], v8, s[44:47], s91 offen offset:768 sc1
    v_mfma_f32_16x16x32_bf16 v[96:99], v[208:211], a[60:63], v[96:99]
    v_mfma_f32_16x16x32_bf16 v[44:47], v[208:211], a[48:51], v[44:47]
    v_mfma_f32_16x16x32_bf16 v[44:47], v[204:207], a[32:35], v[44:47]
    s_waitcnt vmcnt(17)
    v_mfma_f32_16x16x32_bf16 v[48:51], v[212:215], a[32:35], v[48:51]
    ds_read_b64_tr_b16 a[240:241], v10 offset:16384
    v_mfma_f32_16x16x32_bf16 v[48:51], v[216:219], a[48:51], v[48:51]
    buffer_load_dwordx4 v[204:207], v8, s[44:47], s90 offen offset:1024 sc1
    v_mfma_f32_16x16x32_bf16 v[108:111], v[216:219], a[60:63], v[108:111]
    v_mfma_f32_16x16x32_bf16 v[108:111], v[212:215], a[44:47], v[108:111]
    v_mfma_f32_16x16x32_bf16 v[104:107], v[212:215], a[40:43], v[104:107]
    buffer_load_dwordx4 v[208:211], v8, s[44:47], s91 offen offset:1024 sc1
    v_mfma_f32_16x16x32_bf16 v[104:107], v[216:219], a[56:59], v[104:107]
    ds_read_b64_tr_b16 a[242:243], v10 offset:18432
    v_mfma_f32_16x16x32_bf16 v[100:103], v[216:219], a[52:55], v[100:103]
    v_mfma_f32_16x16x32_bf16 v[100:103], v[212:215], a[36:39], v[100:103]
    s_waitcnt vmcnt(17)
    v_mfma_f32_16x16x32_bf16 v[52:55], v[140:143], a[68:71], v[52:55]
    v_mfma_f32_16x16x32_bf16 v[52:55], v[144:147], a[84:87], v[52:55]
    buffer_load_dwordx4 v[212:215], v9, s[44:47], s90 offen offset:1536 sc1
    v_mfma_f32_16x16x32_bf16 v[56:59], v[144:147], a[88:91], v[56:59]
    v_add_u32 v11, 131072, v11
    v_mfma_f32_16x16x32_bf16 v[56:59], v[140:143], a[72:75], v[56:59]
    v_mfma_f32_16x16x32_bf16 v[60:63], v[140:143], a[76:79], v[60:63]
    buffer_load_dwordx4 v[216:219], v9, s[44:47], s91 offen offset:1536 sc1
    v_mfma_f32_16x16x32_bf16 v[60:63], v[144:147], a[92:95], v[60:63]
    v_mfma_f32_16x16x32_bf16 v[32:35], v[144:147], a[80:83], v[32:35]
    v_mfma_f32_16x16x32_bf16 v[32:35], v[140:143], a[64:67], v[32:35]
    s_waitcnt vmcnt(16)
    v_mfma_f32_16x16x32_bf16 v[36:39], v[148:151], a[64:67], v[36:39]
    ds_read_b64_tr_b16 a[244:245], v11 offset:16384
    v_mfma_f32_16x16x32_bf16 v[36:39], v[152:155], a[80:83], v[36:39]
    buffer_load_dwordx4 v[140:143], v8, s[44:47], s92 offen offset:0 sc1
    v_mfma_f32_16x16x32_bf16 v[72:75], v[152:155], a[92:95], v[72:75]
    v_mfma_f32_16x16x32_bf16 v[72:75], v[148:151], a[76:79], v[72:75]
    v_mfma_f32_16x16x32_bf16 v[68:71], v[148:151], a[72:75], v[68:71]
    buffer_load_dwordx4 v[144:147], v8, s[44:47], s93 offen offset:0 sc1
    v_mfma_f32_16x16x32_bf16 v[68:71], v[152:155], a[88:91], v[68:71]
    ds_read_b64_tr_b16 a[246:247], v11 offset:18432
    v_mfma_f32_16x16x32_bf16 v[64:67], v[152:155], a[84:87], v[64:67]
    v_mfma_f32_16x16x32_bf16 v[64:67], v[148:151], a[68:71], v[64:67]
    s_waitcnt vmcnt(16)
    v_mfma_f32_16x16x32_bf16 v[76:79], v[156:159], a[68:71], v[76:79]
    v_add_u32 v12, 131072, v12
    v_mfma_f32_16x16x32_bf16 v[76:79], v[160:163], a[84:87], v[76:79]
    buffer_load_dwordx4 v[148:151], v8, s[44:47], s92 offen offset:512 sc1
    v_mfma_f32_16x16x32_bf16 v[80:83], v[160:163], a[88:91], v[80:83]
    v_mfma_f32_16x16x32_bf16 v[80:83], v[156:159], a[72:75], v[80:83]
    v_mfma_f32_16x16x32_bf16 v[84:87], v[156:159], a[76:79], v[84:87]
    buffer_load_dwordx4 v[152:155], v8, s[44:47], s93 offen offset:512 sc1
    v_mfma_f32_16x16x32_bf16 v[84:87], v[160:163], a[92:95], v[84:87]
    v_mfma_f32_16x16x32_bf16 v[40:43], v[160:163], a[80:83], v[40:43]
    ds_read_b64_tr_b16 a[248:249], v12 offset:16384
    v_mfma_f32_16x16x32_bf16 v[40:43], v[156:159], a[64:67], v[40:43]
    s_waitcnt vmcnt(16)
    v_mfma_f32_16x16x32_bf16 v[44:47], v[164:167], a[64:67], v[44:47]
    v_mfma_f32_16x16x32_bf16 v[44:47], v[168:171], a[80:83], v[44:47]
    buffer_load_dwordx4 v[156:159], v8, s[44:47], s92 offen offset:768 sc1
    v_mfma_f32_16x16x32_bf16 v[96:99], v[168:171], a[92:95], v[96:99]
    ds_read_b64_tr_b16 a[250:251], v12 offset:18432
    v_mfma_f32_16x16x32_bf16 v[96:99], v[164:167], a[76:79], v[96:99]
    v_mfma_f32_16x16x32_bf16 v[92:95], v[164:167], a[72:75], v[92:95]
    buffer_load_dwordx4 v[160:163], v8, s[44:47], s93 offen offset:768 sc1
    v_mfma_f32_16x16x32_bf16 v[92:95], v[168:171], a[88:91], v[92:95]
    v_mfma_f32_16x16x32_bf16 v[88:91], v[168:171], a[84:87], v[88:91]
    v_add_u32 v13, 131072, v13
    v_mfma_f32_16x16x32_bf16 v[88:91], v[164:167], a[68:71], v[88:91]
    s_waitcnt vmcnt(16)
    v_mfma_f32_16x16x32_bf16 v[100:103], v[172:175], a[68:71], v[100:103]
    v_mfma_f32_16x16x32_bf16 v[100:103], v[176:179], a[84:87], v[100:103]
    buffer_load_dwordx4 v[164:167], v8, s[44:47], s92 offen offset:1024 sc1
    v_mfma_f32_16x16x32_bf16 v[104:107], v[176:179], a[88:91], v[104:107]
    ds_read_b64_tr_b16 a[252:253], v13 offset:16384
    v_mfma_f32_16x16x32_bf16 v[104:107], v[172:175], a[72:75], v[104:107]
    v_mfma_f32_16x16x32_bf16 v[108:111], v[172:175], a[76:79], v[108:111]
    buffer_load_dwordx4 v[168:171], v8, s[44:47], s93 offen offset:1024 sc1
    v_mfma_f32_16x16x32_bf16 v[108:111], v[176:179], a[92:95], v[108:111]
    v_mfma_f32_16x16x32_bf16 v[48:51], v[176:179], a[80:83], v[48:51]
    ds_read_b64_tr_b16 a[254:255], v13 offset:18432
    v_mfma_f32_16x16x32_bf16 v[48:51], v[172:175], a[64:67], v[48:51]
    s_waitcnt vmcnt(16)
    v_mfma_f32_16x16x32_bf16 v[32:35], v[180:183], a[96:99], v[32:35]
    v_mfma_f32_16x16x32_bf16 v[32:35], v[184:187], a[112:115], v[32:35]
    buffer_load_dwordx4 v[172:175], v9, s[44:47], s92 offen offset:1536 sc1
    v_mfma_f32_16x16x32_bf16 v[60:63], v[184:187], a[124:127], v[60:63]
    v_mfma_f32_16x16x32_bf16 v[60:63], v[180:183], a[108:111], v[60:63]
    v_mfma_f32_16x16x32_bf16 v[56:59], v[180:183], a[104:107], v[56:59]
    buffer_load_dwordx4 v[176:179], v9, s[44:47], s93 offen offset:1536 sc1
    v_mfma_f32_16x16x32_bf16 v[56:59], v[184:187], a[120:123], v[56:59]
    ds_read_b64 v[14:15], v1 offset:0
    v_mfma_f32_16x16x32_bf16 v[52:55], v[184:187], a[116:119], v[52:55]
    ds_read_b64 v[16:17], v1 offset:32
    v_mfma_f32_16x16x32_bf16 v[52:55], v[180:183], a[100:103], v[52:55]
    s_waitcnt vmcnt(16)
    v_mfma_f32_16x16x32_bf16 v[64:67], v[188:191], a[100:103], v[64:67]
    v_add_u32 v10, -131072, v10
    v_mfma_f32_16x16x32_bf16 v[64:67], v[192:195], a[116:119], v[64:67]
    buffer_load_dwordx4 v[180:183], v8, s[44:47], s94 offen offset:0 sc1
    v_mfma_f32_16x16x32_bf16 v[68:71], v[192:195], a[120:123], v[68:71]
    v_mfma_f32_16x16x32_bf16 v[68:71], v[188:191], a[104:107], v[68:71]
    ds_read_b64 v[18:19], v1 offset:64
    v_mfma_f32_16x16x32_bf16 v[72:75], v[188:191], a[108:111], v[72:75]
    buffer_load_dwordx4 v[184:187], v8, s[44:47], s95 offen offset:0 sc1
    v_mfma_f32_16x16x32_bf16 v[72:75], v[192:195], a[124:127], v[72:75]
    ds_read_b64_tr_b16 v[220:221], v10 offset:0
    v_mfma_f32_16x16x32_bf16 v[36:39], v[192:195], a[112:115], v[36:39]
    ds_read_b64 v[20:21], v1 offset:96
    v_mfma_f32_16x16x32_bf16 v[36:39], v[188:191], a[96:99], v[36:39]
    s_waitcnt vmcnt(16)
    v_mfma_f32_16x16x32_bf16 v[40:43], v[196:199], a[96:99], v[40:43]
    ds_read_b64_tr_b16 v[222:223], v10 offset:2048
    v_mfma_f32_16x16x32_bf16 v[40:43], v[200:203], a[112:115], v[40:43]
    buffer_load_dwordx4 v[188:191], v8, s[44:47], s94 offen offset:512 sc1
    v_mfma_f32_16x16x32_bf16 v[84:87], v[200:203], a[124:127], v[84:87]
    ds_read_b64 v[22:23], v24 offset:128
    v_mfma_f32_16x16x32_bf16 v[84:87], v[196:199], a[108:111], v[84:87]
    v_mfma_f32_16x16x32_bf16 v[80:83], v[196:199], a[104:107], v[80:83]
    buffer_load_dwordx4 v[192:195], v8, s[44:47], s95 offen offset:512 sc1
    v_mfma_f32_16x16x32_bf16 v[80:83], v[200:203], a[120:123], v[80:83]
    v_mfma_f32_16x16x32_bf16 v[76:79], v[200:203], a[116:119], v[76:79]
    v_add_u32 v11, -131072, v11
    v_mfma_f32_16x16x32_bf16 v[76:79], v[196:199], a[100:103], v[76:79]
    s_waitcnt vmcnt(16)
    v_mfma_f32_16x16x32_bf16 v[88:91], v[204:207], a[100:103], v[88:91]
    v_mfma_f32_16x16x32_bf16 v[88:91], v[208:211], a[116:119], v[88:91]
    buffer_load_dwordx4 v[196:199], v8, s[44:47], s94 offen offset:768 sc1
    v_mfma_f32_16x16x32_bf16 v[92:95], v[208:211], a[120:123], v[92:95]
    v_mfma_f32_16x16x32_bf16 v[92:95], v[204:207], a[104:107], v[92:95]
    ds_read_b64_tr_b16 v[224:225], v11 offset:0
    v_mfma_f32_16x16x32_bf16 v[96:99], v[204:207], a[108:111], v[96:99]
    buffer_load_dwordx4 v[200:203], v8, s[44:47], s95 offen offset:768 sc1
    v_mfma_f32_16x16x32_bf16 v[96:99], v[208:211], a[124:127], v[96:99]
    v_mfma_f32_16x16x32_bf16 v[44:47], v[208:211], a[112:115], v[44:47]
    v_mfma_f32_16x16x32_bf16 v[44:47], v[204:207], a[96:99], v[44:47]
    s_waitcnt vmcnt(16)
    v_mfma_f32_16x16x32_bf16 v[48:51], v[212:215], a[96:99], v[48:51]
    ds_read_b64_tr_b16 v[226:227], v11 offset:2048
    v_mfma_f32_16x16x32_bf16 v[48:51], v[216:219], a[112:115], v[48:51]
    buffer_load_dwordx4 v[204:207], v8, s[44:47], s94 offen offset:1024 sc1
    v_mfma_f32_16x16x32_bf16 v[108:111], v[216:219], a[124:127], v[108:111]
    v_mfma_f32_16x16x32_bf16 v[108:111], v[212:215], a[108:111], v[108:111]
    v_mfma_f32_16x16x32_bf16 v[104:107], v[212:215], a[104:107], v[104:107]
    buffer_load_dwordx4 v[208:211], v8, s[44:47], s95 offen offset:1024 sc1
    v_mfma_f32_16x16x32_bf16 v[104:107], v[216:219], a[120:123], v[104:107]
    v_add_u32 v12, -131072, v12
    v_mfma_f32_16x16x32_bf16 v[100:103], v[216:219], a[116:119], v[100:103]
    v_mfma_f32_16x16x32_bf16 v[100:103], v[212:215], a[100:103], v[100:103]
    s_waitcnt vmcnt(16)
    v_mfma_f32_16x16x32_bf16 v[52:55], v[140:143], a[132:135], v[52:55]
    v_mfma_f32_16x16x32_bf16 v[52:55], v[144:147], a[148:151], v[52:55]
    buffer_load_dwordx4 v[212:215], v9, s[44:47], s94 offen offset:1536 sc1
    v_mfma_f32_16x16x32_bf16 v[56:59], v[144:147], a[152:155], v[56:59]
    ds_read_b64_tr_b16 v[228:229], v12 offset:0
    v_mfma_f32_16x16x32_bf16 v[56:59], v[140:143], a[136:139], v[56:59]
    v_mfma_f32_16x16x32_bf16 v[60:63], v[140:143], a[140:143], v[60:63]
    buffer_load_dwordx4 v[216:219], v9, s[44:47], s95 offen offset:1536 sc1
    v_mfma_f32_16x16x32_bf16 v[60:63], v[144:147], a[156:159], v[60:63]
    v_mfma_f32_16x16x32_bf16 v[32:35], v[144:147], a[144:147], v[32:35]
    ds_read_b64_tr_b16 v[230:231], v12 offset:2048
    v_mfma_f32_16x16x32_bf16 v[32:35], v[140:143], a[128:131], v[32:35]
    s_waitcnt vmcnt(16)
    v_mfma_f32_16x16x32_bf16 v[36:39], v[148:151], a[128:131], v[36:39]
    v_mfma_f32_16x16x32_bf16 v[36:39], v[152:155], a[144:147], v[36:39]
    buffer_load_dwordx4 v[140:143], v8, s[44:47], s96 offen offset:0 sc1
    v_mfma_f32_16x16x32_bf16 v[72:75], v[152:155], a[156:159], v[72:75]
    v_add_u32 v13, -131072, v13
    v_mfma_f32_16x16x32_bf16 v[72:75], v[148:151], a[140:143], v[72:75]
    v_mfma_f32_16x16x32_bf16 v[68:71], v[148:151], a[136:139], v[68:71]
    buffer_load_dwordx4 v[144:147], v8, s[44:47], s97 offen offset:0 sc1
    v_mfma_f32_16x16x32_bf16 v[68:71], v[152:155], a[152:155], v[68:71]
    v_mfma_f32_16x16x32_bf16 v[64:67], v[152:155], a[148:151], v[64:67]
    ds_read_b64_tr_b16 v[232:233], v13 offset:0
    v_mfma_f32_16x16x32_bf16 v[64:67], v[148:151], a[132:135], v[64:67]
    s_waitcnt vmcnt(16)
    v_mfma_f32_16x16x32_bf16 v[76:79], v[156:159], a[132:135], v[76:79]
    v_mfma_f32_16x16x32_bf16 v[76:79], v[160:163], a[148:151], v[76:79]
    buffer_load_dwordx4 v[148:151], v8, s[44:47], s96 offen offset:512 sc1
    v_mfma_f32_16x16x32_bf16 v[80:83], v[160:163], a[152:155], v[80:83]
    ds_read_b64_tr_b16 v[234:235], v13 offset:2048
    v_mfma_f32_16x16x32_bf16 v[80:83], v[156:159], a[136:139], v[80:83]
    v_mfma_f32_16x16x32_bf16 v[84:87], v[156:159], a[140:143], v[84:87]
    buffer_load_dwordx4 v[152:155], v8, s[44:47], s97 offen offset:512 sc1
    v_mfma_f32_16x16x32_bf16 v[84:87], v[160:163], a[156:159], v[84:87]
    s_mul_i32 s4, s72, 9
    s_lshr_b32 s4, s4, 1
    s_lshl_b32 s4, s4, 2
    v_min_u32 v28, 19, v2
    v_mfma_f32_16x16x32_bf16 v[40:43], v[160:163], a[144:147], v[40:43]
    v_mfma_f32_16x16x32_bf16 v[40:43], v[156:159], a[128:131], v[40:43]
    s_waitcnt vmcnt(16)
    v_mfma_f32_16x16x32_bf16 v[44:47], v[164:167], a[128:131], v[44:47]
    v_add_u32 v28, s4, v28
    v_mfma_f32_16x16x32_bf16 v[44:47], v[168:171], a[144:147], v[44:47]
    buffer_load_dwordx4 v[156:159], v8, s[44:47], s96 offen offset:768 sc1
    v_mfma_f32_16x16x32_bf16 v[96:99], v[168:171], a[156:159], v[96:99]
    v_and_b32 v29, 3, v28
    v_mfma_f32_16x16x32_bf16 v[96:99], v[164:167], a[140:143], v[96:99]
    ds_read_b64_tr_b16 v[236:237], v10 offset:16384
    v_mfma_f32_16x16x32_bf16 v[92:95], v[164:167], a[136:139], v[92:95]
    buffer_load_dwordx4 v[160:163], v8, s[44:47], s97 offen offset:768 sc1
    v_mfma_f32_16x16x32_bf16 v[92:95], v[168:171], a[152:155], v[92:95]
    v_lshrrev_b32 v28, 2, v28
    v_mfma_f32_16x16x32_bf16 v[88:91], v[168:171], a[148:151], v[88:91]
    v_lshlrev_b32 v28, 7, v28
    v_mfma_f32_16x16x32_bf16 v[88:91], v[164:167], a[132:135], v[88:91]
    s_waitcnt vmcnt(16)
    v_mfma_f32_16x16x32_bf16 v[100:103], v[172:175], a[132:135], v[100:103]
    ds_read_b64_tr_b16 v[238:239], v10 offset:18432
    v_mfma_f32_16x16x32_bf16 v[100:103], v[176:179], a[148:151], v[100:103]
    buffer_load_dwordx4 v[164:167], v8, s[44:47], s96 offen offset:1024 sc1
    v_mfma_f32_16x16x32_bf16 v[104:107], v[176:179], a[152:155], v[104:107]
    v_lshl_add_u32 v28, v29, 2, v28
    v_mfma_f32_16x16x32_bf16 v[104:107], v[172:175], a[136:139], v[104:107]
    v_add_u32 v28, 12582912, v28
    v_mfma_f32_16x16x32_bf16 v[108:111], v[172:175], a[140:143], v[108:111]
    buffer_load_dwordx4 v[168:171], v8, s[44:47], s97 offen offset:1024 sc1
    v_mfma_f32_16x16x32_bf16 v[108:111], v[176:179], a[156:159], v[108:111]
    ds_read_b64_tr_b16 v[240:241], v11 offset:16384
    v_mfma_f32_16x16x32_bf16 v[48:51], v[176:179], a[144:147], v[48:51]
    buffer_load_dword v29, v28, s[44:47], 0 offen sc1
    v_mfma_f32_16x16x32_bf16 v[48:51], v[172:175], a[128:131], v[48:51]
    s_waitcnt vmcnt(17)
    v_mfma_f32_16x16x32_bf16 v[32:35], v[180:183], a[160:163], v[32:35]
    v_mfma_f32_16x16x32_bf16 v[32:35], v[184:187], a[176:179], v[32:35]
    buffer_load_dwordx4 v[172:175], v9, s[44:47], s96 offen offset:1536 sc1
    v_mfma_f32_16x16x32_bf16 v[60:63], v[184:187], a[188:191], v[60:63]
    ds_read_b64_tr_b16 v[242:243], v11 offset:18432
    v_mfma_f32_16x16x32_bf16 v[60:63], v[180:183], a[172:175], v[60:63]
    v_mfma_f32_16x16x32_bf16 v[56:59], v[180:183], a[168:171], v[56:59]
    buffer_load_dwordx4 v[176:179], v9, s[44:47], s97 offen offset:1536 sc1
    v_mfma_f32_16x16x32_bf16 v[56:59], v[184:187], a[184:187], v[56:59]
    v_mfma_f32_16x16x32_bf16 v[52:55], v[184:187], a[180:183], v[52:55]
    ds_read_b64_tr_b16 v[244:245], v12 offset:16384
    v_mfma_f32_16x16x32_bf16 v[52:55], v[180:183], a[164:167], v[52:55]
    s_waitcnt vmcnt(17)
    v_mfma_f32_16x16x32_bf16 v[64:67], v[188:191], a[164:167], v[64:67]
    v_mfma_f32_16x16x32_bf16 v[64:67], v[192:195], a[180:183], v[64:67]
    buffer_load_dwordx4 v[180:183], v8, s[44:47], s98 offen offset:0 sc1
    v_mfma_f32_16x16x32_bf16 v[68:71], v[192:195], a[184:187], v[68:71]
    ds_read_b64_tr_b16 v[246:247], v12 offset:18432
    v_mfma_f32_16x16x32_bf16 v[68:71], v[188:191], a[168:171], v[68:71]
    v_mfma_f32_16x16x32_bf16 v[72:75], v[188:191], a[172:175], v[72:75]
    buffer_load_dwordx4 v[184:187], v8, s[44:47], s99 offen offset:0 sc1
    v_mfma_f32_16x16x32_bf16 v[72:75], v[192:195], a[188:191], v[72:75]
    v_mfma_f32_16x16x32_bf16 v[36:39], v[192:195], a[176:179], v[36:39]
    ds_read_b64_tr_b16 v[248:249], v13 offset:16384
    v_mfma_f32_16x16x32_bf16 v[36:39], v[188:191], a[160:163], v[36:39]
    s_waitcnt vmcnt(17)
    v_mfma_f32_16x16x32_bf16 v[40:43], v[196:199], a[160:163], v[40:43]
    v_mfma_f32_16x16x32_bf16 v[40:43], v[200:203], a[176:179], v[40:43]
    buffer_load_dwordx4 v[188:191], v8, s[44:47], s98 offen offset:512 sc1
    v_mfma_f32_16x16x32_bf16 v[84:87], v[200:203], a[188:191], v[84:87]
    ds_read_b64_tr_b16 v[250:251], v13 offset:18432
    v_mfma_f32_16x16x32_bf16 v[84:87], v[196:199], a[172:175], v[84:87]
    v_mfma_f32_16x16x32_bf16 v[80:83], v[196:199], a[168:171], v[80:83]
    buffer_load_dwordx4 v[192:195], v8, s[44:47], s99 offen offset:512 sc1
    v_mfma_f32_16x16x32_bf16 v[80:83], v[200:203], a[184:187], v[80:83]
    v_mfma_f32_16x16x32_bf16 v[76:79], v[200:203], a[180:183], v[76:79]
    v_mfma_f32_16x16x32_bf16 v[76:79], v[196:199], a[164:167], v[76:79]
    s_waitcnt vmcnt(17)
    v_mfma_f32_16x16x32_bf16 v[88:91], v[204:207], a[164:167], v[88:91]
    v_mfma_f32_16x16x32_bf16 v[88:91], v[208:211], a[180:183], v[88:91]
    buffer_load_dwordx4 v[196:199], v8, s[44:47], s98 offen offset:768 sc1
    v_mfma_f32_16x16x32_bf16 v[92:95], v[208:211], a[184:187], v[92:95]
    v_mfma_f32_16x16x32_bf16 v[92:95], v[204:207], a[168:171], v[92:95]
    v_mfma_f32_16x16x32_bf16 v[96:99], v[204:207], a[172:175], v[96:99]
    buffer_load_dwordx4 v[200:203], v8, s[44:47], s99 offen offset:768 sc1
    v_mfma_f32_16x16x32_bf16 v[96:99], v[208:211], a[188:191], v[96:99]
    v_mfma_f32_16x16x32_bf16 v[44:47], v[208:211], a[176:179], v[44:47]
    v_mfma_f32_16x16x32_bf16 v[44:47], v[204:207], a[160:163], v[44:47]
    s_waitcnt vmcnt(17)
    v_mfma_f32_16x16x32_bf16 v[48:51], v[212:215], a[160:163], v[48:51]
    v_mfma_f32_16x16x32_bf16 v[48:51], v[216:219], a[176:179], v[48:51]
    buffer_load_dwordx4 v[204:207], v8, s[44:47], s98 offen offset:1024 sc1
L_pl_X_7:
    s_cbranch_execz L_wret
    v_mfma_f32_16x16x32_bf16 v[108:111], v[216:219], a[188:191], v[108:111]
    v_mfma_f32_16x16x32_bf16 v[108:111], v[212:215], a[172:175], v[108:111]
    v_mfma_f32_16x16x32_bf16 v[104:107], v[212:215], a[168:171], v[104:107]
    buffer_load_dwordx4 v[208:211], v8, s[44:47], s99 offen offset:1024 sc1
    v_mfma_f32_16x16x32_bf16 v[104:107], v[216:219], a[184:187], v[104:107]
    v_mfma_f32_16x16x32_bf16 v[100:103], v[216:219], a[180:183], v[100:103]
    v_mfma_f32_16x16x32_bf16 v[100:103], v[212:215], a[164:167], v[100:103]
    s_branch L_Dc
L_idle:
    s_waitcnt vmcnt(0)
    s_barrier
    s_add_u32 m0, s73, 32768
    s_lshl_b32 s14, s84, 17
    buffer_load_dwordx4 v4, s[52:55], s14 offen offset:0 lds
    buffer_load_dwordx4 v5, s[52:55], s14 offen offset:1024 lds
    buffer_load_dwordx4 v6, s[52:55], s14 offen offset:2048 lds
    buffer_load_dwordx4 v7, s[52:55], s14 offen offset:3072 lds
    s_add_u32 m0, s73, 49152
    s_lshl_b32 s14, s85, 17
    buffer_load_dwordx4 v4, s[52:55], s14 offen offset:0 lds
    buffer_load_dwordx4 v5, s[52:55], s14 offen offset:1024 lds
    buffer_load_dwordx4 v6, s[52:55], s14 offen offset:2048 lds
    buffer_load_dwordx4 v7, s[52:55], s14 offen offset:3072 lds
    s_add_u32 m0, s73, 65536
    s_lshl_b32 s14, s86, 17
    buffer_load_dwordx4 v4, s[52:55], s14 offen offset:0 lds
    buffer_load_dwordx4 v5, s[52:55], s14 offen offset:1024 lds
    buffer_load_dwordx4 v6, s[52:55], s14 offen offset:2048 lds
    buffer_load_dwordx4 v7, s[52:55], s14 offen offset:3072 lds
    s_add_u32 m0, s73, 81920
    s_lshl_b32 s14, s87, 17
    buffer_load_dwordx4 v4, s[52:55], s14 offen offset:0 lds
    buffer_load_dwordx4 v5, s[52:55], s14 offen offset:1024 lds
    buffer_load_dwordx4 v6, s[52:55], s14 offen offset:2048 lds
    buffer_load_dwordx4 v7, s[52:55], s14 offen offset:3072 lds
    s_add_u32 m0, s73, 98304
    s_lshl_b32 s14, s88, 17
    buffer_load_dwordx4 v4, s[52:55], s14 offen offset:0 lds
    buffer_load_dwordx4 v5, s[52:55], s14 offen offset:1024 lds
    buffer_load_dwordx4 v6, s[52:55], s14 offen offset:2048 lds
    buffer_load_dwordx4 v7, s[52:55], s14 offen offset:3072 lds
    s_add_u32 m0, s73, 114688
    s_lshl_b32 s14, s89, 17
    buffer_load_dwordx4 v4, s[52:55], s14 offen offset:0 lds
    buffer_load_dwordx4 v5, s[52:55], s14 offen offset:1024 lds
    buffer_load_dwordx4 v6, s[52:55], s14 offen offset:2048 lds
    buffer_load_dwordx4 v7, s[52:55], s14 offen offset:3072 lds
    s_add_u32 m0, s73, 131072
    s_lshl_b32 s14, s90, 17
    buffer_load_dwordx4 v4, s[52:55], s14 offen offset:0 lds
    buffer_load_dwordx4 v5, s[52:55], s14 offen offset:1024 lds
    buffer_load_dwordx4 v6, s[52:55], s14 offen offset:2048 lds
    buffer_load_dwordx4 v7, s[52:55], s14 offen offset:3072 lds
    s_add_u32 m0, s73, 0
    s_lshl_b32 s14, s91, 17
    buffer_load_dwordx4 v4, s[52:55], s14 offen offset:0 lds
    buffer_load_dwordx4 v5, s[52:55], s14 offen offset:1024 lds
    buffer_load_dwordx4 v6, s[52:55], s14 offen offset:2048 lds
    buffer_load_dwordx4 v7, s[52:55], s14 offen offset:3072 lds
    s_add_u32 m0, s73, 16384
    s_lshl_b32 s14, s92, 17
    buffer_load_dwordx4 v4, s[52:55], s14 offen offset:0 lds
    buffer_load_dwordx4 v5, s[52:55], s14 offen offset:1024 lds
    buffer_load_dwordx4 v6, s[52:55], s14 offen offset:2048 lds
    buffer_load_dwordx4 v7, s[52:55], s14 offen offset:3072 lds
    s_add_u32 m0, s73, 147456
    s_lshl_b32 s14, s93, 17
    buffer_load_dwordx4 v4, s[52:55], s14 offen offset:0 lds
    buffer_load_dwordx4 v5, s[52:55], s14 offen offset:1024 lds
    buffer_load_dwordx4 v6, s[52:55], s14 offen offset:2048 lds
    buffer_load_dwordx4 v7, s[52:55], s14 offen offset:3072 lds
    s_waitcnt vmcnt(36)
    ds_read_b64_tr_b16 a[0:1], v10 offset:32768
    ds_read_b64_tr_b16 a[2:3], v10 offset:34816
    ds_read_b64_tr_b16 a[4:5], v11 offset:32768
    ds_read_b64_tr_b16 a[6:7], v11 offset:34816
    ds_read_b64_tr_b16 a[8:9], v12 offset:32768
    ds_read_b64_tr_b16 a[10:11], v12 offset:34816
    ds_read_b64_tr_b16 a[12:13], v13 offset:32768
    ds_read_b64_tr_b16 a[14:15], v13 offset:34816
    s_waitcnt vmcnt(32) lgkmcnt(0)
    ds_read_b64_tr_b16 a[16:17], v10 offset:49152
    s_add_u32 m0, s73, 32768
    s_lshl_b32 s14, s94, 17
    ds_read_b64_tr_b16 a[18:19], v10 offset:51200
    buffer_load_dwordx4 v4, s[52:55], s14 offen offset:0 lds
    ds_read_b64_tr_b16 a[20:21], v11 offset:49152
    ds_read_b64_tr_b16 a[22:23], v11 offset:51200
    buffer_load_dwordx4 v5, s[52:55], s14 offen offset:1024 lds
    ds_read_b64_tr_b16 a[24:25], v12 offset:49152
    buffer_load_dwordx4 v6, s[52:55], s14 offen offset:2048 lds
    ds_read_b64_tr_b16 a[26:27], v12 offset:51200
    ds_read_b64_tr_b16 a[28:29], v13 offset:49152
    buffer_load_dwordx4 v7, s[52:55], s14 offen offset:3072 lds
    ds_read_b64_tr_b16 a[30:31], v13 offset:51200
    s_waitcnt vmcnt(32) lgkmcnt(0)
    v_add_u32 v10, 65536, v10
    ds_read_b64_tr_b16 a[32:33], v10 offset:0
    s_add_u32 m0, s73, 49152
    s_lshl_b32 s14, s95, 17
    ds_read_b64_tr_b16 a[34:35], v10 offset:2048
    buffer_load_dwordx4 v4, s[52:55], s14 offen offset:0 lds
    v_add_u32 v11, 65536, v11
    ds_read_b64_tr_b16 a[36:37], v11 offset:0
    ds_read_b64_tr_b16 a[38:39], v11 offset:2048
    buffer_load_dwordx4 v5, s[52:55], s14 offen offset:1024 lds
    v_add_u32 v12, 65536, v12
    ds_read_b64_tr_b16 a[40:41], v12 offset:0
    buffer_load_dwordx4 v6, s[52:55], s14 offen offset:2048 lds
    ds_read_b64_tr_b16 a[42:43], v12 offset:2048
    v_add_u32 v13, 65536, v13
    ds_read_b64_tr_b16 a[44:45], v13 offset:0
    buffer_load_dwordx4 v7, s[52:55], s14 offen offset:3072 lds
    ds_read_b64_tr_b16 a[46:47], v13 offset:2048
    s_waitcnt vmcnt(32) lgkmcnt(0)
    ds_read_b64_tr_b16 a[48:49], v10 offset:16384
    s_add_u32 m0, s73, 65536
    s_lshl_b32 s14, s96, 17
    ds_read_b64_tr_b16 a[50:51], v10 offset:18432
    buffer_load_dwordx4 v4, s[52:55], s14 offen offset:0 lds
    ds_read_b64_tr_b16 a[52:53], v11 offset:16384
    ds_read_b64_tr_b16 a[54:55], v11 offset:18432
    buffer_load_dwordx4 v5, s[52:55], s14 offen offset:1024 lds
    ds_read_b64_tr_b16 a[56:57], v12 offset:16384
    buffer_load_dwordx4 v6, s[52:55], s14 offen offset:2048 lds
    ds_read_b64_tr_b16 a[58:59], v12 offset:18432
    ds_read_b64_tr_b16 a[60:61], v13 offset:16384
    buffer_load_dwordx4 v7, s[52:55], s14 offen offset:3072 lds
    ds_read_b64_tr_b16 a[62:63], v13 offset:18432
    s_waitcnt vmcnt(32) lgkmcnt(0)
    ds_read_b64_tr_b16 a[64:65], v10 offset:32768
    s_add_u32 m0, s73, 81920
    s_lshl_b32 s14, s97, 17
    ds_read_b64_tr_b16 a[66:67], v10 offset:34816
    buffer_load_dwordx4 v4, s[52:55], s14 offen offset:0 lds
    ds_read_b64_tr_b16 a[68:69], v11 offset:32768
    ds_read_b64_tr_b16 a[70:71], v11 offset:34816
    buffer_load_dwordx4 v5, s[52:55], s14 offen offset:1024 lds
    ds_read_b64_tr_b16 a[72:73], v12 offset:32768
    buffer_load_dwordx4 v6, s[52:55], s14 offen offset:2048 lds
    ds_read_b64_tr_b16 a[74:75], v12 offset:34816
    ds_read_b64_tr_b16 a[76:77], v13 offset:32768
    buffer_load_dwordx4 v7, s[52:55], s14 offen offset:3072 lds
    ds_read_b64_tr_b16 a[78:79], v13 offset:34816
    s_waitcnt vmcnt(32) lgkmcnt(0)
    ds_read_b64_tr_b16 a[80:81], v10 offset:49152
    s_add_u32 m0, s73, 98304
    s_lshl_b32 s14, s98, 17
    ds_read_b64_tr_b16 a[82:83], v10 offset:51200
    buffer_load_dwordx4 v4, s[52:55], s14 offen offset:0 lds
    ds_read_b64_tr_b16 a[84:85], v11 offset:49152
    ds_read_b64_tr_b16 a[86:87], v11 offset:51200
    buffer_load_dwordx4 v5, s[52:55], s14 offen offset:1024 lds
    ds_read_b64_tr_b16 a[88:89], v12 offset:49152
    buffer_load_dwordx4 v6, s[52:55], s14 offen offset:2048 lds
    ds_read_b64_tr_b16 a[90:91], v12 offset:51200
    ds_read_b64_tr_b16 a[92:93], v13 offset:49152
    buffer_load_dwordx4 v7, s[52:55], s14 offen offset:3072 lds
    ds_read_b64_tr_b16 a[94:95], v13 offset:51200
    s_waitcnt vmcnt(32) lgkmcnt(0)
    v_add_u32 v10, 65536, v10
    ds_read_b64_tr_b16 a[96:97], v10 offset:0
    ds_read_b64_tr_b16 a[98:99], v10 offset:2048
    v_add_u32 v11, 65536, v11
    ds_read_b64_tr_b16 a[100:101], v11 offset:0
    ds_read_b64_tr_b16 a[102:103], v11 offset:2048
    v_add_u32 v12, 65536, v12
    ds_read_b64_tr_b16 a[104:105], v12 offset:0
    ds_read_b64_tr_b16 a[106:107], v12 offset:2048
    v_add_u32 v13, 65536, v13
    ds_read_b64_tr_b16 a[108:109], v13 offset:0
    ds_read_b64_tr_b16 a[110:111], v13 offset:2048
    s_waitcnt vmcnt(28) lgkmcnt(0)
    v_add_u32 v10, -131072, v10
    ds_read_b64_tr_b16 a[112:113], v10 offset:0
    ds_read_b64_tr_b16 a[114:115], v10 offset:2048
    v_add_u32 v11, -131072, v11
    ds_read_b64_tr_b16 a[116:117], v11 offset:0
    ds_read_b64_tr_b16 a[118:119], v11 offset:2048
    v_add_u32 v12, -131072, v12
    ds_read_b64_tr_b16 a[120:121], v12 offset:0
    ds_read_b64_tr_b16 a[122:123], v12 offset:2048
    v_add_u32 v13, -131072, v13
    ds_read_b64_tr_b16 a[124:125], v13 offset:0
    ds_read_b64_tr_b16 a[126:127], v13 offset:2048
    s_waitcnt vmcnt(24) lgkmcnt(0)
    ds_read_b64_tr_b16 a[128:129], v10 offset:16384
    s_add_u32 m0, s73, 0
    s_lshl_b32 s14, s100, 17
    ds_read_b64_tr_b16 a[130:131], v10 offset:18432
    buffer_load_dwordx4 v4, s[52:55], s14 offen offset:0 lds
    ds_read_b64_tr_b16 a[132:133], v11 offset:16384
    ds_read_b64_tr_b16 a[134:135], v11 offset:18432
    buffer_load_dwordx4 v5, s[52:55], s14 offen offset:1024 lds
    ds_read_b64_tr_b16 a[136:137], v12 offset:16384
    buffer_load_dwordx4 v6, s[52:55], s14 offen offset:2048 lds
    ds_read_b64_tr_b16 a[138:139], v12 offset:18432
    ds_read_b64_tr_b16 a[140:141], v13 offset:16384
    buffer_load_dwordx4 v7, s[52:55], s14 offen offset:3072 lds
    ds_read_b64_tr_b16 a[142:143], v13 offset:18432
    s_waitcnt vmcnt(24) lgkmcnt(0)
    v_add_u32 v10, 131072, v10
    ds_read_b64_tr_b16 a[144:145], v10 offset:16384
    s_add_u32 m0, s73, 16384
    s_lshl_b32 s14, s101, 17
    ds_read_b64_tr_b16 a[146:147], v10 offset:18432
    buffer_load_dwordx4 v4, s[52:55], s14 offen offset:0 lds
    v_add_u32 v11, 131072, v11
    ds_read_b64_tr_b16 a[148:149], v11 offset:16384
    ds_read_b64_tr_b16 a[150:151], v11 offset:18432
    buffer_load_dwordx4 v5, s[52:55], s14 offen offset:1024 lds
    v_add_u32 v12, 131072, v12
    ds_read_b64_tr_b16 a[152:153], v12 offset:16384
    buffer_load_dwordx4 v6, s[52:55], s14 offen offset:2048 lds
    ds_read_b64_tr_b16 a[154:155], v12 offset:18432
    v_add_u32 v13, 131072, v13
    ds_read_b64_tr_b16 a[156:157], v13 offset:16384
    buffer_load_dwordx4 v7, s[52:55], s14 offen offset:3072 lds
    ds_read_b64_tr_b16 a[158:159], v13 offset:18432
    s_waitcnt vmcnt(24) lgkmcnt(0)
    v_add_u32 v10, -131072, v10
    ds_read_b64_tr_b16 a[160:161], v10 offset:32768
    s_add_u32 m0, s73, 147456
    s_lshl_b32 s14, s99, 17
    ds_read_b64_tr_b16 a[162:163], v10 offset:34816
    buffer_load_dwordx4 v4, s[52:55], s14 offen offset:0 lds
    v_add_u32 v11, -131072, v11
    ds_read_b64_tr_b16 a[164:165], v11 offset:32768
    ds_read_b64_tr_b16 a[166:167], v11 offset:34816
    buffer_load_dwordx4 v5, s[52:55], s14 offen offset:1024 lds
    v_add_u32 v12, -131072, v12
    ds_read_b64_tr_b16 a[168:169], v12 offset:32768
    buffer_load_dwordx4 v6, s[52:55], s14 offen offset:2048 lds
    ds_read_b64_tr_b16 a[170:171], v12 offset:34816
    v_add_u32 v13, -131072, v13
    ds_read_b64_tr_b16 a[172:173], v13 offset:32768
    buffer_load_dwordx4 v7, s[52:55], s14 offen offset:3072 lds
    ds_read_b64_tr_b16 a[174:175], v13 offset:34816
    s_waitcnt vmcnt(24)
    ds_read_b64_tr_b16 a[176:177], v10 offset:49152
    ds_read_b64_tr_b16 a[178:179], v10 offset:51200
    ds_read_b64_tr_b16 a[180:181], v11 offset:49152
    ds_read_b64_tr_b16 a[182:183], v11 offset:51200
    ds_read_b64_tr_b16 a[184:185], v12 offset:49152
    ds_read_b64_tr_b16 a[186:187], v12 offset:51200
    ds_read_b64_tr_b16 a[188:189], v13 offset:49152
    ds_read_b64_tr_b16 a[190:191], v13 offset:51200
    s_waitcnt vmcnt(20)
    v_add_u32 v10, 65536, v10
    ds_read_b64_tr_b16 a[192:193], v10 offset:0
    ds_read_b64_tr_b16 a[194:195], v10 offset:2048
    v_add_u32 v11, 65536, v11
    ds_read_b64_tr_b16 a[196:197], v11 offset:0
    ds_read_b64_tr_b16 a[198:199], v11 offset:2048
    v_add_u32 v12, 65536, v12
    ds_read_b64_tr_b16 a[200:201], v12 offset:0
    ds_read_b64_tr_b16 a[202:203], v12 offset:2048
    v_add_u32 v13, 65536, v13
    ds_read_b64_tr_b16 a[204:205], v13 offset:0
    ds_read_b64_tr_b16 a[206:207], v13 offset:2048
    s_waitcnt vmcnt(16)
    ds_read_b64_tr_b16 a[208:209], v10 offset:16384
    ds_read_b64_tr_b16 a[210:211], v10 offset:18432
    ds_read_b64_tr_b16 a[212:213], v11 offset:16384
    ds_read_b64_tr_b16 a[214:215], v11 offset:18432
    ds_read_b64_tr_b16 a[216:217], v12 offset:16384
    ds_read_b64_tr_b16 a[218:219], v12 offset:18432
    ds_read_b64_tr_b16 a[220:221], v13 offset:16384
    ds_read_b64_tr_b16 a[222:223], v13 offset:18432
    s_waitcnt vmcnt(12)
    ds_read_b64_tr_b16 a[224:225], v10 offset:32768
    ds_read_b64_tr_b16 a[226:227], v10 offset:34816
    ds_read_b64_tr_b16 a[228:229], v11 offset:32768
    ds_read_b64_tr_b16 a[230:231], v11 offset:34816
    ds_read_b64_tr_b16 a[232:233], v12 offset:32768
    ds_read_b64_tr_b16 a[234:235], v12 offset:34816
    ds_read_b64_tr_b16 a[236:237], v13 offset:32768
    ds_read_b64_tr_b16 a[238:239], v13 offset:34816
    s_waitcnt lgkmcnt(0)
    v_add_u32 v10, -65536, v10
    v_add_u32 v11, -65536, v11
    v_add_u32 v12, -65536, v12
    v_add_u32 v13, -65536, v13
    s_mov_b64 exec, 0
    s_call_b64 s[82:83], L_wc_D
    s_mov_b64 exec, -1
    s_and_b32 s4, s72, 1
    s_lshl_b32 s4, s4, 2
    s_add_u32 s4, s4, s3
    s_mul_i32 s4, s4, 18
    s_lshr_b32 s4, s4, 2
    s_mul_i32 s4, s4, 6
    s_lshr_b32 s5, s72, 1
    s_mul_i32 s5, s5, 3
    s_lshr_b32 s5, s5, 1
    s_add_u32 s4, s4, s5
    v_min_u32 v28, 9, v2
    v_lshrrev_b32 v29, 1, v28
    v_lshl_add_u32 v28, v29, 2, v28
    v_add_u32 v28, s4, v28
    v_and_b32 v29, 3, v28
    v_lshrrev_b32 v28, 2, v28
    v_lshlrev_b32 v28, 7, v28
    v_lshl_add_u32 v28, v29, 2, v28
    v_add_u32 v28, 12566528, v28
    buffer_load_dword v29, v28, s[44:47], 0 offen sc1
    s_branch L_DX
L_end:
.section .rodata,"a"
.p2align 6
.amdhsa_kernel recurrent_scan__ssm_conv_h3__mixer_token_mlp__prompt_kernel
  .amdhsa_next_free_vgpr 512
  .amdhsa_next_free_sgpr 102
  .amdhsa_accum_offset 256
  .amdhsa_group_segment_fixed_size 0
  .amdhsa_kernarg_size 112
  .amdhsa_user_sgpr_count 2
  .amdhsa_user_sgpr_kernarg_segment_ptr 1
  .amdhsa_system_sgpr_workgroup_id_x 1
  .amdhsa_float_denorm_mode_32 3
.end_amdhsa_kernel
```

```asm
; @launch grid=(256,1,1) block=(256,1,1) lds=163840
.amdgcn_target "amdgcn-amd-amdhsa--gfx950"
.text
.globl recurrent_scan__ssm_conv_h3__mixer_token_mlp__prompt_kernel
.p2align 8
.type recurrent_scan__ssm_conv_h3__mixer_token_mlp__prompt_kernel,@function
recurrent_scan__ssm_conv_h3__mixer_token_mlp__prompt_kernel:
    s_cmp_lt_u32 s2, 256
    s_cbranch_scc0 L_exit
    s_load_dwordx2 s[56:57], s[0:1], 0
    s_load_dwordx2 s[48:49], s[0:1], 8
    s_load_dwordx2 s[52:53], s[0:1], 16
    s_load_dwordx2 s[60:61], s[0:1], 24
    s_load_dwordx4 s[24:27], s[0:1], 32
    s_load_dwordx2 s[30:31], s[0:1], 56
    s_load_dwordx8 s[32:39], s[0:1], 64
    s_load_dwordx4 s[40:43], s[0:1], 96
    s_memrealtime s[12:13]
    v_lshrrev_b32 v1, 6, v0
    v_and_b32 v2, 63, v0
    s_getpc_b64 s[6:7]
L_pc:
    s_lshr_b32 s4, s2, 1
    s_and_b32 s4, s4, 124
    v_add_u32 v3, s4, v1
    v_lshl_add_u32 v3, v2, 7, v3
    v_lshlrev_b32 v3, 7, v3
    v_min_u32 v3, L_end-L_pc-4, v3
    s_mov_b64 exec, 63
    global_load_dword v255, v3, s[6:7]
    s_mov_b64 exec, -1
    v_readfirstlane_b32 s3, v1
    s_and_b32 s4, s2, 7
    s_lshr_b32 s5, s2, 3
    s_lshl_b32 s4, s4, 5
    s_add_u32 s17, s4, s5
    v_lshrrev_b32 v3, 5, v0
    v_and_b32 v31, 31, v0
    v_mul_u32_u24 v215, 1152, v3
    v_mad_u32_u24 v215, v31, 12, v215
    s_mul_i32 s15, s17, 9216
    v_lshlrev_b32 v21, 4, v2
    s_mov_b32 s58, 2359296
    s_mov_b32 s59, 0x20000
    s_mov_b32 s50, 2359296
    s_mov_b32 s51, 0x20000
    s_mov_b32 s54, 2359296
    s_mov_b32 s55, 0x20000
    s_mov_b32 s62, 4608
    s_mov_b32 s63, 0x20000
    v_lshlrev_b32 v219, 3, v0
    s_movk_i32 s10, 4096
    s_waitcnt lgkmcnt(0)
    buffer_load_dwordx3 v[64:66], v215, s[56:59], s15 offen offset:0
    buffer_load_dwordx3 v[68:70], v215, s[56:59], s15 offen offset:384
    buffer_load_dwordx3 v[72:74], v215, s[56:59], s15 offen offset:768
    s_mov_b32 s64, s40
    s_and_b32 s65, s41, 0xffff
    s_mov_b32 s66, 256
    s_mov_b32 s67, 0x20000
    s_or_b32 s12, s12, 1
    v_or_b32 v1, s2, v0
    v_lshlrev_b32 v1, 8, v1
    v_mov_b32 v3, s12
    buffer_store_dword v3, v1, s[64:67], 0 offen sc1
    s_mov_b32 s44, s42
    s_and_b32 s45, s43, 0xffff
    s_mov_b32 s46, 32309248
    s_mov_b32 s47, 0x20000
    s_mov_b64 s[42:43], s[34:35]
    s_and_b32 s5, s2, 7
    s_lshr_b32 s6, s2, 3
    s_and_b32 s22, s6, 3
    s_lshr_b32 s23, s5, 1
    s_lshl_b32 s20, s3, 12
    s_mul_i32 s21, s3, 3072
    s_add_u32 s21, s21, 90112
    s_mul_i32 s34, s5, 72
    s_add_u32 s34, s34, s6
    s_lshr_b32 s7, s6, 2
    s_lshl_b32 s8, s7, 1
    s_and_b32 s4, s5, 1
    s_lshl_b32 s4, s4, 4
    s_add_u32 s9, s8, 0
    s_cmp_ge_u32 s9, 3
    s_addc_u32 s40, s9, 0
    s_cmp_ge_u32 s9, 10
    s_addc_u32 s40, s40, 0
    s_cmp_eq_u32 s7, 7
    s_cselect_b32 s40, 3, s40
    s_add_u32 s40, s40, s4
    s_lshl_b32 s40, s40, 7
    s_add_u32 s9, s8, 1
    s_cmp_ge_u32 s9, 3
    s_addc_u32 s41, s9, 0
    s_cmp_ge_u32 s9, 10
    s_addc_u32 s41, s41, 0
    s_cmp_eq_u32 s7, 7
    s_cselect_b32 s41, 11, s41
    s_add_u32 s41, s41, s4
    s_lshl_b32 s41, s41, 7
    v_min_u32 v25, 1, v0
    v_lshlrev_b32 v25, 30, v25
    v_min_u32 v23, 1, v2
    v_lshlrev_b32 v23, 30, v23
    v_and_b32 v1, 15, v2
    v_lshrrev_b32 v3, 4, v2
    v_mul_u32_u24 v3, 12288, v3
    v_lshl_add_u32 v22, v1, 4, v3
    s_cmp_lt_u32 s6, 27
    s_cbranch_scc0 L_aux
    s_branch L_org
L_exit:
    s_endpgm
L_nw_G:
    s_mov_b32 s13, 0
L_nl_G:
    buffer_load_dword v226, v225, s[64:67], 0 offen sc1
    s_waitcnt vmcnt(0)
    v_readfirstlane_b32 s16, v226
    s_nop 1
    s_cmp_lg_u32 s16, 0
    s_cbranch_scc1 L_ng_G
    s_add_u32 s13, s13, 1
    s_cmp_lt_u32 s13, 100000
    s_cbranch_scc1 L_nl_G
    s_branch L_ng_G
L_rs_ph:
    s_mov_b32 s13, 0
L_rt_ph:
    s_mov_b64 exec, vcc
    s_sleep 12
    buffer_load_dword v29, v28, s[44:47], 0 offen offset:0 sc1
    s_waitcnt vmcnt(0)
    v_cmp_ne_u32 vcc, s16, v29
    s_cbranch_vccz L_rx_ph
    s_add_u32 s13, s13, 1
    s_cmp_lt_u32 s13, 100000
    s_cbranch_scc1 L_rt_ph
L_rx_ph:
    s_mov_b64 exec, -1
    s_branch L_ok_ph
L_rs_pk:
    s_mov_b32 s13, 0
L_rt_pk:
    s_mov_b64 exec, vcc
    s_sleep 12
    buffer_load_dword v143, v142, s[44:47], 0 offen offset:0 sc1
    s_waitcnt vmcnt(0)
    v_cmp_ne_u32 vcc, s16, v143
    s_cbranch_vccz L_rx_pk
    s_add_u32 s13, s13, 1
    s_cmp_lt_u32 s13, 100000
    s_cbranch_scc1 L_rt_pk
L_rx_pk:
    s_mov_b64 exec, -1
    s_branch L_ok_pk
L_rs_p1:
    s_mov_b32 s13, 0
L_rt_p1:
    s_mov_b64 exec, vcc
    s_sleep 24
    buffer_load_dword v27, v26, s[44:47], 0 offen offset:0 sc1
    s_waitcnt vmcnt(0)
    v_cmp_ne_u32 vcc, s16, v27
    s_cbranch_vccz L_rx_p1
    s_add_u32 s13, s13, 1
    s_cmp_lt_u32 s13, 100000
    s_cbranch_scc1 L_rt_p1
L_rx_p1:
    s_mov_b64 exec, -1
    s_branch L_ok_p1
L_rs_p2:
    s_mov_b32 s13, 0
L_rt_p2:
    s_mov_b64 exec, vcc
    s_sleep 12
    buffer_load_dword v27, v26, s[44:47], 0 offen offset:0 sc1
    s_waitcnt vmcnt(0)
    v_cmp_ne_u32 vcc, s16, v27
    s_cbranch_vccz L_rx_p2
    s_add_u32 s13, s13, 1
    s_cmp_lt_u32 s13, 100000
    s_cbranch_scc1 L_rt_p2
L_rx_p2:
    s_mov_b64 exec, -1
    s_branch L_ok_p2
L_rs_py:
    s_mov_b32 s13, 0
L_rt_py:
    s_mov_b64 exec, vcc
    s_sleep 12
    buffer_load_dword v29, v28, s[44:47], 0 offen offset:0 sc1
    s_waitcnt vmcnt(0)
    v_cmp_ne_u32 vcc, s16, v29
    s_cbranch_vccz L_rx_py
    s_add_u32 s13, s13, 1
    s_cmp_lt_u32 s13, 100000
    s_cbranch_scc1 L_rt_py
L_rx_py:
    s_mov_b64 exec, -1
    s_branch L_ok_py
L_rs_bl0:
    s_mov_b32 s13, 0
L_rt_bl0:
    s_add_u32 s13, s13, 1
    s_cmp_lt_u32 s13, 100000
    s_cbranch_scc0 L_ok_bl0
    buffer_load_dwordx4 v[136:139], v21, s[44:47], s43 offen offset:0 sc1
    buffer_load_dwordx4 v[140:143], v21, s[44:47], s43 offen offset:1024 sc1
    buffer_load_dwordx4 v[108:111], v21, s[44:47], s43 offen offset:2048 sc1
    s_waitcnt vmcnt(0)
    v_xor_b32 v136, v253, v136
    v_xor_b32 v137, v255, v137
    v_xor_b32 v138, v23, v138
    v_xor_b32 v139, v0, v139
    v_or3_b32 v1, v136, v137, v138
    v_xor_b32 v140, v253, v140
    v_xor_b32 v141, v255, v141
    v_or3_b32 v1, v139, v140, v1
    v_xor_b32 v142, v23, v142
    v_xor_b32 v143, v0, v143
    v_or3_b32 v1, v141, v142, v1
    v_xor_b32 v108, v253, v108
    v_xor_b32 v109, v255, v109
    v_or3_b32 v1, v143, v108, v1
    v_xor_b32 v110, v23, v110
    v_xor_b32 v111, v0, v111
    v_or3_b32 v1, v109, v110, v1
    v_or_b32 v1, v111, v1
    v_and_b32 v1, s33, v1
    v_cmp_ne_u32 vcc, 0, v1
    s_cbranch_vccnz L_rt_bl0
    s_branch L_ok_bl0
L_rs_bl1:
    s_mov_b32 s13, 0
L_rt_bl1:
    s_add_u32 s13, s13, 1
    s_cmp_lt_u32 s13, 100000
    s_cbranch_scc0 L_ok_bl1
    buffer_load_dwordx4 v[136:139], v21, s[44:47], s9 offen offset:0 sc1
    buffer_load_dwordx4 v[140:143], v21, s[44:47], s9 offen offset:1024 sc1
    buffer_load_dwordx4 v[108:111], v21, s[44:47], s9 offen offset:2048 sc1
    s_waitcnt vmcnt(0)
    v_xor_b32 v136, v253, v136
    v_xor_b32 v137, v255, v137
    v_xor_b32 v138, v23, v138
    v_xor_b32 v139, v0, v139
    v_or3_b32 v1, v136, v137, v138
    v_xor_b32 v140, v253, v140
    v_xor_b32 v141, v255, v141
    v_or3_b32 v1, v139, v140, v1
    v_xor_b32 v142, v23, v142
    v_xor_b32 v143, v0, v143
    v_or3_b32 v1, v141, v142, v1
    v_xor_b32 v108, v253, v108
    v_xor_b32 v109, v255, v109
    v_or3_b32 v1, v143, v108, v1
    v_xor_b32 v110, v23, v110
    v_xor_b32 v111, v0, v111
    v_or3_b32 v1, v109, v110, v1
    v_or_b32 v1, v111, v1
    v_and_b32 v1, s33, v1
    v_cmp_ne_u32 vcc, 0, v1
    s_cbranch_vccnz L_rt_bl1
    s_branch L_ok_bl1
L_rs_cl:
    s_mov_b32 s13, 0
L_rt_cl:
    s_add_u32 s13, s13, 1
    s_cmp_lt_u32 s13, 100000
    s_cbranch_scc0 L_ok_cl
    buffer_load_dwordx4 v[132:135], v21, s[44:47], s4 offen sc1
    buffer_load_dwordx4 v[136:139], v21, s[44:47], s5 offen sc1
    buffer_load_dwordx4 v[140:143], v21, s[44:47], s7 offen sc1
    s_waitcnt vmcnt(0)
    v_xor_b32 v132, v253, v132
    v_xor_b32 v133, v255, v133
    v_xor_b32 v134, v23, v134
    v_xor_b32 v135, v0, v135
    v_or3_b32 v1, v132, v133, v134
    v_xor_b32 v136, v253, v136
    v_xor_b32 v137, v255, v137
    v_or3_b32 v1, v135, v136, v1
    v_xor_b32 v138, v23, v138
    v_xor_b32 v139, v0, v139
    v_or3_b32 v1, v137, v138, v1
    v_xor_b32 v140, v253, v140
    v_xor_b32 v141, v255, v141
    v_or3_b32 v1, v139, v140, v1
    v_xor_b32 v142, v23, v142
    v_xor_b32 v143, v0, v143
    v_or3_b32 v1, v141, v142, v1
    v_or_b32 v1, v143, v1
    v_and_b32 v1, s33, v1
    v_cmp_ne_u32 vcc, 0, v1
    s_cbranch_vccnz L_rt_cl
    s_branch L_ok_cl
L_rs_ol0:
    s_mov_b32 s13, 0
L_rt_ol0:
    s_add_u32 s13, s13, 1
    s_cmp_lt_u32 s13, 100000
    s_cbranch_scc0 L_ok_ol0
    buffer_load_dwordx4 v[64:67], v21, s[44:47], s6 offen offset:0 sc1
    buffer_load_dwordx4 v[68:71], v21, s[44:47], s6 offen offset:1024 sc1
    buffer_load_dwordx4 v[72:75], v21, s[44:47], s6 offen offset:2048 sc1
    s_waitcnt vmcnt(0)
    v_xor_b32 v64, v253, v64
    v_xor_b32 v65, v255, v65
    v_xor_b32 v66, v23, v66
    v_xor_b32 v67, v0, v67
    v_or3_b32 v1, v64, v65, v66
    v_xor_b32 v68, v253, v68
    v_xor_b32 v69, v255, v69
    v_or3_b32 v1, v67, v68, v1
    v_xor_b32 v70, v23, v70
    v_xor_b32 v71, v0, v71
    v_or3_b32 v1, v69, v70, v1
    v_xor_b32 v72, v253, v72
    v_xor_b32 v73, v255, v73
    v_or3_b32 v1, v71, v72, v1
    v_xor_b32 v74, v23, v74
    v_xor_b32 v75, v0, v75
    v_or3_b32 v1, v73, v74, v1
    v_or_b32 v1, v75, v1
    v_and_b32 v1, s33, v1
    v_cmp_ne_u32 vcc, 0, v1
    s_cbranch_vccnz L_rt_ol0
    s_branch L_ok_ol0
L_rs_ol1:
    s_mov_b32 s13, 0
L_rt_ol1:
    s_add_u32 s13, s13, 1
    s_cmp_lt_u32 s13, 100000
    s_cbranch_scc0 L_ok_ol1
    buffer_load_dwordx4 v[64:67], v21, s[44:47], s6 offen offset:0 sc1
    buffer_load_dwordx4 v[68:71], v21, s[44:47], s6 offen offset:1024 sc1
    buffer_load_dwordx4 v[72:75], v21, s[44:47], s6 offen offset:2048 sc1
    s_waitcnt vmcnt(0)
    v_xor_b32 v64, v253, v64
    v_xor_b32 v65, v255, v65
    v_xor_b32 v66, v23, v66
    v_xor_b32 v67, v0, v67
    v_or3_b32 v1, v64, v65, v66
    v_xor_b32 v68, v253, v68
    v_xor_b32 v69, v255, v69
    v_or3_b32 v1, v67, v68, v1
    v_xor_b32 v70, v23, v70
    v_xor_b32 v71, v0, v71
    v_or3_b32 v1, v69, v70, v1
    v_xor_b32 v72, v253, v72
    v_xor_b32 v73, v255, v73
    v_or3_b32 v1, v71, v72, v1
    v_xor_b32 v74, v23, v74
    v_xor_b32 v75, v0, v75
    v_or3_b32 v1, v73, v74, v1
    v_or_b32 v1, v75, v1
    v_and_b32 v1, s33, v1
    v_cmp_ne_u32 vcc, 0, v1
    s_cbranch_vccnz L_rt_ol1
    s_branch L_ok_ol1
L_nw_X:
    s_mov_b32 s13, 0
L_nl_X:
    buffer_load_dword v226, v225, s[64:67], 0 offen sc1
    s_waitcnt vmcnt(0)
    v_readfirstlane_b32 s16, v226
    s_nop 1
    s_cmp_lg_u32 s16, 0
    s_cbranch_scc1 L_ng_X
    s_add_u32 s13, s13, 1
    s_cmp_lt_u32 s13, 100000
    s_cbranch_scc1 L_nl_X
    s_branch L_ng_X
L_rs_pkX:
    s_mov_b32 s13, 0
L_rt_pkX:
    s_mov_b64 exec, vcc
    s_sleep 16
    buffer_load_dword v29, v28, s[44:47], 0 offen offset:0 sc1
    s_waitcnt vmcnt(0)
    v_cmp_ne_u32 vcc, s16, v29
    s_cbranch_vccz L_rx_pkX
    s_add_u32 s13, s13, 1
    s_cmp_lt_u32 s13, 100000
    s_cbranch_scc1 L_rt_pkX
L_rx_pkX:
    s_mov_b64 exec, -1
    s_branch L_ok_pkX
L_wc_G:
    s_cmp_eq_u32 s3, 0
    s_cbranch_scc1 L_pl_G_0
    s_cmp_eq_u32 s3, 1
    s_cbranch_scc1 L_pl_G_1
    s_cmp_eq_u32 s3, 2
    s_cbranch_scc1 L_pl_G_2
    s_branch L_pl_G_3
L_wc_X:
    s_cmp_eq_u32 s3, 0
    s_cbranch_scc1 L_pl_X_0
    s_cmp_eq_u32 s3, 1
    s_cbranch_scc1 L_pl_X_1
    s_cmp_eq_u32 s3, 2
    s_cbranch_scc1 L_pl_X_2
    s_branch L_pl_X_3
L_wc_S:
    s_cmp_eq_u32 s3, 0
    s_cbranch_scc1 L_pl_S_0
    s_cmp_eq_u32 s3, 1
    s_cbranch_scc1 L_pl_S_1
    s_cmp_eq_u32 s3, 2
    s_cbranch_scc1 L_pl_S_2
    s_branch L_pl_S_3
L_wret:
    s_setpc_b64 s[10:11]
.p2align 12
L_org:
    s_mul_i32 s7, s6, 21846
    s_lshr_b32 s7, s7, 16
    s_mul_i32 s8, s7, 3
    s_sub_u32 s9, s6, s8
    s_mul_i32 s8, s23, 9
    s_add_u32 s18, s8, s7
    s_and_b32 s4, s5, 1
    s_lshl1_add_u32 s19, s9, s4
    s_mov_b32 s48, s30
    s_and_b32 s49, s31, 0xffff
    s_mov_b32 s50, 18874368
    s_mov_b32 s51, 0x20000
    s_mov_b32 s52, s42
    s_and_b32 s53, s43, 0xffff
    s_mov_b32 s54, 18874368
    s_mov_b32 s55, 0x20000
    s_mul_i32 s4, s4, 1572864
    s_mul_i32 s7, s9, 65538
    s_lshr_b32 s7, s7, 16
    s_mul_i32 s7, s7, 98304
    s_add_u32 s5, s4, 0
    s_add_u32 s68, s7, s5
    s_add_u32 s8, s5, 294912
    s_add_u32 s69, s68, 98304
    s_cmp_eq_u32 s69, s8
    s_cselect_b32 s69, s5, s69
    s_add_u32 s70, s69, 98304
    s_cmp_eq_u32 s70, s8
    s_cselect_b32 s70, s5, s70
    s_mul_i32 s7, s9, 65538
    s_lshr_b32 s7, s7, 16
    s_mul_i32 s7, s7, 98304
    s_add_u32 s5, s4, 294912
    s_add_u32 s71, s7, s5
    s_add_u32 s8, s5, 294912
    s_add_u32 s72, s71, 98304
    s_cmp_eq_u32 s72, s8
    s_cselect_b32 s72, s5, s72
    s_add_u32 s73, s72, 98304
    s_cmp_eq_u32 s73, s8
    s_cselect_b32 s73, s5, s73
    s_mul_i32 s7, s9, 65538
    s_lshr_b32 s7, s7, 16
    s_mul_i32 s7, s7, 98304
    s_add_u32 s5, s4, 589824
    s_add_u32 s74, s7, s5
    s_add_u32 s8, s5, 294912
    s_add_u32 s75, s74, 98304
    s_cmp_eq_u32 s75, s8
    s_cselect_b32 s75, s5, s75
    s_add_u32 s76, s75, 98304
    s_cmp_eq_u32 s76, s8
    s_cselect_b32 s76, s5, s76
    s_mul_i32 s7, s9, 152922
    s_lshr_b32 s7, s7, 16
    s_mul_i32 s7, s7, 98304
    s_add_u32 s5, s4, 884736
    s_add_u32 s77, s7, s5
    s_add_u32 s8, s5, 688128
    s_add_u32 s78, s77, 98304
    s_cmp_eq_u32 s78, s8
    s_cselect_b32 s78, s5, s78
    s_add_u32 s79, s78, 98304
    s_cmp_eq_u32 s79, s8
    s_cselect_b32 s79, s5, s79
    s_add_u32 s80, s79, 98304
    s_cmp_eq_u32 s80, s8
    s_cselect_b32 s80, s5, s80
    s_add_u32 s81, s80, 98304
    s_cmp_eq_u32 s81, s8
    s_cselect_b32 s81, s5, s81
    s_add_u32 s82, s81, 98304
    s_cmp_eq_u32 s82, s8
    s_cselect_b32 s82, s5, s82
    s_add_u32 s83, s82, 98304
    s_cmp_eq_u32 s83, s8
    s_cselect_b32 s83, s5, s83
    v_lshrrev_b32 v1, 4, v2
    v_and_b32 v3, 15, v2
    v_lshlrev_b32 v31, 1, v1
    v_xor_b32 v3, v3, v31
    v_mul_u32_u24 v1, 9216, v1
    v_lshl_add_u32 v1, v3, 4, v1
    s_mul_i32 s7, s3, 147456
    s_lshl_b32 s8, s18, 8
    s_add_u32 s7, s7, s8
    v_add_u32 v4, s7, v1
    v_add_u32 v5, 35840, v4
    v_xor_b32 v1, 128, v4
    v_add_u32 v6, 71680, v1
    v_add_u32 v7, 35840, v6
    s_mov_b32 s60, s32
    s_and_b32 s61, s33, 0xffff
    s_mov_b32 s62, 9216
    s_mov_b32 s63, 0x20000
    v_lshrrev_b32 v3, 5, v0
    v_and_b32 v1, 31, v0
    v_mul_u32_u24 v220, 1216, v3
    v_mad_u32_u24 v220, v1, 12, v220
    v_add_u32 v220, 152960, v220
    v_lshlrev_b32 v3, 3, v3
    v_cmp_eq_u32 vcc, 0, v1
    v_mov_b32 v31, 0x40000000
    s_nop 0
    v_cndmask_b32 v216, v31, v3, vcc
    v_lshrrev_b32 v31, 4, v0
    v_and_b32 v1, 3, v2
    v_lshlrev_b32 v1, 3, v1
    v_lshl_add_u32 v1, v31, 5, v1
    v_bfe_u32 v3, v2, 2, 2
    v_mul_u32_u24 v221, 1216, v3
    v_mul_u32_u24 v222, 1152, v3
    s_mov_b32 s9, 152960
    s_mov_b32 s8, 0
    v_add3_u32 v221, v221, v1, s9
    v_add3_u32 v222, v222, v1, s8
    v_and_b32 v223, 15, v0
    v_lshlrev_b32 v223, 4, v223
    v_add_u32 v1, 0, v31
    v_mul_u32_u24 v3, 43, v1
    v_lshrrev_b32 v3, 7, v3
    v_mad_i32_i24 v224, v3, -3, v1
    v_min_u32 v224, 1, v224
    v_add3_u32 v1, v1, v3, v224
    v_lshl_add_u32 v212, v1, 8, v223
    v_add_u32 v1, 16, v31
    v_mul_u32_u24 v3, 43, v1
    v_lshrrev_b32 v3, 7, v3
    v_mad_i32_i24 v224, v3, -3, v1
    v_min_u32 v224, 1, v224
    v_add3_u32 v1, v1, v3, v224
    v_lshl_add_u32 v213, v1, 8, v223
    v_add_u32 v1, 32, v31
    v_mul_u32_u24 v3, 43, v1
    v_lshrrev_b32 v3, 7, v3
    v_mad_i32_i24 v224, v3, -3, v1
    v_min_u32 v224, 1, v224
    v_add3_u32 v1, v1, v3, v224
    v_lshl_add_u32 v214, v1, 8, v223
    s_mul_i32 s4, s17, 12288
    s_add_u32 s6, s4, 4096
    s_add_u32 s7, s4, 3211264
    s_cmp_eq_u32 s3, 0
    s_cselect_b32 s8, s6, 0x40000000
    s_cselect_b32 s9, s7, 0x40000000
    s_lshl_b32 s5, s17, 6
    s_add_u32 s5, s5, 8716288
    v_mov_b32 v225, 0
    s_lshr_b32 s12, s17, 2
    s_lshl_b32 s12, s12, 7
    s_and_b32 s4, s17, 3
    s_lshl2_add_u32 s12, s4, s12
    s_add_u32 s12, s12, 8863744
    s_add_u32 m0, s20, 98304
    s_mul_i32 s14, s68, 6
    buffer_load_dwordx4 v4, s[48:51], s14 offen offset:0 lds
    buffer_load_dwordx4 v5, s[48:51], s14 offen offset:1024 lds
    buffer_load_dwordx4 v6, s[48:51], s14 offen offset:2048 lds
    buffer_load_dwordx4 v7, s[48:51], s14 offen offset:3072 lds
    s_add_u32 m0, s20, 81920
    s_mul_i32 s14, s69, 6
    buffer_load_dwordx4 v4, s[48:51], s14 offen offset:0 lds
    buffer_load_dwordx4 v5, s[48:51], s14 offen offset:1024 lds
    buffer_load_dwordx4 v6, s[48:51], s14 offen offset:2048 lds
    buffer_load_dwordx4 v7, s[48:51], s14 offen offset:3072 lds
    s_waitcnt vmcnt(9)
    v_and_b32 v77, 0xffff0000, v64
    v_lshlrev_b32 v76, 16, v64
    v_and_b32 v79, 0xffff0000, v65
    v_lshlrev_b32 v78, 16, v65
    v_and_b32 v81, 0xffff0000, v66
    v_lshlrev_b32 v80, 16, v66
    v_and_b32 v83, 0xffff0000, v68
    v_lshlrev_b32 v82, 16, v68
    v_and_b32 v85, 0xffff0000, v69
    v_lshlrev_b32 v84, 16, v69
    v_and_b32 v87, 0xffff0000, v70
    v_lshlrev_b32 v86, 16, v70
    v_and_b32 v89, 0xffff0000, v72
    v_lshlrev_b32 v88, 16, v72
    v_and_b32 v91, 0xffff0000, v73
    v_lshlrev_b32 v90, 16, v73
    v_and_b32 v93, 0xffff0000, v74
    v_lshlrev_b32 v92, 16, v74
    v_pk_add_f32 v[94:95], v[76:77], v[78:79]
    v_pk_add_f32 v[96:97], v[80:81], v[82:83]
    v_pk_add_f32 v[98:99], v[84:85], v[86:87]
    v_pk_add_f32 v[100:101], v[88:89], v[90:91]
    v_pk_add_f32 v[94:95], v[94:95], v[96:97]
    v_pk_add_f32 v[98:99], v[98:99], v[100:101]
    v_pk_add_f32 v[94:95], v[94:95], v[92:93]
    v_pk_add_f32 v[94:95], v[94:95], v[98:99]
    v_add_f32 v102, v94, v95
    s_nop 1
    v_add_f32_dpp v102, v102, v102 row_ror:8 row_mask:0xf bank_mask:0xf
    s_nop 1
    v_add_f32_dpp v102, v102, v102 row_ror:4 row_mask:0xf bank_mask:0xf
    s_nop 1
    v_add_f32_dpp v102, v102, v102 row_ror:2 row_mask:0xf bank_mask:0xf
    s_nop 1
    v_add_f32_dpp v102, v102, v102 row_ror:1 row_mask:0xf bank_mask:0xf
    v_mov_b32 v103, v102
    s_nop 1
    v_permlane16_swap_b32 v102, v103
    v_add_f32 v102, v102, v103
    v_mul_f32 v102, 0x3ae38e39, v102
    v_pk_add_f32 v[76:77], v[76:77], v[102:103] op_sel_hi:[1,0] neg_lo:[0,1] neg_hi:[0,1]
    v_pk_add_f32 v[78:79], v[78:79], v[102:103] op_sel_hi:[1,0] neg_lo:[0,1] neg_hi:[0,1]
    v_pk_add_f32 v[80:81], v[80:81], v[102:103] op_sel_hi:[1,0] neg_lo:[0,1] neg_hi:[0,1]
    v_pk_add_f32 v[82:83], v[82:83], v[102:103] op_sel_hi:[1,0] neg_lo:[0,1] neg_hi:[0,1]
    v_pk_add_f32 v[84:85], v[84:85], v[102:103] op_sel_hi:[1,0] neg_lo:[0,1] neg_hi:[0,1]
    v_pk_add_f32 v[86:87], v[86:87], v[102:103] op_sel_hi:[1,0] neg_lo:[0,1] neg_hi:[0,1]
    v_pk_add_f32 v[88:89], v[88:89], v[102:103] op_sel_hi:[1,0] neg_lo:[0,1] neg_hi:[0,1]
    v_pk_add_f32 v[90:91], v[90:91], v[102:103] op_sel_hi:[1,0] neg_lo:[0,1] neg_hi:[0,1]
    v_pk_add_f32 v[92:93], v[92:93], v[102:103] op_sel_hi:[1,0] neg_lo:[0,1] neg_hi:[0,1]
    v_pk_mul_f32 v[94:95], v[76:77], v[76:77]
    v_pk_mul_f32 v[96:97], v[78:79], v[78:79]
    v_pk_fma_f32 v[94:95], v[80:81], v[80:81], v[94:95]
    v_pk_fma_f32 v[96:97], v[82:83], v[82:83], v[96:97]
    v_pk_fma_f32 v[94:95], v[84:85], v[84:85], v[94:95]
    v_pk_fma_f32 v[96:97], v[86:87], v[86:87], v[96:97]
    v_pk_fma_f32 v[94:95], v[88:89], v[88:89], v[94:95]
    v_pk_fma_f32 v[96:97], v[90:91], v[90:91], v[96:97]
    v_pk_fma_f32 v[94:95], v[92:93], v[92:93], v[94:95]
    v_pk_add_f32 v[94:95], v[94:95], v[96:97]
    v_add_f32 v104, v94, v95
    s_nop 1
    v_add_f32_dpp v104, v104, v104 row_ror:8 row_mask:0xf bank_mask:0xf
    s_nop 1
    v_add_f32_dpp v104, v104, v104 row_ror:4 row_mask:0xf bank_mask:0xf
    s_nop 1
    v_add_f32_dpp v104, v104, v104 row_ror:2 row_mask:0xf bank_mask:0xf
    s_nop 1
    v_add_f32_dpp v104, v104, v104 row_ror:1 row_mask:0xf bank_mask:0xf
    v_mov_b32 v105, v104
    s_nop 1
    v_permlane16_swap_b32 v104, v105
    v_add_f32 v104, v104, v105
    v_mul_f32 v104, 0x3ae38e39, v104
    v_cvt_pk_bf16_f32 v94, v102, v104
    v_lshlrev_b32 v106, 16, v94
    v_and_b32 v94, 0xffff0000, v94
    v_add_f32 v94, 0x3727c5ac, v94
    v_sub_f32 v102, v102, v106
    v_cvt_pk_bf16_f32 v94, v94, v94
    v_lshlrev_b32 v94, 16, v94
    v_sqrt_f32 v94, v94
    s_nop 0
    v_cvt_pk_bf16_f32 v94, v94, v94
    v_lshlrev_b32 v94, 16, v94
    v_rcp_f32 v107, v94
    s_nop 0
    v_mul_f32 v102, v102, v107
    v_mul_f32 v104, v104, v107
    v_mul_f32 v104, v104, v107
    v_cvt_pk_bf16_f32 v94, v102, v104
    v_lshlrev_b32 v95, 16, v94
    v_and_b32 v94, 0xffff0000, v94
    v_add_f32 v94, 0x3727c5ac, v94
    v_sub_f32 v102, v102, v95
    v_cvt_pk_bf16_f32 v94, v94, v94
    v_lshlrev_b32 v94, 16, v94
    v_sqrt_f32 v94, v94
    s_nop 0
    v_cvt_pk_bf16_f32 v94, v94, v94
    v_lshlrev_b32 v94, 16, v94
    v_rcp_f32 v94, v94
    s_nop 0
    v_mul_f32 v104, v107, v94
    v_mul_f32 v102, v102, v94
    v_pk_fma_f32 v[76:77], v[76:77], v[104:105], v[102:103] op_sel_hi:[1,0,0]
    v_pk_fma_f32 v[78:79], v[78:79], v[104:105], v[102:103] op_sel_hi:[1,0,0]
    v_pk_fma_f32 v[80:81], v[80:81], v[104:105], v[102:103] op_sel_hi:[1,0,0]
    v_pk_fma_f32 v[82:83], v[82:83], v[104:105], v[102:103] op_sel_hi:[1,0,0]
    v_pk_fma_f32 v[84:85], v[84:85], v[104:105], v[102:103] op_sel_hi:[1,0,0]
    v_pk_fma_f32 v[86:87], v[86:87], v[104:105], v[102:103] op_sel_hi:[1,0,0]
    v_pk_fma_f32 v[88:89], v[88:89], v[104:105], v[102:103] op_sel_hi:[1,0,0]
    v_pk_fma_f32 v[90:91], v[90:91], v[104:105], v[102:103] op_sel_hi:[1,0,0]
    v_pk_fma_f32 v[92:93], v[92:93], v[104:105], v[102:103] op_sel_hi:[1,0,0]
    v_cvt_pk_bf16_f32 v64, v76, v77
    v_cvt_pk_bf16_f32 v65, v78, v79
    v_cvt_pk_bf16_f32 v66, v80, v81
    v_cvt_pk_bf16_f32 v67, v82, v83
    v_cvt_pk_bf16_f32 v68, v84, v85
    v_cvt_pk_bf16_f32 v69, v86, v87
    v_cvt_pk_bf16_f32 v70, v88, v89
    v_cvt_pk_bf16_f32 v71, v90, v91
    v_cvt_pk_bf16_f32 v72, v92, v93
    ds_write_b32 v220, v64 offset:0
    ds_write_b32 v220, v65 offset:4
    ds_write_b32 v220, v66 offset:8
    ds_write_b32 v220, v67 offset:384
    ds_write_b32 v220, v68 offset:388
    ds_write_b32 v220, v69 offset:392
    ds_write_b32 v220, v70 offset:768
    ds_write_b32 v220, v71 offset:772
    ds_write_b32 v220, v72 offset:776
    buffer_store_dwordx2 v[106:107], v216, s[44:47], s5 offen sc1
    s_waitcnt lgkmcnt(0)
    s_barrier
    ds_read_b64_tr_b16 v[200:201], v221 offset:0
    ds_read_b64_tr_b16 v[202:203], v221 offset:4864
    ds_read_b64_tr_b16 v[204:205], v221 offset:512
    ds_read_b64_tr_b16 v[206:207], v221 offset:5376
    ds_read_b64_tr_b16 v[208:209], v221 offset:1024
    ds_read_b64_tr_b16 v[210:211], v221 offset:5888
    s_waitcnt lgkmcnt(4)
    buffer_store_dwordx4 v[200:203], v212, s[44:47], s6 offen sc1
    s_waitcnt lgkmcnt(2)
    buffer_store_dwordx4 v[204:207], v213, s[44:47], s6 offen sc1
    s_waitcnt lgkmcnt(0)
    buffer_store_dwordx4 v[208:211], v214, s[44:47], s8 offen sc1
    buffer_load_dword v226, v225, s[64:67], 0 offen sc1
    v_lshrrev_b32 v1, 4, v2
    v_lshlrev_b32 v1, 3, v1
    s_lshl_b32 s4, s18, 8
    s_lshl_b32 s14, s3, 6
    s_add_u32 s4, s4, s14
    buffer_load_dwordx2 v[148:149], v1, s[60:63], s4 offen
    buffer_load_dwordx2 v[150:151], v1, s[60:63], s4 offen offset:32
    s_mov_b32 s60, s36
    s_and_b32 s61, s37, 0xffff
    s_mov_b32 s62, 4096
    s_mov_b32 s63, 0x20000
    s_cmp_lt_u32 s3, 2
    s_cselect_b32 s4, s40, s41
    s_and_b32 s14, s3, 1
    s_lshl_b32 s14, s14, 6
    s_add_u32 s4, s4, s14
    v_and_b32 v1, 15, v2
    v_lshl_add_u32 v3, v1, 1, s4
    s_and_b32 s14, s23, 1
    s_lshl_b32 s14, s14, 5
    buffer_load_ushort v152, v3, s[60:63], 0 offen
    buffer_load_ushort v153, v3, s[60:63], 0 offen offset:32
    buffer_load_ushort v154, v3, s[60:63], s14 offen
    s_mov_b32 s60, s26
    s_and_b32 s61, s27, 0xffff
    s_mov_b32 s62, 1152
    s_mov_b32 s63, 0x20000
    s_lshl_b32 s4, s34, 1
    v_mov_b32 v30, 0
    buffer_load_ushort v30, v30, s[60:63], s4 offen
    s_add_u32 m0, s20, 65536
    s_mul_i32 s14, s70, 6
    buffer_load_dwordx4 v4, s[48:51], s14 offen offset:0 lds
    buffer_load_dwordx4 v5, s[48:51], s14 offen offset:1024 lds
    buffer_load_dwordx4 v6, s[48:51], s14 offen offset:2048 lds
    buffer_load_dwordx4 v7, s[48:51], s14 offen offset:3072 lds
    s_waitcnt vmcnt(10)
    v_readfirstlane_b32 s16, v226
    s_nop 1
    s_cmp_eq_u32 s16, 0
    s_cbranch_scc1 L_nw_G
L_ng_G:
    v_mov_b32 v24, s16
    s_barrier
    buffer_store_dword v24, v25, s[44:47], s12 offen sc1
    s_add_u32 s12, s12, 8192
L_segG:
L_pl_G_0:
    s_cbranch_execz L_pl_G_4
    s_add_u32 m0, s20, 0
    s_mul_i32 s14, s71, 6
    buffer_load_dwordx4 v4, s[48:51], s14 offen offset:0 lds
    buffer_load_dwordx4 v5, s[48:51], s14 offen offset:1024 lds
    buffer_load_dwordx4 v6, s[48:51], s14 offen offset:2048 lds
    buffer_load_dwordx4 v7, s[48:51], s14 offen offset:3072 lds
    s_add_u32 m0, s20, 16384
    s_mul_i32 s14, s72, 6
    buffer_load_dwordx4 v4, s[48:51], s14 offen offset:0 lds
    buffer_load_dwordx4 v5, s[48:51], s14 offen offset:1024 lds
    buffer_load_dwordx4 v6, s[48:51], s14 offen offset:2048 lds
    buffer_load_dwordx4 v7, s[48:51], s14 offen offset:3072 lds
    s_add_u32 m0, s20, 32768
    s_mul_i32 s14, s73, 6
    buffer_load_dwordx4 v4, s[48:51], s14 offen offset:0 lds
    buffer_load_dwordx4 v5, s[48:51], s14 offen offset:1024 lds
    buffer_load_dwordx4 v6, s[48:51], s14 offen offset:2048 lds
    buffer_load_dwordx4 v7, s[48:51], s14 offen offset:3072 lds
    s_add_u32 m0, s20, 49152
    s_mul_i32 s14, s74, 6
    buffer_load_dwordx4 v4, s[48:51], s14 offen offset:0 lds
    buffer_load_dwordx4 v5, s[48:51], s14 offen offset:1024 lds
    buffer_load_dwordx4 v6, s[48:51], s14 offen offset:2048 lds
    buffer_load_dwordx4 v7, s[48:51], s14 offen offset:3072 lds
    s_mov_b64 exec, 0
    s_call_b64 s[10:11], L_wc_G
    s_mov_b64 exec, -1
    s_mov_b64 exec, 0
    s_call_b64 s[10:11], L_wc_S
    s_mov_b64 exec, -1
    v_bfe_u32 v1, v2, 2, 2
    v_lshrrev_b32 v3, 4, v2
    v_lshl_add_u32 v31, v3, 3, v1
    v_lshlrev_b32 v31, 8, v31
    v_and_b32 v3, 1, v3
    v_lshl_add_u32 v1, v3, 2, v1
    v_and_b32 v3, 3, v2
    v_lshl_add_u32 v31, v3, 3, v31
    s_lshl_b32 s7, s3, 1
    v_xor_b32 v1, s7, v1
    v_lshl_add_u32 v12, v1, 5, v31
    v_xor_b32 v13, 32, v12
    v_add_u32 v14, 0x10000, v12
    v_add_u32 v15, 0x10000, v13
    v_add_u32 v16, 90112, v21
    v_add_u32 v17, 126976, v21
    s_and_b32 s4, s19, 1
    s_lshl2_add_u32 s4, s4, s3
    s_lshl_b32 s4, s4, 5
    v_min_u32 v28, 31, v2
    v_add_u32 v28, s4, v28
    v_and_b32 v29, 3, v28
    v_lshrrev_b32 v28, 2, v28
    v_lshlrev_b32 v28, 7, v28
    v_lshl_add_u32 v28, v29, 2, v28
    v_add_u32 v28, 8863744, v28
    s_waitcnt lgkmcnt(0)
    s_barrier
    ds_read_b64_tr_b16 a[0:1], v14 offset:32768
    ds_read_b64_tr_b16 a[2:3], v14 offset:33792
    ds_read_b64_tr_b16 a[4:5], v15 offset:32768
    ds_read_b64_tr_b16 a[6:7], v15 offset:33792
    ds_read_b64_tr_b16 a[8:9], v14 offset:40960
    ds_read_b64_tr_b16 a[10:11], v14 offset:41984
    ds_read_b64_tr_b16 a[12:13], v15 offset:40960
    ds_read_b64_tr_b16 a[14:15], v15 offset:41984
    s_xor_b32 s4, s19, 1
    s_mov_b32 s5, 247192
    s_cmp_eq_u32 s4, 1
    s_cselect_b32 s5, 255256, s5
    s_cmp_eq_u32 s4, 4
    s_cselect_b32 s5, 255256, s5
    s_lshr_b32 s6, s3, 1
    s_mul_i32 s6, s6, 3
    s_lshr_b32 s5, s5, s6
    s_and_b32 s7, s3, 1
    s_mul_i32 s7, s7, 49152
    s_add_u32 s7, s7, 4096
    s_lshl_b32 s4, s4, 11
    s_waitcnt lgkmcnt(0)
    s_barrier
    ds_read_b64_tr_b16 a[16:17], v14 offset:16384
    ds_read_b64_tr_b16 a[18:19], v14 offset:17408
    ds_read_b64_tr_b16 a[20:21], v15 offset:16384
    ds_read_b64_tr_b16 a[22:23], v15 offset:17408
    ds_read_b64_tr_b16 a[24:25], v14 offset:24576
    ds_read_b64_tr_b16 a[26:27], v14 offset:25600
    ds_read_b64_tr_b16 a[28:29], v15 offset:24576
    ds_read_b64_tr_b16 a[30:31], v15 offset:25600
    s_add_u32 s4, s4, s7
    s_bfe_u32 s8, s5, 0x30000
    s_lshl_b32 s8, s8, 8
    s_add_u32 s8, s8, s4
    s_sub_u32 s8, s8, 0
    v_add_u32 v18, s8, v22
    s_bfe_u32 s8, s5, 0x30006
    s_lshl_b32 s8, s8, 8
    s_add_u32 s8, s8, s4
    s_sub_u32 s8, s8, 1024
    v_add_u32 v19, s8, v22
    s_waitcnt vmcnt(17) lgkmcnt(0)
    s_barrier
    ds_read_b64_tr_b16 a[32:33], v14 offset:0
    ds_read_b64_tr_b16 a[34:35], v14 offset:1024
    ds_read_b64_tr_b16 a[36:37], v15 offset:0
    ds_read_b64_tr_b16 a[38:39], v15 offset:1024
    ds_read_b64_tr_b16 a[40:41], v14 offset:8192
    ds_read_b64_tr_b16 a[42:43], v14 offset:9216
    ds_read_b64_tr_b16 a[44:45], v15 offset:8192
    ds_read_b64_tr_b16 a[46:47], v15 offset:9216
    s_bfe_u32 s8, s5, 0x3000c
    s_lshl_b32 s8, s8, 8
    s_add_u32 s8, s8, s4
    s_sub_u32 s8, s8, 2048
    v_add_u32 v20, s8, v22
    s_mov_b32 s31, 247192
    s_cmp_eq_u32 s19, 1
    s_cselect_b32 s31, 255256, s31
    s_cmp_eq_u32 s19, 4
    s_cselect_b32 s31, 255256, s31
    s_lshl_b32 s4, s19, 11
    s_add_u32 s17, s4, s7
    buffer_load_dword v29, v28, s[44:47], 0 offen offset:0 sc1
    s_waitcnt vmcnt(13) lgkmcnt(0)
    s_barrier
    ds_read_b64_tr_b16 a[48:49], v12 offset:0
    ds_read_b64_tr_b16 a[50:51], v12 offset:1024
    ds_read_b64_tr_b16 a[52:53], v13 offset:0
    ds_read_b64_tr_b16 a[54:55], v13 offset:1024
    ds_read_b64_tr_b16 a[56:57], v12 offset:8192
    ds_read_b64_tr_b16 a[58:59], v12 offset:9216
    ds_read_b64_tr_b16 a[60:61], v13 offset:8192
    ds_read_b64_tr_b16 a[62:63], v13 offset:9216
    v_and_b32 v129, 0xffff0000, v148
    v_lshlrev_b32 v128, 16, v148
    v_and_b32 v131, 0xffff0000, v149
    v_lshlrev_b32 v130, 16, v149
    v_and_b32 v133, 0xffff0000, v150
    v_lshlrev_b32 v132, 16, v150
    v_and_b32 v135, 0xffff0000, v151
    v_lshlrev_b32 v134, 16, v151
    s_waitcnt vmcnt(0)
    v_cmp_ne_u32 vcc, s16, v29
    s_cbranch_vccnz L_rs_ph
L_ok_ph:
    s_waitcnt lgkmcnt(0)
    s_barrier
    s_add_u32 m0, s21, 24576
    s_nop 0
    buffer_load_dwordx4 v18, s[44:47], s68 offen offset:0 sc1 lds
    buffer_load_dwordx4 v19, s[44:47], s68 offen offset:1024 sc1 lds
    buffer_load_dwordx4 v20, s[44:47], s68 offen offset:2048 sc1 lds
    s_add_u32 m0, s21, 36864
    s_nop 0
    buffer_load_dwordx4 v18, s[44:47], s69 offen offset:0 sc1 lds
    buffer_load_dwordx4 v19, s[44:47], s69 offen offset:1024 sc1 lds
    buffer_load_dwordx4 v20, s[44:47], s69 offen offset:2048 sc1 lds
    s_add_u32 m0, s21, 49152
    s_nop 0
    buffer_load_dwordx4 v18, s[44:47], s70 offen offset:0 sc1 lds
    buffer_load_dwordx4 v19, s[44:47], s70 offen offset:1024 sc1 lds
    buffer_load_dwordx4 v20, s[44:47], s70 offen offset:2048 sc1 lds
    s_add_u32 m0, s21, 61440
    s_nop 0
    buffer_load_dwordx4 v18, s[44:47], s71 offen offset:0 sc1 lds
    buffer_load_dwordx4 v19, s[44:47], s71 offen offset:1024 sc1 lds
    buffer_load_dwordx4 v20, s[44:47], s71 offen offset:2048 sc1 lds
    s_add_u32 m0, s21, 0
    s_nop 0
    buffer_load_dwordx4 v18, s[44:47], s72 offen offset:0 sc1 lds
    buffer_load_dwordx4 v19, s[44:47], s72 offen offset:1024 sc1 lds
    buffer_load_dwordx4 v20, s[44:47], s72 offen offset:2048 sc1 lds
    s_add_u32 m0, s21, 12288
    s_nop 0
    buffer_load_dwordx4 v18, s[44:47], s73 offen offset:0 sc1 lds
    buffer_load_dwordx4 v19, s[44:47], s73 offen offset:1024 sc1 lds
    buffer_load_dwordx4 v20, s[44:47], s73 offen offset:2048 sc1 lds
    s_waitcnt vmcnt(15)
    s_barrier
    ds_read_b128 v[32:35], v16 offset:24576
    ds_read_b128 v[36:39], v16 offset:27648
    ds_read_b128 v[40:43], v16 offset:30720
    ds_read_b128 v[44:47], v16 offset:33792
    ds_read_b128 v[48:51], v16 offset:25600
    ds_read_b128 v[52:55], v16 offset:28672
    s_waitcnt lgkmcnt(4)
    v_mfma_f32_16x16x32_bf16 v[64:67], a[0:3], v[32:35], v[128:131]
    ds_read_b128 v[56:59], v16 offset:31744
    v_lshrrev_b32 v1, 4, v2
    v_mfma_f32_16x16x32_bf16 v[64:67], a[8:11], v[36:39], v[64:67]
    v_mfma_f32_16x16x32_bf16 v[68:71], a[12:15], v[36:39], v[132:135]
    s_add_u32 m0, s20, 0
    ds_read_b128 v[60:63], v16 offset:34816
    s_mul_i32 s14, s75, 6
    v_mfma_f32_16x16x32_bf16 v[68:71], a[4:7], v[32:35], v[68:71]
    s_waitcnt lgkmcnt(4)
    buffer_load_dwordx4 v4, s[48:51], s14 offen offset:0 lds
    v_and_b32 v3, 15, v2
    v_mfma_f32_16x16x32_bf16 v[76:79], a[4:7], v[40:43], v[132:135]
    ds_read_b128 v[32:35], v16 offset:26624
    v_lshlrev_b32 v31, 1, v1
    v_mfma_f32_16x16x32_bf16 v[76:79], a[12:15], v[44:47], v[76:79]
    v_mfma_f32_16x16x32_bf16 v[72:75], a[8:11], v[44:47], v[128:131]
    ds_read_b128 v[36:39], v16 offset:29696
    v_xor_b32 v3, v3, v31
    v_mfma_f32_16x16x32_bf16 v[72:75], a[0:3], v[40:43], v[72:75]
    s_waitcnt lgkmcnt(4)
    v_mfma_f32_16x16x32_bf16 v[80:83], a[0:3], v[48:51], v[128:131]
    ds_read_b128 v[40:43], v16 offset:32768
    v_lshlrev_b32 v1, 12, v1
    v_mfma_f32_16x16x32_bf16 v[80:83], a[8:11], v[52:55], v[80:83]
    buffer_load_dwordx4 v5, s[48:51], s14 offen offset:1024 lds
    v_mfma_f32_16x16x32_bf16 v[84:87], a[12:15], v[52:55], v[132:135]
    ds_read_b128 v[44:47], v16 offset:35840
    v_and_b32 v31, 7, v3
    v_mfma_f32_16x16x32_bf16 v[84:87], a[4:7], v[48:51], v[84:87]
    s_waitcnt vmcnt(14) lgkmcnt(4)
    s_barrier
    v_lshl_add_u32 v1, v31, 4, v1
    v_mfma_f32_16x16x32_bf16 v[92:95], a[4:7], v[56:59], v[132:135]
    ds_read_b128 v[48:51], v17 offset:0
    v_mfma_f32_16x16x32_bf16 v[92:95], a[12:15], v[60:63], v[92:95]
    s_lshr_b32 s4, s3, 1
    buffer_load_dwordx4 v6, s[48:51], s14 offen offset:2048 lds
    ds_read_b64_tr_b16 a[64:65], v12 offset:16384
    v_mfma_f32_16x16x32_bf16 v[88:91], a[8:11], v[60:63], v[128:131]
    ds_read_b128 v[52:55], v17 offset:3072
    v_mfma_f32_16x16x32_bf16 v[88:91], a[0:3], v[56:59], v[88:91]
    s_waitcnt lgkmcnt(5)
    s_lshl_b32 s4, s4, 2
    buffer_load_dwordx4 v7, s[48:51], s14 offen offset:3072 lds
    ds_read_b64_tr_b16 a[66:67], v12 offset:17408
    v_mfma_f32_16x16x32_bf16 v[96:99], a[0:3], v[32:35], v[128:131]
    ds_read_b128 v[56:59], v17 offset:6144
    v_mfma_f32_16x16x32_bf16 v[96:99], a[8:11], v[36:39], v[96:99]
    s_and_b32 s5, s3, 1
    v_mfma_f32_16x16x32_bf16 v[100:103], a[12:15], v[36:39], v[132:135]
    ds_read_b128 v[60:63], v17 offset:9216
    v_mfma_f32_16x16x32_bf16 v[100:103], a[4:7], v[32:35], v[100:103]
    s_waitcnt lgkmcnt(6)
    s_add_u32 s4, s4, s5
    ds_read_b64_tr_b16 a[68:69], v13 offset:16384
    v_mfma_f32_16x16x32_bf16 v[108:111], a[4:7], v[40:43], v[132:135]
    ds_read_b128 v[32:35], v17 offset:1024
    v_mfma_f32_16x16x32_bf16 v[108:111], a[12:15], v[44:47], v[108:111]
    s_lshl_b32 s4, s4, 15
    ds_read_b64_tr_b16 a[70:71], v13 offset:17408
    v_mfma_f32_16x16x32_bf16 v[104:107], a[8:11], v[44:47], v[128:131]
    ds_read_b128 v[36:39], v17 offset:4096
    v_add_u32 v1, s4, v1
    v_mfma_f32_16x16x32_bf16 v[104:107], a[0:3], v[40:43], v[104:107]
    s_waitcnt lgkmcnt(7)
    v_mfma_f32_16x16x32_bf16 v[64:67], a[16:19], v[48:51], v[64:67]
    ds_read_b128 v[40:43], v17 offset:7168
    v_mov_b32 v31, s40
    v_mfma_f32_16x16x32_bf16 v[64:67], a[24:27], v[52:55], v[64:67]
    ds_read_b64_tr_b16 a[72:73], v12 offset:24576
    v_mfma_f32_16x16x32_bf16 v[68:71], a[28:31], v[52:55], v[68:71]
    ds_read_b128 v[44:47], v17 offset:10240
    v_mov_b32 v11, s41
    v_mfma_f32_16x16x32_bf16 v[68:71], a[20:23], v[48:51], v[68:71]
    s_waitcnt lgkmcnt(7)
    ds_read_b64_tr_b16 a[74:75], v12 offset:25600
    v_mfma_f32_16x16x32_bf16 v[76:79], a[20:23], v[56:59], v[76:79]
    ds_read_b128 v[48:51], v17 offset:2048
    v_mfma_f32_16x16x32_bf16 v[76:79], a[28:31], v[60:63], v[76:79]
    v_cmp_lt_u32 vcc, 7, v3
    s_nop 1
    v_cndmask_b32 v8, v31, v11, vcc
    v_cndmask_b32 v10, v11, v31, vcc
    v_mfma_f32_16x16x32_bf16 v[72:75], a[24:27], v[60:63], v[72:75]
    ds_read_b128 v[52:55], v17 offset:5120
    v_add_u32 v8, v8, v1
    v_mfma_f32_16x16x32_bf16 v[72:75], a[16:19], v[56:59], v[72:75]
    s_waitcnt lgkmcnt(6)
    ds_read_b64_tr_b16 a[76:77], v13 offset:24576
    v_mfma_f32_16x16x32_bf16 v[80:83], a[16:19], v[32:35], v[80:83]
    ds_read_b128 v[56:59], v17 offset:8192
    v_add_u32 v10, v10, v1
    v_mfma_f32_16x16x32_bf16 v[80:83], a[24:27], v[36:39], v[80:83]
    ds_read_b64_tr_b16 a[78:79], v13 offset:25600
    v_add_u32 v9, 64512, v8
    v_mfma_f32_16x16x32_bf16 v[84:87], a[28:31], v[36:39], v[84:87]
    ds_read_b128 v[60:63], v17 offset:11264
    v_mfma_f32_16x16x32_bf16 v[84:87], a[20:23], v[32:35], v[84:87]
    s_waitcnt vmcnt(13) lgkmcnt(1)
    s_barrier
    v_add_u32 v10, 14336, v10
    v_mfma_f32_16x16x32_bf16 v[92:95], a[20:23], v[40:43], v[92:95]
    s_add_u32 m0, s20, 16384
    ds_read_b128 v[32:35], v17 offset:12288
    s_mul_i32 s14, s76, 6
L_pl_G_1:
    s_cbranch_execz L_pl_G_5
    v_mfma_f32_16x16x32_bf16 v[92:95], a[28:31], v[44:47], v[92:95]
    buffer_load_dwordx4 v4, s[48:51], s14 offen offset:0 lds
    ds_read_b64_tr_b16 a[80:81], v12 offset:32768
    v_mfma_f32_16x16x32_bf16 v[88:91], a[24:27], v[44:47], v[88:91]
    ds_read_b128 v[36:39], v17 offset:15360
    v_add_u32 v11, 64512, v10
    v_mfma_f32_16x16x32_bf16 v[88:91], a[16:19], v[40:43], v[88:91]
    s_mov_b32 s4, 141658144
    buffer_load_dwordx4 v5, s[48:51], s14 offen offset:1024 lds
    ds_read_b64_tr_b16 a[82:83], v12 offset:33792
    v_mfma_f32_16x16x32_bf16 v[96:99], a[16:19], v[48:51], v[96:99]
    ds_read_b128 v[40:43], v17 offset:18432
    v_mfma_f32_16x16x32_bf16 v[96:99], a[24:27], v[52:55], v[96:99]
    s_cmp_eq_u32 s22, 1
    s_cselect_b32 s4, 271646849, s4
    buffer_load_dwordx4 v6, s[48:51], s14 offen offset:2048 lds
    v_mfma_f32_16x16x32_bf16 v[100:103], a[28:31], v[52:55], v[100:103]
    s_cmp_eq_u32 s22, 2
    s_cselect_b32 s4, 137401346, s4
    ds_read_b128 v[44:47], v17 offset:21504
    v_mfma_f32_16x16x32_bf16 v[100:103], a[20:23], v[48:51], v[100:103]
    s_waitcnt lgkmcnt(6)
    buffer_load_dwordx4 v7, s[48:51], s14 offen offset:3072 lds
    ds_read_b64_tr_b16 a[84:85], v13 offset:32768
    v_mfma_f32_16x16x32_bf16 v[108:111], a[20:23], v[56:59], v[108:111]
    s_add_u32 m0, s21, 24576
    ds_read_b128 v[48:51], v17 offset:13312
    v_mfma_f32_16x16x32_bf16 v[108:111], a[28:31], v[60:63], v[108:111]
    buffer_load_dwordx4 v18, s[44:47], s74 offen offset:0 sc1 lds
    ds_read_b64_tr_b16 a[86:87], v13 offset:33792
    v_mfma_f32_16x16x32_bf16 v[104:107], a[24:27], v[60:63], v[104:107]
    s_cmp_eq_u32 s22, 3
    s_cselect_b32 s4, 136512515, s4
    ds_read_b128 v[52:55], v17 offset:16384
    v_mfma_f32_16x16x32_bf16 v[104:107], a[16:19], v[56:59], v[104:107]
    s_waitcnt lgkmcnt(7)
    s_bfe_u32 s84, s4, 0x50000
    buffer_load_dwordx4 v19, s[44:47], s74 offen offset:1024 sc1 lds
    v_mfma_f32_16x16x32_bf16 v[64:67], a[32:35], v[32:35], v[64:67]
    s_bfe_u32 s85, s4, 0x50005
    ds_read_b128 v[56:59], v17 offset:19456
    v_mfma_f32_16x16x32_bf16 v[64:67], a[40:43], v[36:39], v[64:67]
    buffer_load_dwordx4 v20, s[44:47], s74 offen offset:2048 sc1 lds
    ds_read_b64_tr_b16 a[88:89], v12 offset:40960
    v_mfma_f32_16x16x32_bf16 v[68:71], a[44:47], v[36:39], v[68:71]
    s_bfe_u32 s86, s4, 0x5000a
    ds_read_b128 v[60:63], v17 offset:22528
    v_mfma_f32_16x16x32_bf16 v[68:71], a[36:39], v[32:35], v[68:71]
    s_waitcnt lgkmcnt(7)
    ds_read_b64_tr_b16 a[90:91], v12 offset:41984
    v_mfma_f32_16x16x32_bf16 v[76:79], a[36:39], v[40:43], v[76:79]
    s_bfe_u32 s87, s4, 0x5000f
    ds_read_b128 v[32:35], v17 offset:14336
    v_mfma_f32_16x16x32_bf16 v[76:79], a[44:47], v[44:47], v[76:79]
    v_mfma_f32_16x16x32_bf16 v[72:75], a[40:43], v[44:47], v[72:75]
    s_bfe_u32 s88, s4, 0x50014
    ds_read_b128 v[36:39], v17 offset:17408
    v_mfma_f32_16x16x32_bf16 v[72:75], a[32:35], v[40:43], v[72:75]
    s_waitcnt lgkmcnt(6)
    s_bfe_u32 s89, s4, 0x50019
    ds_read_b64_tr_b16 a[92:93], v13 offset:40960
    v_mfma_f32_16x16x32_bf16 v[80:83], a[32:35], v[48:51], v[80:83]
    ds_read_b128 v[40:43], v17 offset:20480
    v_mfma_f32_16x16x32_bf16 v[80:83], a[40:43], v[52:55], v[80:83]
    s_mov_b32 s4, 345255109
    ds_read_b64_tr_b16 a[94:95], v13 offset:41984
    v_mfma_f32_16x16x32_bf16 v[84:87], a[44:47], v[52:55], v[84:87]
    ds_read_b128 v[44:47], v17 offset:23552
    v_mfma_f32_16x16x32_bf16 v[84:87], a[36:39], v[48:51], v[84:87]
    s_waitcnt vmcnt(17) lgkmcnt(1)
    s_barrier
    s_cmp_eq_u32 s22, 1
    s_cselect_b32 s4, 345382085, s4
    v_mfma_f32_16x16x32_bf16 v[92:95], a[36:39], v[56:59], v[92:95]
    s_add_u32 m0, s20, 32768
    ds_read_b128 v[48:51], v17 offset:24576
    s_mul_i32 s14, s77, 6
    v_mfma_f32_16x16x32_bf16 v[92:95], a[44:47], v[60:63], v[92:95]
    buffer_load_dwordx4 v4, s[48:51], s14 offen offset:0 lds
    ds_read_b64_tr_b16 a[96:97], v12 offset:49152
    v_mfma_f32_16x16x32_bf16 v[88:91], a[40:43], v[60:63], v[88:91]
    s_cmp_eq_u32 s22, 2
    s_cselect_b32 s4, 349445321, s4
    ds_read_b128 v[52:55], v17 offset:27648
    v_mfma_f32_16x16x32_bf16 v[88:91], a[32:35], v[56:59], v[88:91]
    buffer_load_dwordx4 v5, s[48:51], s14 offen offset:1024 lds
    ds_read_b64_tr_b16 a[98:99], v12 offset:50176
    v_mfma_f32_16x16x32_bf16 v[96:99], a[32:35], v[32:35], v[96:99]
    s_cmp_eq_u32 s22, 3
    s_cselect_b32 s4, 479468869, s4
    ds_read_b128 v[56:59], v17 offset:30720
    v_mfma_f32_16x16x32_bf16 v[96:99], a[40:43], v[36:39], v[96:99]
    s_bfe_u32 s90, s4, 0x50000
    buffer_load_dwordx4 v6, s[48:51], s14 offen offset:2048 lds
    v_mfma_f32_16x16x32_bf16 v[100:103], a[44:47], v[36:39], v[100:103]
    s_bfe_u32 s91, s4, 0x50005
    ds_read_b128 v[60:63], v17 offset:33792
    v_mfma_f32_16x16x32_bf16 v[100:103], a[36:39], v[32:35], v[100:103]
    s_waitcnt lgkmcnt(6)
    buffer_load_dwordx4 v7, s[48:51], s14 offen offset:3072 lds
    ds_read_b64_tr_b16 a[100:101], v13 offset:49152
    v_mfma_f32_16x16x32_bf16 v[108:111], a[36:39], v[40:43], v[108:111]
    s_add_u32 m0, s21, 36864
    ds_read_b128 v[32:35], v17 offset:25600
    s_bfe_u32 s92, s4, 0x5000a
    v_mfma_f32_16x16x32_bf16 v[108:111], a[44:47], v[44:47], v[108:111]
    buffer_load_dwordx4 v18, s[44:47], s75 offen offset:0 sc1 lds
    ds_read_b64_tr_b16 a[102:103], v13 offset:50176
    v_mfma_f32_16x16x32_bf16 v[104:107], a[40:43], v[44:47], v[104:107]
    s_bfe_u32 s93, s4, 0x5000f
    ds_read_b128 v[36:39], v17 offset:28672
    v_mfma_f32_16x16x32_bf16 v[104:107], a[32:35], v[40:43], v[104:107]
    s_waitcnt lgkmcnt(7)
    buffer_load_dwordx4 v19, s[44:47], s75 offen offset:1024 sc1 lds
    v_mfma_f32_16x16x32_bf16 v[64:67], a[48:51], v[48:51], v[64:67]
    s_bfe_u32 s94, s4, 0x50014
    ds_read_b128 v[40:43], v17 offset:31744
    v_mfma_f32_16x16x32_bf16 v[64:67], a[56:59], v[52:55], v[64:67]
    ds_read_b64_tr_b16 a[104:105], v12 offset:57344
    v_mfma_f32_16x16x32_bf16 v[68:71], a[60:63], v[52:55], v[68:71]
    s_bfe_u32 s95, s4, 0x50019
    ds_read_b128 v[44:47], v17 offset:34816
    v_mfma_f32_16x16x32_bf16 v[68:71], a[52:55], v[48:51], v[68:71]
    s_waitcnt lgkmcnt(7)
    s_mov_b32 s4, 587675023
    ds_read_b64_tr_b16 a[106:107], v12 offset:58368
    v_mfma_f32_16x16x32_bf16 v[76:79], a[52:55], v[56:59], v[76:79]
    ds_read_b128 v[48:51], v17 offset:26624
    v_mfma_f32_16x16x32_bf16 v[76:79], a[60:63], v[60:63], v[76:79]
    s_cmp_eq_u32 s22, 1
    s_cselect_b32 s4, 586626571, s4
    v_mfma_f32_16x16x32_bf16 v[72:75], a[56:59], v[60:63], v[72:75]
    ds_read_b128 v[52:55], v17 offset:29696
    v_mfma_f32_16x16x32_bf16 v[72:75], a[48:51], v[56:59], v[72:75]
    s_waitcnt lgkmcnt(6)
    buffer_load_dwordx4 v20, s[44:47], s75 offen offset:2048 sc1 lds
    ds_read_b64_tr_b16 a[108:109], v13 offset:57344
    v_mfma_f32_16x16x32_bf16 v[80:83], a[48:51], v[32:35], v[80:83]
    s_cmp_eq_u32 s22, 2
    s_cselect_b32 s4, 553076107, s4
    ds_read_b128 v[56:59], v17 offset:32768
    v_mfma_f32_16x16x32_bf16 v[80:83], a[56:59], v[36:39], v[80:83]
    s_cmp_eq_u32 s22, 3
    s_cselect_b32 s4, 587707787, s4
    ds_read_b64_tr_b16 a[110:111], v13 offset:58368
    v_mfma_f32_16x16x32_bf16 v[84:87], a[60:63], v[36:39], v[84:87]
    ds_read_b128 v[60:63], v17 offset:35840
    v_mfma_f32_16x16x32_bf16 v[84:87], a[52:55], v[32:35], v[84:87]
    s_waitcnt vmcnt(14) lgkmcnt(1)
    s_barrier
    s_bfe_u32 s96, s4, 0x50000
    v_mfma_f32_16x16x32_bf16 v[92:95], a[52:55], v[40:43], v[92:95]
    s_add_u32 m0, s20, 49152
    ds_read_b128 v[32:35], v16 offset:0
    s_mul_i32 s14, s78, 6
    v_mfma_f32_16x16x32_bf16 v[92:95], a[60:63], v[44:47], v[92:95]
    s_bfe_u32 s97, s4, 0x50005
    buffer_load_dwordx4 v4, s[48:51], s14 offen offset:0 lds
    ds_read_b64_tr_b16 a[112:113], v12 offset:0
    v_mfma_f32_16x16x32_bf16 v[88:91], a[56:59], v[44:47], v[88:91]
    s_bfe_u32 s98, s4, 0x5000a
    ds_read_b128 v[36:39], v16 offset:3072
    v_mfma_f32_16x16x32_bf16 v[88:91], a[48:51], v[40:43], v[88:91]
    buffer_load_dwordx4 v5, s[48:51], s14 offen offset:1024 lds
    ds_read_b64_tr_b16 a[114:115], v12 offset:1024
    v_mfma_f32_16x16x32_bf16 v[96:99], a[48:51], v[48:51], v[96:99]
    s_bfe_u32 s99, s4, 0x5000f
    ds_read_b128 v[40:43], v16 offset:6144
    v_mfma_f32_16x16x32_bf16 v[96:99], a[56:59], v[52:55], v[96:99]
    v_mfma_f32_16x16x32_bf16 v[100:103], a[60:63], v[52:55], v[100:103]
    s_bfe_u32 s100, s4, 0x50014
    ds_read_b128 v[44:47], v16 offset:9216
    v_mfma_f32_16x16x32_bf16 v[100:103], a[52:55], v[48:51], v[100:103]
    s_waitcnt lgkmcnt(6)
    ds_read_b64_tr_b16 a[116:117], v13 offset:0
    v_mfma_f32_16x16x32_bf16 v[108:111], a[52:55], v[56:59], v[108:111]
    s_bfe_u32 s101, s4, 0x50019
    ds_read_b128 v[48:51], v16 offset:1024
    v_mfma_f32_16x16x32_bf16 v[108:111], a[60:63], v[60:63], v[108:111]
    ds_read_b64_tr_b16 a[118:119], v13 offset:1024
    v_mfma_f32_16x16x32_bf16 v[104:107], a[56:59], v[60:63], v[104:107]
    s_mul_i32 s4, s23, 18
    ds_read_b128 v[52:55], v16 offset:4096
    v_mfma_f32_16x16x32_bf16 v[104:107], a[48:51], v[56:59], v[104:107]
    s_waitcnt lgkmcnt(7)
    v_mfma_f32_16x16x32_bf16 v[64:67], a[64:67], v[32:35], v[64:67]
    s_add_u32 s84, s84, s4
    ds_read_b128 v[56:59], v16 offset:7168
    v_mfma_f32_16x16x32_bf16 v[64:67], a[72:75], v[36:39], v[64:67]
    s_lshl_b32 s84, s84, 17
    ds_read_b64_tr_b16 a[120:121], v12 offset:8192
    v_mfma_f32_16x16x32_bf16 v[68:71], a[76:79], v[36:39], v[68:71]
    ds_read_b128 v[60:63], v16 offset:10240
    v_mfma_f32_16x16x32_bf16 v[68:71], a[68:71], v[32:35], v[68:71]
    s_waitcnt lgkmcnt(7)
    s_add_u32 s85, s85, s4
    ds_read_b64_tr_b16 a[122:123], v12 offset:9216
    v_mfma_f32_16x16x32_bf16 v[76:79], a[68:71], v[40:43], v[76:79]
    ds_read_b128 v[32:35], v16 offset:2048
    v_mfma_f32_16x16x32_bf16 v[76:79], a[76:79], v[44:47], v[76:79]
    s_lshl_b32 s85, s85, 17
    buffer_load_dwordx4 v6, s[48:51], s14 offen offset:2048 lds
    v_mfma_f32_16x16x32_bf16 v[72:75], a[72:75], v[44:47], v[72:75]
    ds_read_b128 v[36:39], v16 offset:5120
    v_mfma_f32_16x16x32_bf16 v[72:75], a[64:67], v[40:43], v[72:75]
    s_waitcnt lgkmcnt(6)
    s_add_u32 s86, s86, s4
    buffer_load_dwordx4 v7, s[48:51], s14 offen offset:3072 lds
    ds_read_b64_tr_b16 a[124:125], v13 offset:8192
    v_mfma_f32_16x16x32_bf16 v[80:83], a[64:67], v[48:51], v[80:83]
    s_add_u32 m0, s21, 49152
    ds_read_b128 v[40:43], v16 offset:8192
    v_mfma_f32_16x16x32_bf16 v[80:83], a[72:75], v[52:55], v[80:83]
    s_lshl_b32 s86, s86, 17
    buffer_load_dwordx4 v18, s[44:47], s76 offen offset:0 sc1 lds
    ds_read_b64_tr_b16 a[126:127], v13 offset:9216
    v_mfma_f32_16x16x32_bf16 v[84:87], a[76:79], v[52:55], v[84:87]
    ds_read_b128 v[44:47], v16 offset:11264
    v_mfma_f32_16x16x32_bf16 v[84:87], a[68:71], v[48:51], v[84:87]
    s_waitcnt vmcnt(15) lgkmcnt(1)
    s_barrier
    s_add_u32 s87, s87, s4
    v_mfma_f32_16x16x32_bf16 v[92:95], a[68:71], v[56:59], v[92:95]
    s_lshl_b32 s87, s87, 17
    ds_read_b128 v[48:51], v16 offset:12288
    v_mfma_f32_16x16x32_bf16 v[92:95], a[76:79], v[60:63], v[92:95]
    buffer_load_dwordx4 v19, s[44:47], s76 offen offset:1024 sc1 lds
    ds_read_b64_tr_b16 a[128:129], v12 offset:16384
    v_mfma_f32_16x16x32_bf16 v[88:91], a[72:75], v[60:63], v[88:91]
    s_add_u32 s88, s88, s4
    ds_read_b128 v[52:55], v16 offset:15360
    v_mfma_f32_16x16x32_bf16 v[88:91], a[64:67], v[56:59], v[88:91]
    buffer_load_dwordx4 v20, s[44:47], s76 offen offset:2048 sc1 lds
    ds_read_b64_tr_b16 a[130:131], v12 offset:17408
    v_mfma_f32_16x16x32_bf16 v[96:99], a[64:67], v[32:35], v[96:99]
    s_lshl_b32 s88, s88, 17
    ds_read_b128 v[56:59], v16 offset:18432
    v_mfma_f32_16x16x32_bf16 v[96:99], a[72:75], v[36:39], v[96:99]
    s_add_u32 s89, s89, s4
    v_mfma_f32_16x16x32_bf16 v[100:103], a[76:79], v[36:39], v[100:103]
    s_add_u32 m0, s20, 0
    ds_read_b128 v[60:63], v16 offset:21504
    s_mul_i32 s14, s79, 6
    v_mfma_f32_16x16x32_bf16 v[100:103], a[68:71], v[32:35], v[100:103]
    s_waitcnt lgkmcnt(6)
    buffer_load_dwordx4 v4, s[48:51], s14 offen offset:0 lds
    ds_read_b64_tr_b16 a[132:133], v13 offset:16384
    v_mfma_f32_16x16x32_bf16 v[108:111], a[68:71], v[40:43], v[108:111]
    s_lshl_b32 s89, s89, 17
    ds_read_b128 v[32:35], v16 offset:13312
    v_mfma_f32_16x16x32_bf16 v[108:111], a[76:79], v[44:47], v[108:111]
    buffer_load_dwordx4 v5, s[48:51], s14 offen offset:1024 lds
    ds_read_b64_tr_b16 a[134:135], v13 offset:17408
    v_mfma_f32_16x16x32_bf16 v[104:107], a[72:75], v[44:47], v[104:107]
    s_add_u32 s90, s90, s4
    ds_read_b128 v[36:39], v16 offset:16384
    v_mfma_f32_16x16x32_bf16 v[104:107], a[64:67], v[40:43], v[104:107]
    s_waitcnt lgkmcnt(7)
    s_lshl_b32 s90, s90, 17
    v_mfma_f32_16x16x32_bf16 v[64:67], a[80:83], v[48:51], v[64:67]
    ds_read_b128 v[40:43], v16 offset:19456
    v_mfma_f32_16x16x32_bf16 v[64:67], a[88:91], v[52:55], v[64:67]
    s_add_u32 s91, s91, s4
    ds_read_b64_tr_b16 a[136:137], v12 offset:24576
    v_mfma_f32_16x16x32_bf16 v[68:71], a[92:95], v[52:55], v[68:71]
    ds_read_b128 v[44:47], v16 offset:22528
    v_mfma_f32_16x16x32_bf16 v[68:71], a[84:87], v[48:51], v[68:71]
    s_waitcnt lgkmcnt(7)
    s_lshl_b32 s91, s91, 17
    ds_read_b64_tr_b16 a[138:139], v12 offset:25600
    v_mfma_f32_16x16x32_bf16 v[76:79], a[84:87], v[56:59], v[76:79]
    ds_read_b128 v[48:51], v16 offset:14336
    v_mfma_f32_16x16x32_bf16 v[76:79], a[92:95], v[60:63], v[76:79]
    s_add_u32 s92, s92, s4
    buffer_load_dwordx4 v6, s[48:51], s14 offen offset:2048 lds
    v_mfma_f32_16x16x32_bf16 v[72:75], a[88:91], v[60:63], v[72:75]
    ds_read_b128 v[52:55], v16 offset:17408
    v_mfma_f32_16x16x32_bf16 v[72:75], a[80:83], v[56:59], v[72:75]
    s_waitcnt lgkmcnt(6)
    s_lshl_b32 s92, s92, 17
    buffer_load_dwordx4 v7, s[48:51], s14 offen offset:3072 lds
    ds_read_b64_tr_b16 a[140:141], v13 offset:24576
    v_mfma_f32_16x16x32_bf16 v[80:83], a[80:83], v[32:35], v[80:83]
    s_add_u32 m0, s21, 61440
    ds_read_b128 v[56:59], v16 offset:20480
    v_mfma_f32_16x16x32_bf16 v[80:83], a[88:91], v[36:39], v[80:83]
    s_add_u32 s93, s93, s4
    buffer_load_dwordx4 v18, s[44:47], s77 offen offset:0 sc1 lds
    ds_read_b64_tr_b16 a[142:143], v13 offset:25600
    v_mfma_f32_16x16x32_bf16 v[84:87], a[92:95], v[36:39], v[84:87]
    s_lshl_b32 s93, s93, 17
    ds_read_b128 v[60:63], v16 offset:23552
    v_mfma_f32_16x16x32_bf16 v[84:87], a[84:87], v[32:35], v[84:87]
    s_waitcnt vmcnt(15) lgkmcnt(1)
    s_barrier
    v_mfma_f32_16x16x32_bf16 v[92:95], a[84:87], v[40:43], v[92:95]
    s_add_u32 s94, s94, s4
    ds_read_b128 v[32:35], v16 offset:24576
    v_mfma_f32_16x16x32_bf16 v[92:95], a[92:95], v[44:47], v[92:95]
    buffer_load_dwordx4 v19, s[44:47], s77 offen offset:1024 sc1 lds
    ds_read_b64_tr_b16 a[144:145], v12 offset:32768
    v_mfma_f32_16x16x32_bf16 v[88:91], a[88:91], v[44:47], v[88:91]
    s_lshl_b32 s94, s94, 17
    ds_read_b128 v[36:39], v16 offset:27648
    v_mfma_f32_16x16x32_bf16 v[88:91], a[80:83], v[40:43], v[88:91]
    buffer_load_dwordx4 v20, s[44:47], s77 offen offset:2048 sc1 lds
    ds_read_b64_tr_b16 a[146:147], v12 offset:33792
    v_mfma_f32_16x16x32_bf16 v[96:99], a[80:83], v[48:51], v[96:99]
    s_add_u32 s95, s95, s4
    ds_read_b128 v[40:43], v16 offset:30720
    v_mfma_f32_16x16x32_bf16 v[96:99], a[88:91], v[52:55], v[96:99]
    s_lshl_b32 s95, s95, 17
    v_mfma_f32_16x16x32_bf16 v[100:103], a[92:95], v[52:55], v[100:103]
    s_add_u32 m0, s20, 16384
    ds_read_b128 v[44:47], v16 offset:33792
    s_mul_i32 s14, s80, 6
    v_mfma_f32_16x16x32_bf16 v[100:103], a[84:87], v[48:51], v[100:103]
    s_waitcnt lgkmcnt(6)
    buffer_load_dwordx4 v4, s[48:51], s14 offen offset:0 lds
    ds_read_b64_tr_b16 a[148:149], v13 offset:32768
    v_mfma_f32_16x16x32_bf16 v[108:111], a[84:87], v[56:59], v[108:111]
    s_add_u32 s96, s96, s4
    ds_read_b128 v[48:51], v16 offset:25600
    v_mfma_f32_16x16x32_bf16 v[108:111], a[92:95], v[60:63], v[108:111]
    s_lshl_b32 s96, s96, 17
    buffer_load_dwordx4 v5, s[48:51], s14 offen offset:1024 lds
    ds_read_b64_tr_b16 a[150:151], v13 offset:33792
    v_mfma_f32_16x16x32_bf16 v[104:107], a[88:91], v[60:63], v[104:107]
    ds_read_b128 v[52:55], v16 offset:28672
    v_mfma_f32_16x16x32_bf16 v[104:107], a[80:83], v[56:59], v[104:107]
    s_waitcnt lgkmcnt(7)
    s_cmp_lt_u32 s3, 2
    s_cselect_b32 s68, s68, s69
    s_add_u32 s97, s97, s4
    v_mfma_f32_16x16x32_bf16 v[64:67], a[96:99], v[32:35], v[64:67]
    ds_read_b128 v[56:59], v16 offset:31744
    v_mfma_f32_16x16x32_bf16 v[64:67], a[104:107], v[36:39], v[64:67]
    s_lshl_b32 s97, s97, 17
    ds_read_b64_tr_b16 a[152:153], v12 offset:40960
    v_mfma_f32_16x16x32_bf16 v[68:71], a[108:111], v[36:39], v[68:71]
    ds_read_b128 v[60:63], v16 offset:34816
    v_mfma_f32_16x16x32_bf16 v[68:71], a[100:103], v[32:35], v[68:71]
    s_waitcnt lgkmcnt(7)
    s_add_u32 s98, s98, s4
    ds_read_b64_tr_b16 a[154:155], v12 offset:41984
    v_mfma_f32_16x16x32_bf16 v[76:79], a[100:103], v[40:43], v[76:79]
    ds_read_b128 v[32:35], v16 offset:26624
    v_mfma_f32_16x16x32_bf16 v[76:79], a[108:111], v[44:47], v[76:79]
    s_lshl_b32 s98, s98, 17
    buffer_load_dwordx4 v6, s[48:51], s14 offen offset:2048 lds
    v_mfma_f32_16x16x32_bf16 v[72:75], a[104:107], v[44:47], v[72:75]
    ds_read_b128 v[36:39], v16 offset:29696
    v_mfma_f32_16x16x32_bf16 v[72:75], a[96:99], v[40:43], v[72:75]
    s_waitcnt lgkmcnt(6)
    s_add_u32 s99, s99, s4
    buffer_load_dwordx4 v7, s[48:51], s14 offen offset:3072 lds
    ds_read_b64_tr_b16 a[156:157], v13 offset:40960
    v_mfma_f32_16x16x32_bf16 v[80:83], a[96:99], v[48:51], v[80:83]
    s_add_u32 m0, s21, 0
    ds_read_b128 v[40:43], v16 offset:32768
    s_lshl_b32 s99, s99, 17
    v_mfma_f32_16x16x32_bf16 v[80:83], a[104:107], v[52:55], v[80:83]
    buffer_load_dwordx4 v18, s[44:47], s78 offen offset:0 sc1 lds
    ds_read_b64_tr_b16 a[158:159], v13 offset:41984
    v_mfma_f32_16x16x32_bf16 v[84:87], a[108:111], v[52:55], v[84:87]
    s_cmp_lt_u32 s3, 2
    s_cselect_b32 s70, s70, s71
    ds_read_b128 v[44:47], v16 offset:35840
    v_mfma_f32_16x16x32_bf16 v[84:87], a[100:103], v[48:51], v[84:87]
    s_waitcnt vmcnt(15) lgkmcnt(1)
    s_barrier
    s_add_u32 s100, s100, s4
    v_mfma_f32_16x16x32_bf16 v[92:95], a[100:103], v[56:59], v[92:95]
    s_lshl_b32 s100, s100, 17
    ds_read_b128 v[48:51], v17 offset:0
    v_mfma_f32_16x16x32_bf16 v[92:95], a[108:111], v[60:63], v[92:95]
    buffer_load_dwordx4 v19, s[44:47], s78 offen offset:1024 sc1 lds
    ds_read_b64_tr_b16 a[160:161], v12 offset:49152
    v_mfma_f32_16x16x32_bf16 v[88:91], a[104:107], v[60:63], v[88:91]
    s_add_u32 s101, s101, s4
    ds_read_b128 v[52:55], v17 offset:3072
    v_mfma_f32_16x16x32_bf16 v[88:91], a[96:99], v[56:59], v[88:91]
    buffer_load_dwordx4 v20, s[44:47], s78 offen offset:2048 sc1 lds
    ds_read_b64_tr_b16 a[162:163], v12 offset:50176
    v_mfma_f32_16x16x32_bf16 v[96:99], a[96:99], v[32:35], v[96:99]
    s_lshl_b32 s101, s101, 17
    ds_read_b128 v[56:59], v17 offset:6144
    v_mfma_f32_16x16x32_bf16 v[96:99], a[104:107], v[36:39], v[96:99]
    s_lshl_b32 s6, s3, 6
    v_mfma_f32_16x16x32_bf16 v[100:103], a[108:111], v[36:39], v[100:103]
    s_add_u32 m0, s20, 32768
    ds_read_b128 v[60:63], v17 offset:9216
    s_mul_i32 s14, s81, 6
    v_mfma_f32_16x16x32_bf16 v[100:103], a[100:103], v[32:35], v[100:103]
    s_waitcnt lgkmcnt(6)
    buffer_load_dwordx4 v4, s[48:51], s14 offen offset:0 lds
    ds_read_b64_tr_b16 a[164:165], v13 offset:49152
    v_mfma_f32_16x16x32_bf16 v[108:111], a[100:103], v[40:43], v[108:111]
    ds_read_b128 v[32:35], v17 offset:1024
    v_add_u32 v142, s6, v2
    v_mfma_f32_16x16x32_bf16 v[108:111], a[108:111], v[44:47], v[108:111]
    buffer_load_dwordx4 v5, s[48:51], s14 offen offset:1024 lds
    ds_read_b64_tr_b16 a[166:167], v13 offset:50176
    v_mfma_f32_16x16x32_bf16 v[104:107], a[104:107], v[44:47], v[104:107]
    ds_read_b128 v[36:39], v17 offset:4096
    v_and_b32 v143, 3, v142
    v_mfma_f32_16x16x32_bf16 v[104:107], a[96:99], v[40:43], v[104:107]
    s_waitcnt lgkmcnt(7)
    buffer_load_dwordx4 v6, s[48:51], s14 offen offset:2048 lds
    v_lshrrev_b32 v142, 2, v142
    v_mfma_f32_16x16x32_bf16 v[64:67], a[112:115], v[48:51], v[64:67]
    s_cmp_lt_u32 s3, 2
    s_cselect_b32 s72, s72, s73
    ds_read_b128 v[40:43], v17 offset:7168
    v_mfma_f32_16x16x32_bf16 v[64:67], a[120:123], v[52:55], v[64:67]
    buffer_load_dwordx4 v7, s[48:51], s14 offen offset:3072 lds
    ds_read_b64_tr_b16 a[168:169], v12 offset:57344
    v_mfma_f32_16x16x32_bf16 v[68:71], a[124:127], v[52:55], v[68:71]
    ds_read_b128 v[44:47], v17 offset:10240
    v_lshlrev_b32 v142, 7, v142
    v_mfma_f32_16x16x32_bf16 v[68:71], a[116:119], v[48:51], v[68:71]
    s_waitcnt lgkmcnt(7)
    ds_read_b64_tr_b16 a[170:171], v12 offset:58368
    v_lshl_add_u32 v142, v143, 2, v142
    v_mfma_f32_16x16x32_bf16 v[76:79], a[116:119], v[56:59], v[76:79]
    s_add_u32 m0, s21, 12288
    ds_read_b128 v[48:51], v17 offset:2048
    v_add_u32 v142, 8871936, v142
    v_mfma_f32_16x16x32_bf16 v[76:79], a[124:127], v[60:63], v[76:79]
    buffer_load_dwordx4 v18, s[44:47], s79 offen offset:0 sc1 lds
    v_mfma_f32_16x16x32_bf16 v[72:75], a[120:123], v[60:63], v[72:75]
    s_mov_b32 s60, s24
    ds_read_b128 v[52:55], v17 offset:5120
    v_mfma_f32_16x16x32_bf16 v[72:75], a[112:115], v[56:59], v[72:75]
    s_waitcnt lgkmcnt(6)
    buffer_load_dwordx4 v19, s[44:47], s79 offen offset:1024 sc1 lds
    ds_read_b64_tr_b16 a[172:173], v13 offset:57344
    v_mfma_f32_16x16x32_bf16 v[80:83], a[112:115], v[32:35], v[80:83]
    s_and_b32 s61, s25, 0xffff
    ds_read_b128 v[56:59], v17 offset:8192
    v_mfma_f32_16x16x32_bf16 v[80:83], a[120:123], v[36:39], v[80:83]
    buffer_load_dwordx4 v20, s[44:47], s79 offen offset:2048 sc1 lds
    ds_read_b64_tr_b16 a[174:175], v13 offset:58368
    v_mfma_f32_16x16x32_bf16 v[84:87], a[124:127], v[36:39], v[84:87]
    s_mov_b32 s62, 2359296
    ds_read_b128 v[60:63], v17 offset:11264
    v_mfma_f32_16x16x32_bf16 v[84:87], a[116:119], v[32:35], v[84:87]
    s_waitcnt vmcnt(17) lgkmcnt(1)
    s_barrier
    v_mfma_f32_16x16x32_bf16 v[92:95], a[116:119], v[40:43], v[92:95]
    s_mov_b32 s63, 0x20000
    ds_read_b128 v[32:35], v17 offset:12288
    v_mfma_f32_16x16x32_bf16 v[92:95], a[124:127], v[44:47], v[92:95]
    s_lshl_b32 s12, s34, 12
    ds_read_b64_tr_b16 a[176:177], v12 offset:0
    v_mfma_f32_16x16x32_bf16 v[88:91], a[120:123], v[44:47], v[88:91]
    s_add_u32 m0, s20, 49152
    ds_read_b128 v[36:39], v17 offset:15360
    s_mul_i32 s14, s82, 6
    v_mfma_f32_16x16x32_bf16 v[88:91], a[112:115], v[40:43], v[88:91]
    s_lshl_b32 s8, s3, 10
    buffer_load_dwordx4 v4, s[48:51], s14 offen offset:0 lds
    ds_read_b64_tr_b16 a[178:179], v12 offset:1024
    v_mfma_f32_16x16x32_bf16 v[96:99], a[112:115], v[48:51], v[96:99]
    ds_read_b128 v[40:43], v17 offset:18432
    v_mfma_f32_16x16x32_bf16 v[96:99], a[120:123], v[52:55], v[96:99]
    s_add_u32 s12, s12, s8
    buffer_load_dwordx4 v5, s[48:51], s14 offen offset:1024 lds
    v_mfma_f32_16x16x32_bf16 v[100:103], a[124:127], v[52:55], v[100:103]
    ds_read_b128 v[44:47], v17 offset:21504
    v_mfma_f32_16x16x32_bf16 v[100:103], a[116:119], v[48:51], v[100:103]
    s_waitcnt lgkmcnt(6)
    s_lshr_b32 s9, s34, 4
    ds_read_b64_tr_b16 a[180:181], v13 offset:0
    v_mfma_f32_16x16x32_bf16 v[108:111], a[116:119], v[56:59], v[108:111]
    ds_read_b128 v[48:51], v17 offset:13312
    v_mfma_f32_16x16x32_bf16 v[108:111], a[124:127], v[60:63], v[108:111]
    s_mul_i32 s8, s9, 43
    buffer_load_dwordx4 v6, s[48:51], s14 offen offset:2048 lds
    ds_read_b64_tr_b16 a[182:183], v13 offset:1024
    v_mfma_f32_16x16x32_bf16 v[104:107], a[120:123], v[60:63], v[104:107]
    ds_read_b128 v[52:55], v17 offset:16384
    v_mfma_f32_16x16x32_bf16 v[104:107], a[112:115], v[56:59], v[104:107]
    s_waitcnt lgkmcnt(7)
    s_lshr_b32 s8, s8, 7
    buffer_load_dwordx4 v7, s[48:51], s14 offen offset:3072 lds
    v_mfma_f32_16x16x32_bf16 v[64:67], a[128:131], v[32:35], v[64:67]
    ds_read_b128 v[56:59], v17 offset:19456
    v_mfma_f32_16x16x32_bf16 v[64:67], a[136:139], v[36:39], v[64:67]
    s_add_u32 s15, s9, s8
    ds_read_b64_tr_b16 a[184:185], v12 offset:8192
    v_mfma_f32_16x16x32_bf16 v[68:71], a[140:143], v[36:39], v[68:71]
    s_add_u32 m0, s21, 24576
    ds_read_b128 v[60:63], v17 offset:22528
    s_mul_i32 s8, s8, 3
    v_mfma_f32_16x16x32_bf16 v[68:71], a[132:135], v[32:35], v[68:71]
    s_waitcnt lgkmcnt(7)
    buffer_load_dwordx4 v18, s[44:47], s80 offen offset:0 sc1 lds
    ds_read_b64_tr_b16 a[186:187], v12 offset:9216
    v_mfma_f32_16x16x32_bf16 v[76:79], a[132:135], v[40:43], v[76:79]
    s_sub_u32 s8, s9, s8
    ds_read_b128 v[32:35], v17 offset:14336
    v_mfma_f32_16x16x32_bf16 v[76:79], a[140:143], v[44:47], v[76:79]
    v_mfma_f32_16x16x32_bf16 v[72:75], a[136:139], v[44:47], v[72:75]
    s_min_u32 s8, s8, 1
    ds_read_b128 v[36:39], v17 offset:17408
    v_mfma_f32_16x16x32_bf16 v[72:75], a[128:131], v[40:43], v[72:75]
    s_waitcnt lgkmcnt(6)
    buffer_load_dwordx4 v19, s[44:47], s80 offen offset:1024 sc1 lds
    ds_read_b64_tr_b16 a[188:189], v13 offset:8192
    v_mfma_f32_16x16x32_bf16 v[80:83], a[128:131], v[48:51], v[80:83]
    s_add_u32 s15, s15, s8
    ds_read_b128 v[40:43], v17 offset:20480
    v_mfma_f32_16x16x32_bf16 v[80:83], a[136:139], v[52:55], v[80:83]
    buffer_load_dwordx4 v20, s[44:47], s80 offen offset:2048 sc1 lds
    ds_read_b64_tr_b16 a[190:191], v13 offset:9216
    v_mfma_f32_16x16x32_bf16 v[84:87], a[140:143], v[52:55], v[84:87]
    s_lshl_b32 s15, s15, 8
    ds_read_b128 v[44:47], v17 offset:23552
    v_mfma_f32_16x16x32_bf16 v[84:87], a[132:135], v[48:51], v[84:87]
    s_waitcnt vmcnt(17) lgkmcnt(1)
    s_barrier
    v_mfma_f32_16x16x32_bf16 v[92:95], a[132:135], v[56:59], v[92:95]
    s_and_b32 s8, s34, 15
    ds_read_b128 v[48:51], v17 offset:24576
    v_mfma_f32_16x16x32_bf16 v[92:95], a[140:143], v[60:63], v[92:95]
    s_lshl4_add_u32 s15, s8, s15
    ds_read_b64_tr_b16 a[192:193], v12 offset:16384
    v_mfma_f32_16x16x32_bf16 v[88:91], a[136:139], v[60:63], v[88:91]
    s_add_u32 m0, s20, 0
    ds_read_b128 v[52:55], v17 offset:27648
    s_mul_i32 s14, s83, 6
    v_mfma_f32_16x16x32_bf16 v[88:91], a[128:131], v[56:59], v[88:91]
    s_mul_i32 s8, s3, 786432
    buffer_load_dwordx4 v4, s[48:51], s14 offen offset:0 lds
    ds_read_b64_tr_b16 a[194:195], v12 offset:17408
    v_mfma_f32_16x16x32_bf16 v[96:99], a[128:131], v[32:35], v[96:99]
    ds_read_b128 v[56:59], v17 offset:30720
    v_mfma_f32_16x16x32_bf16 v[96:99], a[136:139], v[36:39], v[96:99]
    s_add_u32 s15, s15, s8
    buffer_load_dwordx4 v5, s[48:51], s14 offen offset:1024 lds
    v_mfma_f32_16x16x32_bf16 v[100:103], a[140:143], v[36:39], v[100:103]
    ds_read_b128 v[60:63], v17 offset:33792
    v_mfma_f32_16x16x32_bf16 v[100:103], a[132:135], v[32:35], v[100:103]
    s_waitcnt lgkmcnt(6)
    s_add_u32 s15, s15, 3211264
    ds_read_b64_tr_b16 a[196:197], v13 offset:16384
    v_mfma_f32_16x16x32_bf16 v[108:111], a[132:135], v[40:43], v[108:111]
    ds_read_b128 v[32:35], v17 offset:25600
    v_mul_u32_u24 v147, 12288, v2
    v_mfma_f32_16x16x32_bf16 v[108:111], a[140:143], v[44:47], v[108:111]
    buffer_load_dwordx4 v6, s[48:51], s14 offen offset:2048 lds
    ds_read_b64_tr_b16 a[198:199], v13 offset:17408
    v_mfma_f32_16x16x32_bf16 v[104:107], a[136:139], v[44:47], v[104:107]
    ds_read_b128 v[36:39], v17 offset:28672
    v_mfma_f32_16x16x32_bf16 v[104:107], a[128:131], v[40:43], v[104:107]
    s_waitcnt lgkmcnt(7)
    s_lshr_b32 s10, s20, 2
    buffer_load_dwordx4 v7, s[48:51], s14 offen offset:3072 lds
    v_mfma_f32_16x16x32_bf16 v[64:67], a[144:147], v[48:51], v[64:67]
    s_mul_i32 s4, s18, 6
    ds_read_b128 v[40:43], v17 offset:31744
    v_mfma_f32_16x16x32_bf16 v[64:67], a[152:155], v[52:55], v[64:67]
    s_cmp_lt_u32 s3, 2
    s_cselect_b32 s74, s74, s75
    ds_read_b64_tr_b16 a[200:201], v12 offset:24576
    v_mfma_f32_16x16x32_bf16 v[68:71], a[156:159], v[52:55], v[68:71]
    s_add_u32 m0, s21, 36864
    ds_read_b128 v[44:47], v17 offset:34816
    s_add_u32 s4, s4, s19
    v_mfma_f32_16x16x32_bf16 v[68:71], a[148:151], v[48:51], v[68:71]
    s_waitcnt lgkmcnt(7)
    s_lshl2_add_u32 s5, s4, s3
    buffer_load_dwordx4 v18, s[44:47], s81 offen offset:0 sc1 lds
    ds_read_b64_tr_b16 a[202:203], v12 offset:25600
    v_mfma_f32_16x16x32_bf16 v[76:79], a[148:151], v[56:59], v[76:79]
    s_xor_b32 s6, s5, 4
    ds_read_b128 v[48:51], v17 offset:26624
    v_mfma_f32_16x16x32_bf16 v[76:79], a[156:159], v[60:63], v[76:79]
L_pl_G_2:
    s_cbranch_execz L_wret
    v_mfma_f32_16x16x32_bf16 v[72:75], a[152:155], v[60:63], v[72:75]
    s_mul_i32 s43, s5, 6144
    ds_read_b128 v[52:55], v17 offset:29696
    v_mfma_f32_16x16x32_bf16 v[72:75], a[144:147], v[56:59], v[72:75]
    s_waitcnt lgkmcnt(6)
    s_add_u32 s43, s43, 9175040
    buffer_load_dwordx4 v19, s[44:47], s81 offen offset:1024 sc1 lds
    ds_read_b64_tr_b16 a[204:205], v13 offset:24576
    v_mfma_f32_16x16x32_bf16 v[80:83], a[144:147], v[32:35], v[80:83]
    s_mul_i32 s42, s6, 6144
    ds_read_b128 v[56:59], v17 offset:32768
    v_mfma_f32_16x16x32_bf16 v[80:83], a[152:155], v[36:39], v[80:83]
    buffer_load_dwordx4 v20, s[44:47], s81 offen offset:2048 sc1 lds
    ds_read_b64_tr_b16 a[206:207], v13 offset:25600
    v_mfma_f32_16x16x32_bf16 v[84:87], a[156:159], v[36:39], v[84:87]
    s_add_u32 s42, s42, 9175040
    ds_read_b128 v[60:63], v17 offset:35840
    v_mfma_f32_16x16x32_bf16 v[84:87], a[148:151], v[32:35], v[84:87]
    s_waitcnt vmcnt(17) lgkmcnt(1)
    s_barrier
    s_lshl_b32 s4, s18, 1
    v_mfma_f32_16x16x32_bf16 v[92:95], a[148:151], v[40:43], v[92:95]
    s_lshr_b32 s5, s3, 1
    ds_read_b128 v[32:35], v16 offset:0
    v_mfma_f32_16x16x32_bf16 v[92:95], a[156:159], v[44:47], v[92:95]
    ds_read_b64_tr_b16 a[208:209], v12 offset:32768
    v_mfma_f32_16x16x32_bf16 v[88:91], a[152:155], v[44:47], v[88:91]
    s_add_u32 m0, s21, 49152
    ds_read_b128 v[36:39], v16 offset:3072
    s_add_u32 s4, s4, s5
    v_mfma_f32_16x16x32_bf16 v[88:91], a[144:147], v[40:43], v[88:91]
    s_lshl_b32 s4, s4, 17
    buffer_load_dwordx4 v18, s[44:47], s82 offen offset:0 sc1 lds
    ds_read_b64_tr_b16 a[210:211], v12 offset:33792
    v_mfma_f32_16x16x32_bf16 v[96:99], a[144:147], v[48:51], v[96:99]
    s_and_b32 s5, s3, 1
    ds_read_b128 v[40:43], v16 offset:6144
    v_mfma_f32_16x16x32_bf16 v[96:99], a[152:155], v[52:55], v[96:99]
    buffer_load_dwordx4 v19, s[44:47], s82 offen offset:1024 sc1 lds
    v_mfma_f32_16x16x32_bf16 v[100:103], a[156:159], v[52:55], v[100:103]
    s_mul_i32 s5, s5, 49152
    ds_read_b128 v[44:47], v16 offset:9216
    v_mfma_f32_16x16x32_bf16 v[100:103], a[148:151], v[48:51], v[100:103]
    s_waitcnt lgkmcnt(6)
    s_add_u32 s4, s4, s5
    ds_read_b64_tr_b16 a[212:213], v13 offset:32768
    v_mfma_f32_16x16x32_bf16 v[108:111], a[148:151], v[56:59], v[108:111]
    s_lshl_b32 s5, s19, 11
    ds_read_b128 v[48:51], v16 offset:1024
    v_mfma_f32_16x16x32_bf16 v[108:111], a[156:159], v[60:63], v[108:111]
    buffer_load_dwordx4 v20, s[44:47], s82 offen offset:2048 sc1 lds
    ds_read_b64_tr_b16 a[214:215], v13 offset:33792
    v_mfma_f32_16x16x32_bf16 v[104:107], a[152:155], v[60:63], v[104:107]
    s_add_u32 s4, s4, s5
    ds_read_b128 v[52:55], v16 offset:4096
    s_add_u32 s30, s4, 22872064
    v_mfma_f32_16x16x32_bf16 v[104:107], a[144:147], v[56:59], v[104:107]
    s_waitcnt lgkmcnt(7)
    s_cmp_ge_u32 s19, 3
    s_cselect_b32 s5, 3, 0
    s_cselect_b32 s4, 1, 0
    v_mfma_f32_16x16x32_bf16 v[64:67], a[160:163], v[32:35], v[64:67]
    ds_read_b128 v[56:59], v16 offset:7168
    v_mfma_f32_16x16x32_bf16 v[64:67], a[168:171], v[36:39], v[64:67]
    ds_read_b64_tr_b16 a[216:217], v12 offset:40960
    v_mfma_f32_16x16x32_bf16 v[68:71], a[172:175], v[36:39], v[68:71]
    s_sub_u32 s5, s19, s5
    ds_read_b128 v[60:63], v16 offset:10240
    v_mfma_f32_16x16x32_bf16 v[68:71], a[164:167], v[32:35], v[68:71]
    s_waitcnt lgkmcnt(7)
    s_lshl1_add_u32 s4, s18, s4
    ds_read_b64_tr_b16 a[218:219], v12 offset:41984
    v_mfma_f32_16x16x32_bf16 v[76:79], a[164:167], v[40:43], v[76:79]
    s_lshl_b32 s4, s4, 7
    ds_read_b128 v[32:35], v16 offset:2048
    v_mfma_f32_16x16x32_bf16 v[76:79], a[172:175], v[44:47], v[76:79]
    v_mfma_f32_16x16x32_bf16 v[72:75], a[168:171], v[44:47], v[72:75]
    s_lshl2_add_u32 s4, s5, s4
    ds_read_b128 v[36:39], v16 offset:5120
    v_mfma_f32_16x16x32_bf16 v[72:75], a[160:163], v[40:43], v[72:75]
    s_waitcnt lgkmcnt(6)
    s_add_u32 s32, s4, 8994816
    ds_read_b64_tr_b16 a[220:221], v13 offset:40960
    v_mfma_f32_16x16x32_bf16 v[80:83], a[160:163], v[48:51], v[80:83]
    s_mov_b32 s64, s38
    ds_read_b128 v[40:43], v16 offset:8192
    v_mfma_f32_16x16x32_bf16 v[80:83], a[168:171], v[52:55], v[80:83]
    ds_read_b64_tr_b16 a[222:223], v13 offset:41984
    v_mfma_f32_16x16x32_bf16 v[84:87], a[172:175], v[52:55], v[84:87]
    s_and_b32 s65, s39, 0xffff
    ds_read_b128 v[44:47], v16 offset:11264
    v_mfma_f32_16x16x32_bf16 v[84:87], a[164:167], v[48:51], v[84:87]
    s_waitcnt vmcnt(13) lgkmcnt(1)
    s_barrier
    s_mov_b32 s66, 2359296
    v_mfma_f32_16x16x32_bf16 v[92:95], a[164:167], v[56:59], v[92:95]
    s_add_u32 m0, s21, 61440
    ds_read_b128 v[48:51], v16 offset:12288
    s_mov_b32 s67, 0x20000
    v_mfma_f32_16x16x32_bf16 v[92:95], a[172:175], v[60:63], v[92:95]
    buffer_load_dwordx4 v18, s[44:47], s83 offen offset:0 sc1 lds
    ds_read_b64_tr_b16 a[224:225], v12 offset:49152
    v_mfma_f32_16x16x32_bf16 v[88:91], a[168:171], v[60:63], v[88:91]
    s_cmp_lt_u32 s3, 2
    s_cselect_b32 s4, s40, s41
    ds_read_b128 v[52:55], v16 offset:15360
    v_mfma_f32_16x16x32_bf16 v[88:91], a[160:163], v[56:59], v[88:91]
    s_lshr_b32 s4, s4, 1
    buffer_load_dwordx4 v19, s[44:47], s83 offen offset:1024 sc1 lds
    ds_read_b64_tr_b16 a[226:227], v12 offset:50176
    v_mfma_f32_16x16x32_bf16 v[96:99], a[160:163], v[32:35], v[96:99]
    s_and_b32 s5, s3, 1
    ds_read_b128 v[56:59], v16 offset:18432
    v_mfma_f32_16x16x32_bf16 v[96:99], a[168:171], v[36:39], v[96:99]
    buffer_load_dwordx4 v20, s[44:47], s83 offen offset:2048 sc1 lds
    v_mfma_f32_16x16x32_bf16 v[100:103], a[172:175], v[36:39], v[100:103]
    s_lshl_b32 s5, s5, 5
    ds_read_b128 v[60:63], v16 offset:21504
    v_mfma_f32_16x16x32_bf16 v[100:103], a[164:167], v[32:35], v[100:103]
    s_waitcnt lgkmcnt(6)
    s_add_u32 s4, s4, s5
    ds_read_b64_tr_b16 a[228:229], v13 offset:49152
    v_mfma_f32_16x16x32_bf16 v[108:111], a[164:167], v[40:43], v[108:111]
    ds_read_b128 v[32:35], v16 offset:13312
    v_and_b32 v1, 15, v2
    v_mfma_f32_16x16x32_bf16 v[108:111], a[172:175], v[44:47], v[108:111]
    ds_read_b64_tr_b16 a[230:231], v13 offset:50176
    v_mfma_f32_16x16x32_bf16 v[104:107], a[168:171], v[44:47], v[104:107]
    ds_read_b128 v[36:39], v16 offset:16384
    v_add_u32 v1, s4, v1
    v_mfma_f32_16x16x32_bf16 v[104:107], a[160:163], v[40:43], v[104:107]
    s_waitcnt lgkmcnt(7)
    s_cmp_lt_u32 s3, 2
    s_cselect_b32 s76, s76, s77
    v_lshlrev_b32 v14, 3, v1
    v_mfma_f32_16x16x32_bf16 v[64:67], a[176:179], v[48:51], v[64:67]
    s_add_u32 m0, s20, 16384
    ds_read_b128 v[40:43], v16 offset:19456
    s_lshl_b32 s14, s84, 1
    v_mfma_f32_16x16x32_bf16 v[64:67], a[184:187], v[52:55], v[64:67]
    s_and_b32 s9, s23, 1
    buffer_load_dwordx4 v8, s[52:55], s14 offen offset:0 lds
    ds_read_b64_tr_b16 a[232:233], v12 offset:57344
    v_mfma_f32_16x16x32_bf16 v[68:71], a[188:191], v[52:55], v[68:71]
    s_sub_u32 s26, 0, s9
    ds_read_b128 v[44:47], v16 offset:22528
    v_mfma_f32_16x16x32_bf16 v[68:71], a[180:183], v[48:51], v[68:71]
    s_waitcnt lgkmcnt(7)
    s_sub_u32 s27, 0, s9
    buffer_load_dwordx4 v9, s[52:55], s14 offen offset:1024 lds
    ds_read_b64_tr_b16 a[234:235], v12 offset:58368
    v_mfma_f32_16x16x32_bf16 v[76:79], a[180:183], v[56:59], v[76:79]
    ds_read_b128 v[48:51], v16 offset:14336
    v_mul_u32_u24 v1, 1152, v1
    v_mfma_f32_16x16x32_bf16 v[76:79], a[188:191], v[60:63], v[76:79]
    buffer_load_dwordx4 v10, s[52:55], s14 offen offset:2048 lds
    v_mfma_f32_16x16x32_bf16 v[72:75], a[184:187], v[60:63], v[72:75]
    s_and_b32 s6, s22, 1
    ds_read_b128 v[52:55], v16 offset:17408
    v_mfma_f32_16x16x32_bf16 v[72:75], a[176:179], v[56:59], v[72:75]
    s_waitcnt lgkmcnt(6)
    s_movk_i32 s7, 5971
    buffer_load_dwordx4 v11, s[52:55], s14 offen offset:3072 lds
    ds_read_b64_tr_b16 a[236:237], v13 offset:57344
    v_mfma_f32_16x16x32_bf16 v[80:83], a[176:179], v[32:35], v[80:83]
    s_add_u32 m0, s20, 32768
    ds_read_b128 v[56:59], v16 offset:20480
    s_lshl_b32 s14, s85, 1
    v_mfma_f32_16x16x32_bf16 v[80:83], a[184:187], v[36:39], v[80:83]
    buffer_load_dwordx4 v8, s[52:55], s14 offen offset:0 lds
    ds_read_b64_tr_b16 a[238:239], v13 offset:58368
    v_mfma_f32_16x16x32_bf16 v[84:87], a[188:191], v[36:39], v[84:87]
    s_cmp_eq_u32 s6, 0
    s_cselect_b32 s7, 25632, s7
    ds_read_b128 v[60:63], v16 offset:23552
    v_mfma_f32_16x16x32_bf16 v[84:87], a[180:183], v[32:35], v[84:87]
    s_waitcnt vmcnt(14) lgkmcnt(1)
    s_barrier
    s_lshl_b32 s8, s23, 2
    s_lshr_b32 s7, s7, s8
    v_mfma_f32_16x16x32_bf16 v[92:95], a[180:183], v[40:43], v[92:95]
    s_and_b32 s7, s7, 15
    ds_read_b128 v[32:35], v16 offset:24576
    v_mfma_f32_16x16x32_bf16 v[92:95], a[188:191], v[44:47], v[92:95]
    buffer_load_dwordx4 v9, s[52:55], s14 offen offset:1024 lds
    ds_read_b64_tr_b16 a[240:241], v12 offset:0
    v_mfma_f32_16x16x32_bf16 v[88:91], a[184:187], v[44:47], v[88:91]
    s_mul_i32 s8, s22, 9
    ds_read_b128 v[36:39], v16 offset:27648
    v_mfma_f32_16x16x32_bf16 v[88:91], a[176:179], v[40:43], v[88:91]
    s_add_u32 s7, s7, s8
    buffer_load_dwordx4 v10, s[52:55], s14 offen offset:2048 lds
    ds_read_b64_tr_b16 a[242:243], v12 offset:1024
    v_mfma_f32_16x16x32_bf16 v[96:99], a[176:179], v[48:51], v[96:99]
    s_xor_b32 s6, s6, 1
    ds_read_b128 v[40:43], v16 offset:30720
    v_mfma_f32_16x16x32_bf16 v[96:99], a[184:187], v[52:55], v[96:99]
    buffer_load_dwordx4 v11, s[52:55], s14 offen offset:3072 lds
    v_mfma_f32_16x16x32_bf16 v[100:103], a[188:191], v[52:55], v[100:103]
    s_lshl3_add_u32 s6, s6, s8
    ds_read_b128 v[44:47], v16 offset:33792
    v_mfma_f32_16x16x32_bf16 v[100:103], a[180:183], v[48:51], v[100:103]
    s_waitcnt lgkmcnt(6)
    s_lshl_b32 s8, s7, 5
    ds_read_b64_tr_b16 a[244:245], v13 offset:0
    v_bfe_u32 v3, v2, 4, 1
    v_mfma_f32_16x16x32_bf16 v[108:111], a[180:183], v[56:59], v[108:111]
    s_add_u32 m0, s21, 0
    ds_read_b128 v[48:51], v16 offset:25600
    s_bfe_u32 s14, s31, 0x30000
    s_lshl_b32 s14, s14, 8
    s_add_u32 s14, s14, s17
    v_add_u32 v18, s14, v22
    v_mfma_f32_16x16x32_bf16 v[108:111], a[188:191], v[60:63], v[108:111]
    buffer_load_dwordx4 v18, s[44:47], s68 offen offset:0 sc1 lds
    ds_read_b64_tr_b16 a[246:247], v13 offset:1024
    v_mfma_f32_16x16x32_bf16 v[104:107], a[184:187], v[60:63], v[104:107]
    ds_read_b128 v[52:55], v16 offset:28672
    v_lshl_add_u32 v3, v3, 5, v1
    v_mfma_f32_16x16x32_bf16 v[104:107], a[176:179], v[56:59], v[104:107]
    s_waitcnt lgkmcnt(7)
    v_lshrrev_b32 v31, 5, v2
    v_mfma_f32_16x16x32_bf16 v[64:67], a[192:195], v[32:35], v[64:67]
    ds_read_b128 v[56:59], v16 offset:31744
    v_lshl_add_u32 v3, v31, 4, v3
    v_mfma_f32_16x16x32_bf16 v[64:67], a[200:203], v[36:39], v[64:67]
    s_cmp_lt_u32 s3, 2
    s_cselect_b32 s78, s78, s79
    ds_read_b64_tr_b16 a[248:249], v12 offset:8192
    v_mfma_f32_16x16x32_bf16 v[68:71], a[204:207], v[36:39], v[68:71]
    ds_read_b128 v[60:63], v16 offset:34816
    v_add_u32 v144, s8, v3
    v_mfma_f32_16x16x32_bf16 v[68:71], a[196:199], v[32:35], v[68:71]
    s_waitcnt lgkmcnt(7)
    s_mul_i32 s8, s9, 18432
    ds_read_b64_tr_b16 a[250:251], v12 offset:9216
    v_mfma_f32_16x16x32_bf16 v[76:79], a[196:199], v[40:43], v[76:79]
    s_lshl_b32 s5, s6, 5
    ds_read_b128 v[32:35], v16 offset:26624
    v_mfma_f32_16x16x32_bf16 v[76:79], a[204:207], v[44:47], v[76:79]
    v_mfma_f32_16x16x32_bf16 v[72:75], a[200:203], v[44:47], v[72:75]
    s_add_u32 s8, s8, s5
    ds_read_b128 v[36:39], v16 offset:29696
    v_lshrrev_b32 v3, 4, v2
    v_mfma_f32_16x16x32_bf16 v[72:75], a[192:195], v[40:43], v[72:75]
    s_waitcnt lgkmcnt(6)
    ds_read_b64_tr_b16 a[252:253], v13 offset:8192
    v_lshl_add_u32 v3, v3, 3, v1
    v_mfma_f32_16x16x32_bf16 v[80:83], a[192:195], v[48:51], v[80:83]
    s_bfe_u32 s14, s31, 0x30003
    ds_read_b128 v[40:43], v16 offset:32768
    s_lshl_b32 s14, s14, 8
    s_add_u32 s14, s14, s17
    s_sub_u32 s14, s14, 1024
    v_add_u32 v19, s14, v22
    v_mfma_f32_16x16x32_bf16 v[80:83], a[200:203], v[52:55], v[80:83]
    buffer_load_dwordx4 v19, s[44:47], s68 offen offset:1024 sc1 lds
    ds_read_b64_tr_b16 a[254:255], v13 offset:9216
    v_mfma_f32_16x16x32_bf16 v[84:87], a[204:207], v[52:55], v[84:87]
    ds_read_b128 v[44:47], v16 offset:35840
    v_add_u32 v3, s8, v3
    v_mfma_f32_16x16x32_bf16 v[84:87], a[196:199], v[48:51], v[84:87]
    s_waitcnt vmcnt(16) lgkmcnt(1)
    s_barrier
    s_lshr_b32 s8, s23, 1
    v_mfma_f32_16x16x32_bf16 v[92:95], a[196:199], v[56:59], v[92:95]
    s_bfe_u32 s14, s31, 0x30006
    ds_read_b128 v[48:51], v17 offset:0
    s_lshl_b32 s14, s14, 8
    s_add_u32 s14, s14, s17
    s_sub_u32 s14, s14, 2048
    v_add_u32 v20, s14, v22
    v_mfma_f32_16x16x32_bf16 v[92:95], a[204:207], v[60:63], v[92:95]
    buffer_load_dwordx4 v20, s[44:47], s68 offen offset:2048 sc1 lds
    v_mov_b32 v1, 0x40000000
    v_mfma_f32_16x16x32_bf16 v[88:91], a[200:203], v[60:63], v[88:91]
    ds_read_b128 v[52:55], v17 offset:3072
    v_mfma_f32_16x16x32_bf16 v[88:91], a[192:195], v[56:59], v[88:91]
    v_cmp_eq_u32 vcc, s8, v31
    s_nop 1
    v_cndmask_b32 v145, v1, v3, vcc
    v_mfma_f32_16x16x32_bf16 v[96:99], a[192:195], v[32:35], v[96:99]
    s_add_u32 m0, s21, 12288
    ds_read_b128 v[56:59], v17 offset:6144
    s_lshl_b32 s36, s7, 16
    v_mfma_f32_16x16x32_bf16 v[96:99], a[200:203], v[36:39], v[96:99]
    s_add_u32 s36, s36, 6356992
    buffer_load_dwordx4 v18, s[44:47], s70 offen offset:0 sc1 lds
    v_mfma_f32_16x16x32_bf16 v[100:103], a[204:207], v[36:39], v[100:103]
    s_lshl_b32 s37, s6, 16
    ds_read_b128 v[60:63], v17 offset:9216
    v_mfma_f32_16x16x32_bf16 v[100:103], a[196:199], v[32:35], v[100:103]
    s_waitcnt lgkmcnt(4)
    s_add_u32 s37, s37, 6356992
    v_mfma_f32_16x16x32_bf16 v[108:111], a[196:199], v[40:43], v[108:111]
    ds_read_b128 v[32:35], v17 offset:1024
    v_mov_b32 v3, s40
    v_mfma_f32_16x16x32_bf16 v[108:111], a[204:207], v[44:47], v[108:111]
    buffer_load_dwordx4 v19, s[44:47], s70 offen offset:1024 sc1 lds
    v_mov_b32 v31, s41
    v_mfma_f32_16x16x32_bf16 v[104:107], a[200:203], v[44:47], v[104:107]
    ds_read_b128 v[36:39], v17 offset:4096
    v_and_b32 v1, 8, v2
    v_mfma_f32_16x16x32_bf16 v[104:107], a[192:195], v[40:43], v[104:107]
    s_waitcnt lgkmcnt(4)
    v_cmp_lt_u32 vcc, 0, v1
    s_nop 1
    v_cndmask_b32 v3, v3, v31, vcc
    v_mfma_f32_16x16x32_bf16 v[64:67], a[208:211], v[48:51], v[64:67]
    ds_read_b128 v[40:43], v17 offset:7168
    v_mfma_f32_16x16x32_bf16 v[64:67], a[216:219], v[52:55], v[64:67]
    buffer_load_dwordx4 v20, s[44:47], s70 offen offset:2048 sc1 lds
    v_mfma_f32_16x16x32_bf16 v[68:71], a[220:223], v[52:55], v[68:71]
    ds_read_b128 v[44:47], v17 offset:10240
    v_and_b32 v1, 7, v2
    v_mfma_f32_16x16x32_bf16 v[68:71], a[212:215], v[48:51], v[68:71]
    s_waitcnt lgkmcnt(4)
    v_lshl_add_u32 v3, v1, 4, v3
    v_mfma_f32_16x16x32_bf16 v[76:79], a[212:215], v[56:59], v[76:79]
    s_add_u32 m0, s20, 49152
    ds_read_b128 v[48:51], v17 offset:2048
    s_lshl_b32 s14, s86, 1
    v_mfma_f32_16x16x32_bf16 v[76:79], a[220:223], v[60:63], v[76:79]
    buffer_load_dwordx4 v8, s[52:55], s14 offen offset:0 lds
    v_lshrrev_b32 v1, 4, v2
    v_mfma_f32_16x16x32_bf16 v[72:75], a[216:219], v[60:63], v[72:75]
    ds_read_b128 v[52:55], v17 offset:5120
    v_lshl_add_u32 v3, v1, 12, v3
    v_mfma_f32_16x16x32_bf16 v[72:75], a[208:211], v[56:59], v[72:75]
    s_waitcnt lgkmcnt(4)
    s_lshl_b32 s8, s3, 14
    v_mfma_f32_16x16x32_bf16 v[80:83], a[208:211], v[32:35], v[80:83]
    ds_read_b128 v[56:59], v17 offset:8192
    v_add_u32 v155, s8, v3
    v_mfma_f32_16x16x32_bf16 v[80:83], a[216:219], v[36:39], v[80:83]
    v_mfma_f32_16x16x32_bf16 v[84:87], a[220:223], v[36:39], v[84:87]
    ds_read_b128 v[60:63], v17 offset:11264
    v_lshrrev_b32 v1, 2, v2
    v_mfma_f32_16x16x32_bf16 v[84:87], a[212:215], v[32:35], v[84:87]
    s_waitcnt vmcnt(11) lgkmcnt(4)
    s_barrier
    v_lshlrev_b32 v1, 8, v1
    v_mfma_f32_16x16x32_bf16 v[92:95], a[212:215], v[40:43], v[92:95]
    ds_read_b128 v[32:35], v17 offset:12288
    buffer_load_dword v143, v142, s[44:47], 0 offen offset:0 sc1
    v_mfma_f32_16x16x32_bf16 v[92:95], a[220:223], v[44:47], v[92:95]
    ds_read_b64_tr_b16 v[156:157], v12 offset:16384
    v_and_b32 v3, 3, v2
    v_mfma_f32_16x16x32_bf16 v[88:91], a[216:219], v[44:47], v[88:91]
    ds_read_b128 v[36:39], v17 offset:15360
    v_lshl_add_u32 v1, v3, 3, v1
    v_mfma_f32_16x16x32_bf16 v[88:91], a[208:211], v[40:43], v[88:91]
    s_waitcnt lgkmcnt(5)
    s_lshl_b32 s8, s3, 6
    buffer_load_dwordx4 v9, s[52:55], s14 offen offset:1024 lds
    ds_read_b64_tr_b16 v[158:159], v12 offset:17408
    v_mfma_f32_16x16x32_bf16 v[96:99], a[208:211], v[48:51], v[96:99]
    ds_read_b128 v[40:43], v17 offset:18432
    v_add_u32 v252, s8, v1
    v_mfma_f32_16x16x32_bf16 v[96:99], a[216:219], v[52:55], v[96:99]
    buffer_load_dwordx4 v10, s[52:55], s14 offen offset:2048 lds
    v_min_u32 v1, 17, v2
    v_mfma_f32_16x16x32_bf16 v[100:103], a[220:223], v[52:55], v[100:103]
    ds_read_b128 v[44:47], v17 offset:21504
    v_lshrrev_b32 v3, 1, v1
    v_mfma_f32_16x16x32_bf16 v[100:103], a[212:215], v[48:51], v[100:103]
    s_waitcnt lgkmcnt(6)
    ds_read_b64_tr_b16 v[160:161], v13 offset:16384
    v_and_b32 v1, 1, v1
    v_mfma_f32_16x16x32_bf16 v[108:111], a[212:215], v[56:59], v[108:111]
    s_cmp_lt_u32 s3, 2
    s_cselect_b32 s80, s80, s81
    ds_read_b128 v[48:51], v17 offset:13312
    v_mfma_f32_16x16x32_bf16 v[108:111], a[220:223], v[60:63], v[108:111]
    buffer_load_dwordx4 v11, s[52:55], s14 offen offset:3072 lds
    ds_read_b64_tr_b16 v[162:163], v13 offset:17408
    v_mfma_f32_16x16x32_bf16 v[104:107], a[216:219], v[60:63], v[104:107]
    s_add_u32 m0, s21, 24576
    ds_read_b128 v[52:55], v17 offset:16384
    v_lshlrev_b32 v3, 8, v3
    v_mfma_f32_16x16x32_bf16 v[104:107], a[208:211], v[56:59], v[104:107]
    s_waitcnt lgkmcnt(7)
    buffer_load_dwordx4 v18, s[44:47], s72 offen offset:0 sc1 lds
    v_lshl_add_u32 v3, v1, 2, v3
    v_mfma_f32_16x16x32_bf16 v[64:67], a[224:227], v[32:35], v[64:67]
    s_mul_i32 s8, s23, 18
    ds_read_b128 v[56:59], v17 offset:19456
    v_mfma_f32_16x16x32_bf16 v[64:67], a[232:235], v[36:39], v[64:67]
    buffer_load_dwordx4 v19, s[44:47], s72 offen offset:1024 sc1 lds
    ds_read_b64_tr_b16 v[164:165], v12 offset:24576
    v_mfma_f32_16x16x32_bf16 v[68:71], a[236:239], v[36:39], v[68:71]
    s_lshr_b32 s5, s22, 1
    ds_read_b128 v[60:63], v17 offset:22528
    v_mfma_f32_16x16x32_bf16 v[68:71], a[228:231], v[32:35], v[68:71]
    s_waitcnt lgkmcnt(7)
    s_add_u32 s8, s8, s5
    buffer_load_dwordx4 v20, s[44:47], s72 offen offset:2048 sc1 lds
    ds_read_b64_tr_b16 v[166:167], v12 offset:25600
    v_mfma_f32_16x16x32_bf16 v[76:79], a[228:231], v[40:43], v[76:79]
    s_lshl_b32 s8, s8, 5
    ds_read_b128 v[32:35], v17 offset:14336
    v_mfma_f32_16x16x32_bf16 v[76:79], a[236:239], v[44:47], v[76:79]
    v_mfma_f32_16x16x32_bf16 v[72:75], a[232:235], v[44:47], v[72:75]
    s_and_b32 s5, s22, 1
    ds_read_b128 v[36:39], v17 offset:17408
    v_mfma_f32_16x16x32_bf16 v[72:75], a[224:227], v[40:43], v[72:75]
    s_waitcnt lgkmcnt(6)
    s_add_u32 s8, s8, s5
    ds_read_b64_tr_b16 v[168:169], v13 offset:24576
    v_mfma_f32_16x16x32_bf16 v[80:83], a[224:227], v[48:51], v[80:83]
    s_lshl_b32 s8, s8, 2
    ds_read_b128 v[40:43], v17 offset:20480
    v_mfma_f32_16x16x32_bf16 v[80:83], a[232:235], v[52:55], v[80:83]
    ds_read_b64_tr_b16 v[170:171], v13 offset:25600
    v_mfma_f32_16x16x32_bf16 v[84:87], a[236:239], v[52:55], v[84:87]
    s_add_u32 s8, s8, 8994816
    ds_read_b128 v[44:47], v17 offset:23552
    v_add_u32 v26, s8, v3
    v_mfma_f32_16x16x32_bf16 v[84:87], a[228:231], v[48:51], v[84:87]
    s_waitcnt vmcnt(14) lgkmcnt(1)
    s_barrier
    v_mov_b32 v1, s34
    v_and_b32 v31, 3, v1
    v_mfma_f32_16x16x32_bf16 v[92:95], a[228:231], v[56:59], v[92:95]
    ds_read_b128 v[48:51], v17 offset:24576
    v_lshrrev_b32 v1, 2, v1
    v_mfma_f32_16x16x32_bf16 v[92:95], a[236:239], v[60:63], v[92:95]
    ds_read_b64_tr_b16 v[172:173], v12 offset:32768
    v_lshlrev_b32 v1, 7, v1
    v_mfma_f32_16x16x32_bf16 v[88:91], a[232:235], v[60:63], v[88:91]
    ds_read_b128 v[52:55], v17 offset:27648
    v_lshl_add_u32 v1, v31, 2, v1
    v_mfma_f32_16x16x32_bf16 v[88:91], a[224:227], v[56:59], v[88:91]
    ds_read_b64_tr_b16 v[174:175], v12 offset:33792
    v_add_u32 v1, 9023488, v1
    v_mfma_f32_16x16x32_bf16 v[96:99], a[224:227], v[32:35], v[96:99]
    ds_read_b128 v[56:59], v17 offset:30720
    v_mov_b32 v31, 0x40000000
    v_mfma_f32_16x16x32_bf16 v[96:99], a[232:235], v[36:39], v[96:99]
    v_cmp_gt_u32 vcc, 1, v0
    s_nop 1
    v_cndmask_b32 v29, v31, v1, vcc
    v_mfma_f32_16x16x32_bf16 v[100:103], a[236:239], v[36:39], v[100:103]
    s_add_u32 m0, s21, 36864
    ds_read_b128 v[60:63], v17 offset:33792
    v_mfma_f32_16x16x32_bf16 v[100:103], a[228:231], v[32:35], v[100:103]
    s_waitcnt lgkmcnt(6)
    buffer_load_dwordx4 v18, s[44:47], s74 offen offset:0 sc1 lds
    ds_read_b64_tr_b16 v[176:177], v13 offset:32768
    v_mfma_f32_16x16x32_bf16 v[108:111], a[228:231], v[40:43], v[108:111]
    ds_read_b128 v[32:35], v17 offset:25600
    v_mfma_f32_16x16x32_bf16 v[108:111], a[236:239], v[44:47], v[108:111]
    ds_read_b64_tr_b16 v[178:179], v13 offset:33792
    v_mfma_f32_16x16x32_bf16 v[104:107], a[232:235], v[44:47], v[104:107]
    ds_read_b128 v[36:39], v17 offset:28672
    v_mfma_f32_16x16x32_bf16 v[104:107], a[224:227], v[40:43], v[104:107]
    s_waitcnt lgkmcnt(7)
    s_cmp_lt_u32 s3, 2
    s_cselect_b32 s82, s82, s83
    s_mul_i32 s4, s16, 0x9e3779b1
    v_mfma_f32_16x16x32_bf16 v[64:67], a[240:243], v[48:51], v[64:67]
    s_lshr_b32 s5, s4, 15
    ds_read_b128 v[40:43], v17 offset:31744
    v_mfma_f32_16x16x32_bf16 v[64:67], a[248:251], v[52:55], v[64:67]
    ds_read_b64_tr_b16 v[180:181], v12 offset:40960
    v_mfma_f32_16x16x32_bf16 v[68:71], a[252:255], v[52:55], v[68:71]
    s_xor_b32 s4, s4, s5
    ds_read_b128 v[44:47], v17 offset:34816
    v_mfma_f32_16x16x32_bf16 v[68:71], a[244:247], v[48:51], v[68:71]
    s_waitcnt lgkmcnt(7)
    s_mul_i32 s4, s4, 0x85ebca77
    ds_read_b64_tr_b16 v[182:183], v12 offset:41984
    v_mfma_f32_16x16x32_bf16 v[76:79], a[244:247], v[56:59], v[76:79]
    s_lshr_b32 s5, s4, 13
    ds_read_b128 v[48:51], v17 offset:26624
    v_mfma_f32_16x16x32_bf16 v[76:79], a[252:255], v[60:63], v[76:79]
    s_waitcnt vmcnt(7)
    buffer_load_dwordx4 v19, s[44:47], s74 offen offset:1024 sc1 lds
    ds_read_b64_tr_b16 v[184:185], v13 offset:40960
    v_mfma_f32_16x16x32_bf16 v[72:75], a[248:251], v[60:63], v[72:75]
    s_xor_b32 s4, s4, s5
    ds_read_b128 v[52:55], v17 offset:29696
    v_mfma_f32_16x16x32_bf16 v[72:75], a[240:243], v[56:59], v[72:75]
    s_waitcnt lgkmcnt(7)
    s_mov_b32 s33, 0x10001
    v_cmp_ne_u32 vcc, s16, v143
    s_cbranch_vccnz L_rs_pk
L_ok_pk:
    buffer_load_dwordx4 v20, s[44:47], s74 offen offset:2048 sc1 lds
    v_mfma_f32_16x16x32_bf16 v[80:83], a[240:243], v[32:35], v[80:83]
    s_add_u32 m0, s10, 70176
    ds_read_b128 v[56:59], v17 offset:32768
    v_and_b32 v1, 3, v2
    v_mfma_f32_16x16x32_bf16 v[80:83], a[248:251], v[36:39], v[80:83]
    buffer_load_dwordx4 v147, s[44:47], s15 offen sc1 lds
    ds_read_b64_tr_b16 v[186:187], v13 offset:41984
    v_mfma_f32_16x16x32_bf16 v[84:87], a[252:255], v[36:39], v[84:87]
    ds_read_b128 v[60:63], v17 offset:35840
    v_lshlrev_b32 v1, 3, v1
    v_mfma_f32_16x16x32_bf16 v[84:87], a[244:247], v[32:35], v[84:87]
    s_waitcnt vmcnt(7) lgkmcnt(1)
    s_barrier
    v_mov_b32 v148, 0
    v_lshrrev_b32 v1, v1, s4
    v_mfma_f32_16x16x32_bf16 v[92:95], a[244:247], v[40:43], v[92:95]
    s_add_u32 m0, s10, 65568
    ds_read_b128 v[32:35], v16 offset:0
    v_bfe_u32 v31, v1, 1, 1
    v_mfma_f32_16x16x32_bf16 v[92:95], a[252:255], v[44:47], v[92:95]
    buffer_load_dwordx4 v21, s[60:63], s12 offen lds
    ds_read_b64_tr_b16 v[188:189], v12 offset:49152
    v_mfma_f32_16x16x32_bf16 v[88:91], a[248:251], v[44:47], v[88:91]
    ds_read_b128 v[36:39], v16 offset:3072
    v_bfe_u32 v253, v1, 0, 1
    v_mfma_f32_16x16x32_bf16 v[88:91], a[240:243], v[40:43], v[88:91]
    ds_read_b64_tr_b16 v[190:191], v12 offset:50176
    v_lshl_or_b32 v253, v31, 16, v253
    v_mfma_f32_16x16x32_bf16 v[96:99], a[240:243], v[48:51], v[96:99]
    ds_read_b128 v[40:43], v16 offset:1024
    v_bfe_u32 v31, v1, 3, 1
    v_mfma_f32_16x16x32_bf16 v[96:99], a[248:251], v[52:55], v[96:99]
    v_bfe_u32 v255, v1, 2, 1
    v_mfma_f32_16x16x32_bf16 v[100:103], a[252:255], v[52:55], v[100:103]
    ds_read_b128 v[44:47], v16 offset:4096
    v_mov_b32 v149, 0
    v_mfma_f32_16x16x32_bf16 v[100:103], a[244:247], v[48:51], v[100:103]
    s_waitcnt lgkmcnt(6)
    ds_read_b64_tr_b16 v[192:193], v13 offset:49152
    v_lshl_or_b32 v255, v31, 16, v255
    v_mfma_f32_16x16x32_bf16 v[108:111], a[244:247], v[56:59], v[108:111]
    ds_read_b128 v[48:51], v16 offset:2048
    v_bfe_u32 v31, v1, 5, 1
    v_mfma_f32_16x16x32_bf16 v[108:111], a[252:255], v[60:63], v[108:111]
    ds_read_b64_tr_b16 v[194:195], v13 offset:50176
    v_mfma_f32_16x16x32_bf16 v[104:107], a[248:251], v[60:63], v[104:107]
    ds_read_b128 v[52:55], v16 offset:5120
    v_bfe_u32 v23, v1, 4, 1
    v_mfma_f32_16x16x32_bf16 v[104:107], a[240:243], v[56:59], v[104:107]
    s_waitcnt lgkmcnt(7)
    v_lshl_or_b32 v23, v31, 16, v23
    v_mfma_f32_16x16x32_bf16 v[112:115], a[0:3], v[32:35], 0
    ds_read_b128 v[56:59], v16 offset:6144
    v_bfe_u32 v31, v1, 7, 1
    v_mfma_f32_16x16x32_bf16 v[112:115], a[8:11], v[36:39], v[112:115]
    ds_read_b64_tr_b16 v[196:197], v12 offset:57344
    v_lshlrev_b32 v150, 3, v2
    v_mfma_f32_16x16x32_bf16 v[116:119], a[12:15], v[36:39], 0
    ds_read_b128 v[60:63], v16 offset:9216
    v_bfe_u32 v0, v1, 6, 1
    v_mfma_f32_16x16x32_bf16 v[116:119], a[4:7], v[32:35], v[116:119]
    s_waitcnt lgkmcnt(7)
    ds_read_b64_tr_b16 v[198:199], v12 offset:58368
    v_lshl_or_b32 v0, v31, 16, v0
    v_mfma_f32_16x16x32_bf16 v[124:127], a[4:7], v[40:43], 0
    ds_read_b128 v[32:35], v16 offset:7168
    v_add_u32 v150, 69664, v150
    v_mfma_f32_16x16x32_bf16 v[124:127], a[12:15], v[44:47], v[124:127]
    v_cvt_pk_bf16_f32 v64, v64, v65
    v_cvt_pk_bf16_f32 v65, v66, v67
    v_mfma_f32_16x16x32_bf16 v[120:123], a[8:11], v[44:47], 0
    ds_read_b128 v[36:39], v16 offset:10240
    v_cvt_pk_bf16_f32 v66, v68, v69
    v_mfma_f32_16x16x32_bf16 v[120:123], a[0:3], v[40:43], v[120:123]
    s_waitcnt lgkmcnt(6)
    ds_read_b64_tr_b16 v[200:201], v13 offset:57344
    v_cvt_pk_bf16_f32 v67, v70, v71
    v_mfma_f32_16x16x32_bf16 v[128:131], a[0:3], v[48:51], 0
    s_add_u32 m0, s21, 49152
    ds_read_b128 v[40:43], v16 offset:8192
    v_bfi_b32 v64, s33, v253, v64
    v_mfma_f32_16x16x32_bf16 v[128:131], a[8:11], v[52:55], v[128:131]
    buffer_load_dwordx4 v18, s[44:47], s76 offen offset:0 sc1 lds
    ds_read_b64_tr_b16 v[202:203], v13 offset:58368
    v_mfma_f32_16x16x32_bf16 v[132:135], a[12:15], v[52:55], 0
    ds_read_b128 v[44:47], v16 offset:11264
    v_bfi_b32 v65, s33, v255, v65
    v_mfma_f32_16x16x32_bf16 v[132:135], a[4:7], v[48:51], v[132:135]
    s_waitcnt lgkmcnt(1)
    s_barrier
    v_bfi_b32 v66, s33, v23, v66
    v_bfi_b32 v67, s33, v0, v67
    v_mfma_f32_16x16x32_bf16 v[116:119], a[20:23], v[56:59], v[116:119]
    ds_read_b128 v[48:51], v16 offset:12288
    v_cvt_pk_bf16_f32 v72, v72, v73
    v_cvt_pk_bf16_f32 v73, v74, v75
    v_mfma_f32_16x16x32_bf16 v[116:119], a[28:31], v[60:63], v[116:119]
    buffer_load_dwordx4 v19, s[44:47], s76 offen offset:1024 sc1 lds
    buffer_store_dwordx4 v[64:67], v21, s[44:47], s42 offen offset:0 sc1
    v_cvt_pk_bf16_f32 v74, v76, v77
    v_mfma_f32_16x16x32_bf16 v[112:115], a[24:27], v[60:63], v[112:115]
    ds_read_b128 v[52:55], v16 offset:15360
    v_cvt_pk_bf16_f32 v75, v78, v79
    v_bfi_b32 v72, s33, v253, v72
    v_mfma_f32_16x16x32_bf16 v[112:115], a[16:19], v[56:59], v[112:115]
    buffer_load_dwordx4 v20, s[44:47], s76 offen offset:2048 sc1 lds
    v_bfi_b32 v73, s33, v255, v73
L_pl_G_3:
    s_cbranch_execz L_wret
    v_mfma_f32_16x16x32_bf16 v[120:123], a[16:19], v[32:35], v[120:123]
    s_add_u32 m0, s21, 61440
    ds_read_b128 v[56:59], v16 offset:13312
    v_bfi_b32 v74, s33, v23, v74
    v_bfi_b32 v75, s33, v0, v75
    v_mfma_f32_16x16x32_bf16 v[120:123], a[24:27], v[36:39], v[120:123]
    buffer_load_dwordx4 v18, s[44:47], s78 offen offset:0 sc1 lds
    v_cvt_pk_bf16_f32 v80, v80, v81
    v_cvt_pk_bf16_f32 v81, v82, v83
    v_mfma_f32_16x16x32_bf16 v[124:127], a[28:31], v[36:39], v[124:127]
    ds_read_b128 v[60:63], v16 offset:16384
    buffer_store_dwordx4 v[72:75], v21, s[44:47], s42 offen offset:1024 sc1
    v_cvt_pk_bf16_f32 v82, v84, v85
    v_mfma_f32_16x16x32_bf16 v[124:127], a[20:23], v[32:35], v[124:127]
    s_waitcnt lgkmcnt(4)
    buffer_load_dwordx4 v19, s[44:47], s78 offen offset:1024 sc1 lds
    v_cvt_pk_bf16_f32 v83, v86, v87
    v_bfi_b32 v80, s33, v253, v80
    v_mfma_f32_16x16x32_bf16 v[132:135], a[20:23], v[40:43], v[132:135]
    ds_read_b128 v[32:35], v16 offset:14336
    v_bfi_b32 v81, s33, v255, v81
    v_mfma_f32_16x16x32_bf16 v[132:135], a[28:31], v[44:47], v[132:135]
    v_bfi_b32 v82, s33, v23, v82
    v_bfi_b32 v83, s33, v0, v83
    v_mfma_f32_16x16x32_bf16 v[128:131], a[24:27], v[44:47], v[128:131]
    ds_read_b128 v[36:39], v16 offset:17408
    v_mfma_f32_16x16x32_bf16 v[128:131], a[16:19], v[40:43], v[128:131]
    s_waitcnt lgkmcnt(4)
    buffer_store_dwordx4 v[80:83], v21, s[44:47], s42 offen offset:2048 sc1
    v_mfma_f32_16x16x32_bf16 v[112:115], a[32:35], v[48:51], v[112:115]
    ds_read_b128 v[40:43], v16 offset:18432
    v_mfma_f32_16x16x32_bf16 v[112:115], a[40:43], v[52:55], v[112:115]
    buffer_load_dwordx4 v20, s[44:47], s78 offen offset:2048 sc1 lds
    v_mfma_f32_16x16x32_bf16 v[116:119], a[44:47], v[52:55], v[116:119]
    s_add_u32 m0, s20, 0
    ds_read_b128 v[44:47], v16 offset:21504
    s_lshl_b32 s14, s87, 1
    v_mfma_f32_16x16x32_bf16 v[116:119], a[36:39], v[48:51], v[116:119]
    s_waitcnt lgkmcnt(4)
    buffer_load_dwordx4 v8, s[52:55], s14 offen offset:0 lds
    v_mfma_f32_16x16x32_bf16 v[124:127], a[36:39], v[56:59], v[124:127]
    ds_read_b128 v[48:51], v16 offset:19456
    v_mfma_f32_16x16x32_bf16 v[124:127], a[44:47], v[60:63], v[124:127]
    ds_write_b64 v150, v[148:149]
    v_mfma_f32_16x16x32_bf16 v[120:123], a[40:43], v[60:63], v[120:123]
    ds_read_b128 v[52:55], v16 offset:22528
    v_bfe_u32 v150, v2, 3, 1
    v_mfma_f32_16x16x32_bf16 v[120:123], a[32:35], v[56:59], v[120:123]
    s_waitcnt lgkmcnt(5)
    v_mul_u32_u24 v150, 8736, v150
    v_mfma_f32_16x16x32_bf16 v[128:131], a[32:35], v[32:35], v[128:131]
    ds_read_b128 v[56:59], v16 offset:20480
    v_mfma_f32_16x16x32_bf16 v[128:131], a[40:43], v[36:39], v[128:131]
    v_mfma_f32_16x16x32_bf16 v[132:135], a[44:47], v[36:39], v[132:135]
    ds_read_b128 v[60:63], v16 offset:23552
    v_mfma_f32_16x16x32_bf16 v[132:135], a[36:39], v[32:35], v[132:135]
    s_waitcnt vmcnt(15) lgkmcnt(5)
    s_barrier
    v_and_b32 v151, 7, v2
    v_mfma_f32_16x16x32_bf16 v[116:119], a[52:55], v[40:43], v[116:119]
    ds_read_b128 v[32:35], v16 offset:24576
    v_mfma_f32_16x16x32_bf16 v[116:119], a[60:63], v[44:47], v[116:119]
    v_mfma_f32_16x16x32_bf16 v[112:115], a[56:59], v[44:47], v[112:115]
    ds_read_b128 v[36:39], v16 offset:27648
    v_mfma_f32_16x16x32_bf16 v[112:115], a[48:51], v[40:43], v[112:115]
    s_waitcnt lgkmcnt(4)
    v_mfma_f32_16x16x32_bf16 v[120:123], a[48:51], v[48:51], v[120:123]
    ds_read_b128 v[40:43], v16 offset:25600
    v_mfma_f32_16x16x32_bf16 v[120:123], a[56:59], v[52:55], v[120:123]
    v_lshl_add_u32 v150, v151, 2, v150
    v_mfma_f32_16x16x32_bf16 v[124:127], a[60:63], v[52:55], v[124:127]
    ds_read_b128 v[44:47], v16 offset:28672
    v_mfma_f32_16x16x32_bf16 v[124:127], a[52:55], v[48:51], v[124:127]
    s_waitcnt lgkmcnt(4)
    v_mfma_f32_16x16x32_bf16 v[132:135], a[52:55], v[56:59], v[132:135]
    ds_read_b128 v[48:51], v16 offset:26624
    v_mfma_f32_16x16x32_bf16 v[132:135], a[60:63], v[60:63], v[132:135]
    v_mfma_f32_16x16x32_bf16 v[128:131], a[56:59], v[60:63], v[128:131]
    ds_read_b128 v[52:55], v16 offset:29696
    v_mfma_f32_16x16x32_bf16 v[128:131], a[48:51], v[56:59], v[128:131]
    s_waitcnt lgkmcnt(4)
    v_mfma_f32_16x16x32_bf16 v[112:115], a[64:67], v[32:35], v[112:115]
    s_add_u32 s9, s43, 3072
    ds_read_b128 v[56:59], v16 offset:30720
    v_add_u32 v150, 65536, v150
    v_mfma_f32_16x16x32_bf16 v[112:115], a[72:75], v[36:39], v[112:115]
    ds_write_b32 v150, v148
    v_mfma_f32_16x16x32_bf16 v[116:119], a[76:79], v[36:39], v[116:119]
    ds_read_b128 v[60:63], v16 offset:33792
    v_mfma_f32_16x16x32_bf16 v[116:119], a[68:71], v[32:35], v[116:119]
    s_waitcnt lgkmcnt(5)
    buffer_load_dwordx4 v9, s[52:55], s14 offen offset:1024 lds
    v_mfma_f32_16x16x32_bf16 v[124:127], a[68:71], v[40:43], v[124:127]
    ds_read_b128 v[32:35], v16 offset:31744
    v_mfma_f32_16x16x32_bf16 v[124:127], a[76:79], v[44:47], v[124:127]
    buffer_load_dwordx4 v10, s[52:55], s14 offen offset:2048 lds
    v_mfma_f32_16x16x32_bf16 v[120:123], a[72:75], v[44:47], v[120:123]
    ds_read_b128 v[36:39], v16 offset:34816
    v_mfma_f32_16x16x32_bf16 v[120:123], a[64:67], v[40:43], v[120:123]
    s_waitcnt lgkmcnt(5)
    buffer_load_dwordx4 v11, s[52:55], s14 offen offset:3072 lds
    v_mfma_f32_16x16x32_bf16 v[128:131], a[64:67], v[48:51], v[128:131]
    s_add_u32 m0, s21, 0
    ds_read_b128 v[40:43], v16 offset:32768
    v_mfma_f32_16x16x32_bf16 v[128:131], a[72:75], v[52:55], v[128:131]
    buffer_load_dwordx4 v18, s[44:47], s80 offen offset:0 sc1 lds
    v_mfma_f32_16x16x32_bf16 v[132:135], a[76:79], v[52:55], v[132:135]
    ds_read_b128 v[44:47], v16 offset:35840
    v_mfma_f32_16x16x32_bf16 v[132:135], a[68:71], v[48:51], v[132:135]
    s_waitcnt vmcnt(14) lgkmcnt(4)
    s_barrier
    v_mfma_f32_16x16x32_bf16 v[116:119], a[84:87], v[56:59], v[116:119]
    s_add_u32 s12, s10, 65568
    ds_read_b128 v[48:51], v17 offset:0
    v_add_u32 v136, s12, v21
    v_mfma_f32_16x16x32_bf16 v[116:119], a[92:95], v[60:63], v[116:119]
    buffer_load_dwordx4 v19, s[44:47], s80 offen offset:1024 sc1 lds
    ds_read_b128 v[138:141], v136
    v_mfma_f32_16x16x32_bf16 v[112:115], a[88:91], v[60:63], v[112:115]
    ds_read_b128 v[52:55], v17 offset:3072
    v_mfma_f32_16x16x32_bf16 v[112:115], a[80:83], v[56:59], v[112:115]
    s_waitcnt lgkmcnt(5)
    buffer_load_dwordx4 v20, s[44:47], s80 offen offset:2048 sc1 lds
    v_cvt_pk_bf16_f32 v88, v88, v89
    v_mfma_f32_16x16x32_bf16 v[120:123], a[80:83], v[32:35], v[120:123]
    ds_read_b128 v[56:59], v17 offset:1024
    v_mfma_f32_16x16x32_bf16 v[120:123], a[88:91], v[36:39], v[120:123]
    ds_read_b32 v142, v136 offset:16
    v_lshrrev_b32 v137, 30, v25
    v_mfma_f32_16x16x32_bf16 v[124:127], a[92:95], v[36:39], v[124:127]
    ds_read_b128 v[60:63], v17 offset:4096
    v_cvt_pk_bf16_f32 v89, v90, v91
    v_mfma_f32_16x16x32_bf16 v[124:127], a[84:87], v[32:35], v[124:127]
    s_waitcnt lgkmcnt(6)
    v_mul_u32_u24 v137, 28, v137
    v_sub_u32 v137, 65568, v137
    v_mfma_f32_16x16x32_bf16 v[132:135], a[84:87], v[40:43], v[132:135]
    ds_read_b128 v[32:35], v17 offset:2048
    v_lshlrev_b32 v30, 16, v30
    v_mfma_f32_16x16x32_bf16 v[132:135], a[92:95], v[44:47], v[132:135]
    s_waitcnt lgkmcnt(2)
    v_cvt_pk_bf16_f32 v90, v92, v93
    v_lshlrev_b32 v143, 16, v138
    v_mfma_f32_16x16x32_bf16 v[128:131], a[88:91], v[44:47], v[128:131]
    ds_read_b128 v[36:39], v17 offset:5120
    v_add_f32 v143, v143, v30
    v_mfma_f32_16x16x32_bf16 v[128:131], a[80:83], v[40:43], v[128:131]
    v_alignbit_b32 v138, v139, v138, 16
    v_alignbit_b32 v139, v140, v139, 16
    v_mfma_f32_16x16x32_bf16 v[112:115], a[96:99], v[48:51], v[112:115]
    ds_read_b128 v[40:43], v17 offset:6144
    v_cvt_pk_bf16_f32 v91, v94, v95
    v_mfma_f32_16x16x32_bf16 v[112:115], a[104:107], v[52:55], v[112:115]
    v_alignbit_b32 v140, v141, v140, 16
    v_alignbit_b32 v141, v142, v141, 16
    v_mfma_f32_16x16x32_bf16 v[116:119], a[108:111], v[52:55], v[116:119]
    ds_read_b128 v[44:47], v17 offset:9216
    v_cvt_pk_bf16_f32 v143, v143, v143
    v_mfma_f32_16x16x32_bf16 v[116:119], a[100:103], v[48:51], v[116:119]
    s_waitcnt lgkmcnt(4)
    v_bfi_b32 v88, s33, v253, v88
    ds_write_b128 v136, v[138:141] offset:8736
    v_mfma_f32_16x16x32_bf16 v[124:127], a[100:103], v[56:59], v[124:127]
    s_add_u32 m0, s21, 12288
    ds_read_b128 v[48:51], v17 offset:7168
    v_cmp_eq_u32 vcc, 0, v25
    s_nop 1
    v_cndmask_b32 v143, 0, v143, vcc
    v_mfma_f32_16x16x32_bf16 v[124:127], a[108:111], v[60:63], v[124:127]
    buffer_load_dwordx4 v18, s[44:47], s82 offen offset:0 sc1 lds
    ds_write_b16 v137, v143
    v_mfma_f32_16x16x32_bf16 v[120:123], a[104:107], v[60:63], v[120:123]
    ds_read_b128 v[52:55], v17 offset:10240
    v_bfi_b32 v89, s33, v255, v89
    v_mfma_f32_16x16x32_bf16 v[120:123], a[96:99], v[56:59], v[120:123]
    s_waitcnt lgkmcnt(6)
    buffer_load_dwordx4 v19, s[44:47], s82 offen offset:1024 sc1 lds
    ds_write_b16 v137, v143 offset:8734
    v_mfma_f32_16x16x32_bf16 v[128:131], a[96:99], v[32:35], v[128:131]
    ds_read_b128 v[56:59], v17 offset:8192
    v_mfma_f32_16x16x32_bf16 v[128:131], a[104:107], v[36:39], v[128:131]
    buffer_load_dwordx4 v20, s[44:47], s82 offen offset:2048 sc1 lds
    v_bfi_b32 v90, s33, v23, v90
    v_mfma_f32_16x16x32_bf16 v[132:135], a[108:111], v[36:39], v[132:135]
    ds_read_b128 v[60:63], v17 offset:11264
    v_mfma_f32_16x16x32_bf16 v[132:135], a[100:103], v[32:35], v[132:135]
    s_waitcnt vmcnt(15) lgkmcnt(2)
    s_barrier
    v_and_b32 v1, 15, v2
    v_lshrrev_b32 v31, 4, v2
    v_mfma_f32_16x16x32_bf16 v[116:119], a[116:119], v[40:43], v[116:119]
    s_add_u32 m0, s21, 24576
    ds_read_b128 v[32:35], v17 offset:12288
    s_bfe_u32 s14, s31, 0x30009
    s_lshl_b32 s14, s14, 8
    s_add_u32 s14, s14, s17
    v_add_u32 v18, s14, v22
    v_mfma_f32_16x16x32_bf16 v[116:119], a[124:127], v[44:47], v[116:119]
    buffer_load_dwordx4 v18, s[44:47], s68 offen offset:0 sc1 lds
    v_bfi_b32 v91, s33, v0, v91
    v_mfma_f32_16x16x32_bf16 v[112:115], a[120:123], v[44:47], v[112:115]
    s_add_u32 s42, s42, 3072
    ds_read_b128 v[36:39], v17 offset:15360
    v_cvt_pk_bf16_f32 v96, v96, v97
    v_mfma_f32_16x16x32_bf16 v[112:115], a[112:115], v[40:43], v[112:115]
    buffer_store_dwordx4 v[88:91], v21, s[44:47], s42 offen offset:0 sc1
    v_mfma_f32_16x16x32_bf16 v[120:123], a[112:115], v[48:51], v[120:123]
    s_bfe_u32 s14, s31, 0x3000c
    ds_read_b128 v[40:43], v17 offset:13312
    s_lshl_b32 s14, s14, 8
    s_add_u32 s14, s14, s17
    s_sub_u32 s14, s14, 1024
    v_add_u32 v19, s14, v22
    v_mfma_f32_16x16x32_bf16 v[120:123], a[120:123], v[52:55], v[120:123]
    buffer_load_dwordx4 v19, s[44:47], s68 offen offset:1024 sc1 lds
    v_cvt_pk_bf16_f32 v97, v98, v99
    v_mfma_f32_16x16x32_bf16 v[124:127], a[124:127], v[52:55], v[124:127]
    s_bfe_u32 s14, s31, 0x3000f
    ds_read_b128 v[44:47], v17 offset:16384
    s_lshl_b32 s14, s14, 8
    s_add_u32 s14, s14, s17
    s_sub_u32 s14, s14, 2048
    v_add_u32 v20, s14, v22
    v_mfma_f32_16x16x32_bf16 v[124:127], a[116:119], v[48:51], v[124:127]
    s_waitcnt lgkmcnt(4)
    buffer_load_dwordx4 v20, s[44:47], s68 offen offset:2048 sc1 lds
    v_lshlrev_b32 v3, 1, v1
    v_mfma_f32_16x16x32_bf16 v[132:135], a[116:119], v[56:59], v[132:135]
    s_add_u32 m0, s20, 16384
    ds_read_b128 v[48:51], v17 offset:14336
    s_lshl_b32 s14, s88, 1
    v_mfma_f32_16x16x32_bf16 v[132:135], a[124:127], v[60:63], v[132:135]
    buffer_load_dwordx4 v8, s[52:55], s14 offen offset:0 lds
    v_cvt_pk_bf16_f32 v98, v100, v101
    v_mfma_f32_16x16x32_bf16 v[128:131], a[120:123], v[60:63], v[128:131]
    ds_read_b128 v[52:55], v17 offset:17408
    v_sub_u32 v3, v3, v31
    v_mfma_f32_16x16x32_bf16 v[128:131], a[112:115], v[56:59], v[128:131]
    s_waitcnt lgkmcnt(4)
    s_lshl_b32 s4, s3, 7
    buffer_load_dwordx4 v9, s[52:55], s14 offen offset:1024 lds
    v_cvt_pk_bf16_f32 v99, v102, v103
    v_mfma_f32_16x16x32_bf16 v[112:115], a[128:131], v[32:35], v[112:115]
    s_sub_u32 s4, 70128, s4
    ds_read_b128 v[56:59], v17 offset:18432
    v_mfma_f32_16x16x32_bf16 v[112:115], a[136:139], v[36:39], v[112:115]
    buffer_load_dwordx4 v10, s[52:55], s14 offen offset:2048 lds
    v_mfma_f32_16x16x32_bf16 v[116:119], a[140:143], v[36:39], v[116:119]
    ds_read_b128 v[60:63], v17 offset:21504
    v_bfi_b32 v96, s33, v253, v96
    v_mfma_f32_16x16x32_bf16 v[116:119], a[132:135], v[32:35], v[116:119]
    s_waitcnt lgkmcnt(4)
    v_lshl_add_u32 v30, v3, 4, s4
    v_mfma_f32_16x16x32_bf16 v[124:127], a[132:135], v[40:43], v[124:127]
    ds_read_b128 v[32:35], v17 offset:19456
    v_and_b32 v1, 15, v2
    v_mfma_f32_16x16x32_bf16 v[124:127], a[140:143], v[44:47], v[124:127]
    buffer_load_dwordx4 v11, s[52:55], s14 offen offset:3072 lds
    v_bfi_b32 v97, s33, v255, v97
    v_mfma_f32_16x16x32_bf16 v[120:123], a[136:139], v[44:47], v[120:123]
    ds_read_b128 v[36:39], v17 offset:22528
    v_mfma_f32_16x16x32_bf16 v[120:123], a[128:131], v[40:43], v[120:123]
    s_waitcnt lgkmcnt(4)
    v_bfi_b32 v98, s33, v23, v98
    v_add_u32 v1, 1, v1
    v_mfma_f32_16x16x32_bf16 v[128:131], a[128:131], v[48:51], v[128:131]
    s_add_u32 m0, s20, 32768
    ds_read_b128 v[40:43], v17 offset:20480
    s_lshl_b32 s14, s89, 1
    v_mfma_f32_16x16x32_bf16 v[128:131], a[136:139], v[52:55], v[128:131]
    buffer_load_dwordx4 v8, s[52:55], s14 offen offset:0 lds
    v_and_b32 v3, 1, v1
    v_mfma_f32_16x16x32_bf16 v[132:135], a[140:143], v[52:55], v[132:135]
    ds_read_b128 v[44:47], v17 offset:23552
    v_bfi_b32 v99, s33, v0, v99
    v_mfma_f32_16x16x32_bf16 v[132:135], a[132:135], v[48:51], v[132:135]
    s_waitcnt vmcnt(15) lgkmcnt(4)
    s_barrier
    v_cvt_pk_bf16_f32 v104, v104, v105
    v_mfma_f32_16x16x32_bf16 v[116:119], a[148:151], v[56:59], v[116:119]
    ds_read_b128 v[48:51], v17 offset:24576
    v_mul_u32_u24 v3, 8736, v3
    v_mfma_f32_16x16x32_bf16 v[116:119], a[156:159], v[60:63], v[116:119]
    ds_read_b64_tr_b16 v[204:205], v12 offset:0
    buffer_store_dwordx4 v[96:99], v21, s[44:47], s42 offen offset:1024 sc1
    v_mfma_f32_16x16x32_bf16 v[112:115], a[152:155], v[60:63], v[112:115]
    ds_read_b128 v[52:55], v17 offset:27648
    v_cvt_pk_bf16_f32 v105, v106, v107
    v_mfma_f32_16x16x32_bf16 v[112:115], a[144:147], v[56:59], v[112:115]
    s_waitcnt lgkmcnt(5)
    ds_read_b64_tr_b16 v[206:207], v12 offset:1024
    v_cvt_pk_bf16_f32 v106, v108, v109
    v_mfma_f32_16x16x32_bf16 v[120:123], a[144:147], v[32:35], v[120:123]
    ds_read_b128 v[56:59], v17 offset:25600
    v_lshrrev_b32 v1, 1, v1
    v_mfma_f32_16x16x32_bf16 v[120:123], a[152:155], v[36:39], v[120:123]
    v_cvt_pk_bf16_f32 v107, v110, v111
    v_lshl_add_u32 v3, v1, 2, v3
    v_mfma_f32_16x16x32_bf16 v[124:127], a[156:159], v[36:39], v[124:127]
    ds_read_b128 v[60:63], v17 offset:28672
    v_bfi_b32 v104, s33, v253, v104
    v_mfma_f32_16x16x32_bf16 v[124:127], a[148:151], v[32:35], v[124:127]
    s_waitcnt lgkmcnt(6)
    ds_read_b64_tr_b16 v[208:209], v13 offset:0
    v_lshrrev_b32 v1, 4, v2
    v_mfma_f32_16x16x32_bf16 v[132:135], a[148:151], v[40:43], v[132:135]
    ds_read_b128 v[32:35], v17 offset:26624
    v_bfi_b32 v105, s33, v255, v105
    v_mfma_f32_16x16x32_bf16 v[132:135], a[156:159], v[44:47], v[132:135]
    ds_read_b64_tr_b16 v[210:211], v13 offset:1024
    v_lshl_add_u32 v3, v1, 4, v3
    v_mfma_f32_16x16x32_bf16 v[128:131], a[152:155], v[44:47], v[128:131]
    ds_read_b128 v[36:39], v17 offset:29696
    v_bfi_b32 v106, s33, v23, v106
    v_mfma_f32_16x16x32_bf16 v[128:131], a[144:147], v[40:43], v[128:131]
    s_waitcnt lgkmcnt(7)
    v_mfma_f32_16x16x32_bf16 v[112:115], a[160:163], v[48:51], v[112:115]
    s_lshl_b32 s4, s3, 7
    ds_read_b128 v[40:43], v17 offset:30720
    v_bfi_b32 v107, s33, v0, v107
    v_mfma_f32_16x16x32_bf16 v[112:115], a[168:171], v[52:55], v[112:115]
    ds_read_b64_tr_b16 v[212:213], v12 offset:8192
    v_mfma_f32_16x16x32_bf16 v[116:119], a[172:175], v[52:55], v[116:119]
    ds_read_b128 v[44:47], v17 offset:33792
    buffer_load_dwordx4 v[136:139], v21, s[44:47], s43 offen offset:0 sc1
    v_mfma_f32_16x16x32_bf16 v[116:119], a[164:167], v[48:51], v[116:119]
    s_waitcnt lgkmcnt(7)
    s_add_u32 s4, s4, 65536
    buffer_load_dwordx4 v9, s[52:55], s14 offen offset:1024 lds
    ds_read_b64_tr_b16 v[214:215], v12 offset:9216
    v_mfma_f32_16x16x32_bf16 v[124:127], a[164:167], v[56:59], v[124:127]
    ds_read_b128 v[48:51], v17 offset:31744
    v_mfma_f32_16x16x32_bf16 v[124:127], a[172:175], v[60:63], v[124:127]
    buffer_load_dwordx4 v10, s[52:55], s14 offen offset:2048 lds
    v_add_u32 v4, s4, v3
    v_mfma_f32_16x16x32_bf16 v[120:123], a[168:171], v[60:63], v[120:123]
    ds_read_b128 v[52:55], v17 offset:34816
    buffer_load_dwordx4 v[140:143], v21, s[44:47], s43 offen offset:1024 sc1
    v_mfma_f32_16x16x32_bf16 v[120:123], a[160:163], v[56:59], v[120:123]
    s_waitcnt lgkmcnt(6)
    buffer_load_dwordx4 v11, s[52:55], s14 offen offset:3072 lds
    ds_read_b64_tr_b16 v[216:217], v13 offset:8192
    v_mfma_f32_16x16x32_bf16 v[128:131], a[160:163], v[32:35], v[128:131]
    s_add_u32 m0, s21, 36864
    ds_read_b128 v[56:59], v17 offset:32768
    buffer_load_dwordx4 v[108:111], v21, s[44:47], s43 offen offset:2048 sc1
    v_mfma_f32_16x16x32_bf16 v[128:131], a[168:171], v[36:39], v[128:131]
    buffer_load_dwordx4 v18, s[44:47], s70 offen offset:0 sc1 lds
    ds_read_b64_tr_b16 v[218:219], v13 offset:9216
    v_mfma_f32_16x16x32_bf16 v[132:135], a[172:175], v[36:39], v[132:135]
    ds_read_b128 v[60:63], v17 offset:35840
    v_add_u32 v5, 1024, v4
    v_mfma_f32_16x16x32_bf16 v[132:135], a[164:167], v[32:35], v[132:135]
    s_waitcnt vmcnt(9) lgkmcnt(1)
    s_barrier
    v_add_u32 v6, 1024, v5
    v_mfma_f32_16x16x32_bf16 v[116:119], a[180:183], v[40:43], v[116:119]
    ds_read_b128 v[32:35], v16 offset:0
    v_add_u32 v7, 1024, v6
    v_mfma_f32_16x16x32_bf16 v[116:119], a[188:191], v[44:47], v[116:119]
    buffer_load_dwordx4 v19, s[44:47], s70 offen offset:1024 sc1 lds
    ds_read_b64_tr_b16 v[220:221], v12 offset:16384
    v_mfma_f32_16x16x32_bf16 v[112:115], a[184:187], v[44:47], v[112:115]
    ds_read_b128 v[36:39], v16 offset:3072
    buffer_store_dwordx4 v[104:107], v21, s[44:47], s42 offen offset:2048 sc1
    v_mfma_f32_16x16x32_bf16 v[112:115], a[176:179], v[40:43], v[112:115]
    buffer_load_dwordx4 v20, s[44:47], s70 offen offset:2048 sc1 lds
    ds_read_b64_tr_b16 v[222:223], v12 offset:17408
    v_mfma_f32_16x16x32_bf16 v[120:123], a[176:179], v[48:51], v[120:123]
    ds_read_b128 v[40:43], v16 offset:1024
    v_and_b32 v1, 15, v2
    v_mfma_f32_16x16x32_bf16 v[120:123], a[184:187], v[52:55], v[120:123]
    v_mfma_f32_16x16x32_bf16 v[124:127], a[188:191], v[52:55], v[124:127]
    s_add_u32 m0, s21, 49152
    ds_read_b128 v[44:47], v16 offset:4096
    v_lshrrev_b32 v31, 4, v2
    v_mfma_f32_16x16x32_bf16 v[124:127], a[180:183], v[48:51], v[124:127]
    s_waitcnt lgkmcnt(6)
    buffer_load_dwordx4 v18, s[44:47], s72 offen offset:0 sc1 lds
    ds_read_b64_tr_b16 v[224:225], v13 offset:16384
    v_mfma_f32_16x16x32_bf16 v[132:135], a[180:183], v[56:59], v[132:135]
    ds_read_b128 v[48:51], v16 offset:2048
    v_lshlrev_b32 v31, 2, v31
    v_mfma_f32_16x16x32_bf16 v[132:135], a[188:191], v[60:63], v[132:135]
    buffer_load_dwordx4 v19, s[44:47], s72 offen offset:1024 sc1 lds
    ds_read_b64_tr_b16 v[226:227], v13 offset:17408
    v_mfma_f32_16x16x32_bf16 v[128:131], a[184:187], v[60:63], v[128:131]
    ds_read_b128 v[52:55], v16 offset:5120
    v_sub_u32 v1, v1, v31
    v_mfma_f32_16x16x32_bf16 v[128:131], a[176:179], v[56:59], v[128:131]
    s_waitcnt lgkmcnt(7)
    v_mfma_f32_16x16x32_bf16 v[112:115], a[192:195], v[32:35], v[112:115]
    ds_read_b128 v[56:59], v16 offset:6144
    v_mfma_f32_16x16x32_bf16 v[112:115], a[200:203], v[36:39], v[112:115]
    ds_read_b64_tr_b16 v[228:229], v12 offset:24576
    v_and_b32 v31, 1, v1
    v_mfma_f32_16x16x32_bf16 v[116:119], a[204:207], v[36:39], v[116:119]
    ds_read_b128 v[60:63], v16 offset:9216
    v_mfma_f32_16x16x32_bf16 v[116:119], a[196:199], v[32:35], v[116:119]
    s_waitcnt lgkmcnt(7)
    ds_read_b64_tr_b16 v[230:231], v12 offset:25600
    v_lshlrev_b32 v31, 4, v31
    v_mfma_f32_16x16x32_bf16 v[124:127], a[196:199], v[40:43], v[124:127]
    ds_read_b128 v[32:35], v16 offset:7168
    v_mfma_f32_16x16x32_bf16 v[124:127], a[204:207], v[44:47], v[124:127]
    s_movk_i32 s4, 0x3f80
    buffer_load_dwordx4 v20, s[44:47], s72 offen offset:2048 sc1 lds
    v_mfma_f32_16x16x32_bf16 v[120:123], a[200:203], v[44:47], v[120:123]
    s_add_u32 m0, s20, 49152
    ds_read_b128 v[36:39], v16 offset:10240
    s_lshl_b32 s14, s90, 1
    v_mfma_f32_16x16x32_bf16 v[120:123], a[192:195], v[40:43], v[120:123]
    s_waitcnt lgkmcnt(6)
    buffer_load_dwordx4 v8, s[52:55], s14 offen offset:0 lds
    ds_read_b64_tr_b16 v[232:233], v13 offset:24576
    v_mfma_f32_16x16x32_bf16 v[128:131], a[192:195], v[48:51], v[128:131]
    ds_read_b128 v[40:43], v16 offset:8192
    v_lshlrev_b32 v31, v31, s4
    v_mfma_f32_16x16x32_bf16 v[128:131], a[200:203], v[52:55], v[128:131]
    ds_read_b64_tr_b16 v[234:235], v13 offset:25600
    v_mfma_f32_16x16x32_bf16 v[132:135], a[204:207], v[52:55], v[132:135]
    ds_read_b128 v[44:47], v16 offset:11264
    v_ashrrev_i32 v1, 1, v1
    v_mfma_f32_16x16x32_bf16 v[132:135], a[196:199], v[48:51], v[132:135]
    s_waitcnt vmcnt(9) lgkmcnt(1)
    s_barrier
    v_cmp_eq_u32 vcc, 0, v1
    s_nop 1
    v_cndmask_b32 v148, 0, v31, vcc
    v_mfma_f32_16x16x32_bf16 v[116:119], a[212:215], v[56:59], v[116:119]
    ds_read_b128 v[48:51], v16 offset:12288
    v_mfma_f32_16x16x32_bf16 v[116:119], a[220:223], v[60:63], v[116:119]
    buffer_load_dwordx4 v9, s[52:55], s14 offen offset:1024 lds
    ds_read_b64_tr_b16 v[236:237], v12 offset:32768
    v_mfma_f32_16x16x32_bf16 v[112:115], a[216:219], v[60:63], v[112:115]
    ds_read_b128 v[52:55], v16 offset:15360
    v_mfma_f32_16x16x32_bf16 v[112:115], a[208:211], v[56:59], v[112:115]
    buffer_load_dwordx4 v10, s[52:55], s14 offen offset:2048 lds
    ds_read_b64_tr_b16 v[238:239], v12 offset:33792
    v_mfma_f32_16x16x32_bf16 v[120:123], a[208:211], v[32:35], v[120:123]
    ds_read_b128 v[56:59], v16 offset:13312
    v_mfma_f32_16x16x32_bf16 v[120:123], a[216:219], v[36:39], v[120:123]
    buffer_load_dwordx4 v11, s[52:55], s14 offen offset:3072 lds
    v_mfma_f32_16x16x32_bf16 v[124:127], a[220:223], v[36:39], v[124:127]
    ds_read_b128 v[60:63], v16 offset:16384
    v_mfma_f32_16x16x32_bf16 v[124:127], a[212:215], v[32:35], v[124:127]
    s_waitcnt lgkmcnt(6)
    ds_read_b64_tr_b16 v[240:241], v13 offset:32768
    v_mfma_f32_16x16x32_bf16 v[132:135], a[212:215], v[40:43], v[132:135]
    ds_read_b128 v[32:35], v16 offset:14336
    v_mfma_f32_16x16x32_bf16 v[132:135], a[220:223], v[44:47], v[132:135]
    ds_read_b64_tr_b16 v[242:243], v13 offset:33792
    v_mfma_f32_16x16x32_bf16 v[128:131], a[216:219], v[44:47], v[128:131]
    ds_read_b128 v[36:39], v16 offset:17408
    v_mfma_f32_16x16x32_bf16 v[128:131], a[208:211], v[40:43], v[128:131]
    s_waitcnt lgkmcnt(7)
    v_cmp_eq_u32 vcc, 1, v1
    s_nop 1
    v_cndmask_b32 v149, 0, v31, vcc
    v_mfma_f32_16x16x32_bf16 v[112:115], a[224:227], v[48:51], v[112:115]
    ds_read_b128 v[40:43], v16 offset:18432
    v_mov_b32 v146, 0
    v_mfma_f32_16x16x32_bf16 v[112:115], a[232:235], v[52:55], v[112:115]
    ds_read_b64_tr_b16 v[244:245], v12 offset:40960
    v_mov_b32 v147, 0
    v_mfma_f32_16x16x32_bf16 v[116:119], a[236:239], v[52:55], v[116:119]
    ds_read_b128 v[44:47], v16 offset:21504
    v_mov_b32 v150, 0
    v_mfma_f32_16x16x32_bf16 v[116:119], a[228:231], v[48:51], v[116:119]
    s_waitcnt lgkmcnt(7)
    ds_read_b64_tr_b16 v[246:247], v12 offset:41984
    v_mov_b32 v151, 0
    v_mfma_f32_16x16x32_bf16 v[124:127], a[228:231], v[56:59], v[124:127]
    s_mov_b32 s10, 0xbdd2d3e8
    ds_read_b128 v[48:51], v16 offset:19456
    v_mfma_f32_16x16x32_bf16 v[124:127], a[236:239], v[60:63], v[124:127]
    v_mfma_f32_16x16x32_bf16 v[120:123], a[232:235], v[60:63], v[120:123]
    ds_read_b128 v[52:55], v16 offset:22528
    v_mov_b32 v3, 0xc0135761
    v_mfma_f32_16x16x32_bf16 v[120:123], a[224:227], v[56:59], v[120:123]
    s_waitcnt lgkmcnt(6)
    ds_read_b64_tr_b16 v[248:249], v13 offset:40960
    v_mfma_f32_16x16x32_bf16 v[128:131], a[224:227], v[32:35], v[128:131]
    s_add_u32 m0, s21, 61440
    ds_read_b128 v[56:59], v16 offset:20480
    v_mfma_f32_16x16x32_bf16 v[128:131], a[232:235], v[36:39], v[128:131]
    buffer_load_dwordx4 v18, s[44:47], s74 offen offset:0 sc1 lds
    ds_read_b64_tr_b16 v[250:251], v13 offset:41984
    v_mfma_f32_16x16x32_bf16 v[132:135], a[236:239], v[36:39], v[132:135]
    s_waitcnt vmcnt(12)
    ds_read_b128 v[60:63], v16 offset:23552
    v_xor_b32 v136, v253, v136
    v_mfma_f32_16x16x32_bf16 v[132:135], a[228:231], v[32:35], v[132:135]
    s_waitcnt lgkmcnt(1)
    s_barrier
    v_xor_b32 v137, v255, v137
    v_xor_b32 v138, v23, v138
    v_mfma_f32_16x16x32_bf16 v[116:119], a[244:247], v[40:43], v[116:119]
    ds_read_b128 v[32:35], v16 offset:24576
    v_xor_b32 v139, v0, v139
    v_mfma_f32_16x16x32_bf16 v[116:119], a[252:255], v[44:47], v[116:119]
    buffer_load_dwordx4 v19, s[44:47], s74 offen offset:1024 sc1 lds
    v_or3_b32 v1, v136, v137, v138
    v_mfma_f32_16x16x32_bf16 v[112:115], a[248:251], v[44:47], v[112:115]
    ds_read_b128 v[36:39], v16 offset:27648
    v_xor_b32 v140, v253, v140
    v_mfma_f32_16x16x32_bf16 v[112:115], a[240:243], v[40:43], v[112:115]
    buffer_load_dwordx4 v20, s[44:47], s74 offen offset:2048 sc1 lds
    v_xor_b32 v141, v255, v141
    v_mfma_f32_16x16x32_bf16 v[120:123], a[240:243], v[48:51], v[120:123]
    s_add_u32 m0, s20, 0
    ds_read_b128 v[40:43], v16 offset:25600
    s_lshl_b32 s14, s91, 1
    v_mfma_f32_16x16x32_bf16 v[120:123], a[248:251], v[52:55], v[120:123]
    buffer_load_dwordx4 v8, s[52:55], s14 offen offset:0 lds
    v_or3_b32 v1, v139, v140, v1
    v_mfma_f32_16x16x32_bf16 v[124:127], a[252:255], v[52:55], v[124:127]
    ds_read_b128 v[44:47], v16 offset:28672
    v_xor_b32 v142, v23, v142
    v_mfma_f32_16x16x32_bf16 v[124:127], a[244:247], v[48:51], v[124:127]
    s_waitcnt lgkmcnt(4)
    buffer_load_dwordx4 v9, s[52:55], s14 offen offset:1024 lds
    v_xor_b32 v143, v0, v143
    v_mfma_f32_16x16x32_bf16 v[132:135], a[244:247], v[56:59], v[132:135]
    ds_read_b128 v[48:51], v16 offset:26624
    v_or3_b32 v1, v141, v142, v1
    v_mfma_f32_16x16x32_bf16 v[132:135], a[252:255], v[60:63], v[132:135]
    buffer_load_dwordx4 v10, s[52:55], s14 offen offset:2048 lds
    v_xor_b32 v108, v253, v108
    v_mfma_f32_16x16x32_bf16 v[128:131], a[248:251], v[60:63], v[128:131]
    ds_read_b128 v[52:55], v16 offset:29696
    v_xor_b32 v109, v255, v109
    v_mfma_f32_16x16x32_bf16 v[128:131], a[240:243], v[56:59], v[128:131]
    s_waitcnt lgkmcnt(4)
    buffer_load_dwordx4 v11, s[52:55], s14 offen offset:3072 lds
    v_or3_b32 v1, v143, v108, v1
    v_mfma_f32_16x16x32_bf16 v[64:67], a[0:3], v[32:35], 0
    ds_read_b128 v[56:59], v16 offset:30720
    v_xor_b32 v110, v23, v110
    v_mfma_f32_16x16x32_bf16 v[64:67], a[8:11], v[36:39], v[64:67]
    v_xor_b32 v111, v0, v111
    v_or3_b32 v1, v109, v110, v1
    v_mfma_f32_16x16x32_bf16 v[68:71], a[12:15], v[36:39], 0
    s_add_u32 m0, s20, 16384
    ds_read_b128 v[60:63], v16 offset:33792
    s_lshl_b32 s14, s92, 1
    v_mfma_f32_16x16x32_bf16 v[68:71], a[4:7], v[32:35], v[68:71]
    s_waitcnt lgkmcnt(4)
    buffer_load_dwordx4 v8, s[52:55], s14 offen offset:0 lds
    v_or_b32 v1, v111, v1
    v_mfma_f32_16x16x32_bf16 v[76:79], a[4:7], v[40:43], 0
    ds_read_b128 v[32:35], v16 offset:31744
    v_and_b32 v1, s33, v1
    v_mfma_f32_16x16x32_bf16 v[76:79], a[12:15], v[44:47], v[76:79]
    buffer_load_dwordx4 v9, s[52:55], s14 offen offset:1024 lds
    v_cmp_ne_u32 vcc, 0, v1
    s_cbranch_vccnz L_rs_bl0
L_ok_bl0:
    v_mfma_f32_16x16x32_bf16 v[72:75], a[8:11], v[44:47], 0
    ds_read_b128 v[36:39], v16 offset:34816
    v_mfma_f32_16x16x32_bf16 v[112:115], v[148:151], v[136:139], v[112:115]
    v_mfma_f32_16x16x32_bf16 v[72:75], a[0:3], v[40:43], v[72:75]
    s_waitcnt lgkmcnt(4)
    buffer_load_dwordx4 v10, s[52:55], s14 offen offset:2048 lds
    v_mfma_f32_16x16x32_bf16 v[116:119], v[146:149], v[136:139], v[116:119]
    v_mfma_f32_16x16x32_bf16 v[80:83], a[0:3], v[48:51], 0
    ds_read_b128 v[40:43], v16 offset:32768
    v_mfma_f32_16x16x32_bf16 v[120:123], v[148:151], v[140:143], v[120:123]
    v_mfma_f32_16x16x32_bf16 v[80:83], a[8:11], v[52:55], v[80:83]
    buffer_load_dwordx4 v11, s[52:55], s14 offen offset:3072 lds
    v_mfma_f32_16x16x32_bf16 v[124:127], v[146:149], v[140:143], v[124:127]
    v_mfma_f32_16x16x32_bf16 v[84:87], a[12:15], v[52:55], 0
    ds_read_b128 v[44:47], v16 offset:35840
    v_mfma_f32_16x16x32_bf16 v[128:131], v[148:151], v[108:111], v[128:131]
L_pl_G_4:
    s_cbranch_execz L_wret
    v_mfma_f32_16x16x32_bf16 v[84:87], a[4:7], v[48:51], v[84:87]
    s_waitcnt vmcnt(11) lgkmcnt(4)
    s_barrier
    v_mfma_f32_16x16x32_bf16 v[132:135], v[146:149], v[108:111], v[132:135]
    v_mfma_f32_16x16x32_bf16 v[68:71], a[20:23], v[56:59], v[68:71]
    s_add_u32 m0, s21, 0
    ds_read_b128 v[48:51], v17 offset:0
    v_mfma_f32_16x16x32_bf16 v[68:71], a[28:31], v[60:63], v[68:71]
    buffer_load_dwordx4 v18, s[44:47], s76 offen offset:0 sc1 lds
    ds_read_b64_tr_b16 a[0:1], v12 offset:49152
    v_mfma_f32_16x16x32_bf16 v[64:67], a[24:27], v[60:63], v[64:67]
    ds_read_b128 v[52:55], v17 offset:3072
    v_mfma_f32_16x16x32_bf16 v[64:67], a[16:19], v[56:59], v[64:67]
    s_waitcnt lgkmcnt(5)
    buffer_load_dwordx4 v19, s[44:47], s76 offen offset:1024 sc1 lds
    ds_read_b64_tr_b16 a[2:3], v12 offset:50176
    v_mfma_f32_16x16x32_bf16 v[72:75], a[16:19], v[32:35], v[72:75]
    ds_read_b128 v[56:59], v17 offset:1024
    v_mov_b32 v136, 0xc0135761
    v_pk_mul_f32 v[88:89], v[112:113], v[112:113]
    v_pk_mul_f32 v[90:91], v[114:115], v[114:115]
    v_pk_mul_f32 v[92:93], v[116:117], v[116:117]
    v_pk_mul_f32 v[94:95], v[118:119], v[118:119]
    v_pk_mul_f32 v[96:97], v[120:121], v[120:121]
    v_pk_mul_f32 v[98:99], v[122:123], v[122:123]
    v_pk_mul_f32 v[100:101], v[124:125], v[124:125]
    v_pk_mul_f32 v[102:103], v[126:127], v[126:127]
    v_pk_mul_f32 v[104:105], v[128:129], v[128:129]
    v_pk_mul_f32 v[106:107], v[130:131], v[130:131]
    v_pk_mul_f32 v[108:109], v[132:133], v[132:133]
    v_pk_mul_f32 v[110:111], v[134:135], v[134:135]
    v_pk_fma_f32 v[88:89], v[88:89], s[10:11], v[136:137] op_sel_hi:[1,0,0]
    v_pk_fma_f32 v[90:91], v[90:91], s[10:11], v[136:137] op_sel_hi:[1,0,0]
    v_pk_fma_f32 v[92:93], v[92:93], s[10:11], v[136:137] op_sel_hi:[1,0,0]
    v_pk_fma_f32 v[94:95], v[94:95], s[10:11], v[136:137] op_sel_hi:[1,0,0]
    v_pk_fma_f32 v[96:97], v[96:97], s[10:11], v[136:137] op_sel_hi:[1,0,0]
    v_pk_fma_f32 v[98:99], v[98:99], s[10:11], v[136:137] op_sel_hi:[1,0,0]
    v_mfma_f32_16x16x32_bf16 v[72:75], a[24:27], v[36:39], v[72:75]
    buffer_load_dwordx4 v20, s[44:47], s76 offen offset:2048 sc1 lds
    v_mfma_f32_16x16x32_bf16 v[76:79], a[28:31], v[36:39], v[76:79]
    s_add_u32 m0, s20, 32768
    ds_read_b128 v[60:63], v17 offset:4096
    s_lshl_b32 s14, s93, 1
    v_pk_fma_f32 v[100:101], v[100:101], s[10:11], v[136:137] op_sel_hi:[1,0,0]
    v_pk_fma_f32 v[102:103], v[102:103], s[10:11], v[136:137] op_sel_hi:[1,0,0]
    v_pk_fma_f32 v[104:105], v[104:105], s[10:11], v[136:137] op_sel_hi:[1,0,0]
    v_pk_fma_f32 v[106:107], v[106:107], s[10:11], v[136:137] op_sel_hi:[1,0,0]
    v_pk_fma_f32 v[108:109], v[108:109], s[10:11], v[136:137] op_sel_hi:[1,0,0]
    v_pk_fma_f32 v[110:111], v[110:111], s[10:11], v[136:137] op_sel_hi:[1,0,0]
    v_pk_mul_f32 v[88:89], v[88:89], v[112:113]
    v_pk_mul_f32 v[90:91], v[90:91], v[114:115]
    v_pk_mul_f32 v[92:93], v[92:93], v[116:117]
    v_pk_mul_f32 v[94:95], v[94:95], v[118:119]
    v_pk_mul_f32 v[96:97], v[96:97], v[120:121]
    v_pk_mul_f32 v[98:99], v[98:99], v[122:123]
    v_pk_mul_f32 v[100:101], v[100:101], v[124:125]
    v_pk_mul_f32 v[102:103], v[102:103], v[126:127]
    v_pk_mul_f32 v[104:105], v[104:105], v[128:129]
    v_pk_mul_f32 v[106:107], v[106:107], v[130:131]
    v_pk_mul_f32 v[108:109], v[108:109], v[132:133]
    v_pk_mul_f32 v[110:111], v[110:111], v[134:135]
    v_exp_f32 v88, v88
    v_mfma_f32_16x16x32_bf16 v[76:79], a[20:23], v[32:35], v[76:79]
    s_waitcnt lgkmcnt(6)
    buffer_load_dwordx4 v8, s[52:55], s14 offen offset:0 lds
    ds_read_b64_tr_b16 a[4:5], v13 offset:49152
    v_mfma_f32_16x16x32_bf16 v[84:87], a[20:23], v[40:43], v[84:87]
    ds_read_b128 v[32:35], v17 offset:2048
    v_exp_f32 v89, v89
    v_exp_f32 v90, v90
    v_exp_f32 v91, v91
    v_exp_f32 v92, v92
    v_exp_f32 v93, v93
    v_exp_f32 v94, v94
    v_exp_f32 v95, v95
    v_exp_f32 v96, v96
    v_exp_f32 v97, v97
    v_exp_f32 v98, v98
    v_exp_f32 v99, v99
    v_exp_f32 v100, v100
    v_exp_f32 v101, v101
    v_exp_f32 v102, v102
    v_exp_f32 v103, v103
    v_exp_f32 v104, v104
    v_exp_f32 v105, v105
    v_exp_f32 v106, v106
    v_exp_f32 v107, v107
    v_mfma_f32_16x16x32_bf16 v[84:87], a[28:31], v[44:47], v[84:87]
    buffer_load_dwordx4 v9, s[52:55], s14 offen offset:1024 lds
    ds_read_b64_tr_b16 a[6:7], v13 offset:50176
    v_mfma_f32_16x16x32_bf16 v[80:83], a[24:27], v[44:47], v[80:83]
    ds_read_b128 v[36:39], v17 offset:5120
    v_exp_f32 v108, v108
    v_exp_f32 v109, v109
    v_exp_f32 v110, v110
    v_exp_f32 v111, v111
    v_pk_add_f32 v[88:89], v[88:89], 1.0 op_sel_hi:[1,0]
    v_pk_add_f32 v[90:91], v[90:91], 1.0 op_sel_hi:[1,0]
    v_pk_add_f32 v[92:93], v[92:93], 1.0 op_sel_hi:[1,0]
    v_pk_add_f32 v[94:95], v[94:95], 1.0 op_sel_hi:[1,0]
    v_pk_add_f32 v[96:97], v[96:97], 1.0 op_sel_hi:[1,0]
    v_pk_add_f32 v[98:99], v[98:99], 1.0 op_sel_hi:[1,0]
    v_pk_add_f32 v[100:101], v[100:101], 1.0 op_sel_hi:[1,0]
    v_pk_add_f32 v[102:103], v[102:103], 1.0 op_sel_hi:[1,0]
    v_pk_add_f32 v[104:105], v[104:105], 1.0 op_sel_hi:[1,0]
    v_pk_add_f32 v[106:107], v[106:107], 1.0 op_sel_hi:[1,0]
    v_pk_add_f32 v[108:109], v[108:109], 1.0 op_sel_hi:[1,0]
    v_pk_add_f32 v[110:111], v[110:111], 1.0 op_sel_hi:[1,0]
    v_rcp_f32 v88, v88
    v_rcp_f32 v89, v89
    v_rcp_f32 v90, v90
    v_mfma_f32_16x16x32_bf16 v[80:83], a[16:19], v[40:43], v[80:83]
    s_waitcnt lgkmcnt(7)
    buffer_load_dwordx4 v10, s[52:55], s14 offen offset:2048 lds
    v_mfma_f32_16x16x32_bf16 v[64:67], a[32:35], v[48:51], v[64:67]
    ds_read_b128 v[40:43], v17 offset:6144
    v_rcp_f32 v91, v91
    v_rcp_f32 v92, v92
    v_rcp_f32 v93, v93
    v_rcp_f32 v94, v94
    v_rcp_f32 v95, v95
    v_pk_mul_f32 v[88:89], v[112:113], v[88:89]
    v_pk_mul_f32 v[90:91], v[114:115], v[90:91]
    v_pk_mul_f32 v[92:93], v[116:117], v[92:93]
    v_pk_mul_f32 v[94:95], v[118:119], v[94:95]
    v_cvt_pk_bf16_f32 v112, v88, v89
    v_cvt_pk_bf16_f32 v113, v90, v91
    v_cvt_pk_bf16_f32 v114, v92, v93
    v_cvt_pk_bf16_f32 v115, v94, v95
    s_bfe_u32 s11, s31, 0x30000
    s_lshl_b32 s11, s11, 8
    s_add_u32 s11, s11, s30
    buffer_store_dwordx4 v[112:115], v22, s[44:47], s11 offen sc1
    v_rcp_f32 v96, v96
    v_rcp_f32 v97, v97
    v_mfma_f32_16x16x32_bf16 v[64:67], a[40:43], v[52:55], v[64:67]
    buffer_load_dwordx4 v11, s[52:55], s14 offen offset:3072 lds
    ds_read_b64_tr_b16 a[8:9], v12 offset:57344
    v_mfma_f32_16x16x32_bf16 v[68:71], a[44:47], v[52:55], v[68:71]
    s_add_u32 m0, s21, 12288
    ds_read_b128 v[44:47], v17 offset:9216
    v_rcp_f32 v98, v98
    v_rcp_f32 v99, v99
    v_rcp_f32 v100, v100
    v_rcp_f32 v101, v101
    v_rcp_f32 v102, v102
    v_rcp_f32 v103, v103
    v_pk_mul_f32 v[96:97], v[120:121], v[96:97]
    v_pk_mul_f32 v[98:99], v[122:123], v[98:99]
    v_pk_mul_f32 v[100:101], v[124:125], v[100:101]
    v_pk_mul_f32 v[102:103], v[126:127], v[102:103]
    v_cvt_pk_bf16_f32 v120, v96, v97
    v_cvt_pk_bf16_f32 v121, v98, v99
    v_cvt_pk_bf16_f32 v122, v100, v101
    v_cvt_pk_bf16_f32 v123, v102, v103
    s_bfe_u32 s11, s31, 0x30003
    s_lshl_b32 s11, s11, 8
    s_add_u32 s11, s11, s30
    buffer_store_dwordx4 v[120:123], v22, s[44:47], s11 offen sc1
    v_rcp_f32 v104, v104
    v_mfma_f32_16x16x32_bf16 v[68:71], a[36:39], v[48:51], v[68:71]
    s_waitcnt lgkmcnt(7)
    buffer_load_dwordx4 v18, s[44:47], s78 offen offset:0 sc1 lds
    ds_read_b64_tr_b16 a[10:11], v12 offset:58368
    v_mfma_f32_16x16x32_bf16 v[76:79], a[36:39], v[56:59], v[76:79]
    ds_read_b128 v[48:51], v17 offset:7168
    v_rcp_f32 v105, v105
    v_rcp_f32 v106, v106
    v_rcp_f32 v107, v107
    v_rcp_f32 v108, v108
    v_rcp_f32 v109, v109
    v_rcp_f32 v110, v110
    v_rcp_f32 v111, v111
    v_pk_mul_f32 v[104:105], v[128:129], v[104:105]
    v_pk_mul_f32 v[106:107], v[130:131], v[106:107]
    v_pk_mul_f32 v[108:109], v[132:133], v[108:109]
    v_pk_mul_f32 v[110:111], v[134:135], v[110:111]
    v_cvt_pk_bf16_f32 v128, v104, v105
    v_cvt_pk_bf16_f32 v129, v106, v107
    v_cvt_pk_bf16_f32 v130, v108, v109
    v_cvt_pk_bf16_f32 v131, v110, v111
    s_bfe_u32 s11, s31, 0x30006
    s_lshl_b32 s11, s11, 8
    s_add_u32 s11, s11, s30
    buffer_store_dwordx4 v[128:131], v22, s[44:47], s11 offen sc1
    v_mfma_f32_16x16x32_bf16 v[76:79], a[44:47], v[60:63], v[76:79]
    buffer_load_dwordx4 v19, s[44:47], s78 offen offset:1024 sc1 lds
    v_mfma_f32_16x16x32_bf16 v[72:75], a[40:43], v[60:63], v[72:75]
    ds_read_b128 v[52:55], v17 offset:10240
    v_mfma_f32_16x16x32_bf16 v[72:75], a[32:35], v[56:59], v[72:75]
    s_waitcnt lgkmcnt(6)
    buffer_load_dwordx4 v20, s[44:47], s78 offen offset:2048 sc1 lds
    ds_read_b64_tr_b16 a[12:13], v13 offset:57344
    v_mfma_f32_16x16x32_bf16 v[80:83], a[32:35], v[32:35], v[80:83]
    ds_read_b128 v[56:59], v17 offset:8192
    v_mfma_f32_16x16x32_bf16 v[80:83], a[40:43], v[36:39], v[80:83]
    ds_read_b64_tr_b16 a[14:15], v13 offset:58368
    v_mfma_f32_16x16x32_bf16 v[84:87], a[44:47], v[36:39], v[84:87]
    ds_read_b128 v[60:63], v17 offset:11264
    v_mfma_f32_16x16x32_bf16 v[84:87], a[36:39], v[32:35], v[84:87]
    s_waitcnt vmcnt(17) lgkmcnt(1)
    s_barrier
    v_mfma_f32_16x16x32_bf16 v[68:71], a[52:55], v[40:43], v[68:71]
    s_add_u32 m0, s20, 49152
    ds_read_b128 v[32:35], v17 offset:12288
    s_lshl_b32 s14, s94, 1
    v_mfma_f32_16x16x32_bf16 v[68:71], a[60:63], v[44:47], v[68:71]
    buffer_load_dwordx4 v8, s[52:55], s14 offen offset:0 lds
    ds_read_b64_tr_b16 a[16:17], v12 offset:0
    v_mfma_f32_16x16x32_bf16 v[64:67], a[56:59], v[44:47], v[64:67]
    ds_read_b128 v[36:39], v17 offset:15360
    v_mfma_f32_16x16x32_bf16 v[64:67], a[48:51], v[40:43], v[64:67]
    buffer_load_dwordx4 v9, s[52:55], s14 offen offset:1024 lds
    ds_read_b64_tr_b16 a[18:19], v12 offset:1024
    v_mfma_f32_16x16x32_bf16 v[72:75], a[48:51], v[48:51], v[72:75]
    ds_read_b128 v[40:43], v17 offset:13312
    v_mfma_f32_16x16x32_bf16 v[72:75], a[56:59], v[52:55], v[72:75]
    v_mfma_f32_16x16x32_bf16 v[76:79], a[60:63], v[52:55], v[76:79]
    ds_read_b128 v[44:47], v17 offset:16384
    v_mfma_f32_16x16x32_bf16 v[76:79], a[52:55], v[48:51], v[76:79]
    s_waitcnt lgkmcnt(6)
    ds_read_b64_tr_b16 a[20:21], v13 offset:0
    v_mfma_f32_16x16x32_bf16 v[84:87], a[52:55], v[56:59], v[84:87]
    ds_read_b128 v[48:51], v17 offset:14336
    v_mfma_f32_16x16x32_bf16 v[84:87], a[60:63], v[60:63], v[84:87]
    ds_read_b64_tr_b16 a[22:23], v13 offset:1024
    v_mfma_f32_16x16x32_bf16 v[80:83], a[56:59], v[60:63], v[80:83]
    ds_read_b128 v[52:55], v17 offset:17408
    v_mfma_f32_16x16x32_bf16 v[80:83], a[48:51], v[56:59], v[80:83]
    s_waitcnt lgkmcnt(7)
    v_mfma_f32_16x16x32_bf16 v[64:67], a[64:67], v[32:35], v[64:67]
    ds_read_b128 v[56:59], v17 offset:18432
    v_mfma_f32_16x16x32_bf16 v[64:67], a[72:75], v[36:39], v[64:67]
    ds_read_b64_tr_b16 a[24:25], v12 offset:8192
    v_mfma_f32_16x16x32_bf16 v[68:71], a[76:79], v[36:39], v[68:71]
    ds_read_b128 v[60:63], v17 offset:21504
    v_mfma_f32_16x16x32_bf16 v[68:71], a[68:71], v[32:35], v[68:71]
    s_waitcnt lgkmcnt(7)
    ds_read_b64_tr_b16 a[26:27], v12 offset:9216
    v_mfma_f32_16x16x32_bf16 v[76:79], a[68:71], v[40:43], v[76:79]
    ds_read_b128 v[32:35], v17 offset:19456
    v_mfma_f32_16x16x32_bf16 v[76:79], a[76:79], v[44:47], v[76:79]
    buffer_load_dwordx4 v10, s[52:55], s14 offen offset:2048 lds
    v_mfma_f32_16x16x32_bf16 v[72:75], a[72:75], v[44:47], v[72:75]
    ds_read_b128 v[36:39], v17 offset:22528
    v_mfma_f32_16x16x32_bf16 v[72:75], a[64:67], v[40:43], v[72:75]
    s_waitcnt lgkmcnt(6)
    buffer_load_dwordx4 v11, s[52:55], s14 offen offset:3072 lds
    ds_read_b64_tr_b16 a[28:29], v13 offset:8192
    v_mfma_f32_16x16x32_bf16 v[80:83], a[64:67], v[48:51], v[80:83]
    s_add_u32 m0, s21, 24576
    ds_read_b128 v[40:43], v17 offset:20480
    v_mfma_f32_16x16x32_bf16 v[80:83], a[72:75], v[52:55], v[80:83]
    buffer_load_dwordx4 v18, s[44:47], s80 offen offset:0 sc1 lds
    ds_read_b64_tr_b16 a[30:31], v13 offset:9216
    v_mfma_f32_16x16x32_bf16 v[84:87], a[76:79], v[52:55], v[84:87]
    ds_read_b128 v[44:47], v17 offset:23552
    v_mfma_f32_16x16x32_bf16 v[84:87], a[68:71], v[48:51], v[84:87]
    s_waitcnt vmcnt(18) lgkmcnt(1)
    s_barrier
    v_mfma_f32_16x16x32_bf16 v[68:71], a[84:87], v[56:59], v[68:71]
    ds_read_b128 v[48:51], v17 offset:24576
    v_mfma_f32_16x16x32_bf16 v[68:71], a[92:95], v[60:63], v[68:71]
    buffer_load_dwordx4 v19, s[44:47], s80 offen offset:1024 sc1 lds
    ds_read_b64_tr_b16 a[32:33], v12 offset:16384
    v_mfma_f32_16x16x32_bf16 v[64:67], a[88:91], v[60:63], v[64:67]
    ds_read_b128 v[52:55], v17 offset:27648
    v_mfma_f32_16x16x32_bf16 v[64:67], a[80:83], v[56:59], v[64:67]
    buffer_load_dwordx4 v20, s[44:47], s80 offen offset:2048 sc1 lds
    ds_read_b64_tr_b16 a[34:35], v12 offset:17408
    v_mfma_f32_16x16x32_bf16 v[72:75], a[80:83], v[32:35], v[72:75]
    ds_read_b128 v[56:59], v17 offset:25600
    v_mfma_f32_16x16x32_bf16 v[72:75], a[88:91], v[36:39], v[72:75]
    v_mfma_f32_16x16x32_bf16 v[76:79], a[92:95], v[36:39], v[76:79]
    s_add_u32 m0, s20, 0
    ds_read_b128 v[60:63], v17 offset:28672
    s_lshl_b32 s14, s95, 1
    v_mfma_f32_16x16x32_bf16 v[76:79], a[84:87], v[32:35], v[76:79]
    s_waitcnt lgkmcnt(6)
    buffer_load_dwordx4 v8, s[52:55], s14 offen offset:0 lds
    ds_read_b64_tr_b16 a[36:37], v13 offset:16384
    v_mfma_f32_16x16x32_bf16 v[84:87], a[84:87], v[40:43], v[84:87]
    ds_read_b128 v[32:35], v17 offset:26624
    v_mfma_f32_16x16x32_bf16 v[84:87], a[92:95], v[44:47], v[84:87]
    buffer_load_dwordx4 v9, s[52:55], s14 offen offset:1024 lds
    ds_read_b64_tr_b16 a[38:39], v13 offset:17408
    v_mfma_f32_16x16x32_bf16 v[80:83], a[88:91], v[44:47], v[80:83]
    ds_read_b128 v[36:39], v17 offset:29696
    v_mfma_f32_16x16x32_bf16 v[80:83], a[80:83], v[40:43], v[80:83]
    s_waitcnt lgkmcnt(7)
    buffer_load_dwordx4 v10, s[52:55], s14 offen offset:2048 lds
    v_mfma_f32_16x16x32_bf16 v[64:67], a[96:99], v[48:51], v[64:67]
    ds_read_b128 v[40:43], v17 offset:30720
    v_mfma_f32_16x16x32_bf16 v[64:67], a[104:107], v[52:55], v[64:67]
    buffer_load_dwordx4 v11, s[52:55], s14 offen offset:3072 lds
    ds_read_b64_tr_b16 a[40:41], v12 offset:24576
    v_mfma_f32_16x16x32_bf16 v[68:71], a[108:111], v[52:55], v[68:71]
    ds_read_b128 v[44:47], v17 offset:33792
    v_mfma_f32_16x16x32_bf16 v[68:71], a[100:103], v[48:51], v[68:71]
    s_waitcnt lgkmcnt(7)
    ds_read_b64_tr_b16 a[42:43], v12 offset:25600
    v_mfma_f32_16x16x32_bf16 v[76:79], a[100:103], v[56:59], v[76:79]
    s_add_u32 m0, s21, 36864
    ds_read_b128 v[48:51], v17 offset:31744
    v_mfma_f32_16x16x32_bf16 v[76:79], a[108:111], v[60:63], v[76:79]
    buffer_load_dwordx4 v18, s[44:47], s82 offen offset:0 sc1 lds
    v_mfma_f32_16x16x32_bf16 v[72:75], a[104:107], v[60:63], v[72:75]
    ds_read_b128 v[52:55], v17 offset:34816
    v_mfma_f32_16x16x32_bf16 v[72:75], a[96:99], v[56:59], v[72:75]
    s_waitcnt lgkmcnt(6)
    buffer_load_dwordx4 v19, s[44:47], s82 offen offset:1024 sc1 lds
    ds_read_b64_tr_b16 a[44:45], v13 offset:24576
    v_mfma_f32_16x16x32_bf16 v[80:83], a[96:99], v[32:35], v[80:83]
    ds_read_b128 v[56:59], v17 offset:32768
    v_mfma_f32_16x16x32_bf16 v[80:83], a[104:107], v[36:39], v[80:83]
    buffer_load_dwordx4 v20, s[44:47], s82 offen offset:2048 sc1 lds
    ds_read_b64_tr_b16 a[46:47], v13 offset:25600
    v_mfma_f32_16x16x32_bf16 v[84:87], a[108:111], v[36:39], v[84:87]
    s_mov_b32 s6, 241306688
    ds_read_b128 v[60:63], v17 offset:35840
    s_mov_b32 s7, 2898
    v_mfma_f32_16x16x32_bf16 v[84:87], a[100:103], v[32:35], v[84:87]
    s_waitcnt vmcnt(16) lgkmcnt(1)
    s_barrier
    s_bitcmp1_b32 s22, 0
    s_cselect_b32 s6, 2942979664, s6
    s_cselect_b32 s7, 3195, s7
    v_mfma_f32_16x16x32_bf16 v[68:71], a[116:119], v[40:43], v[68:71]
    ds_read_b128 v[32:35], v16 offset:0
    v_mfma_f32_16x16x32_bf16 v[68:71], a[124:127], v[44:47], v[68:71]
    s_mov_b32 s83, 2348962
    ds_read_b64_tr_b16 a[48:49], v12 offset:32768
    buffer_store_dword v24, v25, s[44:47], s32 offen sc1
    v_mfma_f32_16x16x32_bf16 v[64:67], a[120:123], v[44:47], v[64:67]
    s_cmp_eq_u32 s23, 1
    s_cselect_b32 s83, 6880132, s83
    ds_read_b128 v[36:39], v16 offset:3072
    v_mfma_f32_16x16x32_bf16 v[64:67], a[112:115], v[40:43], v[64:67]
    s_add_u32 s32, s32, 9216
    ds_read_b64_tr_b16 a[50:51], v12 offset:33792
    buffer_load_dwordx4 v[136:139], v21, s[44:47], s9 offen offset:0 sc1
    v_mfma_f32_16x16x32_bf16 v[72:75], a[112:115], v[48:51], v[72:75]
    s_cmp_eq_u32 s23, 2
    s_cselect_b32 s83, 11640720, s83
    ds_read_b128 v[40:43], v16 offset:1024
    v_mfma_f32_16x16x32_bf16 v[72:75], a[120:123], v[52:55], v[72:75]
    s_cmp_eq_u32 s23, 3
    s_cselect_b32 s83, 16429840, s83
    s_and_b32 s12, s3, 1
    v_mfma_f32_16x16x32_bf16 v[76:79], a[124:127], v[52:55], v[76:79]
    s_mul_i32 s12, s12, 49152
    ds_read_b128 v[44:47], v16 offset:4096
    buffer_load_dwordx4 v[140:143], v21, s[44:47], s9 offen offset:1024 sc1
    v_mfma_f32_16x16x32_bf16 v[76:79], a[116:119], v[48:51], v[76:79]
    s_waitcnt lgkmcnt(6)
    s_lshr_b32 s4, s22, 1
    ds_read_b64_tr_b16 a[52:53], v13 offset:32768
    s_mul_i32 s4, s4, 6144
    v_mfma_f32_16x16x32_bf16 v[84:87], a[116:119], v[56:59], v[84:87]
    s_add_u32 s12, s12, s4
    ds_read_b128 v[48:51], v16 offset:2048
    buffer_load_dwordx4 v[108:111], v21, s[44:47], s9 offen offset:2048 sc1
    v_mfma_f32_16x16x32_bf16 v[84:87], a[124:127], v[60:63], v[84:87]
    s_add_u32 s12, s12, 22872064
    ds_read_b64_tr_b16 a[54:55], v13 offset:33792
    v_mfma_f32_16x16x32_bf16 v[80:83], a[120:123], v[60:63], v[80:83]
    s_lshr_b32 s4, s7, 8
    ds_read_b128 v[52:55], v16 offset:5120
    s_and_b32 s4, s4, 31
    v_mfma_f32_16x16x32_bf16 v[80:83], a[112:115], v[56:59], v[80:83]
    s_waitcnt lgkmcnt(7)
    s_lshl_b32 s4, s4, 8
    v_mfma_f32_16x16x32_bf16 v[64:67], a[128:131], v[32:35], v[64:67]
    s_add_u32 m0, s20, 16384
    ds_read_b128 v[56:59], v16 offset:6144
    s_lshl_b32 s14, s96, 1
    v_mfma_f32_16x16x32_bf16 v[64:67], a[136:139], v[36:39], v[64:67]
    s_add_u32 s68, s4, s12
    buffer_load_dwordx4 v8, s[52:55], s14 offen offset:0 lds
    ds_read_b64_tr_b16 a[56:57], v12 offset:40960
    v_mfma_f32_16x16x32_bf16 v[68:71], a[140:143], v[36:39], v[68:71]
    s_bfe_u32 s4, s83, 0x30000
    ds_read_b128 v[60:63], v16 offset:9216
    s_mul_i32 s4, s4, 5
    v_mfma_f32_16x16x32_bf16 v[68:71], a[132:135], v[32:35], v[68:71]
    s_waitcnt lgkmcnt(7)
    s_lshr_b64 s[4:5], s[6:7], s4
    ds_read_b64_tr_b16 a[58:59], v12 offset:41984
    v_mfma_f32_16x16x32_bf16 v[76:79], a[132:135], v[40:43], v[76:79]
    s_and_b32 s4, s4, 31
    ds_read_b128 v[32:35], v16 offset:7168
    v_mfma_f32_16x16x32_bf16 v[76:79], a[140:143], v[44:47], v[76:79]
    s_lshl_b32 s4, s4, 8
    buffer_load_dwordx4 v9, s[52:55], s14 offen offset:1024 lds
    s_add_u32 s69, s4, s12
    v_mfma_f32_16x16x32_bf16 v[72:75], a[136:139], v[44:47], v[72:75]
    s_cmp_lt_u32 s3, 2
    s_cselect_b32 s68, s68, s69
    ds_read_b128 v[36:39], v16 offset:10240
    v_mfma_f32_16x16x32_bf16 v[72:75], a[128:131], v[40:43], v[72:75]
    s_waitcnt lgkmcnt(6)
    s_bfe_u32 s4, s83, 0x30003
    ds_read_b64_tr_b16 a[60:61], v13 offset:40960
    v_mfma_f32_16x16x32_bf16 v[80:83], a[128:131], v[48:51], v[80:83]
    s_mul_i32 s4, s4, 5
    ds_read_b128 v[40:43], v16 offset:8192
    v_mfma_f32_16x16x32_bf16 v[80:83], a[136:139], v[52:55], v[80:83]
    s_lshr_b64 s[4:5], s[6:7], s4
    buffer_load_dwordx4 v10, s[52:55], s14 offen offset:2048 lds
    ds_read_b64_tr_b16 a[62:63], v13 offset:41984
    v_mfma_f32_16x16x32_bf16 v[84:87], a[140:143], v[52:55], v[84:87]
    s_and_b32 s4, s4, 31
    ds_read_b128 v[44:47], v16 offset:11264
    v_mfma_f32_16x16x32_bf16 v[84:87], a[132:135], v[48:51], v[84:87]
    s_waitcnt vmcnt(17) lgkmcnt(1)
    s_barrier
    s_lshl_b32 s4, s4, 8
    v_mfma_f32_16x16x32_bf16 v[68:71], a[148:151], v[56:59], v[68:71]
    s_add_u32 s70, s4, s12
    ds_read_b128 v[48:51], v16 offset:12288
    s_bfe_u32 s4, s83, 0x30006
    v_mfma_f32_16x16x32_bf16 v[68:71], a[156:159], v[60:63], v[68:71]
    s_mul_i32 s4, s4, 5
    buffer_load_dwordx4 v11, s[52:55], s14 offen offset:3072 lds
    ds_read_b64_tr_b16 a[64:65], v12 offset:49152
    v_mfma_f32_16x16x32_bf16 v[64:67], a[152:155], v[60:63], v[64:67]
    s_add_u32 m0, s20, 32768
    ds_read_b128 v[52:55], v16 offset:15360
    s_lshl_b32 s14, s97, 1
    v_mfma_f32_16x16x32_bf16 v[64:67], a[144:147], v[56:59], v[64:67]
    s_lshr_b64 s[4:5], s[6:7], s4
    buffer_load_dwordx4 v8, s[52:55], s14 offen offset:0 lds
    ds_read_b64_tr_b16 a[66:67], v12 offset:50176
    v_mfma_f32_16x16x32_bf16 v[72:75], a[144:147], v[32:35], v[72:75]
    s_and_b32 s4, s4, 31
    ds_read_b128 v[56:59], v16 offset:13312
    s_lshl_b32 s4, s4, 8
    v_mfma_f32_16x16x32_bf16 v[72:75], a[152:155], v[36:39], v[72:75]
    s_add_u32 s71, s4, s12
    buffer_load_dwordx4 v9, s[52:55], s14 offen offset:1024 lds
    v_mfma_f32_16x16x32_bf16 v[76:79], a[156:159], v[36:39], v[76:79]
    s_bfe_u32 s4, s83, 0x30009
    ds_read_b128 v[60:63], v16 offset:16384
    v_mfma_f32_16x16x32_bf16 v[76:79], a[148:151], v[32:35], v[76:79]
    s_waitcnt lgkmcnt(6)
    s_mul_i32 s4, s4, 5
    ds_read_b64_tr_b16 a[68:69], v13 offset:49152
    v_mfma_f32_16x16x32_bf16 v[84:87], a[148:151], v[40:43], v[84:87]
    s_lshr_b64 s[4:5], s[6:7], s4
    ds_read_b128 v[32:35], v16 offset:14336
    v_mfma_f32_16x16x32_bf16 v[84:87], a[156:159], v[44:47], v[84:87]
    s_and_b32 s4, s4, 31
    ds_read_b64_tr_b16 a[70:71], v13 offset:50176
    v_mfma_f32_16x16x32_bf16 v[80:83], a[152:155], v[44:47], v[80:83]
    s_lshl_b32 s4, s4, 8
    ds_read_b128 v[36:39], v16 offset:17408
    v_mfma_f32_16x16x32_bf16 v[80:83], a[144:147], v[40:43], v[80:83]
    s_waitcnt lgkmcnt(7)
    s_add_u32 s72, s4, s12
    s_bfe_u32 s4, s83, 0x3000c
    v_mfma_f32_16x16x32_bf16 v[64:67], a[160:163], v[48:51], v[64:67]
    s_mul_i32 s4, s4, 5
    ds_read_b128 v[40:43], v16 offset:18432
    v_mfma_f32_16x16x32_bf16 v[64:67], a[168:171], v[52:55], v[64:67]
    s_lshr_b64 s[4:5], s[6:7], s4
    ds_read_b64_tr_b16 a[72:73], v12 offset:57344
    v_mfma_f32_16x16x32_bf16 v[68:71], a[172:175], v[52:55], v[68:71]
    s_and_b32 s4, s4, 31
    ds_read_b128 v[44:47], v16 offset:21504
    v_mfma_f32_16x16x32_bf16 v[68:71], a[164:167], v[48:51], v[68:71]
    s_waitcnt lgkmcnt(7)
    s_lshl_b32 s4, s4, 8
    ds_read_b64_tr_b16 a[74:75], v12 offset:58368
    v_mfma_f32_16x16x32_bf16 v[76:79], a[164:167], v[56:59], v[76:79]
    s_add_u32 s73, s4, s12
    ds_read_b128 v[48:51], v16 offset:19456
    v_mfma_f32_16x16x32_bf16 v[76:79], a[172:175], v[60:63], v[76:79]
    s_bfe_u32 s4, s83, 0x3000f
    v_mfma_f32_16x16x32_bf16 v[72:75], a[168:171], v[60:63], v[72:75]
    s_mul_i32 s4, s4, 5
    ds_read_b128 v[52:55], v16 offset:22528
    v_mfma_f32_16x16x32_bf16 v[72:75], a[160:163], v[56:59], v[72:75]
    s_waitcnt lgkmcnt(6)
    s_lshr_b64 s[4:5], s[6:7], s4
    ds_read_b64_tr_b16 a[76:77], v13 offset:57344
    s_and_b32 s4, s4, 31
    v_mfma_f32_16x16x32_bf16 v[80:83], a[160:163], v[32:35], v[80:83]
    s_lshl_b32 s4, s4, 8
    ds_read_b128 v[56:59], v16 offset:20480
    s_add_u32 s74, s4, s12
    v_mfma_f32_16x16x32_bf16 v[80:83], a[168:171], v[36:39], v[80:83]
    s_bfe_u32 s4, s83, 0x30012
    ds_read_b64_tr_b16 a[78:79], v13 offset:58368
    s_mul_i32 s4, s4, 5
    v_mfma_f32_16x16x32_bf16 v[84:87], a[172:175], v[36:39], v[84:87]
    s_lshr_b64 s[4:5], s[6:7], s4
    ds_read_b128 v[60:63], v16 offset:23552
    s_and_b32 s4, s4, 31
    v_mfma_f32_16x16x32_bf16 v[84:87], a[164:167], v[32:35], v[84:87]
    s_waitcnt vmcnt(13) lgkmcnt(1)
    s_barrier
    s_lshl_b32 s4, s4, 8
    s_add_u32 s75, s4, s12
    s_bfe_u32 s4, s83, 0x30015
    v_mfma_f32_16x16x32_bf16 v[68:71], a[180:183], v[40:43], v[68:71]
    s_mul_i32 s4, s4, 5
    ds_read_b128 v[32:35], v16 offset:24576
    s_lshr_b64 s[4:5], s[6:7], s4
    v_mfma_f32_16x16x32_bf16 v[68:71], a[188:191], v[44:47], v[68:71]
    s_and_b32 s4, s4, 31
    ds_read_b64_tr_b16 a[80:81], v12 offset:0
    ds_read_b128 a[128:131], v30 offset:64
    v_mfma_f32_16x16x32_bf16 v[64:67], a[184:187], v[44:47], v[64:67]
    s_lshl_b32 s4, s4, 8
    ds_read_b128 v[36:39], v16 offset:27648
    s_add_u32 s76, s4, s12
    v_mfma_f32_16x16x32_bf16 v[64:67], a[176:179], v[40:43], v[64:67]
    s_mov_b32 s6, 994437672
    ds_read_b64_tr_b16 a[82:83], v12 offset:1024
    ds_read_b128 a[132:135], v30 offset:576
    v_mfma_f32_16x16x32_bf16 v[72:75], a[176:179], v[48:51], v[72:75]
    s_cmp_eq_u32 s23, 1
    s_cselect_b32 s6, 391038234, s6
    ds_read_b128 v[40:43], v16 offset:25600
    v_mfma_f32_16x16x32_bf16 v[72:75], a[184:187], v[52:55], v[72:75]
    s_waitcnt vmcnt(6)
    buffer_load_dwordx4 v10, s[52:55], s14 offen offset:2048 lds
    v_xor_b32 v136, v253, v136
    ds_read_b128 a[136:139], v30 offset:1088
    v_mfma_f32_16x16x32_bf16 v[76:79], a[188:191], v[52:55], v[76:79]
    ds_read_b128 v[44:47], v16 offset:28672
    v_xor_b32 v137, v255, v137
    v_mfma_f32_16x16x32_bf16 v[76:79], a[180:183], v[48:51], v[76:79]
    s_waitcnt lgkmcnt(9)
    buffer_load_dwordx4 v11, s[52:55], s14 offen offset:3072 lds
    ds_read_b64_tr_b16 a[84:85], v13 offset:0
    v_mfma_f32_16x16x32_bf16 v[84:87], a[180:183], v[56:59], v[84:87]
    s_add_u32 m0, s20, 49152
    ds_read_b128 v[48:51], v16 offset:26624
    s_lshl_b32 s14, s98, 1
    v_xor_b32 v138, v23, v138
    v_mfma_f32_16x16x32_bf16 v[84:87], a[188:191], v[60:63], v[84:87]
    s_cmp_eq_u32 s23, 2
    s_cselect_b32 s6, 994419537, s6
    buffer_load_dwordx4 v8, s[52:55], s14 offen offset:0 lds
    ds_read_b64_tr_b16 a[86:87], v13 offset:1024
    v_xor_b32 v139, v0, v139
    ds_read_b128 a[140:143], v30 offset:1600
    v_mfma_f32_16x16x32_bf16 v[80:83], a[184:187], v[60:63], v[80:83]
    s_cmp_eq_u32 s23, 3
    s_cselect_b32 s6, 391029306, s6
    ds_read_b128 v[52:55], v16 offset:29696
    v_or3_b32 v1, v136, v137, v138
    v_mfma_f32_16x16x32_bf16 v[80:83], a[176:179], v[56:59], v[80:83]
    s_waitcnt lgkmcnt(10)
    s_bfe_u32 s4, s6, 0x20003
    buffer_load_dwordx4 v9, s[52:55], s14 offen offset:1024 lds
    v_xor_b32 v140, v253, v140
    ds_read_b128 a[144:147], v30 offset:2112
    v_mfma_f32_16x16x32_bf16 v[64:67], a[192:195], v[32:35], v[64:67]
    s_lshl_b32 s4, s4, 1
    ds_read_b128 v[56:59], v16 offset:30720
    v_xor_b32 v141, v255, v141
    v_mfma_f32_16x16x32_bf16 v[64:67], a[200:203], v[36:39], v[64:67]
    s_xor_b32 s4, s4, s2
    buffer_load_dwordx4 v10, s[52:55], s14 offen offset:2048 lds
    ds_read_b64_tr_b16 a[88:89], v12 offset:8192
    v_or3_b32 v1, v139, v140, v1
    ds_read_b128 a[148:151], v30 offset:2624
    v_mfma_f32_16x16x32_bf16 v[68:71], a[204:207], v[36:39], v[68:71]
    s_lshl2_add_u32 s4, s4, s3
    ds_read_b128 v[60:63], v16 offset:33792
    v_xor_b32 v142, v23, v142
    v_mfma_f32_16x16x32_bf16 v[68:71], a[196:199], v[32:35], v[68:71]
    s_waitcnt lgkmcnt(10)
    s_bfe_u32 s5, s6, 0x30000
    buffer_load_dwordx4 v11, s[52:55], s14 offen offset:3072 lds
    ds_read_b64_tr_b16 a[90:91], v12 offset:9216
    v_xor_b32 v143, v0, v143
    ds_read_b128 a[152:155], v30 offset:3136
    v_mfma_f32_16x16x32_bf16 v[76:79], a[196:199], v[40:43], v[76:79]
    s_lshl3_add_u32 s4, s4, s5
    ds_read_b128 v[32:35], v16 offset:31744
    v_or3_b32 v1, v141, v142, v1
    v_mfma_f32_16x16x32_bf16 v[76:79], a[204:207], v[44:47], v[76:79]
    s_lshl_b32 s4, s4, 10
    v_xor_b32 v108, v253, v108
    v_xor_b32 v109, v255, v109
    v_mfma_f32_16x16x32_bf16 v[72:75], a[200:203], v[44:47], v[72:75]
    s_add_u32 s77, s4, 14483456
    ds_read_b128 v[36:39], v16 offset:34816
    v_or3_b32 v1, v143, v108, v1
    v_mfma_f32_16x16x32_bf16 v[72:75], a[192:195], v[40:43], v[72:75]
    s_waitcnt lgkmcnt(9)
    s_bfe_u32 s4, s6, 0x20008
    ds_read_b64_tr_b16 a[92:93], v13 offset:8192
    v_xor_b32 v110, v23, v110
    ds_read_b128 a[156:159], v30 offset:3648
L_pl_G_5:
    s_cbranch_execz L_wret
    v_mfma_f32_16x16x32_bf16 v[80:83], a[192:195], v[48:51], v[80:83]
    s_lshl_b32 s4, s4, 1
    ds_read_b128 v[40:43], v16 offset:32768
    v_xor_b32 v111, v0, v111
    v_mfma_f32_16x16x32_bf16 v[80:83], a[200:203], v[52:55], v[80:83]
    s_xor_b32 s4, s4, s2
    ds_read_b64_tr_b16 a[94:95], v13 offset:9216
    v_or3_b32 v1, v109, v110, v1
    v_or_b32 v1, v111, v1
    v_mfma_f32_16x16x32_bf16 v[84:87], a[204:207], v[52:55], v[84:87]
    s_lshl2_add_u32 s4, s4, s3
    ds_read_b128 v[44:47], v16 offset:35840
    v_and_b32 v1, s33, v1
    v_cmp_ne_u32 vcc, 0, v1
    s_cbranch_vccnz L_rs_bl1
L_ok_bl1:
    v_mfma_f32_16x16x32_bf16 v[84:87], a[196:199], v[48:51], v[84:87]
    s_waitcnt vmcnt(8) lgkmcnt(1)
    s_barrier
    s_bfe_u32 s5, s6, 0x30005
    v_mfma_f32_16x16x32_bf16 v[64:67], v[148:151], v[136:139], v[64:67]
    ds_read2_b32 a[160:161], v4 offset0:0 offset1:1
    v_mfma_f32_16x16x32_bf16 v[68:71], a[212:215], v[56:59], v[68:71]
    s_add_u32 m0, s20, 0
    ds_read_b128 v[48:51], v17 offset:0
    s_lshl_b32 s14, s99, 1
    v_mfma_f32_16x16x32_bf16 v[68:71], a[220:223], v[60:63], v[68:71]
    s_lshl3_add_u32 s4, s4, s5
    buffer_load_dwordx4 v8, s[52:55], s14 offen offset:0 lds
    ds_read_b64_tr_b16 a[96:97], v12 offset:16384
    v_mfma_f32_16x16x32_bf16 v[64:67], a[216:219], v[60:63], v[64:67]
    s_lshl_b32 s4, s4, 10
    ds_read_b128 v[52:55], v17 offset:3072
    v_mfma_f32_16x16x32_bf16 v[68:71], v[146:149], v[136:139], v[68:71]
    v_mfma_f32_16x16x32_bf16 v[64:67], a[208:211], v[56:59], v[64:67]
    s_add_u32 s78, s4, 14483456
    buffer_load_dwordx4 v9, s[52:55], s14 offen offset:1024 lds
    ds_read_b64_tr_b16 a[98:99], v12 offset:17408
    v_mfma_f32_16x16x32_bf16 v[72:75], v[148:151], v[140:143], v[72:75]
    v_mfma_f32_16x16x32_bf16 v[72:75], a[208:211], v[32:35], v[72:75]
    s_bfe_u32 s4, s6, 0x2000d
    ds_read_b128 v[56:59], v17 offset:1024
    v_mfma_f32_16x16x32_bf16 v[76:79], v[146:149], v[140:143], v[76:79]
    v_mfma_f32_16x16x32_bf16 v[72:75], a[216:219], v[36:39], v[72:75]
    s_lshl_b32 s4, s4, 1
    buffer_load_dwordx4 v10, s[52:55], s14 offen offset:2048 lds
    v_mfma_f32_16x16x32_bf16 v[80:83], v[148:151], v[108:111], v[80:83]
    ds_read2_b32 a[162:163], v4 offset0:2 offset1:3
    v_mfma_f32_16x16x32_bf16 v[76:79], a[220:223], v[36:39], v[76:79]
    s_xor_b32 s4, s4, s2
    ds_read_b128 v[60:63], v17 offset:4096
    v_mfma_f32_16x16x32_bf16 v[84:87], v[146:149], v[108:111], v[84:87]
    v_mfma_f32_16x16x32_bf16 v[76:79], a[212:215], v[32:35], v[76:79]
    s_waitcnt lgkmcnt(8)
    s_lshl2_add_u32 s4, s4, s3
    ds_read_b64_tr_b16 a[100:101], v13 offset:16384
    ds_read2_b32 a[164:165], v4 offset0:128 offset1:129
    v_mfma_f32_16x16x32_bf16 v[84:87], a[212:215], v[40:43], v[84:87]
    s_bfe_u32 s5, s6, 0x3000a
    ds_read_b128 v[32:35], v17 offset:2048
    ds_read2_b32 a[166:167], v4 offset0:130 offset1:131
    v_mfma_f32_16x16x32_bf16 v[84:87], a[220:223], v[44:47], v[84:87]
    s_lshl3_add_u32 s4, s4, s5
    buffer_load_dwordx4 v11, s[52:55], s14 offen offset:3072 lds
    ds_read_b64_tr_b16 a[102:103], v13 offset:17408
    v_mfma_f32_16x16x32_bf16 v[80:83], a[216:219], v[44:47], v[80:83]
    s_lshl_b32 s4, s4, 10
    ds_read_b128 v[36:39], v17 offset:5120
    ds_read2_b32 a[168:169], v5 offset0:0 offset1:1
    v_mfma_f32_16x16x32_bf16 v[80:83], a[208:211], v[40:43], v[80:83]
    s_waitcnt lgkmcnt(11)
    s_add_u32 s79, s4, 14483456
    ds_read2_b32 a[170:171], v5 offset0:2 offset1:3
    ds_read2_b32 a[172:173], v5 offset0:128 offset1:129
    v_mfma_f32_16x16x32_bf16 v[64:67], a[224:227], v[48:51], v[64:67]
    s_bfe_u32 s4, s6, 0x20012
    ds_read_b128 v[40:43], v17 offset:6144
    s_lshl_b32 s4, s4, 1
    v_mfma_f32_16x16x32_bf16 v[64:67], a[232:235], v[52:55], v[64:67]
    s_xor_b32 s4, s4, s2
    ds_read_b64_tr_b16 a[104:105], v12 offset:24576
    ds_read2_b32 a[174:175], v5 offset0:130 offset1:131
    v_mfma_f32_16x16x32_bf16 v[68:71], a[236:239], v[52:55], v[68:71]
    s_lshl2_add_u32 s4, s4, s3
    ds_read_b128 v[44:47], v17 offset:9216
    s_bfe_u32 s5, s6, 0x3000f
    v_mfma_f32_16x16x32_bf16 v[68:71], a[228:231], v[48:51], v[68:71]
    s_waitcnt lgkmcnt(13)
    s_lshl3_add_u32 s4, s4, s5
    ds_read_b64_tr_b16 a[106:107], v12 offset:25600
    s_lshl_b32 s4, s4, 10
    v_mfma_f32_16x16x32_bf16 v[76:79], a[228:231], v[56:59], v[76:79]
    s_add_u32 s80, s4, 14483456
    ds_read_b128 v[48:51], v17 offset:7168
    ds_read2_b32 a[176:177], v6 offset0:0 offset1:1
    v_mfma_f32_16x16x32_bf16 v[76:79], a[236:239], v[60:63], v[76:79]
    s_bfe_u32 s4, s6, 0x20017
    ds_read2_b32 a[178:179], v6 offset0:2 offset1:3
    v_mfma_f32_16x16x32_bf16 v[72:75], a[232:235], v[60:63], v[72:75]
    s_lshl_b32 s4, s4, 1
    ds_read_b128 v[52:55], v17 offset:10240
    v_mfma_f32_16x16x32_bf16 v[72:75], a[224:227], v[56:59], v[72:75]
    s_waitcnt lgkmcnt(12)
    s_xor_b32 s4, s4, s2
    ds_read_b64_tr_b16 a[108:109], v13 offset:24576
    v_mfma_f32_16x16x32_bf16 v[80:83], a[224:227], v[32:35], v[80:83]
    s_lshl2_add_u32 s4, s4, s3
    ds_read_b128 v[56:59], v17 offset:8192
    ds_read2_b32 a[180:181], v6 offset0:128 offset1:129
    v_mfma_f32_16x16x32_bf16 v[80:83], a[232:235], v[36:39], v[80:83]
    s_bfe_u32 s5, s6, 0x30014
    ds_read_b64_tr_b16 a[110:111], v13 offset:25600
    s_lshl3_add_u32 s4, s4, s5
    v_mfma_f32_16x16x32_bf16 v[84:87], a[236:239], v[36:39], v[84:87]
    s_lshl_b32 s4, s4, 10
    ds_read_b128 v[60:63], v17 offset:11264
    v_mfma_f32_16x16x32_bf16 v[84:87], a[228:231], v[32:35], v[84:87]
    s_waitcnt vmcnt(8) lgkmcnt(1)
    s_barrier
    s_add_u32 s81, s4, 14483456
    ds_read2_b32 a[182:183], v6 offset0:130 offset1:131
    s_bfe_u32 s4, s6, 0x2001c
    v_mfma_f32_16x16x32_bf16 v[68:71], a[244:247], v[40:43], v[68:71]
    s_add_u32 m0, s20, 16384
    s_lshl_b32 s14, s100, 1
    ds_read_b64_tr_b16 a[112:113], v12 offset:32768
    v_mfma_f32_16x16x32_bf16 v[68:71], a[252:255], v[44:47], v[68:71]
    s_lshl_b32 s4, s4, 1
    buffer_load_dwordx4 v8, s[52:55], s14 offen offset:0 lds
    ds_read2_b32 a[184:185], v7 offset0:0 offset1:1
    v_mfma_f32_16x16x32_bf16 v[64:67], a[248:251], v[44:47], v[64:67]
    s_xor_b32 s4, s4, s2
    ds_read_b64_tr_b16 a[114:115], v12 offset:33792
    v_mfma_f32_16x16x32_bf16 v[64:67], a[240:243], v[40:43], v[64:67]
    s_lshl2_add_u32 s4, s4, s3
    buffer_load_dwordx4 v9, s[52:55], s14 offen offset:1024 lds
    ds_read_b64_tr_b16 a[116:117], v13 offset:32768
    v_mfma_f32_16x16x32_bf16 v[72:75], a[240:243], v[48:51], v[72:75]
    s_bfe_u32 s5, s6, 0x30019
    ds_read_b64_tr_b16 a[118:119], v13 offset:33792
    ds_read2_b32 a[186:187], v7 offset0:2 offset1:3
    v_mfma_f32_16x16x32_bf16 v[72:75], a[248:251], v[52:55], v[72:75]
    s_lshl3_add_u32 s4, s4, s5
    buffer_load_dwordx4 v10, s[52:55], s14 offen offset:2048 lds
    ds_read2_b32 a[188:189], v7 offset0:128 offset1:129
    v_mfma_f32_16x16x32_bf16 v[76:79], a[252:255], v[52:55], v[76:79]
    s_lshl_b32 s4, s4, 10
    ds_read_b64_tr_b16 a[120:121], v12 offset:40960
    s_add_u32 s82, s4, 14483456
    v_mfma_f32_16x16x32_bf16 v[76:79], a[244:247], v[48:51], v[76:79]
    s_waitcnt lgkmcnt(9)
    s_lshl2_add_u32 s4, s2, s3
    buffer_load_dwordx4 v11, s[52:55], s14 offen offset:3072 lds
    ds_read_b64_tr_b16 a[122:123], v12 offset:41984
    v_mfma_f32_16x16x32_bf16 v[84:87], a[244:247], v[56:59], v[84:87]
    s_lshl_b32 s4, s4, 13
    ds_read_b64_tr_b16 a[124:125], v13 offset:40960
    v_mfma_f32_16x16x32_bf16 v[84:87], a[252:255], v[60:63], v[84:87]
    s_add_u32 s83, s4, 14483456
    ds_read2_b32 a[190:191], v7 offset0:130 offset1:131
    v_mfma_f32_16x16x32_bf16 v[80:83], a[248:251], v[60:63], v[80:83]
    ds_read_b64_tr_b16 a[126:127], v13 offset:41984
    v_mfma_f32_16x16x32_bf16 v[80:83], a[240:243], v[56:59], v[80:83]
    v_mov_b32 v56, 0xc0135761
    v_pk_mul_f32 v[32:33], v[64:65], v[64:65]
    v_pk_mul_f32 v[34:35], v[66:67], v[66:67]
    v_pk_mul_f32 v[36:37], v[68:69], v[68:69]
    v_pk_mul_f32 v[38:39], v[70:71], v[70:71]
    v_pk_mul_f32 v[40:41], v[72:73], v[72:73]
    v_pk_mul_f32 v[42:43], v[74:75], v[74:75]
    v_pk_mul_f32 v[44:45], v[76:77], v[76:77]
    v_pk_mul_f32 v[46:47], v[78:79], v[78:79]
    v_pk_mul_f32 v[48:49], v[80:81], v[80:81]
    v_pk_mul_f32 v[50:51], v[82:83], v[82:83]
    v_pk_mul_f32 v[52:53], v[84:85], v[84:85]
    v_pk_mul_f32 v[54:55], v[86:87], v[86:87]
    v_pk_fma_f32 v[32:33], v[32:33], s[10:11], v[56:57] op_sel_hi:[1,0,0]
    v_pk_fma_f32 v[34:35], v[34:35], s[10:11], v[56:57] op_sel_hi:[1,0,0]
    v_pk_fma_f32 v[36:37], v[36:37], s[10:11], v[56:57] op_sel_hi:[1,0,0]
    v_pk_fma_f32 v[38:39], v[38:39], s[10:11], v[56:57] op_sel_hi:[1,0,0]
    v_pk_fma_f32 v[40:41], v[40:41], s[10:11], v[56:57] op_sel_hi:[1,0,0]
    v_pk_fma_f32 v[42:43], v[42:43], s[10:11], v[56:57] op_sel_hi:[1,0,0]
    v_pk_fma_f32 v[44:45], v[44:45], s[10:11], v[56:57] op_sel_hi:[1,0,0]
    v_pk_fma_f32 v[46:47], v[46:47], s[10:11], v[56:57] op_sel_hi:[1,0,0]
    v_pk_fma_f32 v[48:49], v[48:49], s[10:11], v[56:57] op_sel_hi:[1,0,0]
    v_pk_fma_f32 v[50:51], v[50:51], s[10:11], v[56:57] op_sel_hi:[1,0,0]
    v_pk_fma_f32 v[52:53], v[52:53], s[10:11], v[56:57] op_sel_hi:[1,0,0]
    v_pk_fma_f32 v[54:55], v[54:55], s[10:11], v[56:57] op_sel_hi:[1,0,0]
    v_pk_mul_f32 v[32:33], v[32:33], v[64:65]
    v_pk_mul_f32 v[34:35], v[34:35], v[66:67]
    v_pk_mul_f32 v[36:37], v[36:37], v[68:69]
    v_pk_mul_f32 v[38:39], v[38:39], v[70:71]
    v_pk_mul_f32 v[40:41], v[40:41], v[72:73]
    v_pk_mul_f32 v[42:43], v[42:43], v[74:75]
    v_pk_mul_f32 v[44:45], v[44:45], v[76:77]
    v_pk_mul_f32 v[46:47], v[46:47], v[78:79]
    v_pk_mul_f32 v[48:49], v[48:49], v[80:81]
    v_pk_mul_f32 v[50:51], v[50:51], v[82:83]
    v_pk_mul_f32 v[52:53], v[52:53], v[84:85]
    v_pk_mul_f32 v[54:55], v[54:55], v[86:87]
    v_exp_f32 v32, v32
    v_exp_f32 v33, v33
    v_exp_f32 v34, v34
    v_exp_f32 v35, v35
    v_exp_f32 v36, v36
    v_exp_f32 v37, v37
    v_exp_f32 v38, v38
    v_exp_f32 v39, v39
    v_exp_f32 v40, v40
    v_exp_f32 v41, v41
    v_exp_f32 v42, v42
    v_exp_f32 v43, v43
    v_exp_f32 v44, v44
    v_exp_f32 v45, v45
    v_exp_f32 v46, v46
    v_exp_f32 v47, v47
    v_exp_f32 v48, v48
    v_exp_f32 v49, v49
    v_exp_f32 v50, v50
    v_exp_f32 v51, v51
    v_exp_f32 v52, v52
    v_exp_f32 v53, v53
    v_exp_f32 v54, v54
    v_exp_f32 v55, v55
    v_pk_add_f32 v[32:33], v[32:33], 1.0 op_sel_hi:[1,0]
    v_pk_add_f32 v[34:35], v[34:35], 1.0 op_sel_hi:[1,0]
    v_pk_add_f32 v[36:37], v[36:37], 1.0 op_sel_hi:[1,0]
    v_pk_add_f32 v[38:39], v[38:39], 1.0 op_sel_hi:[1,0]
    v_pk_add_f32 v[40:41], v[40:41], 1.0 op_sel_hi:[1,0]
    v_pk_add_f32 v[42:43], v[42:43], 1.0 op_sel_hi:[1,0]
    v_pk_add_f32 v[44:45], v[44:45], 1.0 op_sel_hi:[1,0]
    v_pk_add_f32 v[46:47], v[46:47], 1.0 op_sel_hi:[1,0]
    v_pk_add_f32 v[48:49], v[48:49], 1.0 op_sel_hi:[1,0]
    v_pk_add_f32 v[50:51], v[50:51], 1.0 op_sel_hi:[1,0]
    v_pk_add_f32 v[52:53], v[52:53], 1.0 op_sel_hi:[1,0]
    v_pk_add_f32 v[54:55], v[54:55], 1.0 op_sel_hi:[1,0]
    v_rcp_f32 v32, v32
    v_rcp_f32 v33, v33
    v_rcp_f32 v34, v34
    v_rcp_f32 v35, v35
    v_rcp_f32 v36, v36
    v_rcp_f32 v37, v37
    v_rcp_f32 v38, v38
    v_rcp_f32 v39, v39
    v_pk_mul_f32 v[32:33], v[64:65], v[32:33]
    v_pk_mul_f32 v[34:35], v[66:67], v[34:35]
    v_pk_mul_f32 v[36:37], v[68:69], v[36:37]
    v_pk_mul_f32 v[38:39], v[70:71], v[38:39]
    v_cvt_pk_bf16_f32 v64, v32, v33
    v_cvt_pk_bf16_f32 v65, v34, v35
    v_cvt_pk_bf16_f32 v66, v36, v37
    v_cvt_pk_bf16_f32 v67, v38, v39
    s_bfe_u32 s11, s31, 0x30009
    s_lshl_b32 s11, s11, 8
    s_add_u32 s11, s11, s30
    buffer_store_dwordx4 v[64:67], v22, s[44:47], s11 offen sc1
    v_rcp_f32 v40, v40
    v_rcp_f32 v41, v41
    v_rcp_f32 v42, v42
    v_rcp_f32 v43, v43
    v_rcp_f32 v44, v44
    v_rcp_f32 v45, v45
    v_rcp_f32 v46, v46
    v_rcp_f32 v47, v47
    v_pk_mul_f32 v[40:41], v[72:73], v[40:41]
    v_pk_mul_f32 v[42:43], v[74:75], v[42:43]
    v_pk_mul_f32 v[44:45], v[76:77], v[44:45]
    v_pk_mul_f32 v[46:47], v[78:79], v[46:47]
    v_cvt_pk_bf16_f32 v72, v40, v41
    v_cvt_pk_bf16_f32 v73, v42, v43
    v_cvt_pk_bf16_f32 v74, v44, v45
    v_cvt_pk_bf16_f32 v75, v46, v47
    s_bfe_u32 s11, s31, 0x3000c
    s_lshl_b32 s11, s11, 8
    s_add_u32 s11, s11, s30
    buffer_store_dwordx4 v[72:75], v22, s[44:47], s11 offen sc1
    v_rcp_f32 v48, v48
    v_rcp_f32 v49, v49
    v_rcp_f32 v50, v50
    v_rcp_f32 v51, v51
    v_rcp_f32 v52, v52
    v_rcp_f32 v53, v53
    v_rcp_f32 v54, v54
    v_rcp_f32 v55, v55
    v_pk_mul_f32 v[48:49], v[80:81], v[48:49]
    v_pk_mul_f32 v[50:51], v[82:83], v[50:51]
    v_pk_mul_f32 v[52:53], v[84:85], v[52:53]
    v_pk_mul_f32 v[54:55], v[86:87], v[54:55]
    v_cvt_pk_bf16_f32 v80, v48, v49
    v_cvt_pk_bf16_f32 v81, v50, v51
    v_cvt_pk_bf16_f32 v82, v52, v53
    v_cvt_pk_bf16_f32 v83, v54, v55
    s_bfe_u32 s11, s31, 0x3000f
    s_lshl_b32 s11, s11, 8
    s_add_u32 s11, s11, s30
    buffer_store_dwordx4 v[80:83], v22, s[44:47], s11 offen sc1
L_D:
L_pl_S_0:
    s_cbranch_execz L_wret
    v_mfma_f32_16x16x32_bf16 v[112:115], a[160:163], a[128:131], 0
    v_mfma_f32_16x16x32_bf16 v[116:119], a[160:163], a[132:135], 0
    v_mfma_f32_16x16x32_bf16 v[120:123], a[160:163], a[136:139], 0
    buffer_load_dword v27, v26, s[44:47], 0 offen offset:0 sc1
    v_mfma_f32_16x16x32_bf16 v[124:127], a[160:163], a[140:143], 0
    v_mfma_f32_16x16x32_bf16 v[128:131], a[160:163], a[144:147], 0
    v_mfma_f32_16x16x32_bf16 v[132:135], a[160:163], a[148:151], 0
    v_mfma_f32_16x16x32_bf16 v[136:139], a[160:163], a[152:155], 0
    v_mfma_f32_16x16x32_bf16 v[140:143], a[160:163], a[156:159], 0
    v_mfma_f32_16x16x32_bf16 v[116:119], a[164:167], a[128:131], v[116:119]
    v_mfma_f32_16x16x32_bf16 v[120:123], a[164:167], a[132:135], v[120:123]
    ds_read2_b32 a[160:161], v7 offset0:144 offset1:145
    v_mfma_f32_16x16x32_bf16 v[124:127], a[164:167], a[136:139], v[124:127]
    v_mfma_f32_16x16x32_bf16 v[128:131], a[164:167], a[140:143], v[128:131]
    s_waitcnt vmcnt(9) lgkmcnt(1)
    s_barrier
    ds_read2_b32 a[162:163], v7 offset0:146 offset1:147
    v_mfma_f32_16x16x32_bf16 v[132:135], a[164:167], a[144:147], v[132:135]
    s_add_u32 m0, s20, 32768
    s_lshl_b32 s14, s101, 1
    ds_read_b64_tr_b16 a[192:193], v12 offset:49152
    v_mfma_f32_16x16x32_bf16 v[136:139], a[164:167], a[148:151], v[136:139]
    ds_read_b128 a[156:159], v30 offset:0
    buffer_load_dwordx4 v8, s[52:55], s14 offen offset:0 lds
    v_mfma_f32_16x16x32_bf16 v[140:143], a[164:167], a[152:155], v[140:143]
    ds_read_b64_tr_b16 a[194:195], v12 offset:50176
    v_mfma_f32_16x16x32_bf16 v[120:123], a[168:171], a[128:131], v[120:123]
    buffer_load_dwordx4 v9, s[52:55], s14 offen offset:1024 lds
    ds_read_b64_tr_b16 a[196:197], v13 offset:49152
    v_mfma_f32_16x16x32_bf16 v[124:127], a[168:171], a[132:135], v[124:127]
    ds_read2_b32 a[164:165], v7 offset0:16 offset1:17
    v_mfma_f32_16x16x32_bf16 v[128:131], a[168:171], a[136:139], v[128:131]
    buffer_load_dwordx4 v10, s[52:55], s14 offen offset:2048 lds
    ds_read_b64_tr_b16 a[198:199], v13 offset:50176
    v_mfma_f32_16x16x32_bf16 v[132:135], a[168:171], a[140:143], v[132:135]
    ds_read2_b32 a[166:167], v7 offset0:18 offset1:19
    v_mfma_f32_16x16x32_bf16 v[136:139], a[168:171], a[144:147], v[136:139]
    buffer_load_dwordx4 v11, s[52:55], s14 offen offset:3072 lds
    ds_read_b64_tr_b16 a[200:201], v12 offset:57344
    v_mfma_f32_16x16x32_bf16 v[140:143], a[168:171], a[148:151], v[140:143]
    ds_read_b128 a[152:155], v30 offset:512
    v_mfma_f32_16x16x32_bf16 v[124:127], a[172:175], a[128:131], v[124:127]
    ds_read_b64_tr_b16 a[202:203], v12 offset:58368
    v_mfma_f32_16x16x32_bf16 v[128:131], a[172:175], a[132:135], v[128:131]
    ds_read2_b32 a[168:169], v6 offset0:144 offset1:145
    v_mfma_f32_16x16x32_bf16 v[132:135], a[172:175], a[136:139], v[132:135]
    ds_read_b64_tr_b16 a[204:205], v13 offset:57344
    v_mfma_f32_16x16x32_bf16 v[136:139], a[172:175], a[140:143], v[136:139]
    s_waitcnt vmcnt(4)
    ds_read2_b32 a[170:171], v6 offset0:146 offset1:147
    v_mfma_f32_16x16x32_bf16 v[140:143], a[172:175], a[144:147], v[140:143]
    v_cmp_ne_u32 vcc, s16, v27
    s_cbranch_vccnz L_rs_p1
L_ok_p1:
    v_mfma_f32_16x16x32_bf16 v[128:131], a[176:179], a[128:131], v[128:131]
    s_add_u32 m0, s21, 12288
    ds_read_b128 a[148:151], v30 offset:1024
    v_add_u32 v18, s68, v22
    v_mfma_f32_16x16x32_bf16 v[132:135], a[176:179], a[132:135], v[132:135]
    ds_read2_b32 a[172:173], v6 offset0:16 offset1:17
    buffer_load_dwordx4 v18, s[44:47], s84 offen offset:0 sc1 lds
    v_mfma_f32_16x16x32_bf16 v[136:139], a[176:179], a[136:139], v[136:139]
    v_add_u32 v26, 9216, v26
    v_add_u32 v19, -1024, v18
    v_mfma_f32_16x16x32_bf16 v[140:143], a[176:179], a[140:143], v[140:143]
    ds_read2_b32 a[174:175], v6 offset0:18 offset1:19
    buffer_load_dwordx4 v19, s[44:47], s85 offen offset:1024 sc1 lds
    v_mfma_f32_16x16x32_bf16 v[132:135], a[180:183], a[128:131], v[132:135]
    ds_read2_b32 a[176:177], v5 offset0:144 offset1:145
    v_add_u32 v20, -2048, v18
    v_mfma_f32_16x16x32_bf16 v[136:139], a[180:183], a[132:135], v[136:139]
    ds_read_b128 a[144:147], v30 offset:1536
    buffer_load_dwordx4 v20, s[44:47], s86 offen offset:2048 sc1 lds
    v_mfma_f32_16x16x32_bf16 v[140:143], a[180:183], a[136:139], v[140:143]
    s_add_u32 m0, s21, 24576
    ds_read_b64_tr_b16 a[206:207], v13 offset:58368
    v_mfma_f32_16x16x32_bf16 v[136:139], a[184:187], a[128:131], v[136:139]
    ds_read2_b32 a[178:179], v5 offset0:146 offset1:147
    buffer_load_dwordx4 v18, s[44:47], s87 offen offset:0 sc1 lds
    v_mfma_f32_16x16x32_bf16 v[140:143], a[184:187], a[132:135], v[140:143]
    ds_read2_b32 a[180:181], v5 offset0:16 offset1:17
    v_mfma_f32_16x16x32_bf16 v[140:143], a[188:191], a[128:131], v[140:143]
    s_waitcnt lgkmcnt(2)
    s_barrier
    ds_read_b128 a[140:143], v30 offset:2048
    v_mfma_f32_16x16x32_bf16 v[140:143], a[160:163], a[156:159], v[140:143]
    ds_read2_b32 a[182:183], v5 offset0:18 offset1:19
    v_mfma_f32_16x16x32_bf16 v[136:139], a[164:167], a[156:159], v[136:139]
    ds_read2_b32 a[184:185], v4 offset0:144 offset1:145
    buffer_load_dwordx4 v19, s[44:47], s88 offen offset:1024 sc1 lds
    v_mfma_f32_16x16x32_bf16 v[140:143], a[164:167], a[152:155], v[140:143]
    ds_read_b128 a[136:139], v30 offset:2560
    v_mfma_f32_16x16x32_bf16 v[132:135], a[168:171], a[156:159], v[132:135]
    ds_read2_b32 a[186:187], v4 offset0:146 offset1:147
    buffer_load_dwordx4 v20, s[44:47], s89 offen offset:2048 sc1 lds
    v_mfma_f32_16x16x32_bf16 v[136:139], a[168:171], a[152:155], v[136:139]
    ds_read2_b32 a[188:189], v4 offset0:16 offset1:17
    s_add_u32 m0, s21, 36864
    v_mfma_f32_16x16x32_bf16 v[140:143], a[168:171], a[148:151], v[140:143]
    ds_read2_b32 a[190:191], v4 offset0:18 offset1:19
    buffer_load_dwordx4 v18, s[44:47], s90 offen offset:0 sc1 lds
    v_mfma_f32_16x16x32_bf16 v[128:131], a[172:175], a[156:159], v[128:131]
    ds_read_b128 a[132:135], v30 offset:3072
    v_mfma_f32_16x16x32_bf16 v[132:135], a[172:175], a[152:155], v[132:135]
    ds_read_b128 a[128:131], v30 offset:3584
    buffer_load_dwordx4 v19, s[44:47], s91 offen offset:1024 sc1 lds
    v_mfma_f32_16x16x32_bf16 v[136:139], a[172:175], a[148:151], v[136:139]
    ds_read_b64_tr_b16 a[208:209], v12 offset:0
    v_mfma_f32_16x16x32_bf16 v[140:143], a[172:175], a[144:147], v[140:143]
    s_waitcnt lgkmcnt(11)
    buffer_load_dwordx4 v20, s[44:47], s92 offen offset:2048 sc1 lds
    ds_read_b64_tr_b16 a[210:211], v12 offset:1024
    v_mfma_f32_16x16x32_bf16 v[124:127], a[176:179], a[156:159], v[124:127]
    ds_read_b64_tr_b16 a[212:213], v13 offset:0
    v_mfma_f32_16x16x32_bf16 v[128:131], a[176:179], a[152:155], v[128:131]
    ds_read_b64_tr_b16 a[214:215], v13 offset:1024
    v_mfma_f32_16x16x32_bf16 v[132:135], a[176:179], a[148:151], v[132:135]
    s_add_u32 m0, s21, 49152
    ds_read_b64_tr_b16 a[216:217], v12 offset:8192
    v_mfma_f32_16x16x32_bf16 v[136:139], a[176:179], a[144:147], v[136:139]
    s_waitcnt lgkmcnt(13)
    buffer_load_dwordx4 v18, s[44:47], s93 offen offset:0 sc1 lds
    v_mfma_f32_16x16x32_bf16 v[140:143], a[176:179], a[140:143], v[140:143]
    s_waitcnt lgkmcnt(12)
    v_mfma_f32_16x16x32_bf16 v[120:123], a[180:183], a[156:159], v[120:123]
    ds_read_b64_tr_b16 a[218:219], v12 offset:9216
    v_mfma_f32_16x16x32_bf16 v[124:127], a[180:183], a[152:155], v[124:127]
    s_cmp_lt_u32 s3, 2
    s_cselect_b32 s84, s84, s85
    v_mfma_f32_16x16x32_bf16 v[128:131], a[180:183], a[148:151], v[128:131]
    s_lshl_b32 s8, s3, 13
    buffer_load_dwordx4 v19, s[44:47], s94 offen offset:1024 sc1 lds
    v_mfma_f32_16x16x32_bf16 v[132:135], a[180:183], a[144:147], v[132:135]
    ds_read_b64_tr_b16 a[220:221], v13 offset:8192
    v_mfma_f32_16x16x32_bf16 v[136:139], a[180:183], a[140:143], v[136:139]
    s_waitcnt lgkmcnt(12)
    v_mfma_f32_16x16x32_bf16 v[140:143], a[180:183], a[136:139], v[140:143]
    s_waitcnt lgkmcnt(11)
    v_mfma_f32_16x16x32_bf16 v[116:119], a[184:187], a[156:159], v[116:119]
    buffer_load_dwordx4 v20, s[44:47], s95 offen offset:2048 sc1 lds
    ds_read_b64_tr_b16 a[222:223], v13 offset:9216
    v_mfma_f32_16x16x32_bf16 v[120:123], a[184:187], a[152:155], v[120:123]
    v_mfma_f32_16x16x32_bf16 v[124:127], a[184:187], a[148:151], v[124:127]
    s_waitcnt vmcnt(9) lgkmcnt(0)
    s_barrier
    s_add_u32 s8, s8, 65536
    v_mfma_f32_16x16x32_bf16 v[128:131], a[184:187], a[144:147], v[128:131]
    s_add_u32 m0, s21, 61440
    ds_read_b128 v[32:35], v16 offset:12288
    ds_read_b64_tr_b16 a[240:241], v12 offset:32768
    v_mfma_f32_16x16x32_bf16 v[132:135], a[184:187], a[140:143], v[132:135]
    buffer_load_dwordx4 v18, s[44:47], s96 offen offset:0 sc1 lds
    ds_read_b64_tr_b16 a[224:225], v12 offset:16384
    v_mfma_f32_16x16x32_bf16 v[136:139], a[184:187], a[136:139], v[136:139]
    ds_read_b128 v[36:39], v16 offset:15360
    buffer_store_dword v24, v25, s[44:47], s32 offen sc1
    v_mfma_f32_16x16x32_bf16 v[140:143], a[184:187], a[132:135], v[140:143]
    ds_read_b64_tr_b16 a[226:227], v12 offset:17408
    v_mfma_f32_16x16x32_bf16 v[112:115], a[188:191], a[156:159], v[112:115]
    ds_read_b128 v[40:43], v16 offset:18432
    v_mfma_f32_16x16x32_bf16 v[116:119], a[188:191], a[152:155], v[116:119]
    buffer_load_dwordx4 v19, s[44:47], s97 offen offset:1024 sc1 lds
    ds_read_b64_tr_b16 a[242:243], v12 offset:33792
    v_mfma_f32_16x16x32_bf16 v[120:123], a[188:191], a[148:151], v[120:123]
    ds_read_b128 v[44:47], v16 offset:21504
    v_add_u32 v30, s8, v21
    v_mfma_f32_16x16x32_bf16 v[124:127], a[188:191], a[144:147], v[124:127]
    ds_read_b64_tr_b16 a[228:229], v13 offset:16384
    ds_read_b64_tr_b16 a[244:245], v13 offset:32768
    v_mfma_f32_16x16x32_bf16 v[128:131], a[188:191], a[140:143], v[128:131]
    s_cmp_lt_u32 s3, 2
    s_cselect_b32 s90, s90, s91
    ds_read_b128 v[48:51], v16 offset:13312
    v_mfma_f32_16x16x32_bf16 v[132:135], a[188:191], a[136:139], v[132:135]
    s_lshl_b32 s8, s3, 11
    buffer_load_dwordx4 v20, s[44:47], s98 offen offset:2048 sc1 lds
    ds_read_b64_tr_b16 a[230:231], v13 offset:17408
    v_mfma_f32_16x16x32_bf16 v[136:139], a[188:191], a[132:135], v[136:139]
    ds_read_b128 v[52:55], v16 offset:16384
    s_add_u32 s8, s8, 65536
    ds_write_b128 v30, v[112:115] offset:0
    v_mfma_f32_16x16x32_bf16 v[140:143], a[188:191], a[128:131], v[140:143]
    s_waitcnt lgkmcnt(10)
    ds_read_b64_tr_b16 a[246:247], v13 offset:33792
    v_add_u32 v4, s8, v21
    v_mfma_f32_16x16x32_bf16 v[64:67], v[32:35], v[156:159], 0
    ds_read_b128 v[56:59], v16 offset:19456
    ds_read_b64_tr_b16 a[248:249], v12 offset:40960
    ds_write_b128 v30, v[116:119] offset:1024
    v_mfma_f32_16x16x32_bf16 v[64:67], v[36:39], v[164:167], v[64:67]
    ds_read_b64_tr_b16 a[232:233], v12 offset:24576
    v_and_b32 v1, 15, v2
    v_mfma_f32_16x16x32_bf16 v[68:71], v[36:39], v[168:171], 0
    ds_read_b128 v[60:63], v16 offset:22528
    v_lshlrev_b32 v1, 5, v1
    ds_write_b128 v30, v[120:123] offset:2048
    v_mfma_f32_16x16x32_bf16 v[68:71], v[32:35], v[160:163], v[68:71]
    s_waitcnt lgkmcnt(13)
    ds_read_b64_tr_b16 a[234:235], v12 offset:25600
    ds_read_b64_tr_b16 a[250:251], v12 offset:41984
    ds_write_b128 v30, v[124:127] offset:3072
    v_mfma_f32_16x16x32_bf16 v[76:79], v[40:43], v[160:163], 0
    ds_read_b128 v[32:35], v16 offset:14336
    v_lshrrev_b32 v31, 4, v2
    v_mfma_f32_16x16x32_bf16 v[76:79], v[44:47], v[168:171], v[76:79]
    ds_read_b64_tr_b16 a[252:253], v13 offset:40960
    v_lshl_add_u32 v1, v31, 3, v1
    ds_write_b128 v30, v[128:131] offset:4096
    v_mfma_f32_16x16x32_bf16 v[72:75], v[44:47], v[164:167], 0
    s_lshl_b32 s8, s3, 10
    ds_read_b128 v[36:39], v16 offset:17408
    ds_write_b128 v30, v[132:135] offset:5120
    v_mfma_f32_16x16x32_bf16 v[72:75], v[40:43], v[156:159], v[72:75]
    s_waitcnt lgkmcnt(15)
    ds_read_b64_tr_b16 a[236:237], v13 offset:24576
    v_add_u32 v5, s8, v1
    v_mfma_f32_16x16x32_bf16 v[64:67], v[48:51], v[172:175], v[64:67]
    s_lshl_b32 s15, s34, 12
    ds_read_b128 v[40:43], v16 offset:20480
    ds_write_b128 v30, v[136:139] offset:6144
    v_mfma_f32_16x16x32_bf16 v[64:67], v[52:55], v[180:183], v[64:67]
    s_add_u32 s15, s15, 6356992
    ds_read_b64_tr_b16 a[238:239], v13 offset:25600
    ds_read_b64_tr_b16 a[254:255], v13 offset:41984
    v_mfma_f32_16x16x32_bf16 v[68:71], v[52:55], v[184:187], v[68:71]
    ds_read_b128 v[44:47], v16 offset:23552
    ds_write_b128 v30, v[140:143] offset:7168
    v_mfma_f32_16x16x32_bf16 v[68:71], v[48:51], v[176:179], v[68:71]
    s_waitcnt vmcnt(10) lgkmcnt(0)
    s_barrier
    s_cmp_lt_u32 s3, 2
    s_cselect_b32 s86, s86, s87
    v_accvgpr_write_b32 a128, v146
    v_mfma_f32_16x16x32_bf16 v[76:79], v[56:59], v[176:179], v[76:79]
    ds_read_b128 v[48:51], v16 offset:24576
    v_mfma_f32_16x16x32_bf16 v[76:79], v[60:63], v[184:187], v[76:79]
    ds_read_b128 v[112:115], v4 offset:0
    v_mfma_f32_16x16x32_bf16 v[72:75], v[60:63], v[180:183], v[72:75]
    ds_read_b128 v[52:55], v16 offset:27648
    v_mfma_f32_16x16x32_bf16 v[72:75], v[56:59], v[172:175], v[72:75]
    ds_read_b128 v[116:119], v4 offset:8192
    v_mfma_f32_16x16x32_bf16 v[64:67], v[32:35], v[188:191], v[64:67]
    ds_read_b128 v[56:59], v16 offset:30720
    v_mfma_f32_16x16x32_bf16 v[64:67], v[36:39], v[196:199], v[64:67]
    ds_read_b128 v[120:123], v4 offset:16384
    v_mfma_f32_16x16x32_bf16 v[68:71], v[36:39], v[200:203], v[68:71]
    ds_read_b128 v[60:63], v16 offset:33792
    v_mfma_f32_16x16x32_bf16 v[68:71], v[32:35], v[192:195], v[68:71]
    ds_read_b128 v[124:127], v4 offset:24576
    v_accvgpr_write_b32 a129, v147
    v_mfma_f32_16x16x32_bf16 v[76:79], v[40:43], v[192:195], v[76:79]
    ds_read_b128 v[32:35], v16 offset:25600
    v_mfma_f32_16x16x32_bf16 v[76:79], v[44:47], v[200:203], v[76:79]
    ds_read_b128 v[128:131], v4 offset:1024
    v_mfma_f32_16x16x32_bf16 v[72:75], v[44:47], v[196:199], v[72:75]
    ds_read_b128 v[36:39], v16 offset:28672
    v_mfma_f32_16x16x32_bf16 v[72:75], v[40:43], v[188:191], v[72:75]
    s_waitcnt lgkmcnt(8)
    s_cmp_lt_u32 s3, 2
    s_cselect_b32 s92, s92, s93
    ds_read_b128 v[132:135], v4 offset:9216
    v_mfma_f32_16x16x32_bf16 v[64:67], v[48:51], v[204:207], v[64:67]
    ds_read_b128 v[40:43], v16 offset:31744
    v_mfma_f32_16x16x32_bf16 v[64:67], v[52:55], v[212:215], v[64:67]
    v_mfma_f32_16x16x32_bf16 v[68:71], v[52:55], v[216:219], v[68:71]
    ds_read_b128 v[44:47], v16 offset:34816
    v_mfma_f32_16x16x32_bf16 v[68:71], v[48:51], v[208:211], v[68:71]
    s_waitcnt lgkmcnt(7)
    ds_read_b128 v[136:139], v4 offset:17408
    v_mfma_f32_16x16x32_bf16 v[76:79], v[56:59], v[208:211], v[76:79]
    ds_read_b128 v[48:51], v16 offset:26624
    v_mfma_f32_16x16x32_bf16 v[76:79], v[60:63], v[216:219], v[76:79]
    ds_read_b128 v[140:143], v4 offset:25600
    v_accvgpr_write_b32 a130, v148
    v_mfma_f32_16x16x32_bf16 v[72:75], v[60:63], v[212:215], v[72:75]
    s_cmp_lt_u32 s3, 2
    s_cselect_b32 s88, s88, s89
    ds_read_b128 v[52:55], v16 offset:29696
    v_mfma_f32_16x16x32_bf16 v[72:75], v[56:59], v[204:207], v[72:75]
    s_waitcnt lgkmcnt(7)
    v_mfma_f32_16x16x32_bf16 v[64:67], v[32:35], v[220:223], v[64:67]
    ds_read_b128 v[56:59], v16 offset:32768
    v_accvgpr_write_b32 a131, v149
    v_mfma_f32_16x16x32_bf16 v[64:67], v[36:39], v[228:231], v[64:67]
    v_add_f32 v112, v112, v116
    v_add_f32 v113, v113, v117
    v_mfma_f32_16x16x32_bf16 v[68:71], v[36:39], v[232:235], v[68:71]
    ds_read_b128 v[60:63], v16 offset:35840
    v_add_f32 v114, v114, v118
L_pl_S_1:
    s_cbranch_execz L_wret
    v_mfma_f32_16x16x32_bf16 v[68:71], v[32:35], v[224:227], v[68:71]
    s_waitcnt vmcnt(7) lgkmcnt(3)
    s_barrier
    v_add_f32 v115, v115, v119
    v_add_f32 v120, v120, v124
    v_mfma_f32_16x16x32_bf16 v[76:79], v[40:43], v[224:227], v[76:79]
    s_add_u32 m0, s21, 0
    ds_read_b128 v[32:35], v17 offset:0
    v_add_f32 v121, v121, v125
    v_mfma_f32_16x16x32_bf16 v[76:79], v[44:47], v[232:235], v[76:79]
    buffer_load_dwordx4 v18, s[44:47], s99 offen offset:0 sc1 lds
    v_add_f32 v122, v122, v126
    v_mfma_f32_16x16x32_bf16 v[72:75], v[44:47], v[228:231], v[72:75]
    ds_read_b128 v[36:39], v17 offset:3072
    v_add_f32 v123, v123, v127
    v_mfma_f32_16x16x32_bf16 v[72:75], v[40:43], v[220:223], v[72:75]
    s_waitcnt lgkmcnt(4)
    buffer_load_dwordx4 v19, s[44:47], s100 offen offset:1024 sc1 lds
    v_add_f32 v112, v112, v120
    v_mfma_f32_16x16x32_bf16 v[64:67], v[48:51], v[236:239], v[64:67]
    ds_read_b128 v[40:43], v17 offset:6144
    v_add_f32 v113, v113, v121
    v_mfma_f32_16x16x32_bf16 v[64:67], v[52:55], v[244:247], v[64:67]
    buffer_load_dwordx4 v20, s[44:47], s101 offen offset:2048 sc1 lds
    v_add_f32 v114, v114, v122
    v_mfma_f32_16x16x32_bf16 v[68:71], v[52:55], v[248:251], v[68:71]
    s_add_u32 m0, s21, 12288
    ds_read_b128 v[44:47], v17 offset:9216
    v_add_u32 v18, s70, v22
    v_mfma_f32_16x16x32_bf16 v[68:71], v[48:51], v[240:243], v[68:71]
    s_waitcnt lgkmcnt(4)
    buffer_load_dwordx4 v18, s[44:47], s84 offen offset:0 sc1 lds
    v_add_f32 v115, v115, v123
    v_mfma_f32_16x16x32_bf16 v[76:79], v[56:59], v[240:243], v[76:79]
    ds_read_b128 v[48:51], v17 offset:1024
    v_add_u32 v19, -1024, v18
    v_mfma_f32_16x16x32_bf16 v[76:79], v[60:63], v[248:251], v[76:79]
    buffer_load_dwordx4 v19, s[44:47], s86 offen offset:1024 sc1 lds
    v_cvt_pk_bf16_f32 v112, v112, v113
    v_mfma_f32_16x16x32_bf16 v[72:75], v[60:63], v[244:247], v[72:75]
    ds_read_b128 v[52:55], v17 offset:4096
    v_add_u32 v20, -2048, v18
    v_mfma_f32_16x16x32_bf16 v[72:75], v[56:59], v[236:239], v[72:75]
    s_waitcnt lgkmcnt(4)
    buffer_load_dwordx4 v20, s[44:47], s88 offen offset:2048 sc1 lds
    v_cvt_pk_bf16_f32 v113, v114, v115
    v_mfma_f32_16x16x32_bf16 v[64:67], v[32:35], a[0:3], v[64:67]
    ds_read_b128 v[56:59], v17 offset:7168
    buffer_store_dwordx2 v[112:113], v5, s[44:47], s15 offen offset:0 sc1
    v_mfma_f32_16x16x32_bf16 v[64:67], v[36:39], a[8:11], v[64:67]
    v_add_f32 v128, v128, v132
    v_add_f32 v129, v129, v133
    v_mfma_f32_16x16x32_bf16 v[68:71], v[36:39], a[12:15], v[68:71]
    ds_read_b128 v[60:63], v17 offset:10240
    v_add_f32 v130, v130, v134
    v_mfma_f32_16x16x32_bf16 v[68:71], v[32:35], a[4:7], v[68:71]
    s_waitcnt lgkmcnt(4)
    s_cmp_lt_u32 s3, 2
    s_cselect_b32 s94, s94, s95
    v_add_f32 v131, v131, v135
    v_mfma_f32_16x16x32_bf16 v[76:79], v[40:43], a[4:7], v[76:79]
    ds_read_b128 v[32:35], v17 offset:2048
    v_add_f32 v136, v136, v140
    v_mfma_f32_16x16x32_bf16 v[76:79], v[44:47], a[12:15], v[76:79]
    v_add_f32 v137, v137, v141
    v_add_f32 v138, v138, v142
    v_mfma_f32_16x16x32_bf16 v[72:75], v[44:47], a[8:11], v[72:75]
    ds_read_b128 v[36:39], v17 offset:5120
    v_add_f32 v139, v139, v143
    v_mfma_f32_16x16x32_bf16 v[72:75], v[40:43], a[0:3], v[72:75]
    s_waitcnt lgkmcnt(4)
    v_add_f32 v128, v128, v136
    v_add_f32 v129, v129, v137
    v_mfma_f32_16x16x32_bf16 v[64:67], v[48:51], a[16:19], v[64:67]
    ds_read_b128 v[40:43], v17 offset:8192
    v_add_f32 v130, v130, v138
    v_mfma_f32_16x16x32_bf16 v[64:67], v[52:55], a[24:27], v[64:67]
    v_add_f32 v131, v131, v139
    v_cvt_pk_bf16_f32 v128, v128, v129
    v_mfma_f32_16x16x32_bf16 v[68:71], v[52:55], a[28:31], v[68:71]
    ds_read_b128 v[44:47], v17 offset:11264
    v_cvt_pk_bf16_f32 v129, v130, v131
    v_mfma_f32_16x16x32_bf16 v[68:71], v[48:51], a[20:23], v[68:71]
    s_waitcnt vmcnt(11) lgkmcnt(4)
    s_barrier
    buffer_store_dwordx2 v[128:129], v5, s[44:47], s15 offen offset:512 sc1
    v_mfma_f32_16x16x32_bf16 v[76:79], v[56:59], a[20:23], v[76:79]
    s_add_u32 m0, s21, 24576
    ds_read_b128 v[48:51], v17 offset:12288
    v_accvgpr_write_b32 a132, v150
    v_mfma_f32_16x16x32_bf16 v[76:79], v[60:63], a[28:31], v[76:79]
    s_cmp_lt_u32 s3, 2
    s_cselect_b32 s96, s96, s97
    buffer_load_dwordx4 v18, s[44:47], s90 offen offset:0 sc1 lds
    v_mfma_f32_16x16x32_bf16 v[72:75], v[60:63], a[24:27], v[72:75]
    ds_read_b128 v[52:55], v17 offset:15360
    v_mfma_f32_16x16x32_bf16 v[72:75], v[56:59], a[16:19], v[72:75]
    s_waitcnt lgkmcnt(4)
    s_cmp_lt_u32 s3, 2
    s_cselect_b32 s98, s98, s99
    buffer_load_dwordx4 v19, s[44:47], s92 offen offset:1024 sc1 lds
    v_mfma_f32_16x16x32_bf16 v[64:67], v[32:35], a[32:35], v[64:67]
    ds_read_b128 v[56:59], v17 offset:18432
    v_accvgpr_write_b32 a133, v151
    v_mfma_f32_16x16x32_bf16 v[64:67], v[36:39], a[40:43], v[64:67]
    buffer_load_dwordx4 v20, s[44:47], s94 offen offset:2048 sc1 lds
    v_mfma_f32_16x16x32_bf16 v[68:71], v[36:39], a[44:47], v[68:71]
    ds_read_b128 v[60:63], v17 offset:21504
    v_mfma_f32_16x16x32_bf16 v[68:71], v[32:35], a[36:39], v[68:71]
    s_waitcnt lgkmcnt(4)
    v_mfma_f32_16x16x32_bf16 v[76:79], v[40:43], a[36:39], v[76:79]
    ds_read_b128 v[32:35], v17 offset:13312
    v_mfma_f32_16x16x32_bf16 v[76:79], v[44:47], a[44:47], v[76:79]
    v_mfma_f32_16x16x32_bf16 v[72:75], v[44:47], a[40:43], v[72:75]
    ds_read_b128 v[36:39], v17 offset:16384
    v_mfma_f32_16x16x32_bf16 v[72:75], v[40:43], a[32:35], v[72:75]
    s_waitcnt lgkmcnt(4)
    v_mfma_f32_16x16x32_bf16 v[64:67], v[48:51], a[48:51], v[64:67]
    ds_read_b128 v[40:43], v17 offset:19456
    v_mfma_f32_16x16x32_bf16 v[64:67], v[52:55], a[56:59], v[64:67]
    v_mfma_f32_16x16x32_bf16 v[68:71], v[52:55], a[60:63], v[68:71]
    ds_read_b128 v[44:47], v17 offset:22528
    v_mfma_f32_16x16x32_bf16 v[68:71], v[48:51], a[52:55], v[68:71]
    s_waitcnt lgkmcnt(4)
    v_mfma_f32_16x16x32_bf16 v[76:79], v[56:59], a[52:55], v[76:79]
    ds_read_b128 v[48:51], v17 offset:14336
    v_mfma_f32_16x16x32_bf16 v[76:79], v[60:63], a[60:63], v[76:79]
    s_cmp_lt_u32 s3, 2
    s_cselect_b32 s100, s100, s101
    buffer_load_dword v27, v26, s[44:47], 0 offen offset:0 sc1
    v_mfma_f32_16x16x32_bf16 v[72:75], v[60:63], a[56:59], v[72:75]
    ds_read_b128 v[52:55], v17 offset:17408
    v_mfma_f32_16x16x32_bf16 v[72:75], v[56:59], a[48:51], v[72:75]
    s_waitcnt lgkmcnt(4)
    v_mfma_f32_16x16x32_bf16 v[64:67], v[32:35], a[64:67], v[64:67]
    ds_read_b128 v[56:59], v17 offset:20480
    v_mfma_f32_16x16x32_bf16 v[64:67], v[36:39], a[72:75], v[64:67]
    v_mfma_f32_16x16x32_bf16 v[68:71], v[36:39], a[76:79], v[68:71]
    ds_read_b128 v[60:63], v17 offset:23552
    v_mfma_f32_16x16x32_bf16 v[68:71], v[32:35], a[68:71], v[68:71]
    s_waitcnt vmcnt(12) lgkmcnt(4)
    s_barrier
    v_mfma_f32_16x16x32_bf16 v[76:79], v[40:43], a[68:71], v[76:79]
    s_add_u32 m0, s21, 36864
    ds_read_b128 v[32:35], v17 offset:24576
    v_mfma_f32_16x16x32_bf16 v[76:79], v[44:47], a[76:79], v[76:79]
    buffer_load_dwordx4 v18, s[44:47], s96 offen offset:0 sc1 lds
    v_mfma_f32_16x16x32_bf16 v[72:75], v[44:47], a[72:75], v[72:75]
    ds_read_b128 v[36:39], v17 offset:27648
    v_mfma_f32_16x16x32_bf16 v[72:75], v[40:43], a[64:67], v[72:75]
    s_waitcnt lgkmcnt(4)
    buffer_load_dwordx4 v19, s[44:47], s98 offen offset:1024 sc1 lds
    v_mfma_f32_16x16x32_bf16 v[64:67], v[48:51], a[80:83], v[64:67]
    ds_read_b128 v[40:43], v17 offset:30720
    v_mfma_f32_16x16x32_bf16 v[64:67], v[52:55], a[88:91], v[64:67]
    buffer_load_dwordx4 v20, s[44:47], s100 offen offset:2048 sc1 lds
    v_mfma_f32_16x16x32_bf16 v[68:71], v[52:55], a[92:95], v[68:71]
    ds_read_b128 v[44:47], v17 offset:33792
    v_mfma_f32_16x16x32_bf16 v[68:71], v[48:51], a[84:87], v[68:71]
    s_waitcnt lgkmcnt(4)
    v_mfma_f32_16x16x32_bf16 v[76:79], v[56:59], a[84:87], v[76:79]
    ds_read_b128 v[48:51], v17 offset:25600
    v_mfma_f32_16x16x32_bf16 v[76:79], v[60:63], a[92:95], v[76:79]
    v_mfma_f32_16x16x32_bf16 v[72:75], v[60:63], a[88:91], v[72:75]
    ds_read_b128 v[52:55], v17 offset:28672
    v_mfma_f32_16x16x32_bf16 v[72:75], v[56:59], a[80:83], v[72:75]
    s_waitcnt lgkmcnt(4)
    v_mfma_f32_16x16x32_bf16 v[64:67], v[32:35], a[96:99], v[64:67]
    ds_read_b128 v[56:59], v17 offset:31744
    v_mfma_f32_16x16x32_bf16 v[64:67], v[36:39], a[104:107], v[64:67]
    v_mfma_f32_16x16x32_bf16 v[68:71], v[36:39], a[108:111], v[68:71]
    ds_read_b128 v[60:63], v17 offset:34816
    v_mfma_f32_16x16x32_bf16 v[68:71], v[32:35], a[100:103], v[68:71]
    s_waitcnt lgkmcnt(4)
    v_mfma_f32_16x16x32_bf16 v[76:79], v[40:43], a[100:103], v[76:79]
    ds_read_b128 v[32:35], v17 offset:26624
    v_mfma_f32_16x16x32_bf16 v[76:79], v[44:47], a[108:111], v[76:79]
    v_mfma_f32_16x16x32_bf16 v[72:75], v[44:47], a[104:107], v[72:75]
    ds_read_b128 v[36:39], v17 offset:29696
    v_mfma_f32_16x16x32_bf16 v[72:75], v[40:43], a[96:99], v[72:75]
    s_waitcnt lgkmcnt(4)
    v_mfma_f32_16x16x32_bf16 v[64:67], v[48:51], a[112:115], v[64:67]
    ds_read_b128 v[40:43], v17 offset:32768
    v_mfma_f32_16x16x32_bf16 v[64:67], v[52:55], a[120:123], v[64:67]
    v_mfma_f32_16x16x32_bf16 v[68:71], v[52:55], a[124:127], v[68:71]
    ds_read_b128 v[44:47], v17 offset:35840
    v_mfma_f32_16x16x32_bf16 v[68:71], v[48:51], a[116:119], v[68:71]
    s_waitcnt vmcnt(7) lgkmcnt(4)
    s_barrier
    s_and_b32 s12, s23, 1
    v_mfma_f32_16x16x32_bf16 v[76:79], v[56:59], a[116:119], v[76:79]
    ds_read_b128 v[48:51], v16 offset:0
    v_mfma_f32_16x16x32_bf16 v[76:79], v[60:63], a[124:127], v[76:79]
    buffer_store_dword v24, v29, s[44:47], 0 offen sc1
    v_mfma_f32_16x16x32_bf16 v[72:75], v[60:63], a[120:123], v[72:75]
    s_lshl_b32 s12, s12, 7
    ds_read_b128 v[52:55], v16 offset:3072
    v_mfma_f32_16x16x32_bf16 v[72:75], v[56:59], a[112:115], v[72:75]
    s_waitcnt lgkmcnt(4)
    v_mfma_f32_16x16x32_bf16 v[64:67], v[32:35], a[192:195], v[64:67]
    ds_read_b128 v[56:59], v16 offset:6144
    v_mfma_f32_16x16x32_bf16 v[64:67], v[36:39], a[200:203], v[64:67]
    s_add_u32 s12, s12, 8716288
    v_mfma_f32_16x16x32_bf16 v[68:71], v[36:39], a[204:207], v[68:71]
    ds_read_b128 v[60:63], v16 offset:9216
    v_mfma_f32_16x16x32_bf16 v[68:71], v[32:35], a[196:199], v[68:71]
    s_waitcnt lgkmcnt(4)
    v_mfma_f32_16x16x32_bf16 v[76:79], v[40:43], a[196:199], v[76:79]
    ds_read_b128 v[32:35], v16 offset:1024
    buffer_load_dwordx2 v[150:151], v14, s[44:47], s12 offen sc1
    v_mfma_f32_16x16x32_bf16 v[76:79], v[44:47], a[204:207], v[76:79]
    v_mfma_f32_16x16x32_bf16 v[72:75], v[44:47], a[200:203], v[72:75]
    ds_read_b128 v[36:39], v16 offset:4096
    v_mfma_f32_16x16x32_bf16 v[72:75], v[40:43], a[192:195], v[72:75]
    s_waitcnt lgkmcnt(4)
    s_mov_b32 s12, 8716288
    v_mfma_f32_16x16x32_bf16 v[64:67], v[48:51], a[208:211], v[64:67]
    ds_read_b128 v[40:43], v16 offset:7168
    v_mfma_f32_16x16x32_bf16 v[64:67], v[52:55], a[216:219], v[64:67]
    v_mfma_f32_16x16x32_bf16 v[68:71], v[52:55], a[220:223], v[68:71]
    ds_read_b128 v[44:47], v16 offset:10240
    buffer_load_dwordx2 v[148:149], v14, s[44:47], s12 offen offset:128 sc1
    v_mfma_f32_16x16x32_bf16 v[68:71], v[48:51], a[212:215], v[68:71]
    s_waitcnt lgkmcnt(4)
    v_mfma_f32_16x16x32_bf16 v[76:79], v[56:59], a[212:215], v[76:79]
    ds_read_b128 v[48:51], v16 offset:2048
    v_mfma_f32_16x16x32_bf16 v[76:79], v[60:63], a[220:223], v[76:79]
    buffer_load_dwordx2 v[146:147], v14, s[44:47], s12 offen sc1
    v_mfma_f32_16x16x32_bf16 v[72:75], v[60:63], a[216:219], v[72:75]
    ds_read_b128 v[52:55], v16 offset:5120
    v_mfma_f32_16x16x32_bf16 v[72:75], v[56:59], a[208:211], v[72:75]
    s_waitcnt lgkmcnt(4)
    v_mfma_f32_16x16x32_bf16 v[64:67], v[32:35], a[224:227], v[64:67]
    s_movk_i32 s12, 18432
    ds_read_b128 v[56:59], v16 offset:8192
    v_mfma_f32_16x16x32_bf16 v[64:67], v[36:39], a[232:235], v[64:67]
    v_mfma_f32_16x16x32_bf16 v[68:71], v[36:39], a[236:239], v[68:71]
    ds_read_b128 v[60:63], v16 offset:11264
    v_mfma_f32_16x16x32_bf16 v[68:71], v[32:35], a[228:231], v[68:71]
    s_waitcnt lgkmcnt(4)
    s_barrier
    v_mfma_f32_16x16x32_bf16 v[76:79], v[40:43], a[228:231], v[76:79]
    s_waitcnt vmcnt(7)
    ds_read_b128 v[32:35], v16 offset:12288
    v_mfma_f32_16x16x32_bf16 v[76:79], v[44:47], a[236:239], v[76:79]
    v_cmp_ne_u32 vcc, s16, v27
    s_cbranch_vccnz L_rs_p2
L_ok_p2:
    v_mfma_f32_16x16x32_bf16 v[72:75], v[44:47], a[232:235], v[72:75]
    s_add_u32 m0, s21, 49152
    ds_read_b128 v[36:39], v16 offset:15360
    v_add_u32 v18, s71, v22
    v_mfma_f32_16x16x32_bf16 v[72:75], v[40:43], a[224:227], v[72:75]
    s_waitcnt lgkmcnt(4)
    buffer_load_dwordx4 v18, s[44:47], s84 offen offset:0 sc1 lds
    v_mfma_f32_16x16x32_bf16 v[64:67], v[48:51], a[240:243], v[64:67]
    ds_read_b128 v[40:43], v16 offset:18432
    v_add_u32 v19, -1024, v18
    v_mfma_f32_16x16x32_bf16 v[64:67], v[52:55], a[248:251], v[64:67]
    buffer_load_dwordx4 v19, s[44:47], s86 offen offset:1024 sc1 lds
    v_mfma_f32_16x16x32_bf16 v[68:71], v[52:55], a[252:255], v[68:71]
    ds_read_b128 v[44:47], v16 offset:21504
    v_add_u32 v20, -2048, v18
    v_mfma_f32_16x16x32_bf16 v[68:71], v[48:51], a[244:247], v[68:71]
    s_waitcnt lgkmcnt(4)
    buffer_load_dwordx4 v20, s[44:47], s88 offen offset:2048 sc1 lds
    v_mfma_f32_16x16x32_bf16 v[76:79], v[56:59], a[244:247], v[76:79]
    s_add_u32 m0, s21, 61440
    ds_read_b128 v[48:51], v16 offset:13312
    v_mfma_f32_16x16x32_bf16 v[76:79], v[60:63], a[252:255], v[76:79]
    buffer_load_dwordx4 v18, s[44:47], s90 offen offset:0 sc1 lds
    v_mfma_f32_16x16x32_bf16 v[72:75], v[60:63], a[248:251], v[72:75]
    ds_read_b128 v[52:55], v16 offset:16384
    v_mfma_f32_16x16x32_bf16 v[72:75], v[56:59], a[240:243], v[72:75]
    s_waitcnt lgkmcnt(4)
    buffer_load_dwordx4 v19, s[44:47], s92 offen offset:1024 sc1 lds
    v_mfma_f32_16x16x32_bf16 v[112:115], v[32:35], v[156:159], 0
    ds_read_b128 v[56:59], v16 offset:19456
    v_mfma_f32_16x16x32_bf16 v[112:115], v[36:39], v[164:167], v[112:115]
    buffer_load_dwordx4 v20, s[44:47], s94 offen offset:2048 sc1 lds
    v_mfma_f32_16x16x32_bf16 v[116:119], v[36:39], v[168:171], 0
    ds_read_b128 v[60:63], v16 offset:22528
    v_mfma_f32_16x16x32_bf16 v[116:119], v[32:35], v[160:163], v[116:119]
    s_waitcnt lgkmcnt(4)
    v_mfma_f32_16x16x32_bf16 v[116:119], v[40:43], v[176:179], v[116:119]
    ds_read_b128 v[32:35], v16 offset:14336
    v_mfma_f32_16x16x32_bf16 v[116:119], v[44:47], v[184:187], v[116:119]
    v_cndmask_b32 v128, v64, v68, s[26:27]
    v_cndmask_b32 v129, v65, v69, s[26:27]
    v_mfma_f32_16x16x32_bf16 v[112:115], v[44:47], v[180:183], v[112:115]
    ds_read_b128 v[36:39], v16 offset:17408
    v_cndmask_b32 v130, v66, v70, s[26:27]
    v_mfma_f32_16x16x32_bf16 v[112:115], v[40:43], v[172:175], v[112:115]
    s_waitcnt lgkmcnt(4)
    v_cndmask_b32 v131, v67, v71, s[26:27]
    v_cvt_pk_bf16_f32 v72, v72, v73
    v_mfma_f32_16x16x32_bf16 v[112:115], v[48:51], v[188:191], v[112:115]
    s_add_u32 s8, s83, 6144
    ds_read_b128 v[40:43], v16 offset:20480
    v_cvt_pk_bf16_f32 v64, v64, v65
    v_mfma_f32_16x16x32_bf16 v[112:115], v[52:55], v[196:199], v[112:115]
    v_cvt_pk_bf16_f32 v65, v66, v67
    v_cvt_pk_bf16_f32 v73, v74, v75
    v_mfma_f32_16x16x32_bf16 v[116:119], v[52:55], v[200:203], v[116:119]
    ds_read_b128 v[44:47], v16 offset:23552
    v_cvt_pk_bf16_f32 v66, v68, v69
    v_mfma_f32_16x16x32_bf16 v[116:119], v[48:51], v[192:195], v[116:119]
    s_waitcnt lgkmcnt(4)
    s_barrier
    v_cvt_pk_bf16_f32 v67, v70, v71
    v_bfi_b32 v64, s33, v253, v64
    v_mfma_f32_16x16x32_bf16 v[116:119], v[56:59], v[208:211], v[116:119]
    ds_read_b128 v[48:51], v16 offset:24576
    v_bfi_b32 v65, s33, v255, v65
    v_mfma_f32_16x16x32_bf16 v[116:119], v[60:63], v[216:219], v[116:119]
    v_bfi_b32 v66, s33, v23, v66
    v_bfi_b32 v67, s33, v0, v67
    v_mfma_f32_16x16x32_bf16 v[112:115], v[60:63], v[212:215], v[112:115]
    ds_read_b128 v[52:55], v16 offset:27648
    v_cvt_pk_bf16_f32 v74, v76, v77
    v_mfma_f32_16x16x32_bf16 v[112:115], v[56:59], v[204:207], v[112:115]
    s_waitcnt lgkmcnt(4)
    buffer_store_dwordx4 v[64:67], v21, s[44:47], s8 offen sc1
    buffer_load_dwordx4 v[8:11], v144, s[56:59], 0 offen
    v_mfma_f32_16x16x32_bf16 v[112:115], v[32:35], v[220:223], v[112:115]
    s_add_u32 m0, s21, 0
    ds_read_b128 v[56:59], v16 offset:30720
    v_cvt_pk_bf16_f32 v75, v78, v79
    v_mfma_f32_16x16x32_bf16 v[112:115], v[36:39], v[228:231], v[112:115]
    buffer_load_dwordx4 v18, s[44:47], s96 offen offset:0 sc1 lds
    v_bfi_b32 v72, s33, v253, v72
    v_mfma_f32_16x16x32_bf16 v[116:119], v[36:39], v[232:235], v[116:119]
    ds_read_b128 v[60:63], v16 offset:33792
    v_bfi_b32 v73, s33, v255, v73
    v_mfma_f32_16x16x32_bf16 v[116:119], v[32:35], v[224:227], v[116:119]
    s_waitcnt lgkmcnt(4)
    v_mfma_f32_16x16x32_bf16 v[116:119], v[40:43], v[240:243], v[116:119]
    ds_read_b128 v[32:35], v16 offset:25600
    v_bfi_b32 v74, s33, v23, v74
    v_mfma_f32_16x16x32_bf16 v[116:119], v[44:47], v[248:251], v[116:119]
    buffer_load_dwordx4 v[12:15], v144, s[56:59], s12 offen
    v_mfma_f32_16x16x32_bf16 v[112:115], v[44:47], v[244:247], v[112:115]
    ds_read_b128 v[36:39], v16 offset:28672
    v_bfi_b32 v75, s33, v0, v75
    v_mfma_f32_16x16x32_bf16 v[112:115], v[40:43], v[236:239], v[112:115]
    s_waitcnt lgkmcnt(4)
    buffer_load_dwordx2 v[4:5], v145, s[56:59], 0 offen
    v_mfma_f32_16x16x32_bf16 v[112:115], v[48:51], a[0:3], v[112:115]
    ds_read_b128 v[40:43], v16 offset:31744
    v_mfma_f32_16x16x32_bf16 v[112:115], v[52:55], a[8:11], v[112:115]
    v_mfma_f32_16x16x32_bf16 v[116:119], v[52:55], a[12:15], v[116:119]
    ds_read_b128 v[44:47], v16 offset:34816
    v_mfma_f32_16x16x32_bf16 v[116:119], v[48:51], a[4:7], v[116:119]
    s_waitcnt lgkmcnt(4)
    buffer_load_dwordx4 v19, s[44:47], s98 offen offset:1024 sc1 lds
    v_mfma_f32_16x16x32_bf16 v[116:119], v[56:59], a[20:23], v[116:119]
    ds_read_b128 v[48:51], v16 offset:26624
    v_mfma_f32_16x16x32_bf16 v[116:119], v[60:63], a[28:31], v[116:119]
    v_mfma_f32_16x16x32_bf16 v[112:115], v[60:63], a[24:27], v[112:115]
    ds_read_b128 v[52:55], v16 offset:29696
    v_mfma_f32_16x16x32_bf16 v[112:115], v[56:59], a[16:19], v[112:115]
    s_waitcnt lgkmcnt(4)
    buffer_store_dwordx4 v[72:75], v21, s[44:47], s77 offen sc1
    v_mfma_f32_16x16x32_bf16 v[112:115], v[32:35], a[32:35], v[112:115]
    ds_read_b128 v[56:59], v16 offset:32768
    v_mfma_f32_16x16x32_bf16 v[112:115], v[36:39], a[40:43], v[112:115]
    buffer_load_dwordx4 v20, s[44:47], s100 offen offset:2048 sc1 lds
    v_mfma_f32_16x16x32_bf16 v[116:119], v[36:39], a[44:47], v[116:119]
    ds_read_b128 v[60:63], v16 offset:35840
    v_mfma_f32_16x16x32_bf16 v[116:119], v[32:35], a[36:39], v[116:119]
    s_waitcnt vmcnt(18) lgkmcnt(4)
    s_barrier
    v_mfma_f32_16x16x32_bf16 v[116:119], v[40:43], a[52:55], v[116:119]
    ds_read_b128 v[32:35], v17 offset:0
    v_mfma_f32_16x16x32_bf16 v[116:119], v[44:47], a[60:63], v[116:119]
    v_mfma_f32_16x16x32_bf16 v[112:115], v[44:47], a[56:59], v[112:115]
    ds_read_b128 v[36:39], v17 offset:3072
    v_mfma_f32_16x16x32_bf16 v[112:115], v[40:43], a[48:51], v[112:115]
    s_waitcnt lgkmcnt(4)
    v_mfma_f32_16x16x32_bf16 v[112:115], v[48:51], a[64:67], v[112:115]
    ds_read_b128 v[40:43], v17 offset:6144
    v_mfma_f32_16x16x32_bf16 v[112:115], v[52:55], a[72:75], v[112:115]
    v_mfma_f32_16x16x32_bf16 v[116:119], v[52:55], a[76:79], v[116:119]
    s_add_u32 m0, s21, 12288
    ds_read_b128 v[44:47], v17 offset:9216
    v_add_u32 v18, s72, v22
    v_mfma_f32_16x16x32_bf16 v[116:119], v[48:51], a[68:71], v[116:119]
    s_waitcnt lgkmcnt(4)
    buffer_load_dwordx4 v18, s[44:47], s84 offen offset:0 sc1 lds
    v_mfma_f32_16x16x32_bf16 v[116:119], v[56:59], a[84:87], v[116:119]
    ds_read_b128 v[48:51], v17 offset:1024
    v_add_u32 v19, -1024, v18
    v_mfma_f32_16x16x32_bf16 v[116:119], v[60:63], a[92:95], v[116:119]
    buffer_load_dwordx4 v19, s[44:47], s86 offen offset:1024 sc1 lds
    v_mfma_f32_16x16x32_bf16 v[112:115], v[60:63], a[88:91], v[112:115]
    ds_read_b128 v[52:55], v17 offset:4096
    v_add_u32 v20, -2048, v18
    v_mfma_f32_16x16x32_bf16 v[112:115], v[56:59], a[80:83], v[112:115]
    s_waitcnt lgkmcnt(4)
    buffer_load_dwordx4 v20, s[44:47], s88 offen offset:2048 sc1 lds
    v_mfma_f32_16x16x32_bf16 v[112:115], v[32:35], a[96:99], v[112:115]
    ds_read_b128 v[56:59], v17 offset:7168
    v_mfma_f32_16x16x32_bf16 v[112:115], v[36:39], a[104:107], v[112:115]
    v_mfma_f32_16x16x32_bf16 v[116:119], v[36:39], a[108:111], v[116:119]
    s_sub_u32 s4, s36, 6356992
    ds_read_b128 v[60:63], v17 offset:10240
    v_mfma_f32_16x16x32_bf16 v[116:119], v[32:35], a[100:103], v[116:119]
    s_waitcnt lgkmcnt(4)
    v_mfma_f32_16x16x32_bf16 v[116:119], v[40:43], a[116:119], v[116:119]
    s_lshr_b32 s4, s4, 12
    ds_read_b128 v[32:35], v17 offset:2048
    v_mfma_f32_16x16x32_bf16 v[116:119], v[44:47], a[124:127], v[116:119]
    v_mfma_f32_16x16x32_bf16 v[112:115], v[44:47], a[120:123], v[112:115]
    s_sub_u32 s5, s37, 6488064
    ds_read_b128 v[36:39], v17 offset:5120
    v_mfma_f32_16x16x32_bf16 v[112:115], v[40:43], a[112:115], v[112:115]
    s_waitcnt lgkmcnt(4)
    v_mfma_f32_16x16x32_bf16 v[112:115], v[48:51], a[192:195], v[112:115]
    s_ashr_i32 s5, s5, 12
    ds_read_b128 v[40:43], v17 offset:8192
    v_mfma_f32_16x16x32_bf16 v[112:115], v[52:55], a[200:203], v[112:115]
    v_mfma_f32_16x16x32_bf16 v[116:119], v[52:55], a[204:207], v[116:119]
    ds_read_b128 v[44:47], v17 offset:11264
    v_min_u32 v28, 47, v2
    v_mfma_f32_16x16x32_bf16 v[116:119], v[48:51], a[196:199], v[116:119]
    s_waitcnt vmcnt(14) lgkmcnt(4)
    s_barrier
    v_mfma_f32_16x16x32_bf16 v[116:119], v[56:59], a[212:215], v[116:119]
    s_add_u32 m0, s21, 24576
    ds_read_b128 v[48:51], v17 offset:12288
    v_add_u32 v29, s5, v28
    v_mfma_f32_16x16x32_bf16 v[116:119], v[60:63], a[220:223], v[116:119]
    buffer_load_dwordx4 v18, s[44:47], s90 offen offset:0 sc1 lds
    v_mfma_f32_16x16x32_bf16 v[112:115], v[60:63], a[216:219], v[112:115]
    ds_read_b128 v[52:55], v17 offset:15360
    v_add_u32 v28, s4, v28
    v_mfma_f32_16x16x32_bf16 v[112:115], v[56:59], a[208:211], v[112:115]
    s_waitcnt lgkmcnt(4)
    buffer_load_dwordx4 v19, s[44:47], s92 offen offset:1024 sc1 lds
    v_mfma_f32_16x16x32_bf16 v[112:115], v[32:35], a[224:227], v[112:115]
    ds_read_b128 v[56:59], v17 offset:18432
    v_mfma_f32_16x16x32_bf16 v[112:115], v[36:39], a[232:235], v[112:115]
    v_cmp_lt_u32 vcc, 31, v2
    s_nop 1
    v_cndmask_b32 v28, v28, v29, vcc
    buffer_load_dwordx4 v20, s[44:47], s94 offen offset:2048 sc1 lds
    v_mfma_f32_16x16x32_bf16 v[116:119], v[36:39], a[236:239], v[116:119]
    ds_read_b128 v[60:63], v17 offset:21504
    v_mfma_f32_16x16x32_bf16 v[116:119], v[32:35], a[228:231], v[116:119]
    s_waitcnt lgkmcnt(4)
    v_and_b32 v29, 3, v28
    v_mfma_f32_16x16x32_bf16 v[116:119], v[40:43], a[244:247], v[116:119]
    ds_read_b128 v[32:35], v17 offset:13312
    v_mfma_f32_16x16x32_bf16 v[116:119], v[44:47], a[252:255], v[116:119]
    v_lshrrev_b32 v28, 2, v28
    v_mfma_f32_16x16x32_bf16 v[112:115], v[44:47], a[248:251], v[112:115]
    ds_read_b128 v[36:39], v17 offset:16384
    v_mfma_f32_16x16x32_bf16 v[112:115], v[40:43], a[240:243], v[112:115]
    s_waitcnt lgkmcnt(4)
    v_lshlrev_b32 v28, 7, v28
    v_mfma_f32_16x16x32_bf16 v[120:123], v[48:51], v[156:159], 0
    ds_read_b128 v[40:43], v17 offset:19456
    v_mfma_f32_16x16x32_bf16 v[120:123], v[52:55], v[164:167], v[120:123]
    v_lshl_add_u32 v28, v29, 2, v28
    v_mfma_f32_16x16x32_bf16 v[124:127], v[52:55], v[168:171], 0
    ds_read_b128 v[44:47], v17 offset:22528
    v_mfma_f32_16x16x32_bf16 v[124:127], v[48:51], v[160:163], v[124:127]
    s_waitcnt lgkmcnt(4)
    v_add_u32 v28, 9023488, v28
    v_mfma_f32_16x16x32_bf16 v[124:127], v[56:59], v[176:179], v[124:127]
    ds_read_b128 v[48:51], v17 offset:14336
    v_mfma_f32_16x16x32_bf16 v[124:127], v[60:63], v[184:187], v[124:127]
    buffer_load_dword v29, v28, s[44:47], 0 offen offset:0 sc1
    v_mfma_f32_16x16x32_bf16 v[120:123], v[60:63], v[180:183], v[120:123]
    ds_read_b128 v[52:55], v17 offset:17408
    v_cvt_pk_bf16_f32 v76, v112, v113
    v_mfma_f32_16x16x32_bf16 v[120:123], v[56:59], v[172:175], v[120:123]
    s_waitcnt lgkmcnt(4)
    v_mfma_f32_16x16x32_bf16 v[120:123], v[32:35], v[188:191], v[120:123]
    ds_read_b128 v[56:59], v17 offset:20480
    v_cvt_pk_bf16_f32 v77, v114, v115
    v_mfma_f32_16x16x32_bf16 v[120:123], v[36:39], v[196:199], v[120:123]
    v_mfma_f32_16x16x32_bf16 v[124:127], v[36:39], v[200:203], v[124:127]
    ds_read_b128 v[60:63], v17 offset:23552
    v_cvt_pk_bf16_f32 v78, v116, v117
    v_mfma_f32_16x16x32_bf16 v[124:127], v[32:35], v[192:195], v[124:127]
    s_waitcnt vmcnt(15) lgkmcnt(4)
    s_barrier
    v_mfma_f32_16x16x32_bf16 v[124:127], v[40:43], v[208:211], v[124:127]
    s_add_u32 m0, s21, 36864
    ds_read_b128 v[32:35], v17 offset:24576
    v_mfma_f32_16x16x32_bf16 v[124:127], v[44:47], v[216:219], v[124:127]
    buffer_load_dwordx4 v18, s[44:47], s96 offen offset:0 sc1 lds
    v_cvt_pk_bf16_f32 v79, v118, v119
    v_mfma_f32_16x16x32_bf16 v[120:123], v[44:47], v[212:215], v[120:123]
    s_and_b32 s6, s23, 1
    ds_read_b128 v[36:39], v17 offset:27648
    v_mfma_f32_16x16x32_bf16 v[120:123], v[40:43], v[204:207], v[120:123]
    s_waitcnt lgkmcnt(4)
    buffer_load_dwordx4 v19, s[44:47], s98 offen offset:1024 sc1 lds
    v_bfi_b32 v76, s33, v253, v76
    v_mfma_f32_16x16x32_bf16 v[120:123], v[48:51], v[220:223], v[120:123]
    ds_read_b128 v[40:43], v17 offset:30720
    v_mfma_f32_16x16x32_bf16 v[120:123], v[52:55], v[228:231], v[120:123]
    buffer_load_dwordx4 v20, s[44:47], s100 offen offset:2048 sc1 lds
    v_mfma_f32_16x16x32_bf16 v[124:127], v[52:55], v[232:235], v[124:127]
    ds_read_b128 v[44:47], v17 offset:33792
    v_bfi_b32 v77, s33, v255, v77
    v_mfma_f32_16x16x32_bf16 v[124:127], v[48:51], v[224:227], v[124:127]
    s_waitcnt lgkmcnt(4)
    v_mfma_f32_16x16x32_bf16 v[124:127], v[56:59], v[240:243], v[124:127]
    ds_read_b128 v[48:51], v17 offset:25600
    v_bfi_b32 v78, s33, v23, v78
    v_mfma_f32_16x16x32_bf16 v[124:127], v[60:63], v[248:251], v[124:127]
    v_mfma_f32_16x16x32_bf16 v[120:123], v[60:63], v[244:247], v[120:123]
    ds_read_b128 v[52:55], v17 offset:28672
    v_bfi_b32 v79, s33, v0, v79
    v_mfma_f32_16x16x32_bf16 v[120:123], v[56:59], v[236:239], v[120:123]
    s_waitcnt lgkmcnt(4)
    v_mfma_f32_16x16x32_bf16 v[120:123], v[32:35], a[0:3], v[120:123]
    ds_read_b128 v[56:59], v17 offset:31744
    v_mfma_f32_16x16x32_bf16 v[120:123], v[36:39], a[8:11], v[120:123]
    v_mfma_f32_16x16x32_bf16 v[124:127], v[36:39], a[12:15], v[124:127]
    ds_read_b128 v[60:63], v17 offset:34816
    v_mfma_f32_16x16x32_bf16 v[124:127], v[32:35], a[4:7], v[124:127]
    s_waitcnt lgkmcnt(4)
    s_lshl_b32 s7, s6, 5
    v_mfma_f32_16x16x32_bf16 v[124:127], v[40:43], a[20:23], v[124:127]
    ds_read_b128 v[32:35], v17 offset:26624
    v_mfma_f32_16x16x32_bf16 v[124:127], v[44:47], a[28:31], v[124:127]
    v_mfma_f32_16x16x32_bf16 v[120:123], v[44:47], a[24:27], v[120:123]
    ds_read_b128 v[36:39], v17 offset:29696
    v_mfma_f32_16x16x32_bf16 v[120:123], v[40:43], a[16:19], v[120:123]
    s_waitcnt lgkmcnt(4)
    v_mfma_f32_16x16x32_bf16 v[120:123], v[48:51], a[32:35], v[120:123]
    ds_read_b128 v[40:43], v17 offset:32768
    v_mfma_f32_16x16x32_bf16 v[120:123], v[52:55], a[40:43], v[120:123]
    v_mfma_f32_16x16x32_bf16 v[124:127], v[52:55], a[44:47], v[124:127]
    ds_read_b128 v[44:47], v17 offset:35840
    v_mfma_f32_16x16x32_bf16 v[124:127], v[48:51], a[36:39], v[124:127]
    s_waitcnt vmcnt(10) lgkmcnt(4)
    s_barrier
    v_mfma_f32_16x16x32_bf16 v[124:127], v[56:59], a[52:55], v[124:127]
    s_add_u32 m0, s21, 49152
    ds_read_b128 v[48:51], v16 offset:0
    v_add_u32 v18, s73, v22
    v_mfma_f32_16x16x32_bf16 v[124:127], v[60:63], a[60:63], v[124:127]
    buffer_load_dwordx4 v18, s[44:47], s84 offen offset:0 sc1 lds
    v_mfma_f32_16x16x32_bf16 v[120:123], v[60:63], a[56:59], v[120:123]
    ds_read_b128 v[52:55], v16 offset:3072
    v_add_u32 v19, -1024, v18
    v_mfma_f32_16x16x32_bf16 v[120:123], v[56:59], a[48:51], v[120:123]
    s_waitcnt lgkmcnt(4)
    buffer_load_dwordx4 v19, s[44:47], s86 offen offset:1024 sc1 lds
    v_mfma_f32_16x16x32_bf16 v[120:123], v[32:35], a[64:67], v[120:123]
    ds_read_b128 v[56:59], v16 offset:6144
    v_add_u32 v20, -2048, v18
    v_mfma_f32_16x16x32_bf16 v[120:123], v[36:39], a[72:75], v[120:123]
    s_waitcnt vmcnt(5)
    buffer_load_dwordx4 v20, s[44:47], s88 offen offset:2048 sc1 lds
    v_add_u32 v31, s7, v252
    v_mfma_f32_16x16x32_bf16 v[124:127], v[36:39], a[76:79], v[124:127]
    ds_read_b128 v[60:63], v16 offset:9216
    v_mfma_f32_16x16x32_bf16 v[124:127], v[32:35], a[68:71], v[124:127]
    s_waitcnt lgkmcnt(4)
    v_cmp_ne_u32 vcc, s16, v29
    s_cbranch_vccnz L_rs_py
L_ok_py:
    v_mfma_f32_16x16x32_bf16 v[124:127], v[40:43], a[84:87], v[124:127]
    s_lshr_b32 m0, s20, 2
    ds_read_b128 v[32:35], v16 offset:1024
    v_mfma_f32_16x16x32_bf16 v[124:127], v[44:47], a[92:95], v[124:127]
    buffer_load_dwordx4 v155, s[44:47], s37 offen sc1 lds
    v_mfma_f32_16x16x32_bf16 v[120:123], v[44:47], a[88:91], v[120:123]
    s_add_u32 m0, m0, 4096
    ds_read_b128 v[36:39], v16 offset:4096
    v_mfma_f32_16x16x32_bf16 v[120:123], v[40:43], a[80:83], v[120:123]
L_pl_S_2:
    s_cbranch_execz L_wret
    s_waitcnt lgkmcnt(4)
    buffer_load_dwordx4 v155, s[44:47], s36 offen sc1 lds
    v_mfma_f32_16x16x32_bf16 v[120:123], v[48:51], a[96:99], v[120:123]
    s_add_u32 m0, m0, 4096
    ds_read_b128 v[40:43], v16 offset:7168
    s_add_u32 s14, s36, 65536
    v_mfma_f32_16x16x32_bf16 v[120:123], v[52:55], a[104:107], v[120:123]
    buffer_load_dwordx4 v155, s[44:47], s14 offen sc1 lds
    v_mfma_f32_16x16x32_bf16 v[124:127], v[52:55], a[108:111], v[124:127]
    ds_read_b128 v[44:47], v16 offset:10240
    v_mfma_f32_16x16x32_bf16 v[124:127], v[48:51], a[100:103], v[124:127]
    s_waitcnt lgkmcnt(4)
    v_mfma_f32_16x16x32_bf16 v[124:127], v[56:59], a[116:119], v[124:127]
    ds_read_b128 v[48:51], v16 offset:2048
    v_mfma_f32_16x16x32_bf16 v[124:127], v[60:63], a[124:127], v[124:127]
    v_mfma_f32_16x16x32_bf16 v[120:123], v[60:63], a[120:123], v[120:123]
    s_sub_u32 s7, s83, 14483456
    ds_read_b128 v[52:55], v16 offset:5120
    v_mfma_f32_16x16x32_bf16 v[120:123], v[56:59], a[112:115], v[120:123]
    s_waitcnt lgkmcnt(4)
    v_mfma_f32_16x16x32_bf16 v[120:123], v[32:35], a[192:195], v[120:123]
    ds_read_b128 v[56:59], v16 offset:8192
    v_mfma_f32_16x16x32_bf16 v[120:123], v[36:39], a[200:203], v[120:123]
    v_mfma_f32_16x16x32_bf16 v[124:127], v[36:39], a[204:207], v[124:127]
    ds_read_b128 v[60:63], v16 offset:11264
    v_mfma_f32_16x16x32_bf16 v[124:127], v[32:35], a[196:199], v[124:127]
    s_waitcnt lgkmcnt(4)
    s_barrier
    v_mfma_f32_16x16x32_bf16 v[124:127], v[40:43], a[212:215], v[124:127]
    s_add_u32 m0, s21, 61440
    ds_read_b128 v[32:35], v16 offset:12288
    v_mfma_f32_16x16x32_bf16 v[124:127], v[44:47], a[220:223], v[124:127]
    buffer_load_dwordx4 v18, s[44:47], s90 offen offset:0 sc1 lds
    v_mfma_f32_16x16x32_bf16 v[120:123], v[44:47], a[216:219], v[120:123]
    ds_read_b128 v[36:39], v16 offset:15360
    v_mfma_f32_16x16x32_bf16 v[120:123], v[40:43], a[208:211], v[120:123]
    s_waitcnt lgkmcnt(4)
    buffer_load_dwordx4 v19, s[44:47], s92 offen offset:1024 sc1 lds
    v_mfma_f32_16x16x32_bf16 v[120:123], v[48:51], a[224:227], v[120:123]
    ds_read_b128 v[40:43], v16 offset:18432
    v_mfma_f32_16x16x32_bf16 v[120:123], v[52:55], a[232:235], v[120:123]
    buffer_load_dwordx4 v20, s[44:47], s94 offen offset:2048 sc1 lds
    v_mfma_f32_16x16x32_bf16 v[124:127], v[52:55], a[236:239], v[124:127]
    ds_read_b128 v[44:47], v16 offset:21504
    v_mfma_f32_16x16x32_bf16 v[124:127], v[48:51], a[228:231], v[124:127]
    s_waitcnt lgkmcnt(4)
    s_xor_b32 s4, s7, 65536
    v_mfma_f32_16x16x32_bf16 v[124:127], v[56:59], a[244:247], v[124:127]
    ds_read_b128 v[48:51], v16 offset:13312
    v_mfma_f32_16x16x32_bf16 v[124:127], v[60:63], a[252:255], v[124:127]
    v_mfma_f32_16x16x32_bf16 v[120:123], v[60:63], a[248:251], v[120:123]
    ds_read_b128 v[52:55], v16 offset:16384
    v_mfma_f32_16x16x32_bf16 v[120:123], v[56:59], a[240:243], v[120:123]
    s_waitcnt lgkmcnt(4)
    v_mfma_f32_16x16x32_bf16 v[112:115], v[32:35], v[156:159], 0
    ds_read_b128 v[56:59], v16 offset:19456
    v_mfma_f32_16x16x32_bf16 v[112:115], v[36:39], v[164:167], v[112:115]
    v_mfma_f32_16x16x32_bf16 v[116:119], v[36:39], v[168:171], 0
    ds_read_b128 v[60:63], v16 offset:22528
    v_mfma_f32_16x16x32_bf16 v[116:119], v[32:35], v[160:163], v[116:119]
    s_waitcnt lgkmcnt(4)
    v_mfma_f32_16x16x32_bf16 v[116:119], v[40:43], v[176:179], v[116:119]
    ds_read_b128 v[32:35], v16 offset:14336
    v_mfma_f32_16x16x32_bf16 v[116:119], v[44:47], v[184:187], v[116:119]
    v_cvt_pk_bf16_f32 v120, v120, v121
    v_cvt_pk_bf16_f32 v121, v122, v123
    v_mfma_f32_16x16x32_bf16 v[112:115], v[44:47], v[180:183], v[112:115]
    ds_read_b128 v[36:39], v16 offset:17408
    v_cvt_pk_bf16_f32 v122, v124, v125
    v_mfma_f32_16x16x32_bf16 v[112:115], v[40:43], v[172:175], v[112:115]
    s_waitcnt lgkmcnt(4)
    v_cvt_pk_bf16_f32 v123, v126, v127
    v_bfi_b32 v120, s33, v253, v120
    v_mfma_f32_16x16x32_bf16 v[112:115], v[48:51], v[188:191], v[112:115]
    ds_read_b128 v[40:43], v16 offset:20480
    v_bfi_b32 v121, s33, v255, v121
    v_mfma_f32_16x16x32_bf16 v[112:115], v[52:55], v[196:199], v[112:115]
    s_add_u32 s4, s4, 14489600
    v_bfi_b32 v122, s33, v23, v122
    v_bfi_b32 v123, s33, v0, v123
    v_mfma_f32_16x16x32_bf16 v[116:119], v[52:55], v[200:203], v[116:119]
    ds_read_b128 v[44:47], v16 offset:23552
    v_mfma_f32_16x16x32_bf16 v[116:119], v[48:51], v[192:195], v[116:119]
    s_waitcnt lgkmcnt(4)
    s_barrier
    buffer_store_dwordx4 v[120:123], v21, s[44:47], s79 offen sc1
    v_mfma_f32_16x16x32_bf16 v[116:119], v[56:59], v[208:211], v[116:119]
    s_add_u32 m0, s21, 0
    ds_read_b128 v[48:51], v16 offset:24576
    v_mfma_f32_16x16x32_bf16 v[116:119], v[60:63], v[216:219], v[116:119]
    buffer_load_dwordx4 v18, s[44:47], s96 offen offset:0 sc1 lds
    v_mfma_f32_16x16x32_bf16 v[112:115], v[60:63], v[212:215], v[112:115]
    ds_read_b128 v[52:55], v16 offset:27648
    v_mfma_f32_16x16x32_bf16 v[112:115], v[56:59], v[204:207], v[112:115]
    s_waitcnt lgkmcnt(4)
    buffer_load_dwordx4 v19, s[44:47], s98 offen offset:1024 sc1 lds
    v_mfma_f32_16x16x32_bf16 v[112:115], v[32:35], v[220:223], v[112:115]
    ds_read_b128 v[56:59], v16 offset:30720
    v_mfma_f32_16x16x32_bf16 v[112:115], v[36:39], v[228:231], v[112:115]
    v_mfma_f32_16x16x32_bf16 v[116:119], v[36:39], v[232:235], v[116:119]
    ds_read_b128 v[60:63], v16 offset:33792
    v_mfma_f32_16x16x32_bf16 v[116:119], v[32:35], v[224:227], v[116:119]
    s_waitcnt lgkmcnt(4)
    buffer_store_dwordx4 v[76:79], v21, s[44:47], s78 offen sc1
    v_mfma_f32_16x16x32_bf16 v[116:119], v[40:43], v[240:243], v[116:119]
    ds_read_b128 v[32:35], v16 offset:25600
    v_mfma_f32_16x16x32_bf16 v[116:119], v[44:47], v[248:251], v[116:119]
    v_mfma_f32_16x16x32_bf16 v[112:115], v[44:47], v[244:247], v[112:115]
    s_xor_b32 s5, s7, 131072
    ds_read_b128 v[36:39], v16 offset:28672
    v_mfma_f32_16x16x32_bf16 v[112:115], v[40:43], v[236:239], v[112:115]
    s_waitcnt lgkmcnt(4)
    buffer_load_dwordx4 v20, s[44:47], s100 offen offset:2048 sc1 lds
    v_mfma_f32_16x16x32_bf16 v[112:115], v[48:51], a[0:3], v[112:115]
    ds_read_b128 v[40:43], v16 offset:31744
    v_mfma_f32_16x16x32_bf16 v[112:115], v[52:55], a[8:11], v[112:115]
    v_mfma_f32_16x16x32_bf16 v[116:119], v[52:55], a[12:15], v[116:119]
    ds_read_b128 v[44:47], v16 offset:34816
    v_mfma_f32_16x16x32_bf16 v[116:119], v[48:51], a[4:7], v[116:119]
    s_waitcnt lgkmcnt(4)
    v_mfma_f32_16x16x32_bf16 v[116:119], v[56:59], a[20:23], v[116:119]
    ds_read_b128 v[48:51], v16 offset:26624
    v_mfma_f32_16x16x32_bf16 v[116:119], v[60:63], a[28:31], v[116:119]
    v_mfma_f32_16x16x32_bf16 v[112:115], v[60:63], a[24:27], v[112:115]
    ds_read_b128 v[52:55], v16 offset:29696
    v_mfma_f32_16x16x32_bf16 v[112:115], v[56:59], a[16:19], v[112:115]
    s_waitcnt lgkmcnt(4)
    v_mfma_f32_16x16x32_bf16 v[112:115], v[32:35], a[32:35], v[112:115]
    ds_read_b128 v[56:59], v16 offset:32768
    v_mfma_f32_16x16x32_bf16 v[112:115], v[36:39], a[40:43], v[112:115]
    v_mfma_f32_16x16x32_bf16 v[116:119], v[36:39], a[44:47], v[116:119]
    ds_read_b128 v[60:63], v16 offset:35840
    v_mfma_f32_16x16x32_bf16 v[116:119], v[32:35], a[36:39], v[116:119]
    s_waitcnt vmcnt(8) lgkmcnt(4)
    s_barrier
    s_add_u32 s5, s5, 14489600
    v_mfma_f32_16x16x32_bf16 v[116:119], v[40:43], a[52:55], v[116:119]
    s_add_u32 m0, s21, 12288
    ds_read_b128 v[32:35], v17 offset:0
    v_add_u32 v18, s74, v22
    v_mfma_f32_16x16x32_bf16 v[116:119], v[44:47], a[60:63], v[116:119]
    buffer_load_dwordx4 v18, s[44:47], s84 offen offset:0 sc1 lds
    v_mfma_f32_16x16x32_bf16 v[112:115], v[44:47], a[56:59], v[112:115]
    ds_read_b128 v[36:39], v17 offset:3072
    v_add_u32 v19, -1024, v18
    v_mfma_f32_16x16x32_bf16 v[112:115], v[40:43], a[48:51], v[112:115]
    s_waitcnt lgkmcnt(4)
    buffer_load_dwordx4 v19, s[44:47], s86 offen offset:1024 sc1 lds
    v_mfma_f32_16x16x32_bf16 v[112:115], v[48:51], a[64:67], v[112:115]
    ds_read_b128 v[40:43], v17 offset:6144
    v_add_u32 v20, -2048, v18
    v_mfma_f32_16x16x32_bf16 v[112:115], v[52:55], a[72:75], v[112:115]
    buffer_load_dwordx4 v20, s[44:47], s88 offen offset:2048 sc1 lds
    v_mfma_f32_16x16x32_bf16 v[116:119], v[52:55], a[76:79], v[116:119]
    ds_read_b128 v[44:47], v17 offset:9216
    v_mfma_f32_16x16x32_bf16 v[116:119], v[48:51], a[68:71], v[116:119]
    s_waitcnt lgkmcnt(4)
    v_mfma_f32_16x16x32_bf16 v[116:119], v[56:59], a[84:87], v[116:119]
    ds_read_b128 v[48:51], v17 offset:1024
    v_mfma_f32_16x16x32_bf16 v[116:119], v[60:63], a[92:95], v[116:119]
    v_mfma_f32_16x16x32_bf16 v[112:115], v[60:63], a[88:91], v[112:115]
    ds_read_b128 v[52:55], v17 offset:4096
    v_mfma_f32_16x16x32_bf16 v[112:115], v[56:59], a[80:83], v[112:115]
    s_waitcnt lgkmcnt(4)
    v_mfma_f32_16x16x32_bf16 v[112:115], v[32:35], a[96:99], v[112:115]
    ds_read_b128 v[56:59], v17 offset:7168
    v_mfma_f32_16x16x32_bf16 v[112:115], v[36:39], a[104:107], v[112:115]
    s_xor_b32 s7, s7, 196608
    v_mfma_f32_16x16x32_bf16 v[116:119], v[36:39], a[108:111], v[116:119]
    ds_read_b128 v[60:63], v17 offset:10240
    v_mfma_f32_16x16x32_bf16 v[116:119], v[32:35], a[100:103], v[116:119]
    s_waitcnt lgkmcnt(4)
    v_mfma_f32_16x16x32_bf16 v[116:119], v[40:43], a[116:119], v[116:119]
    ds_read_b128 v[32:35], v17 offset:2048
    v_mfma_f32_16x16x32_bf16 v[116:119], v[44:47], a[124:127], v[116:119]
    v_mfma_f32_16x16x32_bf16 v[112:115], v[44:47], a[120:123], v[112:115]
    ds_read_b128 v[36:39], v17 offset:5120
    v_mfma_f32_16x16x32_bf16 v[112:115], v[40:43], a[112:115], v[112:115]
    s_waitcnt lgkmcnt(4)
    v_mfma_f32_16x16x32_bf16 v[112:115], v[48:51], a[192:195], v[112:115]
    ds_read_b128 v[40:43], v17 offset:8192
    v_mfma_f32_16x16x32_bf16 v[112:115], v[52:55], a[200:203], v[112:115]
    v_mfma_f32_16x16x32_bf16 v[116:119], v[52:55], a[204:207], v[116:119]
    ds_read_b128 v[44:47], v17 offset:11264
    v_mfma_f32_16x16x32_bf16 v[116:119], v[48:51], a[196:199], v[116:119]
    s_waitcnt lgkmcnt(4)
    s_barrier
    v_mfma_f32_16x16x32_bf16 v[116:119], v[56:59], a[212:215], v[116:119]
    s_add_u32 m0, s21, 24576
    ds_read_b128 v[48:51], v17 offset:12288
    v_mfma_f32_16x16x32_bf16 v[116:119], v[60:63], a[220:223], v[116:119]
    buffer_load_dwordx4 v18, s[44:47], s90 offen offset:0 sc1 lds
    v_mfma_f32_16x16x32_bf16 v[112:115], v[60:63], a[216:219], v[112:115]
    s_add_u32 s7, s7, 14489600
    ds_read_b128 v[52:55], v17 offset:15360
    v_mfma_f32_16x16x32_bf16 v[112:115], v[56:59], a[208:211], v[112:115]
    s_waitcnt lgkmcnt(4)
    v_mfma_f32_16x16x32_bf16 v[112:115], v[32:35], a[224:227], v[112:115]
    ds_read_b128 v[56:59], v17 offset:18432
    v_mfma_f32_16x16x32_bf16 v[112:115], v[36:39], a[232:235], v[112:115]
    v_mfma_f32_16x16x32_bf16 v[116:119], v[36:39], a[236:239], v[116:119]
    ds_read_b128 v[60:63], v17 offset:21504
    v_mfma_f32_16x16x32_bf16 v[116:119], v[32:35], a[228:231], v[116:119]
    s_waitcnt lgkmcnt(4)
    v_mfma_f32_16x16x32_bf16 v[116:119], v[40:43], a[244:247], v[116:119]
    ds_read_b128 v[32:35], v17 offset:13312
    v_mfma_f32_16x16x32_bf16 v[116:119], v[44:47], a[252:255], v[116:119]
    v_mfma_f32_16x16x32_bf16 v[112:115], v[44:47], a[248:251], v[112:115]
    ds_read_b128 v[36:39], v17 offset:16384
    v_mfma_f32_16x16x32_bf16 v[112:115], v[40:43], a[240:243], v[112:115]
    s_waitcnt lgkmcnt(4)
    buffer_load_dwordx4 v[132:135], v21, s[44:47], s4 offen sc1
    buffer_load_dwordx4 v[136:139], v21, s[44:47], s5 offen sc1
    v_mfma_f32_16x16x32_bf16 v[120:123], v[48:51], v[156:159], 0
    ds_read_b128 v[40:43], v17 offset:19456
    v_lshlrev_b32 v152, 16, v152
    v_mfma_f32_16x16x32_bf16 v[120:123], v[52:55], v[164:167], v[120:123]
    v_lshlrev_b32 v153, 16, v153
    v_lshlrev_b32 v154, 16, v154
    v_mfma_f32_16x16x32_bf16 v[124:127], v[52:55], v[168:171], 0
    ds_read_b128 v[44:47], v17 offset:22528
    v_mul_f32 v146, v146, v147
    v_mfma_f32_16x16x32_bf16 v[124:127], v[48:51], v[160:163], v[124:127]
    s_waitcnt lgkmcnt(4)
    v_mul_f32 v148, v148, v149
    v_mul_f32 v150, v150, v151
    v_mfma_f32_16x16x32_bf16 v[124:127], v[56:59], v[176:179], v[124:127]
    s_mov_b32 s10, 0xbfb8aa3b
    ds_read_b128 v[48:51], v17 offset:14336
    buffer_load_dwordx4 v[140:143], v21, s[44:47], s7 offen sc1
    v_mfma_f32_16x16x32_bf16 v[124:127], v[60:63], v[184:187], v[124:127]
    v_permlane16_swap_b32 v8, v10
    v_mfma_f32_16x16x32_bf16 v[120:123], v[60:63], v[180:183], v[120:123]
    ds_read_b128 v[52:55], v17 offset:17408
    v_cvt_pk_bf16_f32 v76, v112, v113
    v_mfma_f32_16x16x32_bf16 v[120:123], v[56:59], v[172:175], v[120:123]
    s_waitcnt lgkmcnt(4)
    v_permlane16_swap_b32 v9, v11
    v_and_b32 v81, 0xffff0000, v8
    v_mfma_f32_16x16x32_bf16 v[120:123], v[32:35], v[188:191], v[120:123]
    ds_read_b128 v[56:59], v17 offset:20480
    v_cvt_pk_bf16_f32 v77, v114, v115
    v_lshlrev_b32 v80, 16, v8
    v_mfma_f32_16x16x32_bf16 v[120:123], v[36:39], v[196:199], v[120:123]
    buffer_load_dwordx4 v19, s[44:47], s92 offen offset:1024 sc1 lds
    v_and_b32 v83, 0xffff0000, v9
    v_lshlrev_b32 v82, 16, v9
    v_mfma_f32_16x16x32_bf16 v[124:127], v[36:39], v[200:203], v[124:127]
    ds_read_b128 v[60:63], v17 offset:23552
    v_cvt_pk_bf16_f32 v78, v116, v117
    v_and_b32 v89, 0xffff0000, v10
    v_mfma_f32_16x16x32_bf16 v[124:127], v[32:35], v[192:195], v[124:127]
    s_waitcnt vmcnt(13) lgkmcnt(4)
    s_barrier
    v_lshlrev_b32 v88, 16, v10
    v_and_b32 v91, 0xffff0000, v11
    v_lshlrev_b32 v90, 16, v11
    v_mfma_f32_16x16x32_bf16 v[124:127], v[40:43], v[208:211], v[124:127]
    ds_read_b128 v[32:35], v17 offset:24576
    v_fma_f32 v96, v80, v147, -v146
    v_fma_f32 v97, v81, v147, -v146
    v_mfma_f32_16x16x32_bf16 v[124:127], v[44:47], v[216:219], v[124:127]
    buffer_load_dwordx4 v20, s[44:47], s94 offen offset:2048 sc1 lds
    v_cvt_pk_bf16_f32 v79, v118, v119
    v_fma_f32 v98, v82, v147, -v146
    v_mfma_f32_16x16x32_bf16 v[120:123], v[44:47], v[212:215], v[120:123]
    s_add_u32 m0, s21, 36864
    ds_read_b128 v[36:39], v17 offset:27648
    v_fma_f32 v99, v83, v147, -v146
    v_fma_f32 v104, v88, v147, -v146
    v_mfma_f32_16x16x32_bf16 v[120:123], v[40:43], v[204:207], v[120:123]
    s_waitcnt lgkmcnt(4)
    buffer_load_dwordx4 v18, s[44:47], s96 offen offset:0 sc1 lds
    v_bfi_b32 v76, s33, v253, v76
    v_fma_f32 v105, v89, v147, -v146
    v_mfma_f32_16x16x32_bf16 v[120:123], v[48:51], v[220:223], v[120:123]
    ds_read_b128 v[40:43], v17 offset:30720
    v_fma_f32 v106, v90, v147, -v146
    v_fma_f32 v107, v91, v147, -v146
    v_mfma_f32_16x16x32_bf16 v[120:123], v[52:55], v[228:231], v[120:123]
    buffer_load_dwordx4 v19, s[44:47], s98 offen offset:1024 sc1 lds
    v_permlane16_swap_b32 v12, v14
    v_mfma_f32_16x16x32_bf16 v[124:127], v[52:55], v[232:235], v[124:127]
    ds_read_b128 v[44:47], v17 offset:33792
    v_bfi_b32 v77, s33, v255, v77
    v_mfma_f32_16x16x32_bf16 v[124:127], v[48:51], v[224:227], v[124:127]
    s_waitcnt lgkmcnt(4)
    buffer_load_dwordx4 v20, s[44:47], s100 offen offset:2048 sc1 lds
    v_permlane16_swap_b32 v13, v15
    v_mfma_f32_16x16x32_bf16 v[124:127], v[56:59], v[240:243], v[124:127]
    ds_read_b128 v[48:51], v17 offset:25600
    v_bfi_b32 v78, s33, v23, v78
    v_and_b32 v85, 0xffff0000, v12
    v_mfma_f32_16x16x32_bf16 v[124:127], v[60:63], v[248:251], v[124:127]
    v_lshlrev_b32 v84, 16, v12
    v_and_b32 v87, 0xffff0000, v13
    v_lshlrev_b32 v86, 16, v13
    v_mfma_f32_16x16x32_bf16 v[120:123], v[60:63], v[244:247], v[120:123]
    ds_read_b128 v[52:55], v17 offset:28672
    v_bfi_b32 v79, s33, v0, v79
    v_and_b32 v93, 0xffff0000, v14
    v_mfma_f32_16x16x32_bf16 v[120:123], v[56:59], v[236:239], v[120:123]
    s_waitcnt lgkmcnt(4)
    v_lshlrev_b32 v92, 16, v14
    v_and_b32 v95, 0xffff0000, v15
    v_mfma_f32_16x16x32_bf16 v[120:123], v[32:35], a[0:3], v[120:123]
    ds_read_b128 v[56:59], v17 offset:31744
    v_lshlrev_b32 v94, 16, v15
    v_mfma_f32_16x16x32_bf16 v[120:123], v[36:39], a[8:11], v[120:123]
    v_fma_f32 v100, v84, v149, -v148
    v_fma_f32 v101, v85, v149, -v148
    v_mfma_f32_16x16x32_bf16 v[124:127], v[36:39], a[12:15], v[124:127]
    ds_read_b128 v[60:63], v17 offset:34816
    v_fma_f32 v102, v86, v149, -v148
    v_mfma_f32_16x16x32_bf16 v[124:127], v[32:35], a[4:7], v[124:127]
    s_waitcnt lgkmcnt(4)
    v_fma_f32 v103, v87, v149, -v148
    v_fma_f32 v108, v92, v149, -v148
    v_mfma_f32_16x16x32_bf16 v[124:127], v[40:43], a[20:23], v[124:127]
    ds_read_b128 v[32:35], v17 offset:26624
    v_fma_f32 v109, v93, v149, -v148
    v_mfma_f32_16x16x32_bf16 v[124:127], v[44:47], a[28:31], v[124:127]
    v_fma_f32 v110, v94, v149, -v148
    v_fma_f32 v111, v95, v149, -v148
    v_mfma_f32_16x16x32_bf16 v[120:123], v[44:47], a[24:27], v[120:123]
    ds_read_b128 v[36:39], v17 offset:29696
    ds_read_b64_tr_b16 v[64:65], v252 offset:4096
    ds_read_b64_tr_b16 v[66:67], v252 offset:4128
    ds_read_b64_tr_b16 v[68:69], v252 offset:8192
    ds_read_b64_tr_b16 v[70:71], v252 offset:8224
    v_mfma_f32_16x16x32_bf16 v[120:123], v[40:43], a[16:19], v[120:123]
    s_waitcnt lgkmcnt(8)
    s_waitcnt lgkmcnt(0)
    v_and_b32 v9, 0xffff0000, v64
    v_lshlrev_b32 v8, 16, v64
    v_and_b32 v11, 0xffff0000, v65
    v_lshlrev_b32 v10, 16, v65
    v_mul_f32 v96, v96, v8
    v_mul_f32 v97, v97, v9
    v_mul_f32 v98, v98, v10
    v_mul_f32 v99, v99, v11
    v_and_b32 v9, 0xffff0000, v66
    v_lshlrev_b32 v8, 16, v66
    v_and_b32 v11, 0xffff0000, v67
    v_mfma_f32_16x16x32_bf16 v[120:123], v[48:51], a[32:35], v[120:123]
    ds_read_b128 v[40:43], v17 offset:32768
    v_lshlrev_b32 v10, 16, v67
    v_mul_f32 v100, v100, v8
    v_mul_f32 v101, v101, v9
    v_mul_f32 v102, v102, v10
    v_mul_f32 v103, v103, v11
    v_and_b32 v9, 0xffff0000, v68
    v_lshlrev_b32 v8, 16, v68
    v_and_b32 v11, 0xffff0000, v69
    v_lshlrev_b32 v10, 16, v69
    v_mul_f32 v104, v104, v8
    v_mfma_f32_16x16x32_bf16 v[120:123], v[52:55], a[40:43], v[120:123]
    v_mul_f32 v105, v105, v9
    v_mul_f32 v106, v106, v10
    v_mul_f32 v107, v107, v11
    v_and_b32 v9, 0xffff0000, v70
    v_lshlrev_b32 v8, 16, v70
    v_and_b32 v11, 0xffff0000, v71
    v_lshlrev_b32 v10, 16, v71
    v_mul_f32 v108, v108, v8
    v_mul_f32 v109, v109, v9
    v_mul_f32 v110, v110, v10
    v_mul_f32 v111, v111, v11
    v_mfma_f32_16x16x32_bf16 v[124:127], v[52:55], a[44:47], v[124:127]
    ds_read_b128 v[44:47], v17 offset:35840
    v_mfma_f32_16x16x32_bf16 v[124:127], v[48:51], a[36:39], v[124:127]
    s_waitcnt vmcnt(12)
    s_barrier
    ds_read_b64_tr_b16 v[6:7], v31
    v_add_f32 v128, v128, v154
    v_mfma_f32_16x16x32_bf16 v[124:127], v[56:59], a[52:55], v[124:127]
    s_add_u32 m0, s21, 49152
    ds_read_b128 v[48:51], v16 offset:0
    v_add_u32 v18, s75, v22
    v_mfma_f32_16x16x32_bf16 v[124:127], v[60:63], a[60:63], v[124:127]
    buffer_load_dwordx4 v18, s[44:47], s84 offen offset:0 sc1 lds
    v_add_f32 v129, v129, v154
    v_mfma_f32_16x16x32_bf16 v[120:123], v[60:63], a[56:59], v[120:123]
    ds_read_b128 v[52:55], v16 offset:3072
    v_add_u32 v19, -1024, v18
    v_mfma_f32_16x16x32_bf16 v[120:123], v[56:59], a[48:51], v[120:123]
    buffer_load_dwordx4 v19, s[44:47], s86 offen offset:1024 sc1 lds
    v_add_f32 v130, v130, v154
    v_mfma_f32_16x16x32_bf16 v[120:123], v[32:35], a[64:67], v[120:123]
    ds_read_b128 v[56:59], v16 offset:6144
    v_add_u32 v20, -2048, v18
    v_mfma_f32_16x16x32_bf16 v[120:123], v[36:39], a[72:75], v[120:123]
    buffer_load_dwordx4 v20, s[44:47], s88 offen offset:2048 sc1 lds
    v_add_f32 v131, v131, v154
    v_mfma_f32_16x16x32_bf16 v[124:127], v[36:39], a[76:79], v[124:127]
    s_waitcnt vmcnt(8)
    ds_read_b128 v[60:63], v16 offset:9216
    v_xor_b32 v132, v253, v132
    v_mfma_f32_16x16x32_bf16 v[124:127], v[32:35], a[68:71], v[124:127]
    s_waitcnt lgkmcnt(5)
    v_xor_b32 v133, v255, v133
    v_xor_b32 v134, v23, v134
    v_mfma_f32_16x16x32_bf16 v[124:127], v[40:43], a[84:87], v[124:127]
    ds_read_b128 v[32:35], v16 offset:1024
    v_xor_b32 v135, v0, v135
    v_mfma_f32_16x16x32_bf16 v[124:127], v[44:47], a[92:95], v[124:127]
    buffer_store_dwordx4 v[76:79], v21, s[44:47], s80 offen sc1
    v_mfma_f32_16x16x32_bf16 v[120:123], v[44:47], a[88:91], v[120:123]
    ds_read_b128 v[36:39], v16 offset:4096
    v_or3_b32 v1, v132, v133, v134
    v_mfma_f32_16x16x32_bf16 v[120:123], v[40:43], a[80:83], v[120:123]
    s_waitcnt lgkmcnt(4)
    v_xor_b32 v136, v253, v136
    v_mfma_f32_16x16x32_bf16 v[120:123], v[48:51], a[96:99], v[120:123]
    ds_read_b128 v[40:43], v16 offset:7168
    v_xor_b32 v137, v255, v137
    v_mfma_f32_16x16x32_bf16 v[120:123], v[52:55], a[104:107], v[120:123]
    v_or3_b32 v1, v135, v136, v1
    v_mfma_f32_16x16x32_bf16 v[124:127], v[52:55], a[108:111], v[124:127]
    ds_read_b128 v[44:47], v16 offset:10240
    v_xor_b32 v138, v23, v138
    v_mfma_f32_16x16x32_bf16 v[124:127], v[48:51], a[100:103], v[124:127]
    s_waitcnt lgkmcnt(4)
    v_mfma_f32_16x16x32_bf16 v[124:127], v[56:59], a[116:119], v[124:127]
    ds_read_b128 v[48:51], v16 offset:2048
    v_xor_b32 v139, v0, v139
    v_mfma_f32_16x16x32_bf16 v[124:127], v[60:63], a[124:127], v[124:127]
    v_or3_b32 v1, v137, v138, v1
    v_xor_b32 v140, v253, v140
    v_mfma_f32_16x16x32_bf16 v[120:123], v[60:63], a[120:123], v[120:123]
    ds_read_b128 v[52:55], v16 offset:5120
    v_xor_b32 v141, v255, v141
    v_mfma_f32_16x16x32_bf16 v[120:123], v[56:59], a[112:115], v[120:123]
    s_waitcnt lgkmcnt(4)
    v_or3_b32 v1, v139, v140, v1
    v_xor_b32 v142, v23, v142
    v_mfma_f32_16x16x32_bf16 v[120:123], v[32:35], a[192:195], v[120:123]
    ds_read_b128 v[56:59], v16 offset:8192
    v_xor_b32 v143, v0, v143
    v_mfma_f32_16x16x32_bf16 v[120:123], v[36:39], a[200:203], v[120:123]
    v_or3_b32 v1, v141, v142, v1
    v_or_b32 v1, v143, v1
    v_mfma_f32_16x16x32_bf16 v[124:127], v[36:39], a[204:207], v[124:127]
    ds_read_b128 v[60:63], v16 offset:11264
    v_and_b32 v1, s33, v1
    v_mfma_f32_16x16x32_bf16 v[124:127], v[32:35], a[196:199], v[124:127]
    s_waitcnt lgkmcnt(4)
    s_barrier
    v_cmp_ne_u32 vcc, 0, v1
    s_cbranch_vccnz L_rs_cl
L_ok_cl:
    v_mfma_f32_16x16x32_bf16 v[124:127], v[40:43], a[212:215], v[124:127]
    s_add_u32 m0, s21, 61440
    ds_read_b128 v[32:35], v16 offset:12288
    v_mfma_f32_16x16x32_bf16 v[124:127], v[44:47], a[220:223], v[124:127]
    buffer_load_dwordx4 v18, s[44:47], s90 offen offset:0 sc1 lds
    v_mfma_f32_16x16x32_bf16 v[120:123], v[44:47], a[216:219], v[120:123]
    ds_read_b128 v[36:39], v16 offset:15360
    v_mfma_f32_16x16x32_bf16 v[120:123], v[40:43], a[208:211], v[120:123]
    s_waitcnt lgkmcnt(4)
    buffer_load_dwordx4 v19, s[44:47], s92 offen offset:1024 sc1 lds
    v_mfma_f32_16x16x32_bf16 v[120:123], v[48:51], a[224:227], v[120:123]
    ds_read_b128 v[40:43], v16 offset:18432
    v_cndmask_b32 v132, v132, v134, s[26:27]
    v_mfma_f32_16x16x32_bf16 v[120:123], v[52:55], a[232:235], v[120:123]
    buffer_load_dwordx4 v20, s[44:47], s94 offen offset:2048 sc1 lds
    v_cndmask_b32 v133, v133, v135, s[26:27]
    v_mfma_f32_16x16x32_bf16 v[124:127], v[52:55], a[236:239], v[124:127]
    ds_read_b128 v[44:47], v16 offset:21504
    v_mfma_f32_16x16x32_bf16 v[124:127], v[48:51], a[228:231], v[124:127]
    s_waitcnt lgkmcnt(4)
    v_cndmask_b32 v136, v136, v138, s[26:27]
    v_mfma_f32_16x16x32_bf16 v[124:127], v[56:59], a[244:247], v[124:127]
    s_add_u32 s6, s83, 0
    ds_read_b128 v[48:51], v16 offset:13312
    v_cndmask_b32 v137, v137, v139, s[26:27]
    v_mfma_f32_16x16x32_bf16 v[124:127], v[60:63], a[252:255], v[124:127]
    v_cndmask_b32 v140, v140, v142, s[26:27]
    buffer_load_dwordx4 v[64:67], v21, s[44:47], s6 offen offset:0 sc1
    v_mfma_f32_16x16x32_bf16 v[120:123], v[60:63], a[248:251], v[120:123]
    ds_read_b128 v[52:55], v16 offset:16384
    v_cndmask_b32 v141, v141, v143, s[26:27]
    v_mfma_f32_16x16x32_bf16 v[120:123], v[56:59], a[240:243], v[120:123]
    s_waitcnt lgkmcnt(4)
    v_mfma_f32_16x16x32_bf16 v[128:131], a[130:133], v[132:135], v[128:131]
    v_mfma_f32_16x16x32_bf16 v[112:115], v[32:35], v[156:159], 0
    ds_read_b128 v[56:59], v16 offset:19456
    buffer_load_dwordx4 v[68:71], v21, s[44:47], s6 offen offset:1024 sc1
    v_mfma_f32_16x16x32_bf16 v[112:115], v[36:39], v[164:167], v[112:115]
    v_mfma_f32_16x16x32_bf16 v[128:131], a[130:133], v[136:139], v[128:131]
    v_mfma_f32_16x16x32_bf16 v[116:119], v[36:39], v[168:171], 0
    ds_read_b128 v[60:63], v16 offset:22528
    buffer_load_dwordx4 v[72:75], v21, s[44:47], s6 offen offset:2048 sc1
    v_mfma_f32_16x16x32_bf16 v[116:119], v[32:35], v[160:163], v[116:119]
    s_waitcnt lgkmcnt(4)
    v_mfma_f32_16x16x32_bf16 v[128:131], a[130:133], v[140:143], v[128:131]
    v_mfma_f32_16x16x32_bf16 v[116:119], v[40:43], v[176:179], v[116:119]
    ds_read_b128 v[32:35], v16 offset:14336
    v_and_b32 v133, 0xffff0000, v4
    v_mfma_f32_16x16x32_bf16 v[116:119], v[44:47], v[184:187], v[116:119]
    v_lshlrev_b32 v132, 16, v4
    v_and_b32 v135, 0xffff0000, v5
    v_mfma_f32_16x16x32_bf16 v[112:115], v[44:47], v[180:183], v[112:115]
    ds_read_b128 v[36:39], v16 offset:17408
    v_cvt_pk_bf16_f32 v120, v120, v121
    v_mfma_f32_16x16x32_bf16 v[112:115], v[40:43], v[172:175], v[112:115]
    s_waitcnt lgkmcnt(4)
    v_lshlrev_b32 v134, 16, v5
    v_fma_f32 v12, v132, v151, -v150
    v_mfma_f32_16x16x32_bf16 v[112:115], v[48:51], v[188:191], v[112:115]
    ds_read_b128 v[40:43], v16 offset:20480
    v_cvt_pk_bf16_f32 v121, v122, v123
    v_mfma_f32_16x16x32_bf16 v[112:115], v[52:55], v[196:199], v[112:115]
    v_fma_f32 v13, v133, v151, -v150
    v_fma_f32 v14, v134, v151, -v150
    v_mfma_f32_16x16x32_bf16 v[116:119], v[52:55], v[200:203], v[116:119]
    ds_read_b128 v[44:47], v16 offset:23552
    v_cvt_pk_bf16_f32 v122, v124, v125
    v_mfma_f32_16x16x32_bf16 v[116:119], v[48:51], v[192:195], v[116:119]
    s_waitcnt vmcnt(13) lgkmcnt(4)
    s_barrier
    v_fma_f32 v15, v135, v151, -v150
    v_mfma_f32_16x16x32_bf16 v[116:119], v[56:59], v[208:211], v[116:119]
    s_add_u32 m0, s21, 0
    ds_read_b128 v[48:51], v16 offset:24576
    v_and_b32 v9, 0xffff0000, v6
    v_mfma_f32_16x16x32_bf16 v[116:119], v[60:63], v[216:219], v[116:119]
    buffer_load_dwordx4 v18, s[44:47], s96 offen offset:0 sc1 lds
    v_cvt_pk_bf16_f32 v123, v126, v127
    v_mfma_f32_16x16x32_bf16 v[112:115], v[60:63], v[212:215], v[112:115]
    ds_read_b128 v[52:55], v16 offset:27648
    v_lshlrev_b32 v8, 16, v6
    v_mfma_f32_16x16x32_bf16 v[112:115], v[56:59], v[204:207], v[112:115]
    s_waitcnt lgkmcnt(4)
    buffer_load_dwordx4 v19, s[44:47], s98 offen offset:1024 sc1 lds
    v_bfi_b32 v120, s33, v253, v120
    v_mfma_f32_16x16x32_bf16 v[112:115], v[32:35], v[220:223], v[112:115]
    ds_read_b128 v[56:59], v16 offset:30720
    v_and_b32 v11, 0xffff0000, v7
    v_mfma_f32_16x16x32_bf16 v[112:115], v[36:39], v[228:231], v[112:115]
    v_lshlrev_b32 v10, 16, v7
    v_mul_f32 v12, v12, v8
    v_mfma_f32_16x16x32_bf16 v[116:119], v[36:39], v[232:235], v[116:119]
    ds_read_b128 v[60:63], v16 offset:33792
    v_bfi_b32 v121, s33, v255, v121
    v_mfma_f32_16x16x32_bf16 v[116:119], v[32:35], v[224:227], v[116:119]
    s_waitcnt lgkmcnt(4)
    v_mul_f32 v13, v13, v9
    v_mul_f32 v14, v14, v10
    v_mfma_f32_16x16x32_bf16 v[116:119], v[40:43], v[240:243], v[116:119]
    ds_read_b128 v[32:35], v16 offset:25600
    v_bfi_b32 v122, s33, v23, v122
    v_mfma_f32_16x16x32_bf16 v[116:119], v[44:47], v[248:251], v[116:119]
    v_mul_f32 v15, v15, v11
    v_mul_f32 v8, s10, v128
    v_mfma_f32_16x16x32_bf16 v[112:115], v[44:47], v[244:247], v[112:115]
    ds_read_b128 v[36:39], v16 offset:28672
    v_bfi_b32 v123, s33, v0, v123
    v_mfma_f32_16x16x32_bf16 v[112:115], v[40:43], v[236:239], v[112:115]
    s_waitcnt lgkmcnt(4)
    v_mul_f32 v9, s10, v129
    v_mul_f32 v10, s10, v130
    v_mfma_f32_16x16x32_bf16 v[112:115], v[48:51], a[0:3], v[112:115]
    ds_read_b128 v[40:43], v16 offset:31744
    v_mul_f32 v11, s10, v131
    v_mfma_f32_16x16x32_bf16 v[112:115], v[52:55], a[8:11], v[112:115]
    v_exp_f32 v8, v8
    v_mfma_f32_16x16x32_bf16 v[116:119], v[52:55], a[12:15], v[116:119]
    ds_read_b128 v[44:47], v16 offset:34816
    v_mfma_f32_16x16x32_bf16 v[116:119], v[48:51], a[4:7], v[116:119]
    s_waitcnt lgkmcnt(4)
    v_exp_f32 v9, v9
    v_mfma_f32_16x16x32_bf16 v[116:119], v[56:59], a[20:23], v[116:119]
    ds_read_b128 v[48:51], v16 offset:26624
    v_mfma_f32_16x16x32_bf16 v[116:119], v[60:63], a[28:31], v[116:119]
    v_exp_f32 v10, v10
    v_mfma_f32_16x16x32_bf16 v[112:115], v[60:63], a[24:27], v[112:115]
    ds_read_b128 v[52:55], v16 offset:29696
    v_mfma_f32_16x16x32_bf16 v[112:115], v[56:59], a[16:19], v[112:115]
    s_waitcnt lgkmcnt(4)
    v_exp_f32 v11, v11
    v_mfma_f32_16x16x32_bf16 v[112:115], v[32:35], a[32:35], v[112:115]
    ds_read_b128 v[56:59], v16 offset:32768
    v_mfma_f32_16x16x32_bf16 v[112:115], v[36:39], a[40:43], v[112:115]
L_pl_S_3:
    s_cbranch_execz L_wret
    buffer_load_dwordx4 v20, s[44:47], s100 offen offset:2048 sc1 lds
    v_mul_f32 v12, v12, v128
    v_mfma_f32_16x16x32_bf16 v[116:119], v[36:39], a[44:47], v[116:119]
    ds_read_b128 v[60:63], v16 offset:35840
    v_mul_f32 v13, v13, v129
    v_mfma_f32_16x16x32_bf16 v[116:119], v[32:35], a[36:39], v[116:119]
    s_waitcnt vmcnt(13) lgkmcnt(4)
    s_barrier
    v_mul_f32 v14, v14, v130
    v_mul_f32 v15, v15, v131
    v_mfma_f32_16x16x32_bf16 v[116:119], v[40:43], a[52:55], v[116:119]
    s_add_u32 m0, s21, 12288
    ds_read_b128 v[32:35], v17 offset:0
    v_add_u32 v18, s76, v22
    v_mfma_f32_16x16x32_bf16 v[116:119], v[44:47], a[60:63], v[116:119]
    buffer_load_dwordx4 v18, s[44:47], s84 offen offset:0 sc1 lds
    v_add_f32 v8, 1.0, v8
    v_mfma_f32_16x16x32_bf16 v[112:115], v[44:47], a[56:59], v[112:115]
    ds_read_b128 v[36:39], v17 offset:3072
    v_add_u32 v19, -1024, v18
    v_mfma_f32_16x16x32_bf16 v[112:115], v[40:43], a[48:51], v[112:115]
    s_waitcnt lgkmcnt(4)
    buffer_load_dwordx4 v19, s[44:47], s86 offen offset:1024 sc1 lds
    v_add_f32 v9, 1.0, v9
    v_mfma_f32_16x16x32_bf16 v[112:115], v[48:51], a[64:67], v[112:115]
    ds_read_b128 v[40:43], v17 offset:6144
    v_add_u32 v20, -2048, v18
    v_mfma_f32_16x16x32_bf16 v[112:115], v[52:55], a[72:75], v[112:115]
    buffer_load_dwordx4 v20, s[44:47], s88 offen offset:2048 sc1 lds
    v_add_f32 v10, 1.0, v10
    v_mfma_f32_16x16x32_bf16 v[116:119], v[52:55], a[76:79], v[116:119]
    ds_read_b128 v[44:47], v17 offset:9216
    v_add_f32 v11, 1.0, v11
    v_mfma_f32_16x16x32_bf16 v[116:119], v[48:51], a[68:71], v[116:119]
    s_waitcnt lgkmcnt(4)
    v_rcp_f32 v8, v8
    v_mfma_f32_16x16x32_bf16 v[116:119], v[56:59], a[84:87], v[116:119]
    ds_read_b128 v[48:51], v17 offset:1024
    v_rcp_f32 v9, v9
    v_mfma_f32_16x16x32_bf16 v[116:119], v[60:63], a[92:95], v[116:119]
    v_rcp_f32 v10, v10
    v_mfma_f32_16x16x32_bf16 v[112:115], v[60:63], a[88:91], v[112:115]
    ds_read_b128 v[52:55], v17 offset:4096
    v_rcp_f32 v11, v11
    v_mfma_f32_16x16x32_bf16 v[112:115], v[56:59], a[80:83], v[112:115]
    s_waitcnt lgkmcnt(4)
    v_fma_f32 v12, v12, v8, v132
    v_mfma_f32_16x16x32_bf16 v[112:115], v[32:35], a[96:99], v[112:115]
    ds_read_b128 v[56:59], v17 offset:7168
    v_fma_f32 v13, v13, v9, v133
    v_mfma_f32_16x16x32_bf16 v[112:115], v[36:39], a[104:107], v[112:115]
    buffer_store_dwordx4 v[120:123], v21, s[44:47], s81 offen sc1
    v_mfma_f32_16x16x32_bf16 v[116:119], v[36:39], a[108:111], v[116:119]
    ds_read_b128 v[60:63], v17 offset:10240
    v_fma_f32 v14, v14, v10, v134
    v_mfma_f32_16x16x32_bf16 v[116:119], v[32:35], a[100:103], v[116:119]
    s_waitcnt lgkmcnt(4)
    v_fma_f32 v15, v15, v11, v135
    v_cvt_pk_bf16_f32 v128, v12, v13
    v_mfma_f32_16x16x32_bf16 v[116:119], v[40:43], a[116:119], v[116:119]
    ds_read_b128 v[32:35], v17 offset:2048
    v_cvt_pk_bf16_f32 v129, v14, v15
    v_mfma_f32_16x16x32_bf16 v[116:119], v[44:47], a[124:127], v[116:119]
    buffer_store_dwordx2 v[128:129], v145, s[64:67], 0 offen sc1
    v_mfma_f32_16x16x32_bf16 v[112:115], v[44:47], a[120:123], v[112:115]
    ds_read_b128 v[36:39], v17 offset:5120
    v_mfma_f32_16x16x32_bf16 v[112:115], v[40:43], a[112:115], v[112:115]
    s_waitcnt lgkmcnt(4)
    v_mfma_f32_16x16x32_bf16 v[112:115], v[48:51], a[192:195], v[112:115]
    ds_read_b128 v[40:43], v17 offset:8192
    v_mfma_f32_16x16x32_bf16 v[112:115], v[52:55], a[200:203], v[112:115]
    v_mfma_f32_16x16x32_bf16 v[116:119], v[52:55], a[204:207], v[116:119]
    ds_read_b128 v[44:47], v17 offset:11264
    v_mfma_f32_16x16x32_bf16 v[116:119], v[48:51], a[196:199], v[116:119]
    s_waitcnt vmcnt(15) lgkmcnt(4)
    s_barrier
    v_mfma_f32_16x16x32_bf16 v[116:119], v[56:59], a[212:215], v[116:119]
    s_add_u32 m0, s21, 24576
    ds_read_b128 v[48:51], v17 offset:12288
    v_mfma_f32_16x16x32_bf16 v[116:119], v[60:63], a[220:223], v[116:119]
    buffer_load_dwordx4 v18, s[44:47], s90 offen offset:0 sc1 lds
    v_mfma_f32_16x16x32_bf16 v[112:115], v[60:63], a[216:219], v[112:115]
    ds_read_b128 v[52:55], v17 offset:15360
    v_mfma_f32_16x16x32_bf16 v[112:115], v[56:59], a[208:211], v[112:115]
    s_waitcnt lgkmcnt(4)
    buffer_load_dwordx4 v19, s[44:47], s92 offen offset:1024 sc1 lds
    v_mfma_f32_16x16x32_bf16 v[112:115], v[32:35], a[224:227], v[112:115]
    ds_read_b128 v[56:59], v17 offset:18432
    v_mfma_f32_16x16x32_bf16 v[112:115], v[36:39], a[232:235], v[112:115]
    buffer_load_dwordx4 v20, s[44:47], s94 offen offset:2048 sc1 lds
    v_mfma_f32_16x16x32_bf16 v[116:119], v[36:39], a[236:239], v[116:119]
    ds_read_b128 v[60:63], v17 offset:21504
    v_mfma_f32_16x16x32_bf16 v[116:119], v[32:35], a[228:231], v[116:119]
    s_waitcnt lgkmcnt(4)
    v_mfma_f32_16x16x32_bf16 v[116:119], v[40:43], a[244:247], v[116:119]
    ds_read_b128 v[32:35], v17 offset:13312
    v_mfma_f32_16x16x32_bf16 v[116:119], v[44:47], a[252:255], v[116:119]
    v_mfma_f32_16x16x32_bf16 v[112:115], v[44:47], a[248:251], v[112:115]
    ds_read_b128 v[36:39], v17 offset:16384
    v_mfma_f32_16x16x32_bf16 v[112:115], v[40:43], a[240:243], v[112:115]
    s_waitcnt lgkmcnt(4)
    v_mfma_f32_16x16x32_bf16 v[128:131], v[48:51], v[156:159], 0
    ds_read_b128 v[40:43], v17 offset:19456
    v_mfma_f32_16x16x32_bf16 v[128:131], v[52:55], v[164:167], v[128:131]
    v_mfma_f32_16x16x32_bf16 v[132:135], v[52:55], v[168:171], 0
    ds_read_b128 v[44:47], v17 offset:22528
    v_mfma_f32_16x16x32_bf16 v[132:135], v[48:51], v[160:163], v[132:135]
    s_waitcnt lgkmcnt(4)
    v_mfma_f32_16x16x32_bf16 v[132:135], v[56:59], v[176:179], v[132:135]
    ds_read_b128 v[48:51], v17 offset:14336
    v_mfma_f32_16x16x32_bf16 v[132:135], v[60:63], v[184:187], v[132:135]
    s_waitcnt vmcnt(11)
    v_cvt_pk_bf16_f32 v112, v112, v113
    v_cvt_pk_bf16_f32 v113, v114, v115
    v_mfma_f32_16x16x32_bf16 v[128:131], v[60:63], v[180:183], v[128:131]
    ds_read_b128 v[52:55], v17 offset:17408
    v_cvt_pk_bf16_f32 v114, v116, v117
    v_mfma_f32_16x16x32_bf16 v[128:131], v[56:59], v[172:175], v[128:131]
    s_waitcnt lgkmcnt(4)
    v_cvt_pk_bf16_f32 v115, v118, v119
    v_bfi_b32 v112, s33, v253, v112
    v_mfma_f32_16x16x32_bf16 v[128:131], v[32:35], v[188:191], v[128:131]
    ds_read_b128 v[56:59], v17 offset:20480
    v_bfi_b32 v113, s33, v255, v113
    v_mfma_f32_16x16x32_bf16 v[128:131], v[36:39], v[196:199], v[128:131]
    v_bfi_b32 v114, s33, v23, v114
    v_bfi_b32 v115, s33, v0, v115
    v_mfma_f32_16x16x32_bf16 v[132:135], v[36:39], v[200:203], v[132:135]
    ds_read_b128 v[60:63], v17 offset:23552
    v_xor_b32 v64, v253, v64
    v_mfma_f32_16x16x32_bf16 v[132:135], v[32:35], v[192:195], v[132:135]
    s_waitcnt lgkmcnt(4)
    s_barrier
    buffer_store_dwordx4 v[112:115], v21, s[44:47], s82 offen sc1
    v_mfma_f32_16x16x32_bf16 v[132:135], v[40:43], v[208:211], v[132:135]
    s_add_u32 m0, s21, 36864
    ds_read_b128 v[32:35], v17 offset:24576
    v_xor_b32 v65, v255, v65
    v_mfma_f32_16x16x32_bf16 v[132:135], v[44:47], v[216:219], v[132:135]
    buffer_load_dwordx4 v18, s[44:47], s96 offen offset:0 sc1 lds
    v_xor_b32 v66, v23, v66
    v_mfma_f32_16x16x32_bf16 v[128:131], v[44:47], v[212:215], v[128:131]
    ds_read_b128 v[36:39], v17 offset:27648
    v_xor_b32 v67, v0, v67
    v_mfma_f32_16x16x32_bf16 v[128:131], v[40:43], v[204:207], v[128:131]
    s_waitcnt lgkmcnt(4)
    buffer_load_dwordx4 v19, s[44:47], s98 offen offset:1024 sc1 lds
    v_or3_b32 v1, v64, v65, v66
    v_mfma_f32_16x16x32_bf16 v[128:131], v[48:51], v[220:223], v[128:131]
    ds_read_b128 v[40:43], v17 offset:30720
    v_xor_b32 v68, v253, v68
    v_mfma_f32_16x16x32_bf16 v[128:131], v[52:55], v[228:231], v[128:131]
    buffer_load_dwordx4 v20, s[44:47], s100 offen offset:2048 sc1 lds
    v_xor_b32 v69, v255, v69
    v_mfma_f32_16x16x32_bf16 v[132:135], v[52:55], v[232:235], v[132:135]
    ds_read_b128 v[44:47], v17 offset:33792
    v_or3_b32 v1, v67, v68, v1
    v_mfma_f32_16x16x32_bf16 v[132:135], v[48:51], v[224:227], v[132:135]
    s_waitcnt lgkmcnt(4)
    v_xor_b32 v70, v23, v70
    v_xor_b32 v71, v0, v71
    v_mfma_f32_16x16x32_bf16 v[132:135], v[56:59], v[240:243], v[132:135]
    ds_read_b128 v[48:51], v17 offset:25600
    v_or3_b32 v1, v69, v70, v1
    v_mfma_f32_16x16x32_bf16 v[132:135], v[60:63], v[248:251], v[132:135]
    v_xor_b32 v72, v253, v72
    v_xor_b32 v73, v255, v73
    v_mfma_f32_16x16x32_bf16 v[128:131], v[60:63], v[244:247], v[128:131]
    ds_read_b128 v[52:55], v17 offset:28672
    v_or3_b32 v1, v71, v72, v1
    v_mfma_f32_16x16x32_bf16 v[128:131], v[56:59], v[236:239], v[128:131]
    s_waitcnt lgkmcnt(4)
    v_xor_b32 v74, v23, v74
    v_xor_b32 v75, v0, v75
    v_mfma_f32_16x16x32_bf16 v[128:131], v[32:35], a[0:3], v[128:131]
    ds_read_b128 v[56:59], v17 offset:31744
    v_or3_b32 v1, v73, v74, v1
    v_mfma_f32_16x16x32_bf16 v[128:131], v[36:39], a[8:11], v[128:131]
    v_or_b32 v1, v75, v1
    v_and_b32 v1, s33, v1
    v_mfma_f32_16x16x32_bf16 v[132:135], v[36:39], a[12:15], v[132:135]
    ds_read_b128 v[60:63], v17 offset:34816
    v_cmp_ne_u32 vcc, 0, v1
    s_cbranch_vccnz L_rs_ol0
L_ok_ol0:
    v_mfma_f32_16x16x32_bf16 v[132:135], v[32:35], a[4:7], v[132:135]
    s_waitcnt lgkmcnt(4)
    v_mfma_f32_16x16x32_bf16 v[128:131], a[130:133], v[64:67], v[128:131]
    v_mfma_f32_16x16x32_bf16 v[132:135], v[40:43], a[20:23], v[132:135]
    ds_read_b128 v[32:35], v17 offset:26624
    v_mfma_f32_16x16x32_bf16 v[132:135], v[44:47], a[28:31], v[132:135]
    v_mfma_f32_16x16x32_bf16 v[132:135], a[128:131], v[64:67], v[132:135]
    v_mfma_f32_16x16x32_bf16 v[128:131], v[44:47], a[24:27], v[128:131]
    ds_read_b128 v[36:39], v17 offset:29696
    v_mfma_f32_16x16x32_bf16 v[128:131], v[40:43], a[16:19], v[128:131]
    s_waitcnt lgkmcnt(4)
    v_mfma_f32_16x16x32_bf16 v[128:131], a[130:133], v[68:71], v[128:131]
    v_mfma_f32_16x16x32_bf16 v[128:131], v[48:51], a[32:35], v[128:131]
    ds_read_b128 v[40:43], v17 offset:32768
    v_mfma_f32_16x16x32_bf16 v[132:135], a[128:131], v[68:71], v[132:135]
    v_mfma_f32_16x16x32_bf16 v[128:131], v[52:55], a[40:43], v[128:131]
    v_mfma_f32_16x16x32_bf16 v[128:131], a[130:133], v[72:75], v[128:131]
    v_mfma_f32_16x16x32_bf16 v[132:135], v[52:55], a[44:47], v[132:135]
    ds_read_b128 v[44:47], v17 offset:35840
    v_mfma_f32_16x16x32_bf16 v[132:135], a[128:131], v[72:75], v[132:135]
    v_mfma_f32_16x16x32_bf16 v[132:135], v[48:51], a[36:39], v[132:135]
    s_waitcnt vmcnt(12) lgkmcnt(4)
    s_barrier
    v_mfma_f32_16x16x32_bf16 v[132:135], v[56:59], a[52:55], v[132:135]
    ds_read_b128 v[48:51], v16 offset:0
    v_mfma_f32_16x16x32_bf16 v[132:135], v[60:63], a[60:63], v[132:135]
    v_mfma_f32_16x16x32_bf16 v[128:131], v[60:63], a[56:59], v[128:131]
    ds_read_b128 v[52:55], v16 offset:3072
    v_mfma_f32_16x16x32_bf16 v[128:131], v[56:59], a[48:51], v[128:131]
    s_waitcnt lgkmcnt(4)
    v_mfma_f32_16x16x32_bf16 v[128:131], v[32:35], a[64:67], v[128:131]
    ds_read_b128 v[56:59], v16 offset:6144
    v_mfma_f32_16x16x32_bf16 v[128:131], v[36:39], a[72:75], v[128:131]
    v_mfma_f32_16x16x32_bf16 v[132:135], v[36:39], a[76:79], v[132:135]
    ds_read_b128 v[60:63], v16 offset:9216
    v_mfma_f32_16x16x32_bf16 v[132:135], v[32:35], a[68:71], v[132:135]
    s_waitcnt lgkmcnt(4)
    v_mfma_f32_16x16x32_bf16 v[132:135], v[40:43], a[84:87], v[132:135]
    ds_read_b128 v[32:35], v16 offset:1024
    v_mfma_f32_16x16x32_bf16 v[132:135], v[44:47], a[92:95], v[132:135]
    v_mfma_f32_16x16x32_bf16 v[128:131], v[44:47], a[88:91], v[128:131]
    ds_read_b128 v[36:39], v16 offset:4096
    v_mfma_f32_16x16x32_bf16 v[128:131], v[40:43], a[80:83], v[128:131]
    s_waitcnt lgkmcnt(4)
    v_mfma_f32_16x16x32_bf16 v[128:131], v[48:51], a[96:99], v[128:131]
    ds_read_b128 v[40:43], v16 offset:7168
    v_mfma_f32_16x16x32_bf16 v[128:131], v[52:55], a[104:107], v[128:131]
    v_mfma_f32_16x16x32_bf16 v[132:135], v[52:55], a[108:111], v[132:135]
    ds_read_b128 v[44:47], v16 offset:10240
    v_mfma_f32_16x16x32_bf16 v[132:135], v[48:51], a[100:103], v[132:135]
    s_waitcnt lgkmcnt(4)
    v_mfma_f32_16x16x32_bf16 v[132:135], v[56:59], a[116:119], v[132:135]
    ds_read_b128 v[48:51], v16 offset:2048
    v_mfma_f32_16x16x32_bf16 v[132:135], v[60:63], a[124:127], v[132:135]
    v_mfma_f32_16x16x32_bf16 v[128:131], v[60:63], a[120:123], v[128:131]
    ds_read_b128 v[52:55], v16 offset:5120
    v_mfma_f32_16x16x32_bf16 v[128:131], v[56:59], a[112:115], v[128:131]
    s_waitcnt lgkmcnt(4)
    v_mfma_f32_16x16x32_bf16 v[128:131], v[32:35], a[192:195], v[128:131]
    ds_read_b128 v[56:59], v16 offset:8192
    v_mfma_f32_16x16x32_bf16 v[128:131], v[36:39], a[200:203], v[128:131]
    v_mfma_f32_16x16x32_bf16 v[132:135], v[36:39], a[204:207], v[132:135]
    ds_read_b128 v[60:63], v16 offset:11264
    v_mfma_f32_16x16x32_bf16 v[132:135], v[32:35], a[196:199], v[132:135]
    s_waitcnt vmcnt(9) lgkmcnt(4)
    s_barrier
    v_mfma_f32_16x16x32_bf16 v[132:135], v[40:43], a[212:215], v[132:135]
    ds_read_b128 v[32:35], v16 offset:12288
    v_mfma_f32_16x16x32_bf16 v[132:135], v[44:47], a[220:223], v[132:135]
    v_mfma_f32_16x16x32_bf16 v[128:131], v[44:47], a[216:219], v[128:131]
    ds_read_b128 v[36:39], v16 offset:15360
    v_mfma_f32_16x16x32_bf16 v[128:131], v[40:43], a[208:211], v[128:131]
    s_waitcnt lgkmcnt(4)
    v_mfma_f32_16x16x32_bf16 v[128:131], v[48:51], a[224:227], v[128:131]
    ds_read_b128 v[40:43], v16 offset:18432
    v_mfma_f32_16x16x32_bf16 v[128:131], v[52:55], a[232:235], v[128:131]
    v_mfma_f32_16x16x32_bf16 v[132:135], v[52:55], a[236:239], v[132:135]
    ds_read_b128 v[44:47], v16 offset:21504
    v_mfma_f32_16x16x32_bf16 v[132:135], v[48:51], a[228:231], v[132:135]
    s_waitcnt lgkmcnt(4)
    v_mfma_f32_16x16x32_bf16 v[132:135], v[56:59], a[244:247], v[132:135]
    ds_read_b128 v[48:51], v16 offset:13312
    v_mfma_f32_16x16x32_bf16 v[132:135], v[60:63], a[252:255], v[132:135]
    v_mfma_f32_16x16x32_bf16 v[128:131], v[60:63], a[248:251], v[128:131]
    ds_read_b128 v[52:55], v16 offset:16384
    v_mfma_f32_16x16x32_bf16 v[128:131], v[56:59], a[240:243], v[128:131]
    s_waitcnt lgkmcnt(4)
    v_mfma_f32_16x16x32_bf16 v[136:139], v[32:35], v[156:159], 0
    ds_read_b128 v[56:59], v16 offset:19456
    v_mfma_f32_16x16x32_bf16 v[136:139], v[36:39], v[164:167], v[136:139]
    s_add_u32 s6, s83, 3072
    v_mfma_f32_16x16x32_bf16 v[140:143], v[36:39], v[168:171], 0
    ds_read_b128 v[60:63], v16 offset:22528
    v_mfma_f32_16x16x32_bf16 v[140:143], v[32:35], v[160:163], v[140:143]
    s_waitcnt lgkmcnt(4)
    buffer_load_dwordx4 v[64:67], v21, s[44:47], s6 offen offset:0 sc1
    v_mfma_f32_16x16x32_bf16 v[140:143], v[40:43], v[176:179], v[140:143]
    ds_read_b128 v[32:35], v16 offset:14336
    v_mfma_f32_16x16x32_bf16 v[140:143], v[44:47], v[184:187], v[140:143]
    buffer_load_dwordx4 v[68:71], v21, s[44:47], s6 offen offset:1024 sc1
    v_mfma_f32_16x16x32_bf16 v[136:139], v[44:47], v[180:183], v[136:139]
    ds_read_b128 v[36:39], v16 offset:17408
    v_add_f32 v128, v128, v152
    v_mfma_f32_16x16x32_bf16 v[136:139], v[40:43], v[172:175], v[136:139]
    s_waitcnt lgkmcnt(4)
    buffer_load_dwordx4 v[72:75], v21, s[44:47], s6 offen offset:2048 sc1
    v_add_f32 v129, v129, v152
    v_mfma_f32_16x16x32_bf16 v[136:139], v[48:51], v[188:191], v[136:139]
    ds_read_b128 v[40:43], v16 offset:20480
    v_add_f32 v130, v130, v152
    v_mfma_f32_16x16x32_bf16 v[136:139], v[52:55], v[196:199], v[136:139]
    v_add_f32 v131, v131, v152
    v_mfma_f32_16x16x32_bf16 v[140:143], v[52:55], v[200:203], v[140:143]
    ds_read_b128 v[44:47], v16 offset:23552
    v_add_f32 v132, v132, v153
    v_mfma_f32_16x16x32_bf16 v[140:143], v[48:51], v[192:195], v[140:143]
    s_waitcnt vmcnt(7) lgkmcnt(4)
    s_barrier
    v_add_f32 v133, v133, v153
    v_mfma_f32_16x16x32_bf16 v[140:143], v[56:59], v[208:211], v[140:143]
    ds_read_b128 v[48:51], v16 offset:24576
    v_add_f32 v134, v134, v153
    v_mfma_f32_16x16x32_bf16 v[140:143], v[60:63], v[216:219], v[140:143]
    v_add_f32 v135, v135, v153
    v_mul_f32 v120, s10, v128
    v_mfma_f32_16x16x32_bf16 v[136:139], v[60:63], v[212:215], v[136:139]
    ds_read_b128 v[52:55], v16 offset:27648
    v_mul_f32 v121, s10, v129
    v_mfma_f32_16x16x32_bf16 v[136:139], v[56:59], v[204:207], v[136:139]
    s_waitcnt lgkmcnt(4)
    v_mul_f32 v122, s10, v130
    v_mul_f32 v123, s10, v131
    v_mfma_f32_16x16x32_bf16 v[136:139], v[32:35], v[220:223], v[136:139]
    ds_read_b128 v[56:59], v16 offset:30720
    v_mul_f32 v124, s10, v132
    v_mfma_f32_16x16x32_bf16 v[136:139], v[36:39], v[228:231], v[136:139]
    v_mul_f32 v125, s10, v133
    v_mul_f32 v126, s10, v134
    v_mfma_f32_16x16x32_bf16 v[140:143], v[36:39], v[232:235], v[140:143]
    ds_read_b128 v[60:63], v16 offset:33792
    v_mul_f32 v127, s10, v135
    v_mfma_f32_16x16x32_bf16 v[140:143], v[32:35], v[224:227], v[140:143]
    s_waitcnt lgkmcnt(4)
    v_exp_f32 v120, v120
    v_mfma_f32_16x16x32_bf16 v[140:143], v[40:43], v[240:243], v[140:143]
    ds_read_b128 v[32:35], v16 offset:25600
    v_mfma_f32_16x16x32_bf16 v[140:143], v[44:47], v[248:251], v[140:143]
    v_exp_f32 v121, v121
    v_mfma_f32_16x16x32_bf16 v[136:139], v[44:47], v[244:247], v[136:139]
    ds_read_b128 v[36:39], v16 offset:28672
    v_mfma_f32_16x16x32_bf16 v[136:139], v[40:43], v[236:239], v[136:139]
    s_waitcnt lgkmcnt(4)
    v_exp_f32 v122, v122
    v_mfma_f32_16x16x32_bf16 v[136:139], v[48:51], a[0:3], v[136:139]
    ds_read_b128 v[40:43], v16 offset:31744
    v_mfma_f32_16x16x32_bf16 v[136:139], v[52:55], a[8:11], v[136:139]
    v_exp_f32 v123, v123
    v_mfma_f32_16x16x32_bf16 v[140:143], v[52:55], a[12:15], v[140:143]
    ds_read_b128 v[44:47], v16 offset:34816
    v_mfma_f32_16x16x32_bf16 v[140:143], v[48:51], a[4:7], v[140:143]
    s_waitcnt lgkmcnt(4)
    v_exp_f32 v124, v124
    v_mfma_f32_16x16x32_bf16 v[140:143], v[56:59], a[20:23], v[140:143]
    ds_read_b128 v[48:51], v16 offset:26624
    v_mfma_f32_16x16x32_bf16 v[140:143], v[60:63], a[28:31], v[140:143]
    v_exp_f32 v125, v125
    v_mfma_f32_16x16x32_bf16 v[136:139], v[60:63], a[24:27], v[136:139]
    ds_read_b128 v[52:55], v16 offset:29696
    v_mfma_f32_16x16x32_bf16 v[136:139], v[56:59], a[16:19], v[136:139]
    s_waitcnt lgkmcnt(4)
    v_exp_f32 v126, v126
    v_mfma_f32_16x16x32_bf16 v[136:139], v[32:35], a[32:35], v[136:139]
    ds_read_b128 v[56:59], v16 offset:32768
    v_mfma_f32_16x16x32_bf16 v[136:139], v[36:39], a[40:43], v[136:139]
    v_exp_f32 v127, v127
    v_mfma_f32_16x16x32_bf16 v[140:143], v[36:39], a[44:47], v[140:143]
    ds_read_b128 v[60:63], v16 offset:35840
    v_mul_f32 v96, v96, v128
    v_mfma_f32_16x16x32_bf16 v[140:143], v[32:35], a[36:39], v[140:143]
    s_waitcnt vmcnt(3) lgkmcnt(4)
    s_barrier
    v_mul_f32 v97, v97, v129
    v_mul_f32 v98, v98, v130
    v_mfma_f32_16x16x32_bf16 v[140:143], v[40:43], a[52:55], v[140:143]
    ds_read_b128 v[32:35], v17 offset:0
    v_mul_f32 v99, v99, v131
    v_mfma_f32_16x16x32_bf16 v[140:143], v[44:47], a[60:63], v[140:143]
    v_mul_f32 v100, v100, v132
    v_mul_f32 v101, v101, v133
    v_mfma_f32_16x16x32_bf16 v[136:139], v[44:47], a[56:59], v[136:139]
    ds_read_b128 v[36:39], v17 offset:3072
    v_mul_f32 v102, v102, v134
    v_mfma_f32_16x16x32_bf16 v[136:139], v[40:43], a[48:51], v[136:139]
    s_waitcnt lgkmcnt(4)
    v_mul_f32 v103, v103, v135
    v_add_f32 v120, 1.0, v120
    v_mfma_f32_16x16x32_bf16 v[136:139], v[48:51], a[64:67], v[136:139]
    ds_read_b128 v[40:43], v17 offset:6144
    v_add_f32 v121, 1.0, v121
    v_mfma_f32_16x16x32_bf16 v[136:139], v[52:55], a[72:75], v[136:139]
    v_add_f32 v122, 1.0, v122
    v_add_f32 v123, 1.0, v123
    v_mfma_f32_16x16x32_bf16 v[140:143], v[52:55], a[76:79], v[140:143]
    ds_read_b128 v[44:47], v17 offset:9216
    v_add_f32 v124, 1.0, v124
    v_mfma_f32_16x16x32_bf16 v[140:143], v[48:51], a[68:71], v[140:143]
    s_waitcnt lgkmcnt(4)
    v_add_f32 v125, 1.0, v125
    v_add_f32 v126, 1.0, v126
    v_mfma_f32_16x16x32_bf16 v[140:143], v[56:59], a[84:87], v[140:143]
    ds_read_b128 v[48:51], v17 offset:1024
    v_add_f32 v127, 1.0, v127
    v_mfma_f32_16x16x32_bf16 v[140:143], v[60:63], a[92:95], v[140:143]
    v_rcp_f32 v120, v120
    v_mfma_f32_16x16x32_bf16 v[136:139], v[60:63], a[88:91], v[136:139]
    ds_read_b128 v[52:55], v17 offset:4096
    v_mfma_f32_16x16x32_bf16 v[136:139], v[56:59], a[80:83], v[136:139]
    s_waitcnt lgkmcnt(4)
    v_rcp_f32 v121, v121
    v_mfma_f32_16x16x32_bf16 v[136:139], v[32:35], a[96:99], v[136:139]
    ds_read_b128 v[56:59], v17 offset:7168
    v_mfma_f32_16x16x32_bf16 v[136:139], v[36:39], a[104:107], v[136:139]
    v_rcp_f32 v122, v122
    v_mfma_f32_16x16x32_bf16 v[140:143], v[36:39], a[108:111], v[140:143]
    ds_read_b128 v[60:63], v17 offset:10240
    v_mfma_f32_16x16x32_bf16 v[140:143], v[32:35], a[100:103], v[140:143]
    s_waitcnt lgkmcnt(4)
    v_rcp_f32 v123, v123
    v_mfma_f32_16x16x32_bf16 v[140:143], v[40:43], a[116:119], v[140:143]
    ds_read_b128 v[32:35], v17 offset:2048
    v_mfma_f32_16x16x32_bf16 v[140:143], v[44:47], a[124:127], v[140:143]
    v_rcp_f32 v124, v124
    v_mfma_f32_16x16x32_bf16 v[136:139], v[44:47], a[120:123], v[136:139]
    ds_read_b128 v[36:39], v17 offset:5120
    v_mfma_f32_16x16x32_bf16 v[136:139], v[40:43], a[112:115], v[136:139]
    s_waitcnt lgkmcnt(4)
    v_rcp_f32 v125, v125
    v_mfma_f32_16x16x32_bf16 v[136:139], v[48:51], a[192:195], v[136:139]
    ds_read_b128 v[40:43], v17 offset:8192
    v_mfma_f32_16x16x32_bf16 v[136:139], v[52:55], a[200:203], v[136:139]
    v_rcp_f32 v126, v126
    v_mfma_f32_16x16x32_bf16 v[140:143], v[52:55], a[204:207], v[140:143]
    ds_read_b128 v[44:47], v17 offset:11264
    v_mfma_f32_16x16x32_bf16 v[140:143], v[48:51], a[196:199], v[140:143]
    s_waitcnt lgkmcnt(4)
    v_rcp_f32 v127, v127
    v_mfma_f32_16x16x32_bf16 v[140:143], v[56:59], a[212:215], v[140:143]
    v_fma_f32 v96, v96, v120, v80
    v_fma_f32 v97, v97, v121, v81
    v_mfma_f32_16x16x32_bf16 v[140:143], v[60:63], a[220:223], v[140:143]
    v_fma_f32 v98, v98, v122, v82
    v_fma_f32 v99, v99, v123, v83
    v_mfma_f32_16x16x32_bf16 v[136:139], v[60:63], a[216:219], v[136:139]
    v_fma_f32 v100, v100, v124, v84
    v_fma_f32 v101, v101, v125, v85
    v_mfma_f32_16x16x32_bf16 v[136:139], v[56:59], a[208:211], v[136:139]
    s_waitcnt lgkmcnt(2)
    v_fma_f32 v102, v102, v126, v86
    v_fma_f32 v103, v103, v127, v87
    v_mfma_f32_16x16x32_bf16 v[136:139], v[32:35], a[224:227], v[136:139]
    v_cvt_pk_bf16_f32 v80, v96, v97
    v_mfma_f32_16x16x32_bf16 v[136:139], v[36:39], a[232:235], v[136:139]
    v_cvt_pk_bf16_f32 v81, v98, v99
    v_mfma_f32_16x16x32_bf16 v[140:143], v[36:39], a[236:239], v[140:143]
    v_cvt_pk_bf16_f32 v84, v100, v101
    v_mfma_f32_16x16x32_bf16 v[140:143], v[32:35], a[228:231], v[140:143]
    s_waitcnt lgkmcnt(0)
    v_cvt_pk_bf16_f32 v85, v102, v103
    v_mfma_f32_16x16x32_bf16 v[140:143], v[40:43], a[244:247], v[140:143]
    v_mfma_f32_16x16x32_bf16 v[140:143], v[44:47], a[252:255], v[140:143]
    v_mfma_f32_16x16x32_bf16 v[136:139], v[44:47], a[248:251], v[136:139]
    v_mfma_f32_16x16x32_bf16 v[136:139], v[40:43], a[240:243], v[136:139]
    s_waitcnt vmcnt(0)
    v_xor_b32 v64, v253, v64
    v_xor_b32 v65, v255, v65
    v_xor_b32 v66, v23, v66
    v_xor_b32 v67, v0, v67
    v_or3_b32 v1, v64, v65, v66
    v_xor_b32 v68, v253, v68
    v_xor_b32 v69, v255, v69
    v_or3_b32 v1, v67, v68, v1
    v_xor_b32 v70, v23, v70
    v_xor_b32 v71, v0, v71
    v_or3_b32 v1, v69, v70, v1
    v_xor_b32 v72, v253, v72
    v_xor_b32 v73, v255, v73
    v_or3_b32 v1, v71, v72, v1
    v_xor_b32 v74, v23, v74
    v_xor_b32 v75, v0, v75
    v_or3_b32 v1, v73, v74, v1
    v_or_b32 v1, v75, v1
    v_and_b32 v1, s33, v1
    v_cmp_ne_u32 vcc, 0, v1
    s_cbranch_vccnz L_rs_ol1
L_ok_ol1:
    v_mfma_f32_16x16x32_bf16 v[136:139], a[130:133], v[64:67], v[136:139]
    v_mfma_f32_16x16x32_bf16 v[140:143], a[128:131], v[64:67], v[140:143]
    v_mfma_f32_16x16x32_bf16 v[136:139], a[130:133], v[68:71], v[136:139]
    v_mfma_f32_16x16x32_bf16 v[140:143], a[128:131], v[68:71], v[140:143]
    v_mfma_f32_16x16x32_bf16 v[136:139], a[130:133], v[72:75], v[136:139]
    v_mfma_f32_16x16x32_bf16 v[140:143], a[128:131], v[72:75], v[140:143]
    s_nop 6
    v_add_f32 v136, v136, v152
    v_add_f32 v137, v137, v152
    v_add_f32 v138, v138, v152
    v_add_f32 v139, v139, v152
    v_add_f32 v140, v140, v153
    v_add_f32 v141, v141, v153
    v_add_f32 v142, v142, v153
    v_add_f32 v143, v143, v153
    v_mul_f32 v112, s10, v136
    v_mul_f32 v113, s10, v137
    v_mul_f32 v114, s10, v138
    v_mul_f32 v115, s10, v139
    v_mul_f32 v116, s10, v140
    v_mul_f32 v117, s10, v141
    v_mul_f32 v118, s10, v142
    v_mul_f32 v119, s10, v143
    v_exp_f32 v112, v112
    v_exp_f32 v113, v113
    v_exp_f32 v114, v114
    v_exp_f32 v115, v115
    v_exp_f32 v116, v116
    v_exp_f32 v117, v117
    v_exp_f32 v118, v118
    v_exp_f32 v119, v119
    v_mul_f32 v104, v104, v136
    v_mul_f32 v105, v105, v137
    v_mul_f32 v106, v106, v138
    v_mul_f32 v107, v107, v139
    v_mul_f32 v108, v108, v140
    v_mul_f32 v109, v109, v141
    v_mul_f32 v110, v110, v142
    v_mul_f32 v111, v111, v143
    v_add_f32 v112, 1.0, v112
    v_add_f32 v113, 1.0, v113
    v_add_f32 v114, 1.0, v114
    v_add_f32 v115, 1.0, v115
    v_add_f32 v116, 1.0, v116
    v_add_f32 v117, 1.0, v117
    v_add_f32 v118, 1.0, v118
    v_add_f32 v119, 1.0, v119
    v_rcp_f32 v112, v112
    v_rcp_f32 v113, v113
    v_rcp_f32 v114, v114
    v_rcp_f32 v115, v115
    v_rcp_f32 v116, v116
    v_rcp_f32 v117, v117
    v_rcp_f32 v118, v118
    v_rcp_f32 v119, v119
    v_fma_f32 v104, v104, v112, v88
    v_fma_f32 v105, v105, v113, v89
    v_fma_f32 v106, v106, v114, v90
    v_fma_f32 v107, v107, v115, v91
    v_fma_f32 v108, v108, v116, v92
    v_fma_f32 v109, v109, v117, v93
    v_fma_f32 v110, v110, v118, v94
    v_fma_f32 v111, v111, v119, v95
    v_cvt_pk_bf16_f32 v82, v104, v105
    v_cvt_pk_bf16_f32 v83, v106, v107
    v_cvt_pk_bf16_f32 v86, v108, v109
    v_cvt_pk_bf16_f32 v87, v110, v111
    v_permlane16_swap_b32 v80, v82
    v_permlane16_swap_b32 v81, v83
    buffer_store_dwordx4 v[80:83], v144, s[64:67], 0 offen sc1
    v_permlane16_swap_b32 v84, v86
    v_permlane16_swap_b32 v85, v87
    buffer_store_dwordx4 v[84:87], v144, s[64:67], s12 offen sc1
    s_endpgm
L_segE:
.p2align 12
L_aux:
    s_mul_i32 s7, s5, 5
    s_add_u32 s7, s7, s6
    s_sub_u32 s7, s7, 27
    s_mul_i32 s7, s7, 52429
    s_lshr_b32 s72, s7, 13
    s_mul_i32 s7, s72, 9216
    s_lshl_b32 s8, s3, 10
    s_add_u32 s7, s7, s8
    v_add_u32 v228, s7, v21
    v_subrev_u32 v227, 3456, v228
    buffer_load_dwordx2 v[138:139], v219, s[60:63], 0 offen
    buffer_load_dwordx2 v[140:141], v219, s[60:63], 0 offen offset:2048
    v_lshlrev_b32 v1, 3, v2
    buffer_load_dwordx2 v[142:143], v1, s[60:63], s10 offen
    s_lshr_b32 s69, s20, 2
    s_add_u32 m0, s69, 0
    s_nop 0
    buffer_load_dwordx4 v227, s[48:51], 0 offen lds
    s_add_u32 m0, s69, 4096
    v_add_u32 v227, 4096, v227
    buffer_load_dwordx4 v227, s[48:51], 0 offen lds
    s_add_u32 m0, s69, 69632
    s_nop 0
    buffer_load_dwordx4 v228, s[52:55], 0 offen lds
    s_add_u32 m0, s69, 8192
    v_add_u32 v227, 4096, v227
    buffer_load_dwordx4 v227, s[48:51], 0 offen lds
    s_add_u32 m0, s69, 73728
    v_add_u32 v228, 4096, v228
    buffer_load_dwordx4 v228, s[52:55], 0 offen lds
    s_add_u32 m0, s69, 12288
    v_add_u32 v227, 4096, v227
    buffer_load_dwordx4 v227, s[48:51], 0 offen lds
    s_add_u32 m0, s69, 77824
    v_add_u32 v228, 4096, v228
    buffer_load_dwordx4 v228, s[52:55], 0 offen lds
    s_mul_i32 s7, s5, 72
    s_lshl3_add_u32 s7, s6, s7
    s_sub_u32 s19, s7, 184
    s_mul_i32 s18, s3, 8320
    s_add_u32 s18, s18, 45120
    s_add_u32 s30, s19, s3
    v_lshrrev_b32 v3, 5, v0
    v_and_b32 v1, 31, v0
    v_mul_u32_u24 v220, 1216, v3
    v_mad_u32_u24 v220, v1, 12, v220
    v_add_u32 v220, 152960, v220
    v_lshlrev_b32 v3, 3, v3
    v_cmp_eq_u32 vcc, 0, v1
    v_mov_b32 v31, 0x40000000
    s_nop 0
    v_cndmask_b32 v216, v31, v3, vcc
    v_lshrrev_b32 v31, 4, v0
    v_and_b32 v1, 3, v2
    v_lshlrev_b32 v1, 3, v1
    v_lshl_add_u32 v1, v31, 5, v1
    v_bfe_u32 v3, v2, 2, 2
    v_mul_u32_u24 v221, 1216, v3
    v_mul_u32_u24 v222, 1152, v3
    s_mov_b32 s9, 152960
    s_mov_b32 s8, 0
    v_add3_u32 v221, v221, v1, s9
    v_add3_u32 v222, v222, v1, s8
    v_and_b32 v223, 15, v0
    v_lshlrev_b32 v223, 4, v223
    v_add_u32 v1, 0, v31
    v_mul_u32_u24 v3, 43, v1
    v_lshrrev_b32 v3, 7, v3
    v_mad_i32_i24 v224, v3, -3, v1
    v_min_u32 v224, 1, v224
    v_add3_u32 v1, v1, v3, v224
    v_lshl_add_u32 v212, v1, 8, v223
    v_add_u32 v1, 16, v31
    v_mul_u32_u24 v3, 43, v1
    v_lshrrev_b32 v3, 7, v3
    v_mad_i32_i24 v224, v3, -3, v1
    v_min_u32 v224, 1, v224
    v_add3_u32 v1, v1, v3, v224
    v_lshl_add_u32 v213, v1, 8, v223
    v_add_u32 v1, 32, v31
    v_mul_u32_u24 v3, 43, v1
    v_lshrrev_b32 v3, 7, v3
    v_mad_i32_i24 v224, v3, -3, v1
    v_min_u32 v224, 1, v224
    v_add3_u32 v1, v1, v3, v224
    v_lshl_add_u32 v214, v1, 8, v223
    s_mul_i32 s4, s17, 12288
    s_add_u32 s6, s4, 4096
    s_add_u32 s7, s4, 3211264
    s_cmp_eq_u32 s3, 0
    s_cselect_b32 s8, s6, 0x40000000
    s_cselect_b32 s9, s7, 0x40000000
    s_lshl_b32 s5, s17, 6
    s_add_u32 s5, s5, 8716288
    v_mov_b32 v225, 0
    s_lshr_b32 s12, s17, 2
    s_lshl_b32 s12, s12, 7
    s_and_b32 s4, s17, 3
    s_lshl2_add_u32 s12, s4, s12
    s_add_u32 s12, s12, 8863744
    s_waitcnt vmcnt(11)
    v_and_b32 v77, 0xffff0000, v64
    v_lshlrev_b32 v76, 16, v64
    v_and_b32 v79, 0xffff0000, v65
    v_lshlrev_b32 v78, 16, v65
    v_and_b32 v81, 0xffff0000, v66
    v_lshlrev_b32 v80, 16, v66
    v_and_b32 v83, 0xffff0000, v68
    v_lshlrev_b32 v82, 16, v68
    v_and_b32 v85, 0xffff0000, v69
    v_lshlrev_b32 v84, 16, v69
    v_and_b32 v87, 0xffff0000, v70
    v_lshlrev_b32 v86, 16, v70
    v_and_b32 v89, 0xffff0000, v72
    v_lshlrev_b32 v88, 16, v72
    v_and_b32 v91, 0xffff0000, v73
    v_lshlrev_b32 v90, 16, v73
    v_and_b32 v93, 0xffff0000, v74
    v_lshlrev_b32 v92, 16, v74
    v_pk_add_f32 v[94:95], v[76:77], v[78:79]
    v_pk_add_f32 v[96:97], v[80:81], v[82:83]
    v_pk_add_f32 v[98:99], v[84:85], v[86:87]
    v_pk_add_f32 v[100:101], v[88:89], v[90:91]
    v_pk_add_f32 v[94:95], v[94:95], v[96:97]
    v_pk_add_f32 v[98:99], v[98:99], v[100:101]
    v_pk_add_f32 v[94:95], v[94:95], v[92:93]
    v_pk_add_f32 v[94:95], v[94:95], v[98:99]
    v_add_f32 v102, v94, v95
    s_nop 1
    v_add_f32_dpp v102, v102, v102 row_ror:8 row_mask:0xf bank_mask:0xf
    s_nop 1
    v_add_f32_dpp v102, v102, v102 row_ror:4 row_mask:0xf bank_mask:0xf
    s_nop 1
    v_add_f32_dpp v102, v102, v102 row_ror:2 row_mask:0xf bank_mask:0xf
    s_nop 1
    v_add_f32_dpp v102, v102, v102 row_ror:1 row_mask:0xf bank_mask:0xf
    v_mov_b32 v103, v102
    s_nop 1
    v_permlane16_swap_b32 v102, v103
    v_add_f32 v102, v102, v103
    v_mul_f32 v102, 0x3ae38e39, v102
    v_pk_add_f32 v[76:77], v[76:77], v[102:103] op_sel_hi:[1,0] neg_lo:[0,1] neg_hi:[0,1]
    v_pk_add_f32 v[78:79], v[78:79], v[102:103] op_sel_hi:[1,0] neg_lo:[0,1] neg_hi:[0,1]
    v_pk_add_f32 v[80:81], v[80:81], v[102:103] op_sel_hi:[1,0] neg_lo:[0,1] neg_hi:[0,1]
    v_pk_add_f32 v[82:83], v[82:83], v[102:103] op_sel_hi:[1,0] neg_lo:[0,1] neg_hi:[0,1]
    v_pk_add_f32 v[84:85], v[84:85], v[102:103] op_sel_hi:[1,0] neg_lo:[0,1] neg_hi:[0,1]
    v_pk_add_f32 v[86:87], v[86:87], v[102:103] op_sel_hi:[1,0] neg_lo:[0,1] neg_hi:[0,1]
    v_pk_add_f32 v[88:89], v[88:89], v[102:103] op_sel_hi:[1,0] neg_lo:[0,1] neg_hi:[0,1]
    v_pk_add_f32 v[90:91], v[90:91], v[102:103] op_sel_hi:[1,0] neg_lo:[0,1] neg_hi:[0,1]
    v_pk_add_f32 v[92:93], v[92:93], v[102:103] op_sel_hi:[1,0] neg_lo:[0,1] neg_hi:[0,1]
    v_pk_mul_f32 v[94:95], v[76:77], v[76:77]
    v_pk_mul_f32 v[96:97], v[78:79], v[78:79]
    v_pk_fma_f32 v[94:95], v[80:81], v[80:81], v[94:95]
    v_pk_fma_f32 v[96:97], v[82:83], v[82:83], v[96:97]
    v_pk_fma_f32 v[94:95], v[84:85], v[84:85], v[94:95]
    v_pk_fma_f32 v[96:97], v[86:87], v[86:87], v[96:97]
    v_pk_fma_f32 v[94:95], v[88:89], v[88:89], v[94:95]
    v_pk_fma_f32 v[96:97], v[90:91], v[90:91], v[96:97]
    v_pk_fma_f32 v[94:95], v[92:93], v[92:93], v[94:95]
    v_pk_add_f32 v[94:95], v[94:95], v[96:97]
    v_add_f32 v104, v94, v95
    s_nop 1
    v_add_f32_dpp v104, v104, v104 row_ror:8 row_mask:0xf bank_mask:0xf
    s_nop 1
    v_add_f32_dpp v104, v104, v104 row_ror:4 row_mask:0xf bank_mask:0xf
    s_nop 1
    v_add_f32_dpp v104, v104, v104 row_ror:2 row_mask:0xf bank_mask:0xf
    s_nop 1
    v_add_f32_dpp v104, v104, v104 row_ror:1 row_mask:0xf bank_mask:0xf
    v_mov_b32 v105, v104
    s_nop 1
    v_permlane16_swap_b32 v104, v105
    v_add_f32 v104, v104, v105
    v_mul_f32 v104, 0x3ae38e39, v104
    v_cvt_pk_bf16_f32 v94, v102, v104
    v_lshlrev_b32 v106, 16, v94
    v_and_b32 v94, 0xffff0000, v94
    v_add_f32 v94, 0x3727c5ac, v94
    v_sub_f32 v102, v102, v106
    v_cvt_pk_bf16_f32 v94, v94, v94
    v_lshlrev_b32 v94, 16, v94
    v_sqrt_f32 v94, v94
    s_nop 0
    v_cvt_pk_bf16_f32 v94, v94, v94
    v_lshlrev_b32 v94, 16, v94
    v_rcp_f32 v107, v94
    s_nop 0
    v_mul_f32 v102, v102, v107
    v_mul_f32 v104, v104, v107
    v_mul_f32 v104, v104, v107
    v_cvt_pk_bf16_f32 v94, v102, v104
    v_lshlrev_b32 v95, 16, v94
    v_and_b32 v94, 0xffff0000, v94
    v_add_f32 v94, 0x3727c5ac, v94
    v_sub_f32 v102, v102, v95
    v_cvt_pk_bf16_f32 v94, v94, v94
    v_lshlrev_b32 v94, 16, v94
    v_sqrt_f32 v94, v94
    s_nop 0
    v_cvt_pk_bf16_f32 v94, v94, v94
    v_lshlrev_b32 v94, 16, v94
    v_rcp_f32 v94, v94
    s_nop 0
    v_mul_f32 v104, v107, v94
    v_mul_f32 v102, v102, v94
    v_pk_fma_f32 v[76:77], v[76:77], v[104:105], v[102:103] op_sel_hi:[1,0,0]
    v_pk_fma_f32 v[78:79], v[78:79], v[104:105], v[102:103] op_sel_hi:[1,0,0]
    v_pk_fma_f32 v[80:81], v[80:81], v[104:105], v[102:103] op_sel_hi:[1,0,0]
    v_pk_fma_f32 v[82:83], v[82:83], v[104:105], v[102:103] op_sel_hi:[1,0,0]
    v_pk_fma_f32 v[84:85], v[84:85], v[104:105], v[102:103] op_sel_hi:[1,0,0]
    v_pk_fma_f32 v[86:87], v[86:87], v[104:105], v[102:103] op_sel_hi:[1,0,0]
    v_pk_fma_f32 v[88:89], v[88:89], v[104:105], v[102:103] op_sel_hi:[1,0,0]
    v_pk_fma_f32 v[90:91], v[90:91], v[104:105], v[102:103] op_sel_hi:[1,0,0]
    v_pk_fma_f32 v[92:93], v[92:93], v[104:105], v[102:103] op_sel_hi:[1,0,0]
    v_cvt_pk_bf16_f32 v64, v76, v77
    v_cvt_pk_bf16_f32 v65, v78, v79
    v_cvt_pk_bf16_f32 v66, v80, v81
    v_cvt_pk_bf16_f32 v67, v82, v83
    v_cvt_pk_bf16_f32 v68, v84, v85
    v_cvt_pk_bf16_f32 v69, v86, v87
    v_cvt_pk_bf16_f32 v70, v88, v89
    v_cvt_pk_bf16_f32 v71, v90, v91
    v_cvt_pk_bf16_f32 v72, v92, v93
    ds_write_b32 v220, v64 offset:0
    ds_write_b32 v220, v65 offset:4
    ds_write_b32 v220, v66 offset:8
    ds_write_b32 v220, v67 offset:384
    ds_write_b32 v220, v68 offset:388
    ds_write_b32 v220, v69 offset:392
    ds_write_b32 v220, v70 offset:768
    ds_write_b32 v220, v71 offset:772
    ds_write_b32 v220, v72 offset:776
    buffer_store_dwordx2 v[106:107], v216, s[44:47], s5 offen sc1
    s_waitcnt lgkmcnt(0)
    s_barrier
    ds_read_b64_tr_b16 v[200:201], v221 offset:0
    ds_read_b64_tr_b16 v[202:203], v221 offset:4864
    ds_read_b64_tr_b16 v[204:205], v221 offset:512
    ds_read_b64_tr_b16 v[206:207], v221 offset:5376
    ds_read_b64_tr_b16 v[208:209], v221 offset:1024
    ds_read_b64_tr_b16 v[210:211], v221 offset:5888
    s_waitcnt lgkmcnt(4)
    buffer_store_dwordx4 v[200:203], v212, s[44:47], s6 offen sc1
    s_waitcnt lgkmcnt(2)
    buffer_store_dwordx4 v[204:207], v213, s[44:47], s6 offen sc1
    s_waitcnt lgkmcnt(0)
    buffer_store_dwordx4 v[208:211], v214, s[44:47], s8 offen sc1
    buffer_load_dword v226, v225, s[64:67], 0 offen sc1
    s_add_u32 m0, s69, 16384
    v_add_u32 v227, 4096, v227
    buffer_load_dwordx4 v227, s[48:51], 0 offen lds
    s_add_u32 m0, s69, 81920
    v_add_u32 v228, 4096, v228
    buffer_load_dwordx4 v228, s[52:55], 0 offen lds
    s_add_u32 m0, s69, 20480
    v_add_u32 v227, 4096, v227
    buffer_load_dwordx4 v227, s[48:51], 0 offen lds
    s_add_u32 m0, s69, 86016
    v_add_u32 v228, 4096, v228
    buffer_load_dwordx4 v228, s[52:55], 0 offen lds
    v_add_u32 v229, 69632, v222
    s_mul_i32 s68, s72, 12288
    s_add_u32 s68, s68, 3211264
    s_waitcnt vmcnt(9)
    s_barrier
    ds_read_b64_tr_b16 v[108:109], v222 offset:0
    ds_read_b64_tr_b16 v[110:111], v222 offset:4608
    ds_read_b64_tr_b16 v[112:113], v222 offset:9216
    ds_read_b64_tr_b16 v[114:115], v229 offset:0
    ds_read_b64_tr_b16 v[116:117], v229 offset:4608
    ds_read_b64_tr_b16 v[118:119], v222 offset:512
    ds_read_b64_tr_b16 v[120:121], v222 offset:5120
    ds_read_b64_tr_b16 v[122:123], v222 offset:9728
    ds_read_b64_tr_b16 v[124:125], v229 offset:512
    ds_read_b64_tr_b16 v[126:127], v229 offset:5120
    v_alignbit_b32 v162, v139, v139, 16
    v_alignbit_b32 v163, v138, v138, 16
    s_waitcnt lgkmcnt(5)
    v_alignbit_b32 v156, v109, v108, 16
    v_alignbit_b32 v157, v110, v109, 16
    v_alignbit_b32 v158, v111, v110, 16
    v_alignbit_b32 v159, v112, v111, 16
    v_alignbit_b32 v160, v113, v112, 16
    v_dot2_f32_bf16 v164, v108, v162, 0
    v_dot2_f32_bf16 v165, v156, v162, 0
    v_dot2_f32_bf16 v166, v109, v162, 0
    v_dot2_f32_bf16 v167, v157, v162, 0
    v_dot2_f32_bf16 v168, v110, v162, 0
    v_dot2_f32_bf16 v169, v158, v162, 0
    v_dot2_f32_bf16 v170, v111, v162, 0
    v_dot2_f32_bf16 v171, v159, v162, 0
    v_dot2_f32_bf16 v164, v109, v163, v164
    v_dot2_f32_bf16 v165, v157, v163, v165
    v_dot2_f32_bf16 v166, v110, v163, v166
    v_dot2_f32_bf16 v167, v158, v163, v167
    v_dot2_f32_bf16 v168, v111, v163, v168
    v_dot2_f32_bf16 v169, v159, v163, v169
    v_dot2_f32_bf16 v170, v112, v163, v170
    v_dot2_f32_bf16 v171, v160, v163, v171
    v_and_b32 v181, 0xffff0000, v114
    v_lshlrev_b32 v180, 16, v114
    v_and_b32 v183, 0xffff0000, v115
    v_lshlrev_b32 v182, 16, v115
    v_and_b32 v185, 0xffff0000, v116
    v_lshlrev_b32 v184, 16, v116
    v_and_b32 v187, 0xffff0000, v117
    v_lshlrev_b32 v186, 16, v117
    v_pk_mul_f32 v[164:165], v[164:165], v[180:181]
    v_pk_mul_f32 v[166:167], v[166:167], v[182:183]
    v_pk_mul_f32 v[168:169], v[168:169], v[184:185]
    v_pk_mul_f32 v[170:171], v[170:171], v[186:187]
    v_cvt_pk_bf16_f32 v32, v171, v170
    v_cvt_pk_bf16_f32 v33, v169, v168
    v_cvt_pk_bf16_f32 v34, v167, v166
    v_cvt_pk_bf16_f32 v35, v165, v164
    v_alignbit_b32 v162, v141, v141, 16
    v_alignbit_b32 v163, v140, v140, 16
    s_waitcnt lgkmcnt(0)
    v_alignbit_b32 v156, v119, v118, 16
    v_alignbit_b32 v157, v120, v119, 16
    v_alignbit_b32 v158, v121, v120, 16
    v_alignbit_b32 v159, v122, v121, 16
    v_alignbit_b32 v160, v123, v122, 16
    v_dot2_f32_bf16 v172, v118, v162, 0
    v_dot2_f32_bf16 v173, v156, v162, 0
    v_dot2_f32_bf16 v174, v119, v162, 0
    v_dot2_f32_bf16 v175, v157, v162, 0
    v_dot2_f32_bf16 v176, v120, v162, 0
    v_dot2_f32_bf16 v177, v158, v162, 0
    v_dot2_f32_bf16 v178, v121, v162, 0
    v_dot2_f32_bf16 v179, v159, v162, 0
    v_dot2_f32_bf16 v172, v119, v163, v172
    v_dot2_f32_bf16 v173, v157, v163, v173
    v_dot2_f32_bf16 v174, v120, v163, v174
    v_dot2_f32_bf16 v175, v158, v163, v175
    v_dot2_f32_bf16 v176, v121, v163, v176
    v_dot2_f32_bf16 v177, v159, v163, v177
    v_dot2_f32_bf16 v178, v122, v163, v178
    v_dot2_f32_bf16 v179, v160, v163, v179
    v_and_b32 v181, 0xffff0000, v124
    v_lshlrev_b32 v180, 16, v124
    v_and_b32 v183, 0xffff0000, v125
    v_lshlrev_b32 v182, 16, v125
    v_and_b32 v185, 0xffff0000, v126
    v_lshlrev_b32 v184, 16, v126
    v_and_b32 v187, 0xffff0000, v127
    v_lshlrev_b32 v186, 16, v127
    v_pk_mul_f32 v[172:173], v[172:173], v[180:181]
    v_pk_mul_f32 v[174:175], v[174:175], v[182:183]
    v_pk_mul_f32 v[176:177], v[176:177], v[184:185]
    v_pk_mul_f32 v[178:179], v[178:179], v[186:187]
    v_cvt_pk_bf16_f32 v36, v179, v178
    v_cvt_pk_bf16_f32 v37, v177, v176
    v_cvt_pk_bf16_f32 v38, v175, v174
    v_cvt_pk_bf16_f32 v39, v173, v172
    s_waitcnt vmcnt(4)
    v_readfirstlane_b32 s16, v226
    s_nop 1
    s_cmp_eq_u32 s16, 0
    s_cbranch_scc1 L_nw_X
L_ng_X:
    v_mov_b32 v24, s16
    s_barrier
    buffer_store_dword v24, v25, s[44:47], s12 offen sc1
    s_add_u32 s12, s12, 8192
L_segX:
L_pl_X_0:
    s_cbranch_execz L_pl_X_4
    s_add_u32 m0, s69, 24576
    v_add_u32 v227, 4096, v227
    buffer_load_dwordx4 v227, s[48:51], 0 offen lds
    s_add_u32 m0, s69, 90112
    v_add_u32 v228, 4096, v228
    buffer_load_dwordx4 v228, s[52:55], 0 offen lds
    s_add_u32 m0, s69, 28672
    v_add_u32 v227, 4096, v227
    buffer_load_dwordx4 v227, s[48:51], 0 offen lds
    s_add_u32 m0, s69, 94208
    v_add_u32 v228, 4096, v228
    buffer_load_dwordx4 v228, s[52:55], 0 offen lds
    s_add_u32 m0, s69, 32768
    v_add_u32 v227, 4096, v227
    buffer_load_dwordx4 v227, s[48:51], 0 offen lds
    s_add_u32 m0, s69, 98304
    v_add_u32 v228, 4096, v228
    buffer_load_dwordx4 v228, s[52:55], 0 offen lds
    s_add_u32 m0, s69, 36864
    v_add_u32 v227, 4096, v227
    buffer_load_dwordx4 v227, s[48:51], 0 offen lds
    s_add_u32 m0, s69, 102400
    v_add_u32 v228, 4096, v228
    buffer_load_dwordx4 v228, s[52:55], 0 offen lds
    v_bfe_u32 v1, v2, 2, 2
    v_mul_u32_u24 v1, 1152, v1
    v_lshrrev_b32 v3, 4, v2
    v_lshl_add_u32 v1, v3, 5, v1
    v_and_b32 v31, 3, v2
    v_lshl_add_u32 v1, v31, 3, v1
    s_mul_i32 s4, s3, 9216
    s_add_u32 s4, s4, 1024
    v_add_u32 v230, s4, v1
    v_add_u32 v231, 69632, v230
    s_mov_b32 s4, 791555115
    v_lshlrev_b32 v3, 3, v3
    v_lshrrev_b32 v3, v3, s4
    v_and_b32 v3, 255, v3
    v_lshlrev_b32 v3, 8, v3
    v_and_b32 v1, 15, v2
    v_lshl_add_u32 v232, v1, 4, v3
    s_add_u32 s4, s72, s3
    s_mul_i32 s4, s4, 12288
    s_add_u32 s70, s4, 3211264
    s_add_u32 s71, s70, 49152
    s_cmp_eq_u32 s3, 3
    s_cselect_b32 s71, 0x40000000, s71
    s_waitcnt vmcnt(9)
    s_barrier
    ds_read_b64_tr_b16 v[108:109], v222 offset:9216
    ds_read_b64_tr_b16 v[110:111], v222 offset:13824
    ds_read_b64_tr_b16 v[112:113], v222 offset:18432
    ds_read_b64_tr_b16 v[114:115], v229 offset:9216
    ds_read_b64_tr_b16 v[116:117], v229 offset:13824
    ds_read_b64_tr_b16 v[118:119], v222 offset:9728
    ds_read_b64_tr_b16 v[120:121], v222 offset:14336
    ds_read_b64_tr_b16 v[122:123], v222 offset:18944
    ds_read_b64_tr_b16 v[124:125], v229 offset:9728
    ds_read_b64_tr_b16 v[126:127], v229 offset:14336
    v_alignbit_b32 v162, v139, v139, 16
    v_alignbit_b32 v163, v138, v138, 16
    s_waitcnt lgkmcnt(5)
    s_add_u32 m0, s69, 40960
    v_add_u32 v227, 4096, v227
    buffer_load_dwordx4 v227, s[48:51], 0 offen lds
    v_alignbit_b32 v156, v109, v108, 16
    v_alignbit_b32 v157, v110, v109, 16
    v_alignbit_b32 v158, v111, v110, 16
    v_alignbit_b32 v159, v112, v111, 16
    v_alignbit_b32 v160, v113, v112, 16
    v_dot2_f32_bf16 v164, v108, v162, 0
    v_dot2_f32_bf16 v165, v156, v162, 0
    v_dot2_f32_bf16 v166, v109, v162, 0
    v_dot2_f32_bf16 v167, v157, v162, 0
    v_dot2_f32_bf16 v168, v110, v162, 0
    v_dot2_f32_bf16 v169, v158, v162, 0
    s_add_u32 m0, s69, 106496
    v_add_u32 v228, 4096, v228
    buffer_load_dwordx4 v228, s[52:55], 0 offen lds
    v_dot2_f32_bf16 v170, v111, v162, 0
    v_dot2_f32_bf16 v171, v159, v162, 0
    v_dot2_f32_bf16 v164, v109, v163, v164
    v_dot2_f32_bf16 v165, v157, v163, v165
    v_dot2_f32_bf16 v166, v110, v163, v166
    v_dot2_f32_bf16 v167, v158, v163, v167
    v_dot2_f32_bf16 v168, v111, v163, v168
    v_dot2_f32_bf16 v169, v159, v163, v169
    v_dot2_f32_bf16 v170, v112, v163, v170
    v_dot2_f32_bf16 v171, v160, v163, v171
    v_and_b32 v181, 0xffff0000, v114
    s_add_u32 m0, s69, 45056
    v_add_u32 v227, 4096, v227
    buffer_load_dwordx4 v227, s[48:51], 0 offen lds
    v_lshlrev_b32 v180, 16, v114
    v_and_b32 v183, 0xffff0000, v115
    v_lshlrev_b32 v182, 16, v115
    v_and_b32 v185, 0xffff0000, v116
    v_lshlrev_b32 v184, 16, v116
    v_and_b32 v187, 0xffff0000, v117
    v_lshlrev_b32 v186, 16, v117
    v_pk_mul_f32 v[164:165], v[164:165], v[180:181]
    v_pk_mul_f32 v[166:167], v[166:167], v[182:183]
    v_pk_mul_f32 v[168:169], v[168:169], v[184:185]
    v_pk_mul_f32 v[170:171], v[170:171], v[186:187]
    v_cvt_pk_bf16_f32 v40, v171, v170
    s_add_u32 m0, s69, 110592
    v_add_u32 v228, 4096, v228
    buffer_load_dwordx4 v228, s[52:55], 0 offen lds
    v_cvt_pk_bf16_f32 v41, v169, v168
    v_cvt_pk_bf16_f32 v42, v167, v166
    v_cvt_pk_bf16_f32 v43, v165, v164
    v_alignbit_b32 v162, v141, v141, 16
    v_alignbit_b32 v163, v140, v140, 16
    s_waitcnt lgkmcnt(0)
    v_alignbit_b32 v156, v119, v118, 16
    v_alignbit_b32 v157, v120, v119, 16
    v_alignbit_b32 v158, v121, v120, 16
    v_alignbit_b32 v159, v122, v121, 16
    v_alignbit_b32 v160, v123, v122, 16
    s_add_u32 m0, s69, 49152
    v_add_u32 v227, 4096, v227
    buffer_load_dwordx4 v227, s[48:51], 0 offen lds
    v_dot2_f32_bf16 v172, v118, v162, 0
    v_dot2_f32_bf16 v173, v156, v162, 0
    v_dot2_f32_bf16 v174, v119, v162, 0
    v_dot2_f32_bf16 v175, v157, v162, 0
    v_dot2_f32_bf16 v176, v120, v162, 0
    v_dot2_f32_bf16 v177, v158, v162, 0
    v_dot2_f32_bf16 v178, v121, v162, 0
    v_dot2_f32_bf16 v179, v159, v162, 0
    v_dot2_f32_bf16 v172, v119, v163, v172
    v_dot2_f32_bf16 v173, v157, v163, v173
    v_dot2_f32_bf16 v174, v120, v163, v174
    s_add_u32 m0, s69, 114688
    v_add_u32 v228, 4096, v228
    buffer_load_dwordx4 v228, s[52:55], 0 offen lds
    v_dot2_f32_bf16 v175, v158, v163, v175
    v_dot2_f32_bf16 v176, v121, v163, v176
    v_dot2_f32_bf16 v177, v159, v163, v177
    v_dot2_f32_bf16 v178, v122, v163, v178
    v_dot2_f32_bf16 v179, v160, v163, v179
    v_and_b32 v181, 0xffff0000, v124
    v_lshlrev_b32 v180, 16, v124
    v_and_b32 v183, 0xffff0000, v125
    v_lshlrev_b32 v182, 16, v125
    v_and_b32 v185, 0xffff0000, v126
    v_lshlrev_b32 v184, 16, v126
    v_and_b32 v187, 0xffff0000, v127
    v_lshlrev_b32 v186, 16, v127
    v_pk_mul_f32 v[172:173], v[172:173], v[180:181]
    v_pk_mul_f32 v[174:175], v[174:175], v[182:183]
    v_pk_mul_f32 v[176:177], v[176:177], v[184:185]
    v_pk_mul_f32 v[178:179], v[178:179], v[186:187]
    v_cvt_pk_bf16_f32 v44, v179, v178
    v_cvt_pk_bf16_f32 v45, v177, v176
    v_cvt_pk_bf16_f32 v46, v175, v174
    v_cvt_pk_bf16_f32 v47, v173, v172
    s_waitcnt vmcnt(10)
    s_barrier
    ds_read_b64_tr_b16 v[108:109], v222 offset:18432
    ds_read_b64_tr_b16 v[110:111], v222 offset:23040
    ds_read_b64_tr_b16 v[112:113], v222 offset:27648
    ds_read_b64_tr_b16 v[114:115], v229 offset:18432
    ds_read_b64_tr_b16 v[116:117], v229 offset:23040
    ds_read_b64_tr_b16 v[118:119], v222 offset:18944
    ds_read_b64_tr_b16 v[120:121], v222 offset:23552
    ds_read_b64_tr_b16 v[122:123], v222 offset:28160
    ds_read_b64_tr_b16 v[124:125], v229 offset:18944
    ds_read_b64_tr_b16 v[126:127], v229 offset:23552
    v_alignbit_b32 v162, v139, v139, 16
    v_alignbit_b32 v163, v138, v138, 16
    s_waitcnt lgkmcnt(5)
    s_add_u32 m0, s69, 53248
    v_add_u32 v227, 4096, v227
    buffer_load_dwordx4 v227, s[48:51], 0 offen lds
    v_alignbit_b32 v156, v109, v108, 16
    v_alignbit_b32 v157, v110, v109, 16
    v_alignbit_b32 v158, v111, v110, 16
    v_alignbit_b32 v159, v112, v111, 16
    v_alignbit_b32 v160, v113, v112, 16
    v_dot2_f32_bf16 v164, v108, v162, 0
    v_dot2_f32_bf16 v165, v156, v162, 0
    v_dot2_f32_bf16 v166, v109, v162, 0
    v_dot2_f32_bf16 v167, v157, v162, 0
    v_dot2_f32_bf16 v168, v110, v162, 0
    v_dot2_f32_bf16 v169, v158, v162, 0
    v_dot2_f32_bf16 v170, v111, v162, 0
    v_dot2_f32_bf16 v171, v159, v162, 0
    v_dot2_f32_bf16 v164, v109, v163, v164
    v_dot2_f32_bf16 v165, v157, v163, v165
    v_dot2_f32_bf16 v166, v110, v163, v166
    v_dot2_f32_bf16 v167, v158, v163, v167
    s_add_u32 m0, s69, 118784
    v_add_u32 v228, 4096, v228
    buffer_load_dwordx4 v228, s[52:55], 0 offen lds
    v_dot2_f32_bf16 v168, v111, v163, v168
    v_dot2_f32_bf16 v169, v159, v163, v169
    v_dot2_f32_bf16 v170, v112, v163, v170
    v_dot2_f32_bf16 v171, v160, v163, v171
    v_and_b32 v181, 0xffff0000, v114
    v_lshlrev_b32 v180, 16, v114
    v_and_b32 v183, 0xffff0000, v115
    v_lshlrev_b32 v182, 16, v115
    v_and_b32 v185, 0xffff0000, v116
    v_lshlrev_b32 v184, 16, v116
    v_and_b32 v187, 0xffff0000, v117
    v_lshlrev_b32 v186, 16, v117
    v_pk_mul_f32 v[164:165], v[164:165], v[180:181]
    v_pk_mul_f32 v[166:167], v[166:167], v[182:183]
    v_pk_mul_f32 v[168:169], v[168:169], v[184:185]
    v_pk_mul_f32 v[170:171], v[170:171], v[186:187]
    v_cvt_pk_bf16_f32 v48, v171, v170
    s_add_u32 m0, s69, 57344
    v_add_u32 v227, 4096, v227
    buffer_load_dwordx4 v227, s[48:51], 0 offen lds
    v_cvt_pk_bf16_f32 v49, v169, v168
    v_cvt_pk_bf16_f32 v50, v167, v166
    v_cvt_pk_bf16_f32 v51, v165, v164
    v_alignbit_b32 v162, v141, v141, 16
    v_alignbit_b32 v163, v140, v140, 16
    s_waitcnt lgkmcnt(0)
    v_alignbit_b32 v156, v119, v118, 16
    v_alignbit_b32 v157, v120, v119, 16
L_pl_X_1:
    s_cbranch_execz L_pl_X_5
    v_alignbit_b32 v158, v121, v120, 16
    v_alignbit_b32 v159, v122, v121, 16
    v_alignbit_b32 v160, v123, v122, 16
    v_dot2_f32_bf16 v172, v118, v162, 0
    v_dot2_f32_bf16 v173, v156, v162, 0
    v_dot2_f32_bf16 v174, v119, v162, 0
    v_dot2_f32_bf16 v175, v157, v162, 0
    v_dot2_f32_bf16 v176, v120, v162, 0
    v_dot2_f32_bf16 v177, v158, v162, 0
    s_add_u32 m0, s69, 122880
    v_add_u32 v228, 4096, v228
    buffer_load_dwordx4 v228, s[52:55], 0 offen lds
    v_dot2_f32_bf16 v178, v121, v162, 0
    v_dot2_f32_bf16 v179, v159, v162, 0
    v_dot2_f32_bf16 v172, v119, v163, v172
    v_dot2_f32_bf16 v173, v157, v163, v173
    v_dot2_f32_bf16 v174, v120, v163, v174
    v_dot2_f32_bf16 v175, v158, v163, v175
    v_dot2_f32_bf16 v176, v121, v163, v176
    v_dot2_f32_bf16 v177, v159, v163, v177
    v_dot2_f32_bf16 v178, v122, v163, v178
    v_dot2_f32_bf16 v179, v160, v163, v179
    v_and_b32 v181, 0xffff0000, v124
    v_lshlrev_b32 v180, 16, v124
    v_and_b32 v183, 0xffff0000, v125
    v_lshlrev_b32 v182, 16, v125
    v_and_b32 v185, 0xffff0000, v126
    v_lshlrev_b32 v184, 16, v126
    v_and_b32 v187, 0xffff0000, v127
    v_lshlrev_b32 v186, 16, v127
    v_pk_mul_f32 v[172:173], v[172:173], v[180:181]
    v_pk_mul_f32 v[174:175], v[174:175], v[182:183]
    v_pk_mul_f32 v[176:177], v[176:177], v[184:185]
    v_pk_mul_f32 v[178:179], v[178:179], v[186:187]
    v_cvt_pk_bf16_f32 v52, v179, v178
    v_cvt_pk_bf16_f32 v53, v177, v176
    v_cvt_pk_bf16_f32 v54, v175, v174
    v_cvt_pk_bf16_f32 v55, v173, v172
    s_waitcnt vmcnt(10)
    s_barrier
    ds_read_b64_tr_b16 v[108:109], v222 offset:27648
    ds_read_b64_tr_b16 v[110:111], v222 offset:32256
    ds_read_b64_tr_b16 v[112:113], v222 offset:36864
    ds_read_b64_tr_b16 v[114:115], v229 offset:27648
    ds_read_b64_tr_b16 v[116:117], v229 offset:32256
    ds_read_b64_tr_b16 v[118:119], v222 offset:28160
    ds_read_b64_tr_b16 v[120:121], v222 offset:32768
    ds_read_b64_tr_b16 v[122:123], v222 offset:37376
    ds_read_b64_tr_b16 v[124:125], v229 offset:28160
    ds_read_b64_tr_b16 v[126:127], v229 offset:32768
    v_add_u32 v222, 36864, v222
    v_add_u32 v229, 36864, v229
    v_alignbit_b32 v162, v139, v139, 16
    v_alignbit_b32 v163, v138, v138, 16
    s_waitcnt lgkmcnt(5)
    s_add_u32 m0, s69, 61440
    v_add_u32 v227, 4096, v227
    buffer_load_dwordx4 v227, s[48:51], 0 offen lds
    v_alignbit_b32 v156, v109, v108, 16
    v_alignbit_b32 v157, v110, v109, 16
    v_alignbit_b32 v158, v111, v110, 16
    v_alignbit_b32 v159, v112, v111, 16
    v_alignbit_b32 v160, v113, v112, 16
    v_dot2_f32_bf16 v164, v108, v162, 0
    v_dot2_f32_bf16 v165, v156, v162, 0
    v_dot2_f32_bf16 v166, v109, v162, 0
    v_dot2_f32_bf16 v167, v157, v162, 0
    v_dot2_f32_bf16 v168, v110, v162, 0
    v_dot2_f32_bf16 v169, v158, v162, 0
    v_dot2_f32_bf16 v170, v111, v162, 0
    v_dot2_f32_bf16 v171, v159, v162, 0
    v_dot2_f32_bf16 v164, v109, v163, v164
    v_dot2_f32_bf16 v165, v157, v163, v165
    v_dot2_f32_bf16 v166, v110, v163, v166
    v_dot2_f32_bf16 v167, v158, v163, v167
    s_add_u32 m0, s69, 126976
    v_add_u32 v228, 4096, v228
    buffer_load_dwordx4 v228, s[52:55], 0 offen lds
    v_dot2_f32_bf16 v168, v111, v163, v168
    v_dot2_f32_bf16 v169, v159, v163, v169
    v_dot2_f32_bf16 v170, v112, v163, v170
    v_dot2_f32_bf16 v171, v160, v163, v171
    v_and_b32 v181, 0xffff0000, v114
    v_lshlrev_b32 v180, 16, v114
    v_and_b32 v183, 0xffff0000, v115
    v_lshlrev_b32 v182, 16, v115
    v_and_b32 v185, 0xffff0000, v116
    v_lshlrev_b32 v184, 16, v116
    v_and_b32 v187, 0xffff0000, v117
    v_lshlrev_b32 v186, 16, v117
    v_pk_mul_f32 v[164:165], v[164:165], v[180:181]
    v_pk_mul_f32 v[166:167], v[166:167], v[182:183]
    v_pk_mul_f32 v[168:169], v[168:169], v[184:185]
    v_pk_mul_f32 v[170:171], v[170:171], v[186:187]
    v_cvt_pk_bf16_f32 v56, v171, v170
    s_add_u32 m0, s69, 65536
    v_add_u32 v227, 4096, v227
    buffer_load_dwordx4 v227, s[48:51], 0 offen lds
    v_cvt_pk_bf16_f32 v57, v169, v168
    v_cvt_pk_bf16_f32 v58, v167, v166
    v_cvt_pk_bf16_f32 v59, v165, v164
    v_alignbit_b32 v162, v141, v141, 16
    v_alignbit_b32 v163, v140, v140, 16
    s_waitcnt lgkmcnt(0)
    v_alignbit_b32 v156, v119, v118, 16
    v_alignbit_b32 v157, v120, v119, 16
    v_alignbit_b32 v158, v121, v120, 16
    v_alignbit_b32 v159, v122, v121, 16
    v_alignbit_b32 v160, v123, v122, 16
    v_dot2_f32_bf16 v172, v118, v162, 0
    v_dot2_f32_bf16 v173, v156, v162, 0
    v_dot2_f32_bf16 v174, v119, v162, 0
    v_dot2_f32_bf16 v175, v157, v162, 0
    v_dot2_f32_bf16 v176, v120, v162, 0
    v_dot2_f32_bf16 v177, v158, v162, 0
    s_add_u32 m0, s69, 131072
    v_add_u32 v228, 4096, v228
    buffer_load_dwordx4 v228, s[52:55], 0 offen lds
    v_dot2_f32_bf16 v178, v121, v162, 0
    v_dot2_f32_bf16 v179, v159, v162, 0
    v_dot2_f32_bf16 v172, v119, v163, v172
    v_dot2_f32_bf16 v173, v157, v163, v173
    v_dot2_f32_bf16 v174, v120, v163, v174
    v_dot2_f32_bf16 v175, v158, v163, v175
    v_dot2_f32_bf16 v176, v121, v163, v176
    v_dot2_f32_bf16 v177, v159, v163, v177
    v_dot2_f32_bf16 v178, v122, v163, v178
    v_dot2_f32_bf16 v179, v160, v163, v179
    v_and_b32 v181, 0xffff0000, v124
    v_lshlrev_b32 v180, 16, v124
    v_and_b32 v183, 0xffff0000, v125
    v_lshlrev_b32 v182, 16, v125
    v_and_b32 v185, 0xffff0000, v126
    v_lshlrev_b32 v184, 16, v126
    v_and_b32 v187, 0xffff0000, v127
    v_lshlrev_b32 v186, 16, v127
    v_pk_mul_f32 v[172:173], v[172:173], v[180:181]
    v_pk_mul_f32 v[174:175], v[174:175], v[182:183]
    v_pk_mul_f32 v[176:177], v[176:177], v[184:185]
    v_pk_mul_f32 v[178:179], v[178:179], v[186:187]
    v_cvt_pk_bf16_f32 v60, v179, v178
    v_cvt_pk_bf16_f32 v61, v177, v176
    v_cvt_pk_bf16_f32 v62, v175, v174
    v_cvt_pk_bf16_f32 v63, v173, v172
    ds_read_b64_tr_b16 v[128:129], v230 offset:0
    ds_read_b64_tr_b16 v[130:131], v230 offset:4608
    ds_read_b64_tr_b16 v[132:133], v230 offset:9216
    ds_read_b64_tr_b16 v[134:135], v231 offset:0
    ds_read_b64_tr_b16 v[136:137], v231 offset:4608
    v_alignbit_b32 v162, v143, v143, 16
    v_alignbit_b32 v163, v142, v142, 16
    s_waitcnt lgkmcnt(0)
    v_alignbit_b32 v156, v129, v128, 16
    v_alignbit_b32 v157, v130, v129, 16
    v_alignbit_b32 v158, v131, v130, 16
    v_alignbit_b32 v159, v132, v131, 16
    v_alignbit_b32 v160, v133, v132, 16
    v_dot2_f32_bf16 v164, v128, v162, 0
    v_dot2_f32_bf16 v165, v156, v162, 0
    v_dot2_f32_bf16 v166, v129, v162, 0
    v_dot2_f32_bf16 v167, v157, v162, 0
    v_dot2_f32_bf16 v168, v130, v162, 0
    v_dot2_f32_bf16 v169, v158, v162, 0
    v_dot2_f32_bf16 v170, v131, v162, 0
    v_dot2_f32_bf16 v171, v159, v162, 0
    v_dot2_f32_bf16 v164, v129, v163, v164
    v_dot2_f32_bf16 v165, v157, v163, v165
    v_dot2_f32_bf16 v166, v130, v163, v166
    v_dot2_f32_bf16 v167, v158, v163, v167
    v_dot2_f32_bf16 v168, v131, v163, v168
    v_dot2_f32_bf16 v169, v159, v163, v169
    v_dot2_f32_bf16 v170, v132, v163, v170
    v_dot2_f32_bf16 v171, v160, v163, v171
    v_and_b32 v181, 0xffff0000, v134
    v_lshlrev_b32 v180, 16, v134
    v_and_b32 v183, 0xffff0000, v135
    v_lshlrev_b32 v182, 16, v135
    v_and_b32 v185, 0xffff0000, v136
    v_lshlrev_b32 v184, 16, v136
    v_and_b32 v187, 0xffff0000, v137
    v_lshlrev_b32 v186, 16, v137
    v_pk_mul_f32 v[164:165], v[164:165], v[180:181]
    v_pk_mul_f32 v[166:167], v[166:167], v[182:183]
    v_pk_mul_f32 v[168:169], v[168:169], v[184:185]
    v_pk_mul_f32 v[170:171], v[170:171], v[186:187]
    v_cvt_pk_bf16_f32 v64, v171, v170
    v_cvt_pk_bf16_f32 v65, v169, v168
    v_cvt_pk_bf16_f32 v66, v167, v166
    v_cvt_pk_bf16_f32 v67, v165, v164
    s_waitcnt vmcnt(8)
    s_barrier
    ds_read_b64_tr_b16 v[108:109], v222 offset:0
    ds_read_b64_tr_b16 v[110:111], v222 offset:4608
    ds_read_b64_tr_b16 v[112:113], v222 offset:9216
    ds_read_b64_tr_b16 v[114:115], v229 offset:0
    ds_read_b64_tr_b16 v[116:117], v229 offset:4608
    ds_read_b64_tr_b16 v[118:119], v222 offset:512
    ds_read_b64_tr_b16 v[120:121], v222 offset:5120
    ds_read_b64_tr_b16 v[122:123], v222 offset:9728
    ds_read_b64_tr_b16 v[124:125], v229 offset:512
    ds_read_b64_tr_b16 v[126:127], v229 offset:5120
    v_alignbit_b32 v162, v139, v139, 16
    v_alignbit_b32 v163, v138, v138, 16
    s_waitcnt lgkmcnt(5)
    v_alignbit_b32 v156, v109, v108, 16
    v_alignbit_b32 v157, v110, v109, 16
    v_alignbit_b32 v158, v111, v110, 16
    v_alignbit_b32 v159, v112, v111, 16
    v_alignbit_b32 v160, v113, v112, 16
    v_dot2_f32_bf16 v164, v108, v162, 0
    v_dot2_f32_bf16 v165, v156, v162, 0
    v_dot2_f32_bf16 v166, v109, v162, 0
    v_dot2_f32_bf16 v167, v157, v162, 0
    v_dot2_f32_bf16 v168, v110, v162, 0
    v_dot2_f32_bf16 v169, v158, v162, 0
    v_dot2_f32_bf16 v170, v111, v162, 0
    v_dot2_f32_bf16 v171, v159, v162, 0
    v_dot2_f32_bf16 v164, v109, v163, v164
    v_dot2_f32_bf16 v165, v157, v163, v165
    v_dot2_f32_bf16 v166, v110, v163, v166
    v_dot2_f32_bf16 v167, v158, v163, v167
    v_dot2_f32_bf16 v168, v111, v163, v168
    v_dot2_f32_bf16 v169, v159, v163, v169
    v_dot2_f32_bf16 v170, v112, v163, v170
    v_dot2_f32_bf16 v171, v160, v163, v171
    v_and_b32 v181, 0xffff0000, v114
    v_lshlrev_b32 v180, 16, v114
    v_and_b32 v183, 0xffff0000, v115
    v_lshlrev_b32 v182, 16, v115
    v_and_b32 v185, 0xffff0000, v116
    v_lshlrev_b32 v184, 16, v116
    v_and_b32 v187, 0xffff0000, v117
    v_lshlrev_b32 v186, 16, v117
    v_pk_mul_f32 v[164:165], v[164:165], v[180:181]
    v_pk_mul_f32 v[166:167], v[166:167], v[182:183]
    v_pk_mul_f32 v[168:169], v[168:169], v[184:185]
    v_pk_mul_f32 v[170:171], v[170:171], v[186:187]
    v_cvt_pk_bf16_f32 v68, v171, v170
    v_cvt_pk_bf16_f32 v69, v169, v168
    v_cvt_pk_bf16_f32 v70, v167, v166
    v_cvt_pk_bf16_f32 v71, v165, v164
    v_alignbit_b32 v162, v141, v141, 16
    v_alignbit_b32 v163, v140, v140, 16
    s_waitcnt lgkmcnt(0)
    v_alignbit_b32 v156, v119, v118, 16
    v_alignbit_b32 v157, v120, v119, 16
    v_alignbit_b32 v158, v121, v120, 16
    v_alignbit_b32 v159, v122, v121, 16
    v_alignbit_b32 v160, v123, v122, 16
    v_dot2_f32_bf16 v172, v118, v162, 0
    v_dot2_f32_bf16 v173, v156, v162, 0
    v_dot2_f32_bf16 v174, v119, v162, 0
    v_dot2_f32_bf16 v175, v157, v162, 0
    v_dot2_f32_bf16 v176, v120, v162, 0
    v_dot2_f32_bf16 v177, v158, v162, 0
    v_dot2_f32_bf16 v178, v121, v162, 0
    v_dot2_f32_bf16 v179, v159, v162, 0
    v_dot2_f32_bf16 v172, v119, v163, v172
    v_dot2_f32_bf16 v173, v157, v163, v173
    v_dot2_f32_bf16 v174, v120, v163, v174
    v_dot2_f32_bf16 v175, v158, v163, v175
    v_dot2_f32_bf16 v176, v121, v163, v176
    v_dot2_f32_bf16 v177, v159, v163, v177
    v_dot2_f32_bf16 v178, v122, v163, v178
    v_dot2_f32_bf16 v179, v160, v163, v179
    v_and_b32 v181, 0xffff0000, v124
    v_lshlrev_b32 v180, 16, v124
    v_and_b32 v183, 0xffff0000, v125
    v_lshlrev_b32 v182, 16, v125
    v_and_b32 v185, 0xffff0000, v126
    v_lshlrev_b32 v184, 16, v126
    v_and_b32 v187, 0xffff0000, v127
    v_lshlrev_b32 v186, 16, v127
    v_pk_mul_f32 v[172:173], v[172:173], v[180:181]
    v_pk_mul_f32 v[174:175], v[174:175], v[182:183]
    v_pk_mul_f32 v[176:177], v[176:177], v[184:185]
    v_pk_mul_f32 v[178:179], v[178:179], v[186:187]
    v_cvt_pk_bf16_f32 v72, v179, v178
    v_cvt_pk_bf16_f32 v73, v177, v176
    v_cvt_pk_bf16_f32 v74, v175, v174
    v_cvt_pk_bf16_f32 v75, v173, v172
    buffer_store_dwordx4 v[32:35], v212, s[44:47], s68 offen sc1
    buffer_store_dwordx4 v[36:39], v213, s[44:47], s68 offen sc1
    s_add_u32 s68, s68, 12288
    buffer_store_dwordx4 v[40:43], v212, s[44:47], s68 offen sc1
    buffer_store_dwordx4 v[44:47], v213, s[44:47], s68 offen sc1
    s_add_u32 s68, s68, 12288
    buffer_store_dwordx4 v[48:51], v212, s[44:47], s68 offen sc1
    buffer_store_dwordx4 v[52:55], v213, s[44:47], s68 offen sc1
    s_add_u32 s68, s68, 12288
    buffer_store_dwordx4 v[56:59], v212, s[44:47], s68 offen sc1
    buffer_store_dwordx4 v[60:63], v213, s[44:47], s68 offen sc1
    s_add_u32 s68, s68, 12288
    buffer_store_dwordx4 v[64:67], v232, s[44:47], s70 offen sc1
    buffer_store_dwordx4 v[68:71], v212, s[44:47], s68 offen sc1
    buffer_store_dwordx4 v[72:75], v213, s[44:47], s68 offen sc1
    s_add_u32 s68, s68, 12288
    s_waitcnt vmcnt(15)
    s_barrier
    ds_read_b64_tr_b16 v[108:109], v222 offset:9216
    ds_read_b64_tr_b16 v[110:111], v222 offset:13824
    ds_read_b64_tr_b16 v[112:113], v222 offset:18432
    ds_read_b64_tr_b16 v[114:115], v229 offset:9216
    ds_read_b64_tr_b16 v[116:117], v229 offset:13824
    ds_read_b64_tr_b16 v[118:119], v222 offset:9728
    ds_read_b64_tr_b16 v[120:121], v222 offset:14336
    ds_read_b64_tr_b16 v[122:123], v222 offset:18944
    ds_read_b64_tr_b16 v[124:125], v229 offset:9728
    ds_read_b64_tr_b16 v[126:127], v229 offset:14336
    v_alignbit_b32 v162, v139, v139, 16
    v_alignbit_b32 v163, v138, v138, 16
    s_waitcnt lgkmcnt(5)
    v_alignbit_b32 v156, v109, v108, 16
    v_alignbit_b32 v157, v110, v109, 16
    v_alignbit_b32 v158, v111, v110, 16
    v_alignbit_b32 v159, v112, v111, 16
    v_alignbit_b32 v160, v113, v112, 16
    v_dot2_f32_bf16 v164, v108, v162, 0
    v_dot2_f32_bf16 v165, v156, v162, 0
    v_dot2_f32_bf16 v166, v109, v162, 0
    v_dot2_f32_bf16 v167, v157, v162, 0
    v_dot2_f32_bf16 v168, v110, v162, 0
    v_dot2_f32_bf16 v169, v158, v162, 0
    v_dot2_f32_bf16 v170, v111, v162, 0
    v_dot2_f32_bf16 v171, v159, v162, 0
    v_dot2_f32_bf16 v164, v109, v163, v164
    v_dot2_f32_bf16 v165, v157, v163, v165
    v_dot2_f32_bf16 v166, v110, v163, v166
    v_dot2_f32_bf16 v167, v158, v163, v167
    v_dot2_f32_bf16 v168, v111, v163, v168
    v_dot2_f32_bf16 v169, v159, v163, v169
    v_dot2_f32_bf16 v170, v112, v163, v170
    v_dot2_f32_bf16 v171, v160, v163, v171
    v_and_b32 v181, 0xffff0000, v114
    v_lshlrev_b32 v180, 16, v114
    v_and_b32 v183, 0xffff0000, v115
    v_lshlrev_b32 v182, 16, v115
    v_and_b32 v185, 0xffff0000, v116
    v_lshlrev_b32 v184, 16, v116
    v_and_b32 v187, 0xffff0000, v117
    v_lshlrev_b32 v186, 16, v117
    v_pk_mul_f32 v[164:165], v[164:165], v[180:181]
    v_pk_mul_f32 v[166:167], v[166:167], v[182:183]
    v_pk_mul_f32 v[168:169], v[168:169], v[184:185]
    v_pk_mul_f32 v[170:171], v[170:171], v[186:187]
    v_cvt_pk_bf16_f32 v76, v171, v170
    v_cvt_pk_bf16_f32 v77, v169, v168
    v_cvt_pk_bf16_f32 v78, v167, v166
    v_cvt_pk_bf16_f32 v79, v165, v164
    v_alignbit_b32 v162, v141, v141, 16
    v_alignbit_b32 v163, v140, v140, 16
    s_waitcnt lgkmcnt(0)
    v_alignbit_b32 v156, v119, v118, 16
    v_alignbit_b32 v157, v120, v119, 16
    v_alignbit_b32 v158, v121, v120, 16
    v_alignbit_b32 v159, v122, v121, 16
    v_alignbit_b32 v160, v123, v122, 16
    v_dot2_f32_bf16 v172, v118, v162, 0
    v_dot2_f32_bf16 v173, v156, v162, 0
    v_dot2_f32_bf16 v174, v119, v162, 0
    v_dot2_f32_bf16 v175, v157, v162, 0
    v_dot2_f32_bf16 v176, v120, v162, 0
    v_dot2_f32_bf16 v177, v158, v162, 0
    v_dot2_f32_bf16 v178, v121, v162, 0
    v_dot2_f32_bf16 v179, v159, v162, 0
    v_dot2_f32_bf16 v172, v119, v163, v172
    v_dot2_f32_bf16 v173, v157, v163, v173
    v_dot2_f32_bf16 v174, v120, v163, v174
    v_dot2_f32_bf16 v175, v158, v163, v175
    v_dot2_f32_bf16 v176, v121, v163, v176
    v_dot2_f32_bf16 v177, v159, v163, v177
    v_dot2_f32_bf16 v178, v122, v163, v178
    v_dot2_f32_bf16 v179, v160, v163, v179
    v_and_b32 v181, 0xffff0000, v124
    v_lshlrev_b32 v180, 16, v124
    v_and_b32 v183, 0xffff0000, v125
    v_lshlrev_b32 v182, 16, v125
    v_and_b32 v185, 0xffff0000, v126
    v_lshlrev_b32 v184, 16, v126
    v_and_b32 v187, 0xffff0000, v127
    v_lshlrev_b32 v186, 16, v127
    v_pk_mul_f32 v[172:173], v[172:173], v[180:181]
    v_pk_mul_f32 v[174:175], v[174:175], v[182:183]
    v_pk_mul_f32 v[176:177], v[176:177], v[184:185]
    v_pk_mul_f32 v[178:179], v[178:179], v[186:187]
    v_cvt_pk_bf16_f32 v80, v179, v178
    v_cvt_pk_bf16_f32 v81, v177, v176
    v_cvt_pk_bf16_f32 v82, v175, v174
    v_cvt_pk_bf16_f32 v83, v173, v172
    buffer_store_dwordx4 v[76:79], v212, s[44:47], s68 offen sc1
    buffer_store_dwordx4 v[80:83], v213, s[44:47], s68 offen sc1
    s_add_u32 s68, s68, 12288
    s_mov_b32 s60, s24
    s_and_b32 s61, s25, 0xffff
    s_mov_b32 s62, 2359296
    s_mov_b32 s63, 0x20000
    v_lshrrev_b32 v1, 5, v2
    v_and_b32 v3, 31, v2
    v_lshlrev_b32 v1, 14, v1
    v_lshl_add_u32 v1, v3, 7, v1
    s_lshl_b32 s4, s30, 12
    buffer_load_dword v255, v1, s[60:63], s4 offen
    s_waitcnt vmcnt(14)
    s_barrier
    ds_read_b64_tr_b16 v[108:109], v222 offset:18432
    ds_read_b64_tr_b16 v[110:111], v222 offset:23040
    ds_read_b64_tr_b16 v[112:113], v222 offset:27648
    ds_read_b64_tr_b16 v[114:115], v229 offset:18432
    ds_read_b64_tr_b16 v[116:117], v229 offset:23040
    ds_read_b64_tr_b16 v[118:119], v222 offset:18944
    ds_read_b64_tr_b16 v[120:121], v222 offset:23552
    ds_read_b64_tr_b16 v[122:123], v222 offset:28160
    ds_read_b64_tr_b16 v[124:125], v229 offset:18944
    ds_read_b64_tr_b16 v[126:127], v229 offset:23552
    v_alignbit_b32 v162, v139, v139, 16
    v_alignbit_b32 v163, v138, v138, 16
    s_waitcnt lgkmcnt(5)
    v_alignbit_b32 v156, v109, v108, 16
    v_alignbit_b32 v157, v110, v109, 16
    v_alignbit_b32 v158, v111, v110, 16
    v_alignbit_b32 v159, v112, v111, 16
    v_alignbit_b32 v160, v113, v112, 16
    v_dot2_f32_bf16 v164, v108, v162, 0
    v_dot2_f32_bf16 v165, v156, v162, 0
    v_dot2_f32_bf16 v166, v109, v162, 0
    v_dot2_f32_bf16 v167, v157, v162, 0
    v_dot2_f32_bf16 v168, v110, v162, 0
    v_dot2_f32_bf16 v169, v158, v162, 0
    v_dot2_f32_bf16 v170, v111, v162, 0
    v_dot2_f32_bf16 v171, v159, v162, 0
    v_dot2_f32_bf16 v164, v109, v163, v164
    v_dot2_f32_bf16 v165, v157, v163, v165
    v_dot2_f32_bf16 v166, v110, v163, v166
    v_dot2_f32_bf16 v167, v158, v163, v167
    v_dot2_f32_bf16 v168, v111, v163, v168
    v_dot2_f32_bf16 v169, v159, v163, v169
    v_dot2_f32_bf16 v170, v112, v163, v170
    v_dot2_f32_bf16 v171, v160, v163, v171
    v_and_b32 v181, 0xffff0000, v114
    v_lshlrev_b32 v180, 16, v114
    v_and_b32 v183, 0xffff0000, v115
    v_lshlrev_b32 v182, 16, v115
    v_and_b32 v185, 0xffff0000, v116
    v_lshlrev_b32 v184, 16, v116
    v_and_b32 v187, 0xffff0000, v117
    v_lshlrev_b32 v186, 16, v117
    v_pk_mul_f32 v[164:165], v[164:165], v[180:181]
    v_pk_mul_f32 v[166:167], v[166:167], v[182:183]
    v_pk_mul_f32 v[168:169], v[168:169], v[184:185]
    v_pk_mul_f32 v[170:171], v[170:171], v[186:187]
    v_cvt_pk_bf16_f32 v84, v171, v170
    v_cvt_pk_bf16_f32 v85, v169, v168
    v_cvt_pk_bf16_f32 v86, v167, v166
    v_cvt_pk_bf16_f32 v87, v165, v164
    v_alignbit_b32 v162, v141, v141, 16
    v_alignbit_b32 v163, v140, v140, 16
    s_waitcnt lgkmcnt(0)
    v_alignbit_b32 v156, v119, v118, 16
    v_alignbit_b32 v157, v120, v119, 16
    v_alignbit_b32 v158, v121, v120, 16
    v_alignbit_b32 v159, v122, v121, 16
    v_alignbit_b32 v160, v123, v122, 16
    v_dot2_f32_bf16 v172, v118, v162, 0
    v_dot2_f32_bf16 v173, v156, v162, 0
    v_dot2_f32_bf16 v174, v119, v162, 0
    v_dot2_f32_bf16 v175, v157, v162, 0
    v_dot2_f32_bf16 v176, v120, v162, 0
    v_dot2_f32_bf16 v177, v158, v162, 0
    v_dot2_f32_bf16 v178, v121, v162, 0
    v_dot2_f32_bf16 v179, v159, v162, 0
    v_dot2_f32_bf16 v172, v119, v163, v172
    v_dot2_f32_bf16 v173, v157, v163, v173
    v_dot2_f32_bf16 v174, v120, v163, v174
    v_dot2_f32_bf16 v175, v158, v163, v175
    v_dot2_f32_bf16 v176, v121, v163, v176
    v_dot2_f32_bf16 v177, v159, v163, v177
    v_dot2_f32_bf16 v178, v122, v163, v178
    v_dot2_f32_bf16 v179, v160, v163, v179
    v_and_b32 v181, 0xffff0000, v124
    v_lshlrev_b32 v180, 16, v124
    v_and_b32 v183, 0xffff0000, v125
    v_lshlrev_b32 v182, 16, v125
    v_and_b32 v185, 0xffff0000, v126
    v_lshlrev_b32 v184, 16, v126
    v_and_b32 v187, 0xffff0000, v127
    v_lshlrev_b32 v186, 16, v127
    v_pk_mul_f32 v[172:173], v[172:173], v[180:181]
    v_pk_mul_f32 v[174:175], v[174:175], v[182:183]
    v_pk_mul_f32 v[176:177], v[176:177], v[184:185]
    v_pk_mul_f32 v[178:179], v[178:179], v[186:187]
    v_cvt_pk_bf16_f32 v88, v179, v178
    v_cvt_pk_bf16_f32 v89, v177, v176
    v_cvt_pk_bf16_f32 v90, v175, v174
    v_cvt_pk_bf16_f32 v91, v173, v172
    ds_read_b64_tr_b16 v[128:129], v230 offset:36864
    ds_read_b64_tr_b16 v[130:131], v230 offset:41472
    ds_read_b64_tr_b16 v[132:133], v230 offset:46080
    ds_read_b64_tr_b16 v[134:135], v231 offset:36864
    ds_read_b64_tr_b16 v[136:137], v231 offset:41472
    v_alignbit_b32 v162, v143, v143, 16
    v_alignbit_b32 v163, v142, v142, 16
    s_waitcnt lgkmcnt(0)
    v_alignbit_b32 v156, v129, v128, 16
    v_alignbit_b32 v157, v130, v129, 16
    v_alignbit_b32 v158, v131, v130, 16
    v_alignbit_b32 v159, v132, v131, 16
    v_alignbit_b32 v160, v133, v132, 16
    v_dot2_f32_bf16 v164, v128, v162, 0
    v_dot2_f32_bf16 v165, v156, v162, 0
    v_dot2_f32_bf16 v166, v129, v162, 0
    v_dot2_f32_bf16 v167, v157, v162, 0
    v_dot2_f32_bf16 v168, v130, v162, 0
    v_dot2_f32_bf16 v169, v158, v162, 0
    v_dot2_f32_bf16 v170, v131, v162, 0
    v_dot2_f32_bf16 v171, v159, v162, 0
    v_dot2_f32_bf16 v164, v129, v163, v164
    v_dot2_f32_bf16 v165, v157, v163, v165
    v_dot2_f32_bf16 v166, v130, v163, v166
    v_dot2_f32_bf16 v167, v158, v163, v167
    v_dot2_f32_bf16 v168, v131, v163, v168
    v_dot2_f32_bf16 v169, v159, v163, v169
    v_dot2_f32_bf16 v170, v132, v163, v170
    v_dot2_f32_bf16 v171, v160, v163, v171
    v_and_b32 v181, 0xffff0000, v134
    v_lshlrev_b32 v180, 16, v134
    v_and_b32 v183, 0xffff0000, v135
    v_lshlrev_b32 v182, 16, v135
    v_and_b32 v185, 0xffff0000, v136
    v_lshlrev_b32 v184, 16, v136
    v_and_b32 v187, 0xffff0000, v137
    v_lshlrev_b32 v186, 16, v137
    v_pk_mul_f32 v[164:165], v[164:165], v[180:181]
    v_pk_mul_f32 v[166:167], v[166:167], v[182:183]
    v_pk_mul_f32 v[168:169], v[168:169], v[184:185]
    v_pk_mul_f32 v[170:171], v[170:171], v[186:187]
    v_cvt_pk_bf16_f32 v92, v171, v170
    v_cvt_pk_bf16_f32 v93, v169, v168
    v_cvt_pk_bf16_f32 v94, v167, v166
    v_cvt_pk_bf16_f32 v95, v165, v164
    buffer_store_dwordx4 v[84:87], v212, s[44:47], s68 offen sc1
    buffer_store_dwordx4 v[88:91], v213, s[44:47], s68 offen sc1
    s_add_u32 s68, s68, 12288
    buffer_store_dwordx4 v[92:95], v232, s[44:47], s71 offen sc1
    v_min_u32 v1, 6, v0
    v_add_u32 v28, s72, v1
    v_and_b32 v29, 3, v28
L_pl_X_2:
    s_cbranch_execz L_wret
    v_lshrrev_b32 v28, 2, v28
    v_lshlrev_b32 v28, 7, v28
    v_lshl_add_u32 v28, v29, 2, v28
    v_add_u32 v28, 8871936, v28
    v_mov_b32 v1, 0x40000000
    v_cmp_gt_u32 vcc, 7, v0
    s_nop 1
    v_cndmask_b32 v28, v1, v28, vcc
    s_mov_b64 exec, 0
    s_call_b64 s[10:11], L_wc_X
    s_mov_b64 exec, -1
    s_mov_b64 exec, 0
    s_call_b64 s[10:11], L_wc_S
    s_mov_b64 exec, -1
    v_lshrrev_b32 v1, 4, v2
    v_and_b32 v3, 15, v2
    v_lshlrev_b32 v31, 1, v1
    v_xor_b32 v3, v3, v31
    v_lshlrev_b32 v1, 12, v1
    v_and_b32 v31, 7, v3
    v_lshl_add_u32 v1, v31, 4, v1
    s_lshr_b32 s4, s3, 1
    s_lshl_b32 s4, s4, 2
    s_and_b32 s5, s3, 1
    s_add_u32 s4, s4, s5
    s_lshl_b32 s4, s4, 15
    v_add_u32 v1, s4, v1
    v_mov_b32 v31, s40
    v_mov_b32 v11, s41
    v_cmp_lt_u32 vcc, 7, v3
    s_nop 1
    v_cndmask_b32 v8, v31, v11, vcc
    v_cndmask_b32 v10, v11, v31, vcc
    v_add_u32 v8, v8, v1
    v_add_u32 v10, v10, v1
    v_add_u32 v9, 64512, v8
    v_add_u32 v10, 14336, v10
    v_add_u32 v11, 64512, v10
    s_mov_b32 s4, 172066848
    s_cmp_eq_u32 s22, 1
    s_cselect_b32 s4, 310614180, s4
    s_cmp_eq_u32 s22, 2
    s_cselect_b32 s4, 483798345, s4
    s_cmp_eq_u32 s22, 3
    s_cselect_b32 s4, 18365901, s4
    s_cmp_lt_u32 s2, 224
    s_cselect_b32 s4, 136512515, s4
    s_bfe_u32 s84, s4, 0x50000
    s_bfe_u32 s85, s4, 0x50005
    s_bfe_u32 s86, s4, 0x5000a
    s_bfe_u32 s87, s4, 0x5000f
    s_bfe_u32 s88, s4, 0x50014
    s_bfe_u32 s89, s4, 0x50019
    s_mov_b32 s4, 379887846
    s_cmp_eq_u32 s22, 1
    s_cselect_b32 s4, 518435178, s4
    s_cmp_eq_u32 s22, 2
    s_cselect_b32 s4, 68175375, s4
    s_cmp_eq_u32 s22, 3
    s_cselect_b32 s4, 206703681, s4
    s_cmp_lt_u32 s2, 224
    s_cselect_b32 s4, 479468869, s4
    s_bfe_u32 s90, s4, 0x50000
    s_bfe_u32 s91, s4, 0x50005
    s_bfe_u32 s92, s4, 0x5000a
    s_bfe_u32 s93, s4, 0x5000f
    s_bfe_u32 s94, s4, 0x50014
    s_bfe_u32 s95, s4, 0x50019
    s_mov_b32 s4, 587708844
    s_cmp_eq_u32 s22, 1
    s_cselect_b32 s4, 102793776, s4
    s_cmp_eq_u32 s22, 2
    s_cselect_b32 s4, 275977347, s4
    s_cmp_eq_u32 s22, 3
    s_cselect_b32 s4, 414524679, s4
    s_cmp_lt_u32 s2, 224
    s_cselect_b32 s4, 587707787, s4
    s_bfe_u32 s96, s4, 0x50000
    s_bfe_u32 s97, s4, 0x50005
    s_bfe_u32 s98, s4, 0x5000a
    s_bfe_u32 s99, s4, 0x5000f
    s_bfe_u32 s100, s4, 0x50014
    s_bfe_u32 s101, s4, 0x50019
    s_mul_i32 s4, s23, 18
    s_add_u32 s84, s84, s4
    s_lshl_b32 s84, s84, 17
    s_add_u32 s85, s85, s4
    s_lshl_b32 s85, s85, 17
    s_add_u32 s86, s86, s4
    s_lshl_b32 s86, s86, 17
    s_add_u32 s87, s87, s4
    s_lshl_b32 s87, s87, 17
    s_add_u32 s88, s88, s4
    s_lshl_b32 s88, s88, 17
    s_add_u32 s89, s89, s4
    s_lshl_b32 s89, s89, 17
    s_add_u32 s90, s90, s4
    s_lshl_b32 s90, s90, 17
    s_add_u32 s91, s91, s4
    s_lshl_b32 s91, s91, 17
    s_add_u32 s92, s92, s4
    s_lshl_b32 s92, s92, 17
    s_add_u32 s93, s93, s4
    s_lshl_b32 s93, s93, 17
    s_add_u32 s94, s94, s4
    s_lshl_b32 s94, s94, 17
    s_add_u32 s95, s95, s4
    s_lshl_b32 s95, s95, 17
    s_add_u32 s96, s96, s4
    s_lshl_b32 s96, s96, 17
    s_add_u32 s97, s97, s4
    s_lshl_b32 s97, s97, 17
    s_add_u32 s98, s98, s4
    s_lshl_b32 s98, s98, 17
    s_add_u32 s99, s99, s4
    s_lshl_b32 s99, s99, 17
    s_add_u32 s100, s100, s4
    s_lshl_b32 s100, s100, 17
    s_add_u32 s101, s101, s4
    s_lshl_b32 s101, s101, 17
    v_bfe_u32 v1, v2, 2, 2
    v_lshrrev_b32 v3, 4, v2
    v_lshl_add_u32 v31, v3, 3, v1
    v_lshlrev_b32 v31, 8, v31
    v_and_b32 v3, 1, v3
    v_lshl_add_u32 v1, v3, 2, v1
    v_and_b32 v3, 3, v2
    v_lshl_add_u32 v31, v3, 3, v31
    s_lshl_b32 s7, s3, 1
    v_xor_b32 v1, s7, v1
    v_lshl_add_u32 v12, v1, 5, v31
    v_add_u32 v12, 114688, v12
    v_xor_b32 v13, 32, v12
    s_waitcnt vmcnt(0) lgkmcnt(0)
    s_barrier
    buffer_store_dword v24, v28, s[44:47], 0 offen sc1
    s_mov_b32 s48, s24
    s_and_b32 s49, s25, 0xffff
    s_mov_b32 s50, 2359296
    s_mov_b32 s51, 0x20000
    s_mov_b32 s52, s42
    s_and_b32 s53, s43, 0xffff
    s_mov_b32 s54, 18874368
    s_mov_b32 s55, 0x20000
    s_mov_b32 s60, s36
    s_and_b32 s61, s37, 0xffff
    s_mov_b32 s62, 4096
    s_mov_b32 s63, 0x20000
    s_cmp_lt_u32 s3, 2
    s_cselect_b32 s4, s40, s41
    s_and_b32 s14, s3, 1
    s_lshl_b32 s14, s14, 6
    s_add_u32 s4, s4, s14
    v_and_b32 v1, 15, v2
    v_lshl_add_u32 v3, v1, 1, s4
    s_and_b32 s14, s23, 1
    s_lshl_b32 s14, s14, 5
    buffer_load_ushort v152, v3, s[60:63], 0 offen
    buffer_load_ushort v153, v3, s[60:63], 0 offen offset:32
    buffer_load_ushort v154, v3, s[60:63], s14 offen
    s_mov_b32 s60, s26
    s_and_b32 s61, s27, 0xffff
    s_mov_b32 s62, 1152
    s_mov_b32 s63, 0x20000
    s_lshl_b32 s4, s34, 1
    v_mov_b32 v30, 0
    buffer_load_ushort v30, v30, s[60:63], s4 offen
    s_add_u32 m0, s18, 32
    s_add_u32 s14, s30, 0
    s_lshl_b32 s14, s14, 12
    buffer_load_dwordx4 v21, s[48:51], s14 offen offset:0 lds
    buffer_load_dwordx4 v21, s[48:51], s14 offen offset:1024 lds
    buffer_load_dwordx4 v21, s[48:51], s14 offen offset:2048 lds
    buffer_load_dwordx4 v21, s[48:51], s14 offen offset:3072 lds
    s_lshr_b32 s14, s14, 11
    v_mov_b32 v144, 0
    buffer_load_ushort v144, v144, s[60:63], s14 offen
    s_add_u32 m0, s18, 33312
    s_add_u32 s14, s30, 4
    s_lshl_b32 s14, s14, 12
    buffer_load_dwordx4 v21, s[48:51], s14 offen offset:0 lds
    buffer_load_dwordx4 v21, s[48:51], s14 offen offset:1024 lds
    buffer_load_dwordx4 v21, s[48:51], s14 offen offset:2048 lds
    buffer_load_dwordx4 v21, s[48:51], s14 offen offset:3072 lds
    s_lshr_b32 s14, s14, 11
    v_mov_b32 v145, 0
    buffer_load_ushort v145, v145, s[60:63], s14 offen
    s_lshl_b32 s6, s3, 6
    v_add_u32 v28, s6, v2
    v_and_b32 v29, 3, v28
    v_lshrrev_b32 v28, 2, v28
    v_lshlrev_b32 v28, 7, v28
    v_lshl_add_u32 v28, v29, 2, v28
    v_add_u32 v28, 8871936, v28
    s_add_u32 m0, s20, 114688
    s_lshl_b32 s14, s84, 1
    buffer_load_dwordx4 v8, s[52:55], s14 offen offset:0 lds
    buffer_load_dwordx4 v9, s[52:55], s14 offen offset:1024 lds
    buffer_load_dwordx4 v10, s[52:55], s14 offen offset:2048 lds
    buffer_load_dwordx4 v11, s[52:55], s14 offen offset:3072 lds
    s_add_u32 m0, s20, 131072
    s_lshl_b32 s14, s85, 1
    buffer_load_dwordx4 v8, s[52:55], s14 offen offset:0 lds
    buffer_load_dwordx4 v9, s[52:55], s14 offen offset:1024 lds
    buffer_load_dwordx4 v10, s[52:55], s14 offen offset:2048 lds
    buffer_load_dwordx4 v11, s[52:55], s14 offen offset:3072 lds
    v_add_u32 v26, s18, v21
    v_cmp_eq_u32 vcc, 0, v2
    v_mov_b32 v1, 4140
    s_nop 0
    v_cndmask_b32 v1, v1, 32, vcc
    v_add_u32 v27, s18, v1
    s_mov_b32 s4, 33280
    v_bfe_u32 v1, v2, 3, 1
    v_mul_u32_u24 v1, 4160, v1
    v_bfe_u32 v3, v2, 4, 1
    v_mad_u32_u24 v1, v3, s4, v1
    v_and_b32 v3, 7, v2
    v_lshl_add_u32 v1, v3, 2, v1
    v_add_u32 v1, s18, v1
    v_mov_b32 v36, 0
    v_mov_b32 v37, 0
    v_mov_b32 v38, 0
    v_mov_b32 v39, 0
    ds_write_b32 v1, v36
    v_lshlrev_b32 v1, 4, v0
    ds_write_b128 v1, v[36:39]
    s_waitcnt vmcnt(14)
    ds_read_b128 v[64:67], v26 offset:32
    ds_read_b32 v68, v26 offset:48
    ds_read_b128 v[70:73], v26 offset:1056
    ds_read_b32 v74, v26 offset:1072
    ds_read_b128 v[76:79], v26 offset:2080
    ds_read_b32 v80, v26 offset:2096
    ds_read_b128 v[82:85], v26 offset:3104
    ds_read_b32 v86, v26 offset:3120
    s_waitcnt vmcnt(9)
    ds_read_b128 v[88:91], v26 offset:33312
    ds_read_b32 v92, v26 offset:33328
    ds_read_b128 v[94:97], v26 offset:34336
    ds_read_b32 v98, v26 offset:34352
    ds_read_b128 v[100:103], v26 offset:35360
    ds_read_b32 v104, v26 offset:35376
    ds_read_b128 v[106:109], v26 offset:36384
    ds_read_b32 v110, v26 offset:36400
    v_lshrrev_b32 v1, 3, v2
    v_and_b32 v3, 7, v2
    v_lshrrev_b32 v31, 1, v1
    v_xor_b32 v3, v3, v31
    v_mul_u32_u24 v1, 12288, v1
    v_lshl_add_u32 v14, v3, 4, v1
    v_xor_b32 v15, 64, v14
    v_and_b32 v1, 15, v2
    v_add_u32 v1, 1, v1
    v_and_b32 v3, 1, v1
    v_mul_u32_u24 v3, 4160, v3
    v_lshrrev_b32 v1, 1, v1
    v_lshl_add_u32 v3, v1, 2, v3
    v_lshrrev_b32 v31, 4, v2
    v_lshl_add_u32 v3, v31, 4, v3
    v_add_u32 v4, s18, v3
    v_add_u32 v5, 1024, v4
    v_add_u32 v6, 1024, v5
    v_add_u32 v7, 1024, v6
    s_waitcnt lgkmcnt(8)
    v_lshlrev_b32 v1, 16, v64
    v_lshlrev_b32 v144, 16, v144
    v_add_f32 v1, v1, v144
    v_cvt_pk_bf16_f32 v1, v1, v1
    ds_write_b16 v27, v1 offset:0
    ds_write_b16 v27, v1 offset:4158
    v_alignbit_b32 v64, v65, v64, 16
    v_alignbit_b32 v65, v66, v65, 16
    v_alignbit_b32 v66, v67, v66, 16
    v_alignbit_b32 v67, v68, v67, 16
    ds_write_b128 v26, v[64:67] offset:4192
    v_alignbit_b32 v70, v71, v70, 16
    v_alignbit_b32 v71, v72, v71, 16
    v_alignbit_b32 v72, v73, v72, 16
    v_alignbit_b32 v73, v74, v73, 16
    ds_write_b128 v26, v[70:73] offset:5216
    v_alignbit_b32 v76, v77, v76, 16
    v_alignbit_b32 v77, v78, v77, 16
    v_alignbit_b32 v78, v79, v78, 16
    v_alignbit_b32 v79, v80, v79, 16
    ds_write_b128 v26, v[76:79] offset:6240
    v_alignbit_b32 v82, v83, v82, 16
    v_alignbit_b32 v83, v84, v83, 16
    v_alignbit_b32 v84, v85, v84, 16
    v_alignbit_b32 v85, v86, v85, 16
    ds_write_b128 v26, v[82:85] offset:7264
    buffer_load_dword v29, v28, s[44:47], 0 offen offset:0 sc1
    s_waitcnt vmcnt(9) lgkmcnt(6)
    v_lshlrev_b32 v1, 16, v88
    v_lshlrev_b32 v145, 16, v145
    v_add_f32 v1, v1, v145
    v_cvt_pk_bf16_f32 v1, v1, v1
    ds_write_b16 v27, v1 offset:33280
    ds_write_b16 v27, v1 offset:37438
    v_alignbit_b32 v88, v89, v88, 16
    v_alignbit_b32 v89, v90, v89, 16
    v_alignbit_b32 v90, v91, v90, 16
    v_alignbit_b32 v91, v92, v91, 16
    ds_write_b128 v26, v[88:91] offset:37472
    v_alignbit_b32 v94, v95, v94, 16
    v_alignbit_b32 v95, v96, v95, 16
    v_alignbit_b32 v96, v97, v96, 16
    v_alignbit_b32 v97, v98, v97, 16
    ds_write_b128 v26, v[94:97] offset:38496
    v_alignbit_b32 v100, v101, v100, 16
    v_alignbit_b32 v101, v102, v101, 16
    v_alignbit_b32 v102, v103, v102, 16
    v_alignbit_b32 v103, v104, v103, 16
    ds_write_b128 v26, v[100:103] offset:39520
    v_alignbit_b32 v106, v107, v106, 16
    v_alignbit_b32 v107, v108, v107, 16
    v_alignbit_b32 v108, v109, v108, 16
    v_alignbit_b32 v109, v110, v109, 16
    ds_write_b128 v26, v[106:109] offset:40544
    v_and_b32 v1, 15, v2
    v_lshlrev_b32 v1, 1, v1
    v_sub_u32 v1, v1, v31
    v_add_u32 v1, 17, v1
    v_bfe_u32 v3, v1, 1, 3
    v_xor_b32 v3, s3, v3
    v_lshlrev_b32 v3, 4, v3
    v_lshl_add_u32 v16, v1, 7, v3
    v_and_b32 v1, 15, v2
    v_lshlrev_b32 v1, 1, v1
    v_sub_u32 v1, v1, v31
    v_add_u32 v1, 13, v1
    v_bfe_u32 v3, v1, 1, 3
    v_xor_b32 v3, s3, v3
    v_lshlrev_b32 v3, 4, v3
    v_lshl_add_u32 v17, v1, 7, v3
    v_and_b32 v1, 15, v2
    v_lshlrev_b32 v1, 1, v1
    v_sub_u32 v1, v1, v31
    v_add_u32 v1, 9, v1
    v_bfe_u32 v3, v1, 1, 3
    v_xor_b32 v3, s3, v3
    v_lshlrev_b32 v3, 4, v3
    v_lshl_add_u32 v18, v1, 7, v3
    v_and_b32 v1, 15, v2
    v_lshlrev_b32 v1, 1, v1
    v_sub_u32 v1, v1, v31
    v_add_u32 v1, 5, v1
    v_bfe_u32 v3, v1, 1, 3
    v_xor_b32 v3, s3, v3
    v_lshlrev_b32 v3, 4, v3
    v_lshl_add_u32 v19, v1, 7, v3
    v_and_b32 v1, 15, v2
    v_lshlrev_b32 v1, 5, v1
    v_lshl_add_u32 v20, v31, 3, v1
    s_lshr_b32 s9, s19, 4
    s_mul_i32 s8, s9, 43
    s_lshr_b32 s8, s8, 7
    s_add_u32 s7, s9, s8
    s_mul_i32 s8, s8, 3
    s_sub_u32 s8, s9, s8
    s_min_u32 s8, s8, 1
    s_add_u32 s7, s7, s8
    s_lshl_b32 s7, s7, 8
    s_and_b32 s8, s19, 8
    s_lshl4_add_u32 s7, s8, s7
    s_mul_i32 s8, s3, 786432
    s_add_u32 s7, s7, s8
    s_add_u32 s7, s7, 3211264
    s_lshl_b32 s9, s3, 13
    s_add_u32 s9, s9, 4096
    s_lshl_b32 s15, s30, 12
    s_add_u32 s15, s15, 6356992
    s_waitcnt lgkmcnt(0)
    ds_read2_b32 v[64:65], v4 offset0:0 offset1:1
    ds_read2_b32 v[66:67], v4 offset0:2 offset1:3
    ds_read2_b32 v[68:69], v4 offset0:128 offset1:129
    ds_read2_b32 v[70:71], v4 offset0:130 offset1:131
    ds_read2_b32 v[72:73], v5 offset0:0 offset1:1
    ds_read2_b32 v[74:75], v5 offset0:2 offset1:3
    ds_read2_b32 v[76:77], v5 offset0:128 offset1:129
    ds_read2_b32 v[78:79], v5 offset0:130 offset1:131
    ds_read2_b32 v[80:81], v6 offset0:0 offset1:1
    ds_read2_b32 v[82:83], v6 offset0:2 offset1:3
    ds_read2_b32 v[84:85], v6 offset0:128 offset1:129
    ds_read2_b32 v[86:87], v6 offset0:130 offset1:131
    ds_read2_b32 v[88:89], v7 offset0:0 offset1:1
    ds_read2_b32 v[90:91], v7 offset0:2 offset1:3
    ds_read2_b32 v[92:93], v7 offset0:128 offset1:129
    ds_read2_b32 v[94:95], v7 offset0:130 offset1:131
    s_waitcnt vmcnt(0)
    v_cmp_ne_u32 vcc, s16, v29
    s_cbranch_vccnz L_rs_pkX
L_ok_pkX:
    s_add_u32 m0, s9, 0
    s_add_u32 s14, s7, 0
    buffer_load_dwordx4 v14, s[44:47], s14 offen sc1 lds
    s_add_u32 m0, s9, 1024
    s_add_u32 s14, s7, 98304
    buffer_load_dwordx4 v15, s[44:47], s14 offen sc1 lds
    s_add_u32 m0, s9, 2048
    s_add_u32 s14, s7, 196608
    buffer_load_dwordx4 v14, s[44:47], s14 offen sc1 lds
    s_add_u32 m0, s9, 3072
    s_add_u32 s14, s7, 294912
    buffer_load_dwordx4 v15, s[44:47], s14 offen sc1 lds
    s_add_u32 m0, s9, 4096
    s_add_u32 s14, s7, 393216
    buffer_load_dwordx4 v14, s[44:47], s14 offen sc1 lds
    s_add_u32 m0, s9, 5120
    s_add_u32 s14, s7, 491520
    buffer_load_dwordx4 v15, s[44:47], s14 offen sc1 lds
    s_add_u32 m0, s9, 6144
    s_add_u32 s14, s7, 589824
    buffer_load_dwordx4 v14, s[44:47], s14 offen sc1 lds
    s_add_u32 m0, s9, 7168
    s_add_u32 s14, s7, 688128
    buffer_load_dwordx4 v15, s[44:47], s14 offen sc1 lds
    s_waitcnt vmcnt(0) lgkmcnt(0)
    s_barrier
    ds_read_b128 v[96:99], v16 offset:2048
    ds_read_b128 v[100:103], v16 offset:6144
    ds_read_b128 v[104:107], v16 offset:10240
    ds_read_b128 v[108:111], v16 offset:14336
    ds_read_b128 v[112:115], v16 offset:18432
    ds_read_b128 v[116:119], v16 offset:22528
    ds_read_b128 v[120:123], v16 offset:26624
    ds_read_b128 v[124:127], v16 offset:30720
    ds_read_b64_tr_b16 v[156:157], v12 offset:0
    ds_read_b64_tr_b16 v[158:159], v12 offset:1024
    ds_read_b64_tr_b16 v[160:161], v13 offset:0
    ds_read_b64_tr_b16 v[162:163], v13 offset:1024
    ds_read_b64_tr_b16 v[164:165], v12 offset:8192
    ds_read_b64_tr_b16 v[166:167], v12 offset:9216
    ds_read_b64_tr_b16 v[168:169], v13 offset:8192
    ds_read_b64_tr_b16 v[170:171], v13 offset:9216
    ds_read_b64_tr_b16 v[172:173], v12 offset:16384
    ds_read_b64_tr_b16 v[174:175], v12 offset:17408
    ds_read_b64_tr_b16 v[176:177], v13 offset:16384
    ds_read_b64_tr_b16 v[178:179], v13 offset:17408
    ds_read_b64_tr_b16 v[180:181], v12 offset:24576
    ds_read_b64_tr_b16 v[182:183], v12 offset:25600
    ds_read_b64_tr_b16 v[184:185], v13 offset:24576
    ds_read_b64_tr_b16 v[186:187], v13 offset:25600
    s_waitcnt lgkmcnt(15)
    v_mfma_f32_16x16x32_bf16 v[32:35], v[64:67], v[96:99], 0
    s_mov_b32 s64, s38
    ds_read_b128 a[224:227], v17 offset:2048
    v_mfma_f32_16x16x32_bf16 v[36:39], v[68:71], v[96:99], 0
    s_add_u32 m0, s20, 147456
    s_and_b32 s65, s39, 0xffff
    v_mfma_f32_16x16x32_bf16 v[36:39], v[64:67], v[100:103], v[36:39]
    s_lshl_b32 s14, s86, 1
    ds_read2_b32 a[192:193], v4 offset0:16 offset1:17
    s_mov_b32 s66, 2359296
    v_mfma_f32_16x16x32_bf16 v[40:43], v[64:67], v[104:107], 0
    ds_read2_b32 a[194:195], v4 offset0:18 offset1:19
    v_mfma_f32_16x16x32_bf16 v[40:43], v[68:71], v[100:103], v[40:43]
    s_mov_b32 s67, 0x20000
    buffer_load_dwordx4 v8, s[52:55], s14 offen offset:0 lds
    v_mfma_f32_16x16x32_bf16 v[40:43], v[72:75], v[96:99], v[40:43]
    s_cmp_lt_u32 s3, 2
    s_cselect_b32 s4, s40, s41
    ds_read_b128 a[228:231], v17 offset:6144
    v_mfma_f32_16x16x32_bf16 v[44:47], v[76:79], v[96:99], 0
    s_lshr_b32 s4, s4, 1
    ds_read2_b32 a[196:197], v4 offset0:144 offset1:145
    v_mfma_f32_16x16x32_bf16 v[44:47], v[72:75], v[100:103], v[44:47]
    s_and_b32 s5, s3, 1
    v_mfma_f32_16x16x32_bf16 v[44:47], v[68:71], v[104:107], v[44:47]
    s_lshl_b32 s5, s5, 5
    ds_read2_b32 a[198:199], v4 offset0:146 offset1:147
    buffer_load_dwordx4 v9, s[52:55], s14 offen offset:1024 lds
    v_mfma_f32_16x16x32_bf16 v[44:47], v[64:67], v[108:111], v[44:47]
    s_add_u32 s4, s4, s5
    ds_read_b128 a[232:235], v17 offset:10240
    v_mfma_f32_16x16x32_bf16 v[48:51], v[64:67], v[112:115], 0
    ds_read2_b32 a[200:201], v5 offset0:16 offset1:17
    v_and_b32 v1, 15, v2
    v_mfma_f32_16x16x32_bf16 v[48:51], v[68:71], v[108:111], v[48:51]
    buffer_load_dwordx4 v10, s[52:55], s14 offen offset:2048 lds
    v_mfma_f32_16x16x32_bf16 v[48:51], v[72:75], v[104:107], v[48:51]
    ds_read2_b32 a[202:203], v5 offset0:18 offset1:19
    v_add_u32 v1, s4, v1
    v_mfma_f32_16x16x32_bf16 v[48:51], v[76:79], v[100:103], v[48:51]
    ds_read_b128 a[236:239], v17 offset:14336
    v_lshlrev_b32 v14, 3, v1
    v_mfma_f32_16x16x32_bf16 v[48:51], v[80:83], v[96:99], v[48:51]
    s_and_b32 s9, s23, 1
    v_mfma_f32_16x16x32_bf16 v[52:55], v[84:87], v[96:99], 0
    s_sub_u32 s26, 0, s9
    ds_read2_b32 a[204:205], v5 offset0:144 offset1:145
    buffer_load_dwordx4 v11, s[52:55], s14 offen offset:3072 lds
    v_mfma_f32_16x16x32_bf16 v[52:55], v[80:83], v[100:103], v[52:55]
    s_sub_u32 s27, 0, s9
    ds_read2_b32 a[206:207], v5 offset0:146 offset1:147
    v_mfma_f32_16x16x32_bf16 v[52:55], v[76:79], v[104:107], v[52:55]
    v_mul_u32_u24 v1, 1152, v1
    v_mfma_f32_16x16x32_bf16 v[52:55], v[72:75], v[108:111], v[52:55]
    s_and_b32 s6, s22, 1
    ds_read_b128 a[240:243], v17 offset:18432
    v_mfma_f32_16x16x32_bf16 v[52:55], v[68:71], v[112:115], v[52:55]
    ds_read2_b32 a[208:209], v6 offset0:16 offset1:17
    v_mfma_f32_16x16x32_bf16 v[52:55], v[64:67], v[116:119], v[52:55]
    s_movk_i32 s7, 5971
    v_mfma_f32_16x16x32_bf16 v[56:59], v[64:67], v[120:123], 0
    s_cmp_eq_u32 s6, 0
    s_cselect_b32 s7, 25632, s7
    ds_read2_b32 a[210:211], v6 offset0:18 offset1:19
    v_mfma_f32_16x16x32_bf16 v[56:59], v[68:71], v[116:119], v[56:59]
    s_lshl_b32 s8, s23, 2
    ds_read_b128 a[244:247], v17 offset:22528
    v_mfma_f32_16x16x32_bf16 v[56:59], v[72:75], v[112:115], v[56:59]
    s_lshr_b32 s7, s7, s8
    v_mfma_f32_16x16x32_bf16 v[56:59], v[76:79], v[108:111], v[56:59]
    s_and_b32 s7, s7, 15
    ds_read2_b32 a[212:213], v6 offset0:144 offset1:145
    v_mfma_f32_16x16x32_bf16 v[56:59], v[80:83], v[104:107], v[56:59]
    s_mul_i32 s8, s22, 9
    ds_read2_b32 a[214:215], v6 offset0:146 offset1:147
    v_mfma_f32_16x16x32_bf16 v[56:59], v[84:87], v[100:103], v[56:59]
    ds_read_b128 a[248:251], v17 offset:26624
    v_mfma_f32_16x16x32_bf16 v[56:59], v[88:91], v[96:99], v[56:59]
    s_add_u32 s7, s7, s8
    v_mfma_f32_16x16x32_bf16 v[60:63], v[92:95], v[96:99], 0
    s_xor_b32 s6, s6, 1
    ds_read2_b32 a[216:217], v7 offset0:16 offset1:17
    v_mfma_f32_16x16x32_bf16 v[60:63], v[88:91], v[100:103], v[60:63]
    s_lshl3_add_u32 s6, s6, s8
    ds_read2_b32 a[218:219], v7 offset0:18 offset1:19
    v_mfma_f32_16x16x32_bf16 v[60:63], v[84:87], v[104:107], v[60:63]
    s_lshl_b32 s8, s7, 5
    v_mfma_f32_16x16x32_bf16 v[60:63], v[80:83], v[108:111], v[60:63]
    ds_read_b128 a[252:255], v17 offset:30720
    v_bfe_u32 v3, v2, 4, 1
    v_mfma_f32_16x16x32_bf16 v[60:63], v[76:79], v[112:115], v[60:63]
    ds_read2_b32 a[220:221], v7 offset0:144 offset1:145
    v_lshl_add_u32 v3, v3, 5, v1
    v_mfma_f32_16x16x32_bf16 v[60:63], v[72:75], v[116:119], v[60:63]
    v_lshrrev_b32 v31, 5, v2
    v_mfma_f32_16x16x32_bf16 v[60:63], v[68:71], v[120:123], v[60:63]
    ds_read2_b32 a[222:223], v7 offset0:146 offset1:147
    v_mfma_f32_16x16x32_bf16 v[60:63], v[64:67], v[124:127], v[60:63]
    s_waitcnt lgkmcnt(12)
    s_barrier
    v_lshl_add_u32 v3, v31, 4, v3
    v_mfma_f32_16x16x32_bf16 v[32:35], a[192:195], a[224:227], v[32:35]
    ds_read_b128 v[96:99], v18 offset:2048
    v_add_u32 v144, s8, v3
    v_mfma_f32_16x16x32_bf16 v[36:39], a[196:199], a[224:227], v[36:39]
    s_add_u32 m0, s20, 114688
    s_mul_i32 s8, s9, 18432
    v_mfma_f32_16x16x32_bf16 v[36:39], a[192:195], a[228:231], v[36:39]
    s_lshl_b32 s14, s87, 1
    ds_read2_b32 v[64:65], v4 offset0:32 offset1:33
    s_lshl_b32 s5, s6, 5
    v_mfma_f32_16x16x32_bf16 v[40:43], a[192:195], a[232:235], v[40:43]
    s_add_u32 s8, s8, s5
    ds_read2_b32 v[66:67], v4 offset0:34 offset1:35
    v_lshrrev_b32 v3, 4, v2
    v_mfma_f32_16x16x32_bf16 v[40:43], a[196:199], a[228:231], v[40:43]
    buffer_load_dwordx4 v8, s[52:55], s14 offen offset:0 lds
    v_lshl_add_u32 v3, v3, 3, v1
    v_mfma_f32_16x16x32_bf16 v[40:43], a[200:203], a[224:227], v[40:43]
    ds_read_b128 v[100:103], v18 offset:6144
    v_add_u32 v3, s8, v3
    v_mfma_f32_16x16x32_bf16 v[44:47], a[204:207], a[224:227], v[44:47]
    s_lshr_b32 s8, s23, 1
    ds_read2_b32 v[68:69], v4 offset0:160 offset1:161
    v_mov_b32 v1, 0x40000000
    v_mfma_f32_16x16x32_bf16 v[44:47], a[200:203], a[228:231], v[44:47]
    v_cmp_eq_u32 vcc, s8, v31
    s_nop 1
    v_cndmask_b32 v145, v1, v3, vcc
    v_mfma_f32_16x16x32_bf16 v[44:47], a[196:199], a[232:235], v[44:47]
    ds_read2_b32 v[70:71], v4 offset0:162 offset1:163
    buffer_load_dwordx4 v9, s[52:55], s14 offen offset:1024 lds
    v_mfma_f32_16x16x32_bf16 v[44:47], a[192:195], a[236:239], v[44:47]
    s_waitcnt lgkmcnt(6)
    ds_read_b128 v[104:107], v18 offset:10240
    v_mfma_f32_16x16x32_bf16 v[48:51], a[192:195], a[240:243], v[48:51]
    ds_read2_b32 v[72:73], v5 offset0:32 offset1:33
    v_mfma_f32_16x16x32_bf16 v[48:51], a[196:199], a[236:239], v[48:51]
    s_lshl_b32 s36, s7, 16
    buffer_load_dwordx4 v10, s[52:55], s14 offen offset:2048 lds
    v_mfma_f32_16x16x32_bf16 v[48:51], a[200:203], a[232:235], v[48:51]
    s_add_u32 s36, s36, 6356992
    ds_read2_b32 v[74:75], v5 offset0:34 offset1:35
    v_mfma_f32_16x16x32_bf16 v[48:51], a[204:207], a[228:231], v[48:51]
    ds_read_b128 v[108:111], v18 offset:14336
    v_mfma_f32_16x16x32_bf16 v[48:51], a[208:211], a[224:227], v[48:51]
    s_lshl_b32 s37, s6, 16
    v_mfma_f32_16x16x32_bf16 v[52:55], a[212:215], a[224:227], v[52:55]
    s_add_u32 s37, s37, 6356992
    ds_read2_b32 v[76:77], v5 offset0:160 offset1:161
    buffer_load_dwordx4 v11, s[52:55], s14 offen offset:3072 lds
    v_mfma_f32_16x16x32_bf16 v[52:55], a[208:211], a[228:231], v[52:55]
    ds_read2_b32 v[78:79], v5 offset0:162 offset1:163
    v_mov_b32 v3, s40
    v_mfma_f32_16x16x32_bf16 v[52:55], a[204:207], a[232:235], v[52:55]
    v_mov_b32 v31, s41
    v_mfma_f32_16x16x32_bf16 v[52:55], a[200:203], a[236:239], v[52:55]
    ds_read_b128 v[112:115], v18 offset:18432
    v_and_b32 v1, 8, v2
    v_mfma_f32_16x16x32_bf16 v[52:55], a[196:199], a[240:243], v[52:55]
    ds_read2_b32 v[80:81], v6 offset0:32 offset1:33
    v_mfma_f32_16x16x32_bf16 v[52:55], a[192:195], a[244:247], v[52:55]
    v_cmp_lt_u32 vcc, 0, v1
    s_nop 1
    v_cndmask_b32 v3, v3, v31, vcc
    v_mfma_f32_16x16x32_bf16 v[56:59], a[192:195], a[248:251], v[56:59]
    ds_read2_b32 v[82:83], v6 offset0:34 offset1:35
    v_and_b32 v1, 7, v2
    v_mfma_f32_16x16x32_bf16 v[56:59], a[196:199], a[244:247], v[56:59]
    ds_read_b128 v[116:119], v18 offset:22528
    v_lshl_add_u32 v3, v1, 4, v3
    v_mfma_f32_16x16x32_bf16 v[56:59], a[200:203], a[240:243], v[56:59]
    v_lshrrev_b32 v1, 4, v2
    v_mfma_f32_16x16x32_bf16 v[56:59], a[204:207], a[236:239], v[56:59]
    ds_read2_b32 v[84:85], v6 offset0:160 offset1:161
    v_lshl_add_u32 v3, v1, 12, v3
    v_mfma_f32_16x16x32_bf16 v[56:59], a[208:211], a[232:235], v[56:59]
    s_lshl_b32 s8, s3, 14
    ds_read2_b32 v[86:87], v6 offset0:162 offset1:163
    v_mfma_f32_16x16x32_bf16 v[56:59], a[212:215], a[228:231], v[56:59]
    ds_read_b128 v[120:123], v18 offset:26624
    v_add_u32 v155, s8, v3
    v_mfma_f32_16x16x32_bf16 v[56:59], a[216:219], a[224:227], v[56:59]
    v_lshrrev_b32 v1, 2, v2
    v_mfma_f32_16x16x32_bf16 v[60:63], a[220:223], a[224:227], v[60:63]
    ds_read2_b32 v[88:89], v7 offset0:32 offset1:33
    v_mfma_f32_16x16x32_bf16 v[60:63], a[216:219], a[228:231], v[60:63]
    ds_read2_b32 v[90:91], v7 offset0:34 offset1:35
    v_lshlrev_b32 v1, 8, v1
    v_mfma_f32_16x16x32_bf16 v[60:63], a[212:215], a[232:235], v[60:63]
    v_and_b32 v3, 3, v2
    v_mfma_f32_16x16x32_bf16 v[60:63], a[208:211], a[236:239], v[60:63]
    ds_read_b128 v[124:127], v18 offset:30720
    v_lshl_add_u32 v1, v3, 3, v1
    v_mfma_f32_16x16x32_bf16 v[60:63], a[204:207], a[240:243], v[60:63]
L_pl_X_3:
    s_cbranch_execz L_wret
    s_lshl_b32 s8, s3, 6
    ds_read2_b32 v[92:93], v7 offset0:160 offset1:161
    v_mfma_f32_16x16x32_bf16 v[60:63], a[200:203], a[244:247], v[60:63]
    v_add_u32 v252, s8, v1
    v_mfma_f32_16x16x32_bf16 v[60:63], a[196:199], a[248:251], v[60:63]
    ds_read2_b32 v[94:95], v7 offset0:162 offset1:163
    v_min_u32 v1, 17, v2
    v_mfma_f32_16x16x32_bf16 v[60:63], a[192:195], a[252:255], v[60:63]
    s_waitcnt lgkmcnt(12)
    s_barrier
    v_lshrrev_b32 v3, 1, v1
    v_mfma_f32_16x16x32_bf16 v[32:35], v[64:67], v[96:99], v[32:35]
    ds_read_b128 a[224:227], v19 offset:2048
    v_mfma_f32_16x16x32_bf16 v[36:39], v[68:71], v[96:99], v[36:39]
    s_add_u32 m0, s20, 131072
    v_and_b32 v1, 1, v1
    v_mfma_f32_16x16x32_bf16 v[36:39], v[64:67], v[100:103], v[36:39]
    s_lshl_b32 s14, s88, 1
    ds_read2_b32 a[192:193], v4 offset0:48 offset1:49
    v_lshlrev_b32 v3, 8, v3
    v_mfma_f32_16x16x32_bf16 v[40:43], v[64:67], v[104:107], v[40:43]
    ds_read2_b32 a[194:195], v4 offset0:50 offset1:51
    v_lshl_add_u32 v3, v1, 2, v3
    v_mfma_f32_16x16x32_bf16 v[40:43], v[68:71], v[100:103], v[40:43]
    s_mul_i32 s8, s23, 18
    buffer_load_dwordx4 v8, s[52:55], s14 offen offset:0 lds
    v_mfma_f32_16x16x32_bf16 v[40:43], v[72:75], v[96:99], v[40:43]
    s_lshr_b32 s5, s22, 1
    ds_read_b128 a[228:231], v19 offset:6144
    v_mfma_f32_16x16x32_bf16 v[44:47], v[76:79], v[96:99], v[44:47]
    s_add_u32 s8, s8, s5
    ds_read2_b32 a[196:197], v4 offset0:176 offset1:177
    v_mfma_f32_16x16x32_bf16 v[44:47], v[72:75], v[100:103], v[44:47]
    s_lshl_b32 s8, s8, 5
    v_mfma_f32_16x16x32_bf16 v[44:47], v[68:71], v[104:107], v[44:47]
    ds_read2_b32 a[198:199], v4 offset0:178 offset1:179
    buffer_load_dwordx4 v9, s[52:55], s14 offen offset:1024 lds
    v_mfma_f32_16x16x32_bf16 v[44:47], v[64:67], v[108:111], v[44:47]
    s_waitcnt lgkmcnt(6)
    s_and_b32 s5, s22, 1
    ds_read_b128 a[232:235], v19 offset:10240
    v_mfma_f32_16x16x32_bf16 v[48:51], v[64:67], v[112:115], v[48:51]
    s_add_u32 s8, s8, s5
    ds_read2_b32 a[200:201], v5 offset0:48 offset1:49
    v_mfma_f32_16x16x32_bf16 v[48:51], v[68:71], v[108:111], v[48:51]
    s_lshl_b32 s8, s8, 2
    buffer_load_dwordx4 v10, s[52:55], s14 offen offset:2048 lds
    v_mfma_f32_16x16x32_bf16 v[48:51], v[72:75], v[104:107], v[48:51]
    s_add_u32 s8, s8, 8994816
    ds_read2_b32 a[202:203], v5 offset0:50 offset1:51
    v_mfma_f32_16x16x32_bf16 v[48:51], v[76:79], v[100:103], v[48:51]
    ds_read_b128 a[236:239], v19 offset:14336
    v_add_u32 v26, s8, v3
    v_mfma_f32_16x16x32_bf16 v[48:51], v[80:83], v[96:99], v[48:51]
    s_mov_b32 s6, 241306688
    v_mfma_f32_16x16x32_bf16 v[52:55], v[84:87], v[96:99], v[52:55]
    ds_read2_b32 a[204:205], v5 offset0:176 offset1:177
    buffer_load_dwordx4 v11, s[52:55], s14 offen offset:3072 lds
    v_mfma_f32_16x16x32_bf16 v[52:55], v[80:83], v[100:103], v[52:55]
    s_mov_b32 s7, 2898
    ds_read2_b32 a[206:207], v5 offset0:178 offset1:179
    v_mfma_f32_16x16x32_bf16 v[52:55], v[76:79], v[104:107], v[52:55]
    s_bitcmp1_b32 s22, 0
    s_cselect_b32 s6, 2942979664, s6
    s_cselect_b32 s7, 3195, s7
    v_mfma_f32_16x16x32_bf16 v[52:55], v[72:75], v[108:111], v[52:55]
    s_mov_b32 s83, 2348962
    ds_read_b128 a[240:243], v19 offset:18432
    v_mfma_f32_16x16x32_bf16 v[52:55], v[68:71], v[112:115], v[52:55]
    s_cmp_eq_u32 s23, 1
    s_cselect_b32 s83, 6880132, s83
    ds_read2_b32 a[208:209], v6 offset0:48 offset1:49
    v_mfma_f32_16x16x32_bf16 v[52:55], v[64:67], v[116:119], v[52:55]
    s_cmp_eq_u32 s23, 2
    s_cselect_b32 s83, 11640720, s83
    v_mfma_f32_16x16x32_bf16 v[56:59], v[64:67], v[120:123], v[56:59]
    s_cmp_eq_u32 s23, 3
    s_cselect_b32 s83, 16429840, s83
    ds_read2_b32 a[210:211], v6 offset0:50 offset1:51
    v_mfma_f32_16x16x32_bf16 v[56:59], v[68:71], v[116:119], v[56:59]
    s_and_b32 s12, s3, 1
    ds_read_b128 a[244:247], v19 offset:22528
    v_mfma_f32_16x16x32_bf16 v[56:59], v[72:75], v[112:115], v[56:59]
    v_mfma_f32_16x16x32_bf16 v[56:59], v[76:79], v[108:111], v[56:59]
    s_mul_i32 s12, s12, 49152
    ds_read2_b32 a[212:213], v6 offset0:176 offset1:177
    v_mfma_f32_16x16x32_bf16 v[56:59], v[80:83], v[104:107], v[56:59]
    s_lshr_b32 s4, s22, 1
    ds_read2_b32 a[214:215], v6 offset0:178 offset1:179
    v_mfma_f32_16x16x32_bf16 v[56:59], v[84:87], v[100:103], v[56:59]
    s_mul_i32 s4, s4, 6144
    ds_read_b128 a[248:251], v19 offset:26624
    v_mfma_f32_16x16x32_bf16 v[56:59], v[88:91], v[96:99], v[56:59]
    s_add_u32 s12, s12, s4
    v_mfma_f32_16x16x32_bf16 v[60:63], v[92:95], v[96:99], v[60:63]
    s_add_u32 s12, s12, 22872064
    ds_read2_b32 a[216:217], v7 offset0:48 offset1:49
    v_mfma_f32_16x16x32_bf16 v[60:63], v[88:91], v[100:103], v[60:63]
    s_lshr_b32 s4, s7, 8
    ds_read2_b32 a[218:219], v7 offset0:50 offset1:51
    v_mfma_f32_16x16x32_bf16 v[60:63], v[84:87], v[104:107], v[60:63]
    s_and_b32 s4, s4, 31
    v_mfma_f32_16x16x32_bf16 v[60:63], v[80:83], v[108:111], v[60:63]
    ds_read_b128 a[252:255], v19 offset:30720
    v_mfma_f32_16x16x32_bf16 v[60:63], v[76:79], v[112:115], v[60:63]
    s_lshl_b32 s4, s4, 8
    ds_read2_b32 a[220:221], v7 offset0:176 offset1:177
    v_mfma_f32_16x16x32_bf16 v[60:63], v[72:75], v[116:119], v[60:63]
    s_add_u32 s68, s4, s12
    v_mfma_f32_16x16x32_bf16 v[60:63], v[68:71], v[120:123], v[60:63]
    s_bfe_u32 s4, s83, 0x30000
    ds_read2_b32 a[222:223], v7 offset0:178 offset1:179
    v_mfma_f32_16x16x32_bf16 v[60:63], v[64:67], v[124:127], v[60:63]
    s_waitcnt vmcnt(8) lgkmcnt(12)
    s_barrier
    s_mul_i32 s4, s4, 5
    v_mfma_f32_16x16x32_bf16 v[32:35], a[192:195], a[224:227], v[32:35]
    s_lshr_b64 s[4:5], s[6:7], s4
    ds_read_b128 v[96:99], v16 offset:0
    v_mfma_f32_16x16x32_bf16 v[36:39], a[196:199], a[224:227], v[36:39]
    s_and_b32 s4, s4, 31
    v_mfma_f32_16x16x32_bf16 v[36:39], a[192:195], a[228:231], v[36:39]
    ds_read2_b32 v[64:65], v4 offset0:64 offset1:65
    v_mfma_f32_16x16x32_bf16 v[40:43], a[192:195], a[232:235], v[40:43]
    s_lshl_b32 s4, s4, 8
    ds_read2_b32 v[66:67], v4 offset0:66 offset1:67
    v_mfma_f32_16x16x32_bf16 v[40:43], a[196:199], a[228:231], v[40:43]
    s_add_u32 s69, s4, s12
    ds_read_b64_tr_b16 v[188:189], v12 offset:32768
    v_mfma_f32_16x16x32_bf16 v[40:43], a[200:203], a[224:227], v[40:43]
    s_cmp_lt_u32 s3, 2
    s_cselect_b32 s68, s68, s69
    ds_read_b128 v[100:103], v16 offset:4096
    v_mfma_f32_16x16x32_bf16 v[44:47], a[204:207], a[224:227], v[44:47]
    s_bfe_u32 s4, s83, 0x30003
    ds_read2_b32 v[68:69], v4 offset0:192 offset1:193
    v_mfma_f32_16x16x32_bf16 v[44:47], a[200:203], a[228:231], v[44:47]
    s_mul_i32 s4, s4, 5
    ds_read_b64_tr_b16 v[190:191], v12 offset:33792
    v_mfma_f32_16x16x32_bf16 v[44:47], a[196:199], a[232:235], v[44:47]
    s_lshr_b64 s[4:5], s[6:7], s4
    ds_read2_b32 v[70:71], v4 offset0:194 offset1:195
    v_mfma_f32_16x16x32_bf16 v[44:47], a[192:195], a[236:239], v[44:47]
    s_waitcnt lgkmcnt(8)
    s_and_b32 s4, s4, 31
    ds_read_b128 v[104:107], v16 offset:8192
    v_mfma_f32_16x16x32_bf16 v[48:51], a[192:195], a[240:243], v[48:51]
    ds_read2_b32 v[72:73], v5 offset0:64 offset1:65
    v_mfma_f32_16x16x32_bf16 v[48:51], a[196:199], a[236:239], v[48:51]
    s_lshl_b32 s4, s4, 8
    ds_read_b64_tr_b16 v[192:193], v13 offset:32768
    v_mfma_f32_16x16x32_bf16 v[48:51], a[200:203], a[232:235], v[48:51]
    s_add_u32 s70, s4, s12
    ds_read2_b32 v[74:75], v5 offset0:66 offset1:67
    v_mfma_f32_16x16x32_bf16 v[48:51], a[204:207], a[228:231], v[48:51]
    s_bfe_u32 s4, s83, 0x30006
    ds_read_b128 v[108:111], v16 offset:12288
    v_mfma_f32_16x16x32_bf16 v[48:51], a[208:211], a[224:227], v[48:51]
    s_mul_i32 s4, s4, 5
    ds_read_b64_tr_b16 v[194:195], v13 offset:33792
    v_mfma_f32_16x16x32_bf16 v[52:55], a[212:215], a[224:227], v[52:55]
    s_lshr_b64 s[4:5], s[6:7], s4
    ds_read2_b32 v[76:77], v5 offset0:192 offset1:193
    v_mfma_f32_16x16x32_bf16 v[52:55], a[208:211], a[228:231], v[52:55]
    s_and_b32 s4, s4, 31
    ds_read2_b32 v[78:79], v5 offset0:194 offset1:195
    v_mfma_f32_16x16x32_bf16 v[52:55], a[204:207], a[232:235], v[52:55]
    v_mfma_f32_16x16x32_bf16 v[52:55], a[200:203], a[236:239], v[52:55]
    s_lshl_b32 s4, s4, 8
    ds_read_b128 v[112:115], v16 offset:16384
    v_mfma_f32_16x16x32_bf16 v[52:55], a[196:199], a[240:243], v[52:55]
    s_add_u32 s71, s4, s12
    ds_read2_b32 v[80:81], v6 offset0:64 offset1:65
    v_mfma_f32_16x16x32_bf16 v[52:55], a[192:195], a[244:247], v[52:55]
    s_bfe_u32 s4, s83, 0x30009
    ds_read_b64_tr_b16 v[196:197], v12 offset:40960
    v_mfma_f32_16x16x32_bf16 v[56:59], a[192:195], a[248:251], v[56:59]
    s_mul_i32 s4, s4, 5
    ds_read2_b32 v[82:83], v6 offset0:66 offset1:67
    v_mfma_f32_16x16x32_bf16 v[56:59], a[196:199], a[244:247], v[56:59]
    s_lshr_b64 s[4:5], s[6:7], s4
    ds_read_b128 v[116:119], v16 offset:20480
    v_mfma_f32_16x16x32_bf16 v[56:59], a[200:203], a[240:243], v[56:59]
    s_and_b32 s4, s4, 31
    ds_read_b64_tr_b16 v[198:199], v12 offset:41984
    v_mfma_f32_16x16x32_bf16 v[56:59], a[204:207], a[236:239], v[56:59]
    s_lshl_b32 s4, s4, 8
    ds_read2_b32 v[84:85], v6 offset0:192 offset1:193
    v_mfma_f32_16x16x32_bf16 v[56:59], a[208:211], a[232:235], v[56:59]
    ds_read2_b32 v[86:87], v6 offset0:194 offset1:195
    v_mfma_f32_16x16x32_bf16 v[56:59], a[212:215], a[228:231], v[56:59]
    s_add_u32 s72, s4, s12
    ds_read_b128 v[120:123], v16 offset:24576
    v_mfma_f32_16x16x32_bf16 v[56:59], a[216:219], a[224:227], v[56:59]
    s_bfe_u32 s4, s83, 0x3000c
    ds_read_b64_tr_b16 v[200:201], v13 offset:40960
    v_mfma_f32_16x16x32_bf16 v[60:63], a[220:223], a[224:227], v[60:63]
    s_mul_i32 s4, s4, 5
    ds_read2_b32 v[88:89], v7 offset0:64 offset1:65
    v_mfma_f32_16x16x32_bf16 v[60:63], a[216:219], a[228:231], v[60:63]
    s_lshr_b64 s[4:5], s[6:7], s4
    ds_read2_b32 v[90:91], v7 offset0:66 offset1:67
    v_mfma_f32_16x16x32_bf16 v[60:63], a[212:215], a[232:235], v[60:63]
    s_and_b32 s4, s4, 31
    ds_read_b64_tr_b16 v[202:203], v13 offset:41984
    v_mfma_f32_16x16x32_bf16 v[60:63], a[208:211], a[236:239], v[60:63]
    s_lshl_b32 s4, s4, 8
    ds_read_b128 v[124:127], v16 offset:28672
    v_mfma_f32_16x16x32_bf16 v[60:63], a[204:207], a[240:243], v[60:63]
    s_add_u32 s73, s4, s12
    ds_read2_b32 v[92:93], v7 offset0:192 offset1:193
    v_mfma_f32_16x16x32_bf16 v[60:63], a[200:203], a[244:247], v[60:63]
    v_mfma_f32_16x16x32_bf16 v[60:63], a[196:199], a[248:251], v[60:63]
    s_bfe_u32 s4, s83, 0x3000f
    ds_read2_b32 v[94:95], v7 offset0:194 offset1:195
    v_mfma_f32_16x16x32_bf16 v[60:63], a[192:195], a[252:255], v[60:63]
    s_waitcnt vmcnt(4) lgkmcnt(3)
    s_barrier
    s_mul_i32 s4, s4, 5
    v_mfma_f32_16x16x32_bf16 v[32:35], v[64:67], v[96:99], v[32:35]
    s_lshr_b64 s[4:5], s[6:7], s4
    ds_read_b128 a[224:227], v17 offset:0
    v_mfma_f32_16x16x32_bf16 v[36:39], v[68:71], v[96:99], v[36:39]
    s_add_u32 m0, s20, 147456
    s_and_b32 s4, s4, 31
    v_mfma_f32_16x16x32_bf16 v[36:39], v[64:67], v[100:103], v[36:39]
    s_lshl_b32 s14, s89, 1
    ds_read2_b32 a[192:193], v4 offset0:80 offset1:81
    s_lshl_b32 s4, s4, 8
    v_mfma_f32_16x16x32_bf16 v[40:43], v[64:67], v[104:107], v[40:43]
    s_add_u32 s74, s4, s12
    ds_read2_b32 a[194:195], v4 offset0:82 offset1:83
    v_mfma_f32_16x16x32_bf16 v[40:43], v[68:71], v[100:103], v[40:43]
    ds_read_b64_tr_b16 v[204:205], v12 offset:0
    buffer_load_dwordx4 v8, s[52:55], s14 offen offset:0 lds
    v_mfma_f32_16x16x32_bf16 v[40:43], v[72:75], v[96:99], v[40:43]
    s_bfe_u32 s4, s83, 0x30012
    ds_read_b128 a[228:231], v17 offset:4096
    v_mfma_f32_16x16x32_bf16 v[44:47], v[76:79], v[96:99], v[44:47]
    s_mul_i32 s4, s4, 5
    ds_read2_b32 a[196:197], v4 offset0:208 offset1:209
    v_mfma_f32_16x16x32_bf16 v[44:47], v[72:75], v[100:103], v[44:47]
    s_lshr_b64 s[4:5], s[6:7], s4
    ds_read_b64_tr_b16 v[206:207], v12 offset:1024
    v_mfma_f32_16x16x32_bf16 v[44:47], v[68:71], v[104:107], v[44:47]
    s_and_b32 s4, s4, 31
    ds_read2_b32 a[198:199], v4 offset0:210 offset1:211
    buffer_load_dwordx4 v9, s[52:55], s14 offen offset:1024 lds
    v_mfma_f32_16x16x32_bf16 v[44:47], v[64:67], v[108:111], v[44:47]
    s_waitcnt lgkmcnt(8)
    s_lshl_b32 s4, s4, 8
    ds_read_b128 a[232:235], v17 offset:8192
    v_mfma_f32_16x16x32_bf16 v[48:51], v[64:67], v[112:115], v[48:51]
    s_add_u32 s75, s4, s12
    ds_read2_b32 a[200:201], v5 offset0:80 offset1:81
    v_mfma_f32_16x16x32_bf16 v[48:51], v[68:71], v[108:111], v[48:51]
    s_bfe_u32 s4, s83, 0x30015
    ds_read_b64_tr_b16 v[208:209], v13 offset:0
    buffer_load_dwordx4 v10, s[52:55], s14 offen offset:2048 lds
    v_mfma_f32_16x16x32_bf16 v[48:51], v[72:75], v[104:107], v[48:51]
    ds_read2_b32 a[202:203], v5 offset0:82 offset1:83
    v_mfma_f32_16x16x32_bf16 v[48:51], v[76:79], v[100:103], v[48:51]
    s_mul_i32 s4, s4, 5
    ds_read_b128 a[236:239], v17 offset:12288
    v_mfma_f32_16x16x32_bf16 v[48:51], v[80:83], v[96:99], v[48:51]
    s_lshr_b64 s[4:5], s[6:7], s4
    ds_read_b64_tr_b16 v[210:211], v13 offset:1024
    v_mfma_f32_16x16x32_bf16 v[52:55], v[84:87], v[96:99], v[52:55]
    s_and_b32 s4, s4, 31
    ds_read2_b32 a[204:205], v5 offset0:208 offset1:209
    buffer_load_dwordx4 v11, s[52:55], s14 offen offset:3072 lds
    v_mfma_f32_16x16x32_bf16 v[52:55], v[80:83], v[100:103], v[52:55]
    s_lshl_b32 s4, s4, 8
    ds_read2_b32 a[206:207], v5 offset0:210 offset1:211
    v_mfma_f32_16x16x32_bf16 v[52:55], v[76:79], v[104:107], v[52:55]
    s_add_u32 s76, s4, s12
    v_mfma_f32_16x16x32_bf16 v[52:55], v[72:75], v[108:111], v[52:55]
    s_mov_b32 s6, 994437672
    ds_read_b128 a[240:243], v17 offset:16384
    v_mfma_f32_16x16x32_bf16 v[52:55], v[68:71], v[112:115], v[52:55]
    s_cmp_eq_u32 s23, 1
    s_cselect_b32 s6, 391038234, s6
    ds_read2_b32 a[208:209], v6 offset0:80 offset1:81
    v_mfma_f32_16x16x32_bf16 v[52:55], v[64:67], v[116:119], v[52:55]
    ds_read_b64_tr_b16 v[212:213], v12 offset:8192
    v_mfma_f32_16x16x32_bf16 v[56:59], v[64:67], v[120:123], v[56:59]
    s_cmp_eq_u32 s23, 2
    s_cselect_b32 s6, 994419537, s6
    ds_read2_b32 a[210:211], v6 offset0:82 offset1:83
    v_mfma_f32_16x16x32_bf16 v[56:59], v[68:71], v[116:119], v[56:59]
    s_cmp_eq_u32 s23, 3
    s_cselect_b32 s6, 391029306, s6
    ds_read_b128 a[244:247], v17 offset:20480
    v_mfma_f32_16x16x32_bf16 v[56:59], v[72:75], v[112:115], v[56:59]
    s_bfe_u32 s4, s6, 0x20003
    ds_read_b64_tr_b16 v[214:215], v12 offset:9216
    v_mfma_f32_16x16x32_bf16 v[56:59], v[76:79], v[108:111], v[56:59]
    s_lshl_b32 s4, s4, 1
    ds_read2_b32 a[212:213], v6 offset0:208 offset1:209
    v_mfma_f32_16x16x32_bf16 v[56:59], v[80:83], v[104:107], v[56:59]
    s_xor_b32 s4, s4, s2
    ds_read2_b32 a[214:215], v6 offset0:210 offset1:211
    v_mfma_f32_16x16x32_bf16 v[56:59], v[84:87], v[100:103], v[56:59]
    s_lshl2_add_u32 s4, s4, s3
    ds_read_b128 a[248:251], v17 offset:24576
    v_mfma_f32_16x16x32_bf16 v[56:59], v[88:91], v[96:99], v[56:59]
    ds_read_b64_tr_b16 v[216:217], v13 offset:8192
    v_mfma_f32_16x16x32_bf16 v[60:63], v[92:95], v[96:99], v[60:63]
    s_bfe_u32 s5, s6, 0x30000
    ds_read2_b32 a[216:217], v7 offset0:80 offset1:81
    v_mfma_f32_16x16x32_bf16 v[60:63], v[88:91], v[100:103], v[60:63]
    s_lshl3_add_u32 s4, s4, s5
    ds_read2_b32 a[218:219], v7 offset0:82 offset1:83
    v_mfma_f32_16x16x32_bf16 v[60:63], v[84:87], v[104:107], v[60:63]
    s_lshl_b32 s4, s4, 10
    ds_read_b64_tr_b16 v[218:219], v13 offset:9216
    v_mfma_f32_16x16x32_bf16 v[60:63], v[80:83], v[108:111], v[60:63]
    s_add_u32 s77, s4, 14483456
    ds_read_b128 a[252:255], v17 offset:28672
    v_mfma_f32_16x16x32_bf16 v[60:63], v[76:79], v[112:115], v[60:63]
    s_bfe_u32 s4, s6, 0x20008
    ds_read2_b32 a[220:221], v7 offset0:208 offset1:209
    v_mfma_f32_16x16x32_bf16 v[60:63], v[72:75], v[116:119], v[60:63]
    s_lshl_b32 s4, s4, 1
    v_mfma_f32_16x16x32_bf16 v[60:63], v[68:71], v[120:123], v[60:63]
    s_xor_b32 s4, s4, s2
    ds_read2_b32 a[222:223], v7 offset0:210 offset1:211
    v_mfma_f32_16x16x32_bf16 v[60:63], v[64:67], v[124:127], v[60:63]
    s_waitcnt vmcnt(4) lgkmcnt(3)
    s_barrier
    v_mfma_f32_16x16x32_bf16 v[32:35], a[192:195], a[224:227], v[32:35]
    s_lshl2_add_u32 s4, s4, s3
    ds_read_b128 v[96:99], v18 offset:0
    v_mfma_f32_16x16x32_bf16 v[36:39], a[196:199], a[224:227], v[36:39]
    s_add_u32 m0, s20, 114688
    s_bfe_u32 s5, s6, 0x30005
    v_mfma_f32_16x16x32_bf16 v[36:39], a[192:195], a[228:231], v[36:39]
    s_lshl_b32 s14, s90, 1
    ds_read2_b32 v[64:65], v4 offset0:96 offset1:97
    s_lshl3_add_u32 s4, s4, s5
    v_mfma_f32_16x16x32_bf16 v[40:43], a[192:195], a[232:235], v[40:43]
    s_lshl_b32 s4, s4, 10
    ds_read2_b32 v[66:67], v4 offset0:98 offset1:99
    v_mfma_f32_16x16x32_bf16 v[40:43], a[196:199], a[228:231], v[40:43]
    s_add_u32 s78, s4, 14483456
    ds_read_b64_tr_b16 v[220:221], v12 offset:16384
    buffer_load_dwordx4 v8, s[52:55], s14 offen offset:0 lds
    v_mfma_f32_16x16x32_bf16 v[40:43], a[200:203], a[224:227], v[40:43]
    s_bfe_u32 s4, s6, 0x2000d
    ds_read_b128 v[100:103], v18 offset:4096
    v_mfma_f32_16x16x32_bf16 v[44:47], a[204:207], a[224:227], v[44:47]
    s_lshl_b32 s4, s4, 1
    ds_read2_b32 v[68:69], v4 offset0:224 offset1:225
    v_mfma_f32_16x16x32_bf16 v[44:47], a[200:203], a[228:231], v[44:47]
    ds_read_b64_tr_b16 v[222:223], v12 offset:17408
    v_mfma_f32_16x16x32_bf16 v[44:47], a[196:199], a[232:235], v[44:47]
    s_xor_b32 s4, s4, s2
    ds_read2_b32 v[70:71], v4 offset0:226 offset1:227
    buffer_load_dwordx4 v9, s[52:55], s14 offen offset:1024 lds
    v_mfma_f32_16x16x32_bf16 v[44:47], a[192:195], a[236:239], v[44:47]
    s_waitcnt lgkmcnt(8)
    s_lshl2_add_u32 s4, s4, s3
    ds_read_b128 v[104:107], v18 offset:8192
    v_mfma_f32_16x16x32_bf16 v[48:51], a[192:195], a[240:243], v[48:51]
    s_bfe_u32 s5, s6, 0x3000a
    ds_read2_b32 v[72:73], v5 offset0:96 offset1:97
    v_mfma_f32_16x16x32_bf16 v[48:51], a[196:199], a[236:239], v[48:51]
    s_lshl3_add_u32 s4, s4, s5
    ds_read_b64_tr_b16 v[224:225], v13 offset:16384
    buffer_load_dwordx4 v10, s[52:55], s14 offen offset:2048 lds
    v_mfma_f32_16x16x32_bf16 v[48:51], a[200:203], a[232:235], v[48:51]
    s_lshl_b32 s4, s4, 10
    ds_read2_b32 v[74:75], v5 offset0:98 offset1:99
    v_mfma_f32_16x16x32_bf16 v[48:51], a[204:207], a[228:231], v[48:51]
    s_add_u32 s79, s4, 14483456
    ds_read_b128 v[108:111], v18 offset:12288
    v_mfma_f32_16x16x32_bf16 v[48:51], a[208:211], a[224:227], v[48:51]
    ds_read_b64_tr_b16 v[226:227], v13 offset:17408
    v_mfma_f32_16x16x32_bf16 v[52:55], a[212:215], a[224:227], v[52:55]
    s_bfe_u32 s4, s6, 0x20012
    ds_read2_b32 v[76:77], v5 offset0:224 offset1:225
    buffer_load_dwordx4 v11, s[52:55], s14 offen offset:3072 lds
    v_mfma_f32_16x16x32_bf16 v[52:55], a[208:211], a[228:231], v[52:55]
    s_lshl_b32 s4, s4, 1
    ds_read2_b32 v[78:79], v5 offset0:226 offset1:227
    v_mfma_f32_16x16x32_bf16 v[52:55], a[204:207], a[232:235], v[52:55]
    s_xor_b32 s4, s4, s2
    v_mfma_f32_16x16x32_bf16 v[52:55], a[200:203], a[236:239], v[52:55]
    s_lshl2_add_u32 s4, s4, s3
    ds_read_b128 v[112:115], v18 offset:16384
    v_mfma_f32_16x16x32_bf16 v[52:55], a[196:199], a[240:243], v[52:55]
    s_bfe_u32 s5, s6, 0x3000f
    ds_read2_b32 v[80:81], v6 offset0:96 offset1:97
    v_mfma_f32_16x16x32_bf16 v[52:55], a[192:195], a[244:247], v[52:55]
    s_lshl3_add_u32 s4, s4, s5
    ds_read_b64_tr_b16 v[228:229], v12 offset:24576
    v_mfma_f32_16x16x32_bf16 v[56:59], a[192:195], a[248:251], v[56:59]
    s_lshl_b32 s4, s4, 10
    ds_read2_b32 v[82:83], v6 offset0:98 offset1:99
    v_mfma_f32_16x16x32_bf16 v[56:59], a[196:199], a[244:247], v[56:59]
    ds_read_b128 v[116:119], v18 offset:20480
    v_mfma_f32_16x16x32_bf16 v[56:59], a[200:203], a[240:243], v[56:59]
    s_add_u32 s80, s4, 14483456
    ds_read_b64_tr_b16 v[230:231], v12 offset:25600
    v_mfma_f32_16x16x32_bf16 v[56:59], a[204:207], a[236:239], v[56:59]
    s_bfe_u32 s4, s6, 0x20017
    ds_read2_b32 v[84:85], v6 offset0:224 offset1:225
    v_mfma_f32_16x16x32_bf16 v[56:59], a[208:211], a[232:235], v[56:59]
    s_lshl_b32 s4, s4, 1
    ds_read2_b32 v[86:87], v6 offset0:226 offset1:227
    v_mfma_f32_16x16x32_bf16 v[56:59], a[212:215], a[228:231], v[56:59]
    s_xor_b32 s4, s4, s2
    ds_read_b128 v[120:123], v18 offset:24576
    v_mfma_f32_16x16x32_bf16 v[56:59], a[216:219], a[224:227], v[56:59]
    s_lshl2_add_u32 s4, s4, s3
    ds_read_b64_tr_b16 v[232:233], v13 offset:24576
    v_mfma_f32_16x16x32_bf16 v[60:63], a[220:223], a[224:227], v[60:63]
    s_bfe_u32 s5, s6, 0x30014
    ds_read2_b32 v[88:89], v7 offset0:96 offset1:97
    v_mfma_f32_16x16x32_bf16 v[60:63], a[216:219], a[228:231], v[60:63]
    ds_read2_b32 v[90:91], v7 offset0:98 offset1:99
    v_mfma_f32_16x16x32_bf16 v[60:63], a[212:215], a[232:235], v[60:63]
    s_lshl3_add_u32 s4, s4, s5
    ds_read_b64_tr_b16 v[234:235], v13 offset:25600
    v_mfma_f32_16x16x32_bf16 v[60:63], a[208:211], a[236:239], v[60:63]
    s_lshl_b32 s4, s4, 10
    ds_read_b128 v[124:127], v18 offset:28672
    v_mfma_f32_16x16x32_bf16 v[60:63], a[204:207], a[240:243], v[60:63]
    s_add_u32 s81, s4, 14483456
    ds_read2_b32 v[92:93], v7 offset0:224 offset1:225
    v_mfma_f32_16x16x32_bf16 v[60:63], a[200:203], a[244:247], v[60:63]
    s_bfe_u32 s4, s6, 0x2001c
    v_mfma_f32_16x16x32_bf16 v[60:63], a[196:199], a[248:251], v[60:63]
    s_lshl_b32 s4, s4, 1
    ds_read2_b32 v[94:95], v7 offset0:226 offset1:227
    v_mfma_f32_16x16x32_bf16 v[60:63], a[192:195], a[252:255], v[60:63]
    s_waitcnt lgkmcnt(3)
    s_barrier
    s_xor_b32 s4, s4, s2
    v_mfma_f32_16x16x32_bf16 v[32:35], v[64:67], v[96:99], v[32:35]
    s_lshl2_add_u32 s4, s4, s3
    ds_read_b128 a[224:227], v19 offset:0
    v_mfma_f32_16x16x32_bf16 v[36:39], v[68:71], v[96:99], v[36:39]
    s_add_u32 m0, s20, 131072
    v_mfma_f32_16x16x32_bf16 v[36:39], v[64:67], v[100:103], v[36:39]
    s_lshl_b32 s14, s91, 1
    ds_read_b128 a[228:231], v19 offset:4096
    s_bfe_u32 s5, s6, 0x30019
    v_mfma_f32_16x16x32_bf16 v[40:43], v[64:67], v[104:107], v[40:43]
    s_lshl3_add_u32 s4, s4, s5
    ds_read_b128 a[232:235], v19 offset:8192
    v_mfma_f32_16x16x32_bf16 v[40:43], v[68:71], v[100:103], v[40:43]
    s_lshl_b32 s4, s4, 10
    ds_read_b128 a[236:239], v19 offset:12288
    buffer_load_dwordx4 v8, s[52:55], s14 offen offset:0 lds
    v_mfma_f32_16x16x32_bf16 v[40:43], v[72:75], v[96:99], v[40:43]
    s_add_u32 s82, s4, 14483456
    v_mfma_f32_16x16x32_bf16 v[44:47], v[76:79], v[96:99], v[44:47]
    s_lshl2_add_u32 s4, s2, s3
    ds_read_b128 a[240:243], v19 offset:16384
    v_mfma_f32_16x16x32_bf16 v[44:47], v[72:75], v[100:103], v[44:47]
    s_lshl_b32 s4, s4, 13
    ds_read_b128 a[244:247], v19 offset:20480
    v_mfma_f32_16x16x32_bf16 v[44:47], v[68:71], v[104:107], v[44:47]
    s_add_u32 s83, s4, 14483456
    buffer_load_dwordx4 v9, s[52:55], s14 offen offset:1024 lds
    v_mfma_f32_16x16x32_bf16 v[44:47], v[64:67], v[108:111], v[44:47]
    s_waitcnt lgkmcnt(6)
    ds_read_b128 a[248:251], v19 offset:24576
    v_mfma_f32_16x16x32_bf16 v[48:51], v[64:67], v[112:115], v[48:51]
    s_mov_b32 s60, s24
    ds_read_b128 a[252:255], v19 offset:28672
    v_mfma_f32_16x16x32_bf16 v[48:51], v[68:71], v[108:111], v[48:51]
    s_and_b32 s61, s25, 0xffff
    ds_read2_b32 a[192:193], v4 offset0:112 offset1:113
    buffer_load_dwordx4 v10, s[52:55], s14 offen offset:2048 lds
    v_mfma_f32_16x16x32_bf16 v[48:51], v[72:75], v[104:107], v[48:51]
    s_mov_b32 s62, 2359296
    v_mfma_f32_16x16x32_bf16 v[48:51], v[76:79], v[100:103], v[48:51]
    s_mov_b32 s63, 0x20000
    ds_read2_b32 a[194:195], v4 offset0:114 offset1:115
    v_mfma_f32_16x16x32_bf16 v[48:51], v[80:83], v[96:99], v[48:51]
    s_lshl_b32 s18, s34, 12
    ds_read2_b32 a[196:197], v4 offset0:240 offset1:241
    v_mfma_f32_16x16x32_bf16 v[52:55], v[84:87], v[96:99], v[52:55]
    s_lshl_b32 s8, s3, 10
    ds_read2_b32 a[198:199], v4 offset0:242 offset1:243
    buffer_load_dwordx4 v11, s[52:55], s14 offen offset:3072 lds
    v_mfma_f32_16x16x32_bf16 v[52:55], v[80:83], v[100:103], v[52:55]
    ds_read2_b32 a[200:201], v5 offset0:112 offset1:113
    v_mfma_f32_16x16x32_bf16 v[52:55], v[76:79], v[104:107], v[52:55]
    s_add_u32 s18, s18, s8
    ds_read2_b32 a[202:203], v5 offset0:114 offset1:115
    v_mfma_f32_16x16x32_bf16 v[52:55], v[72:75], v[108:111], v[52:55]
    s_lshr_b32 s9, s34, 4
    ds_read2_b32 a[204:205], v5 offset0:240 offset1:241
    v_mfma_f32_16x16x32_bf16 v[52:55], v[68:71], v[112:115], v[52:55]
    s_mul_i32 s8, s9, 43
    ds_read2_b32 a[206:207], v5 offset0:242 offset1:243
    v_mfma_f32_16x16x32_bf16 v[52:55], v[64:67], v[116:119], v[52:55]
    s_lshr_b32 s8, s8, 7
    ds_read2_b32 a[208:209], v6 offset0:112 offset1:113
    v_xor_b32 v16, 64, v16
    v_mfma_f32_16x16x32_bf16 v[56:59], v[64:67], v[120:123], v[56:59]
    s_add_u32 s43, s9, s8
    v_mfma_f32_16x16x32_bf16 v[56:59], v[68:71], v[116:119], v[56:59]
    s_mul_i32 s8, s8, 3
    ds_read2_b32 a[210:211], v6 offset0:114 offset1:115
    v_mfma_f32_16x16x32_bf16 v[56:59], v[72:75], v[112:115], v[56:59]
    s_sub_u32 s8, s9, s8
    ds_read2_b32 a[212:213], v6 offset0:240 offset1:241
    v_mfma_f32_16x16x32_bf16 v[56:59], v[76:79], v[108:111], v[56:59]
    ds_read2_b32 a[214:215], v6 offset0:242 offset1:243
    v_xor_b32 v17, 64, v17
    v_mfma_f32_16x16x32_bf16 v[56:59], v[80:83], v[104:107], v[56:59]
    s_min_u32 s8, s8, 1
    ds_read2_b32 a[216:217], v7 offset0:112 offset1:113
    v_mfma_f32_16x16x32_bf16 v[56:59], v[84:87], v[100:103], v[56:59]
    s_add_u32 s43, s43, s8
    ds_read2_b32 a[218:219], v7 offset0:114 offset1:115
    v_mfma_f32_16x16x32_bf16 v[56:59], v[88:91], v[96:99], v[56:59]
    s_lshl_b32 s43, s43, 8
    ds_read2_b32 a[220:221], v7 offset0:240 offset1:241
    v_mfma_f32_16x16x32_bf16 v[60:63], v[92:95], v[96:99], v[60:63]
    s_and_b32 s8, s34, 15
    ds_read2_b32 a[222:223], v7 offset0:242 offset1:243
    v_xor_b32 v18, 64, v18
    v_mfma_f32_16x16x32_bf16 v[60:63], v[88:91], v[100:103], v[60:63]
    s_lshl4_add_u32 s43, s8, s43
    v_add_u32 v4, 33280, v4
    v_mfma_f32_16x16x32_bf16 v[60:63], v[84:87], v[104:107], v[60:63]
    s_mul_i32 s8, s3, 786432
    v_mfma_f32_16x16x32_bf16 v[60:63], v[80:83], v[108:111], v[60:63]
    s_add_u32 s43, s43, s8
    v_add_u32 v5, 33280, v5
    v_mfma_f32_16x16x32_bf16 v[60:63], v[76:79], v[112:115], v[60:63]
    v_xor_b32 v19, 64, v19
    v_add_u32 v6, 33280, v6
    v_mfma_f32_16x16x32_bf16 v[60:63], v[72:75], v[116:119], v[60:63]
    s_add_u32 s43, s43, 3211264
    v_mfma_f32_16x16x32_bf16 v[60:63], v[68:71], v[120:123], v[60:63]
    v_add_u32 v7, 33280, v7
    v_mul_u32_u24 v147, 12288, v2
    v_mfma_f32_16x16x32_bf16 v[60:63], v[64:67], v[124:127], v[60:63]
    s_waitcnt vmcnt(8) lgkmcnt(0)
    s_barrier
    s_lshr_b32 s10, s20, 2
    v_mfma_f32_16x16x32_bf16 v[60:63], a[220:223], a[224:227], v[60:63]
    ds_read_b128 v[96:99], v16 offset:2048
    v_mfma_f32_16x16x32_bf16 v[60:63], a[216:219], a[228:231], v[60:63]
    ds_read_b128 v[100:103], v16 offset:6144
    v_mfma_f32_16x16x32_bf16 v[60:63], a[212:215], a[232:235], v[60:63]
    ds_read_b64_tr_b16 v[236:237], v12 offset:32768
    v_mfma_f32_16x16x32_bf16 v[60:63], a[208:211], a[236:239], v[60:63]
    ds_read_b128 v[104:107], v16 offset:10240
    v_mfma_f32_16x16x32_bf16 v[60:63], a[204:207], a[240:243], v[60:63]
    ds_read_b128 v[108:111], v16 offset:14336
    v_mfma_f32_16x16x32_bf16 v[60:63], a[200:203], a[244:247], v[60:63]
    ds_read_b128 v[112:115], v16 offset:18432
    v_mfma_f32_16x16x32_bf16 v[60:63], a[196:199], a[248:251], v[60:63]
    ds_read_b128 v[116:119], v16 offset:22528
    v_mfma_f32_16x16x32_bf16 v[60:63], a[192:195], a[252:255], v[60:63]
    ds_read_b128 v[120:123], v16 offset:26624
    v_mfma_f32_16x16x32_bf16 v[56:59], a[192:195], a[248:251], v[56:59]
    ds_read_b64_tr_b16 v[238:239], v12 offset:33792
    v_mfma_f32_16x16x32_bf16 v[56:59], a[196:199], a[244:247], v[56:59]
    ds_read_b128 v[124:127], v16 offset:30720
    v_mfma_f32_16x16x32_bf16 v[56:59], a[200:203], a[240:243], v[56:59]
    ds_read2_b32 v[64:65], v4 offset0:0 offset1:1
    v_mfma_f32_16x16x32_bf16 v[56:59], a[204:207], a[236:239], v[56:59]
    ds_read2_b32 v[66:67], v4 offset0:2 offset1:3
    v_mfma_f32_16x16x32_bf16 v[56:59], a[208:211], a[232:235], v[56:59]
    ds_read2_b32 v[68:69], v4 offset0:128 offset1:129
    v_mfma_f32_16x16x32_bf16 v[56:59], a[212:215], a[228:231], v[56:59]
    ds_read2_b32 v[70:71], v4 offset0:130 offset1:131
    v_mfma_f32_16x16x32_bf16 v[56:59], a[216:219], a[224:227], v[56:59]
    ds_read_b64_tr_b16 v[240:241], v13 offset:32768
    v_mfma_f32_16x16x32_bf16 v[52:55], a[212:215], a[224:227], v[52:55]
    ds_read2_b32 v[72:73], v5 offset0:0 offset1:1
    v_mfma_f32_16x16x32_bf16 v[52:55], a[208:211], a[228:231], v[52:55]
    ds_read2_b32 v[74:75], v5 offset0:2 offset1:3
    v_mfma_f32_16x16x32_bf16 v[52:55], a[204:207], a[232:235], v[52:55]
    ds_read2_b32 v[76:77], v5 offset0:128 offset1:129
    v_cvt_pk_bf16_f32 v142, v60, v61
L_pl_X_4:
    s_cbranch_execz L_wret
    v_mfma_f32_16x16x32_bf16 v[52:55], a[200:203], a[236:239], v[52:55]
    ds_read2_b32 v[78:79], v5 offset0:130 offset1:131
    v_mfma_f32_16x16x32_bf16 v[52:55], a[196:199], a[240:243], v[52:55]
    ds_read2_b32 v[80:81], v6 offset0:0 offset1:1
    v_cvt_pk_bf16_f32 v143, v62, v63
    v_mfma_f32_16x16x32_bf16 v[52:55], a[192:195], a[244:247], v[52:55]
    ds_read_b64_tr_b16 v[242:243], v13 offset:33792
    v_mfma_f32_16x16x32_bf16 v[48:51], a[192:195], a[240:243], v[48:51]
    ds_read2_b32 v[82:83], v6 offset0:2 offset1:3
    buffer_store_dwordx2 v[142:143], v20, s[44:47], s15 offen offset:3584 sc1
    v_mfma_f32_16x16x32_bf16 v[48:51], a[196:199], a[236:239], v[48:51]
    ds_read2_b32 v[84:85], v6 offset0:128 offset1:129
    v_mfma_f32_16x16x32_bf16 v[48:51], a[200:203], a[232:235], v[48:51]
    ds_read2_b32 v[86:87], v6 offset0:130 offset1:131
    v_cvt_pk_bf16_f32 v140, v56, v57
    v_mfma_f32_16x16x32_bf16 v[48:51], a[204:207], a[228:231], v[48:51]
    ds_read2_b32 v[88:89], v7 offset0:0 offset1:1
    v_mfma_f32_16x16x32_bf16 v[48:51], a[208:211], a[224:227], v[48:51]
    ds_read2_b32 v[90:91], v7 offset0:2 offset1:3
    v_cvt_pk_bf16_f32 v141, v58, v59
    v_mfma_f32_16x16x32_bf16 v[44:47], a[204:207], a[224:227], v[44:47]
    ds_read_b64_tr_b16 v[244:245], v12 offset:40960
    v_mfma_f32_16x16x32_bf16 v[44:47], a[200:203], a[228:231], v[44:47]
    ds_read2_b32 v[92:93], v7 offset0:128 offset1:129
    buffer_store_dwordx2 v[140:141], v20, s[44:47], s15 offen offset:3072 sc1
    v_mfma_f32_16x16x32_bf16 v[44:47], a[196:199], a[232:235], v[44:47]
    ds_read2_b32 v[94:95], v7 offset0:130 offset1:131
    v_mfma_f32_16x16x32_bf16 v[44:47], a[192:195], a[236:239], v[44:47]
    ds_read_b64_tr_b16 v[246:247], v12 offset:41984
    v_mfma_f32_16x16x32_bf16 v[40:43], a[192:195], a[232:235], v[40:43]
    ds_read_b64_tr_b16 v[248:249], v13 offset:40960
    v_cvt_pk_bf16_f32 v138, v52, v53
    v_mfma_f32_16x16x32_bf16 v[40:43], a[196:199], a[228:231], v[40:43]
    ds_read_b64_tr_b16 v[250:251], v13 offset:41984
    v_mfma_f32_16x16x32_bf16 v[40:43], a[200:203], a[224:227], v[40:43]
    v_cvt_pk_bf16_f32 v139, v54, v55
    v_mfma_f32_16x16x32_bf16 v[36:39], a[196:199], a[224:227], v[36:39]
    v_mfma_f32_16x16x32_bf16 v[36:39], a[192:195], a[228:231], v[36:39]
    buffer_store_dwordx2 v[138:139], v20, s[44:47], s15 offen offset:2560 sc1
    v_mfma_f32_16x16x32_bf16 v[32:35], a[192:195], a[224:227], v[32:35]
    s_waitcnt vmcnt(7) lgkmcnt(0)
    s_barrier
    v_mfma_f32_16x16x32_bf16 v[60:63], v[92:95], v[96:99], 0
    ds_read_b128 a[224:227], v17 offset:2048
    v_cvt_pk_bf16_f32 v136, v48, v49
    v_mfma_f32_16x16x32_bf16 v[60:63], v[88:91], v[100:103], v[60:63]
    s_add_u32 m0, s20, 147456
    v_mfma_f32_16x16x32_bf16 v[60:63], v[84:87], v[104:107], v[60:63]
    s_lshl_b32 s14, s92, 1
    ds_read2_b32 a[192:193], v4 offset0:16 offset1:17
    v_cvt_pk_bf16_f32 v137, v50, v51
    v_mfma_f32_16x16x32_bf16 v[60:63], v[80:83], v[108:111], v[60:63]
    ds_read2_b32 a[194:195], v4 offset0:18 offset1:19
    v_mfma_f32_16x16x32_bf16 v[60:63], v[76:79], v[112:115], v[60:63]
    ds_read_b64_tr_b16 a[0:1], v12 offset:0
    buffer_load_dwordx4 v8, s[52:55], s14 offen offset:0 lds
    v_mfma_f32_16x16x32_bf16 v[60:63], v[72:75], v[116:119], v[60:63]
    ds_read_b128 a[228:231], v17 offset:6144
    buffer_store_dwordx2 v[136:137], v20, s[44:47], s15 offen offset:2048 sc1
    v_mfma_f32_16x16x32_bf16 v[60:63], v[68:71], v[120:123], v[60:63]
    ds_read2_b32 a[196:197], v4 offset0:144 offset1:145
    v_cvt_pk_bf16_f32 v134, v44, v45
    v_mfma_f32_16x16x32_bf16 v[60:63], v[64:67], v[124:127], v[60:63]
    ds_read_b64_tr_b16 a[2:3], v12 offset:1024
    v_mfma_f32_16x16x32_bf16 v[56:59], v[64:67], v[120:123], 0
    ds_read2_b32 a[198:199], v4 offset0:146 offset1:147
    buffer_load_dwordx4 v9, s[52:55], s14 offen offset:1024 lds
    v_mfma_f32_16x16x32_bf16 v[56:59], v[68:71], v[116:119], v[56:59]
    ds_read_b128 a[232:235], v17 offset:10240
    v_cvt_pk_bf16_f32 v135, v46, v47
    v_mfma_f32_16x16x32_bf16 v[56:59], v[72:75], v[112:115], v[56:59]
    ds_read2_b32 a[200:201], v5 offset0:16 offset1:17
    buffer_store_dwordx2 v[134:135], v20, s[44:47], s15 offen offset:1536 sc1
    v_mfma_f32_16x16x32_bf16 v[56:59], v[76:79], v[108:111], v[56:59]
    ds_read_b64_tr_b16 a[4:5], v13 offset:0
    buffer_load_dwordx4 v10, s[52:55], s14 offen offset:2048 lds
    v_mfma_f32_16x16x32_bf16 v[56:59], v[80:83], v[104:107], v[56:59]
    ds_read2_b32 a[202:203], v5 offset0:18 offset1:19
    v_cvt_pk_bf16_f32 v132, v40, v41
    v_mfma_f32_16x16x32_bf16 v[56:59], v[84:87], v[100:103], v[56:59]
    ds_read_b128 a[236:239], v17 offset:14336
    v_mfma_f32_16x16x32_bf16 v[56:59], v[88:91], v[96:99], v[56:59]
    ds_read_b64_tr_b16 a[6:7], v13 offset:1024
    v_cvt_pk_bf16_f32 v133, v42, v43
    v_mfma_f32_16x16x32_bf16 v[52:55], v[84:87], v[96:99], 0
    ds_read2_b32 a[204:205], v5 offset0:144 offset1:145
    buffer_load_dwordx4 v11, s[52:55], s14 offen offset:3072 lds
    v_mfma_f32_16x16x32_bf16 v[52:55], v[80:83], v[100:103], v[52:55]
    ds_read2_b32 a[206:207], v5 offset0:146 offset1:147
    buffer_store_dwordx2 v[132:133], v20, s[44:47], s15 offen offset:1024 sc1
    v_mfma_f32_16x16x32_bf16 v[52:55], v[76:79], v[104:107], v[52:55]
    v_cvt_pk_bf16_f32 v130, v36, v37
    v_mfma_f32_16x16x32_bf16 v[52:55], v[72:75], v[108:111], v[52:55]
    ds_read_b128 a[240:243], v17 offset:18432
    v_mfma_f32_16x16x32_bf16 v[52:55], v[68:71], v[112:115], v[52:55]
    ds_read2_b32 a[208:209], v6 offset0:16 offset1:17
    v_cvt_pk_bf16_f32 v131, v38, v39
    v_mfma_f32_16x16x32_bf16 v[52:55], v[64:67], v[116:119], v[52:55]
    ds_read_b64_tr_b16 a[8:9], v12 offset:8192
    buffer_store_dwordx2 v[130:131], v20, s[44:47], s15 offen offset:512 sc1
    v_mfma_f32_16x16x32_bf16 v[48:51], v[64:67], v[112:115], 0
    ds_read2_b32 a[210:211], v6 offset0:18 offset1:19
    v_mfma_f32_16x16x32_bf16 v[48:51], v[68:71], v[108:111], v[48:51]
    ds_read_b128 a[244:247], v17 offset:22528
    v_cvt_pk_bf16_f32 v128, v32, v33
    v_mfma_f32_16x16x32_bf16 v[48:51], v[72:75], v[104:107], v[48:51]
    ds_read_b64_tr_b16 a[10:11], v12 offset:9216
    v_mfma_f32_16x16x32_bf16 v[48:51], v[76:79], v[100:103], v[48:51]
    ds_read2_b32 a[212:213], v6 offset0:144 offset1:145
    v_cvt_pk_bf16_f32 v129, v34, v35
    v_mfma_f32_16x16x32_bf16 v[48:51], v[80:83], v[96:99], v[48:51]
    ds_read2_b32 a[214:215], v6 offset0:146 offset1:147
    buffer_store_dwordx2 v[128:129], v20, s[44:47], s15 offen offset:0 sc1
    v_mfma_f32_16x16x32_bf16 v[44:47], v[76:79], v[96:99], 0
    ds_read_b128 a[248:251], v17 offset:26624
    v_mfma_f32_16x16x32_bf16 v[44:47], v[72:75], v[100:103], v[44:47]
    s_add_u32 s15, s15, 16384
    ds_read_b64_tr_b16 a[12:13], v13 offset:8192
    v_mfma_f32_16x16x32_bf16 v[44:47], v[68:71], v[104:107], v[44:47]
    ds_read2_b32 a[216:217], v7 offset0:16 offset1:17
    v_mfma_f32_16x16x32_bf16 v[44:47], v[64:67], v[108:111], v[44:47]
    ds_read2_b32 a[218:219], v7 offset0:18 offset1:19
    v_mfma_f32_16x16x32_bf16 v[40:43], v[64:67], v[104:107], 0
    ds_read_b64_tr_b16 a[14:15], v13 offset:9216
    v_mfma_f32_16x16x32_bf16 v[40:43], v[68:71], v[100:103], v[40:43]
    ds_read_b128 a[252:255], v17 offset:30720
    v_mfma_f32_16x16x32_bf16 v[40:43], v[72:75], v[96:99], v[40:43]
    ds_read2_b32 a[220:221], v7 offset0:144 offset1:145
    v_mfma_f32_16x16x32_bf16 v[36:39], v[68:71], v[96:99], 0
    v_mfma_f32_16x16x32_bf16 v[36:39], v[64:67], v[100:103], v[36:39]
    ds_read2_b32 a[222:223], v7 offset0:146 offset1:147
    v_mfma_f32_16x16x32_bf16 v[32:35], v[64:67], v[96:99], 0
    s_waitcnt vmcnt(12) lgkmcnt(3)
    s_barrier
    v_mfma_f32_16x16x32_bf16 v[32:35], a[192:195], a[224:227], v[32:35]
    ds_read_b128 v[96:99], v18 offset:2048
    v_mfma_f32_16x16x32_bf16 v[36:39], a[196:199], a[224:227], v[36:39]
    s_add_u32 m0, s20, 114688
    v_mfma_f32_16x16x32_bf16 v[36:39], a[192:195], a[228:231], v[36:39]
    s_lshl_b32 s14, s93, 1
    ds_read2_b32 v[64:65], v4 offset0:32 offset1:33
    v_mfma_f32_16x16x32_bf16 v[40:43], a[192:195], a[232:235], v[40:43]
    ds_read2_b32 v[66:67], v4 offset0:34 offset1:35
    v_mfma_f32_16x16x32_bf16 v[40:43], a[196:199], a[228:231], v[40:43]
    ds_read_b64_tr_b16 a[16:17], v12 offset:16384
    buffer_load_dwordx4 v8, s[52:55], s14 offen offset:0 lds
    v_mfma_f32_16x16x32_bf16 v[40:43], a[200:203], a[224:227], v[40:43]
    ds_read_b128 v[100:103], v18 offset:6144
    v_mfma_f32_16x16x32_bf16 v[44:47], a[204:207], a[224:227], v[44:47]
    ds_read2_b32 v[68:69], v4 offset0:160 offset1:161
    v_mfma_f32_16x16x32_bf16 v[44:47], a[200:203], a[228:231], v[44:47]
    ds_read_b64_tr_b16 a[18:19], v12 offset:17408
    v_mfma_f32_16x16x32_bf16 v[44:47], a[196:199], a[232:235], v[44:47]
    ds_read2_b32 v[70:71], v4 offset0:162 offset1:163
    buffer_load_dwordx4 v9, s[52:55], s14 offen offset:1024 lds
    v_mfma_f32_16x16x32_bf16 v[44:47], a[192:195], a[236:239], v[44:47]
    s_waitcnt lgkmcnt(8)
    ds_read_b128 v[104:107], v18 offset:10240
    v_mfma_f32_16x16x32_bf16 v[48:51], a[192:195], a[240:243], v[48:51]
    ds_read2_b32 v[72:73], v5 offset0:32 offset1:33
    v_mfma_f32_16x16x32_bf16 v[48:51], a[196:199], a[236:239], v[48:51]
    ds_read_b64_tr_b16 a[20:21], v13 offset:16384
    buffer_load_dwordx4 v10, s[52:55], s14 offen offset:2048 lds
    v_mfma_f32_16x16x32_bf16 v[48:51], a[200:203], a[232:235], v[48:51]
    ds_read2_b32 v[74:75], v5 offset0:34 offset1:35
    v_mfma_f32_16x16x32_bf16 v[48:51], a[204:207], a[228:231], v[48:51]
    ds_read_b128 v[108:111], v18 offset:14336
    v_mfma_f32_16x16x32_bf16 v[48:51], a[208:211], a[224:227], v[48:51]
    ds_read_b64_tr_b16 a[22:23], v13 offset:17408
    v_mfma_f32_16x16x32_bf16 v[52:55], a[212:215], a[224:227], v[52:55]
    ds_read2_b32 v[76:77], v5 offset0:160 offset1:161
    buffer_load_dwordx4 v11, s[52:55], s14 offen offset:3072 lds
    v_mfma_f32_16x16x32_bf16 v[52:55], a[208:211], a[228:231], v[52:55]
    ds_read2_b32 v[78:79], v5 offset0:162 offset1:163
    v_mfma_f32_16x16x32_bf16 v[52:55], a[204:207], a[232:235], v[52:55]
    v_mfma_f32_16x16x32_bf16 v[52:55], a[200:203], a[236:239], v[52:55]
    ds_read_b128 v[112:115], v18 offset:18432
    v_mfma_f32_16x16x32_bf16 v[52:55], a[196:199], a[240:243], v[52:55]
    ds_read2_b32 v[80:81], v6 offset0:32 offset1:33
    v_mfma_f32_16x16x32_bf16 v[52:55], a[192:195], a[244:247], v[52:55]
    ds_read_b64_tr_b16 a[24:25], v12 offset:24576
    v_mfma_f32_16x16x32_bf16 v[56:59], a[192:195], a[248:251], v[56:59]
    ds_read2_b32 v[82:83], v6 offset0:34 offset1:35
    v_mfma_f32_16x16x32_bf16 v[56:59], a[196:199], a[244:247], v[56:59]
    ds_read_b128 v[116:119], v18 offset:22528
    v_mfma_f32_16x16x32_bf16 v[56:59], a[200:203], a[240:243], v[56:59]
    ds_read_b64_tr_b16 a[26:27], v12 offset:25600
    v_mfma_f32_16x16x32_bf16 v[56:59], a[204:207], a[236:239], v[56:59]
    ds_read2_b32 v[84:85], v6 offset0:160 offset1:161
    v_mfma_f32_16x16x32_bf16 v[56:59], a[208:211], a[232:235], v[56:59]
    ds_read2_b32 v[86:87], v6 offset0:162 offset1:163
    v_mfma_f32_16x16x32_bf16 v[56:59], a[212:215], a[228:231], v[56:59]
    ds_read_b128 v[120:123], v18 offset:26624
    v_mfma_f32_16x16x32_bf16 v[56:59], a[216:219], a[224:227], v[56:59]
    ds_read_b64_tr_b16 a[28:29], v13 offset:24576
    v_mfma_f32_16x16x32_bf16 v[60:63], a[220:223], a[224:227], v[60:63]
    ds_read2_b32 v[88:89], v7 offset0:32 offset1:33
    v_mfma_f32_16x16x32_bf16 v[60:63], a[216:219], a[228:231], v[60:63]
    ds_read2_b32 v[90:91], v7 offset0:34 offset1:35
    v_mfma_f32_16x16x32_bf16 v[60:63], a[212:215], a[232:235], v[60:63]
    ds_read_b64_tr_b16 a[30:31], v13 offset:25600
    v_mfma_f32_16x16x32_bf16 v[60:63], a[208:211], a[236:239], v[60:63]
    ds_read_b128 v[124:127], v18 offset:30720
    v_mfma_f32_16x16x32_bf16 v[60:63], a[204:207], a[240:243], v[60:63]
    ds_read2_b32 v[92:93], v7 offset0:160 offset1:161
    v_mfma_f32_16x16x32_bf16 v[60:63], a[200:203], a[244:247], v[60:63]
    v_mfma_f32_16x16x32_bf16 v[60:63], a[196:199], a[248:251], v[60:63]
    ds_read2_b32 v[94:95], v7 offset0:162 offset1:163
    v_mfma_f32_16x16x32_bf16 v[60:63], a[192:195], a[252:255], v[60:63]
    s_waitcnt lgkmcnt(3)
    s_barrier
    v_mfma_f32_16x16x32_bf16 v[32:35], v[64:67], v[96:99], v[32:35]
    ds_read_b128 a[224:227], v19 offset:2048
    v_mfma_f32_16x16x32_bf16 v[36:39], v[68:71], v[96:99], v[36:39]
    s_add_u32 m0, s20, 131072
    v_mov_b32 v148, 0
    v_mfma_f32_16x16x32_bf16 v[36:39], v[64:67], v[100:103], v[36:39]
    s_lshl_b32 s14, s94, 1
    ds_read2_b32 a[192:193], v4 offset0:48 offset1:49
    v_mfma_f32_16x16x32_bf16 v[40:43], v[64:67], v[104:107], v[40:43]
    ds_read2_b32 a[194:195], v4 offset0:50 offset1:51
    v_mfma_f32_16x16x32_bf16 v[40:43], v[68:71], v[100:103], v[40:43]
    buffer_load_dwordx4 v8, s[52:55], s14 offen offset:0 lds
    v_mov_b32 v149, 0
    v_mfma_f32_16x16x32_bf16 v[40:43], v[72:75], v[96:99], v[40:43]
    ds_read_b128 a[228:231], v19 offset:6144
    v_mfma_f32_16x16x32_bf16 v[44:47], v[76:79], v[96:99], v[44:47]
    ds_read2_b32 a[196:197], v4 offset0:176 offset1:177
    v_mfma_f32_16x16x32_bf16 v[44:47], v[72:75], v[100:103], v[44:47]
    v_lshlrev_b32 v150, 3, v2
    v_mfma_f32_16x16x32_bf16 v[44:47], v[68:71], v[104:107], v[44:47]
    ds_read2_b32 a[198:199], v4 offset0:178 offset1:179
    buffer_load_dwordx4 v9, s[52:55], s14 offen offset:1024 lds
    v_mfma_f32_16x16x32_bf16 v[44:47], v[64:67], v[108:111], v[44:47]
    s_waitcnt lgkmcnt(6)
    ds_read_b128 a[232:235], v19 offset:10240
    v_mfma_f32_16x16x32_bf16 v[48:51], v[64:67], v[112:115], v[48:51]
    ds_read2_b32 a[200:201], v5 offset0:48 offset1:49
    v_mfma_f32_16x16x32_bf16 v[48:51], v[68:71], v[108:111], v[48:51]
    buffer_load_dwordx4 v10, s[52:55], s14 offen offset:2048 lds
    v_add_u32 v150, 69664, v150
    v_mfma_f32_16x16x32_bf16 v[48:51], v[72:75], v[104:107], v[48:51]
    ds_read2_b32 a[202:203], v5 offset0:50 offset1:51
    v_mfma_f32_16x16x32_bf16 v[48:51], v[76:79], v[100:103], v[48:51]
    ds_read_b128 a[236:239], v19 offset:14336
    v_mfma_f32_16x16x32_bf16 v[48:51], v[80:83], v[96:99], v[48:51]
    ds_write_b64 v150, v[148:149]
    v_mfma_f32_16x16x32_bf16 v[52:55], v[84:87], v[96:99], v[52:55]
    ds_read2_b32 a[204:205], v5 offset0:176 offset1:177
    buffer_load_dwordx4 v11, s[52:55], s14 offen offset:3072 lds
    v_mfma_f32_16x16x32_bf16 v[52:55], v[80:83], v[100:103], v[52:55]
    ds_read2_b32 a[206:207], v5 offset0:178 offset1:179
    v_mfma_f32_16x16x32_bf16 v[52:55], v[76:79], v[104:107], v[52:55]
    v_mfma_f32_16x16x32_bf16 v[52:55], v[72:75], v[108:111], v[52:55]
    ds_read_b128 a[240:243], v19 offset:18432
    v_bfe_u32 v150, v2, 3, 1
    v_mfma_f32_16x16x32_bf16 v[52:55], v[68:71], v[112:115], v[52:55]
    s_add_u32 m0, s10, 70176
    ds_read2_b32 a[208:209], v6 offset0:48 offset1:49
    v_mfma_f32_16x16x32_bf16 v[52:55], v[64:67], v[116:119], v[52:55]
    v_mul_u32_u24 v150, 8736, v150
    v_mfma_f32_16x16x32_bf16 v[56:59], v[64:67], v[120:123], v[56:59]
    ds_read2_b32 a[210:211], v6 offset0:50 offset1:51
    buffer_load_dwordx4 v147, s[44:47], s43 offen sc1 lds
    v_mfma_f32_16x16x32_bf16 v[56:59], v[68:71], v[116:119], v[56:59]
    ds_read_b128 a[244:247], v19 offset:22528
    v_mfma_f32_16x16x32_bf16 v[56:59], v[72:75], v[112:115], v[56:59]
    s_add_u32 m0, s10, 65568
    v_mfma_f32_16x16x32_bf16 v[56:59], v[76:79], v[108:111], v[56:59]
    ds_read2_b32 a[212:213], v6 offset0:176 offset1:177
    v_and_b32 v151, 7, v2
    v_mfma_f32_16x16x32_bf16 v[56:59], v[80:83], v[104:107], v[56:59]
    ds_read2_b32 a[214:215], v6 offset0:178 offset1:179
    buffer_load_dwordx4 v21, s[60:63], s18 offen lds
    v_mfma_f32_16x16x32_bf16 v[56:59], v[84:87], v[100:103], v[56:59]
    ds_read_b128 a[248:251], v19 offset:26624
    v_mfma_f32_16x16x32_bf16 v[56:59], v[88:91], v[96:99], v[56:59]
    v_lshl_add_u32 v150, v151, 2, v150
    v_mfma_f32_16x16x32_bf16 v[60:63], v[92:95], v[96:99], v[60:63]
    ds_read2_b32 a[216:217], v7 offset0:48 offset1:49
    v_mfma_f32_16x16x32_bf16 v[60:63], v[88:91], v[100:103], v[60:63]
    ds_read2_b32 a[218:219], v7 offset0:50 offset1:51
    v_mfma_f32_16x16x32_bf16 v[60:63], v[84:87], v[104:107], v[60:63]
    v_mfma_f32_16x16x32_bf16 v[60:63], v[80:83], v[108:111], v[60:63]
    ds_read_b128 a[252:255], v19 offset:30720
    v_add_u32 v150, 65536, v150
    v_mfma_f32_16x16x32_bf16 v[60:63], v[76:79], v[112:115], v[60:63]
    ds_read2_b32 a[220:221], v7 offset0:176 offset1:177
    v_mfma_f32_16x16x32_bf16 v[60:63], v[72:75], v[116:119], v[60:63]
    ds_write_b32 v150, v148
    v_mfma_f32_16x16x32_bf16 v[60:63], v[68:71], v[120:123], v[60:63]
    ds_read2_b32 a[222:223], v7 offset0:178 offset1:179
    v_mfma_f32_16x16x32_bf16 v[60:63], v[64:67], v[124:127], v[60:63]
    s_waitcnt vmcnt(13) lgkmcnt(13)
    s_barrier
    v_mfma_f32_16x16x32_bf16 v[32:35], a[192:195], a[224:227], v[32:35]
    ds_read_b128 v[96:99], v16 offset:0
    v_mfma_f32_16x16x32_bf16 v[36:39], a[196:199], a[224:227], v[36:39]
    s_add_u32 s8, s30, 0
    v_mfma_f32_16x16x32_bf16 v[36:39], a[192:195], a[228:231], v[36:39]
    ds_read2_b32 v[64:65], v4 offset0:64 offset1:65
    v_mfma_f32_16x16x32_bf16 v[40:43], a[192:195], a[232:235], v[40:43]
    s_and_b32 s9, s8, 3
    ds_read2_b32 v[66:67], v4 offset0:66 offset1:67
    v_mfma_f32_16x16x32_bf16 v[40:43], a[196:199], a[228:231], v[40:43]
    ds_read_b64_tr_b16 a[32:33], v12 offset:32768
    v_mfma_f32_16x16x32_bf16 v[40:43], a[200:203], a[224:227], v[40:43]
    ds_read_b128 v[100:103], v16 offset:4096
    v_mfma_f32_16x16x32_bf16 v[44:47], a[204:207], a[224:227], v[44:47]
    s_lshr_b32 s8, s8, 2
    ds_read2_b32 v[68:69], v4 offset0:192 offset1:193
    v_mfma_f32_16x16x32_bf16 v[44:47], a[200:203], a[228:231], v[44:47]
    ds_read_b64_tr_b16 a[34:35], v12 offset:33792
    v_mfma_f32_16x16x32_bf16 v[44:47], a[196:199], a[232:235], v[44:47]
    s_lshl_b32 s8, s8, 7
    ds_read2_b32 v[70:71], v4 offset0:194 offset1:195
    v_mfma_f32_16x16x32_bf16 v[44:47], a[192:195], a[236:239], v[44:47]
    s_waitcnt lgkmcnt(8)
    ds_read_b128 v[104:107], v16 offset:8192
    v_mfma_f32_16x16x32_bf16 v[48:51], a[192:195], a[240:243], v[48:51]
    ds_read2_b32 v[72:73], v5 offset0:64 offset1:65
    v_mfma_f32_16x16x32_bf16 v[48:51], a[196:199], a[236:239], v[48:51]
    s_lshl2_add_u32 s8, s9, s8
    ds_read_b64_tr_b16 a[36:37], v13 offset:32768
    v_mfma_f32_16x16x32_bf16 v[48:51], a[200:203], a[232:235], v[48:51]
    ds_read2_b32 v[74:75], v5 offset0:66 offset1:67
    v_mfma_f32_16x16x32_bf16 v[48:51], a[204:207], a[228:231], v[48:51]
    s_add_u32 s8, s8, 9023488
    ds_read_b128 v[108:111], v16 offset:12288
    v_mfma_f32_16x16x32_bf16 v[48:51], a[208:211], a[224:227], v[48:51]
    ds_read_b64_tr_b16 a[38:39], v13 offset:33792
    v_mfma_f32_16x16x32_bf16 v[52:55], a[212:215], a[224:227], v[52:55]
    ds_read2_b32 v[76:77], v5 offset0:192 offset1:193
    v_mfma_f32_16x16x32_bf16 v[52:55], a[208:211], a[228:231], v[52:55]
    s_waitcnt vmcnt(10)
    ds_read2_b32 v[78:79], v5 offset0:194 offset1:195
    v_mfma_f32_16x16x32_bf16 v[52:55], a[204:207], a[232:235], v[52:55]
    buffer_store_dword v24, v23, s[44:47], s8 offen sc1
    v_mfma_f32_16x16x32_bf16 v[52:55], a[200:203], a[236:239], v[52:55]
    ds_read_b128 v[112:115], v16 offset:16384
    v_mfma_f32_16x16x32_bf16 v[52:55], a[196:199], a[240:243], v[52:55]
    ds_read2_b32 v[80:81], v6 offset0:64 offset1:65
    v_mfma_f32_16x16x32_bf16 v[52:55], a[192:195], a[244:247], v[52:55]
    ds_read_b64_tr_b16 a[40:41], v12 offset:40960
    v_mfma_f32_16x16x32_bf16 v[56:59], a[192:195], a[248:251], v[56:59]
    ds_read2_b32 v[82:83], v6 offset0:66 offset1:67
    v_mfma_f32_16x16x32_bf16 v[56:59], a[196:199], a[244:247], v[56:59]
    ds_read_b128 v[116:119], v16 offset:20480
    v_mfma_f32_16x16x32_bf16 v[56:59], a[200:203], a[240:243], v[56:59]
    ds_read_b64_tr_b16 a[42:43], v12 offset:41984
    v_mfma_f32_16x16x32_bf16 v[56:59], a[204:207], a[236:239], v[56:59]
    ds_read2_b32 v[84:85], v6 offset0:192 offset1:193
    v_mfma_f32_16x16x32_bf16 v[56:59], a[208:211], a[232:235], v[56:59]
    ds_read2_b32 v[86:87], v6 offset0:194 offset1:195
    v_mfma_f32_16x16x32_bf16 v[56:59], a[212:215], a[228:231], v[56:59]
    ds_read_b128 v[120:123], v16 offset:24576
    v_mfma_f32_16x16x32_bf16 v[56:59], a[216:219], a[224:227], v[56:59]
    ds_read_b64_tr_b16 a[44:45], v13 offset:40960
    v_mfma_f32_16x16x32_bf16 v[60:63], a[220:223], a[224:227], v[60:63]
    ds_read2_b32 v[88:89], v7 offset0:64 offset1:65
    v_mfma_f32_16x16x32_bf16 v[60:63], a[216:219], a[228:231], v[60:63]
    ds_read2_b32 v[90:91], v7 offset0:66 offset1:67
    v_mfma_f32_16x16x32_bf16 v[60:63], a[212:215], a[232:235], v[60:63]
    ds_read_b64_tr_b16 a[46:47], v13 offset:41984
    v_mfma_f32_16x16x32_bf16 v[60:63], a[208:211], a[236:239], v[60:63]
    ds_read_b128 v[124:127], v16 offset:28672
    v_mfma_f32_16x16x32_bf16 v[60:63], a[204:207], a[240:243], v[60:63]
    ds_read2_b32 v[92:93], v7 offset0:192 offset1:193
    v_mfma_f32_16x16x32_bf16 v[60:63], a[200:203], a[244:247], v[60:63]
    v_mfma_f32_16x16x32_bf16 v[60:63], a[196:199], a[248:251], v[60:63]
    ds_read2_b32 v[94:95], v7 offset0:194 offset1:195
    v_mfma_f32_16x16x32_bf16 v[60:63], a[192:195], a[252:255], v[60:63]
    s_waitcnt vmcnt(7) lgkmcnt(3)
    s_barrier
    v_mfma_f32_16x16x32_bf16 v[32:35], v[64:67], v[96:99], v[32:35]
    ds_read_b128 a[224:227], v17 offset:0
    v_mfma_f32_16x16x32_bf16 v[36:39], v[68:71], v[96:99], v[36:39]
    v_mfma_f32_16x16x32_bf16 v[36:39], v[64:67], v[100:103], v[36:39]
    ds_read2_b32 a[192:193], v4 offset0:80 offset1:81
    v_mfma_f32_16x16x32_bf16 v[40:43], v[64:67], v[104:107], v[40:43]
    ds_read2_b32 a[194:195], v4 offset0:82 offset1:83
    v_mfma_f32_16x16x32_bf16 v[40:43], v[68:71], v[100:103], v[40:43]
    ds_read_b64_tr_b16 a[48:49], v12 offset:0
    v_mfma_f32_16x16x32_bf16 v[40:43], v[72:75], v[96:99], v[40:43]
    ds_read_b128 a[228:231], v17 offset:4096
    v_mfma_f32_16x16x32_bf16 v[44:47], v[76:79], v[96:99], v[44:47]
    ds_read2_b32 a[196:197], v4 offset0:208 offset1:209
    v_mfma_f32_16x16x32_bf16 v[44:47], v[72:75], v[100:103], v[44:47]
    ds_read_b64_tr_b16 a[50:51], v12 offset:1024
    v_mfma_f32_16x16x32_bf16 v[44:47], v[68:71], v[104:107], v[44:47]
    ds_read2_b32 a[198:199], v4 offset0:210 offset1:211
    v_mfma_f32_16x16x32_bf16 v[44:47], v[64:67], v[108:111], v[44:47]
    s_waitcnt lgkmcnt(8)
    ds_read_b128 a[232:235], v17 offset:8192
    v_mfma_f32_16x16x32_bf16 v[48:51], v[64:67], v[112:115], v[48:51]
    ds_read2_b32 a[200:201], v5 offset0:80 offset1:81
    v_mfma_f32_16x16x32_bf16 v[48:51], v[68:71], v[108:111], v[48:51]
    ds_read_b64_tr_b16 a[52:53], v13 offset:0
    v_mfma_f32_16x16x32_bf16 v[48:51], v[72:75], v[104:107], v[48:51]
    ds_read2_b32 a[202:203], v5 offset0:82 offset1:83
    v_mfma_f32_16x16x32_bf16 v[48:51], v[76:79], v[100:103], v[48:51]
    ds_read_b128 a[236:239], v17 offset:12288
    v_mfma_f32_16x16x32_bf16 v[48:51], v[80:83], v[96:99], v[48:51]
    ds_read_b64_tr_b16 a[54:55], v13 offset:1024
    v_mfma_f32_16x16x32_bf16 v[52:55], v[84:87], v[96:99], v[52:55]
    ds_read2_b32 a[204:205], v5 offset0:208 offset1:209
    v_mfma_f32_16x16x32_bf16 v[52:55], v[80:83], v[100:103], v[52:55]
    ds_read2_b32 a[206:207], v5 offset0:210 offset1:211
    v_mfma_f32_16x16x32_bf16 v[52:55], v[76:79], v[104:107], v[52:55]
    v_mfma_f32_16x16x32_bf16 v[52:55], v[72:75], v[108:111], v[52:55]
    ds_read_b128 a[240:243], v17 offset:16384
    v_mfma_f32_16x16x32_bf16 v[52:55], v[68:71], v[112:115], v[52:55]
    ds_read2_b32 a[208:209], v6 offset0:80 offset1:81
    v_mfma_f32_16x16x32_bf16 v[52:55], v[64:67], v[116:119], v[52:55]
    ds_read_b64_tr_b16 a[56:57], v12 offset:8192
    v_mfma_f32_16x16x32_bf16 v[56:59], v[64:67], v[120:123], v[56:59]
    ds_read2_b32 a[210:211], v6 offset0:82 offset1:83
    v_mfma_f32_16x16x32_bf16 v[56:59], v[68:71], v[116:119], v[56:59]
    ds_read_b128 a[244:247], v17 offset:20480
    v_mfma_f32_16x16x32_bf16 v[56:59], v[72:75], v[112:115], v[56:59]
    ds_read_b64_tr_b16 a[58:59], v12 offset:9216
    v_mfma_f32_16x16x32_bf16 v[56:59], v[76:79], v[108:111], v[56:59]
    ds_read2_b32 a[212:213], v6 offset0:208 offset1:209
    v_mfma_f32_16x16x32_bf16 v[56:59], v[80:83], v[104:107], v[56:59]
    ds_read2_b32 a[214:215], v6 offset0:210 offset1:211
    v_mfma_f32_16x16x32_bf16 v[56:59], v[84:87], v[100:103], v[56:59]
    ds_read_b128 a[248:251], v17 offset:24576
    v_mfma_f32_16x16x32_bf16 v[56:59], v[88:91], v[96:99], v[56:59]
    ds_read_b64_tr_b16 a[60:61], v13 offset:8192
    v_mfma_f32_16x16x32_bf16 v[60:63], v[92:95], v[96:99], v[60:63]
    ds_read2_b32 a[216:217], v7 offset0:80 offset1:81
    v_mfma_f32_16x16x32_bf16 v[60:63], v[88:91], v[100:103], v[60:63]
    ds_read2_b32 a[218:219], v7 offset0:82 offset1:83
    v_mfma_f32_16x16x32_bf16 v[60:63], v[84:87], v[104:107], v[60:63]
    ds_read_b64_tr_b16 a[62:63], v13 offset:9216
    v_mfma_f32_16x16x32_bf16 v[60:63], v[80:83], v[108:111], v[60:63]
    ds_read_b128 a[252:255], v17 offset:28672
    v_mfma_f32_16x16x32_bf16 v[60:63], v[76:79], v[112:115], v[60:63]
    ds_read2_b32 a[220:221], v7 offset0:208 offset1:209
    v_mfma_f32_16x16x32_bf16 v[60:63], v[72:75], v[116:119], v[60:63]
    v_mfma_f32_16x16x32_bf16 v[60:63], v[68:71], v[120:123], v[60:63]
    ds_read2_b32 a[222:223], v7 offset0:210 offset1:211
    v_mfma_f32_16x16x32_bf16 v[60:63], v[64:67], v[124:127], v[60:63]
    s_waitcnt vmcnt(1) lgkmcnt(3)
    s_barrier
    v_mfma_f32_16x16x32_bf16 v[32:35], a[192:195], a[224:227], v[32:35]
    ds_read_b128 v[96:99], v18 offset:0
    v_mfma_f32_16x16x32_bf16 v[36:39], a[196:199], a[224:227], v[36:39]
    s_add_u32 s18, s10, 65568
    v_mfma_f32_16x16x32_bf16 v[36:39], a[192:195], a[228:231], v[36:39]
    ds_read2_b32 v[64:65], v4 offset0:96 offset1:97
    v_mfma_f32_16x16x32_bf16 v[40:43], a[192:195], a[232:235], v[40:43]
    ds_read2_b32 v[66:67], v4 offset0:98 offset1:99
    v_add_u32 v128, s18, v21
    v_mfma_f32_16x16x32_bf16 v[40:43], a[196:199], a[228:231], v[40:43]
    ds_read_b64_tr_b16 a[64:65], v12 offset:16384
    ds_read_b128 v[130:133], v128
    v_mfma_f32_16x16x32_bf16 v[40:43], a[200:203], a[224:227], v[40:43]
    ds_read_b128 v[100:103], v18 offset:4096
    v_mfma_f32_16x16x32_bf16 v[44:47], a[204:207], a[224:227], v[44:47]
    ds_read2_b32 v[68:69], v4 offset0:224 offset1:225
    ds_read_b32 v134, v128 offset:16
    v_mfma_f32_16x16x32_bf16 v[44:47], a[200:203], a[228:231], v[44:47]
    ds_read_b64_tr_b16 a[66:67], v12 offset:17408
    v_mfma_f32_16x16x32_bf16 v[44:47], a[196:199], a[232:235], v[44:47]
    ds_read2_b32 v[70:71], v4 offset0:226 offset1:227
    v_lshrrev_b32 v129, 30, v25
    v_mfma_f32_16x16x32_bf16 v[44:47], a[192:195], a[236:239], v[44:47]
    s_waitcnt lgkmcnt(10)
    ds_read_b128 v[104:107], v18 offset:8192
    v_mul_u32_u24 v129, 28, v129
    v_mfma_f32_16x16x32_bf16 v[48:51], a[192:195], a[240:243], v[48:51]
    ds_read2_b32 v[72:73], v5 offset0:96 offset1:97
    v_mfma_f32_16x16x32_bf16 v[48:51], a[196:199], a[236:239], v[48:51]
    ds_read_b64_tr_b16 a[68:69], v13 offset:16384
    v_sub_u32 v129, 65568, v129
    v_mfma_f32_16x16x32_bf16 v[48:51], a[200:203], a[232:235], v[48:51]
    ds_read2_b32 v[74:75], v5 offset0:98 offset1:99
    v_mfma_f32_16x16x32_bf16 v[48:51], a[204:207], a[228:231], v[48:51]
    ds_read_b128 v[108:111], v18 offset:12288
    v_mfma_f32_16x16x32_bf16 v[48:51], a[208:211], a[224:227], v[48:51]
    ds_read_b64_tr_b16 a[70:71], v13 offset:17408
    v_lshlrev_b32 v30, 16, v30
    v_mfma_f32_16x16x32_bf16 v[52:55], a[212:215], a[224:227], v[52:55]
    s_waitcnt lgkmcnt(8)
    ds_read2_b32 v[76:77], v5 offset0:224 offset1:225
    v_mfma_f32_16x16x32_bf16 v[52:55], a[208:211], a[228:231], v[52:55]
    ds_read2_b32 v[78:79], v5 offset0:226 offset1:227
    v_mfma_f32_16x16x32_bf16 v[52:55], a[204:207], a[232:235], v[52:55]
    v_lshlrev_b32 v135, 16, v130
    v_mfma_f32_16x16x32_bf16 v[52:55], a[200:203], a[236:239], v[52:55]
    ds_read_b128 v[112:115], v18 offset:16384
    v_mfma_f32_16x16x32_bf16 v[52:55], a[196:199], a[240:243], v[52:55]
    ds_read2_b32 v[80:81], v6 offset0:96 offset1:97
    v_add_f32 v135, v135, v30
    v_mfma_f32_16x16x32_bf16 v[52:55], a[192:195], a[244:247], v[52:55]
    ds_read_b64_tr_b16 a[72:73], v12 offset:24576
    v_alignbit_b32 v130, v131, v130, 16
    v_mfma_f32_16x16x32_bf16 v[56:59], a[192:195], a[248:251], v[56:59]
    ds_read2_b32 v[82:83], v6 offset0:98 offset1:99
    v_mfma_f32_16x16x32_bf16 v[56:59], a[196:199], a[244:247], v[56:59]
    ds_read_b128 v[116:119], v18 offset:20480
    v_alignbit_b32 v131, v132, v131, 16
    v_mfma_f32_16x16x32_bf16 v[56:59], a[200:203], a[240:243], v[56:59]
    ds_read_b64_tr_b16 a[74:75], v12 offset:25600
    v_alignbit_b32 v132, v133, v132, 16
    v_mfma_f32_16x16x32_bf16 v[56:59], a[204:207], a[236:239], v[56:59]
    ds_read2_b32 v[84:85], v6 offset0:224 offset1:225
    v_mfma_f32_16x16x32_bf16 v[56:59], a[208:211], a[232:235], v[56:59]
    ds_read2_b32 v[86:87], v6 offset0:226 offset1:227
    v_alignbit_b32 v133, v134, v133, 16
    v_mfma_f32_16x16x32_bf16 v[56:59], a[212:215], a[228:231], v[56:59]
    ds_read_b128 v[120:123], v18 offset:24576
    v_cvt_pk_bf16_f32 v135, v135, v135
    v_mfma_f32_16x16x32_bf16 v[56:59], a[216:219], a[224:227], v[56:59]
    ds_read_b64_tr_b16 a[76:77], v13 offset:24576
    v_mfma_f32_16x16x32_bf16 v[60:63], a[220:223], a[224:227], v[60:63]
    ds_read2_b32 v[88:89], v7 offset0:96 offset1:97
    ds_write_b128 v128, v[130:133] offset:8736
    v_mfma_f32_16x16x32_bf16 v[60:63], a[216:219], a[228:231], v[60:63]
    ds_read2_b32 v[90:91], v7 offset0:98 offset1:99
    v_mfma_f32_16x16x32_bf16 v[60:63], a[212:215], a[232:235], v[60:63]
    ds_read_b64_tr_b16 a[78:79], v13 offset:25600
    v_cmp_eq_u32 vcc, 0, v25
    s_nop 1
    v_cndmask_b32 v135, 0, v135, vcc
    v_mfma_f32_16x16x32_bf16 v[60:63], a[208:211], a[236:239], v[60:63]
    ds_read_b128 v[124:127], v18 offset:28672
    ds_write_b16 v129, v135
    v_mfma_f32_16x16x32_bf16 v[60:63], a[204:207], a[240:243], v[60:63]
    ds_read2_b32 v[92:93], v7 offset0:224 offset1:225
L_pl_X_5:
    s_cbranch_execz L_wret
    v_mfma_f32_16x16x32_bf16 v[60:63], a[200:203], a[244:247], v[60:63]
    ds_write_b16 v129, v135 offset:8734
    v_mfma_f32_16x16x32_bf16 v[60:63], a[196:199], a[248:251], v[60:63]
    ds_read2_b32 v[94:95], v7 offset0:226 offset1:227
    v_mfma_f32_16x16x32_bf16 v[60:63], a[192:195], a[252:255], v[60:63]
    s_waitcnt lgkmcnt(1)
    s_barrier
    v_mfma_f32_16x16x32_bf16 v[32:35], v[64:67], v[96:99], v[32:35]
    ds_read_b128 a[224:227], v19 offset:0
    v_mov_b32 v1, s34
    v_mfma_f32_16x16x32_bf16 v[36:39], v[68:71], v[96:99], v[36:39]
    s_add_u32 s4, s19, 3
    ds_read_b128 a[228:231], v19 offset:4096
    v_add_u32 v31, s4, v0
    v_mfma_f32_16x16x32_bf16 v[36:39], v[64:67], v[100:103], v[36:39]
    v_cmp_eq_u32 vcc, 0, v0
    s_nop 1
    v_cndmask_b32 v1, v31, v1, vcc
    v_and_b32 v31, 3, v1
    v_mfma_f32_16x16x32_bf16 v[40:43], v[64:67], v[104:107], v[40:43]
    ds_read_b128 a[232:235], v19 offset:8192
    v_lshrrev_b32 v1, 2, v1
    v_mfma_f32_16x16x32_bf16 v[40:43], v[68:71], v[100:103], v[40:43]
    ds_read_b128 a[236:239], v19 offset:12288
    v_lshlrev_b32 v1, 7, v1
    v_mfma_f32_16x16x32_bf16 v[40:43], v[72:75], v[96:99], v[40:43]
    ds_read_b128 a[240:243], v19 offset:16384
    v_lshl_add_u32 v1, v31, 2, v1
    v_mfma_f32_16x16x32_bf16 v[44:47], v[76:79], v[96:99], v[44:47]
    ds_read_b128 a[244:247], v19 offset:20480
    v_add_u32 v1, 9023488, v1
    v_mfma_f32_16x16x32_bf16 v[44:47], v[72:75], v[100:103], v[44:47]
    ds_read_b128 a[248:251], v19 offset:24576
    v_mov_b32 v31, 0x40000000
    v_mfma_f32_16x16x32_bf16 v[44:47], v[68:71], v[104:107], v[44:47]
    v_cmp_gt_u32 vcc, 5, v0
    s_nop 1
    v_cndmask_b32 v29, v31, v1, vcc
    v_mfma_f32_16x16x32_bf16 v[44:47], v[64:67], v[108:111], v[44:47]
    s_waitcnt lgkmcnt(7)
    s_mul_i32 s4, s16, 0x9e3779b1
    ds_read_b128 a[252:255], v19 offset:28672
    s_lshr_b32 s5, s4, 15
    v_mfma_f32_16x16x32_bf16 v[48:51], v[64:67], v[112:115], v[48:51]
    s_xor_b32 s4, s4, s5
    ds_read2_b32 a[192:193], v4 offset0:112 offset1:113
    s_mul_i32 s4, s4, 0x85ebca77
    v_mfma_f32_16x16x32_bf16 v[48:51], v[68:71], v[108:111], v[48:51]
    s_lshr_b32 s5, s4, 13
    ds_read2_b32 a[194:195], v4 offset0:114 offset1:115
    s_xor_b32 s4, s4, s5
    v_mfma_f32_16x16x32_bf16 v[48:51], v[72:75], v[104:107], v[48:51]
    s_mov_b32 s33, 0x10001
    ds_read2_b32 a[196:197], v4 offset0:240 offset1:241
    v_and_b32 v1, 3, v2
    v_lshlrev_b32 v1, 3, v1
    v_mfma_f32_16x16x32_bf16 v[48:51], v[76:79], v[100:103], v[48:51]
    ds_read2_b32 a[198:199], v4 offset0:242 offset1:243
    v_lshrrev_b32 v1, v1, s4
    v_bfe_u32 v31, v1, 1, 1
    v_mfma_f32_16x16x32_bf16 v[48:51], v[80:83], v[96:99], v[48:51]
    v_bfe_u32 v253, v1, 0, 1
    v_lshl_or_b32 v253, v31, 16, v253
    v_mfma_f32_16x16x32_bf16 v[52:55], v[84:87], v[96:99], v[52:55]
    ds_read2_b32 a[200:201], v5 offset0:112 offset1:113
    v_bfe_u32 v31, v1, 3, 1
    v_mfma_f32_16x16x32_bf16 v[52:55], v[80:83], v[100:103], v[52:55]
    ds_read2_b32 a[202:203], v5 offset0:114 offset1:115
    v_bfe_u32 v255, v1, 2, 1
    v_lshl_or_b32 v255, v31, 16, v255
    v_mfma_f32_16x16x32_bf16 v[52:55], v[76:79], v[104:107], v[52:55]
    ds_read2_b32 a[204:205], v5 offset0:240 offset1:241
    v_bfe_u32 v31, v1, 5, 1
    v_mfma_f32_16x16x32_bf16 v[52:55], v[72:75], v[108:111], v[52:55]
    ds_read2_b32 a[206:207], v5 offset0:242 offset1:243
    v_bfe_u32 v23, v1, 4, 1
    v_mfma_f32_16x16x32_bf16 v[52:55], v[68:71], v[112:115], v[52:55]
    ds_read2_b32 a[208:209], v6 offset0:112 offset1:113
    v_lshl_or_b32 v23, v31, 16, v23
    v_mfma_f32_16x16x32_bf16 v[52:55], v[64:67], v[116:119], v[52:55]
    v_bfe_u32 v31, v1, 7, 1
    v_bfe_u32 v0, v1, 6, 1
    v_mfma_f32_16x16x32_bf16 v[56:59], v[64:67], v[120:123], v[56:59]
    ds_read2_b32 a[210:211], v6 offset0:114 offset1:115
    v_lshl_or_b32 v0, v31, 16, v0
    v_mfma_f32_16x16x32_bf16 v[56:59], v[68:71], v[116:119], v[56:59]
    ds_read2_b32 a[212:213], v6 offset0:240 offset1:241
    v_and_b32 v1, 15, v2
    v_mfma_f32_16x16x32_bf16 v[56:59], v[72:75], v[112:115], v[56:59]
    ds_read2_b32 a[214:215], v6 offset0:242 offset1:243
    v_lshrrev_b32 v31, 4, v2
    v_mfma_f32_16x16x32_bf16 v[56:59], v[76:79], v[108:111], v[56:59]
    ds_read2_b32 a[216:217], v7 offset0:112 offset1:113
    v_lshlrev_b32 v31, 2, v31
    v_mfma_f32_16x16x32_bf16 v[56:59], v[80:83], v[104:107], v[56:59]
    ds_read2_b32 a[218:219], v7 offset0:114 offset1:115
    v_sub_u32 v1, v1, v31
    v_mfma_f32_16x16x32_bf16 v[56:59], v[84:87], v[100:103], v[56:59]
    v_and_b32 v31, 1, v1
    v_lshlrev_b32 v31, 4, v31
    v_mfma_f32_16x16x32_bf16 v[56:59], v[88:91], v[96:99], v[56:59]
    s_movk_i32 s4, 0x3f80
    ds_read2_b32 a[220:221], v7 offset0:240 offset1:241
    v_lshlrev_b32 v31, v31, s4
    v_ashrrev_i32 v1, 1, v1
    v_mfma_f32_16x16x32_bf16 v[60:63], v[92:95], v[96:99], v[60:63]
    ds_read2_b32 a[222:223], v7 offset0:242 offset1:243
    v_cmp_eq_u32 vcc, 0, v1
    s_nop 1
    v_cndmask_b32 v148, 0, v31, vcc
    v_mfma_f32_16x16x32_bf16 v[60:63], v[88:91], v[100:103], v[60:63]
    v_cmp_eq_u32 vcc, 1, v1
    s_nop 1
    v_cndmask_b32 v149, 0, v31, vcc
    v_mfma_f32_16x16x32_bf16 v[60:63], v[84:87], v[104:107], v[60:63]
    v_mov_b32 v146, 0
    v_mov_b32 v147, 0
    v_mfma_f32_16x16x32_bf16 v[60:63], v[80:83], v[108:111], v[60:63]
    v_mov_b32 v150, 0
    v_mov_b32 v151, 0
    v_mfma_f32_16x16x32_bf16 v[60:63], v[76:79], v[112:115], v[60:63]
    v_and_b32 v1, 15, v2
    v_lshrrev_b32 v31, 4, v2
    v_mfma_f32_16x16x32_bf16 v[60:63], v[72:75], v[116:119], v[60:63]
    v_lshlrev_b32 v3, 1, v1
    v_sub_u32 v3, v3, v31
    v_mfma_f32_16x16x32_bf16 v[60:63], v[68:71], v[120:123], v[60:63]
    s_lshl_b32 s4, s3, 7
    s_sub_u32 s4, 70128, s4
    v_lshl_add_u32 v30, v3, 4, s4
    v_mfma_f32_16x16x32_bf16 v[60:63], v[64:67], v[124:127], v[60:63]
    s_waitcnt lgkmcnt(0)
    s_barrier
    v_mfma_f32_16x16x32_bf16 v[60:63], a[220:223], a[224:227], v[60:63]
    v_and_b32 v1, 15, v2
    v_mfma_f32_16x16x32_bf16 v[60:63], a[216:219], a[228:231], v[60:63]
    v_add_u32 v1, 1, v1
    v_mfma_f32_16x16x32_bf16 v[60:63], a[212:215], a[232:235], v[60:63]
    v_and_b32 v3, 1, v1
    v_mfma_f32_16x16x32_bf16 v[60:63], a[208:211], a[236:239], v[60:63]
    v_mul_u32_u24 v3, 8736, v3
    v_lshrrev_b32 v1, 1, v1
    v_mfma_f32_16x16x32_bf16 v[60:63], a[204:207], a[240:243], v[60:63]
    v_lshl_add_u32 v3, v1, 2, v3
    v_mfma_f32_16x16x32_bf16 v[60:63], a[200:203], a[244:247], v[60:63]
    v_lshrrev_b32 v1, 4, v2
    v_lshl_add_u32 v3, v1, 4, v3
    v_mfma_f32_16x16x32_bf16 v[60:63], a[196:199], a[248:251], v[60:63]
    s_lshl_b32 s4, s3, 7
    s_add_u32 s4, s4, 65536
    v_add_u32 v4, s4, v3
    v_mfma_f32_16x16x32_bf16 v[60:63], a[192:195], a[252:255], v[60:63]
    v_add_u32 v5, 1024, v4
    v_add_u32 v6, 1024, v5
    v_mfma_f32_16x16x32_bf16 v[56:59], a[192:195], a[248:251], v[56:59]
    v_add_u32 v7, 1024, v6
    v_add_u32 v16, 90112, v21
    v_mfma_f32_16x16x32_bf16 v[56:59], a[196:199], a[244:247], v[56:59]
    v_add_u32 v17, 126976, v21
    v_subrev_u32 v12, 114688, v12
    v_mfma_f32_16x16x32_bf16 v[56:59], a[200:203], a[240:243], v[56:59]
    v_subrev_u32 v13, 114688, v13
    ds_read_b128 a[128:131], v30 offset:64
    v_mfma_f32_16x16x32_bf16 v[56:59], a[204:207], a[236:239], v[56:59]
    ds_read_b128 a[132:135], v30 offset:576
    v_mfma_f32_16x16x32_bf16 v[56:59], a[208:211], a[232:235], v[56:59]
    ds_read_b128 a[136:139], v30 offset:1088
    v_mfma_f32_16x16x32_bf16 v[56:59], a[212:215], a[228:231], v[56:59]
    ds_read_b128 a[140:143], v30 offset:1600
    v_mfma_f32_16x16x32_bf16 v[56:59], a[216:219], a[224:227], v[56:59]
    ds_read_b128 a[144:147], v30 offset:2112
    v_mfma_f32_16x16x32_bf16 v[52:55], a[212:215], a[224:227], v[52:55]
    ds_read_b128 a[148:151], v30 offset:2624
    v_mfma_f32_16x16x32_bf16 v[52:55], a[208:211], a[228:231], v[52:55]
    ds_read_b128 a[152:155], v30 offset:3136
    v_mfma_f32_16x16x32_bf16 v[52:55], a[204:207], a[232:235], v[52:55]
    v_cvt_pk_bf16_f32 v142, v60, v61
    ds_read_b128 a[156:159], v30 offset:3648
    v_mfma_f32_16x16x32_bf16 v[52:55], a[200:203], a[236:239], v[52:55]
    ds_read2_b32 a[160:161], v4 offset0:0 offset1:1
    v_mfma_f32_16x16x32_bf16 v[52:55], a[196:199], a[240:243], v[52:55]
    v_cvt_pk_bf16_f32 v143, v62, v63
    ds_read2_b32 a[162:163], v4 offset0:2 offset1:3
    v_mfma_f32_16x16x32_bf16 v[52:55], a[192:195], a[244:247], v[52:55]
    ds_read2_b32 a[164:165], v4 offset0:128 offset1:129
    v_mfma_f32_16x16x32_bf16 v[48:51], a[192:195], a[240:243], v[48:51]
    buffer_store_dwordx2 v[142:143], v20, s[44:47], s15 offen offset:3584 sc1
    v_mfma_f32_16x16x32_bf16 v[48:51], a[196:199], a[236:239], v[48:51]
    ds_read2_b32 a[166:167], v4 offset0:130 offset1:131
    v_mfma_f32_16x16x32_bf16 v[48:51], a[200:203], a[232:235], v[48:51]
    v_cvt_pk_bf16_f32 v140, v56, v57
    ds_read2_b32 a[168:169], v5 offset0:0 offset1:1
    v_mfma_f32_16x16x32_bf16 v[48:51], a[204:207], a[228:231], v[48:51]
    ds_read2_b32 a[170:171], v5 offset0:2 offset1:3
    v_mfma_f32_16x16x32_bf16 v[48:51], a[208:211], a[224:227], v[48:51]
    v_cvt_pk_bf16_f32 v141, v58, v59
    ds_read2_b32 a[172:173], v5 offset0:128 offset1:129
    v_mfma_f32_16x16x32_bf16 v[44:47], a[204:207], a[224:227], v[44:47]
    ds_read2_b32 a[174:175], v5 offset0:130 offset1:131
    v_mfma_f32_16x16x32_bf16 v[44:47], a[200:203], a[228:231], v[44:47]
    buffer_store_dwordx2 v[140:141], v20, s[44:47], s15 offen offset:3072 sc1
    v_mfma_f32_16x16x32_bf16 v[44:47], a[196:199], a[232:235], v[44:47]
    ds_read2_b32 a[176:177], v6 offset0:0 offset1:1
    v_mfma_f32_16x16x32_bf16 v[44:47], a[192:195], a[236:239], v[44:47]
    ds_read2_b32 a[178:179], v6 offset0:2 offset1:3
    v_mfma_f32_16x16x32_bf16 v[40:43], a[192:195], a[232:235], v[40:43]
    v_cvt_pk_bf16_f32 v138, v52, v53
    ds_read2_b32 a[180:181], v6 offset0:128 offset1:129
    v_mfma_f32_16x16x32_bf16 v[40:43], a[196:199], a[228:231], v[40:43]
    ds_read2_b32 a[182:183], v6 offset0:130 offset1:131
    v_mfma_f32_16x16x32_bf16 v[40:43], a[200:203], a[224:227], v[40:43]
    v_cvt_pk_bf16_f32 v139, v54, v55
    ds_read2_b32 a[184:185], v7 offset0:0 offset1:1
    v_mfma_f32_16x16x32_bf16 v[36:39], a[196:199], a[224:227], v[36:39]
    ds_read2_b32 a[186:187], v7 offset0:2 offset1:3
    v_mfma_f32_16x16x32_bf16 v[36:39], a[192:195], a[228:231], v[36:39]
    buffer_store_dwordx2 v[138:139], v20, s[44:47], s15 offen offset:2560 sc1
    ds_read2_b32 a[188:189], v7 offset0:128 offset1:129
    v_mfma_f32_16x16x32_bf16 v[32:35], a[192:195], a[224:227], v[32:35]
    ds_read2_b32 a[190:191], v7 offset0:130 offset1:131
    v_cvt_pk_bf16_f32 v136, v48, v49
    v_cvt_pk_bf16_f32 v137, v50, v51
    buffer_store_dwordx2 v[136:137], v20, s[44:47], s15 offen offset:2048 sc1
    v_cvt_pk_bf16_f32 v134, v44, v45
    v_cvt_pk_bf16_f32 v135, v46, v47
    buffer_store_dwordx2 v[134:135], v20, s[44:47], s15 offen offset:1536 sc1
    v_cvt_pk_bf16_f32 v132, v40, v41
    v_cvt_pk_bf16_f32 v133, v42, v43
    buffer_store_dwordx2 v[132:133], v20, s[44:47], s15 offen offset:1024 sc1
    v_cvt_pk_bf16_f32 v130, v36, v37
    v_cvt_pk_bf16_f32 v131, v38, v39
    buffer_store_dwordx2 v[130:131], v20, s[44:47], s15 offen offset:512 sc1
    v_cvt_pk_bf16_f32 v128, v32, v33
    v_cvt_pk_bf16_f32 v129, v34, v35
    buffer_store_dwordx2 v[128:129], v20, s[44:47], s15 offen offset:0 sc1
    s_add_u32 m0, s20, 0
    s_lshl_b32 s14, s95, 1
    buffer_load_dwordx4 v8, s[52:55], s14 offen offset:0 lds
    buffer_load_dwordx4 v9, s[52:55], s14 offen offset:1024 lds
    buffer_load_dwordx4 v10, s[52:55], s14 offen offset:2048 lds
    buffer_load_dwordx4 v11, s[52:55], s14 offen offset:3072 lds
    s_add_u32 m0, s20, 16384
    s_lshl_b32 s14, s96, 1
    buffer_load_dwordx4 v8, s[52:55], s14 offen offset:0 lds
    buffer_load_dwordx4 v9, s[52:55], s14 offen offset:1024 lds
    buffer_load_dwordx4 v10, s[52:55], s14 offen offset:2048 lds
    buffer_load_dwordx4 v11, s[52:55], s14 offen offset:3072 lds
    s_add_u32 m0, s20, 32768
    s_lshl_b32 s14, s97, 1
    buffer_load_dwordx4 v8, s[52:55], s14 offen offset:0 lds
    buffer_load_dwordx4 v9, s[52:55], s14 offen offset:1024 lds
    buffer_load_dwordx4 v10, s[52:55], s14 offen offset:2048 lds
    buffer_load_dwordx4 v11, s[52:55], s14 offen offset:3072 lds
    s_waitcnt vmcnt(0)
    s_barrier
    ds_read_b64_tr_b16 a[80:81], v12 offset:0
    ds_read_b64_tr_b16 a[82:83], v12 offset:1024
    ds_read_b64_tr_b16 a[84:85], v13 offset:0
    ds_read_b64_tr_b16 a[86:87], v13 offset:1024
    ds_read_b64_tr_b16 a[88:89], v12 offset:8192
    ds_read_b64_tr_b16 a[90:91], v12 offset:9216
    ds_read_b64_tr_b16 a[92:93], v13 offset:8192
    ds_read_b64_tr_b16 a[94:95], v13 offset:9216
    ds_read_b64_tr_b16 a[96:97], v12 offset:16384
    ds_read_b64_tr_b16 a[98:99], v12 offset:17408
    ds_read_b64_tr_b16 a[100:101], v13 offset:16384
    ds_read_b64_tr_b16 a[102:103], v13 offset:17408
    ds_read_b64_tr_b16 a[104:105], v12 offset:24576
    ds_read_b64_tr_b16 a[106:107], v12 offset:25600
    ds_read_b64_tr_b16 a[108:109], v13 offset:24576
    ds_read_b64_tr_b16 a[110:111], v13 offset:25600
    ds_read_b64_tr_b16 a[112:113], v12 offset:32768
    ds_read_b64_tr_b16 a[114:115], v12 offset:33792
    ds_read_b64_tr_b16 a[116:117], v13 offset:32768
    ds_read_b64_tr_b16 a[118:119], v13 offset:33792
    ds_read_b64_tr_b16 a[120:121], v12 offset:40960
    ds_read_b64_tr_b16 a[122:123], v12 offset:41984
    ds_read_b64_tr_b16 a[124:125], v13 offset:40960
    ds_read_b64_tr_b16 a[126:127], v13 offset:41984
    s_waitcnt lgkmcnt(0)
    s_barrier
    s_add_u32 m0, s20, 49152
    s_lshl_b32 s14, s98, 1
    buffer_load_dwordx4 v8, s[52:55], s14 offen offset:0 lds
    buffer_load_dwordx4 v9, s[52:55], s14 offen offset:1024 lds
    buffer_load_dwordx4 v10, s[52:55], s14 offen offset:2048 lds
    buffer_load_dwordx4 v11, s[52:55], s14 offen offset:3072 lds
    s_add_u32 m0, s20, 0
    s_lshl_b32 s14, s99, 1
    buffer_load_dwordx4 v8, s[52:55], s14 offen offset:0 lds
    buffer_load_dwordx4 v9, s[52:55], s14 offen offset:1024 lds
    buffer_load_dwordx4 v10, s[52:55], s14 offen offset:2048 lds
    buffer_load_dwordx4 v11, s[52:55], s14 offen offset:3072 lds
    s_add_u32 m0, s20, 16384
    s_lshl_b32 s14, s100, 1
    buffer_load_dwordx4 v8, s[52:55], s14 offen offset:0 lds
    buffer_load_dwordx4 v9, s[52:55], s14 offen offset:1024 lds
    buffer_load_dwordx4 v10, s[52:55], s14 offen offset:2048 lds
    buffer_load_dwordx4 v11, s[52:55], s14 offen offset:3072 lds
    s_mov_b32 s30, 0x40000000
    s_mov_b32 s32, 0x40000000
    s_mov_b32 s31, 0
    s_waitcnt lgkmcnt(0)
    s_branch L_D
L_end:
.section .rodata,"a"
.p2align 6
.amdhsa_kernel recurrent_scan__ssm_conv_h3__mixer_token_mlp__prompt_kernel
  .amdhsa_next_free_vgpr 512
  .amdhsa_next_free_sgpr 102
  .amdhsa_accum_offset 256
  .amdhsa_group_segment_fixed_size 0
  .amdhsa_kernarg_size 112
  .amdhsa_user_sgpr_count 2
  .amdhsa_user_sgpr_kernarg_segment_ptr 1
  .amdhsa_system_sgpr_workgroup_id_x 1
  .amdhsa_float_denorm_mode_32 3
.end_amdhsa_kernel
```

```asm
; @launch grid=(256,1,1) block=(256,1,1) lds=163840
.amdgcn_target "amdgcn-amd-amdhsa--gfx950"
.text
.globl recurrent_scan__ssm_conv_h3__mixer_token_mlp__prompt_kernel
.p2align 8
.type recurrent_scan__ssm_conv_h3__mixer_token_mlp__prompt_kernel,@function
recurrent_scan__ssm_conv_h3__mixer_token_mlp__prompt_kernel:
    s_cmp_lt_u32 s2, 256
    s_cbranch_scc0 L_exit
    s_load_dwordx2 s[56:57], s[0:1], 0
    s_load_dwordx2 s[48:49], s[0:1], 8
    s_load_dwordx2 s[52:53], s[0:1], 16
    s_load_dwordx2 s[60:61], s[0:1], 24
    s_load_dwordx4 s[24:27], s[0:1], 32
    s_load_dwordx2 s[30:31], s[0:1], 56
    s_load_dwordx8 s[32:39], s[0:1], 64
    s_load_dwordx4 s[40:43], s[0:1], 96
    s_memrealtime s[12:13]
    v_lshrrev_b32 v1, 6, v0
    v_and_b32 v2, 63, v0
    s_getpc_b64 s[6:7]
L_pc:
    s_lshr_b32 s4, s2, 1
    s_and_b32 s4, s4, 124
    v_add_u32 v3, s4, v1
    v_lshl_add_u32 v3, v2, 7, v3
    v_lshlrev_b32 v3, 7, v3
    v_min_u32 v3, L_end-L_pc-4, v3
    s_mov_b64 exec, 63
    global_load_dword v255, v3, s[6:7]
    s_mov_b64 exec, -1
    v_readfirstlane_b32 s3, v1
    s_and_b32 s4, s2, 7
    s_lshr_b32 s5, s2, 3
    s_lshl_b32 s4, s4, 5
    s_add_u32 s17, s4, s5
    v_lshrrev_b32 v3, 5, v0
    v_and_b32 v31, 31, v0
    v_mul_u32_u24 v215, 1152, v3
    v_mad_u32_u24 v215, v31, 12, v215
    s_mul_i32 s15, s17, 9216
    v_lshlrev_b32 v21, 4, v2
    s_mov_b32 s58, 2359296
    s_mov_b32 s59, 0x20000
    s_mov_b32 s50, 2359296
    s_mov_b32 s51, 0x20000
    s_mov_b32 s54, 2359296
    s_mov_b32 s55, 0x20000
    s_mov_b32 s62, 4608
    s_mov_b32 s63, 0x20000
    v_lshlrev_b32 v219, 3, v0
    s_movk_i32 s10, 4096
    s_waitcnt lgkmcnt(0)
    buffer_load_dwordx3 v[64:66], v215, s[56:59], s15 offen offset:0
    buffer_load_dwordx3 v[68:70], v215, s[56:59], s15 offen offset:384
    buffer_load_dwordx3 v[72:74], v215, s[56:59], s15 offen offset:768
    s_mov_b32 s64, s40
    s_and_b32 s65, s41, 0xffff
    s_mov_b32 s66, 256
    s_mov_b32 s67, 0x20000
    s_or_b32 s12, s12, 1
    v_or_b32 v1, s2, v0
    v_lshlrev_b32 v1, 8, v1
    v_mov_b32 v3, s12
    buffer_store_dword v3, v1, s[64:67], 0 offen sc1
    s_mov_b32 s44, s42
    s_and_b32 s45, s43, 0xffff
    s_mov_b32 s46, 32309248
    s_mov_b32 s47, 0x20000
    s_mov_b64 s[42:43], s[34:35]
    s_and_b32 s5, s2, 7
    s_lshr_b32 s6, s2, 3
    s_and_b32 s22, s6, 3
    s_lshr_b32 s23, s5, 1
    s_lshl_b32 s20, s3, 12
    s_mul_i32 s21, s3, 3072
    s_add_u32 s21, s21, 90112
    s_mul_i32 s34, s5, 72
    s_add_u32 s34, s34, s6
    s_lshr_b32 s7, s6, 2
    s_lshl_b32 s8, s7, 1
    s_and_b32 s4, s5, 1
    s_lshl_b32 s4, s4, 4
    s_add_u32 s9, s8, 0
    s_cmp_ge_u32 s9, 3
    s_addc_u32 s40, s9, 0
    s_cmp_ge_u32 s9, 10
    s_addc_u32 s40, s40, 0
    s_cmp_eq_u32 s7, 7
    s_cselect_b32 s40, 3, s40
    s_add_u32 s40, s40, s4
    s_lshl_b32 s40, s40, 7
    s_add_u32 s9, s8, 1
    s_cmp_ge_u32 s9, 3
    s_addc_u32 s41, s9, 0
    s_cmp_ge_u32 s9, 10
    s_addc_u32 s41, s41, 0
    s_cmp_eq_u32 s7, 7
    s_cselect_b32 s41, 11, s41
    s_add_u32 s41, s41, s4
    s_lshl_b32 s41, s41, 7
    v_min_u32 v25, 1, v0
    v_lshlrev_b32 v25, 30, v25
    v_min_u32 v23, 1, v2
    v_lshlrev_b32 v23, 30, v23
    v_and_b32 v1, 15, v2
    v_lshrrev_b32 v3, 4, v2
    v_mul_u32_u24 v3, 12288, v3
    v_lshl_add_u32 v22, v1, 4, v3
    s_cmp_lt_u32 s6, 27
    s_cbranch_scc0 L_aux
    s_branch L_org
L_exit:
    s_endpgm
L_nw_G:
    s_mov_b32 s13, 0
L_nl_G:
    buffer_load_dword v226, v225, s[64:67], 0 offen sc1
    s_waitcnt vmcnt(0)
    v_readfirstlane_b32 s16, v226
    s_nop 1
    s_cmp_lg_u32 s16, 0
    s_cbranch_scc1 L_ng_G
    s_add_u32 s13, s13, 1
    s_cmp_lt_u32 s13, 100000
    s_cbranch_scc1 L_nl_G
    s_branch L_ng_G
L_rs_ph:
    s_mov_b32 s13, 0
L_rt_ph:
    s_mov_b64 exec, vcc
    s_sleep 12
    buffer_load_dword v29, v28, s[44:47], 0 offen offset:0 sc1
    s_waitcnt vmcnt(0)
    v_cmp_ne_u32 vcc, s16, v29
    s_cbranch_vccz L_rx_ph
    s_add_u32 s13, s13, 1
    s_cmp_lt_u32 s13, 100000
    s_cbranch_scc1 L_rt_ph
L_rx_ph:
    s_mov_b64 exec, -1
    s_branch L_ok_ph
L_rs_pk:
    s_mov_b32 s13, 0
L_rt_pk:
    s_mov_b64 exec, vcc
    s_sleep 12
    buffer_load_dword v143, v142, s[44:47], 0 offen offset:0 sc1
    s_waitcnt vmcnt(0)
    v_cmp_ne_u32 vcc, s16, v143
    s_cbranch_vccz L_rx_pk
    s_add_u32 s13, s13, 1
    s_cmp_lt_u32 s13, 100000
    s_cbranch_scc1 L_rt_pk
L_rx_pk:
    s_mov_b64 exec, -1
    s_branch L_ok_pk
L_rs_p1:
    s_mov_b32 s13, 0
L_rt_p1:
    s_mov_b64 exec, vcc
    s_sleep 24
    buffer_load_dword v27, v26, s[44:47], 0 offen offset:0 sc1
    s_waitcnt vmcnt(0)
    v_cmp_ne_u32 vcc, s16, v27
    s_cbranch_vccz L_rx_p1
    s_add_u32 s13, s13, 1
    s_cmp_lt_u32 s13, 100000
    s_cbranch_scc1 L_rt_p1
L_rx_p1:
    s_mov_b64 exec, -1
    s_branch L_ok_p1
L_rs_p2:
    s_mov_b32 s13, 0
L_rt_p2:
    s_mov_b64 exec, vcc
    s_sleep 12
    buffer_load_dword v27, v26, s[44:47], 0 offen offset:0 sc1
    s_waitcnt vmcnt(0)
    v_cmp_ne_u32 vcc, s16, v27
    s_cbranch_vccz L_rx_p2
    s_add_u32 s13, s13, 1
    s_cmp_lt_u32 s13, 100000
    s_cbranch_scc1 L_rt_p2
L_rx_p2:
    s_mov_b64 exec, -1
    s_branch L_ok_p2
L_rs_py:
    s_mov_b32 s13, 0
L_rt_py:
    s_mov_b64 exec, vcc
    s_sleep 12
    buffer_load_dword v29, v28, s[44:47], 0 offen offset:0 sc1
    s_waitcnt vmcnt(0)
    v_cmp_ne_u32 vcc, s16, v29
    s_cbranch_vccz L_rx_py
    s_add_u32 s13, s13, 1
    s_cmp_lt_u32 s13, 100000
    s_cbranch_scc1 L_rt_py
L_rx_py:
    s_mov_b64 exec, -1
    s_branch L_ok_py
L_rs_bl0:
    s_mov_b32 s13, 0
L_rt_bl0:
    s_add_u32 s13, s13, 1
    s_cmp_lt_u32 s13, 100000
    s_cbranch_scc0 L_ok_bl0
    buffer_load_dwordx4 v[136:139], v21, s[44:47], s43 offen offset:0 sc1
    buffer_load_dwordx4 v[140:143], v21, s[44:47], s43 offen offset:1024 sc1
    buffer_load_dwordx4 v[108:111], v21, s[44:47], s43 offen offset:2048 sc1
    s_waitcnt vmcnt(0)
    v_xor_b32 v136, v253, v136
    v_xor_b32 v137, v255, v137
    v_xor_b32 v138, v23, v138
    v_xor_b32 v139, v0, v139
    v_or3_b32 v1, v136, v137, v138
    v_xor_b32 v140, v253, v140
    v_xor_b32 v141, v255, v141
    v_or3_b32 v1, v139, v140, v1
    v_xor_b32 v142, v23, v142
    v_xor_b32 v143, v0, v143
    v_or3_b32 v1, v141, v142, v1
    v_xor_b32 v108, v253, v108
    v_xor_b32 v109, v255, v109
    v_or3_b32 v1, v143, v108, v1
    v_xor_b32 v110, v23, v110
    v_xor_b32 v111, v0, v111
    v_or3_b32 v1, v109, v110, v1
    v_or_b32 v1, v111, v1
    v_and_b32 v1, s33, v1
    v_cmp_ne_u32 vcc, 0, v1
    s_cbranch_vccnz L_rt_bl0
    s_branch L_ok_bl0
L_rs_bl1:
    s_mov_b32 s13, 0
L_rt_bl1:
    s_add_u32 s13, s13, 1
    s_cmp_lt_u32 s13, 100000
    s_cbranch_scc0 L_ok_bl1
    buffer_load_dwordx4 v[136:139], v21, s[44:47], s9 offen offset:0 sc1
    buffer_load_dwordx4 v[140:143], v21, s[44:47], s9 offen offset:1024 sc1
    buffer_load_dwordx4 v[108:111], v21, s[44:47], s9 offen offset:2048 sc1
    s_waitcnt vmcnt(0)
    v_xor_b32 v136, v253, v136
    v_xor_b32 v137, v255, v137
    v_xor_b32 v138, v23, v138
    v_xor_b32 v139, v0, v139
    v_or3_b32 v1, v136, v137, v138
    v_xor_b32 v140, v253, v140
    v_xor_b32 v141, v255, v141
    v_or3_b32 v1, v139, v140, v1
    v_xor_b32 v142, v23, v142
    v_xor_b32 v143, v0, v143
    v_or3_b32 v1, v141, v142, v1
    v_xor_b32 v108, v253, v108
    v_xor_b32 v109, v255, v109
    v_or3_b32 v1, v143, v108, v1
    v_xor_b32 v110, v23, v110
    v_xor_b32 v111, v0, v111
    v_or3_b32 v1, v109, v110, v1
    v_or_b32 v1, v111, v1
    v_and_b32 v1, s33, v1
    v_cmp_ne_u32 vcc, 0, v1
    s_cbranch_vccnz L_rt_bl1
    s_branch L_ok_bl1
L_rs_cl:
    s_mov_b32 s13, 0
L_rt_cl:
    s_add_u32 s13, s13, 1
    s_cmp_lt_u32 s13, 100000
    s_cbranch_scc0 L_ok_cl
    buffer_load_dwordx4 v[132:135], v21, s[44:47], s4 offen sc1
    buffer_load_dwordx4 v[136:139], v21, s[44:47], s5 offen sc1
    buffer_load_dwordx4 v[140:143], v21, s[44:47], s7 offen sc1
    s_waitcnt vmcnt(0)
    v_xor_b32 v132, v253, v132
    v_xor_b32 v133, v255, v133
    v_xor_b32 v134, v23, v134
    v_xor_b32 v135, v0, v135
    v_or3_b32 v1, v132, v133, v134
    v_xor_b32 v136, v253, v136
    v_xor_b32 v137, v255, v137
    v_or3_b32 v1, v135, v136, v1
    v_xor_b32 v138, v23, v138
    v_xor_b32 v139, v0, v139
    v_or3_b32 v1, v137, v138, v1
    v_xor_b32 v140, v253, v140
    v_xor_b32 v141, v255, v141
    v_or3_b32 v1, v139, v140, v1
    v_xor_b32 v142, v23, v142
    v_xor_b32 v143, v0, v143
    v_or3_b32 v1, v141, v142, v1
    v_or_b32 v1, v143, v1
    v_and_b32 v1, s33, v1
    v_cmp_ne_u32 vcc, 0, v1
    s_cbranch_vccnz L_rt_cl
    s_branch L_ok_cl
L_rs_ol0:
    s_mov_b32 s13, 0
L_rt_ol0:
    s_add_u32 s13, s13, 1
    s_cmp_lt_u32 s13, 100000
    s_cbranch_scc0 L_ok_ol0
    buffer_load_dwordx4 v[64:67], v21, s[44:47], s6 offen offset:0 sc1
    buffer_load_dwordx4 v[68:71], v21, s[44:47], s6 offen offset:1024 sc1
    buffer_load_dwordx4 v[72:75], v21, s[44:47], s6 offen offset:2048 sc1
    s_waitcnt vmcnt(0)
    v_xor_b32 v64, v253, v64
    v_xor_b32 v65, v255, v65
    v_xor_b32 v66, v23, v66
    v_xor_b32 v67, v0, v67
    v_or3_b32 v1, v64, v65, v66
    v_xor_b32 v68, v253, v68
    v_xor_b32 v69, v255, v69
    v_or3_b32 v1, v67, v68, v1
    v_xor_b32 v70, v23, v70
    v_xor_b32 v71, v0, v71
    v_or3_b32 v1, v69, v70, v1
    v_xor_b32 v72, v253, v72
    v_xor_b32 v73, v255, v73
    v_or3_b32 v1, v71, v72, v1
    v_xor_b32 v74, v23, v74
    v_xor_b32 v75, v0, v75
    v_or3_b32 v1, v73, v74, v1
    v_or_b32 v1, v75, v1
    v_and_b32 v1, s33, v1
    v_cmp_ne_u32 vcc, 0, v1
    s_cbranch_vccnz L_rt_ol0
    s_branch L_ok_ol0
L_rs_ol1:
    s_mov_b32 s13, 0
L_rt_ol1:
    s_add_u32 s13, s13, 1
    s_cmp_lt_u32 s13, 100000
    s_cbranch_scc0 L_ok_ol1
    buffer_load_dwordx4 v[64:67], v21, s[44:47], s6 offen offset:0 sc1
    buffer_load_dwordx4 v[68:71], v21, s[44:47], s6 offen offset:1024 sc1
    buffer_load_dwordx4 v[72:75], v21, s[44:47], s6 offen offset:2048 sc1
    s_waitcnt vmcnt(0)
    v_xor_b32 v64, v253, v64
    v_xor_b32 v65, v255, v65
    v_xor_b32 v66, v23, v66
    v_xor_b32 v67, v0, v67
    v_or3_b32 v1, v64, v65, v66
    v_xor_b32 v68, v253, v68
    v_xor_b32 v69, v255, v69
    v_or3_b32 v1, v67, v68, v1
    v_xor_b32 v70, v23, v70
    v_xor_b32 v71, v0, v71
    v_or3_b32 v1, v69, v70, v1
    v_xor_b32 v72, v253, v72
    v_xor_b32 v73, v255, v73
    v_or3_b32 v1, v71, v72, v1
    v_xor_b32 v74, v23, v74
    v_xor_b32 v75, v0, v75
    v_or3_b32 v1, v73, v74, v1
    v_or_b32 v1, v75, v1
    v_and_b32 v1, s33, v1
    v_cmp_ne_u32 vcc, 0, v1
    s_cbranch_vccnz L_rt_ol1
    s_branch L_ok_ol1
L_nw_X:
    s_mov_b32 s13, 0
L_nl_X:
    buffer_load_dword v226, v225, s[64:67], 0 offen sc1
    s_waitcnt vmcnt(0)
    v_readfirstlane_b32 s16, v226
    s_nop 1
    s_cmp_lg_u32 s16, 0
    s_cbranch_scc1 L_ng_X
    s_add_u32 s13, s13, 1
    s_cmp_lt_u32 s13, 100000
    s_cbranch_scc1 L_nl_X
    s_branch L_ng_X
L_rs_pkX:
    s_mov_b32 s13, 0
L_rt_pkX:
    s_mov_b64 exec, vcc
    s_sleep 16
    buffer_load_dword v29, v28, s[44:47], 0 offen offset:0 sc1
    s_waitcnt vmcnt(0)
    v_cmp_ne_u32 vcc, s16, v29
    s_cbranch_vccz L_rx_pkX
    s_add_u32 s13, s13, 1
    s_cmp_lt_u32 s13, 100000
    s_cbranch_scc1 L_rt_pkX
L_rx_pkX:
    s_mov_b64 exec, -1
    s_branch L_ok_pkX
L_wc_G:
    s_cmp_eq_u32 s3, 0
    s_cbranch_scc1 L_pl_G_0
    s_cmp_eq_u32 s3, 1
    s_cbranch_scc1 L_pl_G_1
    s_cmp_eq_u32 s3, 2
    s_cbranch_scc1 L_pl_G_2
    s_branch L_pl_G_3
L_wc_X:
    s_cmp_eq_u32 s3, 0
    s_cbranch_scc1 L_pl_X_0
    s_cmp_eq_u32 s3, 1
    s_cbranch_scc1 L_pl_X_1
    s_cmp_eq_u32 s3, 2
    s_cbranch_scc1 L_pl_X_2
    s_branch L_pl_X_3
L_wc_S:
    s_cmp_eq_u32 s3, 0
    s_cbranch_scc1 L_pl_S_0
    s_cmp_eq_u32 s3, 1
    s_cbranch_scc1 L_pl_S_1
    s_cmp_eq_u32 s3, 2
    s_cbranch_scc1 L_pl_S_2
    s_branch L_pl_S_3
L_wret:
    s_setpc_b64 s[10:11]
.p2align 12
L_org:
    s_mul_i32 s7, s6, 21846
    s_lshr_b32 s7, s7, 16
    s_mul_i32 s8, s7, 3
    s_sub_u32 s9, s6, s8
    s_mul_i32 s8, s23, 9
    s_add_u32 s18, s8, s7
    s_and_b32 s4, s5, 1
    s_lshl1_add_u32 s19, s9, s4
    s_mov_b32 s48, s30
    s_and_b32 s49, s31, 0xffff
    s_mov_b32 s50, 18874368
    s_mov_b32 s51, 0x20000
    s_mov_b32 s52, s42
    s_and_b32 s53, s43, 0xffff
    s_mov_b32 s54, 18874368
    s_mov_b32 s55, 0x20000
    s_mul_i32 s4, s4, 1572864
    s_mul_i32 s7, s9, 65538
    s_lshr_b32 s7, s7, 16
    s_mul_i32 s7, s7, 98304
    s_add_u32 s5, s4, 0
    s_add_u32 s68, s7, s5
    s_add_u32 s8, s5, 294912
    s_add_u32 s69, s68, 98304
    s_cmp_eq_u32 s69, s8
    s_cselect_b32 s69, s5, s69
    s_add_u32 s70, s69, 98304
    s_cmp_eq_u32 s70, s8
    s_cselect_b32 s70, s5, s70
    s_mul_i32 s7, s9, 65538
    s_lshr_b32 s7, s7, 16
    s_mul_i32 s7, s7, 98304
    s_add_u32 s5, s4, 294912
    s_add_u32 s71, s7, s5
    s_add_u32 s8, s5, 294912
    s_add_u32 s72, s71, 98304
    s_cmp_eq_u32 s72, s8
    s_cselect_b32 s72, s5, s72
    s_add_u32 s73, s72, 98304
    s_cmp_eq_u32 s73, s8
    s_cselect_b32 s73, s5, s73
    s_mul_i32 s7, s9, 87384
    s_lshr_b32 s7, s7, 16
    s_mul_i32 s7, s7, 98304
    s_add_u32 s5, s4, 589824
    s_add_u32 s74, s7, s5
    s_add_u32 s8, s5, 393216
    s_add_u32 s75, s74, 98304
    s_cmp_eq_u32 s75, s8
    s_cselect_b32 s75, s5, s75
    s_add_u32 s76, s75, 98304
    s_cmp_eq_u32 s76, s8
    s_cselect_b32 s76, s5, s76
    s_add_u32 s77, s76, 98304
    s_cmp_eq_u32 s77, s8
    s_cselect_b32 s77, s5, s77
    s_mul_i32 s7, s9, 131076
    s_lshr_b32 s7, s7, 16
    s_mul_i32 s7, s7, 98304
    s_add_u32 s5, s4, 983040
    s_add_u32 s78, s7, s5
    s_add_u32 s8, s5, 589824
    s_add_u32 s79, s78, 98304
    s_cmp_eq_u32 s79, s8
    s_cselect_b32 s79, s5, s79
    s_add_u32 s80, s79, 98304
    s_cmp_eq_u32 s80, s8
    s_cselect_b32 s80, s5, s80
    s_add_u32 s81, s80, 98304
    s_cmp_eq_u32 s81, s8
    s_cselect_b32 s81, s5, s81
    s_add_u32 s82, s81, 98304
    s_cmp_eq_u32 s82, s8
    s_cselect_b32 s82, s5, s82
    s_add_u32 s83, s82, 98304
    s_cmp_eq_u32 s83, s8
    s_cselect_b32 s83, s5, s83
    v_lshrrev_b32 v1, 4, v2
    v_and_b32 v3, 15, v2
    v_lshlrev_b32 v31, 1, v1
    v_xor_b32 v3, v3, v31
    v_mul_u32_u24 v1, 9216, v1
    v_lshl_add_u32 v1, v3, 4, v1
    s_mul_i32 s7, s3, 147456
    s_lshl_b32 s8, s18, 8
    s_add_u32 s7, s7, s8
    v_add_u32 v4, s7, v1
    v_add_u32 v5, 35840, v4
    v_xor_b32 v1, 128, v4
    v_add_u32 v6, 71680, v1
    v_add_u32 v7, 35840, v6
    s_mov_b32 s60, s32
    s_and_b32 s61, s33, 0xffff
    s_mov_b32 s62, 9216
    s_mov_b32 s63, 0x20000
    v_lshrrev_b32 v3, 5, v0
    v_and_b32 v1, 31, v0
    v_mul_u32_u24 v220, 1216, v3
    v_mad_u32_u24 v220, v1, 12, v220
    v_add_u32 v220, 152960, v220
    v_lshlrev_b32 v3, 3, v3
    v_cmp_eq_u32 vcc, 0, v1
    v_mov_b32 v31, 0x40000000
    s_nop 0
    v_cndmask_b32 v216, v31, v3, vcc
    v_lshrrev_b32 v31, 4, v0
    v_and_b32 v1, 3, v2
    v_lshlrev_b32 v1, 3, v1
    v_lshl_add_u32 v1, v31, 5, v1
    v_bfe_u32 v3, v2, 2, 2
    v_mul_u32_u24 v221, 1216, v3
    v_mul_u32_u24 v222, 1152, v3
    s_mov_b32 s9, 152960
    s_mov_b32 s8, 0
    v_add3_u32 v221, v221, v1, s9
    v_add3_u32 v222, v222, v1, s8
    v_and_b32 v223, 15, v0
    v_lshlrev_b32 v223, 4, v223
    v_add_u32 v1, 0, v31
    v_mul_u32_u24 v3, 43, v1
    v_lshrrev_b32 v3, 7, v3
    v_mad_i32_i24 v224, v3, -3, v1
    v_min_u32 v224, 1, v224
    v_add3_u32 v1, v1, v3, v224
    v_lshl_add_u32 v212, v1, 8, v223
    v_add_u32 v1, 16, v31
    v_mul_u32_u24 v3, 43, v1
    v_lshrrev_b32 v3, 7, v3
    v_mad_i32_i24 v224, v3, -3, v1
    v_min_u32 v224, 1, v224
    v_add3_u32 v1, v1, v3, v224
    v_lshl_add_u32 v213, v1, 8, v223
    v_add_u32 v1, 32, v31
    v_mul_u32_u24 v3, 43, v1
    v_lshrrev_b32 v3, 7, v3
    v_mad_i32_i24 v224, v3, -3, v1
    v_min_u32 v224, 1, v224
    v_add3_u32 v1, v1, v3, v224
    v_lshl_add_u32 v214, v1, 8, v223
    s_mul_i32 s4, s17, 12288
    s_add_u32 s6, s4, 4096
    s_add_u32 s7, s4, 3211264
    s_cmp_eq_u32 s3, 0
    s_cselect_b32 s8, s6, 0x40000000
    s_cselect_b32 s9, s7, 0x40000000
    s_lshl_b32 s5, s17, 6
    s_add_u32 s5, s5, 8716288
    v_mov_b32 v225, 0
    s_lshr_b32 s12, s17, 2
    s_lshl_b32 s12, s12, 7
    s_and_b32 s4, s17, 3
    s_lshl2_add_u32 s12, s4, s12
    s_add_u32 s12, s12, 8863744
    s_add_u32 m0, s20, 98304
    s_mul_i32 s14, s68, 6
    buffer_load_dwordx4 v4, s[48:51], s14 offen offset:0 lds
    buffer_load_dwordx4 v5, s[48:51], s14 offen offset:1024 lds
    buffer_load_dwordx4 v6, s[48:51], s14 offen offset:2048 lds
    buffer_load_dwordx4 v7, s[48:51], s14 offen offset:3072 lds
    s_add_u32 m0, s20, 81920
    s_mul_i32 s14, s69, 6
    buffer_load_dwordx4 v4, s[48:51], s14 offen offset:0 lds
    buffer_load_dwordx4 v5, s[48:51], s14 offen offset:1024 lds
    buffer_load_dwordx4 v6, s[48:51], s14 offen offset:2048 lds
    buffer_load_dwordx4 v7, s[48:51], s14 offen offset:3072 lds
    s_waitcnt vmcnt(9)
    v_and_b32 v77, 0xffff0000, v64
    v_lshlrev_b32 v76, 16, v64
    v_and_b32 v79, 0xffff0000, v65
    v_lshlrev_b32 v78, 16, v65
    v_and_b32 v81, 0xffff0000, v66
    v_lshlrev_b32 v80, 16, v66
    v_and_b32 v83, 0xffff0000, v68
    v_lshlrev_b32 v82, 16, v68
    v_and_b32 v85, 0xffff0000, v69
    v_lshlrev_b32 v84, 16, v69
    v_and_b32 v87, 0xffff0000, v70
    v_lshlrev_b32 v86, 16, v70
    v_and_b32 v89, 0xffff0000, v72
    v_lshlrev_b32 v88, 16, v72
    v_and_b32 v91, 0xffff0000, v73
    v_lshlrev_b32 v90, 16, v73
    v_and_b32 v93, 0xffff0000, v74
    v_lshlrev_b32 v92, 16, v74
    v_pk_add_f32 v[94:95], v[76:77], v[78:79]
    v_pk_add_f32 v[96:97], v[80:81], v[82:83]
    v_pk_add_f32 v[98:99], v[84:85], v[86:87]
    v_pk_add_f32 v[100:101], v[88:89], v[90:91]
    v_pk_add_f32 v[94:95], v[94:95], v[96:97]
    v_pk_add_f32 v[98:99], v[98:99], v[100:101]
    v_pk_add_f32 v[94:95], v[94:95], v[92:93]
    v_pk_add_f32 v[94:95], v[94:95], v[98:99]
    v_add_f32 v102, v94, v95
    s_nop 1
    v_add_f32_dpp v102, v102, v102 row_ror:8 row_mask:0xf bank_mask:0xf
    s_nop 1
    v_add_f32_dpp v102, v102, v102 row_ror:4 row_mask:0xf bank_mask:0xf
    s_nop 1
    v_add_f32_dpp v102, v102, v102 row_ror:2 row_mask:0xf bank_mask:0xf
    s_nop 1
    v_add_f32_dpp v102, v102, v102 row_ror:1 row_mask:0xf bank_mask:0xf
    v_mov_b32 v103, v102
    s_nop 1
    v_permlane16_swap_b32 v102, v103
    v_add_f32 v102, v102, v103
    v_mul_f32 v102, 0x3ae38e39, v102
    v_pk_add_f32 v[76:77], v[76:77], v[102:103] op_sel_hi:[1,0] neg_lo:[0,1] neg_hi:[0,1]
    v_pk_add_f32 v[78:79], v[78:79], v[102:103] op_sel_hi:[1,0] neg_lo:[0,1] neg_hi:[0,1]
    v_pk_add_f32 v[80:81], v[80:81], v[102:103] op_sel_hi:[1,0] neg_lo:[0,1] neg_hi:[0,1]
    v_pk_add_f32 v[82:83], v[82:83], v[102:103] op_sel_hi:[1,0] neg_lo:[0,1] neg_hi:[0,1]
    v_pk_add_f32 v[84:85], v[84:85], v[102:103] op_sel_hi:[1,0] neg_lo:[0,1] neg_hi:[0,1]
    v_pk_add_f32 v[86:87], v[86:87], v[102:103] op_sel_hi:[1,0] neg_lo:[0,1] neg_hi:[0,1]
    v_pk_add_f32 v[88:89], v[88:89], v[102:103] op_sel_hi:[1,0] neg_lo:[0,1] neg_hi:[0,1]
    v_pk_add_f32 v[90:91], v[90:91], v[102:103] op_sel_hi:[1,0] neg_lo:[0,1] neg_hi:[0,1]
    v_pk_add_f32 v[92:93], v[92:93], v[102:103] op_sel_hi:[1,0] neg_lo:[0,1] neg_hi:[0,1]
    v_pk_mul_f32 v[94:95], v[76:77], v[76:77]
    v_pk_mul_f32 v[96:97], v[78:79], v[78:79]
    v_pk_fma_f32 v[94:95], v[80:81], v[80:81], v[94:95]
    v_pk_fma_f32 v[96:97], v[82:83], v[82:83], v[96:97]
    v_pk_fma_f32 v[94:95], v[84:85], v[84:85], v[94:95]
    v_pk_fma_f32 v[96:97], v[86:87], v[86:87], v[96:97]
    v_pk_fma_f32 v[94:95], v[88:89], v[88:89], v[94:95]
    v_pk_fma_f32 v[96:97], v[90:91], v[90:91], v[96:97]
    v_pk_fma_f32 v[94:95], v[92:93], v[92:93], v[94:95]
    v_pk_add_f32 v[94:95], v[94:95], v[96:97]
    v_add_f32 v104, v94, v95
    s_nop 1
    v_add_f32_dpp v104, v104, v104 row_ror:8 row_mask:0xf bank_mask:0xf
    s_nop 1
    v_add_f32_dpp v104, v104, v104 row_ror:4 row_mask:0xf bank_mask:0xf
    s_nop 1
    v_add_f32_dpp v104, v104, v104 row_ror:2 row_mask:0xf bank_mask:0xf
    s_nop 1
    v_add_f32_dpp v104, v104, v104 row_ror:1 row_mask:0xf bank_mask:0xf
    v_mov_b32 v105, v104
    s_nop 1
    v_permlane16_swap_b32 v104, v105
    v_add_f32 v104, v104, v105
    v_mul_f32 v104, 0x3ae38e39, v104
    v_cvt_pk_bf16_f32 v94, v102, v104
    v_lshlrev_b32 v106, 16, v94
    v_and_b32 v94, 0xffff0000, v94
    v_add_f32 v94, 0x3727c5ac, v94
    v_sub_f32 v102, v102, v106
    v_cvt_pk_bf16_f32 v94, v94, v94
    v_lshlrev_b32 v94, 16, v94
    v_sqrt_f32 v94, v94
    s_nop 0
    v_cvt_pk_bf16_f32 v94, v94, v94
    v_lshlrev_b32 v94, 16, v94
    v_rcp_f32 v107, v94
    s_nop 0
    v_mul_f32 v102, v102, v107
    v_mul_f32 v104, v104, v107
    v_mul_f32 v104, v104, v107
    v_cvt_pk_bf16_f32 v94, v102, v104
    v_lshlrev_b32 v95, 16, v94
    v_and_b32 v94, 0xffff0000, v94
    v_add_f32 v94, 0x3727c5ac, v94
    v_sub_f32 v102, v102, v95
    v_cvt_pk_bf16_f32 v94, v94, v94
    v_lshlrev_b32 v94, 16, v94
    v_sqrt_f32 v94, v94
    s_nop 0
    v_cvt_pk_bf16_f32 v94, v94, v94
    v_lshlrev_b32 v94, 16, v94
    v_rcp_f32 v94, v94
    s_nop 0
    v_mul_f32 v104, v107, v94
    v_mul_f32 v102, v102, v94
    v_pk_fma_f32 v[76:77], v[76:77], v[104:105], v[102:103] op_sel_hi:[1,0,0]
    v_pk_fma_f32 v[78:79], v[78:79], v[104:105], v[102:103] op_sel_hi:[1,0,0]
    v_pk_fma_f32 v[80:81], v[80:81], v[104:105], v[102:103] op_sel_hi:[1,0,0]
    v_pk_fma_f32 v[82:83], v[82:83], v[104:105], v[102:103] op_sel_hi:[1,0,0]
    v_pk_fma_f32 v[84:85], v[84:85], v[104:105], v[102:103] op_sel_hi:[1,0,0]
    v_pk_fma_f32 v[86:87], v[86:87], v[104:105], v[102:103] op_sel_hi:[1,0,0]
    v_pk_fma_f32 v[88:89], v[88:89], v[104:105], v[102:103] op_sel_hi:[1,0,0]
    v_pk_fma_f32 v[90:91], v[90:91], v[104:105], v[102:103] op_sel_hi:[1,0,0]
    v_pk_fma_f32 v[92:93], v[92:93], v[104:105], v[102:103] op_sel_hi:[1,0,0]
    v_cvt_pk_bf16_f32 v64, v76, v77
    v_cvt_pk_bf16_f32 v65, v78, v79
    v_cvt_pk_bf16_f32 v66, v80, v81
    v_cvt_pk_bf16_f32 v67, v82, v83
    v_cvt_pk_bf16_f32 v68, v84, v85
    v_cvt_pk_bf16_f32 v69, v86, v87
    v_cvt_pk_bf16_f32 v70, v88, v89
    v_cvt_pk_bf16_f32 v71, v90, v91
    v_cvt_pk_bf16_f32 v72, v92, v93
    ds_write_b32 v220, v64 offset:0
    ds_write_b32 v220, v65 offset:4
    ds_write_b32 v220, v66 offset:8
    ds_write_b32 v220, v67 offset:384
    ds_write_b32 v220, v68 offset:388
    ds_write_b32 v220, v69 offset:392
    ds_write_b32 v220, v70 offset:768
    ds_write_b32 v220, v71 offset:772
    ds_write_b32 v220, v72 offset:776
    buffer_store_dwordx2 v[106:107], v216, s[44:47], s5 offen sc1
    s_waitcnt lgkmcnt(0)
    s_barrier
    ds_read_b64_tr_b16 v[200:201], v221 offset:0
    ds_read_b64_tr_b16 v[202:203], v221 offset:4864
    ds_read_b64_tr_b16 v[204:205], v221 offset:512
    ds_read_b64_tr_b16 v[206:207], v221 offset:5376
    ds_read_b64_tr_b16 v[208:209], v221 offset:1024
    ds_read_b64_tr_b16 v[210:211], v221 offset:5888
    s_waitcnt lgkmcnt(4)
    buffer_store_dwordx4 v[200:203], v212, s[44:47], s6 offen sc1
    s_waitcnt lgkmcnt(2)
    buffer_store_dwordx4 v[204:207], v213, s[44:47], s6 offen sc1
    s_waitcnt lgkmcnt(0)
    buffer_store_dwordx4 v[208:211], v214, s[44:47], s8 offen sc1
    buffer_load_dword v226, v225, s[64:67], 0 offen sc1
    v_lshrrev_b32 v1, 4, v2
    v_lshlrev_b32 v1, 3, v1
    s_lshl_b32 s4, s18, 8
    s_lshl_b32 s14, s3, 6
    s_add_u32 s4, s4, s14
    buffer_load_dwordx2 v[148:149], v1, s[60:63], s4 offen
    buffer_load_dwordx2 v[150:151], v1, s[60:63], s4 offen offset:32
    s_mov_b32 s60, s36
    s_and_b32 s61, s37, 0xffff
    s_mov_b32 s62, 4096
    s_mov_b32 s63, 0x20000
    s_cmp_lt_u32 s3, 2
    s_cselect_b32 s4, s40, s41
    s_and_b32 s14, s3, 1
    s_lshl_b32 s14, s14, 6
    s_add_u32 s4, s4, s14
    v_and_b32 v1, 15, v2
    v_lshl_add_u32 v3, v1, 1, s4
    s_and_b32 s14, s23, 1
    s_lshl_b32 s14, s14, 5
    buffer_load_ushort v152, v3, s[60:63], 0 offen
    buffer_load_ushort v153, v3, s[60:63], 0 offen offset:32
    buffer_load_ushort v154, v3, s[60:63], s14 offen
    s_mov_b32 s60, s26
    s_and_b32 s61, s27, 0xffff
    s_mov_b32 s62, 1152
    s_mov_b32 s63, 0x20000
    s_lshl_b32 s4, s34, 1
    v_mov_b32 v30, 0
    buffer_load_ushort v30, v30, s[60:63], s4 offen
    s_add_u32 m0, s20, 65536
    s_mul_i32 s14, s70, 6
    buffer_load_dwordx4 v4, s[48:51], s14 offen offset:0 lds
    buffer_load_dwordx4 v5, s[48:51], s14 offen offset:1024 lds
    buffer_load_dwordx4 v6, s[48:51], s14 offen offset:2048 lds
    buffer_load_dwordx4 v7, s[48:51], s14 offen offset:3072 lds
    s_waitcnt vmcnt(10)
    v_readfirstlane_b32 s16, v226
    s_nop 1
    s_cmp_eq_u32 s16, 0
    s_cbranch_scc1 L_nw_G
L_ng_G:
    v_mov_b32 v24, s16
    s_barrier
    buffer_store_dword v24, v25, s[44:47], s12 offen sc1
    s_add_u32 s12, s12, 8192
L_segG:
L_pl_G_0:
    s_cbranch_execz L_pl_G_4
    s_add_u32 m0, s20, 0
    s_mul_i32 s14, s71, 6
    buffer_load_dwordx4 v4, s[48:51], s14 offen offset:0 lds
    buffer_load_dwordx4 v5, s[48:51], s14 offen offset:1024 lds
    buffer_load_dwordx4 v6, s[48:51], s14 offen offset:2048 lds
    buffer_load_dwordx4 v7, s[48:51], s14 offen offset:3072 lds
    s_add_u32 m0, s20, 16384
    s_mul_i32 s14, s72, 6
    buffer_load_dwordx4 v4, s[48:51], s14 offen offset:0 lds
    buffer_load_dwordx4 v5, s[48:51], s14 offen offset:1024 lds
    buffer_load_dwordx4 v6, s[48:51], s14 offen offset:2048 lds
    buffer_load_dwordx4 v7, s[48:51], s14 offen offset:3072 lds
    s_add_u32 m0, s20, 32768
    s_mul_i32 s14, s73, 6
    buffer_load_dwordx4 v4, s[48:51], s14 offen offset:0 lds
    buffer_load_dwordx4 v5, s[48:51], s14 offen offset:1024 lds
    buffer_load_dwordx4 v6, s[48:51], s14 offen offset:2048 lds
    buffer_load_dwordx4 v7, s[48:51], s14 offen offset:3072 lds
    s_add_u32 m0, s20, 49152
    s_mul_i32 s14, s74, 6
    buffer_load_dwordx4 v4, s[48:51], s14 offen offset:0 lds
    buffer_load_dwordx4 v5, s[48:51], s14 offen offset:1024 lds
    buffer_load_dwordx4 v6, s[48:51], s14 offen offset:2048 lds
    buffer_load_dwordx4 v7, s[48:51], s14 offen offset:3072 lds
    s_mov_b64 exec, 0
    s_call_b64 s[10:11], L_wc_G
    s_mov_b64 exec, -1
    s_mov_b64 exec, 0
    s_call_b64 s[10:11], L_wc_S
    s_mov_b64 exec, -1
    v_bfe_u32 v1, v2, 2, 2
    v_lshrrev_b32 v3, 4, v2
    v_lshl_add_u32 v31, v3, 3, v1
    v_lshlrev_b32 v31, 8, v31
    v_and_b32 v3, 1, v3
    v_lshl_add_u32 v1, v3, 2, v1
    v_and_b32 v3, 3, v2
    v_lshl_add_u32 v31, v3, 3, v31
    s_lshl_b32 s7, s3, 1
    v_xor_b32 v1, s7, v1
    v_lshl_add_u32 v12, v1, 5, v31
    v_xor_b32 v13, 32, v12
    v_add_u32 v14, 0x10000, v12
    v_add_u32 v15, 0x10000, v13
    v_add_u32 v16, 90112, v21
    v_add_u32 v17, 126976, v21
    s_and_b32 s4, s19, 1
    s_lshl2_add_u32 s4, s4, s3
    s_lshl_b32 s4, s4, 5
    v_min_u32 v28, 31, v2
    v_add_u32 v28, s4, v28
    v_and_b32 v29, 3, v28
    v_lshrrev_b32 v28, 2, v28
    v_lshlrev_b32 v28, 7, v28
    v_lshl_add_u32 v28, v29, 2, v28
    v_add_u32 v28, 8863744, v28
    buffer_load_dword v29, v28, s[44:47], 0 offen offset:0 sc1
    s_waitcnt lgkmcnt(0)
    s_barrier
    ds_read_b64_tr_b16 a[0:1], v14 offset:32768
    ds_read_b64_tr_b16 a[2:3], v14 offset:33792
    ds_read_b64_tr_b16 a[4:5], v15 offset:32768
    ds_read_b64_tr_b16 a[6:7], v15 offset:33792
    ds_read_b64_tr_b16 a[8:9], v14 offset:40960
    ds_read_b64_tr_b16 a[10:11], v14 offset:41984
    ds_read_b64_tr_b16 a[12:13], v15 offset:40960
    ds_read_b64_tr_b16 a[14:15], v15 offset:41984
    s_xor_b32 s4, s19, 1
    s_mov_b32 s5, 247192
    s_cmp_eq_u32 s4, 1
    s_cselect_b32 s5, 255256, s5
    s_cmp_eq_u32 s4, 4
    s_cselect_b32 s5, 255256, s5
    s_lshr_b32 s6, s3, 1
    s_mul_i32 s6, s6, 3
    s_lshr_b32 s5, s5, s6
    s_and_b32 s7, s3, 1
    s_mul_i32 s7, s7, 49152
    s_add_u32 s7, s7, 4096
    s_lshl_b32 s4, s4, 11
    s_waitcnt lgkmcnt(0)
    s_barrier
    ds_read_b64_tr_b16 a[16:17], v14 offset:16384
    ds_read_b64_tr_b16 a[18:19], v14 offset:17408
    ds_read_b64_tr_b16 a[20:21], v15 offset:16384
    ds_read_b64_tr_b16 a[22:23], v15 offset:17408
    ds_read_b64_tr_b16 a[24:25], v14 offset:24576
    ds_read_b64_tr_b16 a[26:27], v14 offset:25600
    ds_read_b64_tr_b16 a[28:29], v15 offset:24576
    ds_read_b64_tr_b16 a[30:31], v15 offset:25600
    s_add_u32 s4, s4, s7
    s_bfe_u32 s8, s5, 0x30000
    s_lshl_b32 s8, s8, 8
    s_add_u32 s8, s8, s4
    s_sub_u32 s8, s8, 0
    v_add_u32 v18, s8, v22
    s_bfe_u32 s8, s5, 0x30006
    s_lshl_b32 s8, s8, 8
    s_add_u32 s8, s8, s4
    s_sub_u32 s8, s8, 1024
    v_add_u32 v19, s8, v22
    s_waitcnt vmcnt(18) lgkmcnt(0)
    s_barrier
    ds_read_b64_tr_b16 a[32:33], v14 offset:0
    ds_read_b64_tr_b16 a[34:35], v14 offset:1024
    ds_read_b64_tr_b16 a[36:37], v15 offset:0
    ds_read_b64_tr_b16 a[38:39], v15 offset:1024
    ds_read_b64_tr_b16 a[40:41], v14 offset:8192
    ds_read_b64_tr_b16 a[42:43], v14 offset:9216
    ds_read_b64_tr_b16 a[44:45], v15 offset:8192
    ds_read_b64_tr_b16 a[46:47], v15 offset:9216
    s_bfe_u32 s8, s5, 0x3000c
    s_lshl_b32 s8, s8, 8
    s_add_u32 s8, s8, s4
    s_sub_u32 s8, s8, 2048
    v_add_u32 v20, s8, v22
    s_mov_b32 s31, 247192
    s_cmp_eq_u32 s19, 1
    s_cselect_b32 s31, 255256, s31
    s_cmp_eq_u32 s19, 4
    s_cselect_b32 s31, 255256, s31
    s_lshl_b32 s4, s19, 11
    s_add_u32 s17, s4, s7
    s_waitcnt vmcnt(13) lgkmcnt(0)
    s_barrier
    ds_read_b64_tr_b16 a[48:49], v12 offset:0
    ds_read_b64_tr_b16 a[50:51], v12 offset:1024
    ds_read_b64_tr_b16 a[52:53], v13 offset:0
    ds_read_b64_tr_b16 a[54:55], v13 offset:1024
    ds_read_b64_tr_b16 a[56:57], v12 offset:8192
    ds_read_b64_tr_b16 a[58:59], v12 offset:9216
    ds_read_b64_tr_b16 a[60:61], v13 offset:8192
    ds_read_b64_tr_b16 a[62:63], v13 offset:9216
    v_and_b32 v129, 0xffff0000, v148
    v_lshlrev_b32 v128, 16, v148
    v_and_b32 v131, 0xffff0000, v149
    v_lshlrev_b32 v130, 16, v149
    v_and_b32 v133, 0xffff0000, v150
    v_lshlrev_b32 v132, 16, v150
    v_and_b32 v135, 0xffff0000, v151
    v_lshlrev_b32 v134, 16, v151
    s_waitcnt vmcnt(0)
    v_cmp_ne_u32 vcc, s16, v29
    s_cbranch_vccnz L_rs_ph
L_ok_ph:
    s_waitcnt lgkmcnt(0)
    s_barrier
    s_add_u32 m0, s21, 24576
    s_nop 0
    buffer_load_dwordx4 v18, s[44:47], s68 offen offset:0 sc1 lds
    buffer_load_dwordx4 v19, s[44:47], s68 offen offset:1024 sc1 lds
    buffer_load_dwordx4 v20, s[44:47], s68 offen offset:2048 sc1 lds
    s_add_u32 m0, s21, 36864
    s_nop 0
    buffer_load_dwordx4 v18, s[44:47], s69 offen offset:0 sc1 lds
    buffer_load_dwordx4 v19, s[44:47], s69 offen offset:1024 sc1 lds
    buffer_load_dwordx4 v20, s[44:47], s69 offen offset:2048 sc1 lds
    s_add_u32 m0, s21, 49152
    s_nop 0
    buffer_load_dwordx4 v18, s[44:47], s70 offen offset:0 sc1 lds
    buffer_load_dwordx4 v19, s[44:47], s70 offen offset:1024 sc1 lds
    buffer_load_dwordx4 v20, s[44:47], s70 offen offset:2048 sc1 lds
    s_add_u32 m0, s21, 61440
    s_nop 0
    buffer_load_dwordx4 v18, s[44:47], s71 offen offset:0 sc1 lds
    buffer_load_dwordx4 v19, s[44:47], s71 offen offset:1024 sc1 lds
    buffer_load_dwordx4 v20, s[44:47], s71 offen offset:2048 sc1 lds
    s_waitcnt vmcnt(9)
    s_barrier
    ds_read_b128 v[32:35], v16 offset:24576
    ds_read_b128 v[36:39], v16 offset:27648
    ds_read_b128 v[40:43], v16 offset:30720
    ds_read_b128 v[44:47], v16 offset:33792
    ds_read_b128 v[48:51], v16 offset:25600
    ds_read_b128 v[52:55], v16 offset:28672
    s_waitcnt lgkmcnt(4)
    v_mfma_f32_16x16x32_bf16 v[64:67], a[0:3], v[32:35], v[128:131]
    ds_read_b128 v[56:59], v16 offset:31744
    v_mfma_f32_16x16x32_bf16 v[64:67], a[8:11], v[36:39], v[64:67]
    v_mfma_f32_16x16x32_bf16 v[68:71], a[12:15], v[36:39], v[132:135]
    s_add_u32 m0, s20, 0
    ds_read_b128 v[60:63], v16 offset:34816
    s_mul_i32 s14, s75, 6
    v_mfma_f32_16x16x32_bf16 v[68:71], a[4:7], v[32:35], v[68:71]
    s_waitcnt lgkmcnt(4)
    buffer_load_dwordx4 v4, s[48:51], s14 offen offset:0 lds
    v_mfma_f32_16x16x32_bf16 v[76:79], a[4:7], v[40:43], v[132:135]
    ds_read_b128 v[32:35], v16 offset:26624
    v_mfma_f32_16x16x32_bf16 v[76:79], a[12:15], v[44:47], v[76:79]
    buffer_load_dwordx4 v5, s[48:51], s14 offen offset:1024 lds
    v_mfma_f32_16x16x32_bf16 v[72:75], a[8:11], v[44:47], v[128:131]
    ds_read_b128 v[36:39], v16 offset:29696
    v_lshrrev_b32 v1, 4, v2
    v_and_b32 v3, 15, v2
    v_lshlrev_b32 v31, 1, v1
    v_xor_b32 v3, v3, v31
    v_lshlrev_b32 v1, 12, v1
    v_and_b32 v31, 7, v3
    v_lshl_add_u32 v1, v31, 4, v1
    s_lshr_b32 s4, s3, 1
    s_lshl_b32 s4, s4, 2
    s_and_b32 s5, s3, 1
    s_add_u32 s4, s4, s5
    s_lshl_b32 s4, s4, 15
    v_add_u32 v1, s4, v1
    v_mov_b32 v31, s40
    v_mov_b32 v11, s41
    v_mfma_f32_16x16x32_bf16 v[72:75], a[0:3], v[40:43], v[72:75]
    s_waitcnt lgkmcnt(4)
    buffer_load_dwordx4 v6, s[48:51], s14 offen offset:2048 lds
    v_mfma_f32_16x16x32_bf16 v[80:83], a[0:3], v[48:51], v[128:131]
    ds_read_b128 v[40:43], v16 offset:32768
    v_mfma_f32_16x16x32_bf16 v[80:83], a[8:11], v[52:55], v[80:83]
    buffer_load_dwordx4 v7, s[48:51], s14 offen offset:3072 lds
    v_mfma_f32_16x16x32_bf16 v[84:87], a[12:15], v[52:55], v[132:135]
    ds_read_b128 v[44:47], v16 offset:35840
    v_mfma_f32_16x16x32_bf16 v[84:87], a[4:7], v[48:51], v[84:87]
    s_waitcnt vmcnt(10) lgkmcnt(4)
    s_barrier
    v_mfma_f32_16x16x32_bf16 v[92:95], a[4:7], v[56:59], v[132:135]
    s_add_u32 m0, s21, 0
    ds_read_b128 v[48:51], v17 offset:0
    v_mfma_f32_16x16x32_bf16 v[92:95], a[12:15], v[60:63], v[92:95]
    buffer_load_dwordx4 v18, s[44:47], s72 offen offset:0 sc1 lds
    ds_read_b64_tr_b16 a[64:65], v12 offset:16384
    v_mfma_f32_16x16x32_bf16 v[88:91], a[8:11], v[60:63], v[128:131]
    ds_read_b128 v[52:55], v17 offset:3072
    v_mfma_f32_16x16x32_bf16 v[88:91], a[0:3], v[56:59], v[88:91]
    s_waitcnt lgkmcnt(5)
    buffer_load_dwordx4 v19, s[44:47], s72 offen offset:1024 sc1 lds
    ds_read_b64_tr_b16 a[66:67], v12 offset:17408
    v_mfma_f32_16x16x32_bf16 v[96:99], a[0:3], v[32:35], v[128:131]
    ds_read_b128 v[56:59], v17 offset:6144
    v_mfma_f32_16x16x32_bf16 v[96:99], a[8:11], v[36:39], v[96:99]
    buffer_load_dwordx4 v20, s[44:47], s72 offen offset:2048 sc1 lds
    v_mfma_f32_16x16x32_bf16 v[100:103], a[12:15], v[36:39], v[132:135]
    s_add_u32 m0, s21, 12288
    ds_read_b128 v[60:63], v17 offset:9216
    v_cmp_lt_u32 vcc, 7, v3
    s_nop 1
    v_cndmask_b32 v8, v31, v11, vcc
    v_cndmask_b32 v10, v11, v31, vcc
    v_add_u32 v8, v8, v1
    v_add_u32 v10, v10, v1
    v_add_u32 v9, 64512, v8
    v_add_u32 v10, 14336, v10
    v_add_u32 v11, 64512, v10
    s_mov_b32 s4, 141658144
    s_cmp_eq_u32 s22, 1
    s_cselect_b32 s4, 271646849, s4
    s_cmp_eq_u32 s22, 2
    s_cselect_b32 s4, 137401346, s4
    s_cmp_eq_u32 s22, 3
    s_cselect_b32 s4, 136512515, s4
    s_bfe_u32 s84, s4, 0x50000
    s_bfe_u32 s85, s4, 0x50005
    s_bfe_u32 s86, s4, 0x5000a
    s_bfe_u32 s87, s4, 0x5000f
    s_bfe_u32 s88, s4, 0x50014
    v_mfma_f32_16x16x32_bf16 v[100:103], a[4:7], v[32:35], v[100:103]
    s_waitcnt lgkmcnt(6)
    buffer_load_dwordx4 v18, s[44:47], s73 offen offset:0 sc1 lds
    ds_read_b64_tr_b16 a[68:69], v13 offset:16384
    v_mfma_f32_16x16x32_bf16 v[108:111], a[4:7], v[40:43], v[132:135]
    ds_read_b128 v[32:35], v17 offset:1024
    v_mfma_f32_16x16x32_bf16 v[108:111], a[12:15], v[44:47], v[108:111]
    buffer_load_dwordx4 v19, s[44:47], s73 offen offset:1024 sc1 lds
    ds_read_b64_tr_b16 a[70:71], v13 offset:17408
    v_mfma_f32_16x16x32_bf16 v[104:107], a[8:11], v[44:47], v[128:131]
    ds_read_b128 v[36:39], v17 offset:4096
    v_mfma_f32_16x16x32_bf16 v[104:107], a[0:3], v[40:43], v[104:107]
    s_waitcnt lgkmcnt(7)
    v_mfma_f32_16x16x32_bf16 v[64:67], a[16:19], v[48:51], v[64:67]
    ds_read_b128 v[40:43], v17 offset:7168
    v_mfma_f32_16x16x32_bf16 v[64:67], a[24:27], v[52:55], v[64:67]
    ds_read_b64_tr_b16 a[72:73], v12 offset:24576
    v_mfma_f32_16x16x32_bf16 v[68:71], a[28:31], v[52:55], v[68:71]
    ds_read_b128 v[44:47], v17 offset:10240
    v_mfma_f32_16x16x32_bf16 v[68:71], a[20:23], v[48:51], v[68:71]
    s_waitcnt lgkmcnt(7)
    ds_read_b64_tr_b16 a[74:75], v12 offset:25600
    v_mfma_f32_16x16x32_bf16 v[76:79], a[20:23], v[56:59], v[76:79]
    ds_read_b128 v[48:51], v17 offset:2048
    v_mfma_f32_16x16x32_bf16 v[76:79], a[28:31], v[60:63], v[76:79]
    v_mfma_f32_16x16x32_bf16 v[72:75], a[24:27], v[60:63], v[72:75]
    ds_read_b128 v[52:55], v17 offset:5120
    s_bfe_u32 s89, s4, 0x50019
    s_mov_b32 s4, 345255109
    s_cmp_eq_u32 s22, 1
    s_cselect_b32 s4, 345382085, s4
    s_cmp_eq_u32 s22, 2
    s_cselect_b32 s4, 349445321, s4
L_pl_G_1:
    s_cbranch_execz L_pl_G_5
    s_cmp_eq_u32 s22, 3
    s_cselect_b32 s4, 479468869, s4
    s_bfe_u32 s90, s4, 0x50000
    s_bfe_u32 s91, s4, 0x50005
    s_bfe_u32 s92, s4, 0x5000a
    s_bfe_u32 s93, s4, 0x5000f
    s_bfe_u32 s94, s4, 0x50014
    s_bfe_u32 s95, s4, 0x50019
    s_mov_b32 s4, 587675023
    s_cmp_eq_u32 s22, 1
    s_cselect_b32 s4, 586626571, s4
    s_cmp_eq_u32 s22, 2
    s_cselect_b32 s4, 553076107, s4
    s_cmp_eq_u32 s22, 3
    s_cselect_b32 s4, 587707787, s4
    s_bfe_u32 s96, s4, 0x50000
    v_mfma_f32_16x16x32_bf16 v[72:75], a[16:19], v[56:59], v[72:75]
    s_waitcnt lgkmcnt(6)
    ds_read_b64_tr_b16 a[76:77], v13 offset:24576
    v_mfma_f32_16x16x32_bf16 v[80:83], a[16:19], v[32:35], v[80:83]
    ds_read_b128 v[56:59], v17 offset:8192
    v_mfma_f32_16x16x32_bf16 v[80:83], a[24:27], v[36:39], v[80:83]
    buffer_load_dwordx4 v20, s[44:47], s73 offen offset:2048 sc1 lds
    ds_read_b64_tr_b16 a[78:79], v13 offset:25600
    v_mfma_f32_16x16x32_bf16 v[84:87], a[28:31], v[36:39], v[84:87]
    ds_read_b128 v[60:63], v17 offset:11264
    v_mfma_f32_16x16x32_bf16 v[84:87], a[20:23], v[32:35], v[84:87]
    s_waitcnt vmcnt(13) lgkmcnt(1)
    s_barrier
    v_mfma_f32_16x16x32_bf16 v[92:95], a[20:23], v[40:43], v[92:95]
    ds_read_b128 v[32:35], v17 offset:12288
    v_mfma_f32_16x16x32_bf16 v[92:95], a[28:31], v[44:47], v[92:95]
    ds_read_b64_tr_b16 a[80:81], v12 offset:32768
    v_mfma_f32_16x16x32_bf16 v[88:91], a[24:27], v[44:47], v[88:91]
    s_add_u32 m0, s20, 16384
    ds_read_b128 v[36:39], v17 offset:15360
    s_mul_i32 s14, s76, 6
    v_mfma_f32_16x16x32_bf16 v[88:91], a[16:19], v[40:43], v[88:91]
    buffer_load_dwordx4 v4, s[48:51], s14 offen offset:0 lds
    ds_read_b64_tr_b16 a[82:83], v12 offset:33792
    v_mfma_f32_16x16x32_bf16 v[96:99], a[16:19], v[48:51], v[96:99]
    ds_read_b128 v[40:43], v17 offset:18432
    v_mfma_f32_16x16x32_bf16 v[96:99], a[24:27], v[52:55], v[96:99]
    v_mfma_f32_16x16x32_bf16 v[100:103], a[28:31], v[52:55], v[100:103]
    ds_read_b128 v[44:47], v17 offset:21504
    s_bfe_u32 s97, s4, 0x50005
    s_bfe_u32 s98, s4, 0x5000a
    s_bfe_u32 s99, s4, 0x5000f
    s_bfe_u32 s100, s4, 0x50014
    s_bfe_u32 s101, s4, 0x50019
    s_mul_i32 s4, s23, 18
    s_add_u32 s84, s84, s4
    s_lshl_b32 s84, s84, 17
    s_add_u32 s85, s85, s4
    s_lshl_b32 s85, s85, 17
    s_add_u32 s86, s86, s4
    s_lshl_b32 s86, s86, 17
    s_add_u32 s87, s87, s4
    s_lshl_b32 s87, s87, 17
    s_add_u32 s88, s88, s4
    v_mfma_f32_16x16x32_bf16 v[100:103], a[20:23], v[48:51], v[100:103]
    s_waitcnt lgkmcnt(6)
    buffer_load_dwordx4 v5, s[48:51], s14 offen offset:1024 lds
    ds_read_b64_tr_b16 a[84:85], v13 offset:32768
    v_mfma_f32_16x16x32_bf16 v[108:111], a[20:23], v[56:59], v[108:111]
    ds_read_b128 v[48:51], v17 offset:13312
    v_mfma_f32_16x16x32_bf16 v[108:111], a[28:31], v[60:63], v[108:111]
    buffer_load_dwordx4 v6, s[48:51], s14 offen offset:2048 lds
    ds_read_b64_tr_b16 a[86:87], v13 offset:33792
    v_mfma_f32_16x16x32_bf16 v[104:107], a[24:27], v[60:63], v[104:107]
    ds_read_b128 v[52:55], v17 offset:16384
    v_mfma_f32_16x16x32_bf16 v[104:107], a[16:19], v[56:59], v[104:107]
    s_waitcnt lgkmcnt(7)
    buffer_load_dwordx4 v7, s[48:51], s14 offen offset:3072 lds
    v_mfma_f32_16x16x32_bf16 v[64:67], a[32:35], v[32:35], v[64:67]
    s_add_u32 m0, s21, 24576
    ds_read_b128 v[56:59], v17 offset:19456
    v_mfma_f32_16x16x32_bf16 v[64:67], a[40:43], v[36:39], v[64:67]
    buffer_load_dwordx4 v18, s[44:47], s74 offen offset:0 sc1 lds
    ds_read_b64_tr_b16 a[88:89], v12 offset:40960
    v_mfma_f32_16x16x32_bf16 v[68:71], a[44:47], v[36:39], v[68:71]
    ds_read_b128 v[60:63], v17 offset:22528
    v_mfma_f32_16x16x32_bf16 v[68:71], a[36:39], v[32:35], v[68:71]
    s_waitcnt lgkmcnt(7)
    buffer_load_dwordx4 v19, s[44:47], s74 offen offset:1024 sc1 lds
    ds_read_b64_tr_b16 a[90:91], v12 offset:41984
    v_mfma_f32_16x16x32_bf16 v[76:79], a[36:39], v[40:43], v[76:79]
    ds_read_b128 v[32:35], v17 offset:14336
    v_mfma_f32_16x16x32_bf16 v[76:79], a[44:47], v[44:47], v[76:79]
    buffer_load_dwordx4 v20, s[44:47], s74 offen offset:2048 sc1 lds
    v_mfma_f32_16x16x32_bf16 v[72:75], a[40:43], v[44:47], v[72:75]
    ds_read_b128 v[36:39], v17 offset:17408
    s_lshl_b32 s88, s88, 17
    s_add_u32 s89, s89, s4
    s_lshl_b32 s89, s89, 17
    s_add_u32 s90, s90, s4
    s_lshl_b32 s90, s90, 17
    s_add_u32 s91, s91, s4
    s_lshl_b32 s91, s91, 17
    s_add_u32 s92, s92, s4
    s_lshl_b32 s92, s92, 17
    s_add_u32 s93, s93, s4
    s_lshl_b32 s93, s93, 17
    s_add_u32 s94, s94, s4
    s_lshl_b32 s94, s94, 17
    s_add_u32 s95, s95, s4
    s_lshl_b32 s95, s95, 17
    v_mfma_f32_16x16x32_bf16 v[72:75], a[32:35], v[40:43], v[72:75]
    s_waitcnt lgkmcnt(6)
    ds_read_b64_tr_b16 a[92:93], v13 offset:40960
    v_mfma_f32_16x16x32_bf16 v[80:83], a[32:35], v[48:51], v[80:83]
    ds_read_b128 v[40:43], v17 offset:20480
    v_mfma_f32_16x16x32_bf16 v[80:83], a[40:43], v[52:55], v[80:83]
    ds_read_b64_tr_b16 a[94:95], v13 offset:41984
    v_mfma_f32_16x16x32_bf16 v[84:87], a[44:47], v[52:55], v[84:87]
    ds_read_b128 v[44:47], v17 offset:23552
    v_mfma_f32_16x16x32_bf16 v[84:87], a[36:39], v[48:51], v[84:87]
    s_waitcnt vmcnt(17) lgkmcnt(1)
    s_barrier
    v_mfma_f32_16x16x32_bf16 v[92:95], a[36:39], v[56:59], v[92:95]
    s_add_u32 m0, s20, 32768
    ds_read_b128 v[48:51], v17 offset:24576
    s_mul_i32 s14, s77, 6
    v_mfma_f32_16x16x32_bf16 v[92:95], a[44:47], v[60:63], v[92:95]
    buffer_load_dwordx4 v4, s[48:51], s14 offen offset:0 lds
    ds_read_b64_tr_b16 a[96:97], v12 offset:49152
    v_mfma_f32_16x16x32_bf16 v[88:91], a[40:43], v[60:63], v[88:91]
    ds_read_b128 v[52:55], v17 offset:27648
    v_mfma_f32_16x16x32_bf16 v[88:91], a[32:35], v[56:59], v[88:91]
    buffer_load_dwordx4 v5, s[48:51], s14 offen offset:1024 lds
    ds_read_b64_tr_b16 a[98:99], v12 offset:50176
    v_mfma_f32_16x16x32_bf16 v[96:99], a[32:35], v[32:35], v[96:99]
    ds_read_b128 v[56:59], v17 offset:30720
    v_mfma_f32_16x16x32_bf16 v[96:99], a[40:43], v[36:39], v[96:99]
    buffer_load_dwordx4 v6, s[48:51], s14 offen offset:2048 lds
    v_mfma_f32_16x16x32_bf16 v[100:103], a[44:47], v[36:39], v[100:103]
    ds_read_b128 v[60:63], v17 offset:33792
    s_add_u32 s96, s96, s4
    s_lshl_b32 s96, s96, 17
    s_add_u32 s97, s97, s4
    s_lshl_b32 s97, s97, 17
    s_add_u32 s98, s98, s4
    s_lshl_b32 s98, s98, 17
    s_add_u32 s99, s99, s4
    s_lshl_b32 s99, s99, 17
    s_add_u32 s100, s100, s4
    s_lshl_b32 s100, s100, 17
    s_add_u32 s101, s101, s4
    s_lshl_b32 s101, s101, 17
    s_lshl_b32 s6, s3, 6
    v_add_u32 v142, s6, v2
    v_and_b32 v143, 3, v142
    v_lshrrev_b32 v142, 2, v142
    v_mfma_f32_16x16x32_bf16 v[100:103], a[36:39], v[32:35], v[100:103]
    s_waitcnt lgkmcnt(6)
    buffer_load_dwordx4 v7, s[48:51], s14 offen offset:3072 lds
    ds_read_b64_tr_b16 a[100:101], v13 offset:49152
    v_mfma_f32_16x16x32_bf16 v[108:111], a[36:39], v[40:43], v[108:111]
    s_add_u32 m0, s21, 36864
    ds_read_b128 v[32:35], v17 offset:25600
    v_mfma_f32_16x16x32_bf16 v[108:111], a[44:47], v[44:47], v[108:111]
    buffer_load_dwordx4 v18, s[44:47], s75 offen offset:0 sc1 lds
    ds_read_b64_tr_b16 a[102:103], v13 offset:50176
    v_mfma_f32_16x16x32_bf16 v[104:107], a[40:43], v[44:47], v[104:107]
    ds_read_b128 v[36:39], v17 offset:28672
    v_mfma_f32_16x16x32_bf16 v[104:107], a[32:35], v[40:43], v[104:107]
    s_waitcnt lgkmcnt(7)
    buffer_load_dwordx4 v19, s[44:47], s75 offen offset:1024 sc1 lds
    v_mfma_f32_16x16x32_bf16 v[64:67], a[48:51], v[48:51], v[64:67]
    ds_read_b128 v[40:43], v17 offset:31744
    v_mfma_f32_16x16x32_bf16 v[64:67], a[56:59], v[52:55], v[64:67]
    buffer_load_dwordx4 v20, s[44:47], s75 offen offset:2048 sc1 lds
    ds_read_b64_tr_b16 a[104:105], v12 offset:57344
    v_mfma_f32_16x16x32_bf16 v[68:71], a[60:63], v[52:55], v[68:71]
    ds_read_b128 v[44:47], v17 offset:34816
    v_mfma_f32_16x16x32_bf16 v[68:71], a[52:55], v[48:51], v[68:71]
    s_waitcnt lgkmcnt(7)
    ds_read_b64_tr_b16 a[106:107], v12 offset:58368
    v_mfma_f32_16x16x32_bf16 v[76:79], a[52:55], v[56:59], v[76:79]
    ds_read_b128 v[48:51], v17 offset:26624
    v_mfma_f32_16x16x32_bf16 v[76:79], a[60:63], v[60:63], v[76:79]
    v_mfma_f32_16x16x32_bf16 v[72:75], a[56:59], v[60:63], v[72:75]
    ds_read_b128 v[52:55], v17 offset:29696
    v_lshlrev_b32 v142, 7, v142
    v_lshl_add_u32 v142, v143, 2, v142
    v_add_u32 v142, 8871936, v142
    s_mov_b32 s60, s24
    s_and_b32 s61, s25, 0xffff
    s_mov_b32 s62, 2359296
    s_mov_b32 s63, 0x20000
    s_lshl_b32 s12, s34, 12
    s_lshl_b32 s8, s3, 10
    s_add_u32 s12, s12, s8
    s_lshr_b32 s9, s34, 4
    s_mul_i32 s8, s9, 43
    s_lshr_b32 s8, s8, 7
    s_add_u32 s15, s9, s8
    s_mul_i32 s8, s8, 3
    v_mfma_f32_16x16x32_bf16 v[72:75], a[48:51], v[56:59], v[72:75]
    s_waitcnt lgkmcnt(6)
    ds_read_b64_tr_b16 a[108:109], v13 offset:57344
    v_mfma_f32_16x16x32_bf16 v[80:83], a[48:51], v[32:35], v[80:83]
    ds_read_b128 v[56:59], v17 offset:32768
    v_mfma_f32_16x16x32_bf16 v[80:83], a[56:59], v[36:39], v[80:83]
    ds_read_b64_tr_b16 a[110:111], v13 offset:58368
    v_mfma_f32_16x16x32_bf16 v[84:87], a[60:63], v[36:39], v[84:87]
    ds_read_b128 v[60:63], v17 offset:35840
    v_mfma_f32_16x16x32_bf16 v[84:87], a[52:55], v[32:35], v[84:87]
    s_waitcnt vmcnt(17) lgkmcnt(1)
    s_barrier
    v_mfma_f32_16x16x32_bf16 v[92:95], a[52:55], v[40:43], v[92:95]
    s_add_u32 m0, s20, 49152
    ds_read_b128 v[32:35], v16 offset:0
    s_mul_i32 s14, s78, 6
    v_mfma_f32_16x16x32_bf16 v[92:95], a[60:63], v[44:47], v[92:95]
    buffer_load_dwordx4 v4, s[48:51], s14 offen offset:0 lds
    ds_read_b64_tr_b16 a[112:113], v12 offset:0
    v_mfma_f32_16x16x32_bf16 v[88:91], a[56:59], v[44:47], v[88:91]
    ds_read_b128 v[36:39], v16 offset:3072
    v_mfma_f32_16x16x32_bf16 v[88:91], a[48:51], v[40:43], v[88:91]
    buffer_load_dwordx4 v5, s[48:51], s14 offen offset:1024 lds
    ds_read_b64_tr_b16 a[114:115], v12 offset:1024
    v_mfma_f32_16x16x32_bf16 v[96:99], a[48:51], v[48:51], v[96:99]
    ds_read_b128 v[40:43], v16 offset:6144
    v_mfma_f32_16x16x32_bf16 v[96:99], a[56:59], v[52:55], v[96:99]
    buffer_load_dwordx4 v6, s[48:51], s14 offen offset:2048 lds
    v_mfma_f32_16x16x32_bf16 v[100:103], a[60:63], v[52:55], v[100:103]
    ds_read_b128 v[44:47], v16 offset:9216
    s_sub_u32 s8, s9, s8
    s_min_u32 s8, s8, 1
    s_add_u32 s15, s15, s8
    s_lshl_b32 s15, s15, 8
    s_and_b32 s8, s34, 15
    s_lshl4_add_u32 s15, s8, s15
    s_mul_i32 s8, s3, 786432
    s_add_u32 s15, s15, s8
    s_add_u32 s15, s15, 3211264
    v_mul_u32_u24 v147, 12288, v2
    s_lshr_b32 s10, s20, 2
    s_mul_i32 s4, s18, 6
    s_add_u32 s4, s4, s19
    s_lshl2_add_u32 s5, s4, s3
    s_xor_b32 s6, s5, 4
    s_mul_i32 s43, s5, 6144
    v_mfma_f32_16x16x32_bf16 v[100:103], a[52:55], v[48:51], v[100:103]
    s_waitcnt lgkmcnt(6)
    buffer_load_dwordx4 v7, s[48:51], s14 offen offset:3072 lds
    ds_read_b64_tr_b16 a[116:117], v13 offset:0
    v_mfma_f32_16x16x32_bf16 v[108:111], a[52:55], v[56:59], v[108:111]
    s_add_u32 m0, s21, 49152
    ds_read_b128 v[48:51], v16 offset:1024
    v_mfma_f32_16x16x32_bf16 v[108:111], a[60:63], v[60:63], v[108:111]
    buffer_load_dwordx4 v18, s[44:47], s76 offen offset:0 sc1 lds
    ds_read_b64_tr_b16 a[118:119], v13 offset:1024
    v_mfma_f32_16x16x32_bf16 v[104:107], a[56:59], v[60:63], v[104:107]
    ds_read_b128 v[52:55], v16 offset:4096
    v_mfma_f32_16x16x32_bf16 v[104:107], a[48:51], v[56:59], v[104:107]
    s_waitcnt lgkmcnt(7)
    buffer_load_dwordx4 v19, s[44:47], s76 offen offset:1024 sc1 lds
    v_mfma_f32_16x16x32_bf16 v[64:67], a[64:67], v[32:35], v[64:67]
    ds_read_b128 v[56:59], v16 offset:7168
    v_mfma_f32_16x16x32_bf16 v[64:67], a[72:75], v[36:39], v[64:67]
    s_add_u32 s43, s43, 9175040
    buffer_load_dwordx4 v20, s[44:47], s76 offen offset:2048 sc1 lds
    ds_read_b64_tr_b16 a[120:121], v12 offset:8192
    v_mfma_f32_16x16x32_bf16 v[68:71], a[76:79], v[36:39], v[68:71]
    ds_read_b128 v[60:63], v16 offset:10240
    v_mfma_f32_16x16x32_bf16 v[68:71], a[68:71], v[32:35], v[68:71]
    s_waitcnt lgkmcnt(7)
    s_mul_i32 s42, s6, 6144
    ds_read_b64_tr_b16 a[122:123], v12 offset:9216
    v_mfma_f32_16x16x32_bf16 v[76:79], a[68:71], v[40:43], v[76:79]
    ds_read_b128 v[32:35], v16 offset:2048
    v_mfma_f32_16x16x32_bf16 v[76:79], a[76:79], v[44:47], v[76:79]
    s_add_u32 s42, s42, 9175040
    v_mfma_f32_16x16x32_bf16 v[72:75], a[72:75], v[44:47], v[72:75]
    ds_read_b128 v[36:39], v16 offset:5120
    v_mfma_f32_16x16x32_bf16 v[72:75], a[64:67], v[40:43], v[72:75]
    s_waitcnt lgkmcnt(6)
    ds_read_b64_tr_b16 a[124:125], v13 offset:8192
    v_mfma_f32_16x16x32_bf16 v[80:83], a[64:67], v[48:51], v[80:83]
    s_lshl_b32 s4, s18, 1
    ds_read_b128 v[40:43], v16 offset:8192
    v_mfma_f32_16x16x32_bf16 v[80:83], a[72:75], v[52:55], v[80:83]
    ds_read_b64_tr_b16 a[126:127], v13 offset:9216
    v_mfma_f32_16x16x32_bf16 v[84:87], a[76:79], v[52:55], v[84:87]
    s_lshr_b32 s5, s3, 1
    ds_read_b128 v[44:47], v16 offset:11264
    v_mfma_f32_16x16x32_bf16 v[84:87], a[68:71], v[48:51], v[84:87]
    s_waitcnt vmcnt(17) lgkmcnt(1)
    s_barrier
    v_mfma_f32_16x16x32_bf16 v[92:95], a[68:71], v[56:59], v[92:95]
    s_add_u32 m0, s20, 0
    ds_read_b128 v[48:51], v16 offset:12288
    s_mul_i32 s14, s79, 6
    v_mfma_f32_16x16x32_bf16 v[92:95], a[76:79], v[60:63], v[92:95]
    s_add_u32 s4, s4, s5
    buffer_load_dwordx4 v4, s[48:51], s14 offen offset:0 lds
    ds_read_b64_tr_b16 a[128:129], v12 offset:16384
    v_mfma_f32_16x16x32_bf16 v[88:91], a[72:75], v[60:63], v[88:91]
    ds_read_b128 v[52:55], v16 offset:15360
    v_mfma_f32_16x16x32_bf16 v[88:91], a[64:67], v[56:59], v[88:91]
    s_lshl_b32 s4, s4, 17
    buffer_load_dwordx4 v5, s[48:51], s14 offen offset:1024 lds
    ds_read_b64_tr_b16 a[130:131], v12 offset:17408
    v_mfma_f32_16x16x32_bf16 v[96:99], a[64:67], v[32:35], v[96:99]
    ds_read_b128 v[56:59], v16 offset:18432
    v_mfma_f32_16x16x32_bf16 v[96:99], a[72:75], v[36:39], v[96:99]
    s_and_b32 s5, s3, 1
    v_mfma_f32_16x16x32_bf16 v[100:103], a[76:79], v[36:39], v[100:103]
    ds_read_b128 v[60:63], v16 offset:21504
    v_mfma_f32_16x16x32_bf16 v[100:103], a[68:71], v[32:35], v[100:103]
    s_waitcnt lgkmcnt(6)
    ds_read_b64_tr_b16 a[132:133], v13 offset:16384
    v_mfma_f32_16x16x32_bf16 v[108:111], a[68:71], v[40:43], v[108:111]
    s_mul_i32 s5, s5, 49152
    ds_read_b128 v[32:35], v16 offset:13312
    v_mfma_f32_16x16x32_bf16 v[108:111], a[76:79], v[44:47], v[108:111]
    ds_read_b64_tr_b16 a[134:135], v13 offset:17408
    v_mfma_f32_16x16x32_bf16 v[104:107], a[72:75], v[44:47], v[104:107]
    s_add_u32 s4, s4, s5
    ds_read_b128 v[36:39], v16 offset:16384
    v_mfma_f32_16x16x32_bf16 v[104:107], a[64:67], v[40:43], v[104:107]
    s_waitcnt lgkmcnt(7)
    v_mfma_f32_16x16x32_bf16 v[64:67], a[80:83], v[48:51], v[64:67]
    s_lshl_b32 s5, s19, 11
    ds_read_b128 v[40:43], v16 offset:19456
    v_mfma_f32_16x16x32_bf16 v[64:67], a[88:91], v[52:55], v[64:67]
    ds_read_b64_tr_b16 a[136:137], v12 offset:24576
    v_mfma_f32_16x16x32_bf16 v[68:71], a[92:95], v[52:55], v[68:71]
    ds_read_b128 v[44:47], v16 offset:22528
    v_mfma_f32_16x16x32_bf16 v[68:71], a[84:87], v[48:51], v[68:71]
    s_waitcnt lgkmcnt(7)
    s_add_u32 s4, s4, s5
    ds_read_b64_tr_b16 a[138:139], v12 offset:25600
    v_mfma_f32_16x16x32_bf16 v[76:79], a[84:87], v[56:59], v[76:79]
    ds_read_b128 v[48:51], v16 offset:14336
    v_mfma_f32_16x16x32_bf16 v[76:79], a[92:95], v[60:63], v[76:79]
    s_add_u32 s30, s4, 22872064
    buffer_load_dwordx4 v6, s[48:51], s14 offen offset:2048 lds
    v_mfma_f32_16x16x32_bf16 v[72:75], a[88:91], v[60:63], v[72:75]
    ds_read_b128 v[52:55], v16 offset:17408
    v_mfma_f32_16x16x32_bf16 v[72:75], a[80:83], v[56:59], v[72:75]
    s_waitcnt lgkmcnt(6)
    buffer_load_dwordx4 v7, s[48:51], s14 offen offset:3072 lds
    ds_read_b64_tr_b16 a[140:141], v13 offset:24576
    v_mfma_f32_16x16x32_bf16 v[80:83], a[80:83], v[32:35], v[80:83]
    s_add_u32 m0, s21, 61440
    ds_read_b128 v[56:59], v16 offset:20480
    v_mfma_f32_16x16x32_bf16 v[80:83], a[88:91], v[36:39], v[80:83]
    buffer_load_dwordx4 v18, s[44:47], s77 offen offset:0 sc1 lds
    ds_read_b64_tr_b16 a[142:143], v13 offset:25600
    v_mfma_f32_16x16x32_bf16 v[84:87], a[92:95], v[36:39], v[84:87]
    ds_read_b128 v[60:63], v16 offset:23552
    v_mfma_f32_16x16x32_bf16 v[84:87], a[84:87], v[32:35], v[84:87]
    s_waitcnt vmcnt(15) lgkmcnt(1)
    s_barrier
    s_cmp_ge_u32 s19, 3
    s_cselect_b32 s5, 3, 0
    s_cselect_b32 s4, 1, 0
    v_mfma_f32_16x16x32_bf16 v[92:95], a[84:87], v[40:43], v[92:95]
    s_sub_u32 s5, s19, s5
    ds_read_b128 v[32:35], v16 offset:24576
    s_lshl1_add_u32 s4, s18, s4
    v_mfma_f32_16x16x32_bf16 v[92:95], a[92:95], v[44:47], v[92:95]
    buffer_load_dwordx4 v19, s[44:47], s77 offen offset:1024 sc1 lds
    ds_read_b64_tr_b16 a[144:145], v12 offset:32768
    v_mfma_f32_16x16x32_bf16 v[88:91], a[88:91], v[44:47], v[88:91]
    s_lshl_b32 s4, s4, 7
    ds_read_b128 v[36:39], v16 offset:27648
    v_mfma_f32_16x16x32_bf16 v[88:91], a[80:83], v[40:43], v[88:91]
    buffer_load_dwordx4 v20, s[44:47], s77 offen offset:2048 sc1 lds
    ds_read_b64_tr_b16 a[146:147], v12 offset:33792
    v_mfma_f32_16x16x32_bf16 v[96:99], a[80:83], v[48:51], v[96:99]
    ds_read_b128 v[40:43], v16 offset:30720
    v_mfma_f32_16x16x32_bf16 v[96:99], a[88:91], v[52:55], v[96:99]
    s_lshl2_add_u32 s4, s5, s4
    v_mfma_f32_16x16x32_bf16 v[100:103], a[92:95], v[52:55], v[100:103]
    s_add_u32 m0, s20, 16384
    ds_read_b128 v[44:47], v16 offset:33792
    s_mul_i32 s14, s80, 6
    v_mfma_f32_16x16x32_bf16 v[100:103], a[84:87], v[48:51], v[100:103]
    s_waitcnt lgkmcnt(6)
    s_add_u32 s32, s4, 8994816
    buffer_load_dwordx4 v4, s[48:51], s14 offen offset:0 lds
    ds_read_b64_tr_b16 a[148:149], v13 offset:32768
    v_mfma_f32_16x16x32_bf16 v[108:111], a[84:87], v[56:59], v[108:111]
    s_cmp_lt_u32 s3, 2
    s_cselect_b32 s68, s68, s69
    ds_read_b128 v[48:51], v16 offset:25600
    v_mfma_f32_16x16x32_bf16 v[108:111], a[92:95], v[60:63], v[108:111]
    s_mov_b32 s64, s38
    buffer_load_dwordx4 v5, s[48:51], s14 offen offset:1024 lds
    ds_read_b64_tr_b16 a[150:151], v13 offset:33792
    v_mfma_f32_16x16x32_bf16 v[104:107], a[88:91], v[60:63], v[104:107]
    ds_read_b128 v[52:55], v16 offset:28672
    v_mfma_f32_16x16x32_bf16 v[104:107], a[80:83], v[56:59], v[104:107]
    s_waitcnt lgkmcnt(7)
    v_mfma_f32_16x16x32_bf16 v[64:67], a[96:99], v[32:35], v[64:67]
    s_and_b32 s65, s39, 0xffff
    ds_read_b128 v[56:59], v16 offset:31744
    v_mfma_f32_16x16x32_bf16 v[64:67], a[104:107], v[36:39], v[64:67]
    ds_read_b64_tr_b16 a[152:153], v12 offset:40960
    v_mfma_f32_16x16x32_bf16 v[68:71], a[108:111], v[36:39], v[68:71]
    s_mov_b32 s66, 2359296
    ds_read_b128 v[60:63], v16 offset:34816
    v_mfma_f32_16x16x32_bf16 v[68:71], a[100:103], v[32:35], v[68:71]
    s_waitcnt lgkmcnt(7)
    ds_read_b64_tr_b16 a[154:155], v12 offset:41984
    v_mfma_f32_16x16x32_bf16 v[76:79], a[100:103], v[40:43], v[76:79]
    s_mov_b32 s67, 0x20000
    ds_read_b128 v[32:35], v16 offset:26624
    v_mfma_f32_16x16x32_bf16 v[76:79], a[108:111], v[44:47], v[76:79]
    buffer_load_dwordx4 v6, s[48:51], s14 offen offset:2048 lds
    v_mfma_f32_16x16x32_bf16 v[72:75], a[104:107], v[44:47], v[72:75]
    s_cmp_lt_u32 s3, 2
    s_cselect_b32 s4, s40, s41
    ds_read_b128 v[36:39], v16 offset:29696
    v_mfma_f32_16x16x32_bf16 v[72:75], a[96:99], v[40:43], v[72:75]
    s_waitcnt lgkmcnt(6)
    buffer_load_dwordx4 v7, s[48:51], s14 offen offset:3072 lds
    ds_read_b64_tr_b16 a[156:157], v13 offset:40960
    v_mfma_f32_16x16x32_bf16 v[80:83], a[96:99], v[48:51], v[80:83]
    s_add_u32 m0, s21, 0
    ds_read_b128 v[40:43], v16 offset:32768
    v_mfma_f32_16x16x32_bf16 v[80:83], a[104:107], v[52:55], v[80:83]
    s_lshr_b32 s4, s4, 1
    buffer_load_dwordx4 v18, s[44:47], s78 offen offset:0 sc1 lds
    ds_read_b64_tr_b16 a[158:159], v13 offset:41984
    v_mfma_f32_16x16x32_bf16 v[84:87], a[108:111], v[52:55], v[84:87]
    ds_read_b128 v[44:47], v16 offset:35840
    v_mfma_f32_16x16x32_bf16 v[84:87], a[100:103], v[48:51], v[84:87]
    s_waitcnt vmcnt(15) lgkmcnt(1)
    s_barrier
    s_and_b32 s5, s3, 1
    v_mfma_f32_16x16x32_bf16 v[92:95], a[100:103], v[56:59], v[92:95]
    s_cmp_lt_u32 s3, 2
    s_cselect_b32 s70, s70, s71
    ds_read_b128 v[48:51], v17 offset:0
    v_mfma_f32_16x16x32_bf16 v[92:95], a[108:111], v[60:63], v[92:95]
    buffer_load_dwordx4 v19, s[44:47], s78 offen offset:1024 sc1 lds
    ds_read_b64_tr_b16 a[160:161], v12 offset:49152
    v_mfma_f32_16x16x32_bf16 v[88:91], a[104:107], v[60:63], v[88:91]
    s_lshl_b32 s5, s5, 5
    ds_read_b128 v[52:55], v17 offset:3072
    v_mfma_f32_16x16x32_bf16 v[88:91], a[96:99], v[56:59], v[88:91]
    buffer_load_dwordx4 v20, s[44:47], s78 offen offset:2048 sc1 lds
    ds_read_b64_tr_b16 a[162:163], v12 offset:50176
    v_mfma_f32_16x16x32_bf16 v[96:99], a[96:99], v[32:35], v[96:99]
    s_add_u32 s4, s4, s5
    ds_read_b128 v[56:59], v17 offset:6144
    v_mfma_f32_16x16x32_bf16 v[96:99], a[104:107], v[36:39], v[96:99]
    v_mfma_f32_16x16x32_bf16 v[100:103], a[108:111], v[36:39], v[100:103]
    s_add_u32 m0, s20, 32768
    ds_read_b128 v[60:63], v17 offset:9216
    s_mul_i32 s14, s81, 6
    v_mfma_f32_16x16x32_bf16 v[100:103], a[100:103], v[32:35], v[100:103]
    s_waitcnt lgkmcnt(6)
    buffer_load_dwordx4 v4, s[48:51], s14 offen offset:0 lds
    ds_read_b64_tr_b16 a[164:165], v13 offset:49152
    v_mfma_f32_16x16x32_bf16 v[108:111], a[100:103], v[40:43], v[108:111]
    ds_read_b128 v[32:35], v17 offset:1024
    v_and_b32 v1, 15, v2
    v_mfma_f32_16x16x32_bf16 v[108:111], a[108:111], v[44:47], v[108:111]
    buffer_load_dwordx4 v5, s[48:51], s14 offen offset:1024 lds
    ds_read_b64_tr_b16 a[166:167], v13 offset:50176
    v_mfma_f32_16x16x32_bf16 v[104:107], a[104:107], v[44:47], v[104:107]
    ds_read_b128 v[36:39], v17 offset:4096
    v_add_u32 v1, s4, v1
    v_mfma_f32_16x16x32_bf16 v[104:107], a[96:99], v[40:43], v[104:107]
    s_waitcnt lgkmcnt(7)
    buffer_load_dwordx4 v6, s[48:51], s14 offen offset:2048 lds
    v_lshlrev_b32 v14, 3, v1
    v_mfma_f32_16x16x32_bf16 v[64:67], a[112:115], v[48:51], v[64:67]
    ds_read_b128 v[40:43], v17 offset:7168
    v_mfma_f32_16x16x32_bf16 v[64:67], a[120:123], v[52:55], v[64:67]
    buffer_load_dwordx4 v7, s[48:51], s14 offen offset:3072 lds
    ds_read_b64_tr_b16 a[168:169], v12 offset:57344
    v_mfma_f32_16x16x32_bf16 v[68:71], a[124:127], v[52:55], v[68:71]
    s_and_b32 s9, s23, 1
    ds_read_b128 v[44:47], v17 offset:10240
    v_mfma_f32_16x16x32_bf16 v[68:71], a[116:119], v[48:51], v[68:71]
    s_waitcnt lgkmcnt(7)
    ds_read_b64_tr_b16 a[170:171], v12 offset:58368
    v_mfma_f32_16x16x32_bf16 v[76:79], a[116:119], v[56:59], v[76:79]
    s_add_u32 m0, s21, 12288
    ds_read_b128 v[48:51], v17 offset:2048
    s_sub_u32 s26, 0, s9
    v_mfma_f32_16x16x32_bf16 v[76:79], a[124:127], v[60:63], v[76:79]
    buffer_load_dwordx4 v18, s[44:47], s79 offen offset:0 sc1 lds
    v_mfma_f32_16x16x32_bf16 v[72:75], a[120:123], v[60:63], v[72:75]
    s_sub_u32 s27, 0, s9
    ds_read_b128 v[52:55], v17 offset:5120
    v_mfma_f32_16x16x32_bf16 v[72:75], a[112:115], v[56:59], v[72:75]
    s_waitcnt lgkmcnt(6)
    buffer_load_dwordx4 v19, s[44:47], s79 offen offset:1024 sc1 lds
    ds_read_b64_tr_b16 a[172:173], v13 offset:57344
    v_mfma_f32_16x16x32_bf16 v[80:83], a[112:115], v[32:35], v[80:83]
    ds_read_b128 v[56:59], v17 offset:8192
    v_mul_u32_u24 v1, 1152, v1
    v_mfma_f32_16x16x32_bf16 v[80:83], a[120:123], v[36:39], v[80:83]
    buffer_load_dwordx4 v20, s[44:47], s79 offen offset:2048 sc1 lds
    ds_read_b64_tr_b16 a[174:175], v13 offset:58368
    v_mfma_f32_16x16x32_bf16 v[84:87], a[124:127], v[36:39], v[84:87]
    ds_read_b128 v[60:63], v17 offset:11264
    v_mfma_f32_16x16x32_bf16 v[84:87], a[116:119], v[32:35], v[84:87]
    s_waitcnt vmcnt(17) lgkmcnt(1)
    s_barrier
    s_and_b32 s6, s22, 1
    v_mfma_f32_16x16x32_bf16 v[92:95], a[116:119], v[40:43], v[92:95]
    s_movk_i32 s7, 5971
    ds_read_b128 v[32:35], v17 offset:12288
    v_mfma_f32_16x16x32_bf16 v[92:95], a[124:127], v[44:47], v[92:95]
    s_cmp_lt_u32 s3, 2
    s_cselect_b32 s72, s72, s73
    ds_read_b64_tr_b16 a[176:177], v12 offset:0
    v_mfma_f32_16x16x32_bf16 v[88:91], a[120:123], v[44:47], v[88:91]
    s_add_u32 m0, s20, 49152
    ds_read_b128 v[36:39], v17 offset:15360
    s_mul_i32 s14, s82, 6
    v_mfma_f32_16x16x32_bf16 v[88:91], a[112:115], v[40:43], v[88:91]
    buffer_load_dwordx4 v4, s[48:51], s14 offen offset:0 lds
    ds_read_b64_tr_b16 a[178:179], v12 offset:1024
    v_mfma_f32_16x16x32_bf16 v[96:99], a[112:115], v[48:51], v[96:99]
    s_cmp_eq_u32 s6, 0
    s_cselect_b32 s7, 25632, s7
    ds_read_b128 v[40:43], v17 offset:18432
    v_mfma_f32_16x16x32_bf16 v[96:99], a[120:123], v[52:55], v[96:99]
    v_mfma_f32_16x16x32_bf16 v[100:103], a[124:127], v[52:55], v[100:103]
    s_lshl_b32 s8, s23, 2
    ds_read_b128 v[44:47], v17 offset:21504
    v_mfma_f32_16x16x32_bf16 v[100:103], a[116:119], v[48:51], v[100:103]
    s_waitcnt lgkmcnt(6)
    buffer_load_dwordx4 v5, s[48:51], s14 offen offset:1024 lds
    ds_read_b64_tr_b16 a[180:181], v13 offset:0
    v_mfma_f32_16x16x32_bf16 v[108:111], a[116:119], v[56:59], v[108:111]
    ds_read_b128 v[48:51], v17 offset:13312
    v_mfma_f32_16x16x32_bf16 v[108:111], a[124:127], v[60:63], v[108:111]
    s_lshr_b32 s7, s7, s8
    buffer_load_dwordx4 v6, s[48:51], s14 offen offset:2048 lds
    ds_read_b64_tr_b16 a[182:183], v13 offset:1024
    v_mfma_f32_16x16x32_bf16 v[104:107], a[120:123], v[60:63], v[104:107]
    ds_read_b128 v[52:55], v17 offset:16384
    v_mfma_f32_16x16x32_bf16 v[104:107], a[112:115], v[56:59], v[104:107]
    s_waitcnt lgkmcnt(7)
    s_and_b32 s7, s7, 15
    buffer_load_dwordx4 v7, s[48:51], s14 offen offset:3072 lds
    v_mfma_f32_16x16x32_bf16 v[64:67], a[128:131], v[32:35], v[64:67]
    ds_read_b128 v[56:59], v17 offset:19456
    v_mfma_f32_16x16x32_bf16 v[64:67], a[136:139], v[36:39], v[64:67]
    s_mul_i32 s8, s22, 9
    ds_read_b64_tr_b16 a[184:185], v12 offset:8192
    v_mfma_f32_16x16x32_bf16 v[68:71], a[140:143], v[36:39], v[68:71]
    s_add_u32 m0, s21, 24576
    ds_read_b128 v[60:63], v17 offset:22528
    v_mfma_f32_16x16x32_bf16 v[68:71], a[132:135], v[32:35], v[68:71]
    s_waitcnt lgkmcnt(7)
    buffer_load_dwordx4 v18, s[44:47], s80 offen offset:0 sc1 lds
    ds_read_b64_tr_b16 a[186:187], v12 offset:9216
    v_mfma_f32_16x16x32_bf16 v[76:79], a[132:135], v[40:43], v[76:79]
    s_add_u32 s7, s7, s8
    ds_read_b128 v[32:35], v17 offset:14336
    v_mfma_f32_16x16x32_bf16 v[76:79], a[140:143], v[44:47], v[76:79]
    v_mfma_f32_16x16x32_bf16 v[72:75], a[136:139], v[44:47], v[72:75]
    s_xor_b32 s6, s6, 1
    ds_read_b128 v[36:39], v17 offset:17408
    v_mfma_f32_16x16x32_bf16 v[72:75], a[128:131], v[40:43], v[72:75]
    s_waitcnt lgkmcnt(6)
    buffer_load_dwordx4 v19, s[44:47], s80 offen offset:1024 sc1 lds
    ds_read_b64_tr_b16 a[188:189], v13 offset:8192
    v_mfma_f32_16x16x32_bf16 v[80:83], a[128:131], v[48:51], v[80:83]
    s_lshl3_add_u32 s6, s6, s8
    ds_read_b128 v[40:43], v17 offset:20480
    v_mfma_f32_16x16x32_bf16 v[80:83], a[136:139], v[52:55], v[80:83]
    buffer_load_dwordx4 v20, s[44:47], s80 offen offset:2048 sc1 lds
    ds_read_b64_tr_b16 a[190:191], v13 offset:9216
    v_mfma_f32_16x16x32_bf16 v[84:87], a[140:143], v[52:55], v[84:87]
    ds_read_b128 v[44:47], v17 offset:23552
    v_mfma_f32_16x16x32_bf16 v[84:87], a[132:135], v[48:51], v[84:87]
    s_waitcnt vmcnt(17) lgkmcnt(1)
    s_barrier
    s_lshl_b32 s8, s7, 5
    v_mfma_f32_16x16x32_bf16 v[92:95], a[132:135], v[56:59], v[92:95]
    ds_read_b128 v[48:51], v17 offset:24576
    v_mfma_f32_16x16x32_bf16 v[92:95], a[140:143], v[60:63], v[92:95]
    ds_read_b64_tr_b16 a[192:193], v12 offset:16384
    v_bfe_u32 v3, v2, 4, 1
    v_mfma_f32_16x16x32_bf16 v[88:91], a[136:139], v[60:63], v[88:91]
    s_add_u32 m0, s20, 0
    ds_read_b128 v[52:55], v17 offset:27648
    s_mul_i32 s14, s83, 6
    v_mfma_f32_16x16x32_bf16 v[88:91], a[128:131], v[56:59], v[88:91]
    buffer_load_dwordx4 v4, s[48:51], s14 offen offset:0 lds
    ds_read_b64_tr_b16 a[194:195], v12 offset:17408
    v_mfma_f32_16x16x32_bf16 v[96:99], a[128:131], v[32:35], v[96:99]
L_pl_G_2:
    s_cbranch_execz L_wret
    ds_read_b128 v[56:59], v17 offset:30720
    v_lshl_add_u32 v3, v3, 5, v1
    v_mfma_f32_16x16x32_bf16 v[96:99], a[136:139], v[36:39], v[96:99]
    v_mfma_f32_16x16x32_bf16 v[100:103], a[140:143], v[36:39], v[100:103]
    ds_read_b128 v[60:63], v17 offset:33792
    v_lshrrev_b32 v31, 5, v2
    v_mfma_f32_16x16x32_bf16 v[100:103], a[132:135], v[32:35], v[100:103]
    s_waitcnt lgkmcnt(6)
    buffer_load_dwordx4 v5, s[48:51], s14 offen offset:1024 lds
    ds_read_b64_tr_b16 a[196:197], v13 offset:16384
    v_mfma_f32_16x16x32_bf16 v[108:111], a[132:135], v[40:43], v[108:111]
    s_cmp_lt_u32 s3, 2
    s_cselect_b32 s74, s74, s75
    ds_read_b128 v[32:35], v17 offset:25600
    v_mfma_f32_16x16x32_bf16 v[108:111], a[140:143], v[44:47], v[108:111]
    buffer_load_dwordx4 v6, s[48:51], s14 offen offset:2048 lds
    ds_read_b64_tr_b16 a[198:199], v13 offset:17408
    v_mfma_f32_16x16x32_bf16 v[104:107], a[136:139], v[44:47], v[104:107]
    ds_read_b128 v[36:39], v17 offset:28672
    v_lshl_add_u32 v3, v31, 4, v3
    v_mfma_f32_16x16x32_bf16 v[104:107], a[128:131], v[40:43], v[104:107]
    s_waitcnt lgkmcnt(7)
    buffer_load_dwordx4 v7, s[48:51], s14 offen offset:3072 lds
    v_add_u32 v144, s8, v3
    v_mfma_f32_16x16x32_bf16 v[64:67], a[144:147], v[48:51], v[64:67]
    ds_read_b128 v[40:43], v17 offset:31744
    v_mfma_f32_16x16x32_bf16 v[64:67], a[152:155], v[52:55], v[64:67]
    s_mul_i32 s8, s9, 18432
    ds_read_b64_tr_b16 a[200:201], v12 offset:24576
    v_mfma_f32_16x16x32_bf16 v[68:71], a[156:159], v[52:55], v[68:71]
    s_add_u32 m0, s21, 36864
    ds_read_b128 v[44:47], v17 offset:34816
    v_mfma_f32_16x16x32_bf16 v[68:71], a[148:151], v[48:51], v[68:71]
    s_waitcnt lgkmcnt(7)
    s_lshl_b32 s5, s6, 5
    buffer_load_dwordx4 v18, s[44:47], s81 offen offset:0 sc1 lds
    ds_read_b64_tr_b16 a[202:203], v12 offset:25600
    v_mfma_f32_16x16x32_bf16 v[76:79], a[148:151], v[56:59], v[76:79]
    ds_read_b128 v[48:51], v17 offset:26624
    v_mfma_f32_16x16x32_bf16 v[76:79], a[156:159], v[60:63], v[76:79]
    s_add_u32 s8, s8, s5
    v_mfma_f32_16x16x32_bf16 v[72:75], a[152:155], v[60:63], v[72:75]
    ds_read_b128 v[52:55], v17 offset:29696
    v_mfma_f32_16x16x32_bf16 v[72:75], a[144:147], v[56:59], v[72:75]
    s_waitcnt lgkmcnt(6)
    buffer_load_dwordx4 v19, s[44:47], s81 offen offset:1024 sc1 lds
    ds_read_b64_tr_b16 a[204:205], v13 offset:24576
    v_mfma_f32_16x16x32_bf16 v[80:83], a[144:147], v[32:35], v[80:83]
    ds_read_b128 v[56:59], v17 offset:32768
    v_lshrrev_b32 v3, 4, v2
    v_mfma_f32_16x16x32_bf16 v[80:83], a[152:155], v[36:39], v[80:83]
    buffer_load_dwordx4 v20, s[44:47], s81 offen offset:2048 sc1 lds
    ds_read_b64_tr_b16 a[206:207], v13 offset:25600
    v_mfma_f32_16x16x32_bf16 v[84:87], a[156:159], v[36:39], v[84:87]
    ds_read_b128 v[60:63], v17 offset:35840
    v_lshl_add_u32 v3, v3, 3, v1
    v_mfma_f32_16x16x32_bf16 v[84:87], a[148:151], v[32:35], v[84:87]
    s_waitcnt vmcnt(17) lgkmcnt(1)
    s_barrier
    v_mfma_f32_16x16x32_bf16 v[92:95], a[148:151], v[40:43], v[92:95]
    ds_read_b128 v[32:35], v16 offset:0
    v_mfma_f32_16x16x32_bf16 v[92:95], a[156:159], v[44:47], v[92:95]
    ds_read_b64_tr_b16 a[208:209], v12 offset:32768
    v_add_u32 v3, s8, v3
    v_mfma_f32_16x16x32_bf16 v[88:91], a[152:155], v[44:47], v[88:91]
    s_add_u32 m0, s21, 49152
    ds_read_b128 v[36:39], v16 offset:3072
    v_mfma_f32_16x16x32_bf16 v[88:91], a[144:147], v[40:43], v[88:91]
    s_lshr_b32 s8, s23, 1
    buffer_load_dwordx4 v18, s[44:47], s82 offen offset:0 sc1 lds
    ds_read_b64_tr_b16 a[210:211], v12 offset:33792
    v_mfma_f32_16x16x32_bf16 v[96:99], a[144:147], v[48:51], v[96:99]
    ds_read_b128 v[40:43], v16 offset:6144
    v_mfma_f32_16x16x32_bf16 v[96:99], a[152:155], v[52:55], v[96:99]
    buffer_load_dwordx4 v19, s[44:47], s82 offen offset:1024 sc1 lds
    v_mov_b32 v1, 0x40000000
    v_mfma_f32_16x16x32_bf16 v[100:103], a[156:159], v[52:55], v[100:103]
    ds_read_b128 v[44:47], v16 offset:9216
    v_mfma_f32_16x16x32_bf16 v[100:103], a[148:151], v[48:51], v[100:103]
    s_waitcnt lgkmcnt(6)
    ds_read_b64_tr_b16 a[212:213], v13 offset:32768
    v_mfma_f32_16x16x32_bf16 v[108:111], a[148:151], v[56:59], v[108:111]
    ds_read_b128 v[48:51], v16 offset:1024
    v_mfma_f32_16x16x32_bf16 v[108:111], a[156:159], v[60:63], v[108:111]
    buffer_load_dwordx4 v20, s[44:47], s82 offen offset:2048 sc1 lds
    ds_read_b64_tr_b16 a[214:215], v13 offset:33792
    v_mfma_f32_16x16x32_bf16 v[104:107], a[152:155], v[60:63], v[104:107]
    ds_read_b128 v[52:55], v16 offset:4096
    v_mfma_f32_16x16x32_bf16 v[104:107], a[144:147], v[56:59], v[104:107]
    s_waitcnt lgkmcnt(7)
    v_cmp_eq_u32 vcc, s8, v31
    s_nop 1
    v_cndmask_b32 v145, v1, v3, vcc
    v_mfma_f32_16x16x32_bf16 v[64:67], a[160:163], v[32:35], v[64:67]
    s_lshl_b32 s36, s7, 16
    ds_read_b128 v[56:59], v16 offset:7168
    s_add_u32 s36, s36, 6356992
    v_mfma_f32_16x16x32_bf16 v[64:67], a[168:171], v[36:39], v[64:67]
    ds_read_b64_tr_b16 a[216:217], v12 offset:40960
    v_mfma_f32_16x16x32_bf16 v[68:71], a[172:175], v[36:39], v[68:71]
    ds_read_b128 v[60:63], v16 offset:10240
    v_mfma_f32_16x16x32_bf16 v[68:71], a[164:167], v[32:35], v[68:71]
    s_waitcnt lgkmcnt(7)
    s_lshl_b32 s37, s6, 16
    ds_read_b64_tr_b16 a[218:219], v12 offset:41984
    v_mfma_f32_16x16x32_bf16 v[76:79], a[164:167], v[40:43], v[76:79]
    ds_read_b128 v[32:35], v16 offset:2048
    v_mfma_f32_16x16x32_bf16 v[76:79], a[172:175], v[44:47], v[76:79]
    s_add_u32 s37, s37, 6356992
    v_mfma_f32_16x16x32_bf16 v[72:75], a[168:171], v[44:47], v[72:75]
    ds_read_b128 v[36:39], v16 offset:5120
    v_mfma_f32_16x16x32_bf16 v[72:75], a[160:163], v[40:43], v[72:75]
    s_waitcnt lgkmcnt(6)
    ds_read_b64_tr_b16 a[220:221], v13 offset:40960
    v_mov_b32 v3, s40
    v_mfma_f32_16x16x32_bf16 v[80:83], a[160:163], v[48:51], v[80:83]
    ds_read_b128 v[40:43], v16 offset:8192
    v_mfma_f32_16x16x32_bf16 v[80:83], a[168:171], v[52:55], v[80:83]
    ds_read_b64_tr_b16 a[222:223], v13 offset:41984
    v_mov_b32 v31, s41
    v_mfma_f32_16x16x32_bf16 v[84:87], a[172:175], v[52:55], v[84:87]
    ds_read_b128 v[44:47], v16 offset:11264
    v_and_b32 v1, 8, v2
    v_mfma_f32_16x16x32_bf16 v[84:87], a[164:167], v[48:51], v[84:87]
    s_waitcnt vmcnt(13) lgkmcnt(1)
    s_barrier
    v_cmp_lt_u32 vcc, 0, v1
    s_nop 1
    v_cndmask_b32 v3, v3, v31, vcc
    v_mfma_f32_16x16x32_bf16 v[92:95], a[164:167], v[56:59], v[92:95]
    s_add_u32 m0, s21, 61440
    ds_read_b128 v[48:51], v16 offset:12288
    v_mfma_f32_16x16x32_bf16 v[92:95], a[172:175], v[60:63], v[92:95]
    buffer_load_dwordx4 v18, s[44:47], s83 offen offset:0 sc1 lds
    ds_read_b64_tr_b16 a[224:225], v12 offset:49152
    v_mfma_f32_16x16x32_bf16 v[88:91], a[168:171], v[60:63], v[88:91]
    ds_read_b128 v[52:55], v16 offset:15360
    v_mfma_f32_16x16x32_bf16 v[88:91], a[160:163], v[56:59], v[88:91]
    buffer_load_dwordx4 v19, s[44:47], s83 offen offset:1024 sc1 lds
    ds_read_b64_tr_b16 a[226:227], v12 offset:50176
    v_mfma_f32_16x16x32_bf16 v[96:99], a[160:163], v[32:35], v[96:99]
    ds_read_b128 v[56:59], v16 offset:18432
    v_mfma_f32_16x16x32_bf16 v[96:99], a[168:171], v[36:39], v[96:99]
    buffer_load_dwordx4 v20, s[44:47], s83 offen offset:2048 sc1 lds
    v_and_b32 v1, 7, v2
    v_mfma_f32_16x16x32_bf16 v[100:103], a[172:175], v[36:39], v[100:103]
    ds_read_b128 v[60:63], v16 offset:21504
    v_mfma_f32_16x16x32_bf16 v[100:103], a[164:167], v[32:35], v[100:103]
    s_waitcnt lgkmcnt(6)
    ds_read_b64_tr_b16 a[228:229], v13 offset:49152
    v_lshl_add_u32 v3, v1, 4, v3
    v_mfma_f32_16x16x32_bf16 v[108:111], a[164:167], v[40:43], v[108:111]
    ds_read_b128 v[32:35], v16 offset:13312
    v_mfma_f32_16x16x32_bf16 v[108:111], a[172:175], v[44:47], v[108:111]
    ds_read_b64_tr_b16 a[230:231], v13 offset:50176
    v_mfma_f32_16x16x32_bf16 v[104:107], a[168:171], v[44:47], v[104:107]
    ds_read_b128 v[36:39], v16 offset:16384
    v_lshrrev_b32 v1, 4, v2
    v_mfma_f32_16x16x32_bf16 v[104:107], a[160:163], v[40:43], v[104:107]
    s_waitcnt lgkmcnt(7)
    s_cmp_lt_u32 s3, 2
    s_cselect_b32 s76, s76, s77
    v_lshl_add_u32 v3, v1, 12, v3
    v_mfma_f32_16x16x32_bf16 v[64:67], a[176:179], v[48:51], v[64:67]
    s_add_u32 m0, s20, 16384
    ds_read_b128 v[40:43], v16 offset:19456
    s_lshl_b32 s14, s84, 1
    v_mfma_f32_16x16x32_bf16 v[64:67], a[184:187], v[52:55], v[64:67]
    buffer_load_dwordx4 v8, s[52:55], s14 offen offset:0 lds
    ds_read_b64_tr_b16 a[232:233], v12 offset:57344
    v_mfma_f32_16x16x32_bf16 v[68:71], a[188:191], v[52:55], v[68:71]
    s_lshl_b32 s8, s3, 14
    ds_read_b128 v[44:47], v16 offset:22528
    v_mfma_f32_16x16x32_bf16 v[68:71], a[180:183], v[48:51], v[68:71]
    s_waitcnt lgkmcnt(7)
    buffer_load_dwordx4 v9, s[52:55], s14 offen offset:1024 lds
    ds_read_b64_tr_b16 a[234:235], v12 offset:58368
    v_mfma_f32_16x16x32_bf16 v[76:79], a[180:183], v[56:59], v[76:79]
    ds_read_b128 v[48:51], v16 offset:14336
    v_mfma_f32_16x16x32_bf16 v[76:79], a[188:191], v[60:63], v[76:79]
    buffer_load_dwordx4 v10, s[52:55], s14 offen offset:2048 lds
    v_add_u32 v155, s8, v3
    v_mfma_f32_16x16x32_bf16 v[72:75], a[184:187], v[60:63], v[72:75]
    ds_read_b128 v[52:55], v16 offset:17408
    v_lshrrev_b32 v1, 2, v2
    v_mfma_f32_16x16x32_bf16 v[72:75], a[176:179], v[56:59], v[72:75]
    s_waitcnt lgkmcnt(6)
    buffer_load_dwordx4 v11, s[52:55], s14 offen offset:3072 lds
    ds_read_b64_tr_b16 a[236:237], v13 offset:57344
    v_mfma_f32_16x16x32_bf16 v[80:83], a[176:179], v[32:35], v[80:83]
    ds_read_b128 v[56:59], v16 offset:20480
    v_mfma_f32_16x16x32_bf16 v[80:83], a[184:187], v[36:39], v[80:83]
    ds_read_b64_tr_b16 a[238:239], v13 offset:58368
    v_lshlrev_b32 v1, 8, v1
    v_mfma_f32_16x16x32_bf16 v[84:87], a[188:191], v[36:39], v[84:87]
    ds_read_b128 v[60:63], v16 offset:23552
    v_mfma_f32_16x16x32_bf16 v[84:87], a[180:183], v[32:35], v[84:87]
    s_waitcnt vmcnt(13) lgkmcnt(1)
    s_barrier
    v_and_b32 v3, 3, v2
    v_lshl_add_u32 v1, v3, 3, v1
    v_mfma_f32_16x16x32_bf16 v[92:95], a[180:183], v[40:43], v[92:95]
    s_add_u32 m0, s21, 0
    ds_read_b128 v[32:35], v16 offset:24576
    s_bfe_u32 s14, s31, 0x30000
    s_lshl_b32 s14, s14, 8
    s_add_u32 s14, s14, s17
    v_add_u32 v18, s14, v22
    v_mfma_f32_16x16x32_bf16 v[92:95], a[188:191], v[44:47], v[92:95]
    buffer_load_dwordx4 v18, s[44:47], s68 offen offset:0 sc1 lds
    ds_read_b64_tr_b16 a[240:241], v12 offset:0
    v_mfma_f32_16x16x32_bf16 v[88:91], a[184:187], v[44:47], v[88:91]
    s_bfe_u32 s14, s31, 0x30003
    ds_read_b128 v[36:39], v16 offset:27648
    s_lshl_b32 s14, s14, 8
    s_add_u32 s14, s14, s17
    s_sub_u32 s14, s14, 1024
    v_add_u32 v19, s14, v22
    v_mfma_f32_16x16x32_bf16 v[88:91], a[176:179], v[40:43], v[88:91]
    buffer_load_dwordx4 v19, s[44:47], s68 offen offset:1024 sc1 lds
    ds_read_b64_tr_b16 a[242:243], v12 offset:1024
    v_mfma_f32_16x16x32_bf16 v[96:99], a[176:179], v[48:51], v[96:99]
    s_bfe_u32 s14, s31, 0x30006
    ds_read_b128 v[40:43], v16 offset:30720
    s_lshl_b32 s14, s14, 8
    s_add_u32 s14, s14, s17
    s_sub_u32 s14, s14, 2048
    v_add_u32 v20, s14, v22
    v_mfma_f32_16x16x32_bf16 v[96:99], a[184:187], v[52:55], v[96:99]
    s_lshl_b32 s8, s3, 6
    buffer_load_dwordx4 v20, s[44:47], s68 offen offset:2048 sc1 lds
    v_mfma_f32_16x16x32_bf16 v[100:103], a[188:191], v[52:55], v[100:103]
    ds_read_b128 v[44:47], v16 offset:33792
    v_mfma_f32_16x16x32_bf16 v[100:103], a[180:183], v[48:51], v[100:103]
    s_waitcnt lgkmcnt(6)
    ds_read_b64_tr_b16 a[244:245], v13 offset:0
    v_add_u32 v252, s8, v1
    v_mfma_f32_16x16x32_bf16 v[108:111], a[180:183], v[56:59], v[108:111]
    ds_read_b128 v[48:51], v16 offset:25600
    v_mfma_f32_16x16x32_bf16 v[108:111], a[188:191], v[60:63], v[108:111]
    ds_read_b64_tr_b16 a[246:247], v13 offset:1024
    v_min_u32 v1, 17, v2
    v_mfma_f32_16x16x32_bf16 v[104:107], a[184:187], v[60:63], v[104:107]
    ds_read_b128 v[52:55], v16 offset:28672
    v_mfma_f32_16x16x32_bf16 v[104:107], a[176:179], v[56:59], v[104:107]
    s_waitcnt lgkmcnt(7)
    v_lshrrev_b32 v3, 1, v1
    v_mfma_f32_16x16x32_bf16 v[64:67], a[192:195], v[32:35], v[64:67]
    s_add_u32 m0, s20, 32768
    ds_read_b128 v[56:59], v16 offset:31744
    s_lshl_b32 s14, s85, 1
    v_mfma_f32_16x16x32_bf16 v[64:67], a[200:203], v[36:39], v[64:67]
    buffer_load_dwordx4 v8, s[52:55], s14 offen offset:0 lds
    ds_read_b64_tr_b16 a[248:249], v12 offset:8192
    v_mfma_f32_16x16x32_bf16 v[68:71], a[204:207], v[36:39], v[68:71]
    s_cmp_lt_u32 s3, 2
    s_cselect_b32 s78, s78, s79
    ds_read_b128 v[60:63], v16 offset:34816
    v_mfma_f32_16x16x32_bf16 v[68:71], a[196:199], v[32:35], v[68:71]
    s_waitcnt lgkmcnt(7)
    buffer_load_dwordx4 v9, s[52:55], s14 offen offset:1024 lds
    ds_read_b64_tr_b16 a[250:251], v12 offset:9216
    v_mfma_f32_16x16x32_bf16 v[76:79], a[196:199], v[40:43], v[76:79]
    ds_read_b128 v[32:35], v16 offset:26624
    v_and_b32 v1, 1, v1
    v_mfma_f32_16x16x32_bf16 v[76:79], a[204:207], v[44:47], v[76:79]
    v_lshlrev_b32 v3, 8, v3
    v_mfma_f32_16x16x32_bf16 v[72:75], a[200:203], v[44:47], v[72:75]
    ds_read_b128 v[36:39], v16 offset:29696
    v_lshl_add_u32 v3, v1, 2, v3
    v_mfma_f32_16x16x32_bf16 v[72:75], a[192:195], v[40:43], v[72:75]
    s_waitcnt lgkmcnt(6)
    ds_read_b64_tr_b16 a[252:253], v13 offset:8192
    v_mfma_f32_16x16x32_bf16 v[80:83], a[192:195], v[48:51], v[80:83]
    ds_read_b128 v[40:43], v16 offset:32768
    v_mfma_f32_16x16x32_bf16 v[80:83], a[200:203], v[52:55], v[80:83]
    s_mul_i32 s8, s23, 18
    ds_read_b64_tr_b16 a[254:255], v13 offset:9216
    v_mfma_f32_16x16x32_bf16 v[84:87], a[204:207], v[52:55], v[84:87]
    ds_read_b128 v[44:47], v16 offset:35840
    v_mfma_f32_16x16x32_bf16 v[84:87], a[196:199], v[48:51], v[84:87]
    s_waitcnt vmcnt(15) lgkmcnt(1)
    s_barrier
    s_lshr_b32 s5, s22, 1
    v_mfma_f32_16x16x32_bf16 v[92:95], a[196:199], v[56:59], v[92:95]
    ds_read_b128 v[48:51], v17 offset:0
    v_mfma_f32_16x16x32_bf16 v[92:95], a[204:207], v[60:63], v[92:95]
    v_mfma_f32_16x16x32_bf16 v[88:91], a[200:203], v[60:63], v[88:91]
    s_add_u32 s8, s8, s5
    ds_read_b128 v[52:55], v17 offset:3072
    v_mfma_f32_16x16x32_bf16 v[88:91], a[192:195], v[56:59], v[88:91]
    buffer_load_dwordx4 v10, s[52:55], s14 offen offset:2048 lds
    v_mfma_f32_16x16x32_bf16 v[96:99], a[192:195], v[32:35], v[96:99]
    s_lshl_b32 s8, s8, 5
    ds_read_b128 v[56:59], v17 offset:6144
    v_mfma_f32_16x16x32_bf16 v[96:99], a[200:203], v[36:39], v[96:99]
    v_mfma_f32_16x16x32_bf16 v[100:103], a[204:207], v[36:39], v[100:103]
    s_and_b32 s5, s22, 1
    ds_read_b128 v[60:63], v17 offset:9216
    v_mfma_f32_16x16x32_bf16 v[100:103], a[196:199], v[32:35], v[100:103]
    s_waitcnt lgkmcnt(4)
    buffer_load_dwordx4 v11, s[52:55], s14 offen offset:3072 lds
    v_mfma_f32_16x16x32_bf16 v[108:111], a[196:199], v[40:43], v[108:111]
    ds_read_b128 v[32:35], v17 offset:1024
    v_mfma_f32_16x16x32_bf16 v[108:111], a[204:207], v[44:47], v[108:111]
    s_add_u32 s8, s8, s5
    v_mfma_f32_16x16x32_bf16 v[104:107], a[200:203], v[44:47], v[104:107]
    s_add_u32 m0, s21, 12288
    ds_read_b128 v[36:39], v17 offset:4096
    v_mfma_f32_16x16x32_bf16 v[104:107], a[192:195], v[40:43], v[104:107]
    s_waitcnt lgkmcnt(4)
    s_lshl_b32 s8, s8, 2
    buffer_load_dwordx4 v18, s[44:47], s70 offen offset:0 sc1 lds
    v_mfma_f32_16x16x32_bf16 v[64:67], a[208:211], v[48:51], v[64:67]
    ds_read_b128 v[40:43], v17 offset:7168
    v_mfma_f32_16x16x32_bf16 v[64:67], a[216:219], v[52:55], v[64:67]
    s_add_u32 s8, s8, 8994816
    v_mfma_f32_16x16x32_bf16 v[68:71], a[220:223], v[52:55], v[68:71]
    ds_read_b128 v[44:47], v17 offset:10240
    v_mfma_f32_16x16x32_bf16 v[68:71], a[212:215], v[48:51], v[68:71]
    s_waitcnt lgkmcnt(4)
    buffer_load_dwordx4 v19, s[44:47], s70 offen offset:1024 sc1 lds
    v_mfma_f32_16x16x32_bf16 v[76:79], a[212:215], v[56:59], v[76:79]
    ds_read_b128 v[48:51], v17 offset:2048
    v_add_u32 v26, s8, v3
    v_mfma_f32_16x16x32_bf16 v[76:79], a[220:223], v[60:63], v[76:79]
    buffer_load_dwordx4 v20, s[44:47], s70 offen offset:2048 sc1 lds
    v_mfma_f32_16x16x32_bf16 v[72:75], a[216:219], v[60:63], v[72:75]
    ds_read_b128 v[52:55], v17 offset:5120
    v_mov_b32 v1, s34
    v_mfma_f32_16x16x32_bf16 v[72:75], a[208:211], v[56:59], v[72:75]
    s_waitcnt lgkmcnt(4)
    v_mfma_f32_16x16x32_bf16 v[80:83], a[208:211], v[32:35], v[80:83]
    ds_read_b128 v[56:59], v17 offset:8192
    v_and_b32 v31, 3, v1
    v_mfma_f32_16x16x32_bf16 v[80:83], a[216:219], v[36:39], v[80:83]
    v_mfma_f32_16x16x32_bf16 v[84:87], a[220:223], v[36:39], v[84:87]
    ds_read_b128 v[60:63], v17 offset:11264
    v_mfma_f32_16x16x32_bf16 v[84:87], a[212:215], v[32:35], v[84:87]
    s_waitcnt vmcnt(10) lgkmcnt(4)
    s_barrier
    v_lshrrev_b32 v1, 2, v1
    v_mfma_f32_16x16x32_bf16 v[92:95], a[212:215], v[40:43], v[92:95]
    ds_read_b128 v[32:35], v17 offset:12288
    buffer_load_dword v143, v142, s[44:47], 0 offen offset:0 sc1
    v_mfma_f32_16x16x32_bf16 v[92:95], a[220:223], v[44:47], v[92:95]
    ds_read_b64_tr_b16 v[156:157], v12 offset:16384
    v_lshlrev_b32 v1, 7, v1
    v_mfma_f32_16x16x32_bf16 v[88:91], a[216:219], v[44:47], v[88:91]
    ds_read_b128 v[36:39], v17 offset:15360
    v_lshl_add_u32 v1, v31, 2, v1
    v_mfma_f32_16x16x32_bf16 v[88:91], a[208:211], v[40:43], v[88:91]
    s_waitcnt lgkmcnt(5)
    ds_read_b64_tr_b16 v[158:159], v12 offset:17408
    v_add_u32 v1, 9023488, v1
    v_mfma_f32_16x16x32_bf16 v[96:99], a[208:211], v[48:51], v[96:99]
    ds_read_b128 v[40:43], v17 offset:18432
    v_mov_b32 v31, 0x40000000
    v_mfma_f32_16x16x32_bf16 v[96:99], a[216:219], v[52:55], v[96:99]
    v_cmp_gt_u32 vcc, 1, v0
    s_nop 1
    v_cndmask_b32 v29, v31, v1, vcc
    v_mfma_f32_16x16x32_bf16 v[100:103], a[220:223], v[52:55], v[100:103]
    s_add_u32 m0, s21, 24576
    ds_read_b128 v[44:47], v17 offset:21504
    v_mfma_f32_16x16x32_bf16 v[100:103], a[212:215], v[48:51], v[100:103]
    s_waitcnt lgkmcnt(6)
    buffer_load_dwordx4 v18, s[44:47], s72 offen offset:0 sc1 lds
    ds_read_b64_tr_b16 v[160:161], v13 offset:16384
    v_mfma_f32_16x16x32_bf16 v[108:111], a[212:215], v[56:59], v[108:111]
    ds_read_b128 v[48:51], v17 offset:13312
    v_mfma_f32_16x16x32_bf16 v[108:111], a[220:223], v[60:63], v[108:111]
    s_cmp_lt_u32 s3, 2
    s_cselect_b32 s80, s80, s81
    ds_read_b64_tr_b16 v[162:163], v13 offset:17408
    v_mfma_f32_16x16x32_bf16 v[104:107], a[216:219], v[60:63], v[104:107]
    ds_read_b128 v[52:55], v17 offset:16384
    v_mfma_f32_16x16x32_bf16 v[104:107], a[208:211], v[56:59], v[104:107]
    s_waitcnt lgkmcnt(7)
    buffer_load_dwordx4 v19, s[44:47], s72 offen offset:1024 sc1 lds
    v_mfma_f32_16x16x32_bf16 v[64:67], a[224:227], v[32:35], v[64:67]
    ds_read_b128 v[56:59], v17 offset:19456
    v_mfma_f32_16x16x32_bf16 v[64:67], a[232:235], v[36:39], v[64:67]
    s_mul_i32 s4, s16, 0x9e3779b1
    ds_read_b64_tr_b16 v[164:165], v12 offset:24576
    v_mfma_f32_16x16x32_bf16 v[68:71], a[236:239], v[36:39], v[68:71]
    ds_read_b128 v[60:63], v17 offset:22528
    v_mfma_f32_16x16x32_bf16 v[68:71], a[228:231], v[32:35], v[68:71]
    s_waitcnt lgkmcnt(7)
    s_lshr_b32 s5, s4, 15
    ds_read_b64_tr_b16 v[166:167], v12 offset:25600
    v_mfma_f32_16x16x32_bf16 v[76:79], a[228:231], v[40:43], v[76:79]
    ds_read_b128 v[32:35], v17 offset:14336
    v_mfma_f32_16x16x32_bf16 v[76:79], a[236:239], v[44:47], v[76:79]
    v_mfma_f32_16x16x32_bf16 v[72:75], a[232:235], v[44:47], v[72:75]
    s_xor_b32 s4, s4, s5
    ds_read_b128 v[36:39], v17 offset:17408
    v_mfma_f32_16x16x32_bf16 v[72:75], a[224:227], v[40:43], v[72:75]
    s_waitcnt lgkmcnt(6)
    buffer_load_dwordx4 v20, s[44:47], s72 offen offset:2048 sc1 lds
    ds_read_b64_tr_b16 v[168:169], v13 offset:24576
    v_mfma_f32_16x16x32_bf16 v[80:83], a[224:227], v[48:51], v[80:83]
    s_mul_i32 s4, s4, 0x85ebca77
    ds_read_b128 v[40:43], v17 offset:20480
    v_mfma_f32_16x16x32_bf16 v[80:83], a[232:235], v[52:55], v[80:83]
    ds_read_b64_tr_b16 v[170:171], v13 offset:25600
    v_mfma_f32_16x16x32_bf16 v[84:87], a[236:239], v[52:55], v[84:87]
    s_lshr_b32 s5, s4, 13
    ds_read_b128 v[44:47], v17 offset:23552
    v_mfma_f32_16x16x32_bf16 v[84:87], a[228:231], v[48:51], v[84:87]
    s_waitcnt vmcnt(7) lgkmcnt(1)
    s_barrier
    v_mfma_f32_16x16x32_bf16 v[92:95], a[228:231], v[56:59], v[92:95]
    s_add_u32 m0, s21, 36864
    ds_read_b128 v[48:51], v17 offset:24576
    v_mfma_f32_16x16x32_bf16 v[92:95], a[236:239], v[60:63], v[92:95]
    s_xor_b32 s4, s4, s5
    buffer_load_dwordx4 v18, s[44:47], s74 offen offset:0 sc1 lds
    ds_read_b64_tr_b16 v[172:173], v12 offset:32768
    v_mfma_f32_16x16x32_bf16 v[88:91], a[232:235], v[60:63], v[88:91]
    ds_read_b128 v[52:55], v17 offset:27648
    v_mfma_f32_16x16x32_bf16 v[88:91], a[224:227], v[56:59], v[88:91]
    s_mov_b32 s33, 0x10001
    buffer_load_dwordx4 v19, s[44:47], s74 offen offset:1024 sc1 lds
    ds_read_b64_tr_b16 v[174:175], v12 offset:33792
    v_mfma_f32_16x16x32_bf16 v[96:99], a[224:227], v[32:35], v[96:99]
    ds_read_b128 v[56:59], v17 offset:30720
    v_mfma_f32_16x16x32_bf16 v[96:99], a[232:235], v[36:39], v[96:99]
    buffer_load_dwordx4 v20, s[44:47], s74 offen offset:2048 sc1 lds
    v_and_b32 v1, 3, v2
    v_mfma_f32_16x16x32_bf16 v[100:103], a[236:239], v[36:39], v[100:103]
    ds_read_b128 v[60:63], v17 offset:33792
    v_mfma_f32_16x16x32_bf16 v[100:103], a[228:231], v[32:35], v[100:103]
    s_waitcnt lgkmcnt(6)
    ds_read_b64_tr_b16 v[176:177], v13 offset:32768
    v_mfma_f32_16x16x32_bf16 v[108:111], a[228:231], v[40:43], v[108:111]
    ds_read_b128 v[32:35], v17 offset:25600
    v_lshlrev_b32 v1, 3, v1
    v_mfma_f32_16x16x32_bf16 v[108:111], a[236:239], v[44:47], v[108:111]
    ds_read_b64_tr_b16 v[178:179], v13 offset:33792
    v_mfma_f32_16x16x32_bf16 v[104:107], a[232:235], v[44:47], v[104:107]
    ds_read_b128 v[36:39], v17 offset:28672
    v_lshrrev_b32 v1, v1, s4
    v_mfma_f32_16x16x32_bf16 v[104:107], a[224:227], v[40:43], v[104:107]
    s_waitcnt lgkmcnt(7)
    s_cmp_lt_u32 s3, 2
    s_cselect_b32 s82, s82, s83
    v_mfma_f32_16x16x32_bf16 v[64:67], a[240:243], v[48:51], v[64:67]
    ds_read_b128 v[40:43], v17 offset:31744
    v_bfe_u32 v31, v1, 1, 1
    v_mfma_f32_16x16x32_bf16 v[64:67], a[248:251], v[52:55], v[64:67]
    ds_read_b64_tr_b16 v[180:181], v12 offset:40960
    v_mfma_f32_16x16x32_bf16 v[68:71], a[252:255], v[52:55], v[68:71]
    ds_read_b128 v[44:47], v17 offset:34816
    v_mfma_f32_16x16x32_bf16 v[68:71], a[244:247], v[48:51], v[68:71]
    s_waitcnt lgkmcnt(7)
    ds_read_b64_tr_b16 v[182:183], v12 offset:41984
    v_bfe_u32 v253, v1, 0, 1
    v_mfma_f32_16x16x32_bf16 v[76:79], a[244:247], v[56:59], v[76:79]
    ds_read_b128 v[48:51], v17 offset:26624
    v_mfma_f32_16x16x32_bf16 v[76:79], a[252:255], v[60:63], v[76:79]
    s_waitcnt vmcnt(6)
    ds_read_b64_tr_b16 v[184:185], v13 offset:40960
    v_lshl_or_b32 v253, v31, 16, v253
    v_mfma_f32_16x16x32_bf16 v[72:75], a[248:251], v[60:63], v[72:75]
    ds_read_b128 v[52:55], v17 offset:29696
    v_mfma_f32_16x16x32_bf16 v[72:75], a[240:243], v[56:59], v[72:75]
    s_waitcnt lgkmcnt(7)
    v_cmp_ne_u32 vcc, s16, v143
    s_cbranch_vccnz L_rs_pk
L_ok_pk:
    v_mfma_f32_16x16x32_bf16 v[80:83], a[240:243], v[32:35], v[80:83]
    s_add_u32 m0, s10, 70176
    ds_read_b128 v[56:59], v17 offset:32768
    v_bfe_u32 v31, v1, 3, 1
    v_mfma_f32_16x16x32_bf16 v[80:83], a[248:251], v[36:39], v[80:83]
    buffer_load_dwordx4 v147, s[44:47], s15 offen sc1 lds
    ds_read_b64_tr_b16 v[186:187], v13 offset:41984
    v_mfma_f32_16x16x32_bf16 v[84:87], a[252:255], v[36:39], v[84:87]
    ds_read_b128 v[60:63], v17 offset:35840
    v_bfe_u32 v255, v1, 2, 1
    v_mfma_f32_16x16x32_bf16 v[84:87], a[244:247], v[32:35], v[84:87]
    s_waitcnt lgkmcnt(1)
    s_barrier
    v_mov_b32 v148, 0
    v_mfma_f32_16x16x32_bf16 v[92:95], a[244:247], v[40:43], v[92:95]
    s_add_u32 m0, s10, 65568
    ds_read_b128 v[32:35], v16 offset:0
    v_lshl_or_b32 v255, v31, 16, v255
    v_mfma_f32_16x16x32_bf16 v[92:95], a[252:255], v[44:47], v[92:95]
    buffer_load_dwordx4 v21, s[60:63], s12 offen lds
    v_mfma_f32_16x16x32_bf16 v[88:91], a[248:251], v[44:47], v[88:91]
    ds_read_b128 v[36:39], v16 offset:3072
    v_mfma_f32_16x16x32_bf16 v[88:91], a[240:243], v[40:43], v[88:91]
    v_bfe_u32 v31, v1, 5, 1
    v_mfma_f32_16x16x32_bf16 v[96:99], a[240:243], v[48:51], v[96:99]
    ds_read_b128 v[40:43], v16 offset:1024
    v_mfma_f32_16x16x32_bf16 v[96:99], a[248:251], v[52:55], v[96:99]
    v_bfe_u32 v23, v1, 4, 1
    v_mfma_f32_16x16x32_bf16 v[100:103], a[252:255], v[52:55], v[100:103]
    ds_read_b128 v[44:47], v16 offset:4096
    v_mov_b32 v149, 0
    v_mfma_f32_16x16x32_bf16 v[100:103], a[244:247], v[48:51], v[100:103]
    s_waitcnt lgkmcnt(4)
    v_lshl_or_b32 v23, v31, 16, v23
    v_mfma_f32_16x16x32_bf16 v[108:111], a[244:247], v[56:59], v[108:111]
    ds_read_b128 v[48:51], v16 offset:2048
    v_mfma_f32_16x16x32_bf16 v[108:111], a[252:255], v[60:63], v[108:111]
    v_mfma_f32_16x16x32_bf16 v[104:107], a[248:251], v[60:63], v[104:107]
    ds_read_b128 v[52:55], v16 offset:5120
    v_bfe_u32 v31, v1, 7, 1
    v_mfma_f32_16x16x32_bf16 v[104:107], a[240:243], v[56:59], v[104:107]
    s_waitcnt lgkmcnt(4)
    v_mfma_f32_16x16x32_bf16 v[112:115], a[0:3], v[32:35], 0
    ds_read_b128 v[56:59], v16 offset:6144
    v_bfe_u32 v0, v1, 6, 1
    v_mfma_f32_16x16x32_bf16 v[112:115], a[8:11], v[36:39], v[112:115]
    v_lshlrev_b32 v150, 3, v2
    v_lshl_or_b32 v0, v31, 16, v0
    v_mfma_f32_16x16x32_bf16 v[116:119], a[12:15], v[36:39], 0
    ds_read_b128 v[60:63], v16 offset:9216
    v_add_u32 v150, 69664, v150
    v_mfma_f32_16x16x32_bf16 v[116:119], a[4:7], v[32:35], v[116:119]
    s_waitcnt lgkmcnt(4)
    ds_write_b64 v150, v[148:149]
    v_mfma_f32_16x16x32_bf16 v[124:127], a[4:7], v[40:43], 0
    ds_read_b128 v[32:35], v16 offset:7168
    v_mfma_f32_16x16x32_bf16 v[124:127], a[12:15], v[44:47], v[124:127]
    v_cvt_pk_bf16_f32 v64, v64, v65
    v_mfma_f32_16x16x32_bf16 v[120:123], a[8:11], v[44:47], 0
    ds_read_b128 v[36:39], v16 offset:10240
    v_cvt_pk_bf16_f32 v65, v66, v67
    v_mfma_f32_16x16x32_bf16 v[120:123], a[0:3], v[40:43], v[120:123]
    s_waitcnt lgkmcnt(5)
    v_cvt_pk_bf16_f32 v66, v68, v69
    v_cvt_pk_bf16_f32 v67, v70, v71
    v_mfma_f32_16x16x32_bf16 v[128:131], a[0:3], v[48:51], 0
    s_add_u32 m0, s21, 49152
    ds_read_b128 v[40:43], v16 offset:8192
    v_bfi_b32 v64, s33, v253, v64
    v_mfma_f32_16x16x32_bf16 v[128:131], a[8:11], v[52:55], v[128:131]
    buffer_load_dwordx4 v18, s[44:47], s76 offen offset:0 sc1 lds
    v_bfi_b32 v65, s33, v255, v65
    v_mfma_f32_16x16x32_bf16 v[132:135], a[12:15], v[52:55], 0
    ds_read_b128 v[44:47], v16 offset:11264
    v_bfi_b32 v66, s33, v23, v66
    v_mfma_f32_16x16x32_bf16 v[132:135], a[4:7], v[48:51], v[132:135]
    s_waitcnt lgkmcnt(5)
    s_barrier
    v_bfi_b32 v67, s33, v0, v67
    v_mfma_f32_16x16x32_bf16 v[116:119], a[20:23], v[56:59], v[116:119]
    ds_read_b128 v[48:51], v16 offset:12288
    v_cvt_pk_bf16_f32 v72, v72, v73
    v_cvt_pk_bf16_f32 v73, v74, v75
    v_mfma_f32_16x16x32_bf16 v[116:119], a[28:31], v[60:63], v[116:119]
    buffer_load_dwordx4 v19, s[44:47], s76 offen offset:1024 sc1 lds
    buffer_store_dwordx4 v[64:67], v21, s[44:47], s42 offen offset:0 sc1
    v_cvt_pk_bf16_f32 v74, v76, v77
    v_mfma_f32_16x16x32_bf16 v[112:115], a[24:27], v[60:63], v[112:115]
    ds_read_b128 v[52:55], v16 offset:15360
    v_cvt_pk_bf16_f32 v75, v78, v79
    v_bfi_b32 v72, s33, v253, v72
    v_mfma_f32_16x16x32_bf16 v[112:115], a[16:19], v[56:59], v[112:115]
    s_waitcnt lgkmcnt(4)
    buffer_load_dwordx4 v20, s[44:47], s76 offen offset:2048 sc1 lds
    v_bfi_b32 v73, s33, v255, v73
    v_mfma_f32_16x16x32_bf16 v[120:123], a[16:19], v[32:35], v[120:123]
    s_add_u32 m0, s21, 61440
    ds_read_b128 v[56:59], v16 offset:13312
    v_bfi_b32 v74, s33, v23, v74
    v_bfi_b32 v75, s33, v0, v75
    v_mfma_f32_16x16x32_bf16 v[120:123], a[24:27], v[36:39], v[120:123]
    buffer_load_dwordx4 v18, s[44:47], s78 offen offset:0 sc1 lds
    v_cvt_pk_bf16_f32 v80, v80, v81
    v_cvt_pk_bf16_f32 v81, v82, v83
    v_mfma_f32_16x16x32_bf16 v[124:127], a[28:31], v[36:39], v[124:127]
    ds_read_b128 v[60:63], v16 offset:16384
    buffer_store_dwordx4 v[72:75], v21, s[44:47], s42 offen offset:1024 sc1
    v_cvt_pk_bf16_f32 v82, v84, v85
L_pl_G_3:
    s_cbranch_execz L_wret
    v_mfma_f32_16x16x32_bf16 v[124:127], a[20:23], v[32:35], v[124:127]
    s_waitcnt lgkmcnt(4)
    buffer_load_dwordx4 v19, s[44:47], s78 offen offset:1024 sc1 lds
    v_cvt_pk_bf16_f32 v83, v86, v87
    v_bfi_b32 v80, s33, v253, v80
    v_mfma_f32_16x16x32_bf16 v[132:135], a[20:23], v[40:43], v[132:135]
    ds_read_b128 v[32:35], v16 offset:14336
    v_bfi_b32 v81, s33, v255, v81
    v_mfma_f32_16x16x32_bf16 v[132:135], a[28:31], v[44:47], v[132:135]
    v_bfi_b32 v82, s33, v23, v82
    v_bfi_b32 v83, s33, v0, v83
    v_mfma_f32_16x16x32_bf16 v[128:131], a[24:27], v[44:47], v[128:131]
    ds_read_b128 v[36:39], v16 offset:17408
    v_bfe_u32 v150, v2, 3, 1
    v_mfma_f32_16x16x32_bf16 v[128:131], a[16:19], v[40:43], v[128:131]
    s_waitcnt lgkmcnt(4)
    buffer_store_dwordx4 v[80:83], v21, s[44:47], s42 offen offset:2048 sc1
    v_mfma_f32_16x16x32_bf16 v[112:115], a[32:35], v[48:51], v[112:115]
    ds_read_b128 v[40:43], v16 offset:18432
    v_mfma_f32_16x16x32_bf16 v[112:115], a[40:43], v[52:55], v[112:115]
    buffer_load_dwordx4 v20, s[44:47], s78 offen offset:2048 sc1 lds
    v_mfma_f32_16x16x32_bf16 v[116:119], a[44:47], v[52:55], v[116:119]
    ds_read_b128 v[44:47], v16 offset:21504
    v_mfma_f32_16x16x32_bf16 v[116:119], a[36:39], v[48:51], v[116:119]
    s_waitcnt lgkmcnt(4)
    v_mul_u32_u24 v150, 8736, v150
    v_mfma_f32_16x16x32_bf16 v[124:127], a[36:39], v[56:59], v[124:127]
    s_add_u32 m0, s20, 49152
    ds_read_b128 v[48:51], v16 offset:19456
    s_lshl_b32 s14, s86, 1
    v_mfma_f32_16x16x32_bf16 v[124:127], a[44:47], v[60:63], v[124:127]
    buffer_load_dwordx4 v8, s[52:55], s14 offen offset:0 lds
    v_mfma_f32_16x16x32_bf16 v[120:123], a[40:43], v[60:63], v[120:123]
    ds_read_b128 v[52:55], v16 offset:22528
    v_mfma_f32_16x16x32_bf16 v[120:123], a[32:35], v[56:59], v[120:123]
    s_waitcnt lgkmcnt(4)
    v_mfma_f32_16x16x32_bf16 v[128:131], a[32:35], v[32:35], v[128:131]
    ds_read_b128 v[56:59], v16 offset:20480
    v_mfma_f32_16x16x32_bf16 v[128:131], a[40:43], v[36:39], v[128:131]
    v_mfma_f32_16x16x32_bf16 v[132:135], a[44:47], v[36:39], v[132:135]
    ds_read_b128 v[60:63], v16 offset:23552
    v_mfma_f32_16x16x32_bf16 v[132:135], a[36:39], v[32:35], v[132:135]
    s_waitcnt vmcnt(15) lgkmcnt(4)
    s_barrier
    v_and_b32 v151, 7, v2
    v_mfma_f32_16x16x32_bf16 v[116:119], a[52:55], v[40:43], v[116:119]
    ds_read_b128 v[32:35], v16 offset:24576
    v_mfma_f32_16x16x32_bf16 v[116:119], a[60:63], v[44:47], v[116:119]
    v_mfma_f32_16x16x32_bf16 v[112:115], a[56:59], v[44:47], v[112:115]
    ds_read_b128 v[36:39], v16 offset:27648
    v_mfma_f32_16x16x32_bf16 v[112:115], a[48:51], v[40:43], v[112:115]
    s_waitcnt lgkmcnt(4)
    v_mfma_f32_16x16x32_bf16 v[120:123], a[48:51], v[48:51], v[120:123]
    ds_read_b128 v[40:43], v16 offset:25600
    v_mfma_f32_16x16x32_bf16 v[120:123], a[56:59], v[52:55], v[120:123]
    v_lshl_add_u32 v150, v151, 2, v150
    v_mfma_f32_16x16x32_bf16 v[124:127], a[60:63], v[52:55], v[124:127]
    ds_read_b128 v[44:47], v16 offset:28672
    v_mfma_f32_16x16x32_bf16 v[124:127], a[52:55], v[48:51], v[124:127]
    s_waitcnt lgkmcnt(4)
    v_mfma_f32_16x16x32_bf16 v[132:135], a[52:55], v[56:59], v[132:135]
    ds_read_b128 v[48:51], v16 offset:26624
    v_mfma_f32_16x16x32_bf16 v[132:135], a[60:63], v[60:63], v[132:135]
    v_mfma_f32_16x16x32_bf16 v[128:131], a[56:59], v[60:63], v[128:131]
    ds_read_b128 v[52:55], v16 offset:29696
    v_mfma_f32_16x16x32_bf16 v[128:131], a[48:51], v[56:59], v[128:131]
    s_waitcnt lgkmcnt(4)
    v_mfma_f32_16x16x32_bf16 v[112:115], a[64:67], v[32:35], v[112:115]
    s_add_u32 s9, s43, 3072
    ds_read_b128 v[56:59], v16 offset:30720
    v_add_u32 v150, 65536, v150
    v_mfma_f32_16x16x32_bf16 v[112:115], a[72:75], v[36:39], v[112:115]
    ds_write_b32 v150, v148
    v_mfma_f32_16x16x32_bf16 v[116:119], a[76:79], v[36:39], v[116:119]
    ds_read_b128 v[60:63], v16 offset:33792
    v_mfma_f32_16x16x32_bf16 v[116:119], a[68:71], v[32:35], v[116:119]
    s_waitcnt lgkmcnt(5)
    buffer_load_dwordx4 v9, s[52:55], s14 offen offset:1024 lds
    v_mfma_f32_16x16x32_bf16 v[124:127], a[68:71], v[40:43], v[124:127]
    ds_read_b128 v[32:35], v16 offset:31744
    v_mfma_f32_16x16x32_bf16 v[124:127], a[76:79], v[44:47], v[124:127]
    buffer_load_dwordx4 v10, s[52:55], s14 offen offset:2048 lds
    v_mfma_f32_16x16x32_bf16 v[120:123], a[72:75], v[44:47], v[120:123]
    ds_read_b128 v[36:39], v16 offset:34816
    v_mfma_f32_16x16x32_bf16 v[120:123], a[64:67], v[40:43], v[120:123]
    s_waitcnt lgkmcnt(5)
    buffer_load_dwordx4 v11, s[52:55], s14 offen offset:3072 lds
    v_mfma_f32_16x16x32_bf16 v[128:131], a[64:67], v[48:51], v[128:131]
    s_add_u32 m0, s21, 0
    ds_read_b128 v[40:43], v16 offset:32768
    v_mfma_f32_16x16x32_bf16 v[128:131], a[72:75], v[52:55], v[128:131]
    buffer_load_dwordx4 v18, s[44:47], s80 offen offset:0 sc1 lds
    v_mfma_f32_16x16x32_bf16 v[132:135], a[76:79], v[52:55], v[132:135]
    ds_read_b128 v[44:47], v16 offset:35840
    v_mfma_f32_16x16x32_bf16 v[132:135], a[68:71], v[48:51], v[132:135]
    s_waitcnt vmcnt(14) lgkmcnt(4)
    s_barrier
    v_mfma_f32_16x16x32_bf16 v[116:119], a[84:87], v[56:59], v[116:119]
    s_add_u32 s12, s10, 65568
    ds_read_b128 v[48:51], v17 offset:0
    v_add_u32 v136, s12, v21
    v_mfma_f32_16x16x32_bf16 v[116:119], a[92:95], v[60:63], v[116:119]
    buffer_load_dwordx4 v19, s[44:47], s80 offen offset:1024 sc1 lds
    ds_read_b128 v[138:141], v136
    v_mfma_f32_16x16x32_bf16 v[112:115], a[88:91], v[60:63], v[112:115]
    ds_read_b128 v[52:55], v17 offset:3072
    v_mfma_f32_16x16x32_bf16 v[112:115], a[80:83], v[56:59], v[112:115]
    s_waitcnt lgkmcnt(5)
    buffer_load_dwordx4 v20, s[44:47], s80 offen offset:2048 sc1 lds
    v_cvt_pk_bf16_f32 v88, v88, v89
    v_mfma_f32_16x16x32_bf16 v[120:123], a[80:83], v[32:35], v[120:123]
    ds_read_b128 v[56:59], v17 offset:1024
    v_mfma_f32_16x16x32_bf16 v[120:123], a[88:91], v[36:39], v[120:123]
    ds_read_b32 v142, v136 offset:16
    v_lshrrev_b32 v137, 30, v25
    v_mfma_f32_16x16x32_bf16 v[124:127], a[92:95], v[36:39], v[124:127]
    ds_read_b128 v[60:63], v17 offset:4096
    v_cvt_pk_bf16_f32 v89, v90, v91
    v_mfma_f32_16x16x32_bf16 v[124:127], a[84:87], v[32:35], v[124:127]
    s_waitcnt lgkmcnt(6)
    v_mul_u32_u24 v137, 28, v137
    v_sub_u32 v137, 65568, v137
    v_mfma_f32_16x16x32_bf16 v[132:135], a[84:87], v[40:43], v[132:135]
    ds_read_b128 v[32:35], v17 offset:2048
    v_lshlrev_b32 v30, 16, v30
    v_mfma_f32_16x16x32_bf16 v[132:135], a[92:95], v[44:47], v[132:135]
    s_waitcnt lgkmcnt(2)
    v_cvt_pk_bf16_f32 v90, v92, v93
    v_lshlrev_b32 v143, 16, v138
    v_mfma_f32_16x16x32_bf16 v[128:131], a[88:91], v[44:47], v[128:131]
    ds_read_b128 v[36:39], v17 offset:5120
    v_add_f32 v143, v143, v30
    v_mfma_f32_16x16x32_bf16 v[128:131], a[80:83], v[40:43], v[128:131]
    v_alignbit_b32 v138, v139, v138, 16
    v_alignbit_b32 v139, v140, v139, 16
    v_mfma_f32_16x16x32_bf16 v[112:115], a[96:99], v[48:51], v[112:115]
    ds_read_b128 v[40:43], v17 offset:6144
    v_cvt_pk_bf16_f32 v91, v94, v95
    v_mfma_f32_16x16x32_bf16 v[112:115], a[104:107], v[52:55], v[112:115]
    v_alignbit_b32 v140, v141, v140, 16
    v_alignbit_b32 v141, v142, v141, 16
    v_mfma_f32_16x16x32_bf16 v[116:119], a[108:111], v[52:55], v[116:119]
    ds_read_b128 v[44:47], v17 offset:9216
    v_cvt_pk_bf16_f32 v143, v143, v143
    v_mfma_f32_16x16x32_bf16 v[116:119], a[100:103], v[48:51], v[116:119]
    s_waitcnt lgkmcnt(4)
    v_bfi_b32 v88, s33, v253, v88
    ds_write_b128 v136, v[138:141] offset:8736
    v_mfma_f32_16x16x32_bf16 v[124:127], a[100:103], v[56:59], v[124:127]
    s_add_u32 m0, s21, 12288
    ds_read_b128 v[48:51], v17 offset:7168
    v_cmp_eq_u32 vcc, 0, v25
    s_nop 1
    v_cndmask_b32 v143, 0, v143, vcc
    v_mfma_f32_16x16x32_bf16 v[124:127], a[108:111], v[60:63], v[124:127]
    buffer_load_dwordx4 v18, s[44:47], s82 offen offset:0 sc1 lds
    ds_write_b16 v137, v143
    v_mfma_f32_16x16x32_bf16 v[120:123], a[104:107], v[60:63], v[120:123]
    ds_read_b128 v[52:55], v17 offset:10240
    v_bfi_b32 v89, s33, v255, v89
    v_mfma_f32_16x16x32_bf16 v[120:123], a[96:99], v[56:59], v[120:123]
    s_waitcnt lgkmcnt(6)
    buffer_load_dwordx4 v19, s[44:47], s82 offen offset:1024 sc1 lds
    ds_write_b16 v137, v143 offset:8734
    v_mfma_f32_16x16x32_bf16 v[128:131], a[96:99], v[32:35], v[128:131]
    ds_read_b128 v[56:59], v17 offset:8192
    v_mfma_f32_16x16x32_bf16 v[128:131], a[104:107], v[36:39], v[128:131]
    buffer_load_dwordx4 v20, s[44:47], s82 offen offset:2048 sc1 lds
    v_bfi_b32 v90, s33, v23, v90
    v_mfma_f32_16x16x32_bf16 v[132:135], a[108:111], v[36:39], v[132:135]
    ds_read_b128 v[60:63], v17 offset:11264
    v_mfma_f32_16x16x32_bf16 v[132:135], a[100:103], v[32:35], v[132:135]
    s_waitcnt vmcnt(15) lgkmcnt(2)
    s_barrier
    v_and_b32 v1, 15, v2
    v_mfma_f32_16x16x32_bf16 v[116:119], a[116:119], v[40:43], v[116:119]
    s_add_u32 m0, s20, 0
    ds_read_b128 v[32:35], v17 offset:12288
    s_lshl_b32 s14, s87, 1
    v_mfma_f32_16x16x32_bf16 v[116:119], a[124:127], v[44:47], v[116:119]
    buffer_load_dwordx4 v8, s[52:55], s14 offen offset:0 lds
    v_bfi_b32 v91, s33, v0, v91
    v_mfma_f32_16x16x32_bf16 v[112:115], a[120:123], v[44:47], v[112:115]
    s_add_u32 s42, s42, 3072
    ds_read_b128 v[36:39], v17 offset:15360
    v_cvt_pk_bf16_f32 v96, v96, v97
    v_mfma_f32_16x16x32_bf16 v[112:115], a[112:115], v[40:43], v[112:115]
    buffer_store_dwordx4 v[88:91], v21, s[44:47], s42 offen offset:0 sc1
    v_mfma_f32_16x16x32_bf16 v[120:123], a[112:115], v[48:51], v[120:123]
    ds_read_b128 v[40:43], v17 offset:13312
    v_lshrrev_b32 v31, 4, v2
    v_mfma_f32_16x16x32_bf16 v[120:123], a[120:123], v[52:55], v[120:123]
    buffer_load_dwordx4 v9, s[52:55], s14 offen offset:1024 lds
    v_lshlrev_b32 v3, 1, v1
    v_mfma_f32_16x16x32_bf16 v[124:127], a[124:127], v[52:55], v[124:127]
    ds_read_b128 v[44:47], v17 offset:16384
    v_cvt_pk_bf16_f32 v97, v98, v99
    v_mfma_f32_16x16x32_bf16 v[124:127], a[116:119], v[48:51], v[124:127]
    s_waitcnt lgkmcnt(4)
    buffer_load_dwordx4 v10, s[52:55], s14 offen offset:2048 lds
    v_sub_u32 v3, v3, v31
    v_mfma_f32_16x16x32_bf16 v[132:135], a[116:119], v[56:59], v[132:135]
    ds_read_b128 v[48:51], v17 offset:14336
    v_cvt_pk_bf16_f32 v98, v100, v101
    v_mfma_f32_16x16x32_bf16 v[132:135], a[124:127], v[60:63], v[132:135]
    s_lshl_b32 s4, s3, 7
    buffer_load_dwordx4 v11, s[52:55], s14 offen offset:3072 lds
    v_mfma_f32_16x16x32_bf16 v[128:131], a[120:123], v[60:63], v[128:131]
    s_add_u32 m0, s21, 24576
    ds_read_b128 v[52:55], v17 offset:17408
    s_bfe_u32 s14, s31, 0x30009
    s_lshl_b32 s14, s14, 8
    s_add_u32 s14, s14, s17
    v_add_u32 v18, s14, v22
    v_mfma_f32_16x16x32_bf16 v[128:131], a[112:115], v[56:59], v[128:131]
    s_waitcnt lgkmcnt(4)
    buffer_load_dwordx4 v18, s[44:47], s68 offen offset:0 sc1 lds
    v_cvt_pk_bf16_f32 v99, v102, v103
    v_mfma_f32_16x16x32_bf16 v[112:115], a[128:131], v[32:35], v[112:115]
    s_sub_u32 s4, 70128, s4
    ds_read_b128 v[56:59], v17 offset:18432
    v_mfma_f32_16x16x32_bf16 v[112:115], a[136:139], v[36:39], v[112:115]
    v_bfi_b32 v96, s33, v253, v96
    v_mfma_f32_16x16x32_bf16 v[116:119], a[140:143], v[36:39], v[116:119]
    s_bfe_u32 s14, s31, 0x3000c
    ds_read_b128 v[60:63], v17 offset:21504
    s_lshl_b32 s14, s14, 8
    s_add_u32 s14, s14, s17
    s_sub_u32 s14, s14, 1024
    v_add_u32 v19, s14, v22
    v_mfma_f32_16x16x32_bf16 v[116:119], a[132:135], v[32:35], v[116:119]
    s_waitcnt lgkmcnt(4)
    buffer_load_dwordx4 v19, s[44:47], s68 offen offset:1024 sc1 lds
    v_lshl_add_u32 v30, v3, 4, s4
    v_mfma_f32_16x16x32_bf16 v[124:127], a[132:135], v[40:43], v[124:127]
    s_bfe_u32 s14, s31, 0x3000f
    ds_read_b128 v[32:35], v17 offset:19456
    s_lshl_b32 s14, s14, 8
    s_add_u32 s14, s14, s17
    s_sub_u32 s14, s14, 2048
    v_add_u32 v20, s14, v22
    v_mfma_f32_16x16x32_bf16 v[124:127], a[140:143], v[44:47], v[124:127]
    buffer_load_dwordx4 v20, s[44:47], s68 offen offset:2048 sc1 lds
    v_bfi_b32 v97, s33, v255, v97
    v_mfma_f32_16x16x32_bf16 v[120:123], a[136:139], v[44:47], v[120:123]
    ds_read_b128 v[36:39], v17 offset:22528
    v_and_b32 v1, 15, v2
    v_mfma_f32_16x16x32_bf16 v[120:123], a[128:131], v[40:43], v[120:123]
    s_waitcnt lgkmcnt(4)
    v_bfi_b32 v98, s33, v23, v98
    v_add_u32 v1, 1, v1
    v_mfma_f32_16x16x32_bf16 v[128:131], a[128:131], v[48:51], v[128:131]
    ds_read_b128 v[40:43], v17 offset:20480
    v_mfma_f32_16x16x32_bf16 v[128:131], a[136:139], v[52:55], v[128:131]
    v_and_b32 v3, 1, v1
    v_mfma_f32_16x16x32_bf16 v[132:135], a[140:143], v[52:55], v[132:135]
    ds_read_b128 v[44:47], v17 offset:23552
    v_bfi_b32 v99, s33, v0, v99
    v_mfma_f32_16x16x32_bf16 v[132:135], a[132:135], v[48:51], v[132:135]
    s_waitcnt vmcnt(14) lgkmcnt(4)
    s_barrier
    v_cvt_pk_bf16_f32 v104, v104, v105
    v_mfma_f32_16x16x32_bf16 v[116:119], a[148:151], v[56:59], v[116:119]
    ds_read_b128 v[48:51], v17 offset:24576
    v_mul_u32_u24 v3, 8736, v3
    v_mfma_f32_16x16x32_bf16 v[116:119], a[156:159], v[60:63], v[116:119]
    ds_read_b64_tr_b16 v[188:189], v12 offset:49152
    buffer_store_dwordx4 v[96:99], v21, s[44:47], s42 offen offset:1024 sc1
    v_mfma_f32_16x16x32_bf16 v[112:115], a[152:155], v[60:63], v[112:115]
    ds_read_b128 v[52:55], v17 offset:27648
    v_cvt_pk_bf16_f32 v105, v106, v107
    v_mfma_f32_16x16x32_bf16 v[112:115], a[144:147], v[56:59], v[112:115]
    s_waitcnt lgkmcnt(5)
    ds_read_b64_tr_b16 v[190:191], v12 offset:50176
    v_cvt_pk_bf16_f32 v106, v108, v109
    v_mfma_f32_16x16x32_bf16 v[120:123], a[144:147], v[32:35], v[120:123]
    ds_read_b128 v[56:59], v17 offset:25600
    v_lshrrev_b32 v1, 1, v1
    v_mfma_f32_16x16x32_bf16 v[120:123], a[152:155], v[36:39], v[120:123]
    v_cvt_pk_bf16_f32 v107, v110, v111
    v_lshl_add_u32 v3, v1, 2, v3
    v_mfma_f32_16x16x32_bf16 v[124:127], a[156:159], v[36:39], v[124:127]
    ds_read_b128 v[60:63], v17 offset:28672
    v_bfi_b32 v104, s33, v253, v104
    v_mfma_f32_16x16x32_bf16 v[124:127], a[148:151], v[32:35], v[124:127]
    s_waitcnt lgkmcnt(6)
    ds_read_b64_tr_b16 v[192:193], v13 offset:49152
    v_lshrrev_b32 v1, 4, v2
    v_mfma_f32_16x16x32_bf16 v[132:135], a[148:151], v[40:43], v[132:135]
    ds_read_b128 v[32:35], v17 offset:26624
    v_bfi_b32 v105, s33, v255, v105
    v_mfma_f32_16x16x32_bf16 v[132:135], a[156:159], v[44:47], v[132:135]
    ds_read_b64_tr_b16 v[194:195], v13 offset:50176
    v_lshl_add_u32 v3, v1, 4, v3
    v_mfma_f32_16x16x32_bf16 v[128:131], a[152:155], v[44:47], v[128:131]
    ds_read_b128 v[36:39], v17 offset:29696
    v_bfi_b32 v106, s33, v23, v106
    v_mfma_f32_16x16x32_bf16 v[128:131], a[144:147], v[40:43], v[128:131]
    s_waitcnt lgkmcnt(7)
    v_mfma_f32_16x16x32_bf16 v[112:115], a[160:163], v[48:51], v[112:115]
    s_lshl_b32 s4, s3, 7
    ds_read_b128 v[40:43], v17 offset:30720
    v_bfi_b32 v107, s33, v0, v107
    v_mfma_f32_16x16x32_bf16 v[112:115], a[168:171], v[52:55], v[112:115]
    ds_read_b64_tr_b16 v[196:197], v12 offset:57344
    v_mfma_f32_16x16x32_bf16 v[116:119], a[172:175], v[52:55], v[116:119]
    ds_read_b128 v[44:47], v17 offset:33792
    v_mfma_f32_16x16x32_bf16 v[116:119], a[164:167], v[48:51], v[116:119]
    s_waitcnt lgkmcnt(7)
    s_add_u32 s4, s4, 65536
    ds_read_b64_tr_b16 v[198:199], v12 offset:58368
    buffer_load_dwordx4 v[136:139], v21, s[44:47], s43 offen offset:0 sc1
    v_mfma_f32_16x16x32_bf16 v[124:127], a[164:167], v[56:59], v[124:127]
    ds_read_b128 v[48:51], v17 offset:31744
    v_mfma_f32_16x16x32_bf16 v[124:127], a[172:175], v[60:63], v[124:127]
    v_add_u32 v4, s4, v3
    v_mfma_f32_16x16x32_bf16 v[120:123], a[168:171], v[60:63], v[120:123]
    ds_read_b128 v[52:55], v17 offset:34816
    buffer_load_dwordx4 v[140:143], v21, s[44:47], s43 offen offset:1024 sc1
    v_mfma_f32_16x16x32_bf16 v[120:123], a[160:163], v[56:59], v[120:123]
    s_waitcnt lgkmcnt(6)
    ds_read_b64_tr_b16 v[200:201], v13 offset:57344
    v_add_u32 v5, 1024, v4
    v_mfma_f32_16x16x32_bf16 v[128:131], a[160:163], v[32:35], v[128:131]
    s_add_u32 m0, s21, 36864
    ds_read_b128 v[56:59], v17 offset:32768
    buffer_load_dwordx4 v[108:111], v21, s[44:47], s43 offen offset:2048 sc1
    v_mfma_f32_16x16x32_bf16 v[128:131], a[168:171], v[36:39], v[128:131]
    buffer_load_dwordx4 v18, s[44:47], s70 offen offset:0 sc1 lds
    ds_read_b64_tr_b16 v[202:203], v13 offset:58368
    v_mfma_f32_16x16x32_bf16 v[132:135], a[172:175], v[36:39], v[132:135]
    ds_read_b128 v[60:63], v17 offset:35840
    v_add_u32 v6, 1024, v5
    v_mfma_f32_16x16x32_bf16 v[132:135], a[164:167], v[32:35], v[132:135]
    s_waitcnt vmcnt(8) lgkmcnt(1)
    s_barrier
    v_mfma_f32_16x16x32_bf16 v[116:119], a[180:183], v[40:43], v[116:119]
    ds_read_b128 v[32:35], v16 offset:0
    v_add_u32 v7, 1024, v6
    v_mfma_f32_16x16x32_bf16 v[116:119], a[188:191], v[44:47], v[116:119]
    buffer_load_dwordx4 v19, s[44:47], s70 offen offset:1024 sc1 lds
    ds_read_b64_tr_b16 v[204:205], v12 offset:0
    v_mfma_f32_16x16x32_bf16 v[112:115], a[184:187], v[44:47], v[112:115]
    ds_read_b128 v[36:39], v16 offset:3072
    buffer_store_dwordx4 v[104:107], v21, s[44:47], s42 offen offset:2048 sc1
    v_mfma_f32_16x16x32_bf16 v[112:115], a[176:179], v[40:43], v[112:115]
    buffer_load_dwordx4 v20, s[44:47], s70 offen offset:2048 sc1 lds
    ds_read_b64_tr_b16 v[206:207], v12 offset:1024
    v_mfma_f32_16x16x32_bf16 v[120:123], a[176:179], v[48:51], v[120:123]
    s_add_u32 m0, s20, 16384
    ds_read_b128 v[40:43], v16 offset:1024
    s_lshl_b32 s14, s88, 1
    v_mfma_f32_16x16x32_bf16 v[120:123], a[184:187], v[52:55], v[120:123]
    buffer_load_dwordx4 v8, s[52:55], s14 offen offset:0 lds
    v_and_b32 v1, 15, v2
    v_mfma_f32_16x16x32_bf16 v[124:127], a[188:191], v[52:55], v[124:127]
    ds_read_b128 v[44:47], v16 offset:4096
    v_lshrrev_b32 v31, 4, v2
    v_mfma_f32_16x16x32_bf16 v[124:127], a[180:183], v[48:51], v[124:127]
    s_waitcnt lgkmcnt(6)
    ds_read_b64_tr_b16 v[208:209], v13 offset:0
    v_mfma_f32_16x16x32_bf16 v[132:135], a[180:183], v[56:59], v[132:135]
    ds_read_b128 v[48:51], v16 offset:2048
    v_lshlrev_b32 v31, 2, v31
    v_mfma_f32_16x16x32_bf16 v[132:135], a[188:191], v[60:63], v[132:135]
    ds_read_b64_tr_b16 v[210:211], v13 offset:1024
    v_mfma_f32_16x16x32_bf16 v[128:131], a[184:187], v[60:63], v[128:131]
    ds_read_b128 v[52:55], v16 offset:5120
    v_sub_u32 v1, v1, v31
    v_mfma_f32_16x16x32_bf16 v[128:131], a[176:179], v[56:59], v[128:131]
    s_waitcnt lgkmcnt(7)
    v_mfma_f32_16x16x32_bf16 v[112:115], a[192:195], v[32:35], v[112:115]
    ds_read_b128 v[56:59], v16 offset:6144
    v_mfma_f32_16x16x32_bf16 v[112:115], a[200:203], v[36:39], v[112:115]
    ds_read_b64_tr_b16 v[212:213], v12 offset:8192
    v_and_b32 v31, 1, v1
    v_mfma_f32_16x16x32_bf16 v[116:119], a[204:207], v[36:39], v[116:119]
    ds_read_b128 v[60:63], v16 offset:9216
    v_mfma_f32_16x16x32_bf16 v[116:119], a[196:199], v[32:35], v[116:119]
    s_waitcnt lgkmcnt(7)
    buffer_load_dwordx4 v9, s[52:55], s14 offen offset:1024 lds
    ds_read_b64_tr_b16 v[214:215], v12 offset:9216
    v_mfma_f32_16x16x32_bf16 v[124:127], a[196:199], v[40:43], v[124:127]
    ds_read_b128 v[32:35], v16 offset:7168
    v_lshlrev_b32 v31, 4, v31
    v_mfma_f32_16x16x32_bf16 v[124:127], a[204:207], v[44:47], v[124:127]
    buffer_load_dwordx4 v10, s[52:55], s14 offen offset:2048 lds
    v_mfma_f32_16x16x32_bf16 v[120:123], a[200:203], v[44:47], v[120:123]
    s_movk_i32 s4, 0x3f80
    ds_read_b128 v[36:39], v16 offset:10240
    v_mfma_f32_16x16x32_bf16 v[120:123], a[192:195], v[40:43], v[120:123]
    s_waitcnt lgkmcnt(6)
    buffer_load_dwordx4 v11, s[52:55], s14 offen offset:3072 lds
    ds_read_b64_tr_b16 v[216:217], v13 offset:8192
    v_mfma_f32_16x16x32_bf16 v[128:131], a[192:195], v[48:51], v[128:131]
    s_add_u32 m0, s21, 49152
    ds_read_b128 v[40:43], v16 offset:8192
    v_lshlrev_b32 v31, v31, s4
    v_mfma_f32_16x16x32_bf16 v[128:131], a[200:203], v[52:55], v[128:131]
    buffer_load_dwordx4 v18, s[44:47], s72 offen offset:0 sc1 lds
    ds_read_b64_tr_b16 v[218:219], v13 offset:9216
    v_mfma_f32_16x16x32_bf16 v[132:135], a[204:207], v[52:55], v[132:135]
    ds_read_b128 v[44:47], v16 offset:11264
    v_ashrrev_i32 v1, 1, v1
    v_mfma_f32_16x16x32_bf16 v[132:135], a[196:199], v[48:51], v[132:135]
    s_waitcnt lgkmcnt(1)
    s_barrier
    v_cmp_eq_u32 vcc, 0, v1
    s_nop 1
    v_cndmask_b32 v148, 0, v31, vcc
    v_mfma_f32_16x16x32_bf16 v[116:119], a[212:215], v[56:59], v[116:119]
    ds_read_b128 v[48:51], v16 offset:12288
    v_mfma_f32_16x16x32_bf16 v[116:119], a[220:223], v[60:63], v[116:119]
    buffer_load_dwordx4 v19, s[44:47], s72 offen offset:1024 sc1 lds
    v_mfma_f32_16x16x32_bf16 v[112:115], a[216:219], v[60:63], v[112:115]
    ds_read_b128 v[52:55], v16 offset:15360
    v_mfma_f32_16x16x32_bf16 v[112:115], a[208:211], v[56:59], v[112:115]
    buffer_load_dwordx4 v20, s[44:47], s72 offen offset:2048 sc1 lds
    v_mfma_f32_16x16x32_bf16 v[120:123], a[208:211], v[32:35], v[120:123]
    ds_read_b128 v[56:59], v16 offset:13312
    v_mfma_f32_16x16x32_bf16 v[120:123], a[216:219], v[36:39], v[120:123]
    v_cmp_eq_u32 vcc, 1, v1
    s_nop 1
    v_cndmask_b32 v149, 0, v31, vcc
    v_mfma_f32_16x16x32_bf16 v[124:127], a[220:223], v[36:39], v[124:127]
    ds_read_b128 v[60:63], v16 offset:16384
    v_mov_b32 v146, 0
    v_mfma_f32_16x16x32_bf16 v[124:127], a[212:215], v[32:35], v[124:127]
    s_waitcnt lgkmcnt(4)
    v_mfma_f32_16x16x32_bf16 v[132:135], a[212:215], v[40:43], v[132:135]
    ds_read_b128 v[32:35], v16 offset:14336
    v_mov_b32 v147, 0
    v_mfma_f32_16x16x32_bf16 v[132:135], a[220:223], v[44:47], v[132:135]
    v_mfma_f32_16x16x32_bf16 v[128:131], a[216:219], v[44:47], v[128:131]
    ds_read_b128 v[36:39], v16 offset:17408
    v_mfma_f32_16x16x32_bf16 v[128:131], a[208:211], v[40:43], v[128:131]
    s_waitcnt lgkmcnt(4)
    v_mov_b32 v150, 0
    v_mfma_f32_16x16x32_bf16 v[112:115], a[224:227], v[48:51], v[112:115]
    ds_read_b128 v[40:43], v16 offset:18432
    v_mfma_f32_16x16x32_bf16 v[112:115], a[232:235], v[52:55], v[112:115]
    v_mov_b32 v151, 0
    v_mfma_f32_16x16x32_bf16 v[116:119], a[236:239], v[52:55], v[116:119]
    ds_read_b128 v[44:47], v16 offset:21504
    v_mfma_f32_16x16x32_bf16 v[116:119], a[228:231], v[48:51], v[116:119]
    s_waitcnt lgkmcnt(4)
    v_mfma_f32_16x16x32_bf16 v[124:127], a[228:231], v[56:59], v[124:127]
    s_mov_b32 s10, 0xbdd2d3e8
    ds_read_b128 v[48:51], v16 offset:19456
    v_mfma_f32_16x16x32_bf16 v[124:127], a[236:239], v[60:63], v[124:127]
    v_mfma_f32_16x16x32_bf16 v[120:123], a[232:235], v[60:63], v[120:123]
    ds_read_b128 v[52:55], v16 offset:22528
    v_mov_b32 v3, 0xc0135761
    v_mfma_f32_16x16x32_bf16 v[120:123], a[224:227], v[56:59], v[120:123]
    s_waitcnt lgkmcnt(4)
    v_mfma_f32_16x16x32_bf16 v[128:131], a[224:227], v[32:35], v[128:131]
    s_add_u32 m0, s21, 61440
    ds_read_b128 v[56:59], v16 offset:20480
    v_mfma_f32_16x16x32_bf16 v[128:131], a[232:235], v[36:39], v[128:131]
    buffer_load_dwordx4 v18, s[44:47], s74 offen offset:0 sc1 lds
    v_mfma_f32_16x16x32_bf16 v[132:135], a[236:239], v[36:39], v[132:135]
    s_waitcnt vmcnt(12)
    ds_read_b128 v[60:63], v16 offset:23552
    v_xor_b32 v136, v253, v136
    v_mfma_f32_16x16x32_bf16 v[132:135], a[228:231], v[32:35], v[132:135]
    s_waitcnt lgkmcnt(4)
    s_barrier
    v_xor_b32 v137, v255, v137
    v_xor_b32 v138, v23, v138
    v_mfma_f32_16x16x32_bf16 v[116:119], a[244:247], v[40:43], v[116:119]
    ds_read_b128 v[32:35], v16 offset:24576
    v_xor_b32 v139, v0, v139
    v_mfma_f32_16x16x32_bf16 v[116:119], a[252:255], v[44:47], v[116:119]
    buffer_load_dwordx4 v19, s[44:47], s74 offen offset:1024 sc1 lds
    v_or3_b32 v1, v136, v137, v138
    v_mfma_f32_16x16x32_bf16 v[112:115], a[248:251], v[44:47], v[112:115]
    ds_read_b128 v[36:39], v16 offset:27648
    v_xor_b32 v140, v253, v140
    v_mfma_f32_16x16x32_bf16 v[112:115], a[240:243], v[40:43], v[112:115]
    s_waitcnt lgkmcnt(4)
    buffer_load_dwordx4 v20, s[44:47], s74 offen offset:2048 sc1 lds
    v_xor_b32 v141, v255, v141
    v_mfma_f32_16x16x32_bf16 v[120:123], a[240:243], v[48:51], v[120:123]
    s_add_u32 m0, s20, 32768
    ds_read_b128 v[40:43], v16 offset:25600
    s_lshl_b32 s14, s89, 1
    v_mfma_f32_16x16x32_bf16 v[120:123], a[248:251], v[52:55], v[120:123]
    buffer_load_dwordx4 v8, s[52:55], s14 offen offset:0 lds
    v_or3_b32 v1, v139, v140, v1
    v_mfma_f32_16x16x32_bf16 v[124:127], a[252:255], v[52:55], v[124:127]
    ds_read_b128 v[44:47], v16 offset:28672
    v_xor_b32 v142, v23, v142
    v_mfma_f32_16x16x32_bf16 v[124:127], a[244:247], v[48:51], v[124:127]
    s_waitcnt lgkmcnt(4)
    buffer_load_dwordx4 v9, s[52:55], s14 offen offset:1024 lds
    v_xor_b32 v143, v0, v143
    v_mfma_f32_16x16x32_bf16 v[132:135], a[244:247], v[56:59], v[132:135]
    ds_read_b128 v[48:51], v16 offset:26624
    v_or3_b32 v1, v141, v142, v1
    v_mfma_f32_16x16x32_bf16 v[132:135], a[252:255], v[60:63], v[132:135]
    buffer_load_dwordx4 v10, s[52:55], s14 offen offset:2048 lds
    v_xor_b32 v108, v253, v108
    v_mfma_f32_16x16x32_bf16 v[128:131], a[248:251], v[60:63], v[128:131]
    ds_read_b128 v[52:55], v16 offset:29696
    v_xor_b32 v109, v255, v109
    v_mfma_f32_16x16x32_bf16 v[128:131], a[240:243], v[56:59], v[128:131]
    s_waitcnt lgkmcnt(4)
    buffer_load_dwordx4 v11, s[52:55], s14 offen offset:3072 lds
    v_or3_b32 v1, v143, v108, v1
    v_mfma_f32_16x16x32_bf16 v[64:67], a[0:3], v[32:35], 0
    ds_read_b128 v[56:59], v16 offset:30720
    v_xor_b32 v110, v23, v110
    v_mfma_f32_16x16x32_bf16 v[64:67], a[8:11], v[36:39], v[64:67]
    v_xor_b32 v111, v0, v111
    v_or3_b32 v1, v109, v110, v1
    v_mfma_f32_16x16x32_bf16 v[68:71], a[12:15], v[36:39], 0
    s_add_u32 m0, s20, 49152
    ds_read_b128 v[60:63], v16 offset:33792
    s_lshl_b32 s14, s90, 1
    v_mfma_f32_16x16x32_bf16 v[68:71], a[4:7], v[32:35], v[68:71]
    s_waitcnt lgkmcnt(4)
    buffer_load_dwordx4 v8, s[52:55], s14 offen offset:0 lds
    v_or_b32 v1, v111, v1
    v_mfma_f32_16x16x32_bf16 v[76:79], a[4:7], v[40:43], 0
    ds_read_b128 v[32:35], v16 offset:31744
    v_and_b32 v1, s33, v1
    v_mfma_f32_16x16x32_bf16 v[76:79], a[12:15], v[44:47], v[76:79]
    buffer_load_dwordx4 v9, s[52:55], s14 offen offset:1024 lds
    v_cmp_ne_u32 vcc, 0, v1
    s_cbranch_vccnz L_rs_bl0
L_ok_bl0:
    v_mfma_f32_16x16x32_bf16 v[72:75], a[8:11], v[44:47], 0
    ds_read_b128 v[36:39], v16 offset:34816
    v_mfma_f32_16x16x32_bf16 v[112:115], v[148:151], v[136:139], v[112:115]
    v_mfma_f32_16x16x32_bf16 v[72:75], a[0:3], v[40:43], v[72:75]
    s_waitcnt lgkmcnt(4)
    buffer_load_dwordx4 v10, s[52:55], s14 offen offset:2048 lds
    v_mfma_f32_16x16x32_bf16 v[116:119], v[146:149], v[136:139], v[116:119]
    v_mfma_f32_16x16x32_bf16 v[80:83], a[0:3], v[48:51], 0
    ds_read_b128 v[40:43], v16 offset:32768
    v_mfma_f32_16x16x32_bf16 v[120:123], v[148:151], v[140:143], v[120:123]
    v_mfma_f32_16x16x32_bf16 v[80:83], a[8:11], v[52:55], v[80:83]
    buffer_load_dwordx4 v11, s[52:55], s14 offen offset:3072 lds
    v_mfma_f32_16x16x32_bf16 v[124:127], v[146:149], v[140:143], v[124:127]
    v_mfma_f32_16x16x32_bf16 v[84:87], a[12:15], v[52:55], 0
    ds_read_b128 v[44:47], v16 offset:35840
    v_mfma_f32_16x16x32_bf16 v[128:131], v[148:151], v[108:111], v[128:131]
    v_mfma_f32_16x16x32_bf16 v[84:87], a[4:7], v[48:51], v[84:87]
    s_waitcnt vmcnt(14) lgkmcnt(4)
    s_barrier
    v_mfma_f32_16x16x32_bf16 v[132:135], v[146:149], v[108:111], v[132:135]
    v_mfma_f32_16x16x32_bf16 v[68:71], a[20:23], v[56:59], v[68:71]
    s_add_u32 m0, s21, 0
    ds_read_b128 v[48:51], v17 offset:0
    v_mfma_f32_16x16x32_bf16 v[68:71], a[28:31], v[60:63], v[68:71]
    buffer_load_dwordx4 v18, s[44:47], s76 offen offset:0 sc1 lds
    ds_read_b64_tr_b16 v[220:221], v12 offset:16384
    v_mfma_f32_16x16x32_bf16 v[64:67], a[24:27], v[60:63], v[64:67]
    ds_read_b128 v[52:55], v17 offset:3072
    v_mfma_f32_16x16x32_bf16 v[64:67], a[16:19], v[56:59], v[64:67]
    s_waitcnt lgkmcnt(5)
    buffer_load_dwordx4 v19, s[44:47], s76 offen offset:1024 sc1 lds
    ds_read_b64_tr_b16 v[222:223], v12 offset:17408
    v_mfma_f32_16x16x32_bf16 v[72:75], a[16:19], v[32:35], v[72:75]
    ds_read_b128 v[56:59], v17 offset:1024
    v_mov_b32 v136, 0xc0135761
    v_pk_mul_f32 v[88:89], v[112:113], v[112:113]
    v_pk_mul_f32 v[90:91], v[114:115], v[114:115]
    v_pk_mul_f32 v[92:93], v[116:117], v[116:117]
    v_pk_mul_f32 v[94:95], v[118:119], v[118:119]
    v_pk_mul_f32 v[96:97], v[120:121], v[120:121]
    v_pk_mul_f32 v[98:99], v[122:123], v[122:123]
    v_pk_mul_f32 v[100:101], v[124:125], v[124:125]
    v_pk_mul_f32 v[102:103], v[126:127], v[126:127]
    v_pk_mul_f32 v[104:105], v[128:129], v[128:129]
    v_pk_mul_f32 v[106:107], v[130:131], v[130:131]
L_pl_G_4:
    s_cbranch_execz L_wret
    v_pk_mul_f32 v[108:109], v[132:133], v[132:133]
    v_pk_mul_f32 v[110:111], v[134:135], v[134:135]
    v_pk_fma_f32 v[88:89], v[88:89], s[10:11], v[136:137] op_sel_hi:[1,0,0]
    v_pk_fma_f32 v[90:91], v[90:91], s[10:11], v[136:137] op_sel_hi:[1,0,0]
    v_pk_fma_f32 v[92:93], v[92:93], s[10:11], v[136:137] op_sel_hi:[1,0,0]
    v_pk_fma_f32 v[94:95], v[94:95], s[10:11], v[136:137] op_sel_hi:[1,0,0]
    v_pk_fma_f32 v[96:97], v[96:97], s[10:11], v[136:137] op_sel_hi:[1,0,0]
    v_pk_fma_f32 v[98:99], v[98:99], s[10:11], v[136:137] op_sel_hi:[1,0,0]
    v_pk_fma_f32 v[100:101], v[100:101], s[10:11], v[136:137] op_sel_hi:[1,0,0]
    v_pk_fma_f32 v[102:103], v[102:103], s[10:11], v[136:137] op_sel_hi:[1,0,0]
    v_pk_fma_f32 v[104:105], v[104:105], s[10:11], v[136:137] op_sel_hi:[1,0,0]
    v_pk_fma_f32 v[106:107], v[106:107], s[10:11], v[136:137] op_sel_hi:[1,0,0]
    v_pk_fma_f32 v[108:109], v[108:109], s[10:11], v[136:137] op_sel_hi:[1,0,0]
    v_pk_fma_f32 v[110:111], v[110:111], s[10:11], v[136:137] op_sel_hi:[1,0,0]
    v_pk_mul_f32 v[88:89], v[88:89], v[112:113]
    v_mfma_f32_16x16x32_bf16 v[72:75], a[24:27], v[36:39], v[72:75]
    buffer_load_dwordx4 v20, s[44:47], s76 offen offset:2048 sc1 lds
    v_mfma_f32_16x16x32_bf16 v[76:79], a[28:31], v[36:39], v[76:79]
    s_add_u32 m0, s20, 0
    ds_read_b128 v[60:63], v17 offset:4096
    s_lshl_b32 s14, s91, 1
    v_pk_mul_f32 v[90:91], v[90:91], v[114:115]
    v_pk_mul_f32 v[92:93], v[92:93], v[116:117]
    v_pk_mul_f32 v[94:95], v[94:95], v[118:119]
    v_pk_mul_f32 v[96:97], v[96:97], v[120:121]
    v_pk_mul_f32 v[98:99], v[98:99], v[122:123]
    v_pk_mul_f32 v[100:101], v[100:101], v[124:125]
    v_pk_mul_f32 v[102:103], v[102:103], v[126:127]
    v_pk_mul_f32 v[104:105], v[104:105], v[128:129]
    v_pk_mul_f32 v[106:107], v[106:107], v[130:131]
    v_pk_mul_f32 v[108:109], v[108:109], v[132:133]
    v_pk_mul_f32 v[110:111], v[110:111], v[134:135]
    v_exp_f32 v88, v88
    v_exp_f32 v89, v89
    v_exp_f32 v90, v90
    v_exp_f32 v91, v91
    v_exp_f32 v92, v92
    v_exp_f32 v93, v93
    v_exp_f32 v94, v94
    v_exp_f32 v95, v95
    v_exp_f32 v96, v96
    v_exp_f32 v97, v97
    v_exp_f32 v98, v98
    v_exp_f32 v99, v99
    v_exp_f32 v100, v100
    v_exp_f32 v101, v101
    v_exp_f32 v102, v102
    v_exp_f32 v103, v103
    v_mfma_f32_16x16x32_bf16 v[76:79], a[20:23], v[32:35], v[76:79]
    s_waitcnt lgkmcnt(6)
    buffer_load_dwordx4 v8, s[52:55], s14 offen offset:0 lds
    ds_read_b64_tr_b16 v[224:225], v13 offset:16384
    v_mfma_f32_16x16x32_bf16 v[84:87], a[20:23], v[40:43], v[84:87]
    ds_read_b128 v[32:35], v17 offset:2048
    v_exp_f32 v104, v104
    v_exp_f32 v105, v105
    v_exp_f32 v106, v106
    v_exp_f32 v107, v107
    v_exp_f32 v108, v108
    v_exp_f32 v109, v109
    v_exp_f32 v110, v110
    v_exp_f32 v111, v111
    v_pk_add_f32 v[88:89], v[88:89], 1.0 op_sel_hi:[1,0]
    v_pk_add_f32 v[90:91], v[90:91], 1.0 op_sel_hi:[1,0]
    v_pk_add_f32 v[92:93], v[92:93], 1.0 op_sel_hi:[1,0]
    v_pk_add_f32 v[94:95], v[94:95], 1.0 op_sel_hi:[1,0]
    v_pk_add_f32 v[96:97], v[96:97], 1.0 op_sel_hi:[1,0]
    v_pk_add_f32 v[98:99], v[98:99], 1.0 op_sel_hi:[1,0]
    v_pk_add_f32 v[100:101], v[100:101], 1.0 op_sel_hi:[1,0]
    v_pk_add_f32 v[102:103], v[102:103], 1.0 op_sel_hi:[1,0]
    v_pk_add_f32 v[104:105], v[104:105], 1.0 op_sel_hi:[1,0]
    v_pk_add_f32 v[106:107], v[106:107], 1.0 op_sel_hi:[1,0]
    v_pk_add_f32 v[108:109], v[108:109], 1.0 op_sel_hi:[1,0]
    v_pk_add_f32 v[110:111], v[110:111], 1.0 op_sel_hi:[1,0]
    v_rcp_f32 v88, v88
    v_rcp_f32 v89, v89
    v_rcp_f32 v90, v90
    v_rcp_f32 v91, v91
    v_rcp_f32 v92, v92
    v_rcp_f32 v93, v93
    v_mfma_f32_16x16x32_bf16 v[84:87], a[28:31], v[44:47], v[84:87]
    buffer_load_dwordx4 v9, s[52:55], s14 offen offset:1024 lds
    ds_read_b64_tr_b16 v[226:227], v13 offset:17408
    v_mfma_f32_16x16x32_bf16 v[80:83], a[24:27], v[44:47], v[80:83]
    ds_read_b128 v[36:39], v17 offset:5120
    v_rcp_f32 v94, v94
    v_rcp_f32 v95, v95
    v_pk_mul_f32 v[88:89], v[112:113], v[88:89]
    v_pk_mul_f32 v[90:91], v[114:115], v[90:91]
    v_pk_mul_f32 v[92:93], v[116:117], v[92:93]
    v_pk_mul_f32 v[94:95], v[118:119], v[94:95]
    v_cvt_pk_bf16_f32 v112, v88, v89
    v_cvt_pk_bf16_f32 v113, v90, v91
    v_cvt_pk_bf16_f32 v114, v92, v93
    v_cvt_pk_bf16_f32 v115, v94, v95
    s_bfe_u32 s11, s31, 0x30000
    s_lshl_b32 s11, s11, 8
    s_add_u32 s11, s11, s30
    buffer_store_dwordx4 v[112:115], v22, s[44:47], s11 offen sc1
    v_rcp_f32 v96, v96
    v_rcp_f32 v97, v97
    v_rcp_f32 v98, v98
    v_rcp_f32 v99, v99
    v_rcp_f32 v100, v100
    v_rcp_f32 v101, v101
    v_rcp_f32 v102, v102
    v_rcp_f32 v103, v103
    v_pk_mul_f32 v[96:97], v[120:121], v[96:97]
    v_pk_mul_f32 v[98:99], v[122:123], v[98:99]
    v_pk_mul_f32 v[100:101], v[124:125], v[100:101]
    v_pk_mul_f32 v[102:103], v[126:127], v[102:103]
    v_cvt_pk_bf16_f32 v120, v96, v97
    v_mfma_f32_16x16x32_bf16 v[80:83], a[16:19], v[40:43], v[80:83]
    s_waitcnt lgkmcnt(7)
    buffer_load_dwordx4 v10, s[52:55], s14 offen offset:2048 lds
    v_mfma_f32_16x16x32_bf16 v[64:67], a[32:35], v[48:51], v[64:67]
    ds_read_b128 v[40:43], v17 offset:6144
    v_cvt_pk_bf16_f32 v121, v98, v99
    v_cvt_pk_bf16_f32 v122, v100, v101
    v_cvt_pk_bf16_f32 v123, v102, v103
    s_bfe_u32 s11, s31, 0x30003
    s_lshl_b32 s11, s11, 8
    s_add_u32 s11, s11, s30
    buffer_store_dwordx4 v[120:123], v22, s[44:47], s11 offen sc1
    v_rcp_f32 v104, v104
    v_rcp_f32 v105, v105
    v_rcp_f32 v106, v106
    v_rcp_f32 v107, v107
    v_rcp_f32 v108, v108
    v_rcp_f32 v109, v109
    v_rcp_f32 v110, v110
    v_rcp_f32 v111, v111
    v_pk_mul_f32 v[104:105], v[128:129], v[104:105]
    v_pk_mul_f32 v[106:107], v[130:131], v[106:107]
    v_pk_mul_f32 v[108:109], v[132:133], v[108:109]
    v_pk_mul_f32 v[110:111], v[134:135], v[110:111]
    v_cvt_pk_bf16_f32 v128, v104, v105
    v_cvt_pk_bf16_f32 v129, v106, v107
    v_cvt_pk_bf16_f32 v130, v108, v109
    v_cvt_pk_bf16_f32 v131, v110, v111
    s_bfe_u32 s11, s31, 0x30006
    s_lshl_b32 s11, s11, 8
    s_add_u32 s11, s11, s30
    buffer_store_dwordx4 v[128:131], v22, s[44:47], s11 offen sc1
    v_mfma_f32_16x16x32_bf16 v[64:67], a[40:43], v[52:55], v[64:67]
    buffer_load_dwordx4 v11, s[52:55], s14 offen offset:3072 lds
    ds_read_b64_tr_b16 v[228:229], v12 offset:24576
    v_mfma_f32_16x16x32_bf16 v[68:71], a[44:47], v[52:55], v[68:71]
    s_add_u32 m0, s21, 12288
    ds_read_b128 v[44:47], v17 offset:9216
    v_mfma_f32_16x16x32_bf16 v[68:71], a[36:39], v[48:51], v[68:71]
    s_waitcnt lgkmcnt(7)
    buffer_load_dwordx4 v18, s[44:47], s78 offen offset:0 sc1 lds
    ds_read_b64_tr_b16 v[230:231], v12 offset:25600
    v_mfma_f32_16x16x32_bf16 v[76:79], a[36:39], v[56:59], v[76:79]
    ds_read_b128 v[48:51], v17 offset:7168
    v_mfma_f32_16x16x32_bf16 v[76:79], a[44:47], v[60:63], v[76:79]
    buffer_load_dwordx4 v19, s[44:47], s78 offen offset:1024 sc1 lds
    v_mfma_f32_16x16x32_bf16 v[72:75], a[40:43], v[60:63], v[72:75]
    ds_read_b128 v[52:55], v17 offset:10240
    v_mfma_f32_16x16x32_bf16 v[72:75], a[32:35], v[56:59], v[72:75]
    s_waitcnt lgkmcnt(6)
    buffer_load_dwordx4 v20, s[44:47], s78 offen offset:2048 sc1 lds
    ds_read_b64_tr_b16 v[232:233], v13 offset:24576
    v_mfma_f32_16x16x32_bf16 v[80:83], a[32:35], v[32:35], v[80:83]
    ds_read_b128 v[56:59], v17 offset:8192
    v_mfma_f32_16x16x32_bf16 v[80:83], a[40:43], v[36:39], v[80:83]
    ds_read_b64_tr_b16 v[234:235], v13 offset:25600
    v_mfma_f32_16x16x32_bf16 v[84:87], a[44:47], v[36:39], v[84:87]
    ds_read_b128 v[60:63], v17 offset:11264
    v_mfma_f32_16x16x32_bf16 v[84:87], a[36:39], v[32:35], v[84:87]
    s_waitcnt vmcnt(17) lgkmcnt(1)
    s_barrier
    v_mfma_f32_16x16x32_bf16 v[68:71], a[52:55], v[40:43], v[68:71]
    s_add_u32 m0, s20, 16384
    ds_read_b128 v[32:35], v17 offset:12288
    s_lshl_b32 s14, s92, 1
    v_mfma_f32_16x16x32_bf16 v[68:71], a[60:63], v[44:47], v[68:71]
    buffer_load_dwordx4 v8, s[52:55], s14 offen offset:0 lds
    ds_read_b64_tr_b16 v[236:237], v12 offset:32768
    v_mfma_f32_16x16x32_bf16 v[64:67], a[56:59], v[44:47], v[64:67]
    ds_read_b128 v[36:39], v17 offset:15360
    v_mfma_f32_16x16x32_bf16 v[64:67], a[48:51], v[40:43], v[64:67]
    ds_read_b64_tr_b16 v[238:239], v12 offset:33792
    v_mfma_f32_16x16x32_bf16 v[72:75], a[48:51], v[48:51], v[72:75]
    ds_read_b128 v[40:43], v17 offset:13312
    v_mfma_f32_16x16x32_bf16 v[72:75], a[56:59], v[52:55], v[72:75]
    v_mfma_f32_16x16x32_bf16 v[76:79], a[60:63], v[52:55], v[76:79]
    ds_read_b128 v[44:47], v17 offset:16384
    v_mfma_f32_16x16x32_bf16 v[76:79], a[52:55], v[48:51], v[76:79]
    s_waitcnt lgkmcnt(6)
    ds_read_b64_tr_b16 v[240:241], v13 offset:32768
    v_mfma_f32_16x16x32_bf16 v[84:87], a[52:55], v[56:59], v[84:87]
    ds_read_b128 v[48:51], v17 offset:14336
    v_mfma_f32_16x16x32_bf16 v[84:87], a[60:63], v[60:63], v[84:87]
    ds_read_b64_tr_b16 v[242:243], v13 offset:33792
    v_mfma_f32_16x16x32_bf16 v[80:83], a[56:59], v[60:63], v[80:83]
    ds_read_b128 v[52:55], v17 offset:17408
    v_mfma_f32_16x16x32_bf16 v[80:83], a[48:51], v[56:59], v[80:83]
    s_waitcnt lgkmcnt(7)
    v_mfma_f32_16x16x32_bf16 v[64:67], a[64:67], v[32:35], v[64:67]
    ds_read_b128 v[56:59], v17 offset:18432
    v_mfma_f32_16x16x32_bf16 v[64:67], a[72:75], v[36:39], v[64:67]
    ds_read_b64_tr_b16 v[244:245], v12 offset:40960
    v_mfma_f32_16x16x32_bf16 v[68:71], a[76:79], v[36:39], v[68:71]
    ds_read_b128 v[60:63], v17 offset:21504
    v_mfma_f32_16x16x32_bf16 v[68:71], a[68:71], v[32:35], v[68:71]
    s_waitcnt lgkmcnt(7)
    buffer_load_dwordx4 v9, s[52:55], s14 offen offset:1024 lds
    ds_read_b64_tr_b16 v[246:247], v12 offset:41984
    v_mfma_f32_16x16x32_bf16 v[76:79], a[68:71], v[40:43], v[76:79]
    ds_read_b128 v[32:35], v17 offset:19456
    v_mfma_f32_16x16x32_bf16 v[76:79], a[76:79], v[44:47], v[76:79]
    buffer_load_dwordx4 v10, s[52:55], s14 offen offset:2048 lds
    v_mfma_f32_16x16x32_bf16 v[72:75], a[72:75], v[44:47], v[72:75]
    ds_read_b128 v[36:39], v17 offset:22528
    v_mfma_f32_16x16x32_bf16 v[72:75], a[64:67], v[40:43], v[72:75]
    s_waitcnt lgkmcnt(6)
    buffer_load_dwordx4 v11, s[52:55], s14 offen offset:3072 lds
    ds_read_b64_tr_b16 v[248:249], v13 offset:40960
    v_mfma_f32_16x16x32_bf16 v[80:83], a[64:67], v[48:51], v[80:83]
    s_add_u32 m0, s21, 24576
    ds_read_b128 v[40:43], v17 offset:20480
    v_mfma_f32_16x16x32_bf16 v[80:83], a[72:75], v[52:55], v[80:83]
    buffer_load_dwordx4 v18, s[44:47], s80 offen offset:0 sc1 lds
    ds_read_b64_tr_b16 v[250:251], v13 offset:41984
    v_mfma_f32_16x16x32_bf16 v[84:87], a[76:79], v[52:55], v[84:87]
    ds_read_b128 v[44:47], v17 offset:23552
    v_mfma_f32_16x16x32_bf16 v[84:87], a[68:71], v[48:51], v[84:87]
    s_waitcnt vmcnt(18) lgkmcnt(1)
    s_barrier
    v_mfma_f32_16x16x32_bf16 v[68:71], a[84:87], v[56:59], v[68:71]
    ds_read_b128 v[48:51], v17 offset:24576
    v_mfma_f32_16x16x32_bf16 v[68:71], a[92:95], v[60:63], v[68:71]
    buffer_load_dwordx4 v19, s[44:47], s80 offen offset:1024 sc1 lds
    ds_read_b64_tr_b16 a[0:1], v12 offset:49152
    v_mfma_f32_16x16x32_bf16 v[64:67], a[88:91], v[60:63], v[64:67]
    ds_read_b128 v[52:55], v17 offset:27648
    v_mfma_f32_16x16x32_bf16 v[64:67], a[80:83], v[56:59], v[64:67]
    buffer_load_dwordx4 v20, s[44:47], s80 offen offset:2048 sc1 lds
    ds_read_b64_tr_b16 a[2:3], v12 offset:50176
    v_mfma_f32_16x16x32_bf16 v[72:75], a[80:83], v[32:35], v[72:75]
    s_add_u32 m0, s20, 32768
    ds_read_b128 v[56:59], v17 offset:25600
    s_lshl_b32 s14, s93, 1
    v_mfma_f32_16x16x32_bf16 v[72:75], a[88:91], v[36:39], v[72:75]
    buffer_load_dwordx4 v8, s[52:55], s14 offen offset:0 lds
    v_mfma_f32_16x16x32_bf16 v[76:79], a[92:95], v[36:39], v[76:79]
    ds_read_b128 v[60:63], v17 offset:28672
    v_mfma_f32_16x16x32_bf16 v[76:79], a[84:87], v[32:35], v[76:79]
    s_waitcnt lgkmcnt(6)
    buffer_load_dwordx4 v9, s[52:55], s14 offen offset:1024 lds
    ds_read_b64_tr_b16 a[4:5], v13 offset:49152
    v_mfma_f32_16x16x32_bf16 v[84:87], a[84:87], v[40:43], v[84:87]
    ds_read_b128 v[32:35], v17 offset:26624
    v_mfma_f32_16x16x32_bf16 v[84:87], a[92:95], v[44:47], v[84:87]
    ds_read_b64_tr_b16 a[6:7], v13 offset:50176
    v_mfma_f32_16x16x32_bf16 v[80:83], a[88:91], v[44:47], v[80:83]
    ds_read_b128 v[36:39], v17 offset:29696
    v_mfma_f32_16x16x32_bf16 v[80:83], a[80:83], v[40:43], v[80:83]
    s_waitcnt lgkmcnt(7)
    buffer_load_dwordx4 v10, s[52:55], s14 offen offset:2048 lds
    v_mfma_f32_16x16x32_bf16 v[64:67], a[96:99], v[48:51], v[64:67]
    ds_read_b128 v[40:43], v17 offset:30720
    v_mfma_f32_16x16x32_bf16 v[64:67], a[104:107], v[52:55], v[64:67]
    buffer_load_dwordx4 v11, s[52:55], s14 offen offset:3072 lds
    ds_read_b64_tr_b16 a[8:9], v12 offset:57344
    v_mfma_f32_16x16x32_bf16 v[68:71], a[108:111], v[52:55], v[68:71]
    s_add_u32 m0, s21, 36864
    ds_read_b128 v[44:47], v17 offset:33792
    v_mfma_f32_16x16x32_bf16 v[68:71], a[100:103], v[48:51], v[68:71]
    s_waitcnt lgkmcnt(7)
    buffer_load_dwordx4 v18, s[44:47], s82 offen offset:0 sc1 lds
    ds_read_b64_tr_b16 a[10:11], v12 offset:58368
    v_mfma_f32_16x16x32_bf16 v[76:79], a[100:103], v[56:59], v[76:79]
    ds_read_b128 v[48:51], v17 offset:31744
    v_mfma_f32_16x16x32_bf16 v[76:79], a[108:111], v[60:63], v[76:79]
    v_mfma_f32_16x16x32_bf16 v[72:75], a[104:107], v[60:63], v[72:75]
    ds_read_b128 v[52:55], v17 offset:34816
    v_mfma_f32_16x16x32_bf16 v[72:75], a[96:99], v[56:59], v[72:75]
    s_waitcnt lgkmcnt(6)
    ds_read_b64_tr_b16 a[12:13], v13 offset:57344
    v_mfma_f32_16x16x32_bf16 v[80:83], a[96:99], v[32:35], v[80:83]
    ds_read_b128 v[56:59], v17 offset:32768
    v_mfma_f32_16x16x32_bf16 v[80:83], a[104:107], v[36:39], v[80:83]
    buffer_load_dwordx4 v19, s[44:47], s82 offen offset:1024 sc1 lds
    ds_read_b64_tr_b16 a[14:15], v13 offset:58368
    v_mfma_f32_16x16x32_bf16 v[84:87], a[108:111], v[36:39], v[84:87]
    ds_read_b128 v[60:63], v17 offset:35840
    v_mfma_f32_16x16x32_bf16 v[84:87], a[100:103], v[32:35], v[84:87]
    s_waitcnt vmcnt(16) lgkmcnt(1)
    s_barrier
    v_mfma_f32_16x16x32_bf16 v[68:71], a[116:119], v[40:43], v[68:71]
    ds_read_b128 v[32:35], v16 offset:0
    buffer_store_dword v24, v25, s[44:47], s32 offen sc1
    v_mfma_f32_16x16x32_bf16 v[68:71], a[124:127], v[44:47], v[68:71]
    buffer_load_dwordx4 v20, s[44:47], s82 offen offset:2048 sc1 lds
    ds_read_b64_tr_b16 a[16:17], v12 offset:0
    v_mfma_f32_16x16x32_bf16 v[64:67], a[120:123], v[44:47], v[64:67]
    s_mov_b32 s6, 241306688
    ds_read_b128 v[36:39], v16 offset:3072
    s_mov_b32 s7, 2898
    v_mfma_f32_16x16x32_bf16 v[64:67], a[112:115], v[40:43], v[64:67]
    s_add_u32 s32, s32, 9216
    ds_read_b64_tr_b16 a[18:19], v12 offset:1024
    buffer_load_dwordx4 v[136:139], v21, s[44:47], s9 offen offset:0 sc1
    v_mfma_f32_16x16x32_bf16 v[72:75], a[112:115], v[48:51], v[72:75]
    ds_read_b128 v[40:43], v16 offset:1024
    v_mfma_f32_16x16x32_bf16 v[72:75], a[120:123], v[52:55], v[72:75]
    s_bitcmp1_b32 s22, 0
    s_cselect_b32 s6, 2942979664, s6
    s_cselect_b32 s7, 3195, s7
    v_mfma_f32_16x16x32_bf16 v[76:79], a[124:127], v[52:55], v[76:79]
    s_mov_b32 s83, 2348962
    ds_read_b128 v[44:47], v16 offset:4096
    buffer_load_dwordx4 v[140:143], v21, s[44:47], s9 offen offset:1024 sc1
    v_mfma_f32_16x16x32_bf16 v[76:79], a[116:119], v[48:51], v[76:79]
    s_waitcnt lgkmcnt(6)
    s_cmp_eq_u32 s23, 1
    s_cselect_b32 s83, 6880132, s83
    ds_read_b64_tr_b16 a[20:21], v13 offset:0
    v_mfma_f32_16x16x32_bf16 v[84:87], a[116:119], v[56:59], v[84:87]
    ds_read_b128 v[48:51], v16 offset:2048
    buffer_load_dwordx4 v[108:111], v21, s[44:47], s9 offen offset:2048 sc1
    v_mfma_f32_16x16x32_bf16 v[84:87], a[124:127], v[60:63], v[84:87]
    s_cmp_eq_u32 s23, 2
    s_cselect_b32 s83, 11640720, s83
    ds_read_b64_tr_b16 a[22:23], v13 offset:1024
    v_mfma_f32_16x16x32_bf16 v[80:83], a[120:123], v[60:63], v[80:83]
    s_cmp_eq_u32 s23, 3
    s_cselect_b32 s83, 16429840, s83
    ds_read_b128 v[52:55], v16 offset:5120
    v_mfma_f32_16x16x32_bf16 v[80:83], a[112:115], v[56:59], v[80:83]
    s_waitcnt lgkmcnt(7)
    s_and_b32 s12, s3, 1
    s_mul_i32 s12, s12, 49152
    s_lshr_b32 s4, s22, 1
    v_mfma_f32_16x16x32_bf16 v[64:67], a[128:131], v[32:35], v[64:67]
    s_add_u32 m0, s20, 49152
    ds_read_b128 v[56:59], v16 offset:6144
    s_lshl_b32 s14, s94, 1
    v_mfma_f32_16x16x32_bf16 v[64:67], a[136:139], v[36:39], v[64:67]
    s_mul_i32 s4, s4, 6144
    buffer_load_dwordx4 v8, s[52:55], s14 offen offset:0 lds
    ds_read_b64_tr_b16 a[24:25], v12 offset:8192
    v_mfma_f32_16x16x32_bf16 v[68:71], a[140:143], v[36:39], v[68:71]
    s_add_u32 s12, s12, s4
    ds_read_b128 v[60:63], v16 offset:9216
    s_add_u32 s12, s12, 22872064
    v_mfma_f32_16x16x32_bf16 v[68:71], a[132:135], v[32:35], v[68:71]
    s_waitcnt lgkmcnt(7)
    s_lshr_b32 s4, s7, 8
    ds_read_b64_tr_b16 a[26:27], v12 offset:9216
    s_and_b32 s4, s4, 31
    v_mfma_f32_16x16x32_bf16 v[76:79], a[132:135], v[40:43], v[76:79]
    s_lshl_b32 s4, s4, 8
    ds_read_b128 v[32:35], v16 offset:7168
    s_add_u32 s68, s4, s12
    v_mfma_f32_16x16x32_bf16 v[76:79], a[140:143], v[44:47], v[76:79]
    s_bfe_u32 s4, s83, 0x30000
    buffer_load_dwordx4 v9, s[52:55], s14 offen offset:1024 lds
    s_mul_i32 s4, s4, 5
    v_mfma_f32_16x16x32_bf16 v[72:75], a[136:139], v[44:47], v[72:75]
    s_lshr_b64 s[4:5], s[6:7], s4
    ds_read_b128 v[36:39], v16 offset:10240
    v_mfma_f32_16x16x32_bf16 v[72:75], a[128:131], v[40:43], v[72:75]
    s_waitcnt lgkmcnt(6)
    s_and_b32 s4, s4, 31
    ds_read_b64_tr_b16 a[28:29], v13 offset:8192
    v_mfma_f32_16x16x32_bf16 v[80:83], a[128:131], v[48:51], v[80:83]
    s_lshl_b32 s4, s4, 8
    ds_read_b128 v[40:43], v16 offset:8192
    v_mfma_f32_16x16x32_bf16 v[80:83], a[136:139], v[52:55], v[80:83]
    s_add_u32 s69, s4, s12
    buffer_load_dwordx4 v10, s[52:55], s14 offen offset:2048 lds
    ds_read_b64_tr_b16 a[30:31], v13 offset:9216
    v_mfma_f32_16x16x32_bf16 v[84:87], a[140:143], v[52:55], v[84:87]
    s_cmp_lt_u32 s3, 2
    s_cselect_b32 s68, s68, s69
    ds_read_b128 v[44:47], v16 offset:11264
    v_mfma_f32_16x16x32_bf16 v[84:87], a[132:135], v[48:51], v[84:87]
    s_waitcnt vmcnt(17) lgkmcnt(1)
    s_barrier
    s_bfe_u32 s4, s83, 0x30003
    s_mul_i32 s4, s4, 5
    v_mfma_f32_16x16x32_bf16 v[68:71], a[148:151], v[56:59], v[68:71]
    s_lshr_b64 s[4:5], s[6:7], s4
    ds_read_b128 v[48:51], v16 offset:12288
    s_and_b32 s4, s4, 31
    v_mfma_f32_16x16x32_bf16 v[68:71], a[156:159], v[60:63], v[68:71]
    s_lshl_b32 s4, s4, 8
    buffer_load_dwordx4 v11, s[52:55], s14 offen offset:3072 lds
    ds_read_b64_tr_b16 a[32:33], v12 offset:16384
    v_mfma_f32_16x16x32_bf16 v[64:67], a[152:155], v[60:63], v[64:67]
    s_add_u32 m0, s20, 0
    ds_read_b128 v[52:55], v16 offset:15360
    s_lshl_b32 s14, s95, 1
    v_mfma_f32_16x16x32_bf16 v[64:67], a[144:147], v[56:59], v[64:67]
    s_add_u32 s70, s4, s12
    buffer_load_dwordx4 v8, s[52:55], s14 offen offset:0 lds
    ds_read_b64_tr_b16 a[34:35], v12 offset:17408
    v_mfma_f32_16x16x32_bf16 v[72:75], a[144:147], v[32:35], v[72:75]
    s_bfe_u32 s4, s83, 0x30006
    ds_read_b128 v[56:59], v16 offset:13312
    v_mfma_f32_16x16x32_bf16 v[72:75], a[152:155], v[36:39], v[72:75]
    s_mul_i32 s4, s4, 5
    s_lshr_b64 s[4:5], s[6:7], s4
    v_mfma_f32_16x16x32_bf16 v[76:79], a[156:159], v[36:39], v[76:79]
    s_and_b32 s4, s4, 31
    ds_read_b128 v[60:63], v16 offset:16384
    v_mfma_f32_16x16x32_bf16 v[76:79], a[148:151], v[32:35], v[76:79]
    s_waitcnt lgkmcnt(6)
    s_lshl_b32 s4, s4, 8
    ds_read_b64_tr_b16 a[36:37], v13 offset:16384
    v_mfma_f32_16x16x32_bf16 v[84:87], a[148:151], v[40:43], v[84:87]
    s_add_u32 s71, s4, s12
    ds_read_b128 v[32:35], v16 offset:14336
    v_mfma_f32_16x16x32_bf16 v[84:87], a[156:159], v[44:47], v[84:87]
    s_bfe_u32 s4, s83, 0x30009
    ds_read_b64_tr_b16 a[38:39], v13 offset:17408
    v_mfma_f32_16x16x32_bf16 v[80:83], a[152:155], v[44:47], v[80:83]
    s_mul_i32 s4, s4, 5
    ds_read_b128 v[36:39], v16 offset:17408
    v_mfma_f32_16x16x32_bf16 v[80:83], a[144:147], v[40:43], v[80:83]
    s_waitcnt lgkmcnt(7)
    s_lshr_b64 s[4:5], s[6:7], s4
    s_and_b32 s4, s4, 31
    v_mfma_f32_16x16x32_bf16 v[64:67], a[160:163], v[48:51], v[64:67]
    s_lshl_b32 s4, s4, 8
    ds_read_b128 v[40:43], v16 offset:18432
    v_mfma_f32_16x16x32_bf16 v[64:67], a[168:171], v[52:55], v[64:67]
    s_add_u32 s72, s4, s12
    ds_read_b64_tr_b16 a[40:41], v12 offset:24576
    v_mfma_f32_16x16x32_bf16 v[68:71], a[172:175], v[52:55], v[68:71]
    s_bfe_u32 s4, s83, 0x3000c
    ds_read_b128 v[44:47], v16 offset:21504
    v_mfma_f32_16x16x32_bf16 v[68:71], a[164:167], v[48:51], v[68:71]
    s_waitcnt lgkmcnt(7)
    s_mul_i32 s4, s4, 5
    ds_read_b64_tr_b16 a[42:43], v12 offset:25600
    v_mfma_f32_16x16x32_bf16 v[76:79], a[164:167], v[56:59], v[76:79]
    s_lshr_b64 s[4:5], s[6:7], s4
    ds_read_b128 v[48:51], v16 offset:19456
    v_mfma_f32_16x16x32_bf16 v[76:79], a[172:175], v[60:63], v[76:79]
    s_and_b32 s4, s4, 31
    s_lshl_b32 s4, s4, 8
    v_mfma_f32_16x16x32_bf16 v[72:75], a[168:171], v[60:63], v[72:75]
    s_add_u32 s73, s4, s12
    ds_read_b128 v[52:55], v16 offset:22528
    v_mfma_f32_16x16x32_bf16 v[72:75], a[160:163], v[56:59], v[72:75]
    s_waitcnt lgkmcnt(6)
    s_bfe_u32 s4, s83, 0x3000f
    ds_read_b64_tr_b16 a[44:45], v13 offset:24576
    v_mfma_f32_16x16x32_bf16 v[80:83], a[160:163], v[32:35], v[80:83]
    s_mul_i32 s4, s4, 5
    ds_read_b128 v[56:59], v16 offset:20480
    v_mfma_f32_16x16x32_bf16 v[80:83], a[168:171], v[36:39], v[80:83]
    s_lshr_b64 s[4:5], s[6:7], s4
    ds_read_b64_tr_b16 a[46:47], v13 offset:25600
    v_mfma_f32_16x16x32_bf16 v[84:87], a[172:175], v[36:39], v[84:87]
    s_and_b32 s4, s4, 31
    ds_read_b128 v[60:63], v16 offset:23552
    s_lshl_b32 s4, s4, 8
    v_mfma_f32_16x16x32_bf16 v[84:87], a[164:167], v[32:35], v[84:87]
    s_waitcnt vmcnt(12) lgkmcnt(1)
    s_barrier
    s_add_u32 s74, s4, s12
    s_bfe_u32 s4, s83, 0x30012
    s_mul_i32 s4, s4, 5
    v_mfma_f32_16x16x32_bf16 v[68:71], a[180:183], v[40:43], v[68:71]
    s_lshr_b64 s[4:5], s[6:7], s4
    ds_read_b128 v[32:35], v16 offset:24576
    s_and_b32 s4, s4, 31
    v_mfma_f32_16x16x32_bf16 v[68:71], a[188:191], v[44:47], v[68:71]
    s_lshl_b32 s4, s4, 8
    ds_read_b64_tr_b16 a[48:49], v12 offset:32768
    ds_read_b128 a[128:131], v30 offset:64
    v_mfma_f32_16x16x32_bf16 v[64:67], a[184:187], v[44:47], v[64:67]
    s_add_u32 s75, s4, s12
    ds_read_b128 v[36:39], v16 offset:27648
    s_bfe_u32 s4, s83, 0x30015
    v_mfma_f32_16x16x32_bf16 v[64:67], a[176:179], v[40:43], v[64:67]
    s_mul_i32 s4, s4, 5
    ds_read_b64_tr_b16 a[50:51], v12 offset:33792
    ds_read_b128 a[132:135], v30 offset:576
    v_mfma_f32_16x16x32_bf16 v[72:75], a[176:179], v[48:51], v[72:75]
    s_lshr_b64 s[4:5], s[6:7], s4
    ds_read_b128 v[40:43], v16 offset:25600
    s_and_b32 s4, s4, 31
    v_mfma_f32_16x16x32_bf16 v[72:75], a[184:187], v[52:55], v[72:75]
    s_waitcnt vmcnt(5)
    buffer_load_dwordx4 v9, s[52:55], s14 offen offset:1024 lds
    v_xor_b32 v136, v253, v136
    ds_read_b128 a[136:139], v30 offset:1088
    v_mfma_f32_16x16x32_bf16 v[76:79], a[188:191], v[52:55], v[76:79]
    s_lshl_b32 s4, s4, 8
    ds_read_b128 v[44:47], v16 offset:28672
    v_xor_b32 v137, v255, v137
    v_mfma_f32_16x16x32_bf16 v[76:79], a[180:183], v[48:51], v[76:79]
    s_waitcnt lgkmcnt(9)
    s_add_u32 s76, s4, s12
    buffer_load_dwordx4 v10, s[52:55], s14 offen offset:2048 lds
    ds_read_b64_tr_b16 a[52:53], v13 offset:32768
    v_mfma_f32_16x16x32_bf16 v[84:87], a[180:183], v[56:59], v[84:87]
    s_mov_b32 s6, 994437672
    ds_read_b128 v[48:51], v16 offset:26624
    v_xor_b32 v138, v23, v138
    v_mfma_f32_16x16x32_bf16 v[84:87], a[188:191], v[60:63], v[84:87]
    s_cmp_eq_u32 s23, 1
    s_cselect_b32 s6, 391038234, s6
    buffer_load_dwordx4 v11, s[52:55], s14 offen offset:3072 lds
    ds_read_b64_tr_b16 a[54:55], v13 offset:33792
    v_xor_b32 v139, v0, v139
    ds_read_b128 a[140:143], v30 offset:1600
    v_mfma_f32_16x16x32_bf16 v[80:83], a[184:187], v[60:63], v[80:83]
    s_add_u32 m0, s20, 16384
    ds_read_b128 v[52:55], v16 offset:29696
    s_lshl_b32 s14, s96, 1
    v_or3_b32 v1, v136, v137, v138
    v_mfma_f32_16x16x32_bf16 v[80:83], a[176:179], v[56:59], v[80:83]
    s_waitcnt lgkmcnt(10)
    s_cmp_eq_u32 s23, 2
    s_cselect_b32 s6, 994419537, s6
    buffer_load_dwordx4 v8, s[52:55], s14 offen offset:0 lds
    v_xor_b32 v140, v253, v140
    ds_read_b128 a[144:147], v30 offset:2112
    v_mfma_f32_16x16x32_bf16 v[64:67], a[192:195], v[32:35], v[64:67]
    s_cmp_eq_u32 s23, 3
    s_cselect_b32 s6, 391029306, s6
    ds_read_b128 v[56:59], v16 offset:30720
    v_xor_b32 v141, v255, v141
    v_mfma_f32_16x16x32_bf16 v[64:67], a[200:203], v[36:39], v[64:67]
    s_bfe_u32 s4, s6, 0x20003
    buffer_load_dwordx4 v9, s[52:55], s14 offen offset:1024 lds
    ds_read_b64_tr_b16 a[56:57], v12 offset:40960
    v_or3_b32 v1, v139, v140, v1
    ds_read_b128 a[148:151], v30 offset:2624
    v_mfma_f32_16x16x32_bf16 v[68:71], a[204:207], v[36:39], v[68:71]
    s_lshl_b32 s4, s4, 1
    ds_read_b128 v[60:63], v16 offset:33792
    v_xor_b32 v142, v23, v142
    v_mfma_f32_16x16x32_bf16 v[68:71], a[196:199], v[32:35], v[68:71]
    s_waitcnt lgkmcnt(10)
    s_xor_b32 s4, s4, s2
    buffer_load_dwordx4 v10, s[52:55], s14 offen offset:2048 lds
    ds_read_b64_tr_b16 a[58:59], v12 offset:41984
    v_xor_b32 v143, v0, v143
    ds_read_b128 a[152:155], v30 offset:3136
    v_mfma_f32_16x16x32_bf16 v[76:79], a[196:199], v[40:43], v[76:79]
    s_lshl2_add_u32 s4, s4, s3
    ds_read_b128 v[32:35], v16 offset:31744
    v_or3_b32 v1, v141, v142, v1
    v_mfma_f32_16x16x32_bf16 v[76:79], a[204:207], v[44:47], v[76:79]
    s_bfe_u32 s5, s6, 0x30000
    buffer_load_dwordx4 v11, s[52:55], s14 offen offset:3072 lds
    v_xor_b32 v108, v253, v108
    v_mfma_f32_16x16x32_bf16 v[72:75], a[200:203], v[44:47], v[72:75]
    s_lshl3_add_u32 s4, s4, s5
    ds_read_b128 v[36:39], v16 offset:34816
    v_xor_b32 v109, v255, v109
    v_or3_b32 v1, v143, v108, v1
    v_mfma_f32_16x16x32_bf16 v[72:75], a[192:195], v[40:43], v[72:75]
    s_waitcnt lgkmcnt(9)
    s_lshl_b32 s4, s4, 10
    ds_read_b64_tr_b16 a[60:61], v13 offset:40960
    v_xor_b32 v110, v23, v110
    ds_read_b128 a[156:159], v30 offset:3648
    v_mfma_f32_16x16x32_bf16 v[80:83], a[192:195], v[48:51], v[80:83]
    s_add_u32 s77, s4, 14483456
    ds_read_b128 v[40:43], v16 offset:32768
    v_xor_b32 v111, v0, v111
    v_mfma_f32_16x16x32_bf16 v[80:83], a[200:203], v[52:55], v[80:83]
    s_bfe_u32 s4, s6, 0x20008
    ds_read_b64_tr_b16 a[62:63], v13 offset:41984
    v_or3_b32 v1, v109, v110, v1
    v_or_b32 v1, v111, v1
    v_mfma_f32_16x16x32_bf16 v[84:87], a[204:207], v[52:55], v[84:87]
    s_lshl_b32 s4, s4, 1
    ds_read_b128 v[44:47], v16 offset:35840
    v_and_b32 v1, s33, v1
    v_cmp_ne_u32 vcc, 0, v1
    s_cbranch_vccnz L_rs_bl1
L_ok_bl1:
    v_mfma_f32_16x16x32_bf16 v[84:87], a[196:199], v[48:51], v[84:87]
    s_waitcnt vmcnt(8) lgkmcnt(1)
    s_barrier
    s_xor_b32 s4, s4, s2
    v_mfma_f32_16x16x32_bf16 v[64:67], v[148:151], v[136:139], v[64:67]
    ds_read2_b32 a[160:161], v4 offset0:0 offset1:1
    v_mfma_f32_16x16x32_bf16 v[68:71], a[212:215], v[56:59], v[68:71]
    s_add_u32 m0, s20, 32768
    ds_read_b128 v[48:51], v17 offset:0
    s_lshl_b32 s14, s97, 1
    v_mfma_f32_16x16x32_bf16 v[68:71], a[220:223], v[60:63], v[68:71]
    s_lshl2_add_u32 s4, s4, s3
    buffer_load_dwordx4 v8, s[52:55], s14 offen offset:0 lds
    ds_read_b64_tr_b16 a[64:65], v12 offset:49152
    v_mfma_f32_16x16x32_bf16 v[64:67], a[216:219], v[60:63], v[64:67]
    s_bfe_u32 s5, s6, 0x30005
    ds_read_b128 v[52:55], v17 offset:3072
    v_mfma_f32_16x16x32_bf16 v[68:71], v[146:149], v[136:139], v[68:71]
    v_mfma_f32_16x16x32_bf16 v[64:67], a[208:211], v[56:59], v[64:67]
L_pl_G_5:
    s_cbranch_execz L_wret
    s_lshl3_add_u32 s4, s4, s5
    buffer_load_dwordx4 v9, s[52:55], s14 offen offset:1024 lds
    ds_read_b64_tr_b16 a[66:67], v12 offset:50176
    v_mfma_f32_16x16x32_bf16 v[72:75], v[148:151], v[140:143], v[72:75]
    v_mfma_f32_16x16x32_bf16 v[72:75], a[208:211], v[32:35], v[72:75]
    s_lshl_b32 s4, s4, 10
    ds_read_b128 v[56:59], v17 offset:1024
    v_mfma_f32_16x16x32_bf16 v[76:79], v[146:149], v[140:143], v[76:79]
    v_mfma_f32_16x16x32_bf16 v[72:75], a[216:219], v[36:39], v[72:75]
    s_add_u32 s78, s4, 14483456
    v_mfma_f32_16x16x32_bf16 v[80:83], v[148:151], v[108:111], v[80:83]
    ds_read2_b32 a[162:163], v4 offset0:2 offset1:3
    v_mfma_f32_16x16x32_bf16 v[76:79], a[220:223], v[36:39], v[76:79]
    s_bfe_u32 s4, s6, 0x2000d
    ds_read_b128 v[60:63], v17 offset:4096
    v_mfma_f32_16x16x32_bf16 v[84:87], v[146:149], v[108:111], v[84:87]
    v_mfma_f32_16x16x32_bf16 v[76:79], a[212:215], v[32:35], v[76:79]
    s_waitcnt lgkmcnt(8)
    s_lshl_b32 s4, s4, 1
    ds_read_b64_tr_b16 a[68:69], v13 offset:49152
    ds_read2_b32 a[164:165], v4 offset0:128 offset1:129
    v_mfma_f32_16x16x32_bf16 v[84:87], a[212:215], v[40:43], v[84:87]
    s_xor_b32 s4, s4, s2
    ds_read_b128 v[32:35], v17 offset:2048
    ds_read2_b32 a[166:167], v4 offset0:130 offset1:131
    v_mfma_f32_16x16x32_bf16 v[84:87], a[220:223], v[44:47], v[84:87]
    s_lshl2_add_u32 s4, s4, s3
    buffer_load_dwordx4 v10, s[52:55], s14 offen offset:2048 lds
    ds_read_b64_tr_b16 a[70:71], v13 offset:50176
    v_mfma_f32_16x16x32_bf16 v[80:83], a[216:219], v[44:47], v[80:83]
    s_bfe_u32 s5, s6, 0x3000a
    ds_read_b128 v[36:39], v17 offset:5120
    ds_read2_b32 a[168:169], v5 offset0:0 offset1:1
    v_mfma_f32_16x16x32_bf16 v[80:83], a[208:211], v[40:43], v[80:83]
    s_waitcnt lgkmcnt(11)
    s_lshl3_add_u32 s4, s4, s5
    ds_read2_b32 a[170:171], v5 offset0:2 offset1:3
    ds_read2_b32 a[172:173], v5 offset0:128 offset1:129
    v_mfma_f32_16x16x32_bf16 v[64:67], a[224:227], v[48:51], v[64:67]
    s_lshl_b32 s4, s4, 10
    ds_read_b128 v[40:43], v17 offset:6144
    s_add_u32 s79, s4, 14483456
    v_mfma_f32_16x16x32_bf16 v[64:67], a[232:235], v[52:55], v[64:67]
    s_bfe_u32 s4, s6, 0x20012
    buffer_load_dwordx4 v11, s[52:55], s14 offen offset:3072 lds
    ds_read_b64_tr_b16 a[72:73], v12 offset:57344
    v_mfma_f32_16x16x32_bf16 v[68:71], a[236:239], v[52:55], v[68:71]
    s_lshl_b32 s4, s4, 1
    ds_read_b128 v[44:47], v17 offset:9216
    ds_read2_b32 a[174:175], v5 offset0:130 offset1:131
    v_mfma_f32_16x16x32_bf16 v[68:71], a[228:231], v[48:51], v[68:71]
    s_waitcnt lgkmcnt(13)
    s_xor_b32 s4, s4, s2
    ds_read_b64_tr_b16 a[74:75], v12 offset:58368
    s_lshl2_add_u32 s4, s4, s3
    v_mfma_f32_16x16x32_bf16 v[76:79], a[228:231], v[56:59], v[76:79]
    s_bfe_u32 s5, s6, 0x3000f
    ds_read_b128 v[48:51], v17 offset:7168
    ds_read2_b32 a[176:177], v6 offset0:0 offset1:1
    v_mfma_f32_16x16x32_bf16 v[76:79], a[236:239], v[60:63], v[76:79]
    s_lshl3_add_u32 s4, s4, s5
    ds_read2_b32 a[178:179], v6 offset0:2 offset1:3
    s_lshl_b32 s4, s4, 10
    v_mfma_f32_16x16x32_bf16 v[72:75], a[232:235], v[60:63], v[72:75]
    s_add_u32 s80, s4, 14483456
    ds_read_b128 v[52:55], v17 offset:10240
    s_bfe_u32 s4, s6, 0x20017
    v_mfma_f32_16x16x32_bf16 v[72:75], a[224:227], v[56:59], v[72:75]
    s_waitcnt lgkmcnt(12)
    s_lshl_b32 s4, s4, 1
    ds_read_b64_tr_b16 a[76:77], v13 offset:57344
    s_xor_b32 s4, s4, s2
    v_mfma_f32_16x16x32_bf16 v[80:83], a[224:227], v[32:35], v[80:83]
    s_lshl2_add_u32 s4, s4, s3
    ds_read_b128 v[56:59], v17 offset:8192
    ds_read2_b32 a[180:181], v6 offset0:128 offset1:129
    v_mfma_f32_16x16x32_bf16 v[80:83], a[232:235], v[36:39], v[80:83]
    s_bfe_u32 s5, s6, 0x30014
    ds_read_b64_tr_b16 a[78:79], v13 offset:58368
    v_mfma_f32_16x16x32_bf16 v[84:87], a[236:239], v[36:39], v[84:87]
    s_lshl3_add_u32 s4, s4, s5
    ds_read_b128 v[60:63], v17 offset:11264
    v_mfma_f32_16x16x32_bf16 v[84:87], a[228:231], v[32:35], v[84:87]
    s_waitcnt vmcnt(8) lgkmcnt(1)
    s_barrier
    s_lshl_b32 s4, s4, 10
    ds_read2_b32 a[182:183], v6 offset0:130 offset1:131
    s_add_u32 s81, s4, 14483456
    v_mfma_f32_16x16x32_bf16 v[68:71], a[244:247], v[40:43], v[68:71]
    s_add_u32 m0, s20, 49152
    s_lshl_b32 s14, s98, 1
    ds_read_b64_tr_b16 a[80:81], v12 offset:0
    v_mfma_f32_16x16x32_bf16 v[68:71], a[252:255], v[44:47], v[68:71]
    s_bfe_u32 s4, s6, 0x2001c
    buffer_load_dwordx4 v8, s[52:55], s14 offen offset:0 lds
    ds_read2_b32 a[184:185], v7 offset0:0 offset1:1
    v_mfma_f32_16x16x32_bf16 v[64:67], a[248:251], v[44:47], v[64:67]
    s_lshl_b32 s4, s4, 1
    ds_read_b64_tr_b16 a[82:83], v12 offset:1024
    s_xor_b32 s4, s4, s2
    v_mfma_f32_16x16x32_bf16 v[64:67], a[240:243], v[40:43], v[64:67]
    s_lshl2_add_u32 s4, s4, s3
    buffer_load_dwordx4 v9, s[52:55], s14 offen offset:1024 lds
    ds_read_b64_tr_b16 a[84:85], v13 offset:0
    v_mfma_f32_16x16x32_bf16 v[72:75], a[240:243], v[48:51], v[72:75]
    s_bfe_u32 s5, s6, 0x30019
    ds_read_b64_tr_b16 a[86:87], v13 offset:1024
    ds_read2_b32 a[186:187], v7 offset0:2 offset1:3
    v_mfma_f32_16x16x32_bf16 v[72:75], a[248:251], v[52:55], v[72:75]
    s_lshl3_add_u32 s4, s4, s5
    buffer_load_dwordx4 v10, s[52:55], s14 offen offset:2048 lds
    ds_read2_b32 a[188:189], v7 offset0:128 offset1:129
    v_mfma_f32_16x16x32_bf16 v[76:79], a[252:255], v[52:55], v[76:79]
    s_lshl_b32 s4, s4, 10
    ds_read_b64_tr_b16 a[88:89], v12 offset:8192
    s_add_u32 s82, s4, 14483456
    v_mfma_f32_16x16x32_bf16 v[76:79], a[244:247], v[48:51], v[76:79]
    s_waitcnt lgkmcnt(9)
    s_lshl2_add_u32 s4, s2, s3
    buffer_load_dwordx4 v11, s[52:55], s14 offen offset:3072 lds
    ds_read_b64_tr_b16 a[90:91], v12 offset:9216
    v_mfma_f32_16x16x32_bf16 v[84:87], a[244:247], v[56:59], v[84:87]
    s_lshl_b32 s4, s4, 13
    ds_read_b64_tr_b16 a[92:93], v13 offset:8192
    v_mfma_f32_16x16x32_bf16 v[84:87], a[252:255], v[60:63], v[84:87]
    s_add_u32 s83, s4, 14483456
    ds_read2_b32 a[190:191], v7 offset0:130 offset1:131
    v_mfma_f32_16x16x32_bf16 v[80:83], a[248:251], v[60:63], v[80:83]
    ds_read_b64_tr_b16 a[94:95], v13 offset:9216
    v_mfma_f32_16x16x32_bf16 v[80:83], a[240:243], v[56:59], v[80:83]
    v_mov_b32 v56, 0xc0135761
    v_pk_mul_f32 v[32:33], v[64:65], v[64:65]
    v_pk_mul_f32 v[34:35], v[66:67], v[66:67]
    v_pk_mul_f32 v[36:37], v[68:69], v[68:69]
    v_pk_mul_f32 v[38:39], v[70:71], v[70:71]
    v_pk_mul_f32 v[40:41], v[72:73], v[72:73]
    v_pk_mul_f32 v[42:43], v[74:75], v[74:75]
    v_pk_mul_f32 v[44:45], v[76:77], v[76:77]
    v_pk_mul_f32 v[46:47], v[78:79], v[78:79]
    v_pk_mul_f32 v[48:49], v[80:81], v[80:81]
    v_pk_mul_f32 v[50:51], v[82:83], v[82:83]
    v_pk_mul_f32 v[52:53], v[84:85], v[84:85]
    v_pk_mul_f32 v[54:55], v[86:87], v[86:87]
    v_pk_fma_f32 v[32:33], v[32:33], s[10:11], v[56:57] op_sel_hi:[1,0,0]
    v_pk_fma_f32 v[34:35], v[34:35], s[10:11], v[56:57] op_sel_hi:[1,0,0]
    v_pk_fma_f32 v[36:37], v[36:37], s[10:11], v[56:57] op_sel_hi:[1,0,0]
    v_pk_fma_f32 v[38:39], v[38:39], s[10:11], v[56:57] op_sel_hi:[1,0,0]
    v_pk_fma_f32 v[40:41], v[40:41], s[10:11], v[56:57] op_sel_hi:[1,0,0]
    v_pk_fma_f32 v[42:43], v[42:43], s[10:11], v[56:57] op_sel_hi:[1,0,0]
    v_pk_fma_f32 v[44:45], v[44:45], s[10:11], v[56:57] op_sel_hi:[1,0,0]
    v_pk_fma_f32 v[46:47], v[46:47], s[10:11], v[56:57] op_sel_hi:[1,0,0]
    v_pk_fma_f32 v[48:49], v[48:49], s[10:11], v[56:57] op_sel_hi:[1,0,0]
    v_pk_fma_f32 v[50:51], v[50:51], s[10:11], v[56:57] op_sel_hi:[1,0,0]
    v_pk_fma_f32 v[52:53], v[52:53], s[10:11], v[56:57] op_sel_hi:[1,0,0]
    v_pk_fma_f32 v[54:55], v[54:55], s[10:11], v[56:57] op_sel_hi:[1,0,0]
    v_pk_mul_f32 v[32:33], v[32:33], v[64:65]
    v_pk_mul_f32 v[34:35], v[34:35], v[66:67]
    v_pk_mul_f32 v[36:37], v[36:37], v[68:69]
    v_pk_mul_f32 v[38:39], v[38:39], v[70:71]
    v_pk_mul_f32 v[40:41], v[40:41], v[72:73]
    v_pk_mul_f32 v[42:43], v[42:43], v[74:75]
    v_pk_mul_f32 v[44:45], v[44:45], v[76:77]
    v_pk_mul_f32 v[46:47], v[46:47], v[78:79]
    v_pk_mul_f32 v[48:49], v[48:49], v[80:81]
    v_pk_mul_f32 v[50:51], v[50:51], v[82:83]
    v_pk_mul_f32 v[52:53], v[52:53], v[84:85]
    v_pk_mul_f32 v[54:55], v[54:55], v[86:87]
    v_exp_f32 v32, v32
    v_exp_f32 v33, v33
    v_exp_f32 v34, v34
    v_exp_f32 v35, v35
    v_exp_f32 v36, v36
    v_exp_f32 v37, v37
    v_exp_f32 v38, v38
    v_exp_f32 v39, v39
    v_exp_f32 v40, v40
    v_exp_f32 v41, v41
    v_exp_f32 v42, v42
    v_exp_f32 v43, v43
    v_exp_f32 v44, v44
    v_exp_f32 v45, v45
    v_exp_f32 v46, v46
    v_exp_f32 v47, v47
    v_exp_f32 v48, v48
    v_exp_f32 v49, v49
    v_exp_f32 v50, v50
    v_exp_f32 v51, v51
    v_exp_f32 v52, v52
    v_exp_f32 v53, v53
    v_exp_f32 v54, v54
    v_exp_f32 v55, v55
    v_pk_add_f32 v[32:33], v[32:33], 1.0 op_sel_hi:[1,0]
    v_pk_add_f32 v[34:35], v[34:35], 1.0 op_sel_hi:[1,0]
    v_pk_add_f32 v[36:37], v[36:37], 1.0 op_sel_hi:[1,0]
    v_pk_add_f32 v[38:39], v[38:39], 1.0 op_sel_hi:[1,0]
    v_pk_add_f32 v[40:41], v[40:41], 1.0 op_sel_hi:[1,0]
    v_pk_add_f32 v[42:43], v[42:43], 1.0 op_sel_hi:[1,0]
    v_pk_add_f32 v[44:45], v[44:45], 1.0 op_sel_hi:[1,0]
    v_pk_add_f32 v[46:47], v[46:47], 1.0 op_sel_hi:[1,0]
    v_pk_add_f32 v[48:49], v[48:49], 1.0 op_sel_hi:[1,0]
    v_pk_add_f32 v[50:51], v[50:51], 1.0 op_sel_hi:[1,0]
    v_pk_add_f32 v[52:53], v[52:53], 1.0 op_sel_hi:[1,0]
    v_pk_add_f32 v[54:55], v[54:55], 1.0 op_sel_hi:[1,0]
    v_rcp_f32 v32, v32
    v_rcp_f32 v33, v33
    v_rcp_f32 v34, v34
    v_rcp_f32 v35, v35
    v_rcp_f32 v36, v36
    v_rcp_f32 v37, v37
    v_rcp_f32 v38, v38
    v_rcp_f32 v39, v39
    v_pk_mul_f32 v[32:33], v[64:65], v[32:33]
    v_pk_mul_f32 v[34:35], v[66:67], v[34:35]
    v_pk_mul_f32 v[36:37], v[68:69], v[36:37]
    v_pk_mul_f32 v[38:39], v[70:71], v[38:39]
    v_cvt_pk_bf16_f32 v64, v32, v33
    v_cvt_pk_bf16_f32 v65, v34, v35
    v_cvt_pk_bf16_f32 v66, v36, v37
    v_cvt_pk_bf16_f32 v67, v38, v39
    s_bfe_u32 s11, s31, 0x30009
    s_lshl_b32 s11, s11, 8
    s_add_u32 s11, s11, s30
    buffer_store_dwordx4 v[64:67], v22, s[44:47], s11 offen sc1
    v_rcp_f32 v40, v40
    v_rcp_f32 v41, v41
    v_rcp_f32 v42, v42
    v_rcp_f32 v43, v43
    v_rcp_f32 v44, v44
    v_rcp_f32 v45, v45
    v_rcp_f32 v46, v46
    v_rcp_f32 v47, v47
    v_pk_mul_f32 v[40:41], v[72:73], v[40:41]
    v_pk_mul_f32 v[42:43], v[74:75], v[42:43]
    v_pk_mul_f32 v[44:45], v[76:77], v[44:45]
    v_pk_mul_f32 v[46:47], v[78:79], v[46:47]
    v_cvt_pk_bf16_f32 v72, v40, v41
    v_cvt_pk_bf16_f32 v73, v42, v43
    v_cvt_pk_bf16_f32 v74, v44, v45
    v_cvt_pk_bf16_f32 v75, v46, v47
    s_bfe_u32 s11, s31, 0x3000c
    s_lshl_b32 s11, s11, 8
    s_add_u32 s11, s11, s30
    buffer_store_dwordx4 v[72:75], v22, s[44:47], s11 offen sc1
    v_rcp_f32 v48, v48
    v_rcp_f32 v49, v49
    v_rcp_f32 v50, v50
    v_rcp_f32 v51, v51
    v_rcp_f32 v52, v52
    v_rcp_f32 v53, v53
    v_rcp_f32 v54, v54
    v_rcp_f32 v55, v55
    v_pk_mul_f32 v[48:49], v[80:81], v[48:49]
    v_pk_mul_f32 v[50:51], v[82:83], v[50:51]
    v_pk_mul_f32 v[52:53], v[84:85], v[52:53]
    v_pk_mul_f32 v[54:55], v[86:87], v[54:55]
    v_cvt_pk_bf16_f32 v80, v48, v49
    v_cvt_pk_bf16_f32 v81, v50, v51
    v_cvt_pk_bf16_f32 v82, v52, v53
    v_cvt_pk_bf16_f32 v83, v54, v55
    s_bfe_u32 s11, s31, 0x3000f
    s_lshl_b32 s11, s11, 8
    s_add_u32 s11, s11, s30
    buffer_store_dwordx4 v[80:83], v22, s[44:47], s11 offen sc1
L_D:
L_pl_S_0:
    s_cbranch_execz L_wret
    v_mfma_f32_16x16x32_bf16 v[112:115], a[160:163], a[128:131], 0
    v_mfma_f32_16x16x32_bf16 v[116:119], a[160:163], a[132:135], 0
    v_mfma_f32_16x16x32_bf16 v[120:123], a[160:163], a[136:139], 0
    buffer_load_dword v27, v26, s[44:47], 0 offen offset:0 sc1
    v_mfma_f32_16x16x32_bf16 v[124:127], a[160:163], a[140:143], 0
    v_mfma_f32_16x16x32_bf16 v[128:131], a[160:163], a[144:147], 0
    v_mfma_f32_16x16x32_bf16 v[132:135], a[160:163], a[148:151], 0
    v_mfma_f32_16x16x32_bf16 v[136:139], a[160:163], a[152:155], 0
    v_mfma_f32_16x16x32_bf16 v[140:143], a[160:163], a[156:159], 0
    v_mfma_f32_16x16x32_bf16 v[116:119], a[164:167], a[128:131], v[116:119]
    v_mfma_f32_16x16x32_bf16 v[120:123], a[164:167], a[132:135], v[120:123]
    ds_read2_b32 a[160:161], v7 offset0:144 offset1:145
    v_mfma_f32_16x16x32_bf16 v[124:127], a[164:167], a[136:139], v[124:127]
    v_mfma_f32_16x16x32_bf16 v[128:131], a[164:167], a[140:143], v[128:131]
    s_waitcnt vmcnt(9) lgkmcnt(1)
    s_barrier
    ds_read2_b32 a[162:163], v7 offset0:146 offset1:147
    v_mfma_f32_16x16x32_bf16 v[132:135], a[164:167], a[144:147], v[132:135]
    s_add_u32 m0, s20, 0
    s_lshl_b32 s14, s99, 1
    ds_read_b64_tr_b16 a[96:97], v12 offset:16384
    v_mfma_f32_16x16x32_bf16 v[136:139], a[164:167], a[148:151], v[136:139]
    ds_read_b128 a[156:159], v30 offset:0
    buffer_load_dwordx4 v8, s[52:55], s14 offen offset:0 lds
    v_mfma_f32_16x16x32_bf16 v[140:143], a[164:167], a[152:155], v[140:143]
    v_mfma_f32_16x16x32_bf16 v[120:123], a[168:171], a[128:131], v[120:123]
    buffer_load_dwordx4 v9, s[52:55], s14 offen offset:1024 lds
    ds_read_b64_tr_b16 a[98:99], v12 offset:17408
    v_mfma_f32_16x16x32_bf16 v[124:127], a[168:171], a[132:135], v[124:127]
    ds_read2_b32 a[164:165], v7 offset0:16 offset1:17
    v_mfma_f32_16x16x32_bf16 v[128:131], a[168:171], a[136:139], v[128:131]
    buffer_load_dwordx4 v10, s[52:55], s14 offen offset:2048 lds
    v_mfma_f32_16x16x32_bf16 v[132:135], a[168:171], a[140:143], v[132:135]
    ds_read2_b32 a[166:167], v7 offset0:18 offset1:19
    v_mfma_f32_16x16x32_bf16 v[136:139], a[168:171], a[144:147], v[136:139]
    buffer_load_dwordx4 v11, s[52:55], s14 offen offset:3072 lds
    ds_read_b64_tr_b16 a[100:101], v13 offset:16384
    v_mfma_f32_16x16x32_bf16 v[140:143], a[168:171], a[148:151], v[140:143]
    ds_read_b128 a[152:155], v30 offset:512
    v_mfma_f32_16x16x32_bf16 v[124:127], a[172:175], a[128:131], v[124:127]
    ds_read_b64_tr_b16 a[102:103], v13 offset:17408
    v_mfma_f32_16x16x32_bf16 v[128:131], a[172:175], a[132:135], v[128:131]
    ds_read2_b32 a[168:169], v6 offset0:144 offset1:145
    v_mfma_f32_16x16x32_bf16 v[132:135], a[172:175], a[136:139], v[132:135]
    ds_read_b64_tr_b16 a[104:105], v12 offset:24576
    v_mfma_f32_16x16x32_bf16 v[136:139], a[172:175], a[140:143], v[136:139]
    ds_read2_b32 a[170:171], v6 offset0:146 offset1:147
    v_mfma_f32_16x16x32_bf16 v[140:143], a[172:175], a[144:147], v[140:143]
    ds_read_b64_tr_b16 a[106:107], v12 offset:25600
    v_mfma_f32_16x16x32_bf16 v[128:131], a[176:179], a[128:131], v[128:131]
    ds_read_b128 a[148:151], v30 offset:1024
    v_mfma_f32_16x16x32_bf16 v[132:135], a[176:179], a[132:135], v[132:135]
    ds_read2_b32 a[172:173], v6 offset0:16 offset1:17
    v_mfma_f32_16x16x32_bf16 v[136:139], a[176:179], a[136:139], v[136:139]
    ds_read_b64_tr_b16 a[108:109], v13 offset:24576
    v_mfma_f32_16x16x32_bf16 v[140:143], a[176:179], a[140:143], v[140:143]
    ds_read2_b32 a[174:175], v6 offset0:18 offset1:19
    v_mfma_f32_16x16x32_bf16 v[132:135], a[180:183], a[128:131], v[132:135]
    ds_read2_b32 a[176:177], v5 offset0:144 offset1:145
    v_mfma_f32_16x16x32_bf16 v[136:139], a[180:183], a[132:135], v[136:139]
    ds_read_b128 a[144:147], v30 offset:1536
    v_mfma_f32_16x16x32_bf16 v[140:143], a[180:183], a[136:139], v[140:143]
    ds_read_b64_tr_b16 a[110:111], v13 offset:25600
    v_mfma_f32_16x16x32_bf16 v[136:139], a[184:187], a[128:131], v[136:139]
    ds_read2_b32 a[178:179], v5 offset0:146 offset1:147
    v_mfma_f32_16x16x32_bf16 v[140:143], a[184:187], a[132:135], v[140:143]
    ds_read2_b32 a[180:181], v5 offset0:16 offset1:17
    v_mfma_f32_16x16x32_bf16 v[140:143], a[188:191], a[128:131], v[140:143]
    s_waitcnt vmcnt(9) lgkmcnt(2)
    s_barrier
    ds_read_b128 a[140:143], v30 offset:2048
    v_mfma_f32_16x16x32_bf16 v[140:143], a[160:163], a[156:159], v[140:143]
    ds_read2_b32 a[182:183], v5 offset0:18 offset1:19
    s_add_u32 m0, s20, 16384
    s_lshl_b32 s14, s100, 1
    v_mfma_f32_16x16x32_bf16 v[136:139], a[164:167], a[156:159], v[136:139]
    ds_read2_b32 a[184:185], v4 offset0:144 offset1:145
    buffer_load_dwordx4 v8, s[52:55], s14 offen offset:0 lds
    v_mfma_f32_16x16x32_bf16 v[140:143], a[164:167], a[152:155], v[140:143]
    ds_read_b128 a[136:139], v30 offset:2560
    s_waitcnt vmcnt(5)
    v_mfma_f32_16x16x32_bf16 v[132:135], a[168:171], a[156:159], v[132:135]
    ds_read2_b32 a[186:187], v4 offset0:146 offset1:147
    buffer_load_dwordx4 v9, s[52:55], s14 offen offset:1024 lds
    v_mfma_f32_16x16x32_bf16 v[136:139], a[168:171], a[152:155], v[136:139]
    ds_read2_b32 a[188:189], v4 offset0:16 offset1:17
    v_cmp_ne_u32 vcc, s16, v27
    s_cbranch_vccnz L_rs_p1
L_ok_p1:
    v_mfma_f32_16x16x32_bf16 v[140:143], a[168:171], a[148:151], v[140:143]
    ds_read2_b32 a[190:191], v4 offset0:18 offset1:19
    buffer_load_dwordx4 v10, s[52:55], s14 offen offset:2048 lds
    v_mfma_f32_16x16x32_bf16 v[128:131], a[172:175], a[156:159], v[128:131]
    ds_read_b128 a[132:135], v30 offset:3072
    v_add_u32 v26, 9216, v26
    v_mfma_f32_16x16x32_bf16 v[132:135], a[172:175], a[152:155], v[132:135]
    ds_read_b128 a[128:131], v30 offset:3584
    buffer_load_dwordx4 v11, s[52:55], s14 offen offset:3072 lds
    v_mfma_f32_16x16x32_bf16 v[136:139], a[172:175], a[148:151], v[136:139]
    s_add_u32 m0, s21, 12288
    v_add_u32 v18, s68, v22
    v_mfma_f32_16x16x32_bf16 v[140:143], a[172:175], a[144:147], v[140:143]
    s_waitcnt lgkmcnt(10)
    buffer_load_dwordx4 v18, s[44:47], s84 offen offset:0 sc1 lds
    ds_read_b64_tr_b16 a[112:113], v12 offset:32768
    v_mfma_f32_16x16x32_bf16 v[124:127], a[176:179], a[156:159], v[124:127]
    v_add_u32 v19, -1024, v18
    ds_read_b64_tr_b16 a[114:115], v12 offset:33792
    v_mfma_f32_16x16x32_bf16 v[128:131], a[176:179], a[152:155], v[128:131]
    buffer_load_dwordx4 v19, s[44:47], s85 offen offset:1024 sc1 lds
    ds_read_b64_tr_b16 a[116:117], v13 offset:32768
    v_mfma_f32_16x16x32_bf16 v[132:135], a[176:179], a[148:151], v[132:135]
    v_add_u32 v20, -2048, v18
    ds_read_b64_tr_b16 a[118:119], v13 offset:33792
    v_mfma_f32_16x16x32_bf16 v[136:139], a[176:179], a[144:147], v[136:139]
    s_waitcnt lgkmcnt(12)
    buffer_load_dwordx4 v20, s[44:47], s86 offen offset:2048 sc1 lds
    ds_read_b64_tr_b16 a[120:121], v12 offset:40960
    v_mfma_f32_16x16x32_bf16 v[140:143], a[176:179], a[140:143], v[140:143]
    s_waitcnt lgkmcnt(12)
    s_add_u32 m0, s21, 24576
    v_mfma_f32_16x16x32_bf16 v[120:123], a[180:183], a[156:159], v[120:123]
    buffer_load_dwordx4 v18, s[44:47], s87 offen offset:0 sc1 lds
    ds_read_b64_tr_b16 a[122:123], v12 offset:41984
    v_mfma_f32_16x16x32_bf16 v[124:127], a[180:183], a[152:155], v[124:127]
    v_mfma_f32_16x16x32_bf16 v[128:131], a[180:183], a[148:151], v[128:131]
    s_lshl_b32 s8, s3, 13
    buffer_load_dwordx4 v19, s[44:47], s88 offen offset:1024 sc1 lds
    v_mfma_f32_16x16x32_bf16 v[132:135], a[180:183], a[144:147], v[132:135]
    ds_read_b64_tr_b16 a[124:125], v13 offset:40960
    v_mfma_f32_16x16x32_bf16 v[136:139], a[180:183], a[140:143], v[136:139]
    s_waitcnt lgkmcnt(12)
    buffer_load_dwordx4 v20, s[44:47], s89 offen offset:2048 sc1 lds
    v_mfma_f32_16x16x32_bf16 v[140:143], a[180:183], a[136:139], v[140:143]
    s_waitcnt lgkmcnt(11)
    s_add_u32 m0, s21, 36864
    v_mfma_f32_16x16x32_bf16 v[116:119], a[184:187], a[156:159], v[116:119]
    buffer_load_dwordx4 v18, s[44:47], s90 offen offset:0 sc1 lds
    ds_read_b64_tr_b16 a[126:127], v13 offset:41984
    v_mfma_f32_16x16x32_bf16 v[120:123], a[184:187], a[152:155], v[120:123]
    v_mfma_f32_16x16x32_bf16 v[124:127], a[184:187], a[148:151], v[124:127]
    s_waitcnt vmcnt(4) lgkmcnt(0)
    s_barrier
    s_add_u32 s8, s8, 65536
    v_mfma_f32_16x16x32_bf16 v[128:131], a[184:187], a[144:147], v[128:131]
    ds_read_b128 v[32:35], v16 offset:12288
    ds_read_b64_tr_b16 a[208:209], v12 offset:0
    v_mfma_f32_16x16x32_bf16 v[132:135], a[184:187], a[140:143], v[132:135]
    buffer_load_dwordx4 v19, s[44:47], s91 offen offset:1024 sc1 lds
    ds_read_b64_tr_b16 a[192:193], v12 offset:49152
    v_mfma_f32_16x16x32_bf16 v[136:139], a[184:187], a[136:139], v[136:139]
    ds_read_b128 v[36:39], v16 offset:15360
    buffer_store_dword v24, v25, s[44:47], s32 offen sc1
    v_mfma_f32_16x16x32_bf16 v[140:143], a[184:187], a[132:135], v[140:143]
    buffer_load_dwordx4 v20, s[44:47], s92 offen offset:2048 sc1 lds
    ds_read_b64_tr_b16 a[194:195], v12 offset:50176
    v_mfma_f32_16x16x32_bf16 v[112:115], a[188:191], a[156:159], v[112:115]
    s_add_u32 m0, s21, 49152
    ds_read_b128 v[40:43], v16 offset:18432
    v_add_u32 v30, s8, v21
    v_mfma_f32_16x16x32_bf16 v[116:119], a[188:191], a[152:155], v[116:119]
    buffer_load_dwordx4 v18, s[44:47], s93 offen offset:0 sc1 lds
    ds_read_b64_tr_b16 a[210:211], v12 offset:1024
    v_mfma_f32_16x16x32_bf16 v[120:123], a[188:191], a[148:151], v[120:123]
    ds_read_b128 v[44:47], v16 offset:21504
    ds_read_b64_tr_b16 a[212:213], v13 offset:0
    v_mfma_f32_16x16x32_bf16 v[124:127], a[188:191], a[144:147], v[124:127]
    buffer_load_dwordx4 v19, s[44:47], s94 offen offset:1024 sc1 lds
    ds_read_b64_tr_b16 a[196:197], v13 offset:49152
    v_mfma_f32_16x16x32_bf16 v[128:131], a[188:191], a[140:143], v[128:131]
    s_cmp_lt_u32 s3, 2
    s_cselect_b32 s84, s84, s85
    ds_read_b128 v[48:51], v16 offset:13312
    v_mfma_f32_16x16x32_bf16 v[132:135], a[188:191], a[136:139], v[132:135]
    s_lshl_b32 s8, s3, 11
    buffer_load_dwordx4 v20, s[44:47], s95 offen offset:2048 sc1 lds
    ds_read_b64_tr_b16 a[198:199], v13 offset:50176
    v_mfma_f32_16x16x32_bf16 v[136:139], a[188:191], a[132:135], v[136:139]
    ds_read_b128 v[52:55], v16 offset:16384
    s_add_u32 m0, s20, 32768
    s_lshl_b32 s14, s101, 1
    ds_write_b128 v30, v[112:115] offset:0
    v_mfma_f32_16x16x32_bf16 v[140:143], a[188:191], a[128:131], v[140:143]
    s_waitcnt lgkmcnt(10)
    s_add_u32 s8, s8, 65536
    buffer_load_dwordx4 v8, s[52:55], s14 offen offset:0 lds
    ds_read_b64_tr_b16 a[214:215], v13 offset:1024
    v_add_u32 v4, s8, v21
    v_mfma_f32_16x16x32_bf16 v[64:67], v[32:35], v[156:159], 0
    ds_read_b128 v[56:59], v16 offset:19456
    ds_read_b64_tr_b16 a[216:217], v12 offset:8192
    ds_write_b128 v30, v[116:119] offset:1024
    v_mfma_f32_16x16x32_bf16 v[64:67], v[36:39], v[164:167], v[64:67]
    buffer_load_dwordx4 v9, s[52:55], s14 offen offset:1024 lds
    ds_read_b64_tr_b16 a[200:201], v12 offset:57344
    v_and_b32 v1, 15, v2
    v_mfma_f32_16x16x32_bf16 v[68:71], v[36:39], v[168:171], 0
    ds_read_b128 v[60:63], v16 offset:22528
    v_lshlrev_b32 v1, 5, v1
    ds_write_b128 v30, v[120:123] offset:2048
    v_mfma_f32_16x16x32_bf16 v[68:71], v[32:35], v[160:163], v[68:71]
    s_waitcnt lgkmcnt(13)
    buffer_load_dwordx4 v10, s[52:55], s14 offen offset:2048 lds
    ds_read_b64_tr_b16 a[202:203], v12 offset:58368
    v_lshrrev_b32 v31, 4, v2
    ds_write_b128 v30, v[124:127] offset:3072
    v_mfma_f32_16x16x32_bf16 v[76:79], v[40:43], v[160:163], 0
    ds_read_b128 v[32:35], v16 offset:14336
    ds_read_b64_tr_b16 a[218:219], v12 offset:9216
    v_lshl_add_u32 v1, v31, 3, v1
    v_mfma_f32_16x16x32_bf16 v[76:79], v[44:47], v[168:171], v[76:79]
    s_lshl_b32 s8, s3, 10
    buffer_load_dwordx4 v11, s[52:55], s14 offen offset:3072 lds
    ds_read_b64_tr_b16 a[220:221], v13 offset:8192
    ds_write_b128 v30, v[128:131] offset:4096
    v_mfma_f32_16x16x32_bf16 v[72:75], v[44:47], v[164:167], 0
    s_add_u32 m0, s21, 61440
    ds_read_b128 v[36:39], v16 offset:17408
    v_add_u32 v5, s8, v1
    ds_write_b128 v30, v[132:135] offset:5120
    v_mfma_f32_16x16x32_bf16 v[72:75], v[40:43], v[156:159], v[72:75]
    s_waitcnt lgkmcnt(15)
    buffer_load_dwordx4 v18, s[44:47], s96 offen offset:0 sc1 lds
    ds_read_b64_tr_b16 a[204:205], v13 offset:57344
    v_mfma_f32_16x16x32_bf16 v[64:67], v[48:51], v[172:175], v[64:67]
    s_lshl_b32 s15, s34, 12
    ds_read_b128 v[40:43], v16 offset:20480
    ds_write_b128 v30, v[136:139] offset:6144
    v_mfma_f32_16x16x32_bf16 v[64:67], v[52:55], v[180:183], v[64:67]
    s_add_u32 s15, s15, 6356992
    buffer_load_dwordx4 v19, s[44:47], s97 offen offset:1024 sc1 lds
    ds_read_b64_tr_b16 a[206:207], v13 offset:58368
    v_mfma_f32_16x16x32_bf16 v[68:71], v[52:55], v[184:187], v[68:71]
    ds_read_b128 v[44:47], v16 offset:23552
    ds_read_b64_tr_b16 a[222:223], v13 offset:9216
    ds_write_b128 v30, v[140:143] offset:7168
    v_mfma_f32_16x16x32_bf16 v[68:71], v[48:51], v[176:179], v[68:71]
    s_waitcnt vmcnt(13) lgkmcnt(0)
    s_barrier
    s_cmp_lt_u32 s3, 2
    s_cselect_b32 s90, s90, s91
    v_accvgpr_write_b32 a128, v146
    v_mfma_f32_16x16x32_bf16 v[76:79], v[56:59], v[176:179], v[76:79]
    ds_read_b128 v[48:51], v16 offset:24576
    v_mfma_f32_16x16x32_bf16 v[76:79], v[60:63], v[184:187], v[76:79]
    buffer_load_dwordx4 v20, s[44:47], s98 offen offset:2048 sc1 lds
    ds_read_b64_tr_b16 a[224:225], v12 offset:16384
    v_mfma_f32_16x16x32_bf16 v[72:75], v[60:63], v[180:183], v[72:75]
    s_cmp_lt_u32 s3, 2
    s_cselect_b32 s86, s86, s87
    ds_read_b128 v[52:55], v16 offset:27648
    v_mfma_f32_16x16x32_bf16 v[72:75], v[56:59], v[172:175], v[72:75]
    ds_read_b64_tr_b16 a[226:227], v12 offset:17408
    ds_read_b128 v[112:115], v4 offset:0
    v_mfma_f32_16x16x32_bf16 v[64:67], v[32:35], v[188:191], v[64:67]
    ds_read_b128 v[56:59], v16 offset:30720
    v_mfma_f32_16x16x32_bf16 v[64:67], v[36:39], v[196:199], v[64:67]
    ds_read_b128 v[116:119], v4 offset:8192
    v_mfma_f32_16x16x32_bf16 v[68:71], v[36:39], v[200:203], v[68:71]
    ds_read_b128 v[60:63], v16 offset:33792
    v_accvgpr_write_b32 a129, v147
    v_mfma_f32_16x16x32_bf16 v[68:71], v[32:35], v[192:195], v[68:71]
    ds_read_b64_tr_b16 a[228:229], v13 offset:16384
    ds_read_b128 v[120:123], v4 offset:16384
    v_mfma_f32_16x16x32_bf16 v[76:79], v[40:43], v[192:195], v[76:79]
    ds_read_b128 v[32:35], v16 offset:25600
    v_mfma_f32_16x16x32_bf16 v[76:79], v[44:47], v[200:203], v[76:79]
    ds_read_b64_tr_b16 a[230:231], v13 offset:17408
    ds_read_b128 v[124:127], v4 offset:24576
    v_mfma_f32_16x16x32_bf16 v[72:75], v[44:47], v[196:199], v[72:75]
    ds_read_b128 v[36:39], v16 offset:28672
    v_mfma_f32_16x16x32_bf16 v[72:75], v[40:43], v[188:191], v[72:75]
    s_waitcnt lgkmcnt(11)
    ds_read_b128 v[128:131], v4 offset:1024
    v_mfma_f32_16x16x32_bf16 v[64:67], v[48:51], v[204:207], v[64:67]
    ds_read_b128 v[40:43], v16 offset:31744
    v_mfma_f32_16x16x32_bf16 v[64:67], v[52:55], v[212:215], v[64:67]
    ds_read_b64_tr_b16 a[232:233], v12 offset:24576
    ds_read_b128 v[132:135], v4 offset:9216
    v_mfma_f32_16x16x32_bf16 v[68:71], v[52:55], v[216:219], v[68:71]
    ds_read_b128 v[44:47], v16 offset:34816
    v_accvgpr_write_b32 a130, v148
    v_mfma_f32_16x16x32_bf16 v[68:71], v[48:51], v[208:211], v[68:71]
    s_waitcnt lgkmcnt(11)
    ds_read_b64_tr_b16 a[234:235], v12 offset:25600
    ds_read_b128 v[136:139], v4 offset:17408
    v_mfma_f32_16x16x32_bf16 v[76:79], v[56:59], v[208:211], v[76:79]
    ds_read_b128 v[48:51], v16 offset:26624
    v_accvgpr_write_b32 a131, v149
    v_mfma_f32_16x16x32_bf16 v[76:79], v[60:63], v[216:219], v[76:79]
    s_cmp_lt_u32 s3, 2
    s_cselect_b32 s92, s92, s93
    ds_read_b128 v[140:143], v4 offset:25600
    v_mfma_f32_16x16x32_bf16 v[72:75], v[60:63], v[212:215], v[72:75]
    s_cmp_lt_u32 s3, 2
    s_cselect_b32 s94, s94, s95
    ds_read_b128 v[52:55], v16 offset:29696
    v_mfma_f32_16x16x32_bf16 v[72:75], v[56:59], v[204:207], v[72:75]
    s_waitcnt lgkmcnt(10)
    s_cmp_lt_u32 s3, 2
    s_cselect_b32 s88, s88, s89
    ds_read_b64_tr_b16 a[236:237], v13 offset:24576
    v_mfma_f32_16x16x32_bf16 v[64:67], v[32:35], v[220:223], v[64:67]
    ds_read_b128 v[56:59], v16 offset:32768
    v_add_f32 v112, v112, v116
    v_mfma_f32_16x16x32_bf16 v[64:67], v[36:39], v[228:231], v[64:67]
    ds_read_b64_tr_b16 a[238:239], v13 offset:25600
    v_add_f32 v113, v113, v117
    v_mfma_f32_16x16x32_bf16 v[68:71], v[36:39], v[232:235], v[68:71]
    ds_read_b128 v[60:63], v16 offset:35840
    v_add_f32 v114, v114, v118
    v_mfma_f32_16x16x32_bf16 v[68:71], v[32:35], v[224:227], v[68:71]
    s_waitcnt vmcnt(3) lgkmcnt(1)
    s_barrier
    v_add_f32 v115, v115, v119
    v_add_f32 v120, v120, v124
    v_mfma_f32_16x16x32_bf16 v[76:79], v[40:43], v[224:227], v[76:79]
    s_add_u32 m0, s21, 0
    ds_read_b128 v[32:35], v17 offset:0
    v_add_f32 v121, v121, v125
    v_mfma_f32_16x16x32_bf16 v[76:79], v[44:47], v[232:235], v[76:79]
L_pl_S_1:
    s_cbranch_execz L_wret
    buffer_load_dwordx4 v18, s[44:47], s99 offen offset:0 sc1 lds
    ds_read_b64_tr_b16 a[240:241], v12 offset:32768
    v_mfma_f32_16x16x32_bf16 v[72:75], v[44:47], v[228:231], v[72:75]
    ds_read_b128 v[36:39], v17 offset:3072
    v_add_f32 v122, v122, v126
    v_mfma_f32_16x16x32_bf16 v[72:75], v[40:43], v[220:223], v[72:75]
    buffer_load_dwordx4 v19, s[44:47], s100 offen offset:1024 sc1 lds
    ds_read_b64_tr_b16 a[242:243], v12 offset:33792
    v_add_f32 v123, v123, v127
    v_mfma_f32_16x16x32_bf16 v[64:67], v[48:51], v[236:239], v[64:67]
    ds_read_b128 v[40:43], v17 offset:6144
    v_add_f32 v112, v112, v120
    v_mfma_f32_16x16x32_bf16 v[64:67], v[52:55], v[244:247], v[64:67]
    buffer_load_dwordx4 v20, s[44:47], s101 offen offset:2048 sc1 lds
    v_add_f32 v113, v113, v121
    v_mfma_f32_16x16x32_bf16 v[68:71], v[52:55], v[248:251], v[68:71]
    s_add_u32 m0, s21, 12288
    ds_read_b128 v[44:47], v17 offset:9216
    v_add_u32 v18, s70, v22
    v_add_f32 v114, v114, v122
    v_mfma_f32_16x16x32_bf16 v[68:71], v[48:51], v[240:243], v[68:71]
    s_waitcnt lgkmcnt(6)
    buffer_load_dwordx4 v18, s[44:47], s84 offen offset:0 sc1 lds
    ds_read_b64_tr_b16 a[244:245], v13 offset:32768
    v_add_f32 v115, v115, v123
    v_mfma_f32_16x16x32_bf16 v[76:79], v[56:59], v[240:243], v[76:79]
    ds_read_b128 v[48:51], v17 offset:1024
    v_add_u32 v19, -1024, v18
    v_cvt_pk_bf16_f32 v112, v112, v113
    v_mfma_f32_16x16x32_bf16 v[76:79], v[60:63], v[248:251], v[76:79]
    buffer_load_dwordx4 v19, s[44:47], s86 offen offset:1024 sc1 lds
    ds_read_b64_tr_b16 a[246:247], v13 offset:33792
    v_mfma_f32_16x16x32_bf16 v[72:75], v[60:63], v[244:247], v[72:75]
    ds_read_b128 v[52:55], v17 offset:4096
    v_add_u32 v20, -2048, v18
    v_mfma_f32_16x16x32_bf16 v[72:75], v[56:59], v[236:239], v[72:75]
    s_waitcnt lgkmcnt(7)
    buffer_load_dwordx4 v20, s[44:47], s88 offen offset:2048 sc1 lds
    v_cvt_pk_bf16_f32 v113, v114, v115
    v_mfma_f32_16x16x32_bf16 v[64:67], v[32:35], a[0:3], v[64:67]
    ds_read_b128 v[56:59], v17 offset:7168
    buffer_store_dwordx2 v[112:113], v5, s[44:47], s15 offen offset:0 sc1
    v_mfma_f32_16x16x32_bf16 v[64:67], v[36:39], a[8:11], v[64:67]
    ds_read_b64_tr_b16 a[248:249], v12 offset:40960
    v_add_f32 v128, v128, v132
    v_mfma_f32_16x16x32_bf16 v[68:71], v[36:39], a[12:15], v[68:71]
    ds_read_b128 v[60:63], v17 offset:10240
    v_add_f32 v129, v129, v133
    v_mfma_f32_16x16x32_bf16 v[68:71], v[32:35], a[4:7], v[68:71]
    s_waitcnt lgkmcnt(7)
    ds_read_b64_tr_b16 a[250:251], v12 offset:41984
    v_add_f32 v130, v130, v134
    v_mfma_f32_16x16x32_bf16 v[76:79], v[40:43], a[4:7], v[76:79]
    ds_read_b128 v[32:35], v17 offset:2048
    v_add_f32 v131, v131, v135
    v_mfma_f32_16x16x32_bf16 v[76:79], v[44:47], a[12:15], v[76:79]
    v_add_f32 v136, v136, v140
    v_add_f32 v137, v137, v141
    v_mfma_f32_16x16x32_bf16 v[72:75], v[44:47], a[8:11], v[72:75]
    ds_read_b128 v[36:39], v17 offset:5120
    v_add_f32 v138, v138, v142
    v_mfma_f32_16x16x32_bf16 v[72:75], v[40:43], a[0:3], v[72:75]
    s_waitcnt lgkmcnt(6)
    ds_read_b64_tr_b16 a[252:253], v13 offset:40960
    v_add_f32 v139, v139, v143
    v_mfma_f32_16x16x32_bf16 v[64:67], v[48:51], a[16:19], v[64:67]
    ds_read_b128 v[40:43], v17 offset:8192
    v_add_f32 v128, v128, v136
    v_mfma_f32_16x16x32_bf16 v[64:67], v[52:55], a[24:27], v[64:67]
    ds_read_b64_tr_b16 a[254:255], v13 offset:41984
    v_add_f32 v129, v129, v137
    v_mfma_f32_16x16x32_bf16 v[68:71], v[52:55], a[28:31], v[68:71]
    ds_read_b128 v[44:47], v17 offset:11264
    v_add_f32 v130, v130, v138
    v_mfma_f32_16x16x32_bf16 v[68:71], v[48:51], a[20:23], v[68:71]
    s_waitcnt lgkmcnt(1)
    s_barrier
    v_add_f32 v131, v131, v139
    v_cvt_pk_bf16_f32 v128, v128, v129
    v_mfma_f32_16x16x32_bf16 v[76:79], v[56:59], a[20:23], v[76:79]
    s_add_u32 m0, s21, 24576
    ds_read_b128 v[48:51], v17 offset:12288
    v_cvt_pk_bf16_f32 v129, v130, v131
    v_mfma_f32_16x16x32_bf16 v[76:79], v[60:63], a[28:31], v[76:79]
    buffer_load_dwordx4 v18, s[44:47], s90 offen offset:0 sc1 lds
    buffer_store_dwordx2 v[128:129], v5, s[44:47], s15 offen offset:512 sc1
    v_mfma_f32_16x16x32_bf16 v[72:75], v[60:63], a[24:27], v[72:75]
    s_cmp_lt_u32 s3, 2
    s_cselect_b32 s96, s96, s97
    ds_read_b128 v[52:55], v17 offset:15360
    v_mfma_f32_16x16x32_bf16 v[72:75], v[56:59], a[16:19], v[72:75]
    s_cmp_lt_u32 s3, 2
    s_cselect_b32 s98, s98, s99
    buffer_load_dwordx4 v19, s[44:47], s92 offen offset:1024 sc1 lds
    v_mfma_f32_16x16x32_bf16 v[64:67], v[32:35], a[32:35], v[64:67]
    ds_read_b128 v[56:59], v17 offset:18432
    v_accvgpr_write_b32 a132, v150
    v_mfma_f32_16x16x32_bf16 v[64:67], v[36:39], a[40:43], v[64:67]
    buffer_load_dwordx4 v20, s[44:47], s94 offen offset:2048 sc1 lds
    v_accvgpr_write_b32 a133, v151
    v_mfma_f32_16x16x32_bf16 v[68:71], v[36:39], a[44:47], v[68:71]
    ds_read_b128 v[60:63], v17 offset:21504
    v_mfma_f32_16x16x32_bf16 v[68:71], v[32:35], a[36:39], v[68:71]
    s_waitcnt lgkmcnt(4)
    v_mfma_f32_16x16x32_bf16 v[76:79], v[40:43], a[36:39], v[76:79]
    ds_read_b128 v[32:35], v17 offset:13312
    v_mfma_f32_16x16x32_bf16 v[76:79], v[44:47], a[44:47], v[76:79]
    v_mfma_f32_16x16x32_bf16 v[72:75], v[44:47], a[40:43], v[72:75]
    ds_read_b128 v[36:39], v17 offset:16384
    v_mfma_f32_16x16x32_bf16 v[72:75], v[40:43], a[32:35], v[72:75]
    s_waitcnt lgkmcnt(4)
    v_mfma_f32_16x16x32_bf16 v[64:67], v[48:51], a[48:51], v[64:67]
    ds_read_b128 v[40:43], v17 offset:19456
    v_mfma_f32_16x16x32_bf16 v[64:67], v[52:55], a[56:59], v[64:67]
    v_mfma_f32_16x16x32_bf16 v[68:71], v[52:55], a[60:63], v[68:71]
    ds_read_b128 v[44:47], v17 offset:22528
    v_mfma_f32_16x16x32_bf16 v[68:71], v[48:51], a[52:55], v[68:71]
    s_waitcnt lgkmcnt(4)
    v_mfma_f32_16x16x32_bf16 v[76:79], v[56:59], a[52:55], v[76:79]
    ds_read_b128 v[48:51], v17 offset:14336
    v_mfma_f32_16x16x32_bf16 v[76:79], v[60:63], a[60:63], v[76:79]
    s_cmp_lt_u32 s3, 2
    s_cselect_b32 s100, s100, s101
    buffer_load_dword v27, v26, s[44:47], 0 offen offset:0 sc1
    v_mfma_f32_16x16x32_bf16 v[72:75], v[60:63], a[56:59], v[72:75]
    ds_read_b128 v[52:55], v17 offset:17408
    v_mfma_f32_16x16x32_bf16 v[72:75], v[56:59], a[48:51], v[72:75]
    s_waitcnt lgkmcnt(4)
    v_mfma_f32_16x16x32_bf16 v[64:67], v[32:35], a[64:67], v[64:67]
    ds_read_b128 v[56:59], v17 offset:20480
    v_mfma_f32_16x16x32_bf16 v[64:67], v[36:39], a[72:75], v[64:67]
    v_mfma_f32_16x16x32_bf16 v[68:71], v[36:39], a[76:79], v[68:71]
    ds_read_b128 v[60:63], v17 offset:23552
    v_mfma_f32_16x16x32_bf16 v[68:71], v[32:35], a[68:71], v[68:71]
    s_waitcnt vmcnt(12) lgkmcnt(4)
    s_barrier
    v_mfma_f32_16x16x32_bf16 v[76:79], v[40:43], a[68:71], v[76:79]
    s_add_u32 m0, s21, 36864
    ds_read_b128 v[32:35], v17 offset:24576
    v_mfma_f32_16x16x32_bf16 v[76:79], v[44:47], a[76:79], v[76:79]
    buffer_load_dwordx4 v18, s[44:47], s96 offen offset:0 sc1 lds
    v_mfma_f32_16x16x32_bf16 v[72:75], v[44:47], a[72:75], v[72:75]
    ds_read_b128 v[36:39], v17 offset:27648
    v_mfma_f32_16x16x32_bf16 v[72:75], v[40:43], a[64:67], v[72:75]
    s_waitcnt lgkmcnt(4)
    buffer_load_dwordx4 v19, s[44:47], s98 offen offset:1024 sc1 lds
    v_mfma_f32_16x16x32_bf16 v[64:67], v[48:51], a[80:83], v[64:67]
    ds_read_b128 v[40:43], v17 offset:30720
    v_mfma_f32_16x16x32_bf16 v[64:67], v[52:55], a[88:91], v[64:67]
    buffer_load_dwordx4 v20, s[44:47], s100 offen offset:2048 sc1 lds
    v_mfma_f32_16x16x32_bf16 v[68:71], v[52:55], a[92:95], v[68:71]
    ds_read_b128 v[44:47], v17 offset:33792
    v_mfma_f32_16x16x32_bf16 v[68:71], v[48:51], a[84:87], v[68:71]
    s_waitcnt lgkmcnt(4)
    v_mfma_f32_16x16x32_bf16 v[76:79], v[56:59], a[84:87], v[76:79]
    ds_read_b128 v[48:51], v17 offset:25600
    v_mfma_f32_16x16x32_bf16 v[76:79], v[60:63], a[92:95], v[76:79]
    v_mfma_f32_16x16x32_bf16 v[72:75], v[60:63], a[88:91], v[72:75]
    ds_read_b128 v[52:55], v17 offset:28672
    v_mfma_f32_16x16x32_bf16 v[72:75], v[56:59], a[80:83], v[72:75]
    s_waitcnt lgkmcnt(4)
    v_mfma_f32_16x16x32_bf16 v[64:67], v[32:35], a[96:99], v[64:67]
    ds_read_b128 v[56:59], v17 offset:31744
    v_mfma_f32_16x16x32_bf16 v[64:67], v[36:39], a[104:107], v[64:67]
    v_mfma_f32_16x16x32_bf16 v[68:71], v[36:39], a[108:111], v[68:71]
    ds_read_b128 v[60:63], v17 offset:34816
    v_mfma_f32_16x16x32_bf16 v[68:71], v[32:35], a[100:103], v[68:71]
    s_waitcnt lgkmcnt(4)
    v_mfma_f32_16x16x32_bf16 v[76:79], v[40:43], a[100:103], v[76:79]
    ds_read_b128 v[32:35], v17 offset:26624
    v_mfma_f32_16x16x32_bf16 v[76:79], v[44:47], a[108:111], v[76:79]
    v_mfma_f32_16x16x32_bf16 v[72:75], v[44:47], a[104:107], v[72:75]
    ds_read_b128 v[36:39], v17 offset:29696
    v_mfma_f32_16x16x32_bf16 v[72:75], v[40:43], a[96:99], v[72:75]
    s_waitcnt lgkmcnt(4)
    v_mfma_f32_16x16x32_bf16 v[64:67], v[48:51], a[112:115], v[64:67]
    ds_read_b128 v[40:43], v17 offset:32768
    v_mfma_f32_16x16x32_bf16 v[64:67], v[52:55], a[120:123], v[64:67]
    v_mfma_f32_16x16x32_bf16 v[68:71], v[52:55], a[124:127], v[68:71]
    ds_read_b128 v[44:47], v17 offset:35840
    v_mfma_f32_16x16x32_bf16 v[68:71], v[48:51], a[116:119], v[68:71]
    s_waitcnt vmcnt(6) lgkmcnt(4)
    s_barrier
    v_mfma_f32_16x16x32_bf16 v[76:79], v[56:59], a[116:119], v[76:79]
    ds_read_b128 v[48:51], v16 offset:0
    v_mfma_f32_16x16x32_bf16 v[76:79], v[60:63], a[124:127], v[76:79]
    buffer_store_dword v24, v29, s[44:47], 0 offen sc1
    v_mfma_f32_16x16x32_bf16 v[72:75], v[60:63], a[120:123], v[72:75]
    ds_read_b128 v[52:55], v16 offset:3072
    v_mfma_f32_16x16x32_bf16 v[72:75], v[56:59], a[112:115], v[72:75]
    s_waitcnt lgkmcnt(4)
    v_mfma_f32_16x16x32_bf16 v[64:67], v[32:35], a[192:195], v[64:67]
    ds_read_b128 v[56:59], v16 offset:6144
    v_mfma_f32_16x16x32_bf16 v[64:67], v[36:39], a[200:203], v[64:67]
    v_mfma_f32_16x16x32_bf16 v[68:71], v[36:39], a[204:207], v[68:71]
    ds_read_b128 v[60:63], v16 offset:9216
    v_mfma_f32_16x16x32_bf16 v[68:71], v[32:35], a[196:199], v[68:71]
    s_waitcnt lgkmcnt(4)
    v_mfma_f32_16x16x32_bf16 v[76:79], v[40:43], a[196:199], v[76:79]
    ds_read_b128 v[32:35], v16 offset:1024
    v_mfma_f32_16x16x32_bf16 v[76:79], v[44:47], a[204:207], v[76:79]
    v_mfma_f32_16x16x32_bf16 v[72:75], v[44:47], a[200:203], v[72:75]
    s_waitcnt vmcnt(4)
    ds_read_b128 v[36:39], v16 offset:4096
    v_mfma_f32_16x16x32_bf16 v[72:75], v[40:43], a[192:195], v[72:75]
    s_waitcnt lgkmcnt(4)
    v_cmp_ne_u32 vcc, s16, v27
    s_cbranch_vccnz L_rs_p2
L_ok_p2:
    v_mfma_f32_16x16x32_bf16 v[64:67], v[48:51], a[208:211], v[64:67]
    s_add_u32 m0, s21, 49152
    ds_read_b128 v[40:43], v16 offset:7168
    v_add_u32 v18, s71, v22
    v_mfma_f32_16x16x32_bf16 v[64:67], v[52:55], a[216:219], v[64:67]
    buffer_load_dwordx4 v18, s[44:47], s84 offen offset:0 sc1 lds
    v_mfma_f32_16x16x32_bf16 v[68:71], v[52:55], a[220:223], v[68:71]
    ds_read_b128 v[44:47], v16 offset:10240
    v_add_u32 v19, -1024, v18
    v_mfma_f32_16x16x32_bf16 v[68:71], v[48:51], a[212:215], v[68:71]
    s_waitcnt lgkmcnt(4)
    buffer_load_dwordx4 v19, s[44:47], s86 offen offset:1024 sc1 lds
    v_mfma_f32_16x16x32_bf16 v[76:79], v[56:59], a[212:215], v[76:79]
    ds_read_b128 v[48:51], v16 offset:2048
    v_add_u32 v20, -2048, v18
    v_mfma_f32_16x16x32_bf16 v[76:79], v[60:63], a[220:223], v[76:79]
    buffer_load_dwordx4 v20, s[44:47], s88 offen offset:2048 sc1 lds
    v_mfma_f32_16x16x32_bf16 v[72:75], v[60:63], a[216:219], v[72:75]
    s_and_b32 s12, s23, 1
    ds_read_b128 v[52:55], v16 offset:5120
    v_mfma_f32_16x16x32_bf16 v[72:75], v[56:59], a[208:211], v[72:75]
    s_waitcnt lgkmcnt(4)
    v_mfma_f32_16x16x32_bf16 v[64:67], v[32:35], a[224:227], v[64:67]
    ds_read_b128 v[56:59], v16 offset:8192
    v_mfma_f32_16x16x32_bf16 v[64:67], v[36:39], a[232:235], v[64:67]
    s_lshl_b32 s12, s12, 7
    v_mfma_f32_16x16x32_bf16 v[68:71], v[36:39], a[236:239], v[68:71]
    ds_read_b128 v[60:63], v16 offset:11264
    v_mfma_f32_16x16x32_bf16 v[68:71], v[32:35], a[228:231], v[68:71]
    s_waitcnt lgkmcnt(4)
    s_barrier
    v_mfma_f32_16x16x32_bf16 v[76:79], v[40:43], a[228:231], v[76:79]
    s_add_u32 m0, s21, 61440
    ds_read_b128 v[32:35], v16 offset:12288
    s_add_u32 s12, s12, 8716288
    v_mfma_f32_16x16x32_bf16 v[76:79], v[44:47], a[236:239], v[76:79]
    buffer_load_dwordx4 v18, s[44:47], s90 offen offset:0 sc1 lds
    v_mfma_f32_16x16x32_bf16 v[72:75], v[44:47], a[232:235], v[72:75]
    ds_read_b128 v[36:39], v16 offset:15360
    v_mfma_f32_16x16x32_bf16 v[72:75], v[40:43], a[224:227], v[72:75]
    s_waitcnt lgkmcnt(4)
    buffer_load_dwordx4 v19, s[44:47], s92 offen offset:1024 sc1 lds
    buffer_load_dwordx2 v[150:151], v14, s[44:47], s12 offen sc1
    v_mfma_f32_16x16x32_bf16 v[64:67], v[48:51], a[240:243], v[64:67]
    ds_read_b128 v[40:43], v16 offset:18432
    v_mfma_f32_16x16x32_bf16 v[64:67], v[52:55], a[248:251], v[64:67]
    buffer_load_dwordx4 v20, s[44:47], s94 offen offset:2048 sc1 lds
    v_mfma_f32_16x16x32_bf16 v[68:71], v[52:55], a[252:255], v[68:71]
    s_mov_b32 s12, 8716288
    ds_read_b128 v[44:47], v16 offset:21504
    v_mfma_f32_16x16x32_bf16 v[68:71], v[48:51], a[244:247], v[68:71]
    s_waitcnt lgkmcnt(4)
    v_mfma_f32_16x16x32_bf16 v[76:79], v[56:59], a[244:247], v[76:79]
    ds_read_b128 v[48:51], v16 offset:13312
    v_mfma_f32_16x16x32_bf16 v[76:79], v[60:63], a[252:255], v[76:79]
    buffer_load_dwordx2 v[148:149], v14, s[44:47], s12 offen offset:128 sc1
    v_mfma_f32_16x16x32_bf16 v[72:75], v[60:63], a[248:251], v[72:75]
    ds_read_b128 v[52:55], v16 offset:16384
    v_mfma_f32_16x16x32_bf16 v[72:75], v[56:59], a[240:243], v[72:75]
    s_waitcnt lgkmcnt(4)
    v_mfma_f32_16x16x32_bf16 v[112:115], v[32:35], v[156:159], 0
    ds_read_b128 v[56:59], v16 offset:19456
    buffer_load_dwordx2 v[146:147], v14, s[44:47], s12 offen sc1
    v_mfma_f32_16x16x32_bf16 v[112:115], v[36:39], v[164:167], v[112:115]
    v_mfma_f32_16x16x32_bf16 v[116:119], v[36:39], v[168:171], 0
    ds_read_b128 v[60:63], v16 offset:22528
    v_mfma_f32_16x16x32_bf16 v[116:119], v[32:35], v[160:163], v[116:119]
    s_waitcnt lgkmcnt(4)
    s_movk_i32 s12, 18432
    v_mfma_f32_16x16x32_bf16 v[116:119], v[40:43], v[176:179], v[116:119]
    ds_read_b128 v[32:35], v16 offset:14336
    v_mfma_f32_16x16x32_bf16 v[116:119], v[44:47], v[184:187], v[116:119]
    v_cndmask_b32 v128, v64, v68, s[26:27]
    v_cndmask_b32 v129, v65, v69, s[26:27]
    v_mfma_f32_16x16x32_bf16 v[112:115], v[44:47], v[180:183], v[112:115]
    ds_read_b128 v[36:39], v16 offset:17408
    v_cndmask_b32 v130, v66, v70, s[26:27]
    v_cndmask_b32 v131, v67, v71, s[26:27]
    v_mfma_f32_16x16x32_bf16 v[112:115], v[40:43], v[172:175], v[112:115]
    s_waitcnt lgkmcnt(4)
    s_add_u32 s8, s83, 6144
    v_cvt_pk_bf16_f32 v64, v64, v65
    v_cvt_pk_bf16_f32 v65, v66, v67
    v_mfma_f32_16x16x32_bf16 v[112:115], v[48:51], v[188:191], v[112:115]
    ds_read_b128 v[40:43], v16 offset:20480
    v_cvt_pk_bf16_f32 v66, v68, v69
    v_mfma_f32_16x16x32_bf16 v[112:115], v[52:55], v[196:199], v[112:115]
    v_cvt_pk_bf16_f32 v67, v70, v71
    v_bfi_b32 v64, s33, v253, v64
    v_mfma_f32_16x16x32_bf16 v[116:119], v[52:55], v[200:203], v[116:119]
    ds_read_b128 v[44:47], v16 offset:23552
    v_bfi_b32 v65, s33, v255, v65
    v_mfma_f32_16x16x32_bf16 v[116:119], v[48:51], v[192:195], v[116:119]
    s_waitcnt lgkmcnt(4)
    s_barrier
    v_bfi_b32 v66, s33, v23, v66
    v_bfi_b32 v67, s33, v0, v67
    v_mfma_f32_16x16x32_bf16 v[116:119], v[56:59], v[208:211], v[116:119]
    ds_read_b128 v[48:51], v16 offset:24576
    v_cvt_pk_bf16_f32 v72, v72, v73
    v_mfma_f32_16x16x32_bf16 v[116:119], v[60:63], v[216:219], v[116:119]
    buffer_store_dwordx4 v[64:67], v21, s[44:47], s8 offen sc1
    v_mfma_f32_16x16x32_bf16 v[112:115], v[60:63], v[212:215], v[112:115]
    ds_read_b128 v[52:55], v16 offset:27648
    v_cvt_pk_bf16_f32 v73, v74, v75
    v_mfma_f32_16x16x32_bf16 v[112:115], v[56:59], v[204:207], v[112:115]
    s_waitcnt lgkmcnt(4)
    v_cvt_pk_bf16_f32 v74, v76, v77
    v_cvt_pk_bf16_f32 v75, v78, v79
    buffer_load_dwordx4 v[8:11], v144, s[56:59], 0 offen
    v_mfma_f32_16x16x32_bf16 v[112:115], v[32:35], v[220:223], v[112:115]
    ds_read_b128 v[56:59], v16 offset:30720
    v_bfi_b32 v72, s33, v253, v72
    v_mfma_f32_16x16x32_bf16 v[112:115], v[36:39], v[228:231], v[112:115]
    v_mfma_f32_16x16x32_bf16 v[116:119], v[36:39], v[232:235], v[116:119]
    ds_read_b128 v[60:63], v16 offset:33792
    v_bfi_b32 v73, s33, v255, v73
    v_mfma_f32_16x16x32_bf16 v[116:119], v[32:35], v[224:227], v[116:119]
    s_waitcnt lgkmcnt(4)
    v_mfma_f32_16x16x32_bf16 v[116:119], v[40:43], v[240:243], v[116:119]
    ds_read_b128 v[32:35], v16 offset:25600
    v_bfi_b32 v74, s33, v23, v74
    v_mfma_f32_16x16x32_bf16 v[116:119], v[44:47], v[248:251], v[116:119]
    buffer_load_dwordx4 v[12:15], v144, s[56:59], s12 offen
    v_mfma_f32_16x16x32_bf16 v[112:115], v[44:47], v[244:247], v[112:115]
    ds_read_b128 v[36:39], v16 offset:28672
    v_bfi_b32 v75, s33, v0, v75
    v_mfma_f32_16x16x32_bf16 v[112:115], v[40:43], v[236:239], v[112:115]
    s_waitcnt lgkmcnt(4)
    buffer_load_dwordx2 v[4:5], v145, s[56:59], 0 offen
    v_mfma_f32_16x16x32_bf16 v[112:115], v[48:51], a[0:3], v[112:115]
    ds_read_b128 v[40:43], v16 offset:31744
    v_mfma_f32_16x16x32_bf16 v[112:115], v[52:55], a[8:11], v[112:115]
    buffer_store_dwordx4 v[72:75], v21, s[44:47], s77 offen sc1
    v_mfma_f32_16x16x32_bf16 v[116:119], v[52:55], a[12:15], v[116:119]
    s_add_u32 m0, s21, 0
    ds_read_b128 v[44:47], v16 offset:34816
    v_mfma_f32_16x16x32_bf16 v[116:119], v[48:51], a[4:7], v[116:119]
    s_waitcnt lgkmcnt(4)
    buffer_load_dwordx4 v18, s[44:47], s96 offen offset:0 sc1 lds
    v_mfma_f32_16x16x32_bf16 v[116:119], v[56:59], a[20:23], v[116:119]
    ds_read_b128 v[48:51], v16 offset:26624
    v_mfma_f32_16x16x32_bf16 v[116:119], v[60:63], a[28:31], v[116:119]
    v_mfma_f32_16x16x32_bf16 v[112:115], v[60:63], a[24:27], v[112:115]
    ds_read_b128 v[52:55], v16 offset:29696
    v_mfma_f32_16x16x32_bf16 v[112:115], v[56:59], a[16:19], v[112:115]
    s_waitcnt lgkmcnt(4)
    v_mfma_f32_16x16x32_bf16 v[112:115], v[32:35], a[32:35], v[112:115]
    ds_read_b128 v[56:59], v16 offset:32768
    v_mfma_f32_16x16x32_bf16 v[112:115], v[36:39], a[40:43], v[112:115]
    buffer_load_dwordx4 v19, s[44:47], s98 offen offset:1024 sc1 lds
    v_mfma_f32_16x16x32_bf16 v[116:119], v[36:39], a[44:47], v[116:119]
    ds_read_b128 v[60:63], v16 offset:35840
    v_mfma_f32_16x16x32_bf16 v[116:119], v[32:35], a[36:39], v[116:119]
    s_waitcnt vmcnt(17) lgkmcnt(4)
    s_barrier
    v_mfma_f32_16x16x32_bf16 v[116:119], v[40:43], a[52:55], v[116:119]
    ds_read_b128 v[32:35], v17 offset:0
    v_mfma_f32_16x16x32_bf16 v[116:119], v[44:47], a[60:63], v[116:119]
    buffer_load_dwordx4 v20, s[44:47], s100 offen offset:2048 sc1 lds
    v_mfma_f32_16x16x32_bf16 v[112:115], v[44:47], a[56:59], v[112:115]
    ds_read_b128 v[36:39], v17 offset:3072
    v_mfma_f32_16x16x32_bf16 v[112:115], v[40:43], a[48:51], v[112:115]
    s_waitcnt lgkmcnt(4)
    v_mfma_f32_16x16x32_bf16 v[112:115], v[48:51], a[64:67], v[112:115]
    ds_read_b128 v[40:43], v17 offset:6144
    v_mfma_f32_16x16x32_bf16 v[112:115], v[52:55], a[72:75], v[112:115]
    v_mfma_f32_16x16x32_bf16 v[116:119], v[52:55], a[76:79], v[116:119]
    ds_read_b128 v[44:47], v17 offset:9216
    v_mfma_f32_16x16x32_bf16 v[116:119], v[48:51], a[68:71], v[116:119]
    s_waitcnt lgkmcnt(4)
    v_mfma_f32_16x16x32_bf16 v[116:119], v[56:59], a[84:87], v[116:119]
    s_add_u32 m0, s21, 12288
    ds_read_b128 v[48:51], v17 offset:1024
    v_add_u32 v18, s72, v22
    v_mfma_f32_16x16x32_bf16 v[116:119], v[60:63], a[92:95], v[116:119]
    buffer_load_dwordx4 v18, s[44:47], s84 offen offset:0 sc1 lds
    v_mfma_f32_16x16x32_bf16 v[112:115], v[60:63], a[88:91], v[112:115]
    ds_read_b128 v[52:55], v17 offset:4096
    v_add_u32 v19, -1024, v18
    v_mfma_f32_16x16x32_bf16 v[112:115], v[56:59], a[80:83], v[112:115]
    s_waitcnt lgkmcnt(4)
    buffer_load_dwordx4 v19, s[44:47], s86 offen offset:1024 sc1 lds
    v_mfma_f32_16x16x32_bf16 v[112:115], v[32:35], a[96:99], v[112:115]
    ds_read_b128 v[56:59], v17 offset:7168
    v_mfma_f32_16x16x32_bf16 v[112:115], v[36:39], a[104:107], v[112:115]
    v_mfma_f32_16x16x32_bf16 v[116:119], v[36:39], a[108:111], v[116:119]
    s_sub_u32 s4, s36, 6356992
    ds_read_b128 v[60:63], v17 offset:10240
    v_mfma_f32_16x16x32_bf16 v[116:119], v[32:35], a[100:103], v[116:119]
    s_waitcnt lgkmcnt(4)
    v_mfma_f32_16x16x32_bf16 v[116:119], v[40:43], a[116:119], v[116:119]
    s_lshr_b32 s4, s4, 12
    ds_read_b128 v[32:35], v17 offset:2048
    v_add_u32 v20, -2048, v18
    v_mfma_f32_16x16x32_bf16 v[116:119], v[44:47], a[124:127], v[116:119]
    buffer_load_dwordx4 v20, s[44:47], s88 offen offset:2048 sc1 lds
    v_mfma_f32_16x16x32_bf16 v[112:115], v[44:47], a[120:123], v[112:115]
    s_sub_u32 s5, s37, 6488064
    ds_read_b128 v[36:39], v17 offset:5120
    v_mfma_f32_16x16x32_bf16 v[112:115], v[40:43], a[112:115], v[112:115]
    s_waitcnt lgkmcnt(4)
    v_mfma_f32_16x16x32_bf16 v[112:115], v[48:51], a[192:195], v[112:115]
    s_ashr_i32 s5, s5, 12
    ds_read_b128 v[40:43], v17 offset:8192
    v_mfma_f32_16x16x32_bf16 v[112:115], v[52:55], a[200:203], v[112:115]
    v_mfma_f32_16x16x32_bf16 v[116:119], v[52:55], a[204:207], v[116:119]
    ds_read_b128 v[44:47], v17 offset:11264
    v_min_u32 v28, 47, v2
    v_mfma_f32_16x16x32_bf16 v[116:119], v[48:51], a[196:199], v[116:119]
    s_waitcnt vmcnt(17) lgkmcnt(4)
    s_barrier
    v_mfma_f32_16x16x32_bf16 v[116:119], v[56:59], a[212:215], v[116:119]
    s_add_u32 m0, s21, 24576
    ds_read_b128 v[48:51], v17 offset:12288
    v_add_u32 v29, s5, v28
    v_mfma_f32_16x16x32_bf16 v[116:119], v[60:63], a[220:223], v[116:119]
    buffer_load_dwordx4 v18, s[44:47], s90 offen offset:0 sc1 lds
    v_mfma_f32_16x16x32_bf16 v[112:115], v[60:63], a[216:219], v[112:115]
    ds_read_b128 v[52:55], v17 offset:15360
    v_add_u32 v28, s4, v28
    v_mfma_f32_16x16x32_bf16 v[112:115], v[56:59], a[208:211], v[112:115]
    s_waitcnt lgkmcnt(4)
    buffer_load_dwordx4 v19, s[44:47], s92 offen offset:1024 sc1 lds
    v_mfma_f32_16x16x32_bf16 v[112:115], v[32:35], a[224:227], v[112:115]
    ds_read_b128 v[56:59], v17 offset:18432
    v_mfma_f32_16x16x32_bf16 v[112:115], v[36:39], a[232:235], v[112:115]
    v_cmp_lt_u32 vcc, 31, v2
    s_nop 1
    v_cndmask_b32 v28, v28, v29, vcc
    v_mfma_f32_16x16x32_bf16 v[116:119], v[36:39], a[236:239], v[116:119]
    ds_read_b128 v[60:63], v17 offset:21504
    v_mfma_f32_16x16x32_bf16 v[116:119], v[32:35], a[228:231], v[116:119]
    s_waitcnt lgkmcnt(4)
    v_and_b32 v29, 3, v28
    v_mfma_f32_16x16x32_bf16 v[116:119], v[40:43], a[244:247], v[116:119]
    ds_read_b128 v[32:35], v17 offset:13312
    v_mfma_f32_16x16x32_bf16 v[116:119], v[44:47], a[252:255], v[116:119]
    v_lshrrev_b32 v28, 2, v28
    v_mfma_f32_16x16x32_bf16 v[112:115], v[44:47], a[248:251], v[112:115]
    ds_read_b128 v[36:39], v17 offset:16384
    v_mfma_f32_16x16x32_bf16 v[112:115], v[40:43], a[240:243], v[112:115]
    s_waitcnt lgkmcnt(4)
    v_lshlrev_b32 v28, 7, v28
    v_mfma_f32_16x16x32_bf16 v[120:123], v[48:51], v[156:159], 0
    ds_read_b128 v[40:43], v17 offset:19456
    v_mfma_f32_16x16x32_bf16 v[120:123], v[52:55], v[164:167], v[120:123]
    v_lshl_add_u32 v28, v29, 2, v28
    buffer_load_dwordx4 v20, s[44:47], s94 offen offset:2048 sc1 lds
    v_mfma_f32_16x16x32_bf16 v[124:127], v[52:55], v[168:171], 0
    ds_read_b128 v[44:47], v17 offset:22528
    v_mfma_f32_16x16x32_bf16 v[124:127], v[48:51], v[160:163], v[124:127]
    s_waitcnt lgkmcnt(4)
    v_add_u32 v28, 9023488, v28
    v_mfma_f32_16x16x32_bf16 v[124:127], v[56:59], v[176:179], v[124:127]
    ds_read_b128 v[48:51], v17 offset:14336
    v_mfma_f32_16x16x32_bf16 v[124:127], v[60:63], v[184:187], v[124:127]
    buffer_load_dword v29, v28, s[44:47], 0 offen offset:0 sc1
    v_mfma_f32_16x16x32_bf16 v[120:123], v[60:63], v[180:183], v[120:123]
    ds_read_b128 v[52:55], v17 offset:17408
    v_cvt_pk_bf16_f32 v76, v112, v113
    v_mfma_f32_16x16x32_bf16 v[120:123], v[56:59], v[172:175], v[120:123]
    s_waitcnt lgkmcnt(4)
    v_mfma_f32_16x16x32_bf16 v[120:123], v[32:35], v[188:191], v[120:123]
    ds_read_b128 v[56:59], v17 offset:20480
    v_cvt_pk_bf16_f32 v77, v114, v115
    v_mfma_f32_16x16x32_bf16 v[120:123], v[36:39], v[196:199], v[120:123]
    v_mfma_f32_16x16x32_bf16 v[124:127], v[36:39], v[200:203], v[124:127]
    ds_read_b128 v[60:63], v17 offset:23552
    v_cvt_pk_bf16_f32 v78, v116, v117
    v_mfma_f32_16x16x32_bf16 v[124:127], v[32:35], v[192:195], v[124:127]
    s_waitcnt vmcnt(17) lgkmcnt(4)
    s_barrier
    v_mfma_f32_16x16x32_bf16 v[124:127], v[40:43], v[208:211], v[124:127]
    s_add_u32 m0, s21, 36864
    ds_read_b128 v[32:35], v17 offset:24576
    v_mfma_f32_16x16x32_bf16 v[124:127], v[44:47], v[216:219], v[124:127]
    buffer_load_dwordx4 v18, s[44:47], s96 offen offset:0 sc1 lds
    v_cvt_pk_bf16_f32 v79, v118, v119
    v_mfma_f32_16x16x32_bf16 v[120:123], v[44:47], v[212:215], v[120:123]
    s_and_b32 s6, s23, 1
    ds_read_b128 v[36:39], v17 offset:27648
    v_mfma_f32_16x16x32_bf16 v[120:123], v[40:43], v[204:207], v[120:123]
    s_waitcnt lgkmcnt(4)
    buffer_load_dwordx4 v19, s[44:47], s98 offen offset:1024 sc1 lds
    v_bfi_b32 v76, s33, v253, v76
    v_mfma_f32_16x16x32_bf16 v[120:123], v[48:51], v[220:223], v[120:123]
    ds_read_b128 v[40:43], v17 offset:30720
    v_mfma_f32_16x16x32_bf16 v[120:123], v[52:55], v[228:231], v[120:123]
    buffer_load_dwordx4 v20, s[44:47], s100 offen offset:2048 sc1 lds
    v_mfma_f32_16x16x32_bf16 v[124:127], v[52:55], v[232:235], v[124:127]
    ds_read_b128 v[44:47], v17 offset:33792
    v_bfi_b32 v77, s33, v255, v77
    v_mfma_f32_16x16x32_bf16 v[124:127], v[48:51], v[224:227], v[124:127]
    s_waitcnt lgkmcnt(4)
    v_mfma_f32_16x16x32_bf16 v[124:127], v[56:59], v[240:243], v[124:127]
    ds_read_b128 v[48:51], v17 offset:25600
    v_bfi_b32 v78, s33, v23, v78
    v_mfma_f32_16x16x32_bf16 v[124:127], v[60:63], v[248:251], v[124:127]
    v_mfma_f32_16x16x32_bf16 v[120:123], v[60:63], v[244:247], v[120:123]
    ds_read_b128 v[52:55], v17 offset:28672
    v_bfi_b32 v79, s33, v0, v79
    v_mfma_f32_16x16x32_bf16 v[120:123], v[56:59], v[236:239], v[120:123]
    s_waitcnt lgkmcnt(4)
    v_mfma_f32_16x16x32_bf16 v[120:123], v[32:35], a[0:3], v[120:123]
    ds_read_b128 v[56:59], v17 offset:31744
    v_mfma_f32_16x16x32_bf16 v[120:123], v[36:39], a[8:11], v[120:123]
    v_mfma_f32_16x16x32_bf16 v[124:127], v[36:39], a[12:15], v[124:127]
    ds_read_b128 v[60:63], v17 offset:34816
    v_mfma_f32_16x16x32_bf16 v[124:127], v[32:35], a[4:7], v[124:127]
    s_waitcnt lgkmcnt(4)
    s_lshl_b32 s7, s6, 5
    v_mfma_f32_16x16x32_bf16 v[124:127], v[40:43], a[20:23], v[124:127]
    ds_read_b128 v[32:35], v17 offset:26624
    v_mfma_f32_16x16x32_bf16 v[124:127], v[44:47], a[28:31], v[124:127]
    v_mfma_f32_16x16x32_bf16 v[120:123], v[44:47], a[24:27], v[120:123]
    ds_read_b128 v[36:39], v17 offset:29696
    v_mfma_f32_16x16x32_bf16 v[120:123], v[40:43], a[16:19], v[120:123]
    s_waitcnt lgkmcnt(4)
    v_mfma_f32_16x16x32_bf16 v[120:123], v[48:51], a[32:35], v[120:123]
    ds_read_b128 v[40:43], v17 offset:32768
    v_mfma_f32_16x16x32_bf16 v[120:123], v[52:55], a[40:43], v[120:123]
    v_mfma_f32_16x16x32_bf16 v[124:127], v[52:55], a[44:47], v[124:127]
    ds_read_b128 v[44:47], v17 offset:35840
    v_mfma_f32_16x16x32_bf16 v[124:127], v[48:51], a[36:39], v[124:127]
    s_waitcnt vmcnt(10) lgkmcnt(4)
    s_barrier
    v_mfma_f32_16x16x32_bf16 v[124:127], v[56:59], a[52:55], v[124:127]
    s_add_u32 m0, s21, 49152
    ds_read_b128 v[48:51], v16 offset:0
    v_add_u32 v18, s73, v22
    v_mfma_f32_16x16x32_bf16 v[124:127], v[60:63], a[60:63], v[124:127]
    buffer_load_dwordx4 v18, s[44:47], s84 offen offset:0 sc1 lds
    v_mfma_f32_16x16x32_bf16 v[120:123], v[60:63], a[56:59], v[120:123]
    ds_read_b128 v[52:55], v16 offset:3072
    v_add_u32 v19, -1024, v18
    v_mfma_f32_16x16x32_bf16 v[120:123], v[56:59], a[48:51], v[120:123]
    s_waitcnt lgkmcnt(4)
    buffer_load_dwordx4 v19, s[44:47], s86 offen offset:1024 sc1 lds
    v_mfma_f32_16x16x32_bf16 v[120:123], v[32:35], a[64:67], v[120:123]
    ds_read_b128 v[56:59], v16 offset:6144
    v_add_u32 v20, -2048, v18
    v_mfma_f32_16x16x32_bf16 v[120:123], v[36:39], a[72:75], v[120:123]
    s_waitcnt vmcnt(5)
    buffer_load_dwordx4 v20, s[44:47], s88 offen offset:2048 sc1 lds
    v_add_u32 v31, s7, v252
    v_mfma_f32_16x16x32_bf16 v[124:127], v[36:39], a[76:79], v[124:127]
    ds_read_b128 v[60:63], v16 offset:9216
    v_mfma_f32_16x16x32_bf16 v[124:127], v[32:35], a[68:71], v[124:127]
    s_waitcnt lgkmcnt(4)
    v_cmp_ne_u32 vcc, s16, v29
    s_cbranch_vccnz L_rs_py
L_ok_py:
    v_mfma_f32_16x16x32_bf16 v[124:127], v[40:43], a[84:87], v[124:127]
    s_lshr_b32 m0, s20, 2
    ds_read_b128 v[32:35], v16 offset:1024
    v_mfma_f32_16x16x32_bf16 v[124:127], v[44:47], a[92:95], v[124:127]
    buffer_load_dwordx4 v155, s[44:47], s37 offen sc1 lds
    v_mfma_f32_16x16x32_bf16 v[120:123], v[44:47], a[88:91], v[120:123]
    s_add_u32 m0, m0, 4096
    ds_read_b128 v[36:39], v16 offset:4096
    v_mfma_f32_16x16x32_bf16 v[120:123], v[40:43], a[80:83], v[120:123]
    s_waitcnt lgkmcnt(4)
L_pl_S_2:
    s_cbranch_execz L_wret
    buffer_load_dwordx4 v155, s[44:47], s36 offen sc1 lds
    v_mfma_f32_16x16x32_bf16 v[120:123], v[48:51], a[96:99], v[120:123]
    s_add_u32 m0, m0, 4096
    ds_read_b128 v[40:43], v16 offset:7168
    s_add_u32 s14, s36, 65536
    v_mfma_f32_16x16x32_bf16 v[120:123], v[52:55], a[104:107], v[120:123]
    buffer_load_dwordx4 v155, s[44:47], s14 offen sc1 lds
    v_mfma_f32_16x16x32_bf16 v[124:127], v[52:55], a[108:111], v[124:127]
    ds_read_b128 v[44:47], v16 offset:10240
    v_mfma_f32_16x16x32_bf16 v[124:127], v[48:51], a[100:103], v[124:127]
    s_waitcnt lgkmcnt(4)
    v_mfma_f32_16x16x32_bf16 v[124:127], v[56:59], a[116:119], v[124:127]
    ds_read_b128 v[48:51], v16 offset:2048
    v_mfma_f32_16x16x32_bf16 v[124:127], v[60:63], a[124:127], v[124:127]
    v_mfma_f32_16x16x32_bf16 v[120:123], v[60:63], a[120:123], v[120:123]
    s_sub_u32 s7, s83, 14483456
    ds_read_b128 v[52:55], v16 offset:5120
    v_mfma_f32_16x16x32_bf16 v[120:123], v[56:59], a[112:115], v[120:123]
    s_waitcnt lgkmcnt(4)
    v_mfma_f32_16x16x32_bf16 v[120:123], v[32:35], a[192:195], v[120:123]
    ds_read_b128 v[56:59], v16 offset:8192
    v_mfma_f32_16x16x32_bf16 v[120:123], v[36:39], a[200:203], v[120:123]
    v_mfma_f32_16x16x32_bf16 v[124:127], v[36:39], a[204:207], v[124:127]
    ds_read_b128 v[60:63], v16 offset:11264
    v_mfma_f32_16x16x32_bf16 v[124:127], v[32:35], a[196:199], v[124:127]
    s_waitcnt lgkmcnt(4)
    s_barrier
    v_mfma_f32_16x16x32_bf16 v[124:127], v[40:43], a[212:215], v[124:127]
    s_add_u32 m0, s21, 61440
    ds_read_b128 v[32:35], v16 offset:12288
    v_mfma_f32_16x16x32_bf16 v[124:127], v[44:47], a[220:223], v[124:127]
    buffer_load_dwordx4 v18, s[44:47], s90 offen offset:0 sc1 lds
    v_mfma_f32_16x16x32_bf16 v[120:123], v[44:47], a[216:219], v[120:123]
    ds_read_b128 v[36:39], v16 offset:15360
    v_mfma_f32_16x16x32_bf16 v[120:123], v[40:43], a[208:211], v[120:123]
    s_waitcnt lgkmcnt(4)
    buffer_load_dwordx4 v19, s[44:47], s92 offen offset:1024 sc1 lds
    v_mfma_f32_16x16x32_bf16 v[120:123], v[48:51], a[224:227], v[120:123]
    ds_read_b128 v[40:43], v16 offset:18432
    v_mfma_f32_16x16x32_bf16 v[120:123], v[52:55], a[232:235], v[120:123]
    buffer_load_dwordx4 v20, s[44:47], s94 offen offset:2048 sc1 lds
    v_mfma_f32_16x16x32_bf16 v[124:127], v[52:55], a[236:239], v[124:127]
    ds_read_b128 v[44:47], v16 offset:21504
    v_mfma_f32_16x16x32_bf16 v[124:127], v[48:51], a[228:231], v[124:127]
    s_waitcnt lgkmcnt(4)
    s_xor_b32 s4, s7, 65536
    v_mfma_f32_16x16x32_bf16 v[124:127], v[56:59], a[244:247], v[124:127]
    ds_read_b128 v[48:51], v16 offset:13312
    v_mfma_f32_16x16x32_bf16 v[124:127], v[60:63], a[252:255], v[124:127]
    v_mfma_f32_16x16x32_bf16 v[120:123], v[60:63], a[248:251], v[120:123]
    ds_read_b128 v[52:55], v16 offset:16384
    v_mfma_f32_16x16x32_bf16 v[120:123], v[56:59], a[240:243], v[120:123]
    s_waitcnt lgkmcnt(4)
    v_mfma_f32_16x16x32_bf16 v[112:115], v[32:35], v[156:159], 0
    ds_read_b128 v[56:59], v16 offset:19456
    v_mfma_f32_16x16x32_bf16 v[112:115], v[36:39], v[164:167], v[112:115]
    v_mfma_f32_16x16x32_bf16 v[116:119], v[36:39], v[168:171], 0
    ds_read_b128 v[60:63], v16 offset:22528
    v_mfma_f32_16x16x32_bf16 v[116:119], v[32:35], v[160:163], v[116:119]
    s_waitcnt lgkmcnt(4)
    v_mfma_f32_16x16x32_bf16 v[116:119], v[40:43], v[176:179], v[116:119]
    ds_read_b128 v[32:35], v16 offset:14336
    v_mfma_f32_16x16x32_bf16 v[116:119], v[44:47], v[184:187], v[116:119]
    v_cvt_pk_bf16_f32 v120, v120, v121
    v_cvt_pk_bf16_f32 v121, v122, v123
    v_mfma_f32_16x16x32_bf16 v[112:115], v[44:47], v[180:183], v[112:115]
    ds_read_b128 v[36:39], v16 offset:17408
    v_cvt_pk_bf16_f32 v122, v124, v125
    v_mfma_f32_16x16x32_bf16 v[112:115], v[40:43], v[172:175], v[112:115]
    s_waitcnt lgkmcnt(4)
    v_cvt_pk_bf16_f32 v123, v126, v127
    v_bfi_b32 v120, s33, v253, v120
    v_mfma_f32_16x16x32_bf16 v[112:115], v[48:51], v[188:191], v[112:115]
    ds_read_b128 v[40:43], v16 offset:20480
    v_bfi_b32 v121, s33, v255, v121
    v_mfma_f32_16x16x32_bf16 v[112:115], v[52:55], v[196:199], v[112:115]
    s_add_u32 s4, s4, 14489600
    v_bfi_b32 v122, s33, v23, v122
    v_bfi_b32 v123, s33, v0, v123
    v_mfma_f32_16x16x32_bf16 v[116:119], v[52:55], v[200:203], v[116:119]
    ds_read_b128 v[44:47], v16 offset:23552
    v_mfma_f32_16x16x32_bf16 v[116:119], v[48:51], v[192:195], v[116:119]
    s_waitcnt lgkmcnt(4)
    s_barrier
    buffer_store_dwordx4 v[120:123], v21, s[44:47], s79 offen sc1
    v_mfma_f32_16x16x32_bf16 v[116:119], v[56:59], v[208:211], v[116:119]
    s_add_u32 m0, s21, 0
    ds_read_b128 v[48:51], v16 offset:24576
    v_mfma_f32_16x16x32_bf16 v[116:119], v[60:63], v[216:219], v[116:119]
    buffer_load_dwordx4 v18, s[44:47], s96 offen offset:0 sc1 lds
    v_mfma_f32_16x16x32_bf16 v[112:115], v[60:63], v[212:215], v[112:115]
    ds_read_b128 v[52:55], v16 offset:27648
    v_mfma_f32_16x16x32_bf16 v[112:115], v[56:59], v[204:207], v[112:115]
    s_waitcnt lgkmcnt(4)
    buffer_load_dwordx4 v19, s[44:47], s98 offen offset:1024 sc1 lds
    v_mfma_f32_16x16x32_bf16 v[112:115], v[32:35], v[220:223], v[112:115]
    ds_read_b128 v[56:59], v16 offset:30720
    v_mfma_f32_16x16x32_bf16 v[112:115], v[36:39], v[228:231], v[112:115]
    v_mfma_f32_16x16x32_bf16 v[116:119], v[36:39], v[232:235], v[116:119]
    ds_read_b128 v[60:63], v16 offset:33792
    v_mfma_f32_16x16x32_bf16 v[116:119], v[32:35], v[224:227], v[116:119]
    s_waitcnt lgkmcnt(4)
    buffer_store_dwordx4 v[76:79], v21, s[44:47], s78 offen sc1
    v_mfma_f32_16x16x32_bf16 v[116:119], v[40:43], v[240:243], v[116:119]
    ds_read_b128 v[32:35], v16 offset:25600
    v_mfma_f32_16x16x32_bf16 v[116:119], v[44:47], v[248:251], v[116:119]
    v_mfma_f32_16x16x32_bf16 v[112:115], v[44:47], v[244:247], v[112:115]
    s_xor_b32 s5, s7, 131072
    ds_read_b128 v[36:39], v16 offset:28672
    v_mfma_f32_16x16x32_bf16 v[112:115], v[40:43], v[236:239], v[112:115]
    s_waitcnt lgkmcnt(4)
    buffer_load_dwordx4 v20, s[44:47], s100 offen offset:2048 sc1 lds
    v_mfma_f32_16x16x32_bf16 v[112:115], v[48:51], a[0:3], v[112:115]
    ds_read_b128 v[40:43], v16 offset:31744
    v_mfma_f32_16x16x32_bf16 v[112:115], v[52:55], a[8:11], v[112:115]
    v_mfma_f32_16x16x32_bf16 v[116:119], v[52:55], a[12:15], v[116:119]
    ds_read_b128 v[44:47], v16 offset:34816
    v_mfma_f32_16x16x32_bf16 v[116:119], v[48:51], a[4:7], v[116:119]
    s_waitcnt lgkmcnt(4)
    v_mfma_f32_16x16x32_bf16 v[116:119], v[56:59], a[20:23], v[116:119]
    ds_read_b128 v[48:51], v16 offset:26624
    v_mfma_f32_16x16x32_bf16 v[116:119], v[60:63], a[28:31], v[116:119]
    v_mfma_f32_16x16x32_bf16 v[112:115], v[60:63], a[24:27], v[112:115]
    ds_read_b128 v[52:55], v16 offset:29696
    v_mfma_f32_16x16x32_bf16 v[112:115], v[56:59], a[16:19], v[112:115]
    s_waitcnt lgkmcnt(4)
    v_mfma_f32_16x16x32_bf16 v[112:115], v[32:35], a[32:35], v[112:115]
    ds_read_b128 v[56:59], v16 offset:32768
    v_mfma_f32_16x16x32_bf16 v[112:115], v[36:39], a[40:43], v[112:115]
    v_mfma_f32_16x16x32_bf16 v[116:119], v[36:39], a[44:47], v[116:119]
    ds_read_b128 v[60:63], v16 offset:35840
    v_mfma_f32_16x16x32_bf16 v[116:119], v[32:35], a[36:39], v[116:119]
    s_waitcnt vmcnt(8) lgkmcnt(4)
    s_barrier
    s_add_u32 s5, s5, 14489600
    v_mfma_f32_16x16x32_bf16 v[116:119], v[40:43], a[52:55], v[116:119]
    s_add_u32 m0, s21, 12288
    ds_read_b128 v[32:35], v17 offset:0
    v_add_u32 v18, s74, v22
    v_mfma_f32_16x16x32_bf16 v[116:119], v[44:47], a[60:63], v[116:119]
    buffer_load_dwordx4 v18, s[44:47], s84 offen offset:0 sc1 lds
    v_mfma_f32_16x16x32_bf16 v[112:115], v[44:47], a[56:59], v[112:115]
    ds_read_b128 v[36:39], v17 offset:3072
    v_add_u32 v19, -1024, v18
    v_mfma_f32_16x16x32_bf16 v[112:115], v[40:43], a[48:51], v[112:115]
    s_waitcnt lgkmcnt(4)
    buffer_load_dwordx4 v19, s[44:47], s86 offen offset:1024 sc1 lds
    v_mfma_f32_16x16x32_bf16 v[112:115], v[48:51], a[64:67], v[112:115]
    ds_read_b128 v[40:43], v17 offset:6144
    v_add_u32 v20, -2048, v18
    v_mfma_f32_16x16x32_bf16 v[112:115], v[52:55], a[72:75], v[112:115]
    buffer_load_dwordx4 v20, s[44:47], s88 offen offset:2048 sc1 lds
    v_mfma_f32_16x16x32_bf16 v[116:119], v[52:55], a[76:79], v[116:119]
    ds_read_b128 v[44:47], v17 offset:9216
    v_mfma_f32_16x16x32_bf16 v[116:119], v[48:51], a[68:71], v[116:119]
    s_waitcnt lgkmcnt(4)
    v_mfma_f32_16x16x32_bf16 v[116:119], v[56:59], a[84:87], v[116:119]
    ds_read_b128 v[48:51], v17 offset:1024
    v_mfma_f32_16x16x32_bf16 v[116:119], v[60:63], a[92:95], v[116:119]
    v_mfma_f32_16x16x32_bf16 v[112:115], v[60:63], a[88:91], v[112:115]
    ds_read_b128 v[52:55], v17 offset:4096
    v_mfma_f32_16x16x32_bf16 v[112:115], v[56:59], a[80:83], v[112:115]
    s_waitcnt lgkmcnt(4)
    v_mfma_f32_16x16x32_bf16 v[112:115], v[32:35], a[96:99], v[112:115]
    ds_read_b128 v[56:59], v17 offset:7168
    v_mfma_f32_16x16x32_bf16 v[112:115], v[36:39], a[104:107], v[112:115]
    s_xor_b32 s7, s7, 196608
    v_mfma_f32_16x16x32_bf16 v[116:119], v[36:39], a[108:111], v[116:119]
    ds_read_b128 v[60:63], v17 offset:10240
    v_mfma_f32_16x16x32_bf16 v[116:119], v[32:35], a[100:103], v[116:119]
    s_waitcnt lgkmcnt(4)
    v_mfma_f32_16x16x32_bf16 v[116:119], v[40:43], a[116:119], v[116:119]
    ds_read_b128 v[32:35], v17 offset:2048
    v_mfma_f32_16x16x32_bf16 v[116:119], v[44:47], a[124:127], v[116:119]
    v_mfma_f32_16x16x32_bf16 v[112:115], v[44:47], a[120:123], v[112:115]
    ds_read_b128 v[36:39], v17 offset:5120
    v_mfma_f32_16x16x32_bf16 v[112:115], v[40:43], a[112:115], v[112:115]
    s_waitcnt lgkmcnt(4)
    v_mfma_f32_16x16x32_bf16 v[112:115], v[48:51], a[192:195], v[112:115]
    ds_read_b128 v[40:43], v17 offset:8192
    v_mfma_f32_16x16x32_bf16 v[112:115], v[52:55], a[200:203], v[112:115]
    v_mfma_f32_16x16x32_bf16 v[116:119], v[52:55], a[204:207], v[116:119]
    ds_read_b128 v[44:47], v17 offset:11264
    v_mfma_f32_16x16x32_bf16 v[116:119], v[48:51], a[196:199], v[116:119]
    s_waitcnt lgkmcnt(4)
    s_barrier
    v_mfma_f32_16x16x32_bf16 v[116:119], v[56:59], a[212:215], v[116:119]
    s_add_u32 m0, s21, 24576
    ds_read_b128 v[48:51], v17 offset:12288
    v_mfma_f32_16x16x32_bf16 v[116:119], v[60:63], a[220:223], v[116:119]
    buffer_load_dwordx4 v18, s[44:47], s90 offen offset:0 sc1 lds
    v_mfma_f32_16x16x32_bf16 v[112:115], v[60:63], a[216:219], v[112:115]
    s_add_u32 s7, s7, 14489600
    ds_read_b128 v[52:55], v17 offset:15360
    v_mfma_f32_16x16x32_bf16 v[112:115], v[56:59], a[208:211], v[112:115]
    s_waitcnt lgkmcnt(4)
    v_mfma_f32_16x16x32_bf16 v[112:115], v[32:35], a[224:227], v[112:115]
    ds_read_b128 v[56:59], v17 offset:18432
    v_mfma_f32_16x16x32_bf16 v[112:115], v[36:39], a[232:235], v[112:115]
    v_lshlrev_b32 v152, 16, v152
    v_lshlrev_b32 v153, 16, v153
    v_mfma_f32_16x16x32_bf16 v[116:119], v[36:39], a[236:239], v[116:119]
    ds_read_b128 v[60:63], v17 offset:21504
    v_lshlrev_b32 v154, 16, v154
    v_mfma_f32_16x16x32_bf16 v[116:119], v[32:35], a[228:231], v[116:119]
    s_waitcnt lgkmcnt(4)
    v_mul_f32 v146, v146, v147
    v_mul_f32 v148, v148, v149
    v_mfma_f32_16x16x32_bf16 v[116:119], v[40:43], a[244:247], v[116:119]
    ds_read_b128 v[32:35], v17 offset:13312
    v_mul_f32 v150, v150, v151
    v_mfma_f32_16x16x32_bf16 v[116:119], v[44:47], a[252:255], v[116:119]
    s_mov_b32 s10, 0xbfb8aa3b
    v_permlane16_swap_b32 v8, v10
    v_mfma_f32_16x16x32_bf16 v[112:115], v[44:47], a[248:251], v[112:115]
    ds_read_b128 v[36:39], v17 offset:16384
    v_permlane16_swap_b32 v9, v11
    v_mfma_f32_16x16x32_bf16 v[112:115], v[40:43], a[240:243], v[112:115]
    s_waitcnt lgkmcnt(4)
    v_and_b32 v81, 0xffff0000, v8
    v_lshlrev_b32 v80, 16, v8
    buffer_load_dwordx4 v[132:135], v21, s[44:47], s4 offen sc1
    v_mfma_f32_16x16x32_bf16 v[120:123], v[48:51], v[156:159], 0
    ds_read_b128 v[40:43], v17 offset:19456
    v_and_b32 v83, 0xffff0000, v9
    v_mfma_f32_16x16x32_bf16 v[120:123], v[52:55], v[164:167], v[120:123]
    v_lshlrev_b32 v82, 16, v9
    v_and_b32 v89, 0xffff0000, v10
    v_mfma_f32_16x16x32_bf16 v[124:127], v[52:55], v[168:171], 0
    ds_read_b128 v[44:47], v17 offset:22528
    v_lshlrev_b32 v88, 16, v10
    buffer_load_dwordx4 v[136:139], v21, s[44:47], s5 offen sc1
    v_mfma_f32_16x16x32_bf16 v[124:127], v[48:51], v[160:163], v[124:127]
    s_waitcnt lgkmcnt(4)
    v_and_b32 v91, 0xffff0000, v11
    v_lshlrev_b32 v90, 16, v11
    v_mfma_f32_16x16x32_bf16 v[124:127], v[56:59], v[176:179], v[124:127]
    ds_read_b128 v[48:51], v17 offset:14336
    v_fma_f32 v96, v80, v147, -v146
    buffer_load_dwordx4 v[140:143], v21, s[44:47], s7 offen sc1
    v_mfma_f32_16x16x32_bf16 v[124:127], v[60:63], v[184:187], v[124:127]
    v_fma_f32 v97, v81, v147, -v146
    v_fma_f32 v98, v82, v147, -v146
    v_mfma_f32_16x16x32_bf16 v[120:123], v[60:63], v[180:183], v[120:123]
    ds_read_b128 v[52:55], v17 offset:17408
    v_cvt_pk_bf16_f32 v76, v112, v113
    v_mfma_f32_16x16x32_bf16 v[120:123], v[56:59], v[172:175], v[120:123]
    s_waitcnt lgkmcnt(4)
    v_fma_f32 v99, v83, v147, -v146
    v_fma_f32 v104, v88, v147, -v146
    v_mfma_f32_16x16x32_bf16 v[120:123], v[32:35], v[188:191], v[120:123]
    ds_read_b128 v[56:59], v17 offset:20480
    v_cvt_pk_bf16_f32 v77, v114, v115
    v_fma_f32 v105, v89, v147, -v146
    v_mfma_f32_16x16x32_bf16 v[120:123], v[36:39], v[196:199], v[120:123]
    buffer_load_dwordx4 v19, s[44:47], s92 offen offset:1024 sc1 lds
    v_fma_f32 v106, v90, v147, -v146
    v_mfma_f32_16x16x32_bf16 v[124:127], v[36:39], v[200:203], v[124:127]
    ds_read_b128 v[60:63], v17 offset:23552
    v_cvt_pk_bf16_f32 v78, v116, v117
    v_fma_f32 v107, v91, v147, -v146
    v_mfma_f32_16x16x32_bf16 v[124:127], v[32:35], v[192:195], v[124:127]
    s_waitcnt vmcnt(13) lgkmcnt(4)
    s_barrier
    v_permlane16_swap_b32 v12, v14
    v_mfma_f32_16x16x32_bf16 v[124:127], v[40:43], v[208:211], v[124:127]
    ds_read_b128 v[32:35], v17 offset:24576
    v_permlane16_swap_b32 v13, v15
    v_and_b32 v85, 0xffff0000, v12
    v_mfma_f32_16x16x32_bf16 v[124:127], v[44:47], v[216:219], v[124:127]
    buffer_load_dwordx4 v20, s[44:47], s94 offen offset:2048 sc1 lds
    v_cvt_pk_bf16_f32 v79, v118, v119
    v_lshlrev_b32 v84, 16, v12
    v_mfma_f32_16x16x32_bf16 v[120:123], v[44:47], v[212:215], v[120:123]
    s_add_u32 m0, s21, 36864
    ds_read_b128 v[36:39], v17 offset:27648
    v_and_b32 v87, 0xffff0000, v13
    v_lshlrev_b32 v86, 16, v13
    v_mfma_f32_16x16x32_bf16 v[120:123], v[40:43], v[204:207], v[120:123]
    s_waitcnt lgkmcnt(4)
    buffer_load_dwordx4 v18, s[44:47], s96 offen offset:0 sc1 lds
    v_bfi_b32 v76, s33, v253, v76
    v_and_b32 v93, 0xffff0000, v14
    v_mfma_f32_16x16x32_bf16 v[120:123], v[48:51], v[220:223], v[120:123]
    ds_read_b128 v[40:43], v17 offset:30720
    v_lshlrev_b32 v92, 16, v14
    v_and_b32 v95, 0xffff0000, v15
    v_mfma_f32_16x16x32_bf16 v[120:123], v[52:55], v[228:231], v[120:123]
    buffer_load_dwordx4 v19, s[44:47], s98 offen offset:1024 sc1 lds
    v_lshlrev_b32 v94, 16, v15
    v_fma_f32 v100, v84, v149, -v148
    v_mfma_f32_16x16x32_bf16 v[124:127], v[52:55], v[232:235], v[124:127]
    ds_read_b128 v[44:47], v17 offset:33792
    v_bfi_b32 v77, s33, v255, v77
    v_fma_f32 v101, v85, v149, -v148
    v_mfma_f32_16x16x32_bf16 v[124:127], v[48:51], v[224:227], v[124:127]
    s_waitcnt lgkmcnt(4)
    buffer_load_dwordx4 v20, s[44:47], s100 offen offset:2048 sc1 lds
    v_fma_f32 v102, v86, v149, -v148
    v_fma_f32 v103, v87, v149, -v148
    v_mfma_f32_16x16x32_bf16 v[124:127], v[56:59], v[240:243], v[124:127]
    ds_read_b128 v[48:51], v17 offset:25600
    v_bfi_b32 v78, s33, v23, v78
    v_fma_f32 v108, v92, v149, -v148
    v_mfma_f32_16x16x32_bf16 v[124:127], v[60:63], v[248:251], v[124:127]
    v_fma_f32 v109, v93, v149, -v148
    v_fma_f32 v110, v94, v149, -v148
    v_mfma_f32_16x16x32_bf16 v[120:123], v[60:63], v[244:247], v[120:123]
    ds_read_b128 v[52:55], v17 offset:28672
    v_bfi_b32 v79, s33, v0, v79
    v_fma_f32 v111, v95, v149, -v148
    v_mfma_f32_16x16x32_bf16 v[120:123], v[56:59], v[236:239], v[120:123]
    s_waitcnt lgkmcnt(4)
    ds_read_b64_tr_b16 v[64:65], v252 offset:4096
    ds_read_b64_tr_b16 v[66:67], v252 offset:4128
    ds_read_b64_tr_b16 v[68:69], v252 offset:8192
    v_mfma_f32_16x16x32_bf16 v[120:123], v[32:35], a[0:3], v[120:123]
    ds_read_b128 v[56:59], v17 offset:31744
    ds_read_b64_tr_b16 v[70:71], v252 offset:8224
    v_mfma_f32_16x16x32_bf16 v[120:123], v[36:39], a[8:11], v[120:123]
    s_waitcnt lgkmcnt(0)
    v_and_b32 v9, 0xffff0000, v64
    v_lshlrev_b32 v8, 16, v64
    v_and_b32 v11, 0xffff0000, v65
    v_lshlrev_b32 v10, 16, v65
    v_mfma_f32_16x16x32_bf16 v[124:127], v[36:39], a[12:15], v[124:127]
    ds_read_b128 v[60:63], v17 offset:34816
    v_mul_f32 v96, v96, v8
    v_mul_f32 v97, v97, v9
    v_mul_f32 v98, v98, v10
    v_mfma_f32_16x16x32_bf16 v[124:127], v[32:35], a[4:7], v[124:127]
    v_mul_f32 v99, v99, v11
    v_and_b32 v9, 0xffff0000, v66
    v_lshlrev_b32 v8, 16, v66
    v_and_b32 v11, 0xffff0000, v67
    v_mfma_f32_16x16x32_bf16 v[124:127], v[40:43], a[20:23], v[124:127]
    ds_read_b128 v[32:35], v17 offset:26624
    v_lshlrev_b32 v10, 16, v67
    v_mul_f32 v100, v100, v8
    v_mul_f32 v101, v101, v9
    v_mfma_f32_16x16x32_bf16 v[124:127], v[44:47], a[28:31], v[124:127]
    v_mul_f32 v102, v102, v10
    v_mul_f32 v103, v103, v11
    v_and_b32 v9, 0xffff0000, v68
    v_lshlrev_b32 v8, 16, v68
    v_mfma_f32_16x16x32_bf16 v[120:123], v[44:47], a[24:27], v[120:123]
    ds_read_b128 v[36:39], v17 offset:29696
    v_and_b32 v11, 0xffff0000, v69
    v_lshlrev_b32 v10, 16, v69
    v_mul_f32 v104, v104, v8
    v_mfma_f32_16x16x32_bf16 v[120:123], v[40:43], a[16:19], v[120:123]
    v_mul_f32 v105, v105, v9
    v_mul_f32 v106, v106, v10
    v_mul_f32 v107, v107, v11
    v_and_b32 v9, 0xffff0000, v70
    v_mfma_f32_16x16x32_bf16 v[120:123], v[48:51], a[32:35], v[120:123]
    ds_read_b128 v[40:43], v17 offset:32768
    v_lshlrev_b32 v8, 16, v70
    v_and_b32 v11, 0xffff0000, v71
    v_lshlrev_b32 v10, 16, v71
    v_mfma_f32_16x16x32_bf16 v[120:123], v[52:55], a[40:43], v[120:123]
    v_mul_f32 v108, v108, v8
    v_mul_f32 v109, v109, v9
    v_mul_f32 v110, v110, v10
    v_mul_f32 v111, v111, v11
    v_mfma_f32_16x16x32_bf16 v[124:127], v[52:55], a[44:47], v[124:127]
    ds_read_b128 v[44:47], v17 offset:35840
    v_mfma_f32_16x16x32_bf16 v[124:127], v[48:51], a[36:39], v[124:127]
    s_waitcnt vmcnt(12) lgkmcnt(4)
    s_barrier
    ds_read_b64_tr_b16 v[6:7], v31
    v_add_f32 v128, v128, v154
    v_mfma_f32_16x16x32_bf16 v[124:127], v[56:59], a[52:55], v[124:127]
    s_add_u32 m0, s21, 49152
    ds_read_b128 v[48:51], v16 offset:0
    v_add_u32 v18, s75, v22
    v_mfma_f32_16x16x32_bf16 v[124:127], v[60:63], a[60:63], v[124:127]
    buffer_load_dwordx4 v18, s[44:47], s84 offen offset:0 sc1 lds
    v_add_f32 v129, v129, v154
    v_mfma_f32_16x16x32_bf16 v[120:123], v[60:63], a[56:59], v[120:123]
    ds_read_b128 v[52:55], v16 offset:3072
    v_add_u32 v19, -1024, v18
    v_mfma_f32_16x16x32_bf16 v[120:123], v[56:59], a[48:51], v[120:123]
    s_waitcnt lgkmcnt(5)
    buffer_load_dwordx4 v19, s[44:47], s86 offen offset:1024 sc1 lds
    v_add_f32 v130, v130, v154
    v_mfma_f32_16x16x32_bf16 v[120:123], v[32:35], a[64:67], v[120:123]
    ds_read_b128 v[56:59], v16 offset:6144
    v_add_u32 v20, -2048, v18
    v_mfma_f32_16x16x32_bf16 v[120:123], v[36:39], a[72:75], v[120:123]
    buffer_load_dwordx4 v20, s[44:47], s88 offen offset:2048 sc1 lds
    v_add_f32 v131, v131, v154
    v_mfma_f32_16x16x32_bf16 v[124:127], v[36:39], a[76:79], v[124:127]
    s_waitcnt vmcnt(8)
    ds_read_b128 v[60:63], v16 offset:9216
    v_xor_b32 v132, v253, v132
    v_mfma_f32_16x16x32_bf16 v[124:127], v[32:35], a[68:71], v[124:127]
    s_waitcnt lgkmcnt(5)
    v_xor_b32 v133, v255, v133
    v_xor_b32 v134, v23, v134
    v_mfma_f32_16x16x32_bf16 v[124:127], v[40:43], a[84:87], v[124:127]
    ds_read_b128 v[32:35], v16 offset:1024
    v_xor_b32 v135, v0, v135
    v_mfma_f32_16x16x32_bf16 v[124:127], v[44:47], a[92:95], v[124:127]
    buffer_store_dwordx4 v[76:79], v21, s[44:47], s80 offen sc1
    v_mfma_f32_16x16x32_bf16 v[120:123], v[44:47], a[88:91], v[120:123]
    ds_read_b128 v[36:39], v16 offset:4096
    v_or3_b32 v1, v132, v133, v134
    v_mfma_f32_16x16x32_bf16 v[120:123], v[40:43], a[80:83], v[120:123]
    s_waitcnt lgkmcnt(4)
    v_xor_b32 v136, v253, v136
    v_mfma_f32_16x16x32_bf16 v[120:123], v[48:51], a[96:99], v[120:123]
    ds_read_b128 v[40:43], v16 offset:7168
    v_xor_b32 v137, v255, v137
    v_mfma_f32_16x16x32_bf16 v[120:123], v[52:55], a[104:107], v[120:123]
    v_or3_b32 v1, v135, v136, v1
    v_mfma_f32_16x16x32_bf16 v[124:127], v[52:55], a[108:111], v[124:127]
    ds_read_b128 v[44:47], v16 offset:10240
    v_xor_b32 v138, v23, v138
    v_mfma_f32_16x16x32_bf16 v[124:127], v[48:51], a[100:103], v[124:127]
    s_waitcnt lgkmcnt(4)
    v_mfma_f32_16x16x32_bf16 v[124:127], v[56:59], a[116:119], v[124:127]
    ds_read_b128 v[48:51], v16 offset:2048
    v_xor_b32 v139, v0, v139
    v_mfma_f32_16x16x32_bf16 v[124:127], v[60:63], a[124:127], v[124:127]
    v_or3_b32 v1, v137, v138, v1
    v_xor_b32 v140, v253, v140
    v_mfma_f32_16x16x32_bf16 v[120:123], v[60:63], a[120:123], v[120:123]
    ds_read_b128 v[52:55], v16 offset:5120
    v_xor_b32 v141, v255, v141
    v_mfma_f32_16x16x32_bf16 v[120:123], v[56:59], a[112:115], v[120:123]
    s_waitcnt lgkmcnt(4)
    v_or3_b32 v1, v139, v140, v1
    v_xor_b32 v142, v23, v142
    v_mfma_f32_16x16x32_bf16 v[120:123], v[32:35], a[192:195], v[120:123]
    ds_read_b128 v[56:59], v16 offset:8192
    v_xor_b32 v143, v0, v143
    v_mfma_f32_16x16x32_bf16 v[120:123], v[36:39], a[200:203], v[120:123]
    v_or3_b32 v1, v141, v142, v1
    v_or_b32 v1, v143, v1
    v_mfma_f32_16x16x32_bf16 v[124:127], v[36:39], a[204:207], v[124:127]
    ds_read_b128 v[60:63], v16 offset:11264
    v_and_b32 v1, s33, v1
    v_mfma_f32_16x16x32_bf16 v[124:127], v[32:35], a[196:199], v[124:127]
    s_waitcnt lgkmcnt(4)
    s_barrier
    v_cmp_ne_u32 vcc, 0, v1
    s_cbranch_vccnz L_rs_cl
L_ok_cl:
    v_mfma_f32_16x16x32_bf16 v[124:127], v[40:43], a[212:215], v[124:127]
    s_add_u32 m0, s21, 61440
    ds_read_b128 v[32:35], v16 offset:12288
    v_mfma_f32_16x16x32_bf16 v[124:127], v[44:47], a[220:223], v[124:127]
    buffer_load_dwordx4 v18, s[44:47], s90 offen offset:0 sc1 lds
    v_mfma_f32_16x16x32_bf16 v[120:123], v[44:47], a[216:219], v[120:123]
    ds_read_b128 v[36:39], v16 offset:15360
    v_mfma_f32_16x16x32_bf16 v[120:123], v[40:43], a[208:211], v[120:123]
    s_waitcnt lgkmcnt(4)
    buffer_load_dwordx4 v19, s[44:47], s92 offen offset:1024 sc1 lds
    v_mfma_f32_16x16x32_bf16 v[120:123], v[48:51], a[224:227], v[120:123]
    ds_read_b128 v[40:43], v16 offset:18432
    v_cndmask_b32 v132, v132, v134, s[26:27]
    v_mfma_f32_16x16x32_bf16 v[120:123], v[52:55], a[232:235], v[120:123]
    buffer_load_dwordx4 v20, s[44:47], s94 offen offset:2048 sc1 lds
    v_cndmask_b32 v133, v133, v135, s[26:27]
    v_mfma_f32_16x16x32_bf16 v[124:127], v[52:55], a[236:239], v[124:127]
    ds_read_b128 v[44:47], v16 offset:21504
    v_mfma_f32_16x16x32_bf16 v[124:127], v[48:51], a[228:231], v[124:127]
    s_waitcnt lgkmcnt(4)
    v_cndmask_b32 v136, v136, v138, s[26:27]
    v_mfma_f32_16x16x32_bf16 v[124:127], v[56:59], a[244:247], v[124:127]
    ds_read_b128 v[48:51], v16 offset:13312
    v_cndmask_b32 v137, v137, v139, s[26:27]
    v_mfma_f32_16x16x32_bf16 v[124:127], v[60:63], a[252:255], v[124:127]
    v_cndmask_b32 v140, v140, v142, s[26:27]
    v_mfma_f32_16x16x32_bf16 v[120:123], v[60:63], a[248:251], v[120:123]
    ds_read_b128 v[52:55], v16 offset:16384
    v_cndmask_b32 v141, v141, v143, s[26:27]
    v_mfma_f32_16x16x32_bf16 v[120:123], v[56:59], a[240:243], v[120:123]
    s_waitcnt lgkmcnt(4)
    v_mfma_f32_16x16x32_bf16 v[128:131], a[130:133], v[132:135], v[128:131]
    v_mfma_f32_16x16x32_bf16 v[112:115], v[32:35], v[156:159], 0
    ds_read_b128 v[56:59], v16 offset:19456
    v_mfma_f32_16x16x32_bf16 v[112:115], v[36:39], v[164:167], v[112:115]
    v_mfma_f32_16x16x32_bf16 v[128:131], a[130:133], v[136:139], v[128:131]
    v_mfma_f32_16x16x32_bf16 v[116:119], v[36:39], v[168:171], 0
    s_add_u32 s6, s83, 0
    ds_read_b128 v[60:63], v16 offset:22528
    buffer_load_dwordx4 v[64:67], v21, s[44:47], s6 offen offset:0 sc1
    v_mfma_f32_16x16x32_bf16 v[116:119], v[32:35], v[160:163], v[116:119]
    s_waitcnt lgkmcnt(4)
    v_mfma_f32_16x16x32_bf16 v[128:131], a[130:133], v[140:143], v[128:131]
    v_mfma_f32_16x16x32_bf16 v[116:119], v[40:43], v[176:179], v[116:119]
    ds_read_b128 v[32:35], v16 offset:14336
    v_and_b32 v133, 0xffff0000, v4
    v_mfma_f32_16x16x32_bf16 v[116:119], v[44:47], v[184:187], v[116:119]
    v_lshlrev_b32 v132, 16, v4
    v_and_b32 v135, 0xffff0000, v5
    v_mfma_f32_16x16x32_bf16 v[112:115], v[44:47], v[180:183], v[112:115]
    ds_read_b128 v[36:39], v16 offset:17408
    v_cvt_pk_bf16_f32 v120, v120, v121
    v_mfma_f32_16x16x32_bf16 v[112:115], v[40:43], v[172:175], v[112:115]
    s_waitcnt lgkmcnt(4)
    v_lshlrev_b32 v134, 16, v5
    v_fma_f32 v12, v132, v151, -v150
    buffer_load_dwordx4 v[68:71], v21, s[44:47], s6 offen offset:1024 sc1
    v_mfma_f32_16x16x32_bf16 v[112:115], v[48:51], v[188:191], v[112:115]
    ds_read_b128 v[40:43], v16 offset:20480
    v_cvt_pk_bf16_f32 v121, v122, v123
    v_mfma_f32_16x16x32_bf16 v[112:115], v[52:55], v[196:199], v[112:115]
    v_fma_f32 v13, v133, v151, -v150
    v_fma_f32 v14, v134, v151, -v150
    buffer_load_dwordx4 v[72:75], v21, s[44:47], s6 offen offset:2048 sc1
    v_mfma_f32_16x16x32_bf16 v[116:119], v[52:55], v[200:203], v[116:119]
    ds_read_b128 v[44:47], v16 offset:23552
    v_cvt_pk_bf16_f32 v122, v124, v125
    v_mfma_f32_16x16x32_bf16 v[116:119], v[48:51], v[192:195], v[116:119]
    s_waitcnt vmcnt(13) lgkmcnt(4)
    s_barrier
    v_fma_f32 v15, v135, v151, -v150
    v_mfma_f32_16x16x32_bf16 v[116:119], v[56:59], v[208:211], v[116:119]
    s_add_u32 m0, s21, 0
    ds_read_b128 v[48:51], v16 offset:24576
    v_and_b32 v9, 0xffff0000, v6
    v_mfma_f32_16x16x32_bf16 v[116:119], v[60:63], v[216:219], v[116:119]
    buffer_load_dwordx4 v18, s[44:47], s96 offen offset:0 sc1 lds
    v_cvt_pk_bf16_f32 v123, v126, v127
    v_mfma_f32_16x16x32_bf16 v[112:115], v[60:63], v[212:215], v[112:115]
    ds_read_b128 v[52:55], v16 offset:27648
    v_lshlrev_b32 v8, 16, v6
    v_mfma_f32_16x16x32_bf16 v[112:115], v[56:59], v[204:207], v[112:115]
    s_waitcnt lgkmcnt(4)
    buffer_load_dwordx4 v19, s[44:47], s98 offen offset:1024 sc1 lds
    v_bfi_b32 v120, s33, v253, v120
    v_mfma_f32_16x16x32_bf16 v[112:115], v[32:35], v[220:223], v[112:115]
    ds_read_b128 v[56:59], v16 offset:30720
    v_and_b32 v11, 0xffff0000, v7
    v_mfma_f32_16x16x32_bf16 v[112:115], v[36:39], v[228:231], v[112:115]
    v_lshlrev_b32 v10, 16, v7
    v_mul_f32 v12, v12, v8
    v_mfma_f32_16x16x32_bf16 v[116:119], v[36:39], v[232:235], v[116:119]
    ds_read_b128 v[60:63], v16 offset:33792
    v_bfi_b32 v121, s33, v255, v121
    v_mfma_f32_16x16x32_bf16 v[116:119], v[32:35], v[224:227], v[116:119]
    s_waitcnt lgkmcnt(4)
    v_mul_f32 v13, v13, v9
    v_mul_f32 v14, v14, v10
    v_mfma_f32_16x16x32_bf16 v[116:119], v[40:43], v[240:243], v[116:119]
    ds_read_b128 v[32:35], v16 offset:25600
    v_bfi_b32 v122, s33, v23, v122
    v_mfma_f32_16x16x32_bf16 v[116:119], v[44:47], v[248:251], v[116:119]
    v_mul_f32 v15, v15, v11
    v_mul_f32 v8, s10, v128
    v_mfma_f32_16x16x32_bf16 v[112:115], v[44:47], v[244:247], v[112:115]
    ds_read_b128 v[36:39], v16 offset:28672
    v_bfi_b32 v123, s33, v0, v123
    v_mfma_f32_16x16x32_bf16 v[112:115], v[40:43], v[236:239], v[112:115]
    s_waitcnt lgkmcnt(4)
    v_mul_f32 v9, s10, v129
    v_mul_f32 v10, s10, v130
    v_mfma_f32_16x16x32_bf16 v[112:115], v[48:51], a[0:3], v[112:115]
    ds_read_b128 v[40:43], v16 offset:31744
    v_mul_f32 v11, s10, v131
    v_mfma_f32_16x16x32_bf16 v[112:115], v[52:55], a[8:11], v[112:115]
    v_exp_f32 v8, v8
    v_mfma_f32_16x16x32_bf16 v[116:119], v[52:55], a[12:15], v[116:119]
    ds_read_b128 v[44:47], v16 offset:34816
    v_mfma_f32_16x16x32_bf16 v[116:119], v[48:51], a[4:7], v[116:119]
    s_waitcnt lgkmcnt(4)
    v_exp_f32 v9, v9
    v_mfma_f32_16x16x32_bf16 v[116:119], v[56:59], a[20:23], v[116:119]
    ds_read_b128 v[48:51], v16 offset:26624
    v_mfma_f32_16x16x32_bf16 v[116:119], v[60:63], a[28:31], v[116:119]
    v_exp_f32 v10, v10
    v_mfma_f32_16x16x32_bf16 v[112:115], v[60:63], a[24:27], v[112:115]
    ds_read_b128 v[52:55], v16 offset:29696
    v_mfma_f32_16x16x32_bf16 v[112:115], v[56:59], a[16:19], v[112:115]
    s_waitcnt lgkmcnt(4)
    v_exp_f32 v11, v11
    v_mfma_f32_16x16x32_bf16 v[112:115], v[32:35], a[32:35], v[112:115]
    ds_read_b128 v[56:59], v16 offset:32768
    v_mfma_f32_16x16x32_bf16 v[112:115], v[36:39], a[40:43], v[112:115]
    buffer_load_dwordx4 v20, s[44:47], s100 offen offset:2048 sc1 lds
L_pl_S_3:
    s_cbranch_execz L_wret
    v_mul_f32 v12, v12, v128
    v_mfma_f32_16x16x32_bf16 v[116:119], v[36:39], a[44:47], v[116:119]
    ds_read_b128 v[60:63], v16 offset:35840
    v_mul_f32 v13, v13, v129
    v_mfma_f32_16x16x32_bf16 v[116:119], v[32:35], a[36:39], v[116:119]
    s_waitcnt vmcnt(13) lgkmcnt(4)
    s_barrier
    v_mul_f32 v14, v14, v130
    v_mul_f32 v15, v15, v131
    v_mfma_f32_16x16x32_bf16 v[116:119], v[40:43], a[52:55], v[116:119]
    s_add_u32 m0, s21, 12288
    ds_read_b128 v[32:35], v17 offset:0
    v_add_u32 v18, s76, v22
    v_mfma_f32_16x16x32_bf16 v[116:119], v[44:47], a[60:63], v[116:119]
    buffer_load_dwordx4 v18, s[44:47], s84 offen offset:0 sc1 lds
    v_add_f32 v8, 1.0, v8
    v_mfma_f32_16x16x32_bf16 v[112:115], v[44:47], a[56:59], v[112:115]
    ds_read_b128 v[36:39], v17 offset:3072
    v_add_u32 v19, -1024, v18
    v_mfma_f32_16x16x32_bf16 v[112:115], v[40:43], a[48:51], v[112:115]
    s_waitcnt lgkmcnt(4)
    buffer_load_dwordx4 v19, s[44:47], s86 offen offset:1024 sc1 lds
    v_add_f32 v9, 1.0, v9
    v_mfma_f32_16x16x32_bf16 v[112:115], v[48:51], a[64:67], v[112:115]
    ds_read_b128 v[40:43], v17 offset:6144
    v_add_u32 v20, -2048, v18
    v_mfma_f32_16x16x32_bf16 v[112:115], v[52:55], a[72:75], v[112:115]
    buffer_load_dwordx4 v20, s[44:47], s88 offen offset:2048 sc1 lds
    v_add_f32 v10, 1.0, v10
    v_mfma_f32_16x16x32_bf16 v[116:119], v[52:55], a[76:79], v[116:119]
    ds_read_b128 v[44:47], v17 offset:9216
    v_add_f32 v11, 1.0, v11
    v_mfma_f32_16x16x32_bf16 v[116:119], v[48:51], a[68:71], v[116:119]
    s_waitcnt lgkmcnt(4)
    v_rcp_f32 v8, v8
    v_mfma_f32_16x16x32_bf16 v[116:119], v[56:59], a[84:87], v[116:119]
    ds_read_b128 v[48:51], v17 offset:1024
    v_rcp_f32 v9, v9
    v_mfma_f32_16x16x32_bf16 v[116:119], v[60:63], a[92:95], v[116:119]
    v_rcp_f32 v10, v10
    v_mfma_f32_16x16x32_bf16 v[112:115], v[60:63], a[88:91], v[112:115]
    ds_read_b128 v[52:55], v17 offset:4096
    v_rcp_f32 v11, v11
    v_mfma_f32_16x16x32_bf16 v[112:115], v[56:59], a[80:83], v[112:115]
    s_waitcnt lgkmcnt(4)
    v_fma_f32 v12, v12, v8, v132
    v_mfma_f32_16x16x32_bf16 v[112:115], v[32:35], a[96:99], v[112:115]
    ds_read_b128 v[56:59], v17 offset:7168
    v_fma_f32 v13, v13, v9, v133
    v_mfma_f32_16x16x32_bf16 v[112:115], v[36:39], a[104:107], v[112:115]
    buffer_store_dwordx4 v[120:123], v21, s[44:47], s81 offen sc1
    v_mfma_f32_16x16x32_bf16 v[116:119], v[36:39], a[108:111], v[116:119]
    ds_read_b128 v[60:63], v17 offset:10240
    v_fma_f32 v14, v14, v10, v134
    v_mfma_f32_16x16x32_bf16 v[116:119], v[32:35], a[100:103], v[116:119]
    s_waitcnt lgkmcnt(4)
    v_fma_f32 v15, v15, v11, v135
    v_cvt_pk_bf16_f32 v128, v12, v13
    v_mfma_f32_16x16x32_bf16 v[116:119], v[40:43], a[116:119], v[116:119]
    ds_read_b128 v[32:35], v17 offset:2048
    v_cvt_pk_bf16_f32 v129, v14, v15
    v_mfma_f32_16x16x32_bf16 v[116:119], v[44:47], a[124:127], v[116:119]
    buffer_store_dwordx2 v[128:129], v145, s[64:67], 0 offen sc1
    v_mfma_f32_16x16x32_bf16 v[112:115], v[44:47], a[120:123], v[112:115]
    ds_read_b128 v[36:39], v17 offset:5120
    v_mfma_f32_16x16x32_bf16 v[112:115], v[40:43], a[112:115], v[112:115]
    s_waitcnt lgkmcnt(4)
    v_mfma_f32_16x16x32_bf16 v[112:115], v[48:51], a[192:195], v[112:115]
    ds_read_b128 v[40:43], v17 offset:8192
    v_mfma_f32_16x16x32_bf16 v[112:115], v[52:55], a[200:203], v[112:115]
    v_mfma_f32_16x16x32_bf16 v[116:119], v[52:55], a[204:207], v[116:119]
    ds_read_b128 v[44:47], v17 offset:11264
    v_mfma_f32_16x16x32_bf16 v[116:119], v[48:51], a[196:199], v[116:119]
    s_waitcnt vmcnt(15) lgkmcnt(4)
    s_barrier
    v_mfma_f32_16x16x32_bf16 v[116:119], v[56:59], a[212:215], v[116:119]
    s_add_u32 m0, s21, 24576
    ds_read_b128 v[48:51], v17 offset:12288
    v_mfma_f32_16x16x32_bf16 v[116:119], v[60:63], a[220:223], v[116:119]
    buffer_load_dwordx4 v18, s[44:47], s90 offen offset:0 sc1 lds
    v_mfma_f32_16x16x32_bf16 v[112:115], v[60:63], a[216:219], v[112:115]
    ds_read_b128 v[52:55], v17 offset:15360
    v_mfma_f32_16x16x32_bf16 v[112:115], v[56:59], a[208:211], v[112:115]
    s_waitcnt lgkmcnt(4)
    buffer_load_dwordx4 v19, s[44:47], s92 offen offset:1024 sc1 lds
    v_mfma_f32_16x16x32_bf16 v[112:115], v[32:35], a[224:227], v[112:115]
    ds_read_b128 v[56:59], v17 offset:18432
    v_mfma_f32_16x16x32_bf16 v[112:115], v[36:39], a[232:235], v[112:115]
    buffer_load_dwordx4 v20, s[44:47], s94 offen offset:2048 sc1 lds
    v_mfma_f32_16x16x32_bf16 v[116:119], v[36:39], a[236:239], v[116:119]
    ds_read_b128 v[60:63], v17 offset:21504
    v_mfma_f32_16x16x32_bf16 v[116:119], v[32:35], a[228:231], v[116:119]
    s_waitcnt lgkmcnt(4)
    v_mfma_f32_16x16x32_bf16 v[116:119], v[40:43], a[244:247], v[116:119]
    ds_read_b128 v[32:35], v17 offset:13312
    v_mfma_f32_16x16x32_bf16 v[116:119], v[44:47], a[252:255], v[116:119]
    v_mfma_f32_16x16x32_bf16 v[112:115], v[44:47], a[248:251], v[112:115]
    ds_read_b128 v[36:39], v17 offset:16384
    v_mfma_f32_16x16x32_bf16 v[112:115], v[40:43], a[240:243], v[112:115]
    s_waitcnt lgkmcnt(4)
    v_mfma_f32_16x16x32_bf16 v[128:131], v[48:51], v[156:159], 0
    ds_read_b128 v[40:43], v17 offset:19456
    v_mfma_f32_16x16x32_bf16 v[128:131], v[52:55], v[164:167], v[128:131]
    v_mfma_f32_16x16x32_bf16 v[132:135], v[52:55], v[168:171], 0
    ds_read_b128 v[44:47], v17 offset:22528
    v_mfma_f32_16x16x32_bf16 v[132:135], v[48:51], v[160:163], v[132:135]
    s_waitcnt lgkmcnt(4)
    v_mfma_f32_16x16x32_bf16 v[132:135], v[56:59], v[176:179], v[132:135]
    ds_read_b128 v[48:51], v17 offset:14336
    v_mfma_f32_16x16x32_bf16 v[132:135], v[60:63], v[184:187], v[132:135]
    v_mfma_f32_16x16x32_bf16 v[128:131], v[60:63], v[180:183], v[128:131]
    ds_read_b128 v[52:55], v17 offset:17408
    v_cvt_pk_bf16_f32 v112, v112, v113
    v_mfma_f32_16x16x32_bf16 v[128:131], v[56:59], v[172:175], v[128:131]
    s_waitcnt lgkmcnt(4)
    v_mfma_f32_16x16x32_bf16 v[128:131], v[32:35], v[188:191], v[128:131]
    ds_read_b128 v[56:59], v17 offset:20480
    v_cvt_pk_bf16_f32 v113, v114, v115
    v_mfma_f32_16x16x32_bf16 v[128:131], v[36:39], v[196:199], v[128:131]
    v_mfma_f32_16x16x32_bf16 v[132:135], v[36:39], v[200:203], v[132:135]
    ds_read_b128 v[60:63], v17 offset:23552
    v_cvt_pk_bf16_f32 v114, v116, v117
    v_mfma_f32_16x16x32_bf16 v[132:135], v[32:35], v[192:195], v[132:135]
    s_waitcnt vmcnt(14) lgkmcnt(4)
    s_barrier
    v_mfma_f32_16x16x32_bf16 v[132:135], v[40:43], v[208:211], v[132:135]
    s_add_u32 m0, s21, 36864
    ds_read_b128 v[32:35], v17 offset:24576
    v_mfma_f32_16x16x32_bf16 v[132:135], v[44:47], v[216:219], v[132:135]
    buffer_load_dwordx4 v18, s[44:47], s96 offen offset:0 sc1 lds
    v_cvt_pk_bf16_f32 v115, v118, v119
    v_mfma_f32_16x16x32_bf16 v[128:131], v[44:47], v[212:215], v[128:131]
    ds_read_b128 v[36:39], v17 offset:27648
    v_mfma_f32_16x16x32_bf16 v[128:131], v[40:43], v[204:207], v[128:131]
    s_waitcnt lgkmcnt(4)
    buffer_load_dwordx4 v19, s[44:47], s98 offen offset:1024 sc1 lds
    v_bfi_b32 v112, s33, v253, v112
    v_mfma_f32_16x16x32_bf16 v[128:131], v[48:51], v[220:223], v[128:131]
    ds_read_b128 v[40:43], v17 offset:30720
    v_mfma_f32_16x16x32_bf16 v[128:131], v[52:55], v[228:231], v[128:131]
    buffer_load_dwordx4 v20, s[44:47], s100 offen offset:2048 sc1 lds
    v_mfma_f32_16x16x32_bf16 v[132:135], v[52:55], v[232:235], v[132:135]
    ds_read_b128 v[44:47], v17 offset:33792
    v_bfi_b32 v113, s33, v255, v113
    v_mfma_f32_16x16x32_bf16 v[132:135], v[48:51], v[224:227], v[132:135]
    s_waitcnt lgkmcnt(4)
    v_mfma_f32_16x16x32_bf16 v[132:135], v[56:59], v[240:243], v[132:135]
    ds_read_b128 v[48:51], v17 offset:25600
    v_bfi_b32 v114, s33, v23, v114
    v_mfma_f32_16x16x32_bf16 v[132:135], v[60:63], v[248:251], v[132:135]
    v_mfma_f32_16x16x32_bf16 v[128:131], v[60:63], v[244:247], v[128:131]
    ds_read_b128 v[52:55], v17 offset:28672
    v_bfi_b32 v115, s33, v0, v115
    v_mfma_f32_16x16x32_bf16 v[128:131], v[56:59], v[236:239], v[128:131]
    s_waitcnt lgkmcnt(4)
    v_mfma_f32_16x16x32_bf16 v[128:131], v[32:35], a[0:3], v[128:131]
    ds_read_b128 v[56:59], v17 offset:31744
    v_mfma_f32_16x16x32_bf16 v[128:131], v[36:39], a[8:11], v[128:131]
    v_mfma_f32_16x16x32_bf16 v[132:135], v[36:39], a[12:15], v[132:135]
    s_waitcnt vmcnt(14)
    ds_read_b128 v[60:63], v17 offset:34816
    v_mfma_f32_16x16x32_bf16 v[132:135], v[32:35], a[4:7], v[132:135]
    s_waitcnt lgkmcnt(4)
    v_xor_b32 v64, v253, v64
    v_mfma_f32_16x16x32_bf16 v[132:135], v[40:43], a[20:23], v[132:135]
    ds_read_b128 v[32:35], v17 offset:26624
    v_xor_b32 v65, v255, v65
    v_mfma_f32_16x16x32_bf16 v[132:135], v[44:47], a[28:31], v[132:135]
    v_xor_b32 v66, v23, v66
    v_mfma_f32_16x16x32_bf16 v[128:131], v[44:47], a[24:27], v[128:131]
    ds_read_b128 v[36:39], v17 offset:29696
    v_mfma_f32_16x16x32_bf16 v[128:131], v[40:43], a[16:19], v[128:131]
    s_waitcnt lgkmcnt(4)
    v_xor_b32 v67, v0, v67
    v_mfma_f32_16x16x32_bf16 v[128:131], v[48:51], a[32:35], v[128:131]
    ds_read_b128 v[40:43], v17 offset:32768
    v_or3_b32 v1, v64, v65, v66
    v_mfma_f32_16x16x32_bf16 v[128:131], v[52:55], a[40:43], v[128:131]
    v_xor_b32 v68, v253, v68
    v_mfma_f32_16x16x32_bf16 v[132:135], v[52:55], a[44:47], v[132:135]
    ds_read_b128 v[44:47], v17 offset:35840
    v_xor_b32 v69, v255, v69
    v_mfma_f32_16x16x32_bf16 v[132:135], v[48:51], a[36:39], v[132:135]
    s_waitcnt vmcnt(11) lgkmcnt(4)
    s_barrier
    v_or3_b32 v1, v67, v68, v1
    v_mfma_f32_16x16x32_bf16 v[132:135], v[56:59], a[52:55], v[132:135]
    ds_read_b128 v[48:51], v16 offset:0
    v_xor_b32 v70, v23, v70
    v_mfma_f32_16x16x32_bf16 v[132:135], v[60:63], a[60:63], v[132:135]
    v_xor_b32 v71, v0, v71
    v_or3_b32 v1, v69, v70, v1
    v_mfma_f32_16x16x32_bf16 v[128:131], v[60:63], a[56:59], v[128:131]
    ds_read_b128 v[52:55], v16 offset:3072
    v_xor_b32 v72, v253, v72
    v_mfma_f32_16x16x32_bf16 v[128:131], v[56:59], a[48:51], v[128:131]
    s_waitcnt lgkmcnt(4)
    v_xor_b32 v73, v255, v73
    v_or3_b32 v1, v71, v72, v1
    v_mfma_f32_16x16x32_bf16 v[128:131], v[32:35], a[64:67], v[128:131]
    ds_read_b128 v[56:59], v16 offset:6144
    v_xor_b32 v74, v23, v74
    v_mfma_f32_16x16x32_bf16 v[128:131], v[36:39], a[72:75], v[128:131]
    v_xor_b32 v75, v0, v75
    v_or3_b32 v1, v73, v74, v1
    v_mfma_f32_16x16x32_bf16 v[132:135], v[36:39], a[76:79], v[132:135]
    ds_read_b128 v[60:63], v16 offset:9216
    v_or_b32 v1, v75, v1
    v_mfma_f32_16x16x32_bf16 v[132:135], v[32:35], a[68:71], v[132:135]
    s_waitcnt lgkmcnt(4)
    buffer_store_dwordx4 v[112:115], v21, s[44:47], s82 offen sc1
    v_mfma_f32_16x16x32_bf16 v[132:135], v[40:43], a[84:87], v[132:135]
    ds_read_b128 v[32:35], v16 offset:1024
    v_and_b32 v1, s33, v1
    v_mfma_f32_16x16x32_bf16 v[132:135], v[44:47], a[92:95], v[132:135]
    v_cmp_ne_u32 vcc, 0, v1
    s_cbranch_vccnz L_rs_ol0
L_ok_ol0:
    v_mfma_f32_16x16x32_bf16 v[128:131], v[44:47], a[88:91], v[128:131]
    ds_read_b128 v[36:39], v16 offset:4096
    v_mfma_f32_16x16x32_bf16 v[128:131], v[40:43], a[80:83], v[128:131]
    s_waitcnt lgkmcnt(4)
    v_mfma_f32_16x16x32_bf16 v[128:131], a[130:133], v[64:67], v[128:131]
    v_mfma_f32_16x16x32_bf16 v[128:131], v[48:51], a[96:99], v[128:131]
    ds_read_b128 v[40:43], v16 offset:7168
    v_mfma_f32_16x16x32_bf16 v[128:131], v[52:55], a[104:107], v[128:131]
    v_mfma_f32_16x16x32_bf16 v[132:135], a[128:131], v[64:67], v[132:135]
    v_mfma_f32_16x16x32_bf16 v[132:135], v[52:55], a[108:111], v[132:135]
    ds_read_b128 v[44:47], v16 offset:10240
    v_mfma_f32_16x16x32_bf16 v[132:135], v[48:51], a[100:103], v[132:135]
    s_waitcnt lgkmcnt(4)
    v_mfma_f32_16x16x32_bf16 v[128:131], a[130:133], v[68:71], v[128:131]
    v_mfma_f32_16x16x32_bf16 v[132:135], v[56:59], a[116:119], v[132:135]
    ds_read_b128 v[48:51], v16 offset:2048
    v_mfma_f32_16x16x32_bf16 v[132:135], v[60:63], a[124:127], v[132:135]
    v_mfma_f32_16x16x32_bf16 v[132:135], a[128:131], v[68:71], v[132:135]
    v_mfma_f32_16x16x32_bf16 v[128:131], v[60:63], a[120:123], v[128:131]
    ds_read_b128 v[52:55], v16 offset:5120
    v_mfma_f32_16x16x32_bf16 v[128:131], a[130:133], v[72:75], v[128:131]
    v_mfma_f32_16x16x32_bf16 v[128:131], v[56:59], a[112:115], v[128:131]
    s_waitcnt lgkmcnt(4)
    v_mfma_f32_16x16x32_bf16 v[132:135], a[128:131], v[72:75], v[132:135]
    v_mfma_f32_16x16x32_bf16 v[128:131], v[32:35], a[192:195], v[128:131]
    ds_read_b128 v[56:59], v16 offset:8192
    v_mfma_f32_16x16x32_bf16 v[128:131], v[36:39], a[200:203], v[128:131]
    v_mfma_f32_16x16x32_bf16 v[132:135], v[36:39], a[204:207], v[132:135]
    ds_read_b128 v[60:63], v16 offset:11264
    v_mfma_f32_16x16x32_bf16 v[132:135], v[32:35], a[196:199], v[132:135]
    s_waitcnt vmcnt(9) lgkmcnt(4)
    s_barrier
    v_mfma_f32_16x16x32_bf16 v[132:135], v[40:43], a[212:215], v[132:135]
    ds_read_b128 v[32:35], v16 offset:12288
    v_mfma_f32_16x16x32_bf16 v[132:135], v[44:47], a[220:223], v[132:135]
    v_mfma_f32_16x16x32_bf16 v[128:131], v[44:47], a[216:219], v[128:131]
    ds_read_b128 v[36:39], v16 offset:15360
    v_mfma_f32_16x16x32_bf16 v[128:131], v[40:43], a[208:211], v[128:131]
    s_waitcnt lgkmcnt(4)
    v_mfma_f32_16x16x32_bf16 v[128:131], v[48:51], a[224:227], v[128:131]
    ds_read_b128 v[40:43], v16 offset:18432
    v_mfma_f32_16x16x32_bf16 v[128:131], v[52:55], a[232:235], v[128:131]
    v_mfma_f32_16x16x32_bf16 v[132:135], v[52:55], a[236:239], v[132:135]
    ds_read_b128 v[44:47], v16 offset:21504
    v_mfma_f32_16x16x32_bf16 v[132:135], v[48:51], a[228:231], v[132:135]
    s_waitcnt lgkmcnt(4)
    v_mfma_f32_16x16x32_bf16 v[132:135], v[56:59], a[244:247], v[132:135]
    ds_read_b128 v[48:51], v16 offset:13312
    v_mfma_f32_16x16x32_bf16 v[132:135], v[60:63], a[252:255], v[132:135]
    v_mfma_f32_16x16x32_bf16 v[128:131], v[60:63], a[248:251], v[128:131]
    ds_read_b128 v[52:55], v16 offset:16384
    v_mfma_f32_16x16x32_bf16 v[128:131], v[56:59], a[240:243], v[128:131]
    s_waitcnt lgkmcnt(4)
    v_mfma_f32_16x16x32_bf16 v[136:139], v[32:35], v[156:159], 0
    ds_read_b128 v[56:59], v16 offset:19456
    v_mfma_f32_16x16x32_bf16 v[136:139], v[36:39], v[164:167], v[136:139]
    s_add_u32 s6, s83, 3072
    v_mfma_f32_16x16x32_bf16 v[140:143], v[36:39], v[168:171], 0
    ds_read_b128 v[60:63], v16 offset:22528
    v_mfma_f32_16x16x32_bf16 v[140:143], v[32:35], v[160:163], v[140:143]
    s_waitcnt lgkmcnt(4)
    buffer_load_dwordx4 v[64:67], v21, s[44:47], s6 offen offset:0 sc1
    v_mfma_f32_16x16x32_bf16 v[140:143], v[40:43], v[176:179], v[140:143]
    ds_read_b128 v[32:35], v16 offset:14336
    v_mfma_f32_16x16x32_bf16 v[140:143], v[44:47], v[184:187], v[140:143]
    buffer_load_dwordx4 v[68:71], v21, s[44:47], s6 offen offset:1024 sc1
    v_mfma_f32_16x16x32_bf16 v[136:139], v[44:47], v[180:183], v[136:139]
    ds_read_b128 v[36:39], v16 offset:17408
    v_add_f32 v128, v128, v152
    v_mfma_f32_16x16x32_bf16 v[136:139], v[40:43], v[172:175], v[136:139]
    s_waitcnt lgkmcnt(4)
    buffer_load_dwordx4 v[72:75], v21, s[44:47], s6 offen offset:2048 sc1
    v_add_f32 v129, v129, v152
    v_mfma_f32_16x16x32_bf16 v[136:139], v[48:51], v[188:191], v[136:139]
    ds_read_b128 v[40:43], v16 offset:20480
    v_add_f32 v130, v130, v152
    v_mfma_f32_16x16x32_bf16 v[136:139], v[52:55], v[196:199], v[136:139]
    v_add_f32 v131, v131, v152
    v_mfma_f32_16x16x32_bf16 v[140:143], v[52:55], v[200:203], v[140:143]
    ds_read_b128 v[44:47], v16 offset:23552
    v_add_f32 v132, v132, v153
    v_mfma_f32_16x16x32_bf16 v[140:143], v[48:51], v[192:195], v[140:143]
    s_waitcnt vmcnt(7) lgkmcnt(4)
    s_barrier
    v_add_f32 v133, v133, v153
    v_mfma_f32_16x16x32_bf16 v[140:143], v[56:59], v[208:211], v[140:143]
    ds_read_b128 v[48:51], v16 offset:24576
    v_add_f32 v134, v134, v153
    v_mfma_f32_16x16x32_bf16 v[140:143], v[60:63], v[216:219], v[140:143]
    v_add_f32 v135, v135, v153
    v_mul_f32 v120, s10, v128
    v_mfma_f32_16x16x32_bf16 v[136:139], v[60:63], v[212:215], v[136:139]
    ds_read_b128 v[52:55], v16 offset:27648
    v_mul_f32 v121, s10, v129
    v_mfma_f32_16x16x32_bf16 v[136:139], v[56:59], v[204:207], v[136:139]
    s_waitcnt lgkmcnt(4)
    v_mul_f32 v122, s10, v130
    v_mul_f32 v123, s10, v131
    v_mfma_f32_16x16x32_bf16 v[136:139], v[32:35], v[220:223], v[136:139]
    ds_read_b128 v[56:59], v16 offset:30720
    v_mul_f32 v124, s10, v132
    v_mfma_f32_16x16x32_bf16 v[136:139], v[36:39], v[228:231], v[136:139]
    v_mul_f32 v125, s10, v133
    v_mul_f32 v126, s10, v134
    v_mfma_f32_16x16x32_bf16 v[140:143], v[36:39], v[232:235], v[140:143]
    ds_read_b128 v[60:63], v16 offset:33792
    v_mul_f32 v127, s10, v135
    v_mfma_f32_16x16x32_bf16 v[140:143], v[32:35], v[224:227], v[140:143]
    s_waitcnt lgkmcnt(4)
    v_exp_f32 v120, v120
    v_mfma_f32_16x16x32_bf16 v[140:143], v[40:43], v[240:243], v[140:143]
    ds_read_b128 v[32:35], v16 offset:25600
    v_mfma_f32_16x16x32_bf16 v[140:143], v[44:47], v[248:251], v[140:143]
    v_exp_f32 v121, v121
    v_mfma_f32_16x16x32_bf16 v[136:139], v[44:47], v[244:247], v[136:139]
    ds_read_b128 v[36:39], v16 offset:28672
    v_mfma_f32_16x16x32_bf16 v[136:139], v[40:43], v[236:239], v[136:139]
    s_waitcnt lgkmcnt(4)
    v_exp_f32 v122, v122
    v_mfma_f32_16x16x32_bf16 v[136:139], v[48:51], a[0:3], v[136:139]
    ds_read_b128 v[40:43], v16 offset:31744
    v_mfma_f32_16x16x32_bf16 v[136:139], v[52:55], a[8:11], v[136:139]
    v_exp_f32 v123, v123
    v_mfma_f32_16x16x32_bf16 v[140:143], v[52:55], a[12:15], v[140:143]
    ds_read_b128 v[44:47], v16 offset:34816
    v_mfma_f32_16x16x32_bf16 v[140:143], v[48:51], a[4:7], v[140:143]
    s_waitcnt lgkmcnt(4)
    v_exp_f32 v124, v124
    v_mfma_f32_16x16x32_bf16 v[140:143], v[56:59], a[20:23], v[140:143]
    ds_read_b128 v[48:51], v16 offset:26624
    v_mfma_f32_16x16x32_bf16 v[140:143], v[60:63], a[28:31], v[140:143]
    v_exp_f32 v125, v125
    v_mfma_f32_16x16x32_bf16 v[136:139], v[60:63], a[24:27], v[136:139]
    ds_read_b128 v[52:55], v16 offset:29696
    v_mfma_f32_16x16x32_bf16 v[136:139], v[56:59], a[16:19], v[136:139]
    s_waitcnt lgkmcnt(4)
    v_exp_f32 v126, v126
    v_mfma_f32_16x16x32_bf16 v[136:139], v[32:35], a[32:35], v[136:139]
    ds_read_b128 v[56:59], v16 offset:32768
    v_mfma_f32_16x16x32_bf16 v[136:139], v[36:39], a[40:43], v[136:139]
    v_exp_f32 v127, v127
    v_mfma_f32_16x16x32_bf16 v[140:143], v[36:39], a[44:47], v[140:143]
    ds_read_b128 v[60:63], v16 offset:35840
    v_mul_f32 v96, v96, v128
    v_mfma_f32_16x16x32_bf16 v[140:143], v[32:35], a[36:39], v[140:143]
    s_waitcnt vmcnt(4) lgkmcnt(4)
    s_barrier
    v_mul_f32 v97, v97, v129
    v_mul_f32 v98, v98, v130
    v_mfma_f32_16x16x32_bf16 v[140:143], v[40:43], a[52:55], v[140:143]
    ds_read_b128 v[32:35], v17 offset:0
    v_mul_f32 v99, v99, v131
    v_mfma_f32_16x16x32_bf16 v[140:143], v[44:47], a[60:63], v[140:143]
    v_mul_f32 v100, v100, v132
    v_mul_f32 v101, v101, v133
    v_mfma_f32_16x16x32_bf16 v[136:139], v[44:47], a[56:59], v[136:139]
    ds_read_b128 v[36:39], v17 offset:3072
    v_mul_f32 v102, v102, v134
    v_mfma_f32_16x16x32_bf16 v[136:139], v[40:43], a[48:51], v[136:139]
    s_waitcnt lgkmcnt(4)
    v_mul_f32 v103, v103, v135
    v_add_f32 v120, 1.0, v120
    v_mfma_f32_16x16x32_bf16 v[136:139], v[48:51], a[64:67], v[136:139]
    ds_read_b128 v[40:43], v17 offset:6144
    v_add_f32 v121, 1.0, v121
    v_mfma_f32_16x16x32_bf16 v[136:139], v[52:55], a[72:75], v[136:139]
    v_add_f32 v122, 1.0, v122
    v_add_f32 v123, 1.0, v123
    v_mfma_f32_16x16x32_bf16 v[140:143], v[52:55], a[76:79], v[140:143]
    ds_read_b128 v[44:47], v17 offset:9216
    v_add_f32 v124, 1.0, v124
    v_mfma_f32_16x16x32_bf16 v[140:143], v[48:51], a[68:71], v[140:143]
    s_waitcnt lgkmcnt(4)
    v_add_f32 v125, 1.0, v125
    v_add_f32 v126, 1.0, v126
    v_mfma_f32_16x16x32_bf16 v[140:143], v[56:59], a[84:87], v[140:143]
    ds_read_b128 v[48:51], v17 offset:1024
    v_add_f32 v127, 1.0, v127
    v_mfma_f32_16x16x32_bf16 v[140:143], v[60:63], a[92:95], v[140:143]
    v_rcp_f32 v120, v120
    v_mfma_f32_16x16x32_bf16 v[136:139], v[60:63], a[88:91], v[136:139]
    ds_read_b128 v[52:55], v17 offset:4096
    v_mfma_f32_16x16x32_bf16 v[136:139], v[56:59], a[80:83], v[136:139]
    s_waitcnt lgkmcnt(4)
    v_rcp_f32 v121, v121
    v_mfma_f32_16x16x32_bf16 v[136:139], v[32:35], a[96:99], v[136:139]
    ds_read_b128 v[56:59], v17 offset:7168
    v_mfma_f32_16x16x32_bf16 v[136:139], v[36:39], a[104:107], v[136:139]
    v_rcp_f32 v122, v122
    v_mfma_f32_16x16x32_bf16 v[140:143], v[36:39], a[108:111], v[140:143]
    ds_read_b128 v[60:63], v17 offset:10240
    v_mfma_f32_16x16x32_bf16 v[140:143], v[32:35], a[100:103], v[140:143]
    s_waitcnt lgkmcnt(4)
    v_rcp_f32 v123, v123
    v_mfma_f32_16x16x32_bf16 v[140:143], v[40:43], a[116:119], v[140:143]
    ds_read_b128 v[32:35], v17 offset:2048
    v_mfma_f32_16x16x32_bf16 v[140:143], v[44:47], a[124:127], v[140:143]
    v_rcp_f32 v124, v124
    v_mfma_f32_16x16x32_bf16 v[136:139], v[44:47], a[120:123], v[136:139]
    ds_read_b128 v[36:39], v17 offset:5120
    v_mfma_f32_16x16x32_bf16 v[136:139], v[40:43], a[112:115], v[136:139]
    s_waitcnt lgkmcnt(4)
    v_rcp_f32 v125, v125
    v_mfma_f32_16x16x32_bf16 v[136:139], v[48:51], a[192:195], v[136:139]
    ds_read_b128 v[40:43], v17 offset:8192
    v_mfma_f32_16x16x32_bf16 v[136:139], v[52:55], a[200:203], v[136:139]
    v_rcp_f32 v126, v126
    v_mfma_f32_16x16x32_bf16 v[140:143], v[52:55], a[204:207], v[140:143]
    ds_read_b128 v[44:47], v17 offset:11264
    v_mfma_f32_16x16x32_bf16 v[140:143], v[48:51], a[196:199], v[140:143]
    s_waitcnt lgkmcnt(4)
    v_rcp_f32 v127, v127
    v_mfma_f32_16x16x32_bf16 v[140:143], v[56:59], a[212:215], v[140:143]
    v_fma_f32 v96, v96, v120, v80
    v_fma_f32 v97, v97, v121, v81
    v_mfma_f32_16x16x32_bf16 v[140:143], v[60:63], a[220:223], v[140:143]
    v_fma_f32 v98, v98, v122, v82
    v_fma_f32 v99, v99, v123, v83
    v_mfma_f32_16x16x32_bf16 v[136:139], v[60:63], a[216:219], v[136:139]
    v_fma_f32 v100, v100, v124, v84
    v_fma_f32 v101, v101, v125, v85
    v_mfma_f32_16x16x32_bf16 v[136:139], v[56:59], a[208:211], v[136:139]
    s_waitcnt lgkmcnt(2)
    v_fma_f32 v102, v102, v126, v86
    v_fma_f32 v103, v103, v127, v87
    v_mfma_f32_16x16x32_bf16 v[136:139], v[32:35], a[224:227], v[136:139]
    v_cvt_pk_bf16_f32 v80, v96, v97
    v_mfma_f32_16x16x32_bf16 v[136:139], v[36:39], a[232:235], v[136:139]
    v_cvt_pk_bf16_f32 v81, v98, v99
    v_mfma_f32_16x16x32_bf16 v[140:143], v[36:39], a[236:239], v[140:143]
    v_cvt_pk_bf16_f32 v84, v100, v101
    v_mfma_f32_16x16x32_bf16 v[140:143], v[32:35], a[228:231], v[140:143]
    s_waitcnt lgkmcnt(0)
    v_cvt_pk_bf16_f32 v85, v102, v103
    v_mfma_f32_16x16x32_bf16 v[140:143], v[40:43], a[244:247], v[140:143]
    v_mfma_f32_16x16x32_bf16 v[140:143], v[44:47], a[252:255], v[140:143]
    v_mfma_f32_16x16x32_bf16 v[136:139], v[44:47], a[248:251], v[136:139]
    v_mfma_f32_16x16x32_bf16 v[136:139], v[40:43], a[240:243], v[136:139]
    s_waitcnt vmcnt(0)
    v_xor_b32 v64, v253, v64
    v_xor_b32 v65, v255, v65
    v_xor_b32 v66, v23, v66
    v_xor_b32 v67, v0, v67
    v_or3_b32 v1, v64, v65, v66
    v_xor_b32 v68, v253, v68
    v_xor_b32 v69, v255, v69
    v_or3_b32 v1, v67, v68, v1
    v_xor_b32 v70, v23, v70
    v_xor_b32 v71, v0, v71
    v_or3_b32 v1, v69, v70, v1
    v_xor_b32 v72, v253, v72
    v_xor_b32 v73, v255, v73
    v_or3_b32 v1, v71, v72, v1
    v_xor_b32 v74, v23, v74
    v_xor_b32 v75, v0, v75
    v_or3_b32 v1, v73, v74, v1
    v_or_b32 v1, v75, v1
    v_and_b32 v1, s33, v1
    v_cmp_ne_u32 vcc, 0, v1
    s_cbranch_vccnz L_rs_ol1
L_ok_ol1:
    v_mfma_f32_16x16x32_bf16 v[136:139], a[130:133], v[64:67], v[136:139]
    v_mfma_f32_16x16x32_bf16 v[140:143], a[128:131], v[64:67], v[140:143]
    v_mfma_f32_16x16x32_bf16 v[136:139], a[130:133], v[68:71], v[136:139]
    v_mfma_f32_16x16x32_bf16 v[140:143], a[128:131], v[68:71], v[140:143]
    v_mfma_f32_16x16x32_bf16 v[136:139], a[130:133], v[72:75], v[136:139]
    v_mfma_f32_16x16x32_bf16 v[140:143], a[128:131], v[72:75], v[140:143]
    s_nop 6
    v_add_f32 v136, v136, v152
    v_add_f32 v137, v137, v152
    v_add_f32 v138, v138, v152
    v_add_f32 v139, v139, v152
    v_add_f32 v140, v140, v153
    v_add_f32 v141, v141, v153
    v_add_f32 v142, v142, v153
    v_add_f32 v143, v143, v153
    v_mul_f32 v112, s10, v136
    v_mul_f32 v113, s10, v137
    v_mul_f32 v114, s10, v138
    v_mul_f32 v115, s10, v139
    v_mul_f32 v116, s10, v140
    v_mul_f32 v117, s10, v141
    v_mul_f32 v118, s10, v142
    v_mul_f32 v119, s10, v143
    v_exp_f32 v112, v112
    v_exp_f32 v113, v113
    v_exp_f32 v114, v114
    v_exp_f32 v115, v115
    v_exp_f32 v116, v116
    v_exp_f32 v117, v117
    v_exp_f32 v118, v118
    v_exp_f32 v119, v119
    v_mul_f32 v104, v104, v136
    v_mul_f32 v105, v105, v137
    v_mul_f32 v106, v106, v138
    v_mul_f32 v107, v107, v139
    v_mul_f32 v108, v108, v140
    v_mul_f32 v109, v109, v141
    v_mul_f32 v110, v110, v142
    v_mul_f32 v111, v111, v143
    v_add_f32 v112, 1.0, v112
    v_add_f32 v113, 1.0, v113
    v_add_f32 v114, 1.0, v114
    v_add_f32 v115, 1.0, v115
    v_add_f32 v116, 1.0, v116
    v_add_f32 v117, 1.0, v117
    v_add_f32 v118, 1.0, v118
    v_add_f32 v119, 1.0, v119
    v_rcp_f32 v112, v112
    v_rcp_f32 v113, v113
    v_rcp_f32 v114, v114
    v_rcp_f32 v115, v115
    v_rcp_f32 v116, v116
    v_rcp_f32 v117, v117
    v_rcp_f32 v118, v118
    v_rcp_f32 v119, v119
    v_fma_f32 v104, v104, v112, v88
    v_fma_f32 v105, v105, v113, v89
    v_fma_f32 v106, v106, v114, v90
    v_fma_f32 v107, v107, v115, v91
    v_fma_f32 v108, v108, v116, v92
    v_fma_f32 v109, v109, v117, v93
    v_fma_f32 v110, v110, v118, v94
    v_fma_f32 v111, v111, v119, v95
    v_cvt_pk_bf16_f32 v82, v104, v105
    v_cvt_pk_bf16_f32 v83, v106, v107
    v_cvt_pk_bf16_f32 v86, v108, v109
    v_cvt_pk_bf16_f32 v87, v110, v111
    v_permlane16_swap_b32 v80, v82
    v_permlane16_swap_b32 v81, v83
    buffer_store_dwordx4 v[80:83], v144, s[64:67], 0 offen sc1
    v_permlane16_swap_b32 v84, v86
    v_permlane16_swap_b32 v85, v87
    buffer_store_dwordx4 v[84:87], v144, s[64:67], s12 offen sc1
    s_endpgm
L_segE:
.p2align 12
L_aux:
    s_mul_i32 s7, s5, 5
    s_add_u32 s7, s7, s6
    s_sub_u32 s7, s7, 27
    s_mul_i32 s7, s7, 52429
    s_lshr_b32 s72, s7, 13
    s_mul_i32 s7, s72, 9216
    s_lshl_b32 s8, s3, 10
    s_add_u32 s7, s7, s8
    v_add_u32 v228, s7, v21
    v_subrev_u32 v227, 3456, v228
    buffer_load_dwordx2 v[138:139], v219, s[60:63], 0 offen
    buffer_load_dwordx2 v[140:141], v219, s[60:63], 0 offen offset:2048
    v_lshlrev_b32 v1, 3, v2
    buffer_load_dwordx2 v[142:143], v1, s[60:63], s10 offen
    s_lshr_b32 s69, s20, 2
    s_add_u32 m0, s69, 0
    s_nop 0
    buffer_load_dwordx4 v227, s[48:51], 0 offen lds
    s_add_u32 m0, s69, 4096
    v_add_u32 v227, 4096, v227
    buffer_load_dwordx4 v227, s[48:51], 0 offen lds
    s_add_u32 m0, s69, 69632
    s_nop 0
    buffer_load_dwordx4 v228, s[52:55], 0 offen lds
    s_add_u32 m0, s69, 8192
    v_add_u32 v227, 4096, v227
    buffer_load_dwordx4 v227, s[48:51], 0 offen lds
    s_add_u32 m0, s69, 73728
    v_add_u32 v228, 4096, v228
    buffer_load_dwordx4 v228, s[52:55], 0 offen lds
    s_add_u32 m0, s69, 12288
    v_add_u32 v227, 4096, v227
    buffer_load_dwordx4 v227, s[48:51], 0 offen lds
    s_add_u32 m0, s69, 77824
    v_add_u32 v228, 4096, v228
    buffer_load_dwordx4 v228, s[52:55], 0 offen lds
    s_mul_i32 s7, s5, 72
    s_lshl3_add_u32 s7, s6, s7
    s_sub_u32 s19, s7, 184
    s_mul_i32 s18, s3, 8320
    s_add_u32 s18, s18, 45120
    s_add_u32 s30, s19, s3
    v_lshrrev_b32 v3, 5, v0
    v_and_b32 v1, 31, v0
    v_mul_u32_u24 v220, 1216, v3
    v_mad_u32_u24 v220, v1, 12, v220
    v_add_u32 v220, 152960, v220
    v_lshlrev_b32 v3, 3, v3
    v_cmp_eq_u32 vcc, 0, v1
    v_mov_b32 v31, 0x40000000
    s_nop 0
    v_cndmask_b32 v216, v31, v3, vcc
    v_lshrrev_b32 v31, 4, v0
    v_and_b32 v1, 3, v2
    v_lshlrev_b32 v1, 3, v1
    v_lshl_add_u32 v1, v31, 5, v1
    v_bfe_u32 v3, v2, 2, 2
    v_mul_u32_u24 v221, 1216, v3
    v_mul_u32_u24 v222, 1152, v3
    s_mov_b32 s9, 152960
    s_mov_b32 s8, 0
    v_add3_u32 v221, v221, v1, s9
    v_add3_u32 v222, v222, v1, s8
    v_and_b32 v223, 15, v0
    v_lshlrev_b32 v223, 4, v223
    v_add_u32 v1, 0, v31
    v_mul_u32_u24 v3, 43, v1
    v_lshrrev_b32 v3, 7, v3
    v_mad_i32_i24 v224, v3, -3, v1
    v_min_u32 v224, 1, v224
    v_add3_u32 v1, v1, v3, v224
    v_lshl_add_u32 v212, v1, 8, v223
    v_add_u32 v1, 16, v31
    v_mul_u32_u24 v3, 43, v1
    v_lshrrev_b32 v3, 7, v3
    v_mad_i32_i24 v224, v3, -3, v1
    v_min_u32 v224, 1, v224
    v_add3_u32 v1, v1, v3, v224
    v_lshl_add_u32 v213, v1, 8, v223
    v_add_u32 v1, 32, v31
    v_mul_u32_u24 v3, 43, v1
    v_lshrrev_b32 v3, 7, v3
    v_mad_i32_i24 v224, v3, -3, v1
    v_min_u32 v224, 1, v224
    v_add3_u32 v1, v1, v3, v224
    v_lshl_add_u32 v214, v1, 8, v223
    s_mul_i32 s4, s17, 12288
    s_add_u32 s6, s4, 4096
    s_add_u32 s7, s4, 3211264
    s_cmp_eq_u32 s3, 0
    s_cselect_b32 s8, s6, 0x40000000
    s_cselect_b32 s9, s7, 0x40000000
    s_lshl_b32 s5, s17, 6
    s_add_u32 s5, s5, 8716288
    v_mov_b32 v225, 0
    s_lshr_b32 s12, s17, 2
    s_lshl_b32 s12, s12, 7
    s_and_b32 s4, s17, 3
    s_lshl2_add_u32 s12, s4, s12
    s_add_u32 s12, s12, 8863744
    s_waitcnt vmcnt(11)
    v_and_b32 v77, 0xffff0000, v64
    v_lshlrev_b32 v76, 16, v64
    v_and_b32 v79, 0xffff0000, v65
    v_lshlrev_b32 v78, 16, v65
    v_and_b32 v81, 0xffff0000, v66
    v_lshlrev_b32 v80, 16, v66
    v_and_b32 v83, 0xffff0000, v68
    v_lshlrev_b32 v82, 16, v68
    v_and_b32 v85, 0xffff0000, v69
    v_lshlrev_b32 v84, 16, v69
    v_and_b32 v87, 0xffff0000, v70
    v_lshlrev_b32 v86, 16, v70
    v_and_b32 v89, 0xffff0000, v72
    v_lshlrev_b32 v88, 16, v72
    v_and_b32 v91, 0xffff0000, v73
    v_lshlrev_b32 v90, 16, v73
    v_and_b32 v93, 0xffff0000, v74
    v_lshlrev_b32 v92, 16, v74
    v_pk_add_f32 v[94:95], v[76:77], v[78:79]
    v_pk_add_f32 v[96:97], v[80:81], v[82:83]
    v_pk_add_f32 v[98:99], v[84:85], v[86:87]
    v_pk_add_f32 v[100:101], v[88:89], v[90:91]
    v_pk_add_f32 v[94:95], v[94:95], v[96:97]
    v_pk_add_f32 v[98:99], v[98:99], v[100:101]
    v_pk_add_f32 v[94:95], v[94:95], v[92:93]
    v_pk_add_f32 v[94:95], v[94:95], v[98:99]
    v_add_f32 v102, v94, v95
    s_nop 1
    v_add_f32_dpp v102, v102, v102 row_ror:8 row_mask:0xf bank_mask:0xf
    s_nop 1
    v_add_f32_dpp v102, v102, v102 row_ror:4 row_mask:0xf bank_mask:0xf
    s_nop 1
    v_add_f32_dpp v102, v102, v102 row_ror:2 row_mask:0xf bank_mask:0xf
    s_nop 1
    v_add_f32_dpp v102, v102, v102 row_ror:1 row_mask:0xf bank_mask:0xf
    v_mov_b32 v103, v102
    s_nop 1
    v_permlane16_swap_b32 v102, v103
    v_add_f32 v102, v102, v103
    v_mul_f32 v102, 0x3ae38e39, v102
    v_pk_add_f32 v[76:77], v[76:77], v[102:103] op_sel_hi:[1,0] neg_lo:[0,1] neg_hi:[0,1]
    v_pk_add_f32 v[78:79], v[78:79], v[102:103] op_sel_hi:[1,0] neg_lo:[0,1] neg_hi:[0,1]
    v_pk_add_f32 v[80:81], v[80:81], v[102:103] op_sel_hi:[1,0] neg_lo:[0,1] neg_hi:[0,1]
    v_pk_add_f32 v[82:83], v[82:83], v[102:103] op_sel_hi:[1,0] neg_lo:[0,1] neg_hi:[0,1]
    v_pk_add_f32 v[84:85], v[84:85], v[102:103] op_sel_hi:[1,0] neg_lo:[0,1] neg_hi:[0,1]
    v_pk_add_f32 v[86:87], v[86:87], v[102:103] op_sel_hi:[1,0] neg_lo:[0,1] neg_hi:[0,1]
    v_pk_add_f32 v[88:89], v[88:89], v[102:103] op_sel_hi:[1,0] neg_lo:[0,1] neg_hi:[0,1]
    v_pk_add_f32 v[90:91], v[90:91], v[102:103] op_sel_hi:[1,0] neg_lo:[0,1] neg_hi:[0,1]
    v_pk_add_f32 v[92:93], v[92:93], v[102:103] op_sel_hi:[1,0] neg_lo:[0,1] neg_hi:[0,1]
    v_pk_mul_f32 v[94:95], v[76:77], v[76:77]
    v_pk_mul_f32 v[96:97], v[78:79], v[78:79]
    v_pk_fma_f32 v[94:95], v[80:81], v[80:81], v[94:95]
    v_pk_fma_f32 v[96:97], v[82:83], v[82:83], v[96:97]
    v_pk_fma_f32 v[94:95], v[84:85], v[84:85], v[94:95]
    v_pk_fma_f32 v[96:97], v[86:87], v[86:87], v[96:97]
    v_pk_fma_f32 v[94:95], v[88:89], v[88:89], v[94:95]
    v_pk_fma_f32 v[96:97], v[90:91], v[90:91], v[96:97]
    v_pk_fma_f32 v[94:95], v[92:93], v[92:93], v[94:95]
    v_pk_add_f32 v[94:95], v[94:95], v[96:97]
    v_add_f32 v104, v94, v95
    s_nop 1
    v_add_f32_dpp v104, v104, v104 row_ror:8 row_mask:0xf bank_mask:0xf
    s_nop 1
    v_add_f32_dpp v104, v104, v104 row_ror:4 row_mask:0xf bank_mask:0xf
    s_nop 1
    v_add_f32_dpp v104, v104, v104 row_ror:2 row_mask:0xf bank_mask:0xf
    s_nop 1
    v_add_f32_dpp v104, v104, v104 row_ror:1 row_mask:0xf bank_mask:0xf
    v_mov_b32 v105, v104
    s_nop 1
    v_permlane16_swap_b32 v104, v105
    v_add_f32 v104, v104, v105
    v_mul_f32 v104, 0x3ae38e39, v104
    v_cvt_pk_bf16_f32 v94, v102, v104
    v_lshlrev_b32 v106, 16, v94
    v_and_b32 v94, 0xffff0000, v94
    v_add_f32 v94, 0x3727c5ac, v94
    v_sub_f32 v102, v102, v106
    v_cvt_pk_bf16_f32 v94, v94, v94
    v_lshlrev_b32 v94, 16, v94
    v_sqrt_f32 v94, v94
    s_nop 0
    v_cvt_pk_bf16_f32 v94, v94, v94
    v_lshlrev_b32 v94, 16, v94
    v_rcp_f32 v107, v94
    s_nop 0
    v_mul_f32 v102, v102, v107
    v_mul_f32 v104, v104, v107
    v_mul_f32 v104, v104, v107
    v_cvt_pk_bf16_f32 v94, v102, v104
    v_lshlrev_b32 v95, 16, v94
    v_and_b32 v94, 0xffff0000, v94
    v_add_f32 v94, 0x3727c5ac, v94
    v_sub_f32 v102, v102, v95
    v_cvt_pk_bf16_f32 v94, v94, v94
    v_lshlrev_b32 v94, 16, v94
    v_sqrt_f32 v94, v94
    s_nop 0
    v_cvt_pk_bf16_f32 v94, v94, v94
    v_lshlrev_b32 v94, 16, v94
    v_rcp_f32 v94, v94
    s_nop 0
    v_mul_f32 v104, v107, v94
    v_mul_f32 v102, v102, v94
    v_pk_fma_f32 v[76:77], v[76:77], v[104:105], v[102:103] op_sel_hi:[1,0,0]
    v_pk_fma_f32 v[78:79], v[78:79], v[104:105], v[102:103] op_sel_hi:[1,0,0]
    v_pk_fma_f32 v[80:81], v[80:81], v[104:105], v[102:103] op_sel_hi:[1,0,0]
    v_pk_fma_f32 v[82:83], v[82:83], v[104:105], v[102:103] op_sel_hi:[1,0,0]
    v_pk_fma_f32 v[84:85], v[84:85], v[104:105], v[102:103] op_sel_hi:[1,0,0]
    v_pk_fma_f32 v[86:87], v[86:87], v[104:105], v[102:103] op_sel_hi:[1,0,0]
    v_pk_fma_f32 v[88:89], v[88:89], v[104:105], v[102:103] op_sel_hi:[1,0,0]
    v_pk_fma_f32 v[90:91], v[90:91], v[104:105], v[102:103] op_sel_hi:[1,0,0]
    v_pk_fma_f32 v[92:93], v[92:93], v[104:105], v[102:103] op_sel_hi:[1,0,0]
    v_cvt_pk_bf16_f32 v64, v76, v77
    v_cvt_pk_bf16_f32 v65, v78, v79
    v_cvt_pk_bf16_f32 v66, v80, v81
    v_cvt_pk_bf16_f32 v67, v82, v83
    v_cvt_pk_bf16_f32 v68, v84, v85
    v_cvt_pk_bf16_f32 v69, v86, v87
    v_cvt_pk_bf16_f32 v70, v88, v89
    v_cvt_pk_bf16_f32 v71, v90, v91
    v_cvt_pk_bf16_f32 v72, v92, v93
    ds_write_b32 v220, v64 offset:0
    ds_write_b32 v220, v65 offset:4
    ds_write_b32 v220, v66 offset:8
    ds_write_b32 v220, v67 offset:384
    ds_write_b32 v220, v68 offset:388
    ds_write_b32 v220, v69 offset:392
    ds_write_b32 v220, v70 offset:768
    ds_write_b32 v220, v71 offset:772
    ds_write_b32 v220, v72 offset:776
    buffer_store_dwordx2 v[106:107], v216, s[44:47], s5 offen sc1
    s_waitcnt lgkmcnt(0)
    s_barrier
    ds_read_b64_tr_b16 v[200:201], v221 offset:0
    ds_read_b64_tr_b16 v[202:203], v221 offset:4864
    ds_read_b64_tr_b16 v[204:205], v221 offset:512
    ds_read_b64_tr_b16 v[206:207], v221 offset:5376
    ds_read_b64_tr_b16 v[208:209], v221 offset:1024
    ds_read_b64_tr_b16 v[210:211], v221 offset:5888
    s_waitcnt lgkmcnt(4)
    buffer_store_dwordx4 v[200:203], v212, s[44:47], s6 offen sc1
    s_waitcnt lgkmcnt(2)
    buffer_store_dwordx4 v[204:207], v213, s[44:47], s6 offen sc1
    s_waitcnt lgkmcnt(0)
    buffer_store_dwordx4 v[208:211], v214, s[44:47], s8 offen sc1
    buffer_load_dword v226, v225, s[64:67], 0 offen sc1
    s_add_u32 m0, s69, 16384
    v_add_u32 v227, 4096, v227
    buffer_load_dwordx4 v227, s[48:51], 0 offen lds
    s_add_u32 m0, s69, 81920
    v_add_u32 v228, 4096, v228
    buffer_load_dwordx4 v228, s[52:55], 0 offen lds
    s_add_u32 m0, s69, 20480
    v_add_u32 v227, 4096, v227
    buffer_load_dwordx4 v227, s[48:51], 0 offen lds
    s_add_u32 m0, s69, 86016
    v_add_u32 v228, 4096, v228
    buffer_load_dwordx4 v228, s[52:55], 0 offen lds
    v_add_u32 v229, 69632, v222
    s_mul_i32 s68, s72, 12288
    s_add_u32 s68, s68, 3211264
    s_waitcnt vmcnt(9)
    s_barrier
    ds_read_b64_tr_b16 v[108:109], v222 offset:0
    ds_read_b64_tr_b16 v[110:111], v222 offset:4608
    ds_read_b64_tr_b16 v[112:113], v222 offset:9216
    ds_read_b64_tr_b16 v[114:115], v229 offset:0
    ds_read_b64_tr_b16 v[116:117], v229 offset:4608
    ds_read_b64_tr_b16 v[118:119], v222 offset:512
    ds_read_b64_tr_b16 v[120:121], v222 offset:5120
    ds_read_b64_tr_b16 v[122:123], v222 offset:9728
    ds_read_b64_tr_b16 v[124:125], v229 offset:512
    ds_read_b64_tr_b16 v[126:127], v229 offset:5120
    v_alignbit_b32 v162, v139, v139, 16
    v_alignbit_b32 v163, v138, v138, 16
    s_waitcnt lgkmcnt(5)
    v_alignbit_b32 v156, v109, v108, 16
    v_alignbit_b32 v157, v110, v109, 16
    v_alignbit_b32 v158, v111, v110, 16
    v_alignbit_b32 v159, v112, v111, 16
    v_alignbit_b32 v160, v113, v112, 16
    v_dot2_f32_bf16 v164, v108, v162, 0
    v_dot2_f32_bf16 v165, v156, v162, 0
    v_dot2_f32_bf16 v166, v109, v162, 0
    v_dot2_f32_bf16 v167, v157, v162, 0
    v_dot2_f32_bf16 v168, v110, v162, 0
    v_dot2_f32_bf16 v169, v158, v162, 0
    v_dot2_f32_bf16 v170, v111, v162, 0
    v_dot2_f32_bf16 v171, v159, v162, 0
    v_dot2_f32_bf16 v164, v109, v163, v164
    v_dot2_f32_bf16 v165, v157, v163, v165
    v_dot2_f32_bf16 v166, v110, v163, v166
    v_dot2_f32_bf16 v167, v158, v163, v167
    v_dot2_f32_bf16 v168, v111, v163, v168
    v_dot2_f32_bf16 v169, v159, v163, v169
    v_dot2_f32_bf16 v170, v112, v163, v170
    v_dot2_f32_bf16 v171, v160, v163, v171
    v_and_b32 v181, 0xffff0000, v114
    v_lshlrev_b32 v180, 16, v114
    v_and_b32 v183, 0xffff0000, v115
    v_lshlrev_b32 v182, 16, v115
    v_and_b32 v185, 0xffff0000, v116
    v_lshlrev_b32 v184, 16, v116
    v_and_b32 v187, 0xffff0000, v117
    v_lshlrev_b32 v186, 16, v117
    v_pk_mul_f32 v[164:165], v[164:165], v[180:181]
    v_pk_mul_f32 v[166:167], v[166:167], v[182:183]
    v_pk_mul_f32 v[168:169], v[168:169], v[184:185]
    v_pk_mul_f32 v[170:171], v[170:171], v[186:187]
    v_cvt_pk_bf16_f32 v32, v171, v170
    v_cvt_pk_bf16_f32 v33, v169, v168
    v_cvt_pk_bf16_f32 v34, v167, v166
    v_cvt_pk_bf16_f32 v35, v165, v164
    v_alignbit_b32 v162, v141, v141, 16
    v_alignbit_b32 v163, v140, v140, 16
    s_waitcnt lgkmcnt(0)
    v_alignbit_b32 v156, v119, v118, 16
    v_alignbit_b32 v157, v120, v119, 16
    v_alignbit_b32 v158, v121, v120, 16
    v_alignbit_b32 v159, v122, v121, 16
    v_alignbit_b32 v160, v123, v122, 16
    v_dot2_f32_bf16 v172, v118, v162, 0
    v_dot2_f32_bf16 v173, v156, v162, 0
    v_dot2_f32_bf16 v174, v119, v162, 0
    v_dot2_f32_bf16 v175, v157, v162, 0
    v_dot2_f32_bf16 v176, v120, v162, 0
    v_dot2_f32_bf16 v177, v158, v162, 0
    v_dot2_f32_bf16 v178, v121, v162, 0
    v_dot2_f32_bf16 v179, v159, v162, 0
    v_dot2_f32_bf16 v172, v119, v163, v172
    v_dot2_f32_bf16 v173, v157, v163, v173
    v_dot2_f32_bf16 v174, v120, v163, v174
    v_dot2_f32_bf16 v175, v158, v163, v175
    v_dot2_f32_bf16 v176, v121, v163, v176
    v_dot2_f32_bf16 v177, v159, v163, v177
    v_dot2_f32_bf16 v178, v122, v163, v178
    v_dot2_f32_bf16 v179, v160, v163, v179
    v_and_b32 v181, 0xffff0000, v124
    v_lshlrev_b32 v180, 16, v124
    v_and_b32 v183, 0xffff0000, v125
    v_lshlrev_b32 v182, 16, v125
    v_and_b32 v185, 0xffff0000, v126
    v_lshlrev_b32 v184, 16, v126
    v_and_b32 v187, 0xffff0000, v127
    v_lshlrev_b32 v186, 16, v127
    v_pk_mul_f32 v[172:173], v[172:173], v[180:181]
    v_pk_mul_f32 v[174:175], v[174:175], v[182:183]
    v_pk_mul_f32 v[176:177], v[176:177], v[184:185]
    v_pk_mul_f32 v[178:179], v[178:179], v[186:187]
    v_cvt_pk_bf16_f32 v36, v179, v178
    v_cvt_pk_bf16_f32 v37, v177, v176
    v_cvt_pk_bf16_f32 v38, v175, v174
    v_cvt_pk_bf16_f32 v39, v173, v172
    s_waitcnt vmcnt(4)
    v_readfirstlane_b32 s16, v226
    s_nop 1
    s_cmp_eq_u32 s16, 0
    s_cbranch_scc1 L_nw_X
L_ng_X:
    v_mov_b32 v24, s16
    s_barrier
    buffer_store_dword v24, v25, s[44:47], s12 offen sc1
    s_add_u32 s12, s12, 8192
L_segX:
L_pl_X_0:
    s_cbranch_execz L_pl_X_4
    s_add_u32 m0, s69, 24576
    v_add_u32 v227, 4096, v227
    buffer_load_dwordx4 v227, s[48:51], 0 offen lds
    s_add_u32 m0, s69, 90112
    v_add_u32 v228, 4096, v228
    buffer_load_dwordx4 v228, s[52:55], 0 offen lds
    s_add_u32 m0, s69, 28672
    v_add_u32 v227, 4096, v227
    buffer_load_dwordx4 v227, s[48:51], 0 offen lds
    s_add_u32 m0, s69, 94208
    v_add_u32 v228, 4096, v228
    buffer_load_dwordx4 v228, s[52:55], 0 offen lds
    s_add_u32 m0, s69, 32768
    v_add_u32 v227, 4096, v227
    buffer_load_dwordx4 v227, s[48:51], 0 offen lds
    s_add_u32 m0, s69, 98304
    v_add_u32 v228, 4096, v228
    buffer_load_dwordx4 v228, s[52:55], 0 offen lds
    s_add_u32 m0, s69, 36864
    v_add_u32 v227, 4096, v227
    buffer_load_dwordx4 v227, s[48:51], 0 offen lds
    s_add_u32 m0, s69, 102400
    v_add_u32 v228, 4096, v228
    buffer_load_dwordx4 v228, s[52:55], 0 offen lds
    v_bfe_u32 v1, v2, 2, 2
    v_mul_u32_u24 v1, 1152, v1
    v_lshrrev_b32 v3, 4, v2
    v_lshl_add_u32 v1, v3, 5, v1
    v_and_b32 v31, 3, v2
    v_lshl_add_u32 v1, v31, 3, v1
    s_mul_i32 s4, s3, 9216
    s_add_u32 s4, s4, 1024
    v_add_u32 v230, s4, v1
    v_add_u32 v231, 69632, v230
    s_mov_b32 s4, 791555115
    v_lshlrev_b32 v3, 3, v3
    v_lshrrev_b32 v3, v3, s4
    v_and_b32 v3, 255, v3
    v_lshlrev_b32 v3, 8, v3
    v_and_b32 v1, 15, v2
    v_lshl_add_u32 v232, v1, 4, v3
    s_add_u32 s4, s72, s3
    s_mul_i32 s4, s4, 12288
    s_add_u32 s70, s4, 3211264
    s_add_u32 s71, s70, 49152
    s_cmp_eq_u32 s3, 3
    s_cselect_b32 s71, 0x40000000, s71
    s_waitcnt vmcnt(9)
    s_barrier
    ds_read_b64_tr_b16 v[108:109], v222 offset:9216
    ds_read_b64_tr_b16 v[110:111], v222 offset:13824
    ds_read_b64_tr_b16 v[112:113], v222 offset:18432
    ds_read_b64_tr_b16 v[114:115], v229 offset:9216
    ds_read_b64_tr_b16 v[116:117], v229 offset:13824
    ds_read_b64_tr_b16 v[118:119], v222 offset:9728
    ds_read_b64_tr_b16 v[120:121], v222 offset:14336
    ds_read_b64_tr_b16 v[122:123], v222 offset:18944
    ds_read_b64_tr_b16 v[124:125], v229 offset:9728
    ds_read_b64_tr_b16 v[126:127], v229 offset:14336
    v_alignbit_b32 v162, v139, v139, 16
    v_alignbit_b32 v163, v138, v138, 16
    s_waitcnt lgkmcnt(5)
    s_add_u32 m0, s69, 40960
    v_add_u32 v227, 4096, v227
    buffer_load_dwordx4 v227, s[48:51], 0 offen lds
    v_alignbit_b32 v156, v109, v108, 16
    v_alignbit_b32 v157, v110, v109, 16
    v_alignbit_b32 v158, v111, v110, 16
    v_alignbit_b32 v159, v112, v111, 16
    v_alignbit_b32 v160, v113, v112, 16
    v_dot2_f32_bf16 v164, v108, v162, 0
    v_dot2_f32_bf16 v165, v156, v162, 0
    v_dot2_f32_bf16 v166, v109, v162, 0
    v_dot2_f32_bf16 v167, v157, v162, 0
    v_dot2_f32_bf16 v168, v110, v162, 0
    v_dot2_f32_bf16 v169, v158, v162, 0
    s_add_u32 m0, s69, 106496
    v_add_u32 v228, 4096, v228
    buffer_load_dwordx4 v228, s[52:55], 0 offen lds
    v_dot2_f32_bf16 v170, v111, v162, 0
    v_dot2_f32_bf16 v171, v159, v162, 0
    v_dot2_f32_bf16 v164, v109, v163, v164
    v_dot2_f32_bf16 v165, v157, v163, v165
    v_dot2_f32_bf16 v166, v110, v163, v166
    v_dot2_f32_bf16 v167, v158, v163, v167
    v_dot2_f32_bf16 v168, v111, v163, v168
    v_dot2_f32_bf16 v169, v159, v163, v169
    v_dot2_f32_bf16 v170, v112, v163, v170
    v_dot2_f32_bf16 v171, v160, v163, v171
    v_and_b32 v181, 0xffff0000, v114
    s_add_u32 m0, s69, 45056
    v_add_u32 v227, 4096, v227
    buffer_load_dwordx4 v227, s[48:51], 0 offen lds
    v_lshlrev_b32 v180, 16, v114
    v_and_b32 v183, 0xffff0000, v115
    v_lshlrev_b32 v182, 16, v115
    v_and_b32 v185, 0xffff0000, v116
    v_lshlrev_b32 v184, 16, v116
    v_and_b32 v187, 0xffff0000, v117
    v_lshlrev_b32 v186, 16, v117
    v_pk_mul_f32 v[164:165], v[164:165], v[180:181]
    v_pk_mul_f32 v[166:167], v[166:167], v[182:183]
    v_pk_mul_f32 v[168:169], v[168:169], v[184:185]
    v_pk_mul_f32 v[170:171], v[170:171], v[186:187]
    v_cvt_pk_bf16_f32 v40, v171, v170
    s_add_u32 m0, s69, 110592
    v_add_u32 v228, 4096, v228
    buffer_load_dwordx4 v228, s[52:55], 0 offen lds
    v_cvt_pk_bf16_f32 v41, v169, v168
    v_cvt_pk_bf16_f32 v42, v167, v166
    v_cvt_pk_bf16_f32 v43, v165, v164
    v_alignbit_b32 v162, v141, v141, 16
    v_alignbit_b32 v163, v140, v140, 16
    s_waitcnt lgkmcnt(0)
    v_alignbit_b32 v156, v119, v118, 16
    v_alignbit_b32 v157, v120, v119, 16
    v_alignbit_b32 v158, v121, v120, 16
    v_alignbit_b32 v159, v122, v121, 16
    v_alignbit_b32 v160, v123, v122, 16
    s_add_u32 m0, s69, 49152
    v_add_u32 v227, 4096, v227
    buffer_load_dwordx4 v227, s[48:51], 0 offen lds
    v_dot2_f32_bf16 v172, v118, v162, 0
    v_dot2_f32_bf16 v173, v156, v162, 0
    v_dot2_f32_bf16 v174, v119, v162, 0
    v_dot2_f32_bf16 v175, v157, v162, 0
    v_dot2_f32_bf16 v176, v120, v162, 0
    v_dot2_f32_bf16 v177, v158, v162, 0
    v_dot2_f32_bf16 v178, v121, v162, 0
    v_dot2_f32_bf16 v179, v159, v162, 0
    v_dot2_f32_bf16 v172, v119, v163, v172
    v_dot2_f32_bf16 v173, v157, v163, v173
    v_dot2_f32_bf16 v174, v120, v163, v174
    s_add_u32 m0, s69, 114688
    v_add_u32 v228, 4096, v228
    buffer_load_dwordx4 v228, s[52:55], 0 offen lds
    v_dot2_f32_bf16 v175, v158, v163, v175
    v_dot2_f32_bf16 v176, v121, v163, v176
    v_dot2_f32_bf16 v177, v159, v163, v177
    v_dot2_f32_bf16 v178, v122, v163, v178
    v_dot2_f32_bf16 v179, v160, v163, v179
    v_and_b32 v181, 0xffff0000, v124
    v_lshlrev_b32 v180, 16, v124
    v_and_b32 v183, 0xffff0000, v125
    v_lshlrev_b32 v182, 16, v125
    v_and_b32 v185, 0xffff0000, v126
    v_lshlrev_b32 v184, 16, v126
    v_and_b32 v187, 0xffff0000, v127
    v_lshlrev_b32 v186, 16, v127
    v_pk_mul_f32 v[172:173], v[172:173], v[180:181]
    v_pk_mul_f32 v[174:175], v[174:175], v[182:183]
    v_pk_mul_f32 v[176:177], v[176:177], v[184:185]
    v_pk_mul_f32 v[178:179], v[178:179], v[186:187]
    v_cvt_pk_bf16_f32 v44, v179, v178
    v_cvt_pk_bf16_f32 v45, v177, v176
    v_cvt_pk_bf16_f32 v46, v175, v174
    v_cvt_pk_bf16_f32 v47, v173, v172
    s_waitcnt vmcnt(10)
    s_barrier
    ds_read_b64_tr_b16 v[108:109], v222 offset:18432
    ds_read_b64_tr_b16 v[110:111], v222 offset:23040
    ds_read_b64_tr_b16 v[112:113], v222 offset:27648
    ds_read_b64_tr_b16 v[114:115], v229 offset:18432
    ds_read_b64_tr_b16 v[116:117], v229 offset:23040
    ds_read_b64_tr_b16 v[118:119], v222 offset:18944
    ds_read_b64_tr_b16 v[120:121], v222 offset:23552
    ds_read_b64_tr_b16 v[122:123], v222 offset:28160
    ds_read_b64_tr_b16 v[124:125], v229 offset:18944
    ds_read_b64_tr_b16 v[126:127], v229 offset:23552
    v_alignbit_b32 v162, v139, v139, 16
    v_alignbit_b32 v163, v138, v138, 16
    s_waitcnt lgkmcnt(5)
    s_add_u32 m0, s69, 53248
    v_add_u32 v227, 4096, v227
    buffer_load_dwordx4 v227, s[48:51], 0 offen lds
    v_alignbit_b32 v156, v109, v108, 16
    v_alignbit_b32 v157, v110, v109, 16
    v_alignbit_b32 v158, v111, v110, 16
    v_alignbit_b32 v159, v112, v111, 16
    v_alignbit_b32 v160, v113, v112, 16
    v_dot2_f32_bf16 v164, v108, v162, 0
    v_dot2_f32_bf16 v165, v156, v162, 0
    v_dot2_f32_bf16 v166, v109, v162, 0
    v_dot2_f32_bf16 v167, v157, v162, 0
    v_dot2_f32_bf16 v168, v110, v162, 0
    v_dot2_f32_bf16 v169, v158, v162, 0
    v_dot2_f32_bf16 v170, v111, v162, 0
    v_dot2_f32_bf16 v171, v159, v162, 0
    v_dot2_f32_bf16 v164, v109, v163, v164
    v_dot2_f32_bf16 v165, v157, v163, v165
    v_dot2_f32_bf16 v166, v110, v163, v166
    v_dot2_f32_bf16 v167, v158, v163, v167
    s_add_u32 m0, s69, 118784
    v_add_u32 v228, 4096, v228
    buffer_load_dwordx4 v228, s[52:55], 0 offen lds
    v_dot2_f32_bf16 v168, v111, v163, v168
    v_dot2_f32_bf16 v169, v159, v163, v169
    v_dot2_f32_bf16 v170, v112, v163, v170
    v_dot2_f32_bf16 v171, v160, v163, v171
    v_and_b32 v181, 0xffff0000, v114
    v_lshlrev_b32 v180, 16, v114
    v_and_b32 v183, 0xffff0000, v115
    v_lshlrev_b32 v182, 16, v115
    v_and_b32 v185, 0xffff0000, v116
    v_lshlrev_b32 v184, 16, v116
    v_and_b32 v187, 0xffff0000, v117
    v_lshlrev_b32 v186, 16, v117
    v_pk_mul_f32 v[164:165], v[164:165], v[180:181]
    v_pk_mul_f32 v[166:167], v[166:167], v[182:183]
    v_pk_mul_f32 v[168:169], v[168:169], v[184:185]
    v_pk_mul_f32 v[170:171], v[170:171], v[186:187]
    v_cvt_pk_bf16_f32 v48, v171, v170
    s_add_u32 m0, s69, 57344
    v_add_u32 v227, 4096, v227
    buffer_load_dwordx4 v227, s[48:51], 0 offen lds
    v_cvt_pk_bf16_f32 v49, v169, v168
    v_cvt_pk_bf16_f32 v50, v167, v166
    v_cvt_pk_bf16_f32 v51, v165, v164
    v_alignbit_b32 v162, v141, v141, 16
    v_alignbit_b32 v163, v140, v140, 16
    s_waitcnt lgkmcnt(0)
    v_alignbit_b32 v156, v119, v118, 16
    v_alignbit_b32 v157, v120, v119, 16
L_pl_X_1:
    s_cbranch_execz L_pl_X_5
    v_alignbit_b32 v158, v121, v120, 16
    v_alignbit_b32 v159, v122, v121, 16
    v_alignbit_b32 v160, v123, v122, 16
    v_dot2_f32_bf16 v172, v118, v162, 0
    v_dot2_f32_bf16 v173, v156, v162, 0
    v_dot2_f32_bf16 v174, v119, v162, 0
    v_dot2_f32_bf16 v175, v157, v162, 0
    v_dot2_f32_bf16 v176, v120, v162, 0
    v_dot2_f32_bf16 v177, v158, v162, 0
    s_add_u32 m0, s69, 122880
    v_add_u32 v228, 4096, v228
    buffer_load_dwordx4 v228, s[52:55], 0 offen lds
    v_dot2_f32_bf16 v178, v121, v162, 0
    v_dot2_f32_bf16 v179, v159, v162, 0
    v_dot2_f32_bf16 v172, v119, v163, v172
    v_dot2_f32_bf16 v173, v157, v163, v173
    v_dot2_f32_bf16 v174, v120, v163, v174
    v_dot2_f32_bf16 v175, v158, v163, v175
    v_dot2_f32_bf16 v176, v121, v163, v176
    v_dot2_f32_bf16 v177, v159, v163, v177
    v_dot2_f32_bf16 v178, v122, v163, v178
    v_dot2_f32_bf16 v179, v160, v163, v179
    v_and_b32 v181, 0xffff0000, v124
    v_lshlrev_b32 v180, 16, v124
    v_and_b32 v183, 0xffff0000, v125
    v_lshlrev_b32 v182, 16, v125
    v_and_b32 v185, 0xffff0000, v126
    v_lshlrev_b32 v184, 16, v126
    v_and_b32 v187, 0xffff0000, v127
    v_lshlrev_b32 v186, 16, v127
    v_pk_mul_f32 v[172:173], v[172:173], v[180:181]
    v_pk_mul_f32 v[174:175], v[174:175], v[182:183]
    v_pk_mul_f32 v[176:177], v[176:177], v[184:185]
    v_pk_mul_f32 v[178:179], v[178:179], v[186:187]
    v_cvt_pk_bf16_f32 v52, v179, v178
    v_cvt_pk_bf16_f32 v53, v177, v176
    v_cvt_pk_bf16_f32 v54, v175, v174
    v_cvt_pk_bf16_f32 v55, v173, v172
    s_waitcnt vmcnt(10)
    s_barrier
    ds_read_b64_tr_b16 v[108:109], v222 offset:27648
    ds_read_b64_tr_b16 v[110:111], v222 offset:32256
    ds_read_b64_tr_b16 v[112:113], v222 offset:36864
    ds_read_b64_tr_b16 v[114:115], v229 offset:27648
    ds_read_b64_tr_b16 v[116:117], v229 offset:32256
    ds_read_b64_tr_b16 v[118:119], v222 offset:28160
    ds_read_b64_tr_b16 v[120:121], v222 offset:32768
    ds_read_b64_tr_b16 v[122:123], v222 offset:37376
    ds_read_b64_tr_b16 v[124:125], v229 offset:28160
    ds_read_b64_tr_b16 v[126:127], v229 offset:32768
    v_add_u32 v222, 36864, v222
    v_add_u32 v229, 36864, v229
    v_alignbit_b32 v162, v139, v139, 16
    v_alignbit_b32 v163, v138, v138, 16
    s_waitcnt lgkmcnt(5)
    s_add_u32 m0, s69, 61440
    v_add_u32 v227, 4096, v227
    buffer_load_dwordx4 v227, s[48:51], 0 offen lds
    v_alignbit_b32 v156, v109, v108, 16
    v_alignbit_b32 v157, v110, v109, 16
    v_alignbit_b32 v158, v111, v110, 16
    v_alignbit_b32 v159, v112, v111, 16
    v_alignbit_b32 v160, v113, v112, 16
    v_dot2_f32_bf16 v164, v108, v162, 0
    v_dot2_f32_bf16 v165, v156, v162, 0
    v_dot2_f32_bf16 v166, v109, v162, 0
    v_dot2_f32_bf16 v167, v157, v162, 0
    v_dot2_f32_bf16 v168, v110, v162, 0
    v_dot2_f32_bf16 v169, v158, v162, 0
    v_dot2_f32_bf16 v170, v111, v162, 0
    v_dot2_f32_bf16 v171, v159, v162, 0
    v_dot2_f32_bf16 v164, v109, v163, v164
    v_dot2_f32_bf16 v165, v157, v163, v165
    v_dot2_f32_bf16 v166, v110, v163, v166
    v_dot2_f32_bf16 v167, v158, v163, v167
    s_add_u32 m0, s69, 126976
    v_add_u32 v228, 4096, v228
    buffer_load_dwordx4 v228, s[52:55], 0 offen lds
    v_dot2_f32_bf16 v168, v111, v163, v168
    v_dot2_f32_bf16 v169, v159, v163, v169
    v_dot2_f32_bf16 v170, v112, v163, v170
    v_dot2_f32_bf16 v171, v160, v163, v171
    v_and_b32 v181, 0xffff0000, v114
    v_lshlrev_b32 v180, 16, v114
    v_and_b32 v183, 0xffff0000, v115
    v_lshlrev_b32 v182, 16, v115
    v_and_b32 v185, 0xffff0000, v116
    v_lshlrev_b32 v184, 16, v116
    v_and_b32 v187, 0xffff0000, v117
    v_lshlrev_b32 v186, 16, v117
    v_pk_mul_f32 v[164:165], v[164:165], v[180:181]
    v_pk_mul_f32 v[166:167], v[166:167], v[182:183]
    v_pk_mul_f32 v[168:169], v[168:169], v[184:185]
    v_pk_mul_f32 v[170:171], v[170:171], v[186:187]
    v_cvt_pk_bf16_f32 v56, v171, v170
    s_add_u32 m0, s69, 65536
    v_add_u32 v227, 4096, v227
    buffer_load_dwordx4 v227, s[48:51], 0 offen lds
    v_cvt_pk_bf16_f32 v57, v169, v168
    v_cvt_pk_bf16_f32 v58, v167, v166
    v_cvt_pk_bf16_f32 v59, v165, v164
    v_alignbit_b32 v162, v141, v141, 16
    v_alignbit_b32 v163, v140, v140, 16
    s_waitcnt lgkmcnt(0)
    v_alignbit_b32 v156, v119, v118, 16
    v_alignbit_b32 v157, v120, v119, 16
    v_alignbit_b32 v158, v121, v120, 16
    v_alignbit_b32 v159, v122, v121, 16
    v_alignbit_b32 v160, v123, v122, 16
    v_dot2_f32_bf16 v172, v118, v162, 0
    v_dot2_f32_bf16 v173, v156, v162, 0
    v_dot2_f32_bf16 v174, v119, v162, 0
    v_dot2_f32_bf16 v175, v157, v162, 0
    v_dot2_f32_bf16 v176, v120, v162, 0
    v_dot2_f32_bf16 v177, v158, v162, 0
    s_add_u32 m0, s69, 131072
    v_add_u32 v228, 4096, v228
    buffer_load_dwordx4 v228, s[52:55], 0 offen lds
    v_dot2_f32_bf16 v178, v121, v162, 0
    v_dot2_f32_bf16 v179, v159, v162, 0
    v_dot2_f32_bf16 v172, v119, v163, v172
    v_dot2_f32_bf16 v173, v157, v163, v173
    v_dot2_f32_bf16 v174, v120, v163, v174
    v_dot2_f32_bf16 v175, v158, v163, v175
    v_dot2_f32_bf16 v176, v121, v163, v176
    v_dot2_f32_bf16 v177, v159, v163, v177
    v_dot2_f32_bf16 v178, v122, v163, v178
    v_dot2_f32_bf16 v179, v160, v163, v179
    v_and_b32 v181, 0xffff0000, v124
    v_lshlrev_b32 v180, 16, v124
    v_and_b32 v183, 0xffff0000, v125
    v_lshlrev_b32 v182, 16, v125
    v_and_b32 v185, 0xffff0000, v126
    v_lshlrev_b32 v184, 16, v126
    v_and_b32 v187, 0xffff0000, v127
    v_lshlrev_b32 v186, 16, v127
    v_pk_mul_f32 v[172:173], v[172:173], v[180:181]
    v_pk_mul_f32 v[174:175], v[174:175], v[182:183]
    v_pk_mul_f32 v[176:177], v[176:177], v[184:185]
    v_pk_mul_f32 v[178:179], v[178:179], v[186:187]
    v_cvt_pk_bf16_f32 v60, v179, v178
    v_cvt_pk_bf16_f32 v61, v177, v176
    v_cvt_pk_bf16_f32 v62, v175, v174
    v_cvt_pk_bf16_f32 v63, v173, v172
    ds_read_b64_tr_b16 v[128:129], v230 offset:0
    ds_read_b64_tr_b16 v[130:131], v230 offset:4608
    ds_read_b64_tr_b16 v[132:133], v230 offset:9216
    ds_read_b64_tr_b16 v[134:135], v231 offset:0
    ds_read_b64_tr_b16 v[136:137], v231 offset:4608
    v_alignbit_b32 v162, v143, v143, 16
    v_alignbit_b32 v163, v142, v142, 16
    s_waitcnt lgkmcnt(0)
    v_alignbit_b32 v156, v129, v128, 16
    v_alignbit_b32 v157, v130, v129, 16
    v_alignbit_b32 v158, v131, v130, 16
    v_alignbit_b32 v159, v132, v131, 16
    v_alignbit_b32 v160, v133, v132, 16
    v_dot2_f32_bf16 v164, v128, v162, 0
    v_dot2_f32_bf16 v165, v156, v162, 0
    v_dot2_f32_bf16 v166, v129, v162, 0
    v_dot2_f32_bf16 v167, v157, v162, 0
    v_dot2_f32_bf16 v168, v130, v162, 0
    v_dot2_f32_bf16 v169, v158, v162, 0
    v_dot2_f32_bf16 v170, v131, v162, 0
    v_dot2_f32_bf16 v171, v159, v162, 0
    v_dot2_f32_bf16 v164, v129, v163, v164
    v_dot2_f32_bf16 v165, v157, v163, v165
    v_dot2_f32_bf16 v166, v130, v163, v166
    v_dot2_f32_bf16 v167, v158, v163, v167
    v_dot2_f32_bf16 v168, v131, v163, v168
    v_dot2_f32_bf16 v169, v159, v163, v169
    v_dot2_f32_bf16 v170, v132, v163, v170
    v_dot2_f32_bf16 v171, v160, v163, v171
    v_and_b32 v181, 0xffff0000, v134
    v_lshlrev_b32 v180, 16, v134
    v_and_b32 v183, 0xffff0000, v135
    v_lshlrev_b32 v182, 16, v135
    v_and_b32 v185, 0xffff0000, v136
    v_lshlrev_b32 v184, 16, v136
    v_and_b32 v187, 0xffff0000, v137
    v_lshlrev_b32 v186, 16, v137
    v_pk_mul_f32 v[164:165], v[164:165], v[180:181]
    v_pk_mul_f32 v[166:167], v[166:167], v[182:183]
    v_pk_mul_f32 v[168:169], v[168:169], v[184:185]
    v_pk_mul_f32 v[170:171], v[170:171], v[186:187]
    v_cvt_pk_bf16_f32 v64, v171, v170
    v_cvt_pk_bf16_f32 v65, v169, v168
    v_cvt_pk_bf16_f32 v66, v167, v166
    v_cvt_pk_bf16_f32 v67, v165, v164
    s_waitcnt vmcnt(8)
    s_barrier
    ds_read_b64_tr_b16 v[108:109], v222 offset:0
    ds_read_b64_tr_b16 v[110:111], v222 offset:4608
    ds_read_b64_tr_b16 v[112:113], v222 offset:9216
    ds_read_b64_tr_b16 v[114:115], v229 offset:0
    ds_read_b64_tr_b16 v[116:117], v229 offset:4608
    ds_read_b64_tr_b16 v[118:119], v222 offset:512
    ds_read_b64_tr_b16 v[120:121], v222 offset:5120
    ds_read_b64_tr_b16 v[122:123], v222 offset:9728
    ds_read_b64_tr_b16 v[124:125], v229 offset:512
    ds_read_b64_tr_b16 v[126:127], v229 offset:5120
    v_alignbit_b32 v162, v139, v139, 16
    v_alignbit_b32 v163, v138, v138, 16
    s_waitcnt lgkmcnt(5)
    v_alignbit_b32 v156, v109, v108, 16
    v_alignbit_b32 v157, v110, v109, 16
    v_alignbit_b32 v158, v111, v110, 16
    v_alignbit_b32 v159, v112, v111, 16
    v_alignbit_b32 v160, v113, v112, 16
    v_dot2_f32_bf16 v164, v108, v162, 0
    v_dot2_f32_bf16 v165, v156, v162, 0
    v_dot2_f32_bf16 v166, v109, v162, 0
    v_dot2_f32_bf16 v167, v157, v162, 0
    v_dot2_f32_bf16 v168, v110, v162, 0
    v_dot2_f32_bf16 v169, v158, v162, 0
    v_dot2_f32_bf16 v170, v111, v162, 0
    v_dot2_f32_bf16 v171, v159, v162, 0
    v_dot2_f32_bf16 v164, v109, v163, v164
    v_dot2_f32_bf16 v165, v157, v163, v165
    v_dot2_f32_bf16 v166, v110, v163, v166
    v_dot2_f32_bf16 v167, v158, v163, v167
    v_dot2_f32_bf16 v168, v111, v163, v168
    v_dot2_f32_bf16 v169, v159, v163, v169
    v_dot2_f32_bf16 v170, v112, v163, v170
    v_dot2_f32_bf16 v171, v160, v163, v171
    v_and_b32 v181, 0xffff0000, v114
    v_lshlrev_b32 v180, 16, v114
    v_and_b32 v183, 0xffff0000, v115
    v_lshlrev_b32 v182, 16, v115
    v_and_b32 v185, 0xffff0000, v116
    v_lshlrev_b32 v184, 16, v116
    v_and_b32 v187, 0xffff0000, v117
    v_lshlrev_b32 v186, 16, v117
    v_pk_mul_f32 v[164:165], v[164:165], v[180:181]
    v_pk_mul_f32 v[166:167], v[166:167], v[182:183]
    v_pk_mul_f32 v[168:169], v[168:169], v[184:185]
    v_pk_mul_f32 v[170:171], v[170:171], v[186:187]
    v_cvt_pk_bf16_f32 v68, v171, v170
    v_cvt_pk_bf16_f32 v69, v169, v168
    v_cvt_pk_bf16_f32 v70, v167, v166
    v_cvt_pk_bf16_f32 v71, v165, v164
    v_alignbit_b32 v162, v141, v141, 16
    v_alignbit_b32 v163, v140, v140, 16
    s_waitcnt lgkmcnt(0)
    v_alignbit_b32 v156, v119, v118, 16
    v_alignbit_b32 v157, v120, v119, 16
    v_alignbit_b32 v158, v121, v120, 16
    v_alignbit_b32 v159, v122, v121, 16
    v_alignbit_b32 v160, v123, v122, 16
    v_dot2_f32_bf16 v172, v118, v162, 0
    v_dot2_f32_bf16 v173, v156, v162, 0
    v_dot2_f32_bf16 v174, v119, v162, 0
    v_dot2_f32_bf16 v175, v157, v162, 0
    v_dot2_f32_bf16 v176, v120, v162, 0
    v_dot2_f32_bf16 v177, v158, v162, 0
    v_dot2_f32_bf16 v178, v121, v162, 0
    v_dot2_f32_bf16 v179, v159, v162, 0
    v_dot2_f32_bf16 v172, v119, v163, v172
    v_dot2_f32_bf16 v173, v157, v163, v173
    v_dot2_f32_bf16 v174, v120, v163, v174
    v_dot2_f32_bf16 v175, v158, v163, v175
    v_dot2_f32_bf16 v176, v121, v163, v176
    v_dot2_f32_bf16 v177, v159, v163, v177
    v_dot2_f32_bf16 v178, v122, v163, v178
    v_dot2_f32_bf16 v179, v160, v163, v179
    v_and_b32 v181, 0xffff0000, v124
    v_lshlrev_b32 v180, 16, v124
    v_and_b32 v183, 0xffff0000, v125
    v_lshlrev_b32 v182, 16, v125
    v_and_b32 v185, 0xffff0000, v126
    v_lshlrev_b32 v184, 16, v126
    v_and_b32 v187, 0xffff0000, v127
    v_lshlrev_b32 v186, 16, v127
    v_pk_mul_f32 v[172:173], v[172:173], v[180:181]
    v_pk_mul_f32 v[174:175], v[174:175], v[182:183]
    v_pk_mul_f32 v[176:177], v[176:177], v[184:185]
    v_pk_mul_f32 v[178:179], v[178:179], v[186:187]
    v_cvt_pk_bf16_f32 v72, v179, v178
    v_cvt_pk_bf16_f32 v73, v177, v176
    v_cvt_pk_bf16_f32 v74, v175, v174
    v_cvt_pk_bf16_f32 v75, v173, v172
    buffer_store_dwordx4 v[32:35], v212, s[44:47], s68 offen sc1
    buffer_store_dwordx4 v[36:39], v213, s[44:47], s68 offen sc1
    s_add_u32 s68, s68, 12288
    buffer_store_dwordx4 v[40:43], v212, s[44:47], s68 offen sc1
    buffer_store_dwordx4 v[44:47], v213, s[44:47], s68 offen sc1
    s_add_u32 s68, s68, 12288
    buffer_store_dwordx4 v[48:51], v212, s[44:47], s68 offen sc1
    buffer_store_dwordx4 v[52:55], v213, s[44:47], s68 offen sc1
    s_add_u32 s68, s68, 12288
    buffer_store_dwordx4 v[56:59], v212, s[44:47], s68 offen sc1
    buffer_store_dwordx4 v[60:63], v213, s[44:47], s68 offen sc1
    s_add_u32 s68, s68, 12288
    buffer_store_dwordx4 v[64:67], v232, s[44:47], s70 offen sc1
    buffer_store_dwordx4 v[68:71], v212, s[44:47], s68 offen sc1
    buffer_store_dwordx4 v[72:75], v213, s[44:47], s68 offen sc1
    s_add_u32 s68, s68, 12288
    s_mov_b32 s60, s24
    s_and_b32 s61, s25, 0xffff
    s_mov_b32 s62, 2359296
    s_mov_b32 s63, 0x20000
    v_lshrrev_b32 v1, 5, v2
    v_and_b32 v3, 31, v2
    v_lshlrev_b32 v1, 14, v1
    v_lshl_add_u32 v1, v3, 7, v1
    s_lshl_b32 s4, s30, 12
    buffer_load_dword v255, v1, s[60:63], s4 offen
    s_waitcnt vmcnt(16)
    s_barrier
    ds_read_b64_tr_b16 v[108:109], v222 offset:9216
    ds_read_b64_tr_b16 v[110:111], v222 offset:13824
    ds_read_b64_tr_b16 v[112:113], v222 offset:18432
    ds_read_b64_tr_b16 v[114:115], v229 offset:9216
    ds_read_b64_tr_b16 v[116:117], v229 offset:13824
    ds_read_b64_tr_b16 v[118:119], v222 offset:9728
    ds_read_b64_tr_b16 v[120:121], v222 offset:14336
    ds_read_b64_tr_b16 v[122:123], v222 offset:18944
    ds_read_b64_tr_b16 v[124:125], v229 offset:9728
    ds_read_b64_tr_b16 v[126:127], v229 offset:14336
    v_alignbit_b32 v162, v139, v139, 16
    v_alignbit_b32 v163, v138, v138, 16
    s_waitcnt lgkmcnt(5)
    v_alignbit_b32 v156, v109, v108, 16
    v_alignbit_b32 v157, v110, v109, 16
    v_alignbit_b32 v158, v111, v110, 16
    v_alignbit_b32 v159, v112, v111, 16
    v_alignbit_b32 v160, v113, v112, 16
    v_dot2_f32_bf16 v164, v108, v162, 0
    v_dot2_f32_bf16 v165, v156, v162, 0
    v_dot2_f32_bf16 v166, v109, v162, 0
    v_dot2_f32_bf16 v167, v157, v162, 0
    v_dot2_f32_bf16 v168, v110, v162, 0
    v_dot2_f32_bf16 v169, v158, v162, 0
    v_dot2_f32_bf16 v170, v111, v162, 0
    v_dot2_f32_bf16 v171, v159, v162, 0
    v_dot2_f32_bf16 v164, v109, v163, v164
    v_dot2_f32_bf16 v165, v157, v163, v165
    v_dot2_f32_bf16 v166, v110, v163, v166
    v_dot2_f32_bf16 v167, v158, v163, v167
    v_dot2_f32_bf16 v168, v111, v163, v168
    v_dot2_f32_bf16 v169, v159, v163, v169
    v_dot2_f32_bf16 v170, v112, v163, v170
    v_dot2_f32_bf16 v171, v160, v163, v171
    v_and_b32 v181, 0xffff0000, v114
    v_lshlrev_b32 v180, 16, v114
    v_and_b32 v183, 0xffff0000, v115
    v_lshlrev_b32 v182, 16, v115
    v_and_b32 v185, 0xffff0000, v116
    v_lshlrev_b32 v184, 16, v116
    v_and_b32 v187, 0xffff0000, v117
    v_lshlrev_b32 v186, 16, v117
    v_pk_mul_f32 v[164:165], v[164:165], v[180:181]
    v_pk_mul_f32 v[166:167], v[166:167], v[182:183]
    v_pk_mul_f32 v[168:169], v[168:169], v[184:185]
    v_pk_mul_f32 v[170:171], v[170:171], v[186:187]
    v_cvt_pk_bf16_f32 v76, v171, v170
    v_cvt_pk_bf16_f32 v77, v169, v168
    v_cvt_pk_bf16_f32 v78, v167, v166
    v_cvt_pk_bf16_f32 v79, v165, v164
    v_alignbit_b32 v162, v141, v141, 16
    v_alignbit_b32 v163, v140, v140, 16
    s_waitcnt lgkmcnt(0)
    v_alignbit_b32 v156, v119, v118, 16
    v_alignbit_b32 v157, v120, v119, 16
    v_alignbit_b32 v158, v121, v120, 16
    v_alignbit_b32 v159, v122, v121, 16
    v_alignbit_b32 v160, v123, v122, 16
    v_dot2_f32_bf16 v172, v118, v162, 0
    v_dot2_f32_bf16 v173, v156, v162, 0
    v_dot2_f32_bf16 v174, v119, v162, 0
    v_dot2_f32_bf16 v175, v157, v162, 0
    v_dot2_f32_bf16 v176, v120, v162, 0
    v_dot2_f32_bf16 v177, v158, v162, 0
    v_dot2_f32_bf16 v178, v121, v162, 0
    v_dot2_f32_bf16 v179, v159, v162, 0
    v_dot2_f32_bf16 v172, v119, v163, v172
    v_dot2_f32_bf16 v173, v157, v163, v173
    v_dot2_f32_bf16 v174, v120, v163, v174
    v_dot2_f32_bf16 v175, v158, v163, v175
    v_dot2_f32_bf16 v176, v121, v163, v176
    v_dot2_f32_bf16 v177, v159, v163, v177
    v_dot2_f32_bf16 v178, v122, v163, v178
    v_dot2_f32_bf16 v179, v160, v163, v179
    v_and_b32 v181, 0xffff0000, v124
    v_lshlrev_b32 v180, 16, v124
    v_and_b32 v183, 0xffff0000, v125
    v_lshlrev_b32 v182, 16, v125
    v_and_b32 v185, 0xffff0000, v126
    v_lshlrev_b32 v184, 16, v126
    v_and_b32 v187, 0xffff0000, v127
    v_lshlrev_b32 v186, 16, v127
    v_pk_mul_f32 v[172:173], v[172:173], v[180:181]
    v_pk_mul_f32 v[174:175], v[174:175], v[182:183]
    v_pk_mul_f32 v[176:177], v[176:177], v[184:185]
    v_pk_mul_f32 v[178:179], v[178:179], v[186:187]
    v_cvt_pk_bf16_f32 v80, v179, v178
    v_cvt_pk_bf16_f32 v81, v177, v176
    v_cvt_pk_bf16_f32 v82, v175, v174
    v_cvt_pk_bf16_f32 v83, v173, v172
    buffer_store_dwordx4 v[76:79], v212, s[44:47], s68 offen sc1
    buffer_store_dwordx4 v[80:83], v213, s[44:47], s68 offen sc1
    s_add_u32 s68, s68, 12288
    s_waitcnt vmcnt(14)
    s_barrier
    ds_read_b64_tr_b16 v[108:109], v222 offset:18432
    ds_read_b64_tr_b16 v[110:111], v222 offset:23040
    ds_read_b64_tr_b16 v[112:113], v222 offset:27648
    ds_read_b64_tr_b16 v[114:115], v229 offset:18432
    ds_read_b64_tr_b16 v[116:117], v229 offset:23040
    ds_read_b64_tr_b16 v[118:119], v222 offset:18944
    ds_read_b64_tr_b16 v[120:121], v222 offset:23552
    ds_read_b64_tr_b16 v[122:123], v222 offset:28160
    ds_read_b64_tr_b16 v[124:125], v229 offset:18944
    ds_read_b64_tr_b16 v[126:127], v229 offset:23552
    v_alignbit_b32 v162, v139, v139, 16
    v_alignbit_b32 v163, v138, v138, 16
    s_waitcnt lgkmcnt(5)
    v_alignbit_b32 v156, v109, v108, 16
    v_alignbit_b32 v157, v110, v109, 16
    v_alignbit_b32 v158, v111, v110, 16
    v_alignbit_b32 v159, v112, v111, 16
    v_alignbit_b32 v160, v113, v112, 16
    v_dot2_f32_bf16 v164, v108, v162, 0
    v_dot2_f32_bf16 v165, v156, v162, 0
    v_dot2_f32_bf16 v166, v109, v162, 0
    v_dot2_f32_bf16 v167, v157, v162, 0
    v_dot2_f32_bf16 v168, v110, v162, 0
    v_dot2_f32_bf16 v169, v158, v162, 0
    v_dot2_f32_bf16 v170, v111, v162, 0
    v_dot2_f32_bf16 v171, v159, v162, 0
    v_dot2_f32_bf16 v164, v109, v163, v164
    v_dot2_f32_bf16 v165, v157, v163, v165
    v_dot2_f32_bf16 v166, v110, v163, v166
    v_dot2_f32_bf16 v167, v158, v163, v167
    v_dot2_f32_bf16 v168, v111, v163, v168
    v_dot2_f32_bf16 v169, v159, v163, v169
    v_dot2_f32_bf16 v170, v112, v163, v170
    v_dot2_f32_bf16 v171, v160, v163, v171
    v_and_b32 v181, 0xffff0000, v114
    v_lshlrev_b32 v180, 16, v114
    v_and_b32 v183, 0xffff0000, v115
    v_lshlrev_b32 v182, 16, v115
    v_and_b32 v185, 0xffff0000, v116
    v_lshlrev_b32 v184, 16, v116
    v_and_b32 v187, 0xffff0000, v117
    v_lshlrev_b32 v186, 16, v117
    v_pk_mul_f32 v[164:165], v[164:165], v[180:181]
    v_pk_mul_f32 v[166:167], v[166:167], v[182:183]
    v_pk_mul_f32 v[168:169], v[168:169], v[184:185]
    v_pk_mul_f32 v[170:171], v[170:171], v[186:187]
    v_cvt_pk_bf16_f32 v84, v171, v170
    v_cvt_pk_bf16_f32 v85, v169, v168
    v_cvt_pk_bf16_f32 v86, v167, v166
    v_cvt_pk_bf16_f32 v87, v165, v164
    v_alignbit_b32 v162, v141, v141, 16
    v_alignbit_b32 v163, v140, v140, 16
    s_waitcnt lgkmcnt(0)
    v_alignbit_b32 v156, v119, v118, 16
    v_alignbit_b32 v157, v120, v119, 16
    v_alignbit_b32 v158, v121, v120, 16
    v_alignbit_b32 v159, v122, v121, 16
    v_alignbit_b32 v160, v123, v122, 16
    v_dot2_f32_bf16 v172, v118, v162, 0
    v_dot2_f32_bf16 v173, v156, v162, 0
    v_dot2_f32_bf16 v174, v119, v162, 0
    v_dot2_f32_bf16 v175, v157, v162, 0
    v_dot2_f32_bf16 v176, v120, v162, 0
    v_dot2_f32_bf16 v177, v158, v162, 0
    v_dot2_f32_bf16 v178, v121, v162, 0
    v_dot2_f32_bf16 v179, v159, v162, 0
    v_dot2_f32_bf16 v172, v119, v163, v172
    v_dot2_f32_bf16 v173, v157, v163, v173
    v_dot2_f32_bf16 v174, v120, v163, v174
    v_dot2_f32_bf16 v175, v158, v163, v175
    v_dot2_f32_bf16 v176, v121, v163, v176
    v_dot2_f32_bf16 v177, v159, v163, v177
    v_dot2_f32_bf16 v178, v122, v163, v178
    v_dot2_f32_bf16 v179, v160, v163, v179
    v_and_b32 v181, 0xffff0000, v124
    v_lshlrev_b32 v180, 16, v124
    v_and_b32 v183, 0xffff0000, v125
    v_lshlrev_b32 v182, 16, v125
    v_and_b32 v185, 0xffff0000, v126
    v_lshlrev_b32 v184, 16, v126
    v_and_b32 v187, 0xffff0000, v127
    v_lshlrev_b32 v186, 16, v127
    v_pk_mul_f32 v[172:173], v[172:173], v[180:181]
    v_pk_mul_f32 v[174:175], v[174:175], v[182:183]
    v_pk_mul_f32 v[176:177], v[176:177], v[184:185]
    v_pk_mul_f32 v[178:179], v[178:179], v[186:187]
    v_cvt_pk_bf16_f32 v88, v179, v178
    v_cvt_pk_bf16_f32 v89, v177, v176
    v_cvt_pk_bf16_f32 v90, v175, v174
    v_cvt_pk_bf16_f32 v91, v173, v172
    ds_read_b64_tr_b16 v[128:129], v230 offset:36864
    ds_read_b64_tr_b16 v[130:131], v230 offset:41472
    ds_read_b64_tr_b16 v[132:133], v230 offset:46080
    ds_read_b64_tr_b16 v[134:135], v231 offset:36864
    ds_read_b64_tr_b16 v[136:137], v231 offset:41472
    v_alignbit_b32 v162, v143, v143, 16
    v_alignbit_b32 v163, v142, v142, 16
    s_waitcnt lgkmcnt(0)
    v_alignbit_b32 v156, v129, v128, 16
    v_alignbit_b32 v157, v130, v129, 16
    v_alignbit_b32 v158, v131, v130, 16
    v_alignbit_b32 v159, v132, v131, 16
    v_alignbit_b32 v160, v133, v132, 16
    v_dot2_f32_bf16 v164, v128, v162, 0
    v_dot2_f32_bf16 v165, v156, v162, 0
    v_dot2_f32_bf16 v166, v129, v162, 0
    v_dot2_f32_bf16 v167, v157, v162, 0
    v_dot2_f32_bf16 v168, v130, v162, 0
    v_dot2_f32_bf16 v169, v158, v162, 0
    v_dot2_f32_bf16 v170, v131, v162, 0
    v_dot2_f32_bf16 v171, v159, v162, 0
    v_dot2_f32_bf16 v164, v129, v163, v164
    v_dot2_f32_bf16 v165, v157, v163, v165
    v_dot2_f32_bf16 v166, v130, v163, v166
    v_dot2_f32_bf16 v167, v158, v163, v167
    v_dot2_f32_bf16 v168, v131, v163, v168
    v_dot2_f32_bf16 v169, v159, v163, v169
    v_dot2_f32_bf16 v170, v132, v163, v170
    v_dot2_f32_bf16 v171, v160, v163, v171
    v_and_b32 v181, 0xffff0000, v134
    v_lshlrev_b32 v180, 16, v134
    v_and_b32 v183, 0xffff0000, v135
    v_lshlrev_b32 v182, 16, v135
    v_and_b32 v185, 0xffff0000, v136
    v_lshlrev_b32 v184, 16, v136
    v_and_b32 v187, 0xffff0000, v137
    v_lshlrev_b32 v186, 16, v137
    v_pk_mul_f32 v[164:165], v[164:165], v[180:181]
    v_pk_mul_f32 v[166:167], v[166:167], v[182:183]
    v_pk_mul_f32 v[168:169], v[168:169], v[184:185]
    v_pk_mul_f32 v[170:171], v[170:171], v[186:187]
    v_cvt_pk_bf16_f32 v92, v171, v170
    v_cvt_pk_bf16_f32 v93, v169, v168
    v_cvt_pk_bf16_f32 v94, v167, v166
    v_cvt_pk_bf16_f32 v95, v165, v164
    buffer_store_dwordx4 v[84:87], v212, s[44:47], s68 offen sc1
    buffer_store_dwordx4 v[88:91], v213, s[44:47], s68 offen sc1
    s_add_u32 s68, s68, 12288
    buffer_store_dwordx4 v[92:95], v232, s[44:47], s71 offen sc1
    v_min_u32 v1, 6, v0
    v_add_u32 v28, s72, v1
    v_and_b32 v29, 3, v28
L_pl_X_2:
    s_cbranch_execz L_wret
    v_lshrrev_b32 v28, 2, v28
    v_lshlrev_b32 v28, 7, v28
    v_lshl_add_u32 v28, v29, 2, v28
    v_add_u32 v28, 8871936, v28
    v_mov_b32 v1, 0x40000000
    v_cmp_gt_u32 vcc, 7, v0
    s_nop 1
    v_cndmask_b32 v28, v1, v28, vcc
    s_mov_b64 exec, 0
    s_call_b64 s[10:11], L_wc_X
    s_mov_b64 exec, -1
    s_mov_b64 exec, 0
    s_call_b64 s[10:11], L_wc_S
    s_mov_b64 exec, -1
    v_lshrrev_b32 v1, 4, v2
    v_and_b32 v3, 15, v2
    v_lshlrev_b32 v31, 1, v1
    v_xor_b32 v3, v3, v31
    v_lshlrev_b32 v1, 12, v1
    v_and_b32 v31, 7, v3
    v_lshl_add_u32 v1, v31, 4, v1
    s_lshr_b32 s4, s3, 1
    s_lshl_b32 s4, s4, 2
    s_and_b32 s5, s3, 1
    s_add_u32 s4, s4, s5
    s_lshl_b32 s4, s4, 15
    v_add_u32 v1, s4, v1
    v_mov_b32 v31, s40
    v_mov_b32 v11, s41
    v_cmp_lt_u32 vcc, 7, v3
    s_nop 1
    v_cndmask_b32 v8, v31, v11, vcc
    v_cndmask_b32 v10, v11, v31, vcc
    v_add_u32 v8, v8, v1
    v_add_u32 v10, v10, v1
    v_add_u32 v9, 64512, v8
    v_add_u32 v10, 14336, v10
    v_add_u32 v11, 64512, v10
    s_mov_b32 s4, 172066848
    s_cmp_eq_u32 s22, 1
    s_cselect_b32 s4, 310614180, s4
    s_cmp_eq_u32 s22, 2
    s_cselect_b32 s4, 483798345, s4
    s_cmp_eq_u32 s22, 3
    s_cselect_b32 s4, 18365901, s4
    s_cmp_lt_u32 s2, 224
    s_cselect_b32 s4, 136512515, s4
    s_bfe_u32 s84, s4, 0x50000
    s_bfe_u32 s85, s4, 0x50005
    s_bfe_u32 s86, s4, 0x5000a
    s_bfe_u32 s87, s4, 0x5000f
    s_bfe_u32 s88, s4, 0x50014
    s_bfe_u32 s89, s4, 0x50019
    s_mov_b32 s4, 379887846
    s_cmp_eq_u32 s22, 1
    s_cselect_b32 s4, 518435178, s4
    s_cmp_eq_u32 s22, 2
    s_cselect_b32 s4, 68175375, s4
    s_cmp_eq_u32 s22, 3
    s_cselect_b32 s4, 206703681, s4
    s_cmp_lt_u32 s2, 224
    s_cselect_b32 s4, 479468869, s4
    s_bfe_u32 s90, s4, 0x50000
    s_bfe_u32 s91, s4, 0x50005
    s_bfe_u32 s92, s4, 0x5000a
    s_bfe_u32 s93, s4, 0x5000f
    s_bfe_u32 s94, s4, 0x50014
    s_bfe_u32 s95, s4, 0x50019
    s_mov_b32 s4, 587708844
    s_cmp_eq_u32 s22, 1
    s_cselect_b32 s4, 102793776, s4
    s_cmp_eq_u32 s22, 2
    s_cselect_b32 s4, 275977347, s4
    s_cmp_eq_u32 s22, 3
    s_cselect_b32 s4, 414524679, s4
    s_cmp_lt_u32 s2, 224
    s_cselect_b32 s4, 587707787, s4
    s_bfe_u32 s96, s4, 0x50000
    s_bfe_u32 s97, s4, 0x50005
    s_bfe_u32 s98, s4, 0x5000a
    s_bfe_u32 s99, s4, 0x5000f
    s_bfe_u32 s100, s4, 0x50014
    s_bfe_u32 s101, s4, 0x50019
    s_mul_i32 s4, s23, 18
    s_add_u32 s84, s84, s4
    s_lshl_b32 s84, s84, 17
    s_add_u32 s85, s85, s4
    s_lshl_b32 s85, s85, 17
    s_add_u32 s86, s86, s4
    s_lshl_b32 s86, s86, 17
    s_add_u32 s87, s87, s4
    s_lshl_b32 s87, s87, 17
    s_add_u32 s88, s88, s4
    s_lshl_b32 s88, s88, 17
    s_add_u32 s89, s89, s4
    s_lshl_b32 s89, s89, 17
    s_add_u32 s90, s90, s4
    s_lshl_b32 s90, s90, 17
    s_add_u32 s91, s91, s4
    s_lshl_b32 s91, s91, 17
    s_add_u32 s92, s92, s4
    s_lshl_b32 s92, s92, 17
    s_add_u32 s93, s93, s4
    s_lshl_b32 s93, s93, 17
    s_add_u32 s94, s94, s4
    s_lshl_b32 s94, s94, 17
    s_add_u32 s95, s95, s4
    s_lshl_b32 s95, s95, 17
    s_add_u32 s96, s96, s4
    s_lshl_b32 s96, s96, 17
    s_add_u32 s97, s97, s4
    s_lshl_b32 s97, s97, 17
    s_add_u32 s98, s98, s4
    s_lshl_b32 s98, s98, 17
    s_add_u32 s99, s99, s4
    s_lshl_b32 s99, s99, 17
    s_add_u32 s100, s100, s4
    s_lshl_b32 s100, s100, 17
    s_add_u32 s101, s101, s4
    s_lshl_b32 s101, s101, 17
    v_bfe_u32 v1, v2, 2, 2
    v_lshrrev_b32 v3, 4, v2
    v_lshl_add_u32 v31, v3, 3, v1
    v_lshlrev_b32 v31, 8, v31
    v_and_b32 v3, 1, v3
    v_lshl_add_u32 v1, v3, 2, v1
    v_and_b32 v3, 3, v2
    v_lshl_add_u32 v31, v3, 3, v31
    s_lshl_b32 s7, s3, 1
    v_xor_b32 v1, s7, v1
    v_lshl_add_u32 v12, v1, 5, v31
    v_add_u32 v12, 114688, v12
    v_xor_b32 v13, 32, v12
    s_waitcnt vmcnt(0) lgkmcnt(0)
    s_barrier
    buffer_store_dword v24, v28, s[44:47], 0 offen sc1
    s_mov_b32 s48, s24
    s_and_b32 s49, s25, 0xffff
    s_mov_b32 s50, 2359296
    s_mov_b32 s51, 0x20000
    s_mov_b32 s52, s42
    s_and_b32 s53, s43, 0xffff
    s_mov_b32 s54, 18874368
    s_mov_b32 s55, 0x20000
    s_mov_b32 s60, s36
    s_and_b32 s61, s37, 0xffff
    s_mov_b32 s62, 4096
    s_mov_b32 s63, 0x20000
    s_cmp_lt_u32 s3, 2
    s_cselect_b32 s4, s40, s41
    s_and_b32 s14, s3, 1
    s_lshl_b32 s14, s14, 6
    s_add_u32 s4, s4, s14
    v_and_b32 v1, 15, v2
    v_lshl_add_u32 v3, v1, 1, s4
    s_and_b32 s14, s23, 1
    s_lshl_b32 s14, s14, 5
    buffer_load_ushort v152, v3, s[60:63], 0 offen
    buffer_load_ushort v153, v3, s[60:63], 0 offen offset:32
    buffer_load_ushort v154, v3, s[60:63], s14 offen
    s_mov_b32 s60, s26
    s_and_b32 s61, s27, 0xffff
    s_mov_b32 s62, 1152
    s_mov_b32 s63, 0x20000
    s_lshl_b32 s4, s34, 1
    v_mov_b32 v30, 0
    buffer_load_ushort v30, v30, s[60:63], s4 offen
    s_add_u32 m0, s18, 32
    s_add_u32 s14, s30, 0
    s_lshl_b32 s14, s14, 12
    buffer_load_dwordx4 v21, s[48:51], s14 offen offset:0 lds
    buffer_load_dwordx4 v21, s[48:51], s14 offen offset:1024 lds
    buffer_load_dwordx4 v21, s[48:51], s14 offen offset:2048 lds
    buffer_load_dwordx4 v21, s[48:51], s14 offen offset:3072 lds
    s_lshr_b32 s14, s14, 11
    v_mov_b32 v144, 0
    buffer_load_ushort v144, v144, s[60:63], s14 offen
    s_add_u32 m0, s18, 33312
    s_add_u32 s14, s30, 4
    s_lshl_b32 s14, s14, 12
    buffer_load_dwordx4 v21, s[48:51], s14 offen offset:0 lds
    buffer_load_dwordx4 v21, s[48:51], s14 offen offset:1024 lds
    buffer_load_dwordx4 v21, s[48:51], s14 offen offset:2048 lds
    buffer_load_dwordx4 v21, s[48:51], s14 offen offset:3072 lds
    s_lshr_b32 s14, s14, 11
    v_mov_b32 v145, 0
    buffer_load_ushort v145, v145, s[60:63], s14 offen
    s_lshl_b32 s6, s3, 6
    v_add_u32 v28, s6, v2
    v_and_b32 v29, 3, v28
    v_lshrrev_b32 v28, 2, v28
    v_lshlrev_b32 v28, 7, v28
    v_lshl_add_u32 v28, v29, 2, v28
    v_add_u32 v28, 8871936, v28
    s_add_u32 m0, s20, 114688
    s_lshl_b32 s14, s84, 1
    buffer_load_dwordx4 v8, s[52:55], s14 offen offset:0 lds
    buffer_load_dwordx4 v9, s[52:55], s14 offen offset:1024 lds
    buffer_load_dwordx4 v10, s[52:55], s14 offen offset:2048 lds
    buffer_load_dwordx4 v11, s[52:55], s14 offen offset:3072 lds
    s_add_u32 m0, s20, 131072
    s_lshl_b32 s14, s85, 1
    buffer_load_dwordx4 v8, s[52:55], s14 offen offset:0 lds
    buffer_load_dwordx4 v9, s[52:55], s14 offen offset:1024 lds
    buffer_load_dwordx4 v10, s[52:55], s14 offen offset:2048 lds
    buffer_load_dwordx4 v11, s[52:55], s14 offen offset:3072 lds
    v_add_u32 v26, s18, v21
    v_cmp_eq_u32 vcc, 0, v2
    v_mov_b32 v1, 4140
    s_nop 0
    v_cndmask_b32 v1, v1, 32, vcc
    v_add_u32 v27, s18, v1
    s_mov_b32 s4, 33280
    v_bfe_u32 v1, v2, 3, 1
    v_mul_u32_u24 v1, 4160, v1
    v_bfe_u32 v3, v2, 4, 1
    v_mad_u32_u24 v1, v3, s4, v1
    v_and_b32 v3, 7, v2
    v_lshl_add_u32 v1, v3, 2, v1
    v_add_u32 v1, s18, v1
    v_mov_b32 v36, 0
    v_mov_b32 v37, 0
    v_mov_b32 v38, 0
    v_mov_b32 v39, 0
    ds_write_b32 v1, v36
    v_lshlrev_b32 v1, 4, v0
    ds_write_b128 v1, v[36:39]
    s_waitcnt vmcnt(14)
    ds_read_b128 v[64:67], v26 offset:32
    ds_read_b32 v68, v26 offset:48
    ds_read_b128 v[70:73], v26 offset:1056
    ds_read_b32 v74, v26 offset:1072
    ds_read_b128 v[76:79], v26 offset:2080
    ds_read_b32 v80, v26 offset:2096
    ds_read_b128 v[82:85], v26 offset:3104
    ds_read_b32 v86, v26 offset:3120
    s_waitcnt vmcnt(9)
    ds_read_b128 v[88:91], v26 offset:33312
    ds_read_b32 v92, v26 offset:33328
    ds_read_b128 v[94:97], v26 offset:34336
    ds_read_b32 v98, v26 offset:34352
    ds_read_b128 v[100:103], v26 offset:35360
    ds_read_b32 v104, v26 offset:35376
    ds_read_b128 v[106:109], v26 offset:36384
    ds_read_b32 v110, v26 offset:36400
    v_lshrrev_b32 v1, 3, v2
    v_and_b32 v3, 7, v2
    v_lshrrev_b32 v31, 1, v1
    v_xor_b32 v3, v3, v31
    v_mul_u32_u24 v1, 12288, v1
    v_lshl_add_u32 v14, v3, 4, v1
    v_xor_b32 v15, 64, v14
    v_and_b32 v1, 15, v2
    v_add_u32 v1, 1, v1
    v_and_b32 v3, 1, v1
    v_mul_u32_u24 v3, 4160, v3
    v_lshrrev_b32 v1, 1, v1
    v_lshl_add_u32 v3, v1, 2, v3
    v_lshrrev_b32 v31, 4, v2
    v_lshl_add_u32 v3, v31, 4, v3
    v_add_u32 v4, s18, v3
    v_add_u32 v5, 1024, v4
    v_add_u32 v6, 1024, v5
    v_add_u32 v7, 1024, v6
    s_waitcnt lgkmcnt(8)
    v_lshlrev_b32 v1, 16, v64
    v_lshlrev_b32 v144, 16, v144
    v_add_f32 v1, v1, v144
    v_cvt_pk_bf16_f32 v1, v1, v1
    ds_write_b16 v27, v1 offset:0
    ds_write_b16 v27, v1 offset:4158
    v_alignbit_b32 v64, v65, v64, 16
    v_alignbit_b32 v65, v66, v65, 16
    v_alignbit_b32 v66, v67, v66, 16
    v_alignbit_b32 v67, v68, v67, 16
    ds_write_b128 v26, v[64:67] offset:4192
    v_alignbit_b32 v70, v71, v70, 16
    v_alignbit_b32 v71, v72, v71, 16
    v_alignbit_b32 v72, v73, v72, 16
    v_alignbit_b32 v73, v74, v73, 16
    ds_write_b128 v26, v[70:73] offset:5216
    v_alignbit_b32 v76, v77, v76, 16
    v_alignbit_b32 v77, v78, v77, 16
    v_alignbit_b32 v78, v79, v78, 16
    v_alignbit_b32 v79, v80, v79, 16
    ds_write_b128 v26, v[76:79] offset:6240
    v_alignbit_b32 v82, v83, v82, 16
    v_alignbit_b32 v83, v84, v83, 16
    v_alignbit_b32 v84, v85, v84, 16
    v_alignbit_b32 v85, v86, v85, 16
    ds_write_b128 v26, v[82:85] offset:7264
    buffer_load_dword v29, v28, s[44:47], 0 offen offset:0 sc1
    s_waitcnt vmcnt(9) lgkmcnt(6)
    v_lshlrev_b32 v1, 16, v88
    v_lshlrev_b32 v145, 16, v145
    v_add_f32 v1, v1, v145
    v_cvt_pk_bf16_f32 v1, v1, v1
    ds_write_b16 v27, v1 offset:33280
    ds_write_b16 v27, v1 offset:37438
    v_alignbit_b32 v88, v89, v88, 16
    v_alignbit_b32 v89, v90, v89, 16
    v_alignbit_b32 v90, v91, v90, 16
    v_alignbit_b32 v91, v92, v91, 16
    ds_write_b128 v26, v[88:91] offset:37472
    v_alignbit_b32 v94, v95, v94, 16
    v_alignbit_b32 v95, v96, v95, 16
    v_alignbit_b32 v96, v97, v96, 16
    v_alignbit_b32 v97, v98, v97, 16
    ds_write_b128 v26, v[94:97] offset:38496
    v_alignbit_b32 v100, v101, v100, 16
    v_alignbit_b32 v101, v102, v101, 16
    v_alignbit_b32 v102, v103, v102, 16
    v_alignbit_b32 v103, v104, v103, 16
    ds_write_b128 v26, v[100:103] offset:39520
    v_alignbit_b32 v106, v107, v106, 16
    v_alignbit_b32 v107, v108, v107, 16
    v_alignbit_b32 v108, v109, v108, 16
    v_alignbit_b32 v109, v110, v109, 16
    ds_write_b128 v26, v[106:109] offset:40544
    v_and_b32 v1, 15, v2
    v_lshlrev_b32 v1, 1, v1
    v_sub_u32 v1, v1, v31
    v_add_u32 v1, 17, v1
    v_bfe_u32 v3, v1, 1, 3
    v_xor_b32 v3, s3, v3
    v_lshlrev_b32 v3, 4, v3
    v_lshl_add_u32 v16, v1, 7, v3
    v_and_b32 v1, 15, v2
    v_lshlrev_b32 v1, 1, v1
    v_sub_u32 v1, v1, v31
    v_add_u32 v1, 13, v1
    v_bfe_u32 v3, v1, 1, 3
    v_xor_b32 v3, s3, v3
    v_lshlrev_b32 v3, 4, v3
    v_lshl_add_u32 v17, v1, 7, v3
    v_and_b32 v1, 15, v2
    v_lshlrev_b32 v1, 1, v1
    v_sub_u32 v1, v1, v31
    v_add_u32 v1, 9, v1
    v_bfe_u32 v3, v1, 1, 3
    v_xor_b32 v3, s3, v3
    v_lshlrev_b32 v3, 4, v3
    v_lshl_add_u32 v18, v1, 7, v3
    v_and_b32 v1, 15, v2
    v_lshlrev_b32 v1, 1, v1
    v_sub_u32 v1, v1, v31
    v_add_u32 v1, 5, v1
    v_bfe_u32 v3, v1, 1, 3
    v_xor_b32 v3, s3, v3
    v_lshlrev_b32 v3, 4, v3
    v_lshl_add_u32 v19, v1, 7, v3
    v_and_b32 v1, 15, v2
    v_lshlrev_b32 v1, 5, v1
    v_lshl_add_u32 v20, v31, 3, v1
    s_lshr_b32 s9, s19, 4
    s_mul_i32 s8, s9, 43
    s_lshr_b32 s8, s8, 7
    s_add_u32 s7, s9, s8
    s_mul_i32 s8, s8, 3
    s_sub_u32 s8, s9, s8
    s_min_u32 s8, s8, 1
    s_add_u32 s7, s7, s8
    s_lshl_b32 s7, s7, 8
    s_and_b32 s8, s19, 8
    s_lshl4_add_u32 s7, s8, s7
    s_mul_i32 s8, s3, 786432
    s_add_u32 s7, s7, s8
    s_add_u32 s7, s7, 3211264
    s_lshl_b32 s9, s3, 13
    s_add_u32 s9, s9, 4096
    s_lshl_b32 s15, s30, 12
    s_add_u32 s15, s15, 6356992
    s_waitcnt lgkmcnt(0)
    ds_read2_b32 v[64:65], v4 offset0:0 offset1:1
    ds_read2_b32 v[66:67], v4 offset0:2 offset1:3
    ds_read2_b32 v[68:69], v4 offset0:128 offset1:129
    ds_read2_b32 v[70:71], v4 offset0:130 offset1:131
    ds_read2_b32 v[72:73], v5 offset0:0 offset1:1
    ds_read2_b32 v[74:75], v5 offset0:2 offset1:3
    ds_read2_b32 v[76:77], v5 offset0:128 offset1:129
    ds_read2_b32 v[78:79], v5 offset0:130 offset1:131
    ds_read2_b32 v[80:81], v6 offset0:0 offset1:1
    ds_read2_b32 v[82:83], v6 offset0:2 offset1:3
    ds_read2_b32 v[84:85], v6 offset0:128 offset1:129
    ds_read2_b32 v[86:87], v6 offset0:130 offset1:131
    ds_read2_b32 v[88:89], v7 offset0:0 offset1:1
    ds_read2_b32 v[90:91], v7 offset0:2 offset1:3
    ds_read2_b32 v[92:93], v7 offset0:128 offset1:129
    ds_read2_b32 v[94:95], v7 offset0:130 offset1:131
    s_waitcnt vmcnt(0)
    v_cmp_ne_u32 vcc, s16, v29
    s_cbranch_vccnz L_rs_pkX
L_ok_pkX:
    s_add_u32 m0, s9, 0
    s_add_u32 s14, s7, 0
    buffer_load_dwordx4 v14, s[44:47], s14 offen sc1 lds
    s_add_u32 m0, s9, 1024
    s_add_u32 s14, s7, 98304
    buffer_load_dwordx4 v15, s[44:47], s14 offen sc1 lds
    s_add_u32 m0, s9, 2048
    s_add_u32 s14, s7, 196608
    buffer_load_dwordx4 v14, s[44:47], s14 offen sc1 lds
    s_add_u32 m0, s9, 3072
    s_add_u32 s14, s7, 294912
    buffer_load_dwordx4 v15, s[44:47], s14 offen sc1 lds
    s_add_u32 m0, s9, 4096
    s_add_u32 s14, s7, 393216
    buffer_load_dwordx4 v14, s[44:47], s14 offen sc1 lds
    s_add_u32 m0, s9, 5120
    s_add_u32 s14, s7, 491520
    buffer_load_dwordx4 v15, s[44:47], s14 offen sc1 lds
    s_add_u32 m0, s9, 6144
    s_add_u32 s14, s7, 589824
    buffer_load_dwordx4 v14, s[44:47], s14 offen sc1 lds
    s_add_u32 m0, s9, 7168
    s_add_u32 s14, s7, 688128
    buffer_load_dwordx4 v15, s[44:47], s14 offen sc1 lds
    s_waitcnt vmcnt(0) lgkmcnt(0)
    s_barrier
    ds_read_b128 v[96:99], v16 offset:2048
    ds_read_b128 v[100:103], v16 offset:6144
    ds_read_b128 v[104:107], v16 offset:10240
    ds_read_b128 v[108:111], v16 offset:14336
    ds_read_b128 v[112:115], v16 offset:18432
    ds_read_b128 v[116:119], v16 offset:22528
    ds_read_b128 v[120:123], v16 offset:26624
    ds_read_b128 v[124:127], v16 offset:30720
    ds_read_b64_tr_b16 v[156:157], v12 offset:0
    ds_read_b64_tr_b16 v[158:159], v12 offset:1024
    ds_read_b64_tr_b16 v[160:161], v13 offset:0
    ds_read_b64_tr_b16 v[162:163], v13 offset:1024
    ds_read_b64_tr_b16 v[164:165], v12 offset:8192
    ds_read_b64_tr_b16 v[166:167], v12 offset:9216
    ds_read_b64_tr_b16 v[168:169], v13 offset:8192
    ds_read_b64_tr_b16 v[170:171], v13 offset:9216
    ds_read_b64_tr_b16 v[172:173], v12 offset:16384
    ds_read_b64_tr_b16 v[174:175], v12 offset:17408
    ds_read_b64_tr_b16 v[176:177], v13 offset:16384
    ds_read_b64_tr_b16 v[178:179], v13 offset:17408
    ds_read_b64_tr_b16 v[180:181], v12 offset:24576
    ds_read_b64_tr_b16 v[182:183], v12 offset:25600
    ds_read_b64_tr_b16 v[184:185], v13 offset:24576
    ds_read_b64_tr_b16 v[186:187], v13 offset:25600
    s_waitcnt lgkmcnt(15)
    v_mfma_f32_16x16x32_bf16 v[32:35], v[64:67], v[96:99], 0
    s_mov_b32 s64, s38
    ds_read_b128 a[224:227], v17 offset:2048
    v_mfma_f32_16x16x32_bf16 v[36:39], v[68:71], v[96:99], 0
    s_and_b32 s65, s39, 0xffff
    v_mfma_f32_16x16x32_bf16 v[36:39], v[64:67], v[100:103], v[36:39]
    s_mov_b32 s66, 2359296
    ds_read2_b32 a[192:193], v4 offset0:16 offset1:17
    v_mfma_f32_16x16x32_bf16 v[40:43], v[64:67], v[104:107], 0
    ds_read2_b32 a[194:195], v4 offset0:18 offset1:19
    v_mfma_f32_16x16x32_bf16 v[40:43], v[68:71], v[100:103], v[40:43]
    s_mov_b32 s67, 0x20000
    v_mfma_f32_16x16x32_bf16 v[40:43], v[72:75], v[96:99], v[40:43]
    s_cmp_lt_u32 s3, 2
    s_cselect_b32 s4, s40, s41
    ds_read_b128 a[228:231], v17 offset:6144
    v_mfma_f32_16x16x32_bf16 v[44:47], v[76:79], v[96:99], 0
    s_lshr_b32 s4, s4, 1
    ds_read2_b32 a[196:197], v4 offset0:144 offset1:145
    v_mfma_f32_16x16x32_bf16 v[44:47], v[72:75], v[100:103], v[44:47]
    s_and_b32 s5, s3, 1
    v_mfma_f32_16x16x32_bf16 v[44:47], v[68:71], v[104:107], v[44:47]
    s_lshl_b32 s5, s5, 5
    ds_read2_b32 a[198:199], v4 offset0:146 offset1:147
    v_mfma_f32_16x16x32_bf16 v[44:47], v[64:67], v[108:111], v[44:47]
    s_add_u32 s4, s4, s5
    ds_read_b128 a[232:235], v17 offset:10240
    v_mfma_f32_16x16x32_bf16 v[48:51], v[64:67], v[112:115], 0
    ds_read2_b32 a[200:201], v5 offset0:16 offset1:17
    v_and_b32 v1, 15, v2
    v_mfma_f32_16x16x32_bf16 v[48:51], v[68:71], v[108:111], v[48:51]
    v_mfma_f32_16x16x32_bf16 v[48:51], v[72:75], v[104:107], v[48:51]
    ds_read2_b32 a[202:203], v5 offset0:18 offset1:19
    v_add_u32 v1, s4, v1
    v_mfma_f32_16x16x32_bf16 v[48:51], v[76:79], v[100:103], v[48:51]
    ds_read_b128 a[236:239], v17 offset:14336
    v_lshlrev_b32 v14, 3, v1
    v_mfma_f32_16x16x32_bf16 v[48:51], v[80:83], v[96:99], v[48:51]
    s_and_b32 s9, s23, 1
    v_mfma_f32_16x16x32_bf16 v[52:55], v[84:87], v[96:99], 0
    s_sub_u32 s26, 0, s9
    ds_read2_b32 a[204:205], v5 offset0:144 offset1:145
    v_mfma_f32_16x16x32_bf16 v[52:55], v[80:83], v[100:103], v[52:55]
    s_sub_u32 s27, 0, s9
    ds_read2_b32 a[206:207], v5 offset0:146 offset1:147
    v_mfma_f32_16x16x32_bf16 v[52:55], v[76:79], v[104:107], v[52:55]
    v_mul_u32_u24 v1, 1152, v1
    v_mfma_f32_16x16x32_bf16 v[52:55], v[72:75], v[108:111], v[52:55]
    s_and_b32 s6, s22, 1
    ds_read_b128 a[240:243], v17 offset:18432
    v_mfma_f32_16x16x32_bf16 v[52:55], v[68:71], v[112:115], v[52:55]
    ds_read2_b32 a[208:209], v6 offset0:16 offset1:17
    v_mfma_f32_16x16x32_bf16 v[52:55], v[64:67], v[116:119], v[52:55]
    s_movk_i32 s7, 5971
    v_mfma_f32_16x16x32_bf16 v[56:59], v[64:67], v[120:123], 0
    s_cmp_eq_u32 s6, 0
    s_cselect_b32 s7, 25632, s7
    ds_read2_b32 a[210:211], v6 offset0:18 offset1:19
    v_mfma_f32_16x16x32_bf16 v[56:59], v[68:71], v[116:119], v[56:59]
    s_lshl_b32 s8, s23, 2
    ds_read_b128 a[244:247], v17 offset:22528
    v_mfma_f32_16x16x32_bf16 v[56:59], v[72:75], v[112:115], v[56:59]
    s_lshr_b32 s7, s7, s8
    v_mfma_f32_16x16x32_bf16 v[56:59], v[76:79], v[108:111], v[56:59]
    s_and_b32 s7, s7, 15
    ds_read2_b32 a[212:213], v6 offset0:144 offset1:145
    v_mfma_f32_16x16x32_bf16 v[56:59], v[80:83], v[104:107], v[56:59]
    s_mul_i32 s8, s22, 9
    ds_read2_b32 a[214:215], v6 offset0:146 offset1:147
    v_mfma_f32_16x16x32_bf16 v[56:59], v[84:87], v[100:103], v[56:59]
    ds_read_b128 a[248:251], v17 offset:26624
    v_mfma_f32_16x16x32_bf16 v[56:59], v[88:91], v[96:99], v[56:59]
    s_add_u32 s7, s7, s8
    v_mfma_f32_16x16x32_bf16 v[60:63], v[92:95], v[96:99], 0
    s_xor_b32 s6, s6, 1
    ds_read2_b32 a[216:217], v7 offset0:16 offset1:17
    v_mfma_f32_16x16x32_bf16 v[60:63], v[88:91], v[100:103], v[60:63]
    s_lshl3_add_u32 s6, s6, s8
    ds_read2_b32 a[218:219], v7 offset0:18 offset1:19
    v_mfma_f32_16x16x32_bf16 v[60:63], v[84:87], v[104:107], v[60:63]
    s_lshl_b32 s8, s7, 5
    v_mfma_f32_16x16x32_bf16 v[60:63], v[80:83], v[108:111], v[60:63]
    ds_read_b128 a[252:255], v17 offset:30720
    v_bfe_u32 v3, v2, 4, 1
    v_mfma_f32_16x16x32_bf16 v[60:63], v[76:79], v[112:115], v[60:63]
    ds_read2_b32 a[220:221], v7 offset0:144 offset1:145
    v_lshl_add_u32 v3, v3, 5, v1
    v_mfma_f32_16x16x32_bf16 v[60:63], v[72:75], v[116:119], v[60:63]
    v_lshrrev_b32 v31, 5, v2
    v_mfma_f32_16x16x32_bf16 v[60:63], v[68:71], v[120:123], v[60:63]
    ds_read2_b32 a[222:223], v7 offset0:146 offset1:147
    v_mfma_f32_16x16x32_bf16 v[60:63], v[64:67], v[124:127], v[60:63]
    s_waitcnt lgkmcnt(12)
    s_barrier
    v_lshl_add_u32 v3, v31, 4, v3
    v_mfma_f32_16x16x32_bf16 v[32:35], a[192:195], a[224:227], v[32:35]
    ds_read_b128 v[96:99], v18 offset:2048
    v_add_u32 v144, s8, v3
    v_mfma_f32_16x16x32_bf16 v[36:39], a[196:199], a[224:227], v[36:39]
    s_add_u32 m0, s20, 147456
    s_mul_i32 s8, s9, 18432
    v_mfma_f32_16x16x32_bf16 v[36:39], a[192:195], a[228:231], v[36:39]
    s_lshl_b32 s14, s86, 1
    ds_read2_b32 v[64:65], v4 offset0:32 offset1:33
    s_lshl_b32 s5, s6, 5
    v_mfma_f32_16x16x32_bf16 v[40:43], a[192:195], a[232:235], v[40:43]
    s_add_u32 s8, s8, s5
    ds_read2_b32 v[66:67], v4 offset0:34 offset1:35
    v_lshrrev_b32 v3, 4, v2
    v_mfma_f32_16x16x32_bf16 v[40:43], a[196:199], a[228:231], v[40:43]
    buffer_load_dwordx4 v8, s[52:55], s14 offen offset:0 lds
    v_lshl_add_u32 v3, v3, 3, v1
    v_mfma_f32_16x16x32_bf16 v[40:43], a[200:203], a[224:227], v[40:43]
    ds_read_b128 v[100:103], v18 offset:6144
    v_add_u32 v3, s8, v3
    v_mfma_f32_16x16x32_bf16 v[44:47], a[204:207], a[224:227], v[44:47]
    s_lshr_b32 s8, s23, 1
    ds_read2_b32 v[68:69], v4 offset0:160 offset1:161
    v_mov_b32 v1, 0x40000000
    v_mfma_f32_16x16x32_bf16 v[44:47], a[200:203], a[228:231], v[44:47]
    v_cmp_eq_u32 vcc, s8, v31
    s_nop 1
    v_cndmask_b32 v145, v1, v3, vcc
    v_mfma_f32_16x16x32_bf16 v[44:47], a[196:199], a[232:235], v[44:47]
    ds_read2_b32 v[70:71], v4 offset0:162 offset1:163
    buffer_load_dwordx4 v9, s[52:55], s14 offen offset:1024 lds
    v_mfma_f32_16x16x32_bf16 v[44:47], a[192:195], a[236:239], v[44:47]
    s_waitcnt lgkmcnt(6)
    ds_read_b128 v[104:107], v18 offset:10240
    v_mfma_f32_16x16x32_bf16 v[48:51], a[192:195], a[240:243], v[48:51]
    ds_read2_b32 v[72:73], v5 offset0:32 offset1:33
    v_mfma_f32_16x16x32_bf16 v[48:51], a[196:199], a[236:239], v[48:51]
    s_lshl_b32 s36, s7, 16
    buffer_load_dwordx4 v10, s[52:55], s14 offen offset:2048 lds
    v_mfma_f32_16x16x32_bf16 v[48:51], a[200:203], a[232:235], v[48:51]
    s_add_u32 s36, s36, 6356992
    ds_read2_b32 v[74:75], v5 offset0:34 offset1:35
    v_mfma_f32_16x16x32_bf16 v[48:51], a[204:207], a[228:231], v[48:51]
    ds_read_b128 v[108:111], v18 offset:14336
    v_mfma_f32_16x16x32_bf16 v[48:51], a[208:211], a[224:227], v[48:51]
    s_lshl_b32 s37, s6, 16
    v_mfma_f32_16x16x32_bf16 v[52:55], a[212:215], a[224:227], v[52:55]
    s_add_u32 s37, s37, 6356992
    ds_read2_b32 v[76:77], v5 offset0:160 offset1:161
    buffer_load_dwordx4 v11, s[52:55], s14 offen offset:3072 lds
    v_mfma_f32_16x16x32_bf16 v[52:55], a[208:211], a[228:231], v[52:55]
    ds_read2_b32 v[78:79], v5 offset0:162 offset1:163
    v_mov_b32 v3, s40
    v_mfma_f32_16x16x32_bf16 v[52:55], a[204:207], a[232:235], v[52:55]
    v_mov_b32 v31, s41
    v_mfma_f32_16x16x32_bf16 v[52:55], a[200:203], a[236:239], v[52:55]
    ds_read_b128 v[112:115], v18 offset:18432
    v_and_b32 v1, 8, v2
    v_mfma_f32_16x16x32_bf16 v[52:55], a[196:199], a[240:243], v[52:55]
    ds_read2_b32 v[80:81], v6 offset0:32 offset1:33
    v_mfma_f32_16x16x32_bf16 v[52:55], a[192:195], a[244:247], v[52:55]
    v_cmp_lt_u32 vcc, 0, v1
    s_nop 1
    v_cndmask_b32 v3, v3, v31, vcc
    v_mfma_f32_16x16x32_bf16 v[56:59], a[192:195], a[248:251], v[56:59]
    ds_read2_b32 v[82:83], v6 offset0:34 offset1:35
    v_and_b32 v1, 7, v2
    v_mfma_f32_16x16x32_bf16 v[56:59], a[196:199], a[244:247], v[56:59]
    ds_read_b128 v[116:119], v18 offset:22528
    v_lshl_add_u32 v3, v1, 4, v3
    v_mfma_f32_16x16x32_bf16 v[56:59], a[200:203], a[240:243], v[56:59]
    v_lshrrev_b32 v1, 4, v2
    v_mfma_f32_16x16x32_bf16 v[56:59], a[204:207], a[236:239], v[56:59]
    ds_read2_b32 v[84:85], v6 offset0:160 offset1:161
    v_lshl_add_u32 v3, v1, 12, v3
    v_mfma_f32_16x16x32_bf16 v[56:59], a[208:211], a[232:235], v[56:59]
    s_lshl_b32 s8, s3, 14
    ds_read2_b32 v[86:87], v6 offset0:162 offset1:163
    v_mfma_f32_16x16x32_bf16 v[56:59], a[212:215], a[228:231], v[56:59]
    ds_read_b128 v[120:123], v18 offset:26624
    v_add_u32 v155, s8, v3
    v_mfma_f32_16x16x32_bf16 v[56:59], a[216:219], a[224:227], v[56:59]
    v_lshrrev_b32 v1, 2, v2
    v_mfma_f32_16x16x32_bf16 v[60:63], a[220:223], a[224:227], v[60:63]
    ds_read2_b32 v[88:89], v7 offset0:32 offset1:33
    v_mfma_f32_16x16x32_bf16 v[60:63], a[216:219], a[228:231], v[60:63]
    ds_read2_b32 v[90:91], v7 offset0:34 offset1:35
    v_lshlrev_b32 v1, 8, v1
    v_mfma_f32_16x16x32_bf16 v[60:63], a[212:215], a[232:235], v[60:63]
    v_and_b32 v3, 3, v2
    v_mfma_f32_16x16x32_bf16 v[60:63], a[208:211], a[236:239], v[60:63]
    ds_read_b128 v[124:127], v18 offset:30720
    v_lshl_add_u32 v1, v3, 3, v1
    v_mfma_f32_16x16x32_bf16 v[60:63], a[204:207], a[240:243], v[60:63]
    s_lshl_b32 s8, s3, 6
    ds_read2_b32 v[92:93], v7 offset0:160 offset1:161
    v_mfma_f32_16x16x32_bf16 v[60:63], a[200:203], a[244:247], v[60:63]
    v_add_u32 v252, s8, v1
    v_mfma_f32_16x16x32_bf16 v[60:63], a[196:199], a[248:251], v[60:63]
    ds_read2_b32 v[94:95], v7 offset0:162 offset1:163
    v_min_u32 v1, 17, v2
L_pl_X_3:
    s_cbranch_execz L_wret
    v_mfma_f32_16x16x32_bf16 v[60:63], a[192:195], a[252:255], v[60:63]
    s_waitcnt lgkmcnt(12)
    s_barrier
    v_lshrrev_b32 v3, 1, v1
    v_mfma_f32_16x16x32_bf16 v[32:35], v[64:67], v[96:99], v[32:35]
    ds_read_b128 a[224:227], v19 offset:2048
    v_mfma_f32_16x16x32_bf16 v[36:39], v[68:71], v[96:99], v[36:39]
    s_add_u32 m0, s20, 114688
    v_and_b32 v1, 1, v1
    v_mfma_f32_16x16x32_bf16 v[36:39], v[64:67], v[100:103], v[36:39]
    s_lshl_b32 s14, s87, 1
    ds_read2_b32 a[192:193], v4 offset0:48 offset1:49
    v_lshlrev_b32 v3, 8, v3
    v_mfma_f32_16x16x32_bf16 v[40:43], v[64:67], v[104:107], v[40:43]
    ds_read2_b32 a[194:195], v4 offset0:50 offset1:51
    v_lshl_add_u32 v3, v1, 2, v3
    v_mfma_f32_16x16x32_bf16 v[40:43], v[68:71], v[100:103], v[40:43]
    s_mul_i32 s8, s23, 18
    buffer_load_dwordx4 v8, s[52:55], s14 offen offset:0 lds
    v_mfma_f32_16x16x32_bf16 v[40:43], v[72:75], v[96:99], v[40:43]
    s_lshr_b32 s5, s22, 1
    ds_read_b128 a[228:231], v19 offset:6144
    v_mfma_f32_16x16x32_bf16 v[44:47], v[76:79], v[96:99], v[44:47]
    s_add_u32 s8, s8, s5
    ds_read2_b32 a[196:197], v4 offset0:176 offset1:177
    v_mfma_f32_16x16x32_bf16 v[44:47], v[72:75], v[100:103], v[44:47]
    s_lshl_b32 s8, s8, 5
    v_mfma_f32_16x16x32_bf16 v[44:47], v[68:71], v[104:107], v[44:47]
    ds_read2_b32 a[198:199], v4 offset0:178 offset1:179
    buffer_load_dwordx4 v9, s[52:55], s14 offen offset:1024 lds
    v_mfma_f32_16x16x32_bf16 v[44:47], v[64:67], v[108:111], v[44:47]
    s_waitcnt lgkmcnt(6)
    s_and_b32 s5, s22, 1
    ds_read_b128 a[232:235], v19 offset:10240
    v_mfma_f32_16x16x32_bf16 v[48:51], v[64:67], v[112:115], v[48:51]
    s_add_u32 s8, s8, s5
    ds_read2_b32 a[200:201], v5 offset0:48 offset1:49
    v_mfma_f32_16x16x32_bf16 v[48:51], v[68:71], v[108:111], v[48:51]
    s_lshl_b32 s8, s8, 2
    buffer_load_dwordx4 v10, s[52:55], s14 offen offset:2048 lds
    v_mfma_f32_16x16x32_bf16 v[48:51], v[72:75], v[104:107], v[48:51]
    s_add_u32 s8, s8, 8994816
    ds_read2_b32 a[202:203], v5 offset0:50 offset1:51
    v_mfma_f32_16x16x32_bf16 v[48:51], v[76:79], v[100:103], v[48:51]
    ds_read_b128 a[236:239], v19 offset:14336
    v_add_u32 v26, s8, v3
    v_mfma_f32_16x16x32_bf16 v[48:51], v[80:83], v[96:99], v[48:51]
    s_mov_b32 s6, 241306688
    v_mfma_f32_16x16x32_bf16 v[52:55], v[84:87], v[96:99], v[52:55]
    ds_read2_b32 a[204:205], v5 offset0:176 offset1:177
    buffer_load_dwordx4 v11, s[52:55], s14 offen offset:3072 lds
    v_mfma_f32_16x16x32_bf16 v[52:55], v[80:83], v[100:103], v[52:55]
    s_mov_b32 s7, 2898
    ds_read2_b32 a[206:207], v5 offset0:178 offset1:179
    v_mfma_f32_16x16x32_bf16 v[52:55], v[76:79], v[104:107], v[52:55]
    s_bitcmp1_b32 s22, 0
    s_cselect_b32 s6, 2942979664, s6
    s_cselect_b32 s7, 3195, s7
    v_mfma_f32_16x16x32_bf16 v[52:55], v[72:75], v[108:111], v[52:55]
    s_mov_b32 s83, 2348962
    ds_read_b128 a[240:243], v19 offset:18432
    v_mfma_f32_16x16x32_bf16 v[52:55], v[68:71], v[112:115], v[52:55]
    s_cmp_eq_u32 s23, 1
    s_cselect_b32 s83, 6880132, s83
    ds_read2_b32 a[208:209], v6 offset0:48 offset1:49
    v_mfma_f32_16x16x32_bf16 v[52:55], v[64:67], v[116:119], v[52:55]
    s_cmp_eq_u32 s23, 2
    s_cselect_b32 s83, 11640720, s83
    v_mfma_f32_16x16x32_bf16 v[56:59], v[64:67], v[120:123], v[56:59]
    s_cmp_eq_u32 s23, 3
    s_cselect_b32 s83, 16429840, s83
    ds_read2_b32 a[210:211], v6 offset0:50 offset1:51
    v_mfma_f32_16x16x32_bf16 v[56:59], v[68:71], v[116:119], v[56:59]
    s_and_b32 s12, s3, 1
    ds_read_b128 a[244:247], v19 offset:22528
    v_mfma_f32_16x16x32_bf16 v[56:59], v[72:75], v[112:115], v[56:59]
    v_mfma_f32_16x16x32_bf16 v[56:59], v[76:79], v[108:111], v[56:59]
    s_mul_i32 s12, s12, 49152
    ds_read2_b32 a[212:213], v6 offset0:176 offset1:177
    v_mfma_f32_16x16x32_bf16 v[56:59], v[80:83], v[104:107], v[56:59]
    s_lshr_b32 s4, s22, 1
    ds_read2_b32 a[214:215], v6 offset0:178 offset1:179
    v_mfma_f32_16x16x32_bf16 v[56:59], v[84:87], v[100:103], v[56:59]
    s_mul_i32 s4, s4, 6144
    ds_read_b128 a[248:251], v19 offset:26624
    v_mfma_f32_16x16x32_bf16 v[56:59], v[88:91], v[96:99], v[56:59]
    s_add_u32 s12, s12, s4
    v_mfma_f32_16x16x32_bf16 v[60:63], v[92:95], v[96:99], v[60:63]
    s_add_u32 s12, s12, 22872064
    ds_read2_b32 a[216:217], v7 offset0:48 offset1:49
    v_mfma_f32_16x16x32_bf16 v[60:63], v[88:91], v[100:103], v[60:63]
    s_lshr_b32 s4, s7, 8
    ds_read2_b32 a[218:219], v7 offset0:50 offset1:51
    v_mfma_f32_16x16x32_bf16 v[60:63], v[84:87], v[104:107], v[60:63]
    s_and_b32 s4, s4, 31
    v_mfma_f32_16x16x32_bf16 v[60:63], v[80:83], v[108:111], v[60:63]
    ds_read_b128 a[252:255], v19 offset:30720
    v_mfma_f32_16x16x32_bf16 v[60:63], v[76:79], v[112:115], v[60:63]
    s_lshl_b32 s4, s4, 8
    ds_read2_b32 a[220:221], v7 offset0:176 offset1:177
    v_mfma_f32_16x16x32_bf16 v[60:63], v[72:75], v[116:119], v[60:63]
    s_add_u32 s68, s4, s12
    v_mfma_f32_16x16x32_bf16 v[60:63], v[68:71], v[120:123], v[60:63]
    s_bfe_u32 s4, s83, 0x30000
    ds_read2_b32 a[222:223], v7 offset0:178 offset1:179
    v_mfma_f32_16x16x32_bf16 v[60:63], v[64:67], v[124:127], v[60:63]
    s_waitcnt lgkmcnt(12)
    s_barrier
    s_mul_i32 s4, s4, 5
    v_mfma_f32_16x16x32_bf16 v[32:35], a[192:195], a[224:227], v[32:35]
    s_lshr_b64 s[4:5], s[6:7], s4
    ds_read_b128 v[96:99], v16 offset:0
    v_mfma_f32_16x16x32_bf16 v[36:39], a[196:199], a[224:227], v[36:39]
    s_add_u32 m0, s20, 131072
    s_and_b32 s4, s4, 31
    v_mfma_f32_16x16x32_bf16 v[36:39], a[192:195], a[228:231], v[36:39]
    s_lshl_b32 s14, s88, 1
    ds_read2_b32 v[64:65], v4 offset0:64 offset1:65
    v_mfma_f32_16x16x32_bf16 v[40:43], a[192:195], a[232:235], v[40:43]
    s_lshl_b32 s4, s4, 8
    ds_read2_b32 v[66:67], v4 offset0:66 offset1:67
    v_mfma_f32_16x16x32_bf16 v[40:43], a[196:199], a[228:231], v[40:43]
    s_add_u32 s69, s4, s12
    buffer_load_dwordx4 v8, s[52:55], s14 offen offset:0 lds
    v_mfma_f32_16x16x32_bf16 v[40:43], a[200:203], a[224:227], v[40:43]
    s_cmp_lt_u32 s3, 2
    s_cselect_b32 s68, s68, s69
    ds_read_b128 v[100:103], v16 offset:4096
    v_mfma_f32_16x16x32_bf16 v[44:47], a[204:207], a[224:227], v[44:47]
    s_bfe_u32 s4, s83, 0x30003
    ds_read2_b32 v[68:69], v4 offset0:192 offset1:193
    v_mfma_f32_16x16x32_bf16 v[44:47], a[200:203], a[228:231], v[44:47]
    s_mul_i32 s4, s4, 5
    v_mfma_f32_16x16x32_bf16 v[44:47], a[196:199], a[232:235], v[44:47]
    s_lshr_b64 s[4:5], s[6:7], s4
    ds_read2_b32 v[70:71], v4 offset0:194 offset1:195
    buffer_load_dwordx4 v9, s[52:55], s14 offen offset:1024 lds
    v_mfma_f32_16x16x32_bf16 v[44:47], a[192:195], a[236:239], v[44:47]
    s_waitcnt lgkmcnt(6)
    s_and_b32 s4, s4, 31
    ds_read_b128 v[104:107], v16 offset:8192
    v_mfma_f32_16x16x32_bf16 v[48:51], a[192:195], a[240:243], v[48:51]
    ds_read2_b32 v[72:73], v5 offset0:64 offset1:65
    v_mfma_f32_16x16x32_bf16 v[48:51], a[196:199], a[236:239], v[48:51]
    s_lshl_b32 s4, s4, 8
    buffer_load_dwordx4 v10, s[52:55], s14 offen offset:2048 lds
    v_mfma_f32_16x16x32_bf16 v[48:51], a[200:203], a[232:235], v[48:51]
    s_add_u32 s70, s4, s12
    ds_read2_b32 v[74:75], v5 offset0:66 offset1:67
    v_mfma_f32_16x16x32_bf16 v[48:51], a[204:207], a[228:231], v[48:51]
    s_bfe_u32 s4, s83, 0x30006
    ds_read_b128 v[108:111], v16 offset:12288
    v_mfma_f32_16x16x32_bf16 v[48:51], a[208:211], a[224:227], v[48:51]
    s_mul_i32 s4, s4, 5
    v_mfma_f32_16x16x32_bf16 v[52:55], a[212:215], a[224:227], v[52:55]
    s_lshr_b64 s[4:5], s[6:7], s4
    ds_read2_b32 v[76:77], v5 offset0:192 offset1:193
    buffer_load_dwordx4 v11, s[52:55], s14 offen offset:3072 lds
    v_mfma_f32_16x16x32_bf16 v[52:55], a[208:211], a[228:231], v[52:55]
    s_and_b32 s4, s4, 31
    ds_read2_b32 v[78:79], v5 offset0:194 offset1:195
    v_mfma_f32_16x16x32_bf16 v[52:55], a[204:207], a[232:235], v[52:55]
    v_mfma_f32_16x16x32_bf16 v[52:55], a[200:203], a[236:239], v[52:55]
    s_lshl_b32 s4, s4, 8
    ds_read_b128 v[112:115], v16 offset:16384
    v_mfma_f32_16x16x32_bf16 v[52:55], a[196:199], a[240:243], v[52:55]
    s_add_u32 s71, s4, s12
    ds_read2_b32 v[80:81], v6 offset0:64 offset1:65
    v_mfma_f32_16x16x32_bf16 v[52:55], a[192:195], a[244:247], v[52:55]
    s_bfe_u32 s4, s83, 0x30009
    v_mfma_f32_16x16x32_bf16 v[56:59], a[192:195], a[248:251], v[56:59]
    s_mul_i32 s4, s4, 5
    ds_read2_b32 v[82:83], v6 offset0:66 offset1:67
    v_mfma_f32_16x16x32_bf16 v[56:59], a[196:199], a[244:247], v[56:59]
    s_lshr_b64 s[4:5], s[6:7], s4
    ds_read_b128 v[116:119], v16 offset:20480
    v_mfma_f32_16x16x32_bf16 v[56:59], a[200:203], a[240:243], v[56:59]
    s_and_b32 s4, s4, 31
    v_mfma_f32_16x16x32_bf16 v[56:59], a[204:207], a[236:239], v[56:59]
    s_lshl_b32 s4, s4, 8
    ds_read2_b32 v[84:85], v6 offset0:192 offset1:193
    v_mfma_f32_16x16x32_bf16 v[56:59], a[208:211], a[232:235], v[56:59]
    ds_read2_b32 v[86:87], v6 offset0:194 offset1:195
    v_mfma_f32_16x16x32_bf16 v[56:59], a[212:215], a[228:231], v[56:59]
    s_add_u32 s72, s4, s12
    ds_read_b128 v[120:123], v16 offset:24576
    v_mfma_f32_16x16x32_bf16 v[56:59], a[216:219], a[224:227], v[56:59]
    s_bfe_u32 s4, s83, 0x3000c
    v_mfma_f32_16x16x32_bf16 v[60:63], a[220:223], a[224:227], v[60:63]
    s_mul_i32 s4, s4, 5
    ds_read2_b32 v[88:89], v7 offset0:64 offset1:65
    v_mfma_f32_16x16x32_bf16 v[60:63], a[216:219], a[228:231], v[60:63]
    s_lshr_b64 s[4:5], s[6:7], s4
    ds_read2_b32 v[90:91], v7 offset0:66 offset1:67
    v_mfma_f32_16x16x32_bf16 v[60:63], a[212:215], a[232:235], v[60:63]
    s_and_b32 s4, s4, 31
    v_mfma_f32_16x16x32_bf16 v[60:63], a[208:211], a[236:239], v[60:63]
    s_lshl_b32 s4, s4, 8
    ds_read_b128 v[124:127], v16 offset:28672
    v_mfma_f32_16x16x32_bf16 v[60:63], a[204:207], a[240:243], v[60:63]
    s_add_u32 s73, s4, s12
    ds_read2_b32 v[92:93], v7 offset0:192 offset1:193
    v_mfma_f32_16x16x32_bf16 v[60:63], a[200:203], a[244:247], v[60:63]
    v_mfma_f32_16x16x32_bf16 v[60:63], a[196:199], a[248:251], v[60:63]
    s_bfe_u32 s4, s83, 0x3000f
    ds_read2_b32 v[94:95], v7 offset0:194 offset1:195
    v_mfma_f32_16x16x32_bf16 v[60:63], a[192:195], a[252:255], v[60:63]
    s_waitcnt vmcnt(8) lgkmcnt(12)
    s_barrier
    s_mul_i32 s4, s4, 5
    v_mfma_f32_16x16x32_bf16 v[32:35], v[64:67], v[96:99], v[32:35]
    s_lshr_b64 s[4:5], s[6:7], s4
    ds_read_b128 a[224:227], v17 offset:0
    v_mfma_f32_16x16x32_bf16 v[36:39], v[68:71], v[96:99], v[36:39]
    s_and_b32 s4, s4, 31
    v_mfma_f32_16x16x32_bf16 v[36:39], v[64:67], v[100:103], v[36:39]
    s_lshl_b32 s4, s4, 8
    ds_read2_b32 a[192:193], v4 offset0:80 offset1:81
    v_mfma_f32_16x16x32_bf16 v[40:43], v[64:67], v[104:107], v[40:43]
    s_add_u32 s74, s4, s12
    ds_read2_b32 a[194:195], v4 offset0:82 offset1:83
    v_mfma_f32_16x16x32_bf16 v[40:43], v[68:71], v[100:103], v[40:43]
    ds_read_b64_tr_b16 v[188:189], v12 offset:32768
    v_mfma_f32_16x16x32_bf16 v[40:43], v[72:75], v[96:99], v[40:43]
    s_bfe_u32 s4, s83, 0x30012
    ds_read_b128 a[228:231], v17 offset:4096
    v_mfma_f32_16x16x32_bf16 v[44:47], v[76:79], v[96:99], v[44:47]
    s_mul_i32 s4, s4, 5
    ds_read2_b32 a[196:197], v4 offset0:208 offset1:209
    v_mfma_f32_16x16x32_bf16 v[44:47], v[72:75], v[100:103], v[44:47]
    s_lshr_b64 s[4:5], s[6:7], s4
    ds_read_b64_tr_b16 v[190:191], v12 offset:33792
    v_mfma_f32_16x16x32_bf16 v[44:47], v[68:71], v[104:107], v[44:47]
    s_and_b32 s4, s4, 31
    ds_read2_b32 a[198:199], v4 offset0:210 offset1:211
    v_mfma_f32_16x16x32_bf16 v[44:47], v[64:67], v[108:111], v[44:47]
    s_waitcnt lgkmcnt(8)
    s_lshl_b32 s4, s4, 8
    ds_read_b128 a[232:235], v17 offset:8192
    v_mfma_f32_16x16x32_bf16 v[48:51], v[64:67], v[112:115], v[48:51]
    s_add_u32 s75, s4, s12
    ds_read2_b32 a[200:201], v5 offset0:80 offset1:81
    v_mfma_f32_16x16x32_bf16 v[48:51], v[68:71], v[108:111], v[48:51]
    s_bfe_u32 s4, s83, 0x30015
    ds_read_b64_tr_b16 v[192:193], v13 offset:32768
    v_mfma_f32_16x16x32_bf16 v[48:51], v[72:75], v[104:107], v[48:51]
    ds_read2_b32 a[202:203], v5 offset0:82 offset1:83
    v_mfma_f32_16x16x32_bf16 v[48:51], v[76:79], v[100:103], v[48:51]
    s_mul_i32 s4, s4, 5
    ds_read_b128 a[236:239], v17 offset:12288
    v_mfma_f32_16x16x32_bf16 v[48:51], v[80:83], v[96:99], v[48:51]
    s_lshr_b64 s[4:5], s[6:7], s4
    ds_read_b64_tr_b16 v[194:195], v13 offset:33792
    v_mfma_f32_16x16x32_bf16 v[52:55], v[84:87], v[96:99], v[52:55]
    s_and_b32 s4, s4, 31
    ds_read2_b32 a[204:205], v5 offset0:208 offset1:209
    v_mfma_f32_16x16x32_bf16 v[52:55], v[80:83], v[100:103], v[52:55]
    s_lshl_b32 s4, s4, 8
    ds_read2_b32 a[206:207], v5 offset0:210 offset1:211
    v_mfma_f32_16x16x32_bf16 v[52:55], v[76:79], v[104:107], v[52:55]
    s_add_u32 s76, s4, s12
    v_mfma_f32_16x16x32_bf16 v[52:55], v[72:75], v[108:111], v[52:55]
    s_mov_b32 s6, 994437672
    ds_read_b128 a[240:243], v17 offset:16384
    v_mfma_f32_16x16x32_bf16 v[52:55], v[68:71], v[112:115], v[52:55]
    s_cmp_eq_u32 s23, 1
    s_cselect_b32 s6, 391038234, s6
    ds_read2_b32 a[208:209], v6 offset0:80 offset1:81
    v_mfma_f32_16x16x32_bf16 v[52:55], v[64:67], v[116:119], v[52:55]
    ds_read_b64_tr_b16 v[196:197], v12 offset:40960
    v_mfma_f32_16x16x32_bf16 v[56:59], v[64:67], v[120:123], v[56:59]
    s_cmp_eq_u32 s23, 2
    s_cselect_b32 s6, 994419537, s6
    ds_read2_b32 a[210:211], v6 offset0:82 offset1:83
    v_mfma_f32_16x16x32_bf16 v[56:59], v[68:71], v[116:119], v[56:59]
    s_cmp_eq_u32 s23, 3
    s_cselect_b32 s6, 391029306, s6
    ds_read_b128 a[244:247], v17 offset:20480
    v_mfma_f32_16x16x32_bf16 v[56:59], v[72:75], v[112:115], v[56:59]
    s_bfe_u32 s4, s6, 0x20003
    ds_read_b64_tr_b16 v[198:199], v12 offset:41984
    v_mfma_f32_16x16x32_bf16 v[56:59], v[76:79], v[108:111], v[56:59]
    s_lshl_b32 s4, s4, 1
    ds_read2_b32 a[212:213], v6 offset0:208 offset1:209
    v_mfma_f32_16x16x32_bf16 v[56:59], v[80:83], v[104:107], v[56:59]
    s_xor_b32 s4, s4, s2
    ds_read2_b32 a[214:215], v6 offset0:210 offset1:211
    v_mfma_f32_16x16x32_bf16 v[56:59], v[84:87], v[100:103], v[56:59]
    s_lshl2_add_u32 s4, s4, s3
    ds_read_b128 a[248:251], v17 offset:24576
    v_mfma_f32_16x16x32_bf16 v[56:59], v[88:91], v[96:99], v[56:59]
    ds_read_b64_tr_b16 v[200:201], v13 offset:40960
    v_mfma_f32_16x16x32_bf16 v[60:63], v[92:95], v[96:99], v[60:63]
    s_bfe_u32 s5, s6, 0x30000
    ds_read2_b32 a[216:217], v7 offset0:80 offset1:81
    v_mfma_f32_16x16x32_bf16 v[60:63], v[88:91], v[100:103], v[60:63]
    s_lshl3_add_u32 s4, s4, s5
    ds_read2_b32 a[218:219], v7 offset0:82 offset1:83
    v_mfma_f32_16x16x32_bf16 v[60:63], v[84:87], v[104:107], v[60:63]
    s_lshl_b32 s4, s4, 10
    ds_read_b64_tr_b16 v[202:203], v13 offset:41984
    v_mfma_f32_16x16x32_bf16 v[60:63], v[80:83], v[108:111], v[60:63]
    s_add_u32 s77, s4, 14483456
    ds_read_b128 a[252:255], v17 offset:28672
    v_mfma_f32_16x16x32_bf16 v[60:63], v[76:79], v[112:115], v[60:63]
    s_bfe_u32 s4, s6, 0x20008
    ds_read2_b32 a[220:221], v7 offset0:208 offset1:209
    v_mfma_f32_16x16x32_bf16 v[60:63], v[72:75], v[116:119], v[60:63]
    s_lshl_b32 s4, s4, 1
    v_mfma_f32_16x16x32_bf16 v[60:63], v[68:71], v[120:123], v[60:63]
    s_xor_b32 s4, s4, s2
    ds_read2_b32 a[222:223], v7 offset0:210 offset1:211
    v_mfma_f32_16x16x32_bf16 v[60:63], v[64:67], v[124:127], v[60:63]
    s_waitcnt vmcnt(4) lgkmcnt(3)
    s_barrier
    v_mfma_f32_16x16x32_bf16 v[32:35], a[192:195], a[224:227], v[32:35]
    s_lshl2_add_u32 s4, s4, s3
    ds_read_b128 v[96:99], v18 offset:0
    v_mfma_f32_16x16x32_bf16 v[36:39], a[196:199], a[224:227], v[36:39]
    s_add_u32 m0, s20, 147456
    s_bfe_u32 s5, s6, 0x30005
    v_mfma_f32_16x16x32_bf16 v[36:39], a[192:195], a[228:231], v[36:39]
    s_lshl_b32 s14, s89, 1
    ds_read2_b32 v[64:65], v4 offset0:96 offset1:97
    s_lshl3_add_u32 s4, s4, s5
    v_mfma_f32_16x16x32_bf16 v[40:43], a[192:195], a[232:235], v[40:43]
    s_lshl_b32 s4, s4, 10
    ds_read2_b32 v[66:67], v4 offset0:98 offset1:99
    v_mfma_f32_16x16x32_bf16 v[40:43], a[196:199], a[228:231], v[40:43]
    s_add_u32 s78, s4, 14483456
    ds_read_b64_tr_b16 v[204:205], v12 offset:0
    buffer_load_dwordx4 v8, s[52:55], s14 offen offset:0 lds
    v_mfma_f32_16x16x32_bf16 v[40:43], a[200:203], a[224:227], v[40:43]
    s_bfe_u32 s4, s6, 0x2000d
    ds_read_b128 v[100:103], v18 offset:4096
    v_mfma_f32_16x16x32_bf16 v[44:47], a[204:207], a[224:227], v[44:47]
    s_lshl_b32 s4, s4, 1
    ds_read2_b32 v[68:69], v4 offset0:224 offset1:225
    v_mfma_f32_16x16x32_bf16 v[44:47], a[200:203], a[228:231], v[44:47]
    ds_read_b64_tr_b16 v[206:207], v12 offset:1024
    v_mfma_f32_16x16x32_bf16 v[44:47], a[196:199], a[232:235], v[44:47]
    s_xor_b32 s4, s4, s2
    ds_read2_b32 v[70:71], v4 offset0:226 offset1:227
    buffer_load_dwordx4 v9, s[52:55], s14 offen offset:1024 lds
    v_mfma_f32_16x16x32_bf16 v[44:47], a[192:195], a[236:239], v[44:47]
    s_waitcnt lgkmcnt(8)
    s_lshl2_add_u32 s4, s4, s3
    ds_read_b128 v[104:107], v18 offset:8192
    v_mfma_f32_16x16x32_bf16 v[48:51], a[192:195], a[240:243], v[48:51]
    s_bfe_u32 s5, s6, 0x3000a
    ds_read2_b32 v[72:73], v5 offset0:96 offset1:97
    v_mfma_f32_16x16x32_bf16 v[48:51], a[196:199], a[236:239], v[48:51]
    s_lshl3_add_u32 s4, s4, s5
    ds_read_b64_tr_b16 v[208:209], v13 offset:0
    buffer_load_dwordx4 v10, s[52:55], s14 offen offset:2048 lds
    v_mfma_f32_16x16x32_bf16 v[48:51], a[200:203], a[232:235], v[48:51]
    s_lshl_b32 s4, s4, 10
    ds_read2_b32 v[74:75], v5 offset0:98 offset1:99
    v_mfma_f32_16x16x32_bf16 v[48:51], a[204:207], a[228:231], v[48:51]
    s_add_u32 s79, s4, 14483456
    ds_read_b128 v[108:111], v18 offset:12288
    v_mfma_f32_16x16x32_bf16 v[48:51], a[208:211], a[224:227], v[48:51]
    ds_read_b64_tr_b16 v[210:211], v13 offset:1024
    v_mfma_f32_16x16x32_bf16 v[52:55], a[212:215], a[224:227], v[52:55]
    s_bfe_u32 s4, s6, 0x20012
    ds_read2_b32 v[76:77], v5 offset0:224 offset1:225
    buffer_load_dwordx4 v11, s[52:55], s14 offen offset:3072 lds
    v_mfma_f32_16x16x32_bf16 v[52:55], a[208:211], a[228:231], v[52:55]
    s_lshl_b32 s4, s4, 1
    ds_read2_b32 v[78:79], v5 offset0:226 offset1:227
    v_mfma_f32_16x16x32_bf16 v[52:55], a[204:207], a[232:235], v[52:55]
    s_xor_b32 s4, s4, s2
    v_mfma_f32_16x16x32_bf16 v[52:55], a[200:203], a[236:239], v[52:55]
    s_lshl2_add_u32 s4, s4, s3
    ds_read_b128 v[112:115], v18 offset:16384
    v_mfma_f32_16x16x32_bf16 v[52:55], a[196:199], a[240:243], v[52:55]
    s_bfe_u32 s5, s6, 0x3000f
    ds_read2_b32 v[80:81], v6 offset0:96 offset1:97
    v_mfma_f32_16x16x32_bf16 v[52:55], a[192:195], a[244:247], v[52:55]
    s_lshl3_add_u32 s4, s4, s5
    ds_read_b64_tr_b16 v[212:213], v12 offset:8192
    v_mfma_f32_16x16x32_bf16 v[56:59], a[192:195], a[248:251], v[56:59]
    s_lshl_b32 s4, s4, 10
    ds_read2_b32 v[82:83], v6 offset0:98 offset1:99
    v_mfma_f32_16x16x32_bf16 v[56:59], a[196:199], a[244:247], v[56:59]
    ds_read_b128 v[116:119], v18 offset:20480
    v_mfma_f32_16x16x32_bf16 v[56:59], a[200:203], a[240:243], v[56:59]
    s_add_u32 s80, s4, 14483456
    ds_read_b64_tr_b16 v[214:215], v12 offset:9216
    v_mfma_f32_16x16x32_bf16 v[56:59], a[204:207], a[236:239], v[56:59]
    s_bfe_u32 s4, s6, 0x20017
    ds_read2_b32 v[84:85], v6 offset0:224 offset1:225
    v_mfma_f32_16x16x32_bf16 v[56:59], a[208:211], a[232:235], v[56:59]
    s_lshl_b32 s4, s4, 1
    ds_read2_b32 v[86:87], v6 offset0:226 offset1:227
    v_mfma_f32_16x16x32_bf16 v[56:59], a[212:215], a[228:231], v[56:59]
    s_xor_b32 s4, s4, s2
    ds_read_b128 v[120:123], v18 offset:24576
    v_mfma_f32_16x16x32_bf16 v[56:59], a[216:219], a[224:227], v[56:59]
    s_lshl2_add_u32 s4, s4, s3
    ds_read_b64_tr_b16 v[216:217], v13 offset:8192
    v_mfma_f32_16x16x32_bf16 v[60:63], a[220:223], a[224:227], v[60:63]
    s_bfe_u32 s5, s6, 0x30014
    ds_read2_b32 v[88:89], v7 offset0:96 offset1:97
    v_mfma_f32_16x16x32_bf16 v[60:63], a[216:219], a[228:231], v[60:63]
    ds_read2_b32 v[90:91], v7 offset0:98 offset1:99
    v_mfma_f32_16x16x32_bf16 v[60:63], a[212:215], a[232:235], v[60:63]
    s_lshl3_add_u32 s4, s4, s5
    ds_read_b64_tr_b16 v[218:219], v13 offset:9216
    v_mfma_f32_16x16x32_bf16 v[60:63], a[208:211], a[236:239], v[60:63]
    s_lshl_b32 s4, s4, 10
    ds_read_b128 v[124:127], v18 offset:28672
    v_mfma_f32_16x16x32_bf16 v[60:63], a[204:207], a[240:243], v[60:63]
    s_add_u32 s81, s4, 14483456
    ds_read2_b32 v[92:93], v7 offset0:224 offset1:225
    v_mfma_f32_16x16x32_bf16 v[60:63], a[200:203], a[244:247], v[60:63]
    s_bfe_u32 s4, s6, 0x2001c
    v_mfma_f32_16x16x32_bf16 v[60:63], a[196:199], a[248:251], v[60:63]
    s_lshl_b32 s4, s4, 1
    ds_read2_b32 v[94:95], v7 offset0:226 offset1:227
    v_mfma_f32_16x16x32_bf16 v[60:63], a[192:195], a[252:255], v[60:63]
    s_waitcnt vmcnt(4) lgkmcnt(3)
    s_barrier
    s_xor_b32 s4, s4, s2
    v_mfma_f32_16x16x32_bf16 v[32:35], v[64:67], v[96:99], v[32:35]
    s_lshl2_add_u32 s4, s4, s3
    ds_read_b128 a[224:227], v19 offset:0
    v_mfma_f32_16x16x32_bf16 v[36:39], v[68:71], v[96:99], v[36:39]
    s_add_u32 m0, s20, 114688
    ds_read_b64_tr_b16 v[220:221], v12 offset:16384
    v_mfma_f32_16x16x32_bf16 v[36:39], v[64:67], v[100:103], v[36:39]
    s_lshl_b32 s14, s90, 1
    ds_read_b128 a[228:231], v19 offset:4096
    s_bfe_u32 s5, s6, 0x30019
    v_mfma_f32_16x16x32_bf16 v[40:43], v[64:67], v[104:107], v[40:43]
    s_lshl3_add_u32 s4, s4, s5
    ds_read_b128 a[232:235], v19 offset:8192
    v_mfma_f32_16x16x32_bf16 v[40:43], v[68:71], v[100:103], v[40:43]
    s_lshl_b32 s4, s4, 10
    ds_read_b128 a[236:239], v19 offset:12288
    buffer_load_dwordx4 v8, s[52:55], s14 offen offset:0 lds
    v_mfma_f32_16x16x32_bf16 v[40:43], v[72:75], v[96:99], v[40:43]
    s_add_u32 s82, s4, 14483456
    ds_read_b64_tr_b16 v[222:223], v12 offset:17408
    v_mfma_f32_16x16x32_bf16 v[44:47], v[76:79], v[96:99], v[44:47]
    s_lshl2_add_u32 s4, s2, s3
    ds_read_b128 a[240:243], v19 offset:16384
    v_mfma_f32_16x16x32_bf16 v[44:47], v[72:75], v[100:103], v[44:47]
    s_lshl_b32 s4, s4, 13
    ds_read_b128 a[244:247], v19 offset:20480
    v_mfma_f32_16x16x32_bf16 v[44:47], v[68:71], v[104:107], v[44:47]
    s_add_u32 s83, s4, 14483456
    ds_read_b64_tr_b16 v[224:225], v13 offset:16384
    buffer_load_dwordx4 v9, s[52:55], s14 offen offset:1024 lds
    v_mfma_f32_16x16x32_bf16 v[44:47], v[64:67], v[108:111], v[44:47]
    s_waitcnt lgkmcnt(9)
    ds_read_b128 a[248:251], v19 offset:24576
    v_mfma_f32_16x16x32_bf16 v[48:51], v[64:67], v[112:115], v[48:51]
    s_mov_b32 s60, s24
    ds_read_b128 a[252:255], v19 offset:28672
    v_mfma_f32_16x16x32_bf16 v[48:51], v[68:71], v[108:111], v[48:51]
    s_and_b32 s61, s25, 0xffff
    ds_read2_b32 a[192:193], v4 offset0:112 offset1:113
    buffer_load_dwordx4 v10, s[52:55], s14 offen offset:2048 lds
    v_mfma_f32_16x16x32_bf16 v[48:51], v[72:75], v[104:107], v[48:51]
    s_mov_b32 s62, 2359296
    ds_read_b64_tr_b16 v[226:227], v13 offset:17408
    v_mfma_f32_16x16x32_bf16 v[48:51], v[76:79], v[100:103], v[48:51]
    s_mov_b32 s63, 0x20000
    ds_read2_b32 a[194:195], v4 offset0:114 offset1:115
    v_mfma_f32_16x16x32_bf16 v[48:51], v[80:83], v[96:99], v[48:51]
    s_lshl_b32 s18, s34, 12
    ds_read2_b32 a[196:197], v4 offset0:240 offset1:241
    v_mfma_f32_16x16x32_bf16 v[52:55], v[84:87], v[96:99], v[52:55]
    s_lshl_b32 s8, s3, 10
    ds_read2_b32 a[198:199], v4 offset0:242 offset1:243
    buffer_load_dwordx4 v11, s[52:55], s14 offen offset:3072 lds
    v_mfma_f32_16x16x32_bf16 v[52:55], v[80:83], v[100:103], v[52:55]
    ds_read2_b32 a[200:201], v5 offset0:112 offset1:113
    v_mfma_f32_16x16x32_bf16 v[52:55], v[76:79], v[104:107], v[52:55]
    s_add_u32 s18, s18, s8
    ds_read2_b32 a[202:203], v5 offset0:114 offset1:115
    v_mfma_f32_16x16x32_bf16 v[52:55], v[72:75], v[108:111], v[52:55]
    s_lshr_b32 s9, s34, 4
    ds_read2_b32 a[204:205], v5 offset0:240 offset1:241
    v_mfma_f32_16x16x32_bf16 v[52:55], v[68:71], v[112:115], v[52:55]
    s_mul_i32 s8, s9, 43
    ds_read2_b32 a[206:207], v5 offset0:242 offset1:243
    v_mfma_f32_16x16x32_bf16 v[52:55], v[64:67], v[116:119], v[52:55]
    s_lshr_b32 s8, s8, 7
    ds_read2_b32 a[208:209], v6 offset0:112 offset1:113
    v_xor_b32 v16, 64, v16
    v_mfma_f32_16x16x32_bf16 v[56:59], v[64:67], v[120:123], v[56:59]
    s_add_u32 s43, s9, s8
    ds_read_b64_tr_b16 v[228:229], v12 offset:24576
    v_mfma_f32_16x16x32_bf16 v[56:59], v[68:71], v[116:119], v[56:59]
    s_mul_i32 s8, s8, 3
    ds_read2_b32 a[210:211], v6 offset0:114 offset1:115
    v_mfma_f32_16x16x32_bf16 v[56:59], v[72:75], v[112:115], v[56:59]
    s_sub_u32 s8, s9, s8
    ds_read2_b32 a[212:213], v6 offset0:240 offset1:241
    v_mfma_f32_16x16x32_bf16 v[56:59], v[76:79], v[108:111], v[56:59]
    ds_read2_b32 a[214:215], v6 offset0:242 offset1:243
    v_xor_b32 v17, 64, v17
    v_mfma_f32_16x16x32_bf16 v[56:59], v[80:83], v[104:107], v[56:59]
    s_min_u32 s8, s8, 1
    ds_read2_b32 a[216:217], v7 offset0:112 offset1:113
    v_mfma_f32_16x16x32_bf16 v[56:59], v[84:87], v[100:103], v[56:59]
    s_add_u32 s43, s43, s8
    ds_read2_b32 a[218:219], v7 offset0:114 offset1:115
    v_mfma_f32_16x16x32_bf16 v[56:59], v[88:91], v[96:99], v[56:59]
    s_lshl_b32 s43, s43, 8
    ds_read2_b32 a[220:221], v7 offset0:240 offset1:241
    v_mfma_f32_16x16x32_bf16 v[60:63], v[92:95], v[96:99], v[60:63]
    s_and_b32 s8, s34, 15
    ds_read2_b32 a[222:223], v7 offset0:242 offset1:243
    v_xor_b32 v18, 64, v18
    v_mfma_f32_16x16x32_bf16 v[60:63], v[88:91], v[100:103], v[60:63]
    s_lshl4_add_u32 s43, s8, s43
    v_add_u32 v4, 33280, v4
    ds_read_b64_tr_b16 v[230:231], v12 offset:25600
    v_mfma_f32_16x16x32_bf16 v[60:63], v[84:87], v[104:107], v[60:63]
    s_mul_i32 s8, s3, 786432
    ds_read_b64_tr_b16 v[232:233], v13 offset:24576
    v_mfma_f32_16x16x32_bf16 v[60:63], v[80:83], v[108:111], v[60:63]
    s_add_u32 s43, s43, s8
    v_add_u32 v5, 33280, v5
    ds_read_b64_tr_b16 v[234:235], v13 offset:25600
    v_mfma_f32_16x16x32_bf16 v[60:63], v[76:79], v[112:115], v[60:63]
    v_xor_b32 v19, 64, v19
    v_add_u32 v6, 33280, v6
    v_mfma_f32_16x16x32_bf16 v[60:63], v[72:75], v[116:119], v[60:63]
    s_add_u32 s43, s43, 3211264
    v_mfma_f32_16x16x32_bf16 v[60:63], v[68:71], v[120:123], v[60:63]
    v_add_u32 v7, 33280, v7
    v_mul_u32_u24 v147, 12288, v2
    v_mfma_f32_16x16x32_bf16 v[60:63], v[64:67], v[124:127], v[60:63]
    s_waitcnt lgkmcnt(0)
    s_barrier
    s_lshr_b32 s10, s20, 2
    v_mfma_f32_16x16x32_bf16 v[60:63], a[220:223], a[224:227], v[60:63]
    ds_read_b128 v[96:99], v16 offset:2048
    v_mfma_f32_16x16x32_bf16 v[60:63], a[216:219], a[228:231], v[60:63]
    s_add_u32 m0, s20, 131072
    ds_read_b128 v[100:103], v16 offset:6144
    v_mfma_f32_16x16x32_bf16 v[60:63], a[212:215], a[232:235], v[60:63]
    s_lshl_b32 s14, s91, 1
    v_mfma_f32_16x16x32_bf16 v[60:63], a[208:211], a[236:239], v[60:63]
    ds_read_b128 v[104:107], v16 offset:10240
    v_mfma_f32_16x16x32_bf16 v[60:63], a[204:207], a[240:243], v[60:63]
    ds_read_b128 v[108:111], v16 offset:14336
    buffer_load_dwordx4 v8, s[52:55], s14 offen offset:0 lds
    v_mfma_f32_16x16x32_bf16 v[60:63], a[200:203], a[244:247], v[60:63]
    ds_read_b128 v[112:115], v16 offset:18432
    v_mfma_f32_16x16x32_bf16 v[60:63], a[196:199], a[248:251], v[60:63]
    ds_read_b128 v[116:119], v16 offset:22528
    v_mfma_f32_16x16x32_bf16 v[60:63], a[192:195], a[252:255], v[60:63]
    ds_read_b128 v[120:123], v16 offset:26624
    v_mfma_f32_16x16x32_bf16 v[56:59], a[192:195], a[248:251], v[56:59]
    buffer_load_dwordx4 v9, s[52:55], s14 offen offset:1024 lds
    v_mfma_f32_16x16x32_bf16 v[56:59], a[196:199], a[244:247], v[56:59]
    ds_read_b128 v[124:127], v16 offset:30720
    v_mfma_f32_16x16x32_bf16 v[56:59], a[200:203], a[240:243], v[56:59]
    ds_read2_b32 v[64:65], v4 offset0:0 offset1:1
    v_mfma_f32_16x16x32_bf16 v[56:59], a[204:207], a[236:239], v[56:59]
    ds_read2_b32 v[66:67], v4 offset0:2 offset1:3
    buffer_load_dwordx4 v10, s[52:55], s14 offen offset:2048 lds
    v_mfma_f32_16x16x32_bf16 v[56:59], a[208:211], a[232:235], v[56:59]
    ds_read2_b32 v[68:69], v4 offset0:128 offset1:129
    v_mfma_f32_16x16x32_bf16 v[56:59], a[212:215], a[228:231], v[56:59]
    ds_read2_b32 v[70:71], v4 offset0:130 offset1:131
    v_mfma_f32_16x16x32_bf16 v[56:59], a[216:219], a[224:227], v[56:59]
    v_mfma_f32_16x16x32_bf16 v[52:55], a[212:215], a[224:227], v[52:55]
    ds_read2_b32 v[72:73], v5 offset0:0 offset1:1
    buffer_load_dwordx4 v11, s[52:55], s14 offen offset:3072 lds
    v_mfma_f32_16x16x32_bf16 v[52:55], a[208:211], a[228:231], v[52:55]
    ds_read2_b32 v[74:75], v5 offset0:2 offset1:3
    v_mfma_f32_16x16x32_bf16 v[52:55], a[204:207], a[232:235], v[52:55]
    ds_read2_b32 v[76:77], v5 offset0:128 offset1:129
    v_cvt_pk_bf16_f32 v142, v60, v61
    v_mfma_f32_16x16x32_bf16 v[52:55], a[200:203], a[236:239], v[52:55]
    ds_read2_b32 v[78:79], v5 offset0:130 offset1:131
    v_mfma_f32_16x16x32_bf16 v[52:55], a[196:199], a[240:243], v[52:55]
L_pl_X_4:
    s_cbranch_execz L_wret
    ds_read2_b32 v[80:81], v6 offset0:0 offset1:1
    v_cvt_pk_bf16_f32 v143, v62, v63
    v_mfma_f32_16x16x32_bf16 v[52:55], a[192:195], a[244:247], v[52:55]
    buffer_store_dwordx2 v[142:143], v20, s[44:47], s15 offen offset:3584 sc1
    v_mfma_f32_16x16x32_bf16 v[48:51], a[192:195], a[240:243], v[48:51]
    ds_read2_b32 v[82:83], v6 offset0:2 offset1:3
    v_mfma_f32_16x16x32_bf16 v[48:51], a[196:199], a[236:239], v[48:51]
    ds_read2_b32 v[84:85], v6 offset0:128 offset1:129
    v_mfma_f32_16x16x32_bf16 v[48:51], a[200:203], a[232:235], v[48:51]
    ds_read2_b32 v[86:87], v6 offset0:130 offset1:131
    v_cvt_pk_bf16_f32 v140, v56, v57
    v_mfma_f32_16x16x32_bf16 v[48:51], a[204:207], a[228:231], v[48:51]
    ds_read2_b32 v[88:89], v7 offset0:0 offset1:1
    v_mfma_f32_16x16x32_bf16 v[48:51], a[208:211], a[224:227], v[48:51]
    ds_read2_b32 v[90:91], v7 offset0:2 offset1:3
    v_cvt_pk_bf16_f32 v141, v58, v59
    v_mfma_f32_16x16x32_bf16 v[44:47], a[204:207], a[224:227], v[44:47]
    buffer_store_dwordx2 v[140:141], v20, s[44:47], s15 offen offset:3072 sc1
    v_mfma_f32_16x16x32_bf16 v[44:47], a[200:203], a[228:231], v[44:47]
    ds_read2_b32 v[92:93], v7 offset0:128 offset1:129
    v_mfma_f32_16x16x32_bf16 v[44:47], a[196:199], a[232:235], v[44:47]
    ds_read2_b32 v[94:95], v7 offset0:130 offset1:131
    v_mfma_f32_16x16x32_bf16 v[44:47], a[192:195], a[236:239], v[44:47]
    v_mfma_f32_16x16x32_bf16 v[40:43], a[192:195], a[232:235], v[40:43]
    v_cvt_pk_bf16_f32 v138, v52, v53
    v_mfma_f32_16x16x32_bf16 v[40:43], a[196:199], a[228:231], v[40:43]
    v_mfma_f32_16x16x32_bf16 v[40:43], a[200:203], a[224:227], v[40:43]
    v_cvt_pk_bf16_f32 v139, v54, v55
    v_mfma_f32_16x16x32_bf16 v[36:39], a[196:199], a[224:227], v[36:39]
    v_mfma_f32_16x16x32_bf16 v[36:39], a[192:195], a[228:231], v[36:39]
    buffer_store_dwordx2 v[138:139], v20, s[44:47], s15 offen offset:2560 sc1
    v_mfma_f32_16x16x32_bf16 v[32:35], a[192:195], a[224:227], v[32:35]
    s_waitcnt vmcnt(11) lgkmcnt(0)
    s_barrier
    v_mfma_f32_16x16x32_bf16 v[60:63], v[92:95], v[96:99], 0
    ds_read_b128 a[224:227], v17 offset:2048
    v_cvt_pk_bf16_f32 v136, v48, v49
    v_mfma_f32_16x16x32_bf16 v[60:63], v[88:91], v[100:103], v[60:63]
    v_mfma_f32_16x16x32_bf16 v[60:63], v[84:87], v[104:107], v[60:63]
    ds_read2_b32 a[192:193], v4 offset0:16 offset1:17
    v_cvt_pk_bf16_f32 v137, v50, v51
    v_mfma_f32_16x16x32_bf16 v[60:63], v[80:83], v[108:111], v[60:63]
    ds_read2_b32 a[194:195], v4 offset0:18 offset1:19
    v_mfma_f32_16x16x32_bf16 v[60:63], v[76:79], v[112:115], v[60:63]
    ds_read_b64_tr_b16 v[236:237], v12 offset:32768
    buffer_store_dwordx2 v[136:137], v20, s[44:47], s15 offen offset:2048 sc1
    v_mfma_f32_16x16x32_bf16 v[60:63], v[72:75], v[116:119], v[60:63]
    ds_read_b128 a[228:231], v17 offset:6144
    v_mfma_f32_16x16x32_bf16 v[60:63], v[68:71], v[120:123], v[60:63]
    ds_read2_b32 a[196:197], v4 offset0:144 offset1:145
    v_cvt_pk_bf16_f32 v134, v44, v45
    v_mfma_f32_16x16x32_bf16 v[60:63], v[64:67], v[124:127], v[60:63]
    ds_read_b64_tr_b16 v[238:239], v12 offset:33792
    v_mfma_f32_16x16x32_bf16 v[56:59], v[64:67], v[120:123], 0
    ds_read2_b32 a[198:199], v4 offset0:146 offset1:147
    v_cvt_pk_bf16_f32 v135, v46, v47
    v_mfma_f32_16x16x32_bf16 v[56:59], v[68:71], v[116:119], v[56:59]
    ds_read_b128 a[232:235], v17 offset:10240
    v_mfma_f32_16x16x32_bf16 v[56:59], v[72:75], v[112:115], v[56:59]
    ds_read2_b32 a[200:201], v5 offset0:16 offset1:17
    buffer_store_dwordx2 v[134:135], v20, s[44:47], s15 offen offset:1536 sc1
    v_mfma_f32_16x16x32_bf16 v[56:59], v[76:79], v[108:111], v[56:59]
    ds_read_b64_tr_b16 v[240:241], v13 offset:32768
    v_mfma_f32_16x16x32_bf16 v[56:59], v[80:83], v[104:107], v[56:59]
    ds_read2_b32 a[202:203], v5 offset0:18 offset1:19
    v_cvt_pk_bf16_f32 v132, v40, v41
    v_mfma_f32_16x16x32_bf16 v[56:59], v[84:87], v[100:103], v[56:59]
    ds_read_b128 a[236:239], v17 offset:14336
    v_mfma_f32_16x16x32_bf16 v[56:59], v[88:91], v[96:99], v[56:59]
    ds_read_b64_tr_b16 v[242:243], v13 offset:33792
    v_cvt_pk_bf16_f32 v133, v42, v43
    v_mfma_f32_16x16x32_bf16 v[52:55], v[84:87], v[96:99], 0
    ds_read2_b32 a[204:205], v5 offset0:144 offset1:145
    v_mfma_f32_16x16x32_bf16 v[52:55], v[80:83], v[100:103], v[52:55]
    ds_read2_b32 a[206:207], v5 offset0:146 offset1:147
    buffer_store_dwordx2 v[132:133], v20, s[44:47], s15 offen offset:1024 sc1
    v_mfma_f32_16x16x32_bf16 v[52:55], v[76:79], v[104:107], v[52:55]
    v_cvt_pk_bf16_f32 v130, v36, v37
    v_mfma_f32_16x16x32_bf16 v[52:55], v[72:75], v[108:111], v[52:55]
    ds_read_b128 a[240:243], v17 offset:18432
    v_mfma_f32_16x16x32_bf16 v[52:55], v[68:71], v[112:115], v[52:55]
    ds_read2_b32 a[208:209], v6 offset0:16 offset1:17
    v_cvt_pk_bf16_f32 v131, v38, v39
    v_mfma_f32_16x16x32_bf16 v[52:55], v[64:67], v[116:119], v[52:55]
    ds_read_b64_tr_b16 v[244:245], v12 offset:40960
    buffer_store_dwordx2 v[130:131], v20, s[44:47], s15 offen offset:512 sc1
    v_mfma_f32_16x16x32_bf16 v[48:51], v[64:67], v[112:115], 0
    ds_read2_b32 a[210:211], v6 offset0:18 offset1:19
    v_mfma_f32_16x16x32_bf16 v[48:51], v[68:71], v[108:111], v[48:51]
    ds_read_b128 a[244:247], v17 offset:22528
    v_cvt_pk_bf16_f32 v128, v32, v33
    v_mfma_f32_16x16x32_bf16 v[48:51], v[72:75], v[104:107], v[48:51]
    ds_read_b64_tr_b16 v[246:247], v12 offset:41984
    v_mfma_f32_16x16x32_bf16 v[48:51], v[76:79], v[100:103], v[48:51]
    ds_read2_b32 a[212:213], v6 offset0:144 offset1:145
    v_cvt_pk_bf16_f32 v129, v34, v35
    v_mfma_f32_16x16x32_bf16 v[48:51], v[80:83], v[96:99], v[48:51]
    ds_read2_b32 a[214:215], v6 offset0:146 offset1:147
    buffer_store_dwordx2 v[128:129], v20, s[44:47], s15 offen offset:0 sc1
    v_mfma_f32_16x16x32_bf16 v[44:47], v[76:79], v[96:99], 0
    ds_read_b128 a[248:251], v17 offset:26624
    v_mfma_f32_16x16x32_bf16 v[44:47], v[72:75], v[100:103], v[44:47]
    s_add_u32 s15, s15, 16384
    ds_read_b64_tr_b16 v[248:249], v13 offset:40960
    v_mfma_f32_16x16x32_bf16 v[44:47], v[68:71], v[104:107], v[44:47]
    ds_read2_b32 a[216:217], v7 offset0:16 offset1:17
    v_mfma_f32_16x16x32_bf16 v[44:47], v[64:67], v[108:111], v[44:47]
    ds_read2_b32 a[218:219], v7 offset0:18 offset1:19
    v_mfma_f32_16x16x32_bf16 v[40:43], v[64:67], v[104:107], 0
    ds_read_b64_tr_b16 v[250:251], v13 offset:41984
    v_mfma_f32_16x16x32_bf16 v[40:43], v[68:71], v[100:103], v[40:43]
    ds_read_b128 a[252:255], v17 offset:30720
    v_mfma_f32_16x16x32_bf16 v[40:43], v[72:75], v[96:99], v[40:43]
    ds_read2_b32 a[220:221], v7 offset0:144 offset1:145
    v_mfma_f32_16x16x32_bf16 v[36:39], v[68:71], v[96:99], 0
    v_mfma_f32_16x16x32_bf16 v[36:39], v[64:67], v[100:103], v[36:39]
    ds_read2_b32 a[222:223], v7 offset0:146 offset1:147
    v_mfma_f32_16x16x32_bf16 v[32:35], v[64:67], v[96:99], 0
    s_waitcnt vmcnt(12) lgkmcnt(3)
    s_barrier
    v_mfma_f32_16x16x32_bf16 v[32:35], a[192:195], a[224:227], v[32:35]
    ds_read_b128 v[96:99], v18 offset:2048
    v_mfma_f32_16x16x32_bf16 v[36:39], a[196:199], a[224:227], v[36:39]
    s_add_u32 m0, s20, 147456
    v_mfma_f32_16x16x32_bf16 v[36:39], a[192:195], a[228:231], v[36:39]
    s_lshl_b32 s14, s92, 1
    ds_read2_b32 v[64:65], v4 offset0:32 offset1:33
    v_mfma_f32_16x16x32_bf16 v[40:43], a[192:195], a[232:235], v[40:43]
    ds_read2_b32 v[66:67], v4 offset0:34 offset1:35
    v_mfma_f32_16x16x32_bf16 v[40:43], a[196:199], a[228:231], v[40:43]
    ds_read_b64_tr_b16 a[0:1], v12 offset:0
    buffer_load_dwordx4 v8, s[52:55], s14 offen offset:0 lds
    v_mfma_f32_16x16x32_bf16 v[40:43], a[200:203], a[224:227], v[40:43]
    ds_read_b128 v[100:103], v18 offset:6144
    v_mfma_f32_16x16x32_bf16 v[44:47], a[204:207], a[224:227], v[44:47]
    ds_read2_b32 v[68:69], v4 offset0:160 offset1:161
    v_mfma_f32_16x16x32_bf16 v[44:47], a[200:203], a[228:231], v[44:47]
    ds_read_b64_tr_b16 a[2:3], v12 offset:1024
    v_mfma_f32_16x16x32_bf16 v[44:47], a[196:199], a[232:235], v[44:47]
    ds_read2_b32 v[70:71], v4 offset0:162 offset1:163
    buffer_load_dwordx4 v9, s[52:55], s14 offen offset:1024 lds
    v_mfma_f32_16x16x32_bf16 v[44:47], a[192:195], a[236:239], v[44:47]
    s_waitcnt lgkmcnt(8)
    ds_read_b128 v[104:107], v18 offset:10240
    v_mfma_f32_16x16x32_bf16 v[48:51], a[192:195], a[240:243], v[48:51]
    ds_read2_b32 v[72:73], v5 offset0:32 offset1:33
    v_mfma_f32_16x16x32_bf16 v[48:51], a[196:199], a[236:239], v[48:51]
    ds_read_b64_tr_b16 a[4:5], v13 offset:0
    buffer_load_dwordx4 v10, s[52:55], s14 offen offset:2048 lds
    v_mfma_f32_16x16x32_bf16 v[48:51], a[200:203], a[232:235], v[48:51]
    ds_read2_b32 v[74:75], v5 offset0:34 offset1:35
    v_mfma_f32_16x16x32_bf16 v[48:51], a[204:207], a[228:231], v[48:51]
    ds_read_b128 v[108:111], v18 offset:14336
    v_mfma_f32_16x16x32_bf16 v[48:51], a[208:211], a[224:227], v[48:51]
    ds_read_b64_tr_b16 a[6:7], v13 offset:1024
    v_mfma_f32_16x16x32_bf16 v[52:55], a[212:215], a[224:227], v[52:55]
    ds_read2_b32 v[76:77], v5 offset0:160 offset1:161
    buffer_load_dwordx4 v11, s[52:55], s14 offen offset:3072 lds
    v_mfma_f32_16x16x32_bf16 v[52:55], a[208:211], a[228:231], v[52:55]
    ds_read2_b32 v[78:79], v5 offset0:162 offset1:163
    v_mfma_f32_16x16x32_bf16 v[52:55], a[204:207], a[232:235], v[52:55]
    v_mfma_f32_16x16x32_bf16 v[52:55], a[200:203], a[236:239], v[52:55]
    ds_read_b128 v[112:115], v18 offset:18432
    v_mfma_f32_16x16x32_bf16 v[52:55], a[196:199], a[240:243], v[52:55]
    ds_read2_b32 v[80:81], v6 offset0:32 offset1:33
    v_mfma_f32_16x16x32_bf16 v[52:55], a[192:195], a[244:247], v[52:55]
    ds_read_b64_tr_b16 a[8:9], v12 offset:8192
    v_mfma_f32_16x16x32_bf16 v[56:59], a[192:195], a[248:251], v[56:59]
    ds_read2_b32 v[82:83], v6 offset0:34 offset1:35
    v_mfma_f32_16x16x32_bf16 v[56:59], a[196:199], a[244:247], v[56:59]
    ds_read_b128 v[116:119], v18 offset:22528
    v_mfma_f32_16x16x32_bf16 v[56:59], a[200:203], a[240:243], v[56:59]
    ds_read_b64_tr_b16 a[10:11], v12 offset:9216
    v_mfma_f32_16x16x32_bf16 v[56:59], a[204:207], a[236:239], v[56:59]
    ds_read2_b32 v[84:85], v6 offset0:160 offset1:161
    v_mfma_f32_16x16x32_bf16 v[56:59], a[208:211], a[232:235], v[56:59]
    ds_read2_b32 v[86:87], v6 offset0:162 offset1:163
    v_mfma_f32_16x16x32_bf16 v[56:59], a[212:215], a[228:231], v[56:59]
    ds_read_b128 v[120:123], v18 offset:26624
    v_mfma_f32_16x16x32_bf16 v[56:59], a[216:219], a[224:227], v[56:59]
    ds_read_b64_tr_b16 a[12:13], v13 offset:8192
    v_mfma_f32_16x16x32_bf16 v[60:63], a[220:223], a[224:227], v[60:63]
    ds_read2_b32 v[88:89], v7 offset0:32 offset1:33
    v_mfma_f32_16x16x32_bf16 v[60:63], a[216:219], a[228:231], v[60:63]
    ds_read2_b32 v[90:91], v7 offset0:34 offset1:35
    v_mfma_f32_16x16x32_bf16 v[60:63], a[212:215], a[232:235], v[60:63]
    ds_read_b64_tr_b16 a[14:15], v13 offset:9216
    v_mfma_f32_16x16x32_bf16 v[60:63], a[208:211], a[236:239], v[60:63]
    ds_read_b128 v[124:127], v18 offset:30720
    v_mfma_f32_16x16x32_bf16 v[60:63], a[204:207], a[240:243], v[60:63]
    ds_read2_b32 v[92:93], v7 offset0:160 offset1:161
    v_mfma_f32_16x16x32_bf16 v[60:63], a[200:203], a[244:247], v[60:63]
    v_mfma_f32_16x16x32_bf16 v[60:63], a[196:199], a[248:251], v[60:63]
    ds_read2_b32 v[94:95], v7 offset0:162 offset1:163
    v_mfma_f32_16x16x32_bf16 v[60:63], a[192:195], a[252:255], v[60:63]
    s_waitcnt vmcnt(12) lgkmcnt(3)
    s_barrier
    v_mfma_f32_16x16x32_bf16 v[32:35], v[64:67], v[96:99], v[32:35]
    ds_read_b128 a[224:227], v19 offset:2048
    v_mfma_f32_16x16x32_bf16 v[36:39], v[68:71], v[96:99], v[36:39]
    s_add_u32 m0, s20, 114688
    v_mov_b32 v148, 0
    v_mfma_f32_16x16x32_bf16 v[36:39], v[64:67], v[100:103], v[36:39]
    s_lshl_b32 s14, s93, 1
    ds_read2_b32 a[192:193], v4 offset0:48 offset1:49
    v_mfma_f32_16x16x32_bf16 v[40:43], v[64:67], v[104:107], v[40:43]
    ds_read2_b32 a[194:195], v4 offset0:50 offset1:51
    v_mfma_f32_16x16x32_bf16 v[40:43], v[68:71], v[100:103], v[40:43]
    ds_read_b64_tr_b16 a[16:17], v12 offset:16384
    buffer_load_dwordx4 v8, s[52:55], s14 offen offset:0 lds
    v_mfma_f32_16x16x32_bf16 v[40:43], v[72:75], v[96:99], v[40:43]
    ds_read_b128 a[228:231], v19 offset:6144
    v_mov_b32 v149, 0
    v_mfma_f32_16x16x32_bf16 v[44:47], v[76:79], v[96:99], v[44:47]
    ds_read2_b32 a[196:197], v4 offset0:176 offset1:177
    v_mfma_f32_16x16x32_bf16 v[44:47], v[72:75], v[100:103], v[44:47]
    ds_read_b64_tr_b16 a[18:19], v12 offset:17408
    v_lshlrev_b32 v150, 3, v2
    v_mfma_f32_16x16x32_bf16 v[44:47], v[68:71], v[104:107], v[44:47]
    ds_read2_b32 a[198:199], v4 offset0:178 offset1:179
    buffer_load_dwordx4 v9, s[52:55], s14 offen offset:1024 lds
    v_mfma_f32_16x16x32_bf16 v[44:47], v[64:67], v[108:111], v[44:47]
    s_waitcnt lgkmcnt(8)
    ds_read_b128 a[232:235], v19 offset:10240
    v_mfma_f32_16x16x32_bf16 v[48:51], v[64:67], v[112:115], v[48:51]
    ds_read2_b32 a[200:201], v5 offset0:48 offset1:49
    v_add_u32 v150, 69664, v150
    v_mfma_f32_16x16x32_bf16 v[48:51], v[68:71], v[108:111], v[48:51]
    ds_read_b64_tr_b16 a[20:21], v13 offset:16384
    buffer_load_dwordx4 v10, s[52:55], s14 offen offset:2048 lds
    v_mfma_f32_16x16x32_bf16 v[48:51], v[72:75], v[104:107], v[48:51]
    ds_read2_b32 a[202:203], v5 offset0:50 offset1:51
    v_mfma_f32_16x16x32_bf16 v[48:51], v[76:79], v[100:103], v[48:51]
    ds_read_b128 a[236:239], v19 offset:14336
    v_mfma_f32_16x16x32_bf16 v[48:51], v[80:83], v[96:99], v[48:51]
    ds_read_b64_tr_b16 a[22:23], v13 offset:17408
    v_mfma_f32_16x16x32_bf16 v[52:55], v[84:87], v[96:99], v[52:55]
    ds_read2_b32 a[204:205], v5 offset0:176 offset1:177
    buffer_load_dwordx4 v11, s[52:55], s14 offen offset:3072 lds
    v_mfma_f32_16x16x32_bf16 v[52:55], v[80:83], v[100:103], v[52:55]
    ds_read2_b32 a[206:207], v5 offset0:178 offset1:179
    v_mfma_f32_16x16x32_bf16 v[52:55], v[76:79], v[104:107], v[52:55]
    ds_write_b64 v150, v[148:149]
    v_mfma_f32_16x16x32_bf16 v[52:55], v[72:75], v[108:111], v[52:55]
    ds_read_b128 a[240:243], v19 offset:18432
    v_bfe_u32 v150, v2, 3, 1
    v_mfma_f32_16x16x32_bf16 v[52:55], v[68:71], v[112:115], v[52:55]
    s_add_u32 m0, s10, 70176
    ds_read2_b32 a[208:209], v6 offset0:48 offset1:49
    v_mfma_f32_16x16x32_bf16 v[52:55], v[64:67], v[116:119], v[52:55]
    ds_read_b64_tr_b16 a[24:25], v12 offset:24576
    v_mul_u32_u24 v150, 8736, v150
    v_mfma_f32_16x16x32_bf16 v[56:59], v[64:67], v[120:123], v[56:59]
    ds_read2_b32 a[210:211], v6 offset0:50 offset1:51
    buffer_load_dwordx4 v147, s[44:47], s43 offen sc1 lds
    v_mfma_f32_16x16x32_bf16 v[56:59], v[68:71], v[116:119], v[56:59]
    ds_read_b128 a[244:247], v19 offset:22528
    v_mfma_f32_16x16x32_bf16 v[56:59], v[72:75], v[112:115], v[56:59]
    s_add_u32 m0, s10, 65568
    ds_read_b64_tr_b16 a[26:27], v12 offset:25600
    v_mfma_f32_16x16x32_bf16 v[56:59], v[76:79], v[108:111], v[56:59]
    ds_read2_b32 a[212:213], v6 offset0:176 offset1:177
    v_and_b32 v151, 7, v2
    v_mfma_f32_16x16x32_bf16 v[56:59], v[80:83], v[104:107], v[56:59]
    ds_read2_b32 a[214:215], v6 offset0:178 offset1:179
    buffer_load_dwordx4 v21, s[60:63], s18 offen lds
    v_mfma_f32_16x16x32_bf16 v[56:59], v[84:87], v[100:103], v[56:59]
    ds_read_b128 a[248:251], v19 offset:26624
    v_mfma_f32_16x16x32_bf16 v[56:59], v[88:91], v[96:99], v[56:59]
    ds_read_b64_tr_b16 a[28:29], v13 offset:24576
    v_lshl_add_u32 v150, v151, 2, v150
    v_mfma_f32_16x16x32_bf16 v[60:63], v[92:95], v[96:99], v[60:63]
    ds_read2_b32 a[216:217], v7 offset0:48 offset1:49
    v_mfma_f32_16x16x32_bf16 v[60:63], v[88:91], v[100:103], v[60:63]
    ds_read2_b32 a[218:219], v7 offset0:50 offset1:51
    v_mfma_f32_16x16x32_bf16 v[60:63], v[84:87], v[104:107], v[60:63]
    ds_read_b64_tr_b16 a[30:31], v13 offset:25600
    v_mfma_f32_16x16x32_bf16 v[60:63], v[80:83], v[108:111], v[60:63]
    ds_read_b128 a[252:255], v19 offset:30720
    v_add_u32 v150, 65536, v150
    v_mfma_f32_16x16x32_bf16 v[60:63], v[76:79], v[112:115], v[60:63]
    ds_read2_b32 a[220:221], v7 offset0:176 offset1:177
    v_mfma_f32_16x16x32_bf16 v[60:63], v[72:75], v[116:119], v[60:63]
    ds_write_b32 v150, v148
    v_mfma_f32_16x16x32_bf16 v[60:63], v[68:71], v[120:123], v[60:63]
    ds_read2_b32 a[222:223], v7 offset0:178 offset1:179
    v_mfma_f32_16x16x32_bf16 v[60:63], v[64:67], v[124:127], v[60:63]
    s_waitcnt lgkmcnt(4)
    s_barrier
    v_mfma_f32_16x16x32_bf16 v[32:35], a[192:195], a[224:227], v[32:35]
    ds_read_b128 v[96:99], v16 offset:0
    v_mfma_f32_16x16x32_bf16 v[36:39], a[196:199], a[224:227], v[36:39]
    s_add_u32 m0, s20, 131072
    s_add_u32 s8, s30, 0
    v_mfma_f32_16x16x32_bf16 v[36:39], a[192:195], a[228:231], v[36:39]
    s_lshl_b32 s14, s94, 1
    ds_read2_b32 v[64:65], v4 offset0:64 offset1:65
    v_mfma_f32_16x16x32_bf16 v[40:43], a[192:195], a[232:235], v[40:43]
    s_and_b32 s9, s8, 3
    ds_read2_b32 v[66:67], v4 offset0:66 offset1:67
    v_mfma_f32_16x16x32_bf16 v[40:43], a[196:199], a[228:231], v[40:43]
    buffer_load_dwordx4 v8, s[52:55], s14 offen offset:0 lds
    v_mfma_f32_16x16x32_bf16 v[40:43], a[200:203], a[224:227], v[40:43]
    ds_read_b128 v[100:103], v16 offset:4096
    v_mfma_f32_16x16x32_bf16 v[44:47], a[204:207], a[224:227], v[44:47]
    s_lshr_b32 s8, s8, 2
    ds_read2_b32 v[68:69], v4 offset0:192 offset1:193
    v_mfma_f32_16x16x32_bf16 v[44:47], a[200:203], a[228:231], v[44:47]
    v_mfma_f32_16x16x32_bf16 v[44:47], a[196:199], a[232:235], v[44:47]
    s_lshl_b32 s8, s8, 7
    ds_read2_b32 v[70:71], v4 offset0:194 offset1:195
    buffer_load_dwordx4 v9, s[52:55], s14 offen offset:1024 lds
    v_mfma_f32_16x16x32_bf16 v[44:47], a[192:195], a[236:239], v[44:47]
    s_waitcnt lgkmcnt(6)
    ds_read_b128 v[104:107], v16 offset:8192
    v_mfma_f32_16x16x32_bf16 v[48:51], a[192:195], a[240:243], v[48:51]
    ds_read2_b32 v[72:73], v5 offset0:64 offset1:65
    v_mfma_f32_16x16x32_bf16 v[48:51], a[196:199], a[236:239], v[48:51]
    s_lshl2_add_u32 s8, s9, s8
    buffer_load_dwordx4 v10, s[52:55], s14 offen offset:2048 lds
    v_mfma_f32_16x16x32_bf16 v[48:51], a[200:203], a[232:235], v[48:51]
    ds_read2_b32 v[74:75], v5 offset0:66 offset1:67
    v_mfma_f32_16x16x32_bf16 v[48:51], a[204:207], a[228:231], v[48:51]
    s_add_u32 s8, s8, 9023488
    ds_read_b128 v[108:111], v16 offset:12288
    v_mfma_f32_16x16x32_bf16 v[48:51], a[208:211], a[224:227], v[48:51]
    v_mfma_f32_16x16x32_bf16 v[52:55], a[212:215], a[224:227], v[52:55]
    ds_read2_b32 v[76:77], v5 offset0:192 offset1:193
    buffer_load_dwordx4 v11, s[52:55], s14 offen offset:3072 lds
    v_mfma_f32_16x16x32_bf16 v[52:55], a[208:211], a[228:231], v[52:55]
    s_waitcnt vmcnt(14)
    ds_read2_b32 v[78:79], v5 offset0:194 offset1:195
    v_mfma_f32_16x16x32_bf16 v[52:55], a[204:207], a[232:235], v[52:55]
    buffer_store_dword v24, v23, s[44:47], s8 offen sc1
    v_mfma_f32_16x16x32_bf16 v[52:55], a[200:203], a[236:239], v[52:55]
    ds_read_b128 v[112:115], v16 offset:16384
    v_mfma_f32_16x16x32_bf16 v[52:55], a[196:199], a[240:243], v[52:55]
    ds_read2_b32 v[80:81], v6 offset0:64 offset1:65
    v_mfma_f32_16x16x32_bf16 v[52:55], a[192:195], a[244:247], v[52:55]
    v_mfma_f32_16x16x32_bf16 v[56:59], a[192:195], a[248:251], v[56:59]
    ds_read2_b32 v[82:83], v6 offset0:66 offset1:67
    v_mfma_f32_16x16x32_bf16 v[56:59], a[196:199], a[244:247], v[56:59]
    ds_read_b128 v[116:119], v16 offset:20480
    v_mfma_f32_16x16x32_bf16 v[56:59], a[200:203], a[240:243], v[56:59]
    v_mfma_f32_16x16x32_bf16 v[56:59], a[204:207], a[236:239], v[56:59]
    ds_read2_b32 v[84:85], v6 offset0:192 offset1:193
    v_mfma_f32_16x16x32_bf16 v[56:59], a[208:211], a[232:235], v[56:59]
    ds_read2_b32 v[86:87], v6 offset0:194 offset1:195
    v_mfma_f32_16x16x32_bf16 v[56:59], a[212:215], a[228:231], v[56:59]
    ds_read_b128 v[120:123], v16 offset:24576
    v_mfma_f32_16x16x32_bf16 v[56:59], a[216:219], a[224:227], v[56:59]
    v_mfma_f32_16x16x32_bf16 v[60:63], a[220:223], a[224:227], v[60:63]
    ds_read2_b32 v[88:89], v7 offset0:64 offset1:65
    v_mfma_f32_16x16x32_bf16 v[60:63], a[216:219], a[228:231], v[60:63]
    ds_read2_b32 v[90:91], v7 offset0:66 offset1:67
    v_mfma_f32_16x16x32_bf16 v[60:63], a[212:215], a[232:235], v[60:63]
    v_mfma_f32_16x16x32_bf16 v[60:63], a[208:211], a[236:239], v[60:63]
    ds_read_b128 v[124:127], v16 offset:28672
    v_mfma_f32_16x16x32_bf16 v[60:63], a[204:207], a[240:243], v[60:63]
    ds_read2_b32 v[92:93], v7 offset0:192 offset1:193
    v_mfma_f32_16x16x32_bf16 v[60:63], a[200:203], a[244:247], v[60:63]
    v_mfma_f32_16x16x32_bf16 v[60:63], a[196:199], a[248:251], v[60:63]
    ds_read2_b32 v[94:95], v7 offset0:194 offset1:195
    v_mfma_f32_16x16x32_bf16 v[60:63], a[192:195], a[252:255], v[60:63]
    s_waitcnt vmcnt(11) lgkmcnt(12)
    s_barrier
    v_mfma_f32_16x16x32_bf16 v[32:35], v[64:67], v[96:99], v[32:35]
    ds_read_b128 a[224:227], v17 offset:0
    v_mfma_f32_16x16x32_bf16 v[36:39], v[68:71], v[96:99], v[36:39]
    v_mfma_f32_16x16x32_bf16 v[36:39], v[64:67], v[100:103], v[36:39]
    ds_read2_b32 a[192:193], v4 offset0:80 offset1:81
    v_mfma_f32_16x16x32_bf16 v[40:43], v[64:67], v[104:107], v[40:43]
    ds_read2_b32 a[194:195], v4 offset0:82 offset1:83
    v_mfma_f32_16x16x32_bf16 v[40:43], v[68:71], v[100:103], v[40:43]
    ds_read_b64_tr_b16 a[32:33], v12 offset:32768
    v_mfma_f32_16x16x32_bf16 v[40:43], v[72:75], v[96:99], v[40:43]
    ds_read_b128 a[228:231], v17 offset:4096
    v_mfma_f32_16x16x32_bf16 v[44:47], v[76:79], v[96:99], v[44:47]
    ds_read2_b32 a[196:197], v4 offset0:208 offset1:209
    v_mfma_f32_16x16x32_bf16 v[44:47], v[72:75], v[100:103], v[44:47]
    ds_read_b64_tr_b16 a[34:35], v12 offset:33792
    v_mfma_f32_16x16x32_bf16 v[44:47], v[68:71], v[104:107], v[44:47]
    ds_read2_b32 a[198:199], v4 offset0:210 offset1:211
    v_mfma_f32_16x16x32_bf16 v[44:47], v[64:67], v[108:111], v[44:47]
    s_waitcnt lgkmcnt(8)
    ds_read_b128 a[232:235], v17 offset:8192
    v_mfma_f32_16x16x32_bf16 v[48:51], v[64:67], v[112:115], v[48:51]
    ds_read2_b32 a[200:201], v5 offset0:80 offset1:81
    v_mfma_f32_16x16x32_bf16 v[48:51], v[68:71], v[108:111], v[48:51]
    ds_read_b64_tr_b16 a[36:37], v13 offset:32768
    v_mfma_f32_16x16x32_bf16 v[48:51], v[72:75], v[104:107], v[48:51]
    ds_read2_b32 a[202:203], v5 offset0:82 offset1:83
    v_mfma_f32_16x16x32_bf16 v[48:51], v[76:79], v[100:103], v[48:51]
    ds_read_b128 a[236:239], v17 offset:12288
    v_mfma_f32_16x16x32_bf16 v[48:51], v[80:83], v[96:99], v[48:51]
    ds_read_b64_tr_b16 a[38:39], v13 offset:33792
    v_mfma_f32_16x16x32_bf16 v[52:55], v[84:87], v[96:99], v[52:55]
    ds_read2_b32 a[204:205], v5 offset0:208 offset1:209
    v_mfma_f32_16x16x32_bf16 v[52:55], v[80:83], v[100:103], v[52:55]
    ds_read2_b32 a[206:207], v5 offset0:210 offset1:211
    v_mfma_f32_16x16x32_bf16 v[52:55], v[76:79], v[104:107], v[52:55]
    v_mfma_f32_16x16x32_bf16 v[52:55], v[72:75], v[108:111], v[52:55]
    ds_read_b128 a[240:243], v17 offset:16384
    v_mfma_f32_16x16x32_bf16 v[52:55], v[68:71], v[112:115], v[52:55]
    ds_read2_b32 a[208:209], v6 offset0:80 offset1:81
    v_mfma_f32_16x16x32_bf16 v[52:55], v[64:67], v[116:119], v[52:55]
    ds_read_b64_tr_b16 a[40:41], v12 offset:40960
    v_mfma_f32_16x16x32_bf16 v[56:59], v[64:67], v[120:123], v[56:59]
    ds_read2_b32 a[210:211], v6 offset0:82 offset1:83
    v_mfma_f32_16x16x32_bf16 v[56:59], v[68:71], v[116:119], v[56:59]
    ds_read_b128 a[244:247], v17 offset:20480
    v_mfma_f32_16x16x32_bf16 v[56:59], v[72:75], v[112:115], v[56:59]
    ds_read_b64_tr_b16 a[42:43], v12 offset:41984
    v_mfma_f32_16x16x32_bf16 v[56:59], v[76:79], v[108:111], v[56:59]
    ds_read2_b32 a[212:213], v6 offset0:208 offset1:209
    v_mfma_f32_16x16x32_bf16 v[56:59], v[80:83], v[104:107], v[56:59]
    ds_read2_b32 a[214:215], v6 offset0:210 offset1:211
    v_mfma_f32_16x16x32_bf16 v[56:59], v[84:87], v[100:103], v[56:59]
    ds_read_b128 a[248:251], v17 offset:24576
    v_mfma_f32_16x16x32_bf16 v[56:59], v[88:91], v[96:99], v[56:59]
    ds_read_b64_tr_b16 a[44:45], v13 offset:40960
    v_mfma_f32_16x16x32_bf16 v[60:63], v[92:95], v[96:99], v[60:63]
    ds_read2_b32 a[216:217], v7 offset0:80 offset1:81
    v_mfma_f32_16x16x32_bf16 v[60:63], v[88:91], v[100:103], v[60:63]
    ds_read2_b32 a[218:219], v7 offset0:82 offset1:83
    v_mfma_f32_16x16x32_bf16 v[60:63], v[84:87], v[104:107], v[60:63]
    ds_read_b64_tr_b16 a[46:47], v13 offset:41984
    v_mfma_f32_16x16x32_bf16 v[60:63], v[80:83], v[108:111], v[60:63]
    ds_read_b128 a[252:255], v17 offset:28672
    v_mfma_f32_16x16x32_bf16 v[60:63], v[76:79], v[112:115], v[60:63]
    ds_read2_b32 a[220:221], v7 offset0:208 offset1:209
    v_mfma_f32_16x16x32_bf16 v[60:63], v[72:75], v[116:119], v[60:63]
    v_mfma_f32_16x16x32_bf16 v[60:63], v[68:71], v[120:123], v[60:63]
    ds_read2_b32 a[222:223], v7 offset0:210 offset1:211
    v_mfma_f32_16x16x32_bf16 v[60:63], v[64:67], v[124:127], v[60:63]
    s_waitcnt vmcnt(5) lgkmcnt(3)
    s_barrier
    v_mfma_f32_16x16x32_bf16 v[32:35], a[192:195], a[224:227], v[32:35]
    ds_read_b128 v[96:99], v18 offset:0
    v_mfma_f32_16x16x32_bf16 v[36:39], a[196:199], a[224:227], v[36:39]
    s_add_u32 s18, s10, 65568
    v_mfma_f32_16x16x32_bf16 v[36:39], a[192:195], a[228:231], v[36:39]
    ds_read2_b32 v[64:65], v4 offset0:96 offset1:97
    v_mfma_f32_16x16x32_bf16 v[40:43], a[192:195], a[232:235], v[40:43]
    ds_read2_b32 v[66:67], v4 offset0:98 offset1:99
    v_add_u32 v128, s18, v21
    v_mfma_f32_16x16x32_bf16 v[40:43], a[196:199], a[228:231], v[40:43]
    ds_read_b64_tr_b16 a[48:49], v12 offset:0
    ds_read_b128 v[130:133], v128
    v_mfma_f32_16x16x32_bf16 v[40:43], a[200:203], a[224:227], v[40:43]
    ds_read_b128 v[100:103], v18 offset:4096
    v_mfma_f32_16x16x32_bf16 v[44:47], a[204:207], a[224:227], v[44:47]
    ds_read2_b32 v[68:69], v4 offset0:224 offset1:225
    ds_read_b32 v134, v128 offset:16
    v_mfma_f32_16x16x32_bf16 v[44:47], a[200:203], a[228:231], v[44:47]
    ds_read_b64_tr_b16 a[50:51], v12 offset:1024
    v_mfma_f32_16x16x32_bf16 v[44:47], a[196:199], a[232:235], v[44:47]
    ds_read2_b32 v[70:71], v4 offset0:226 offset1:227
    v_lshrrev_b32 v129, 30, v25
    v_mfma_f32_16x16x32_bf16 v[44:47], a[192:195], a[236:239], v[44:47]
    s_waitcnt lgkmcnt(10)
    ds_read_b128 v[104:107], v18 offset:8192
    v_mul_u32_u24 v129, 28, v129
    v_mfma_f32_16x16x32_bf16 v[48:51], a[192:195], a[240:243], v[48:51]
    ds_read2_b32 v[72:73], v5 offset0:96 offset1:97
    v_mfma_f32_16x16x32_bf16 v[48:51], a[196:199], a[236:239], v[48:51]
    ds_read_b64_tr_b16 a[52:53], v13 offset:0
    v_sub_u32 v129, 65568, v129
    v_mfma_f32_16x16x32_bf16 v[48:51], a[200:203], a[232:235], v[48:51]
    ds_read2_b32 v[74:75], v5 offset0:98 offset1:99
    v_mfma_f32_16x16x32_bf16 v[48:51], a[204:207], a[228:231], v[48:51]
    ds_read_b128 v[108:111], v18 offset:12288
    v_mfma_f32_16x16x32_bf16 v[48:51], a[208:211], a[224:227], v[48:51]
    ds_read_b64_tr_b16 a[54:55], v13 offset:1024
    v_lshlrev_b32 v30, 16, v30
    v_mfma_f32_16x16x32_bf16 v[52:55], a[212:215], a[224:227], v[52:55]
    s_waitcnt lgkmcnt(8)
    ds_read2_b32 v[76:77], v5 offset0:224 offset1:225
    v_mfma_f32_16x16x32_bf16 v[52:55], a[208:211], a[228:231], v[52:55]
    ds_read2_b32 v[78:79], v5 offset0:226 offset1:227
    v_mfma_f32_16x16x32_bf16 v[52:55], a[204:207], a[232:235], v[52:55]
    v_lshlrev_b32 v135, 16, v130
    v_mfma_f32_16x16x32_bf16 v[52:55], a[200:203], a[236:239], v[52:55]
    ds_read_b128 v[112:115], v18 offset:16384
    v_mfma_f32_16x16x32_bf16 v[52:55], a[196:199], a[240:243], v[52:55]
    ds_read2_b32 v[80:81], v6 offset0:96 offset1:97
    v_add_f32 v135, v135, v30
    v_mfma_f32_16x16x32_bf16 v[52:55], a[192:195], a[244:247], v[52:55]
    ds_read_b64_tr_b16 a[56:57], v12 offset:8192
    v_alignbit_b32 v130, v131, v130, 16
    v_mfma_f32_16x16x32_bf16 v[56:59], a[192:195], a[248:251], v[56:59]
    ds_read2_b32 v[82:83], v6 offset0:98 offset1:99
    v_mfma_f32_16x16x32_bf16 v[56:59], a[196:199], a[244:247], v[56:59]
    ds_read_b128 v[116:119], v18 offset:20480
    v_alignbit_b32 v131, v132, v131, 16
    v_mfma_f32_16x16x32_bf16 v[56:59], a[200:203], a[240:243], v[56:59]
    ds_read_b64_tr_b16 a[58:59], v12 offset:9216
    v_alignbit_b32 v132, v133, v132, 16
    v_mfma_f32_16x16x32_bf16 v[56:59], a[204:207], a[236:239], v[56:59]
    ds_read2_b32 v[84:85], v6 offset0:224 offset1:225
    v_mfma_f32_16x16x32_bf16 v[56:59], a[208:211], a[232:235], v[56:59]
    ds_read2_b32 v[86:87], v6 offset0:226 offset1:227
    v_alignbit_b32 v133, v134, v133, 16
    v_mfma_f32_16x16x32_bf16 v[56:59], a[212:215], a[228:231], v[56:59]
    ds_read_b128 v[120:123], v18 offset:24576
    v_cvt_pk_bf16_f32 v135, v135, v135
    v_mfma_f32_16x16x32_bf16 v[56:59], a[216:219], a[224:227], v[56:59]
    ds_read_b64_tr_b16 a[60:61], v13 offset:8192
    v_mfma_f32_16x16x32_bf16 v[60:63], a[220:223], a[224:227], v[60:63]
    ds_read2_b32 v[88:89], v7 offset0:96 offset1:97
    ds_write_b128 v128, v[130:133] offset:8736
    v_mfma_f32_16x16x32_bf16 v[60:63], a[216:219], a[228:231], v[60:63]
    ds_read2_b32 v[90:91], v7 offset0:98 offset1:99
    v_mfma_f32_16x16x32_bf16 v[60:63], a[212:215], a[232:235], v[60:63]
    ds_read_b64_tr_b16 a[62:63], v13 offset:9216
    v_cmp_eq_u32 vcc, 0, v25
    s_nop 1
    v_cndmask_b32 v135, 0, v135, vcc
    v_mfma_f32_16x16x32_bf16 v[60:63], a[208:211], a[236:239], v[60:63]
    ds_read_b128 v[124:127], v18 offset:28672
    ds_write_b16 v129, v135
    v_mfma_f32_16x16x32_bf16 v[60:63], a[204:207], a[240:243], v[60:63]
    ds_read2_b32 v[92:93], v7 offset0:224 offset1:225
    v_mfma_f32_16x16x32_bf16 v[60:63], a[200:203], a[244:247], v[60:63]
    ds_write_b16 v129, v135 offset:8734
    v_mfma_f32_16x16x32_bf16 v[60:63], a[196:199], a[248:251], v[60:63]
    ds_read2_b32 v[94:95], v7 offset0:226 offset1:227
    v_mfma_f32_16x16x32_bf16 v[60:63], a[192:195], a[252:255], v[60:63]
    s_waitcnt vmcnt(1) lgkmcnt(1)
    s_barrier
    v_mfma_f32_16x16x32_bf16 v[32:35], v[64:67], v[96:99], v[32:35]
    ds_read_b128 a[224:227], v19 offset:0
L_pl_X_5:
    s_cbranch_execz L_wret
    v_mov_b32 v1, s34
    v_mfma_f32_16x16x32_bf16 v[36:39], v[68:71], v[96:99], v[36:39]
    s_add_u32 s4, s19, 3
    ds_read_b128 a[228:231], v19 offset:4096
    v_add_u32 v31, s4, v0
    v_mfma_f32_16x16x32_bf16 v[36:39], v[64:67], v[100:103], v[36:39]
    ds_read_b64_tr_b16 a[64:65], v12 offset:16384
    v_cmp_eq_u32 vcc, 0, v0
    s_nop 1
    v_cndmask_b32 v1, v31, v1, vcc
    v_mfma_f32_16x16x32_bf16 v[40:43], v[64:67], v[104:107], v[40:43]
    ds_read_b128 a[232:235], v19 offset:8192
    v_and_b32 v31, 3, v1
    v_lshrrev_b32 v1, 2, v1
    v_mfma_f32_16x16x32_bf16 v[40:43], v[68:71], v[100:103], v[40:43]
    ds_read_b128 a[236:239], v19 offset:12288
    v_lshlrev_b32 v1, 7, v1
    v_lshl_add_u32 v1, v31, 2, v1
    v_mfma_f32_16x16x32_bf16 v[40:43], v[72:75], v[96:99], v[40:43]
    ds_read_b128 a[240:243], v19 offset:16384
    v_add_u32 v1, 9023488, v1
    v_mfma_f32_16x16x32_bf16 v[44:47], v[76:79], v[96:99], v[44:47]
    ds_read_b128 a[244:247], v19 offset:20480
    v_mov_b32 v31, 0x40000000
    v_mfma_f32_16x16x32_bf16 v[44:47], v[72:75], v[100:103], v[44:47]
    ds_read_b128 a[248:251], v19 offset:24576
    v_cmp_gt_u32 vcc, 5, v0
    s_nop 1
    v_cndmask_b32 v29, v31, v1, vcc
    v_mfma_f32_16x16x32_bf16 v[44:47], v[68:71], v[104:107], v[44:47]
    s_mul_i32 s4, s16, 0x9e3779b1
    ds_read_b64_tr_b16 a[66:67], v12 offset:17408
    s_lshr_b32 s5, s4, 15
    v_mfma_f32_16x16x32_bf16 v[44:47], v[64:67], v[108:111], v[44:47]
    s_waitcnt lgkmcnt(9)
    s_xor_b32 s4, s4, s5
    ds_read_b128 a[252:255], v19 offset:28672
    s_mul_i32 s4, s4, 0x85ebca77
    v_mfma_f32_16x16x32_bf16 v[48:51], v[64:67], v[112:115], v[48:51]
    s_lshr_b32 s5, s4, 13
    ds_read2_b32 a[192:193], v4 offset0:112 offset1:113
    s_xor_b32 s4, s4, s5
    v_mfma_f32_16x16x32_bf16 v[48:51], v[68:71], v[108:111], v[48:51]
    s_mov_b32 s33, 0x10001
    ds_read2_b32 a[194:195], v4 offset0:114 offset1:115
    v_and_b32 v1, 3, v2
    v_mfma_f32_16x16x32_bf16 v[48:51], v[72:75], v[104:107], v[48:51]
    ds_read2_b32 a[196:197], v4 offset0:240 offset1:241
    v_lshlrev_b32 v1, 3, v1
    v_mfma_f32_16x16x32_bf16 v[48:51], v[76:79], v[100:103], v[48:51]
    ds_read2_b32 a[198:199], v4 offset0:242 offset1:243
    v_lshrrev_b32 v1, v1, s4
    v_bfe_u32 v31, v1, 1, 1
    v_mfma_f32_16x16x32_bf16 v[48:51], v[80:83], v[96:99], v[48:51]
    ds_read_b64_tr_b16 a[68:69], v13 offset:16384
    v_bfe_u32 v253, v1, 0, 1
    v_lshl_or_b32 v253, v31, 16, v253
    v_mfma_f32_16x16x32_bf16 v[52:55], v[84:87], v[96:99], v[52:55]
    ds_read2_b32 a[200:201], v5 offset0:112 offset1:113
    v_bfe_u32 v31, v1, 3, 1
    v_mfma_f32_16x16x32_bf16 v[52:55], v[80:83], v[100:103], v[52:55]
    ds_read2_b32 a[202:203], v5 offset0:114 offset1:115
    v_bfe_u32 v255, v1, 2, 1
    v_lshl_or_b32 v255, v31, 16, v255
    v_mfma_f32_16x16x32_bf16 v[52:55], v[76:79], v[104:107], v[52:55]
    ds_read2_b32 a[204:205], v5 offset0:240 offset1:241
    v_bfe_u32 v31, v1, 5, 1
    v_mfma_f32_16x16x32_bf16 v[52:55], v[72:75], v[108:111], v[52:55]
    ds_read2_b32 a[206:207], v5 offset0:242 offset1:243
    v_bfe_u32 v23, v1, 4, 1
    v_lshl_or_b32 v23, v31, 16, v23
    v_mfma_f32_16x16x32_bf16 v[52:55], v[68:71], v[112:115], v[52:55]
    ds_read2_b32 a[208:209], v6 offset0:112 offset1:113
    v_bfe_u32 v31, v1, 7, 1
    v_mfma_f32_16x16x32_bf16 v[52:55], v[64:67], v[116:119], v[52:55]
    ds_read_b64_tr_b16 a[70:71], v13 offset:17408
    v_bfe_u32 v0, v1, 6, 1
    v_lshl_or_b32 v0, v31, 16, v0
    v_mfma_f32_16x16x32_bf16 v[56:59], v[64:67], v[120:123], v[56:59]
    ds_read2_b32 a[210:211], v6 offset0:114 offset1:115
    v_and_b32 v1, 15, v2
    v_lshrrev_b32 v31, 4, v2
    v_mfma_f32_16x16x32_bf16 v[56:59], v[68:71], v[116:119], v[56:59]
    ds_read2_b32 a[212:213], v6 offset0:240 offset1:241
    v_lshlrev_b32 v31, 2, v31
    v_mfma_f32_16x16x32_bf16 v[56:59], v[72:75], v[112:115], v[56:59]
    ds_read2_b32 a[214:215], v6 offset0:242 offset1:243
    v_sub_u32 v1, v1, v31
    v_and_b32 v31, 1, v1
    v_mfma_f32_16x16x32_bf16 v[56:59], v[76:79], v[108:111], v[56:59]
    ds_read2_b32 a[216:217], v7 offset0:112 offset1:113
    v_lshlrev_b32 v31, 4, v31
    v_mfma_f32_16x16x32_bf16 v[56:59], v[80:83], v[104:107], v[56:59]
    s_movk_i32 s4, 0x3f80
    ds_read2_b32 a[218:219], v7 offset0:114 offset1:115
    v_lshlrev_b32 v31, v31, s4
    v_ashrrev_i32 v1, 1, v1
    v_mfma_f32_16x16x32_bf16 v[56:59], v[84:87], v[100:103], v[56:59]
    ds_read_b64_tr_b16 a[72:73], v12 offset:24576
    v_cmp_eq_u32 vcc, 0, v1
    s_nop 1
    v_cndmask_b32 v148, 0, v31, vcc
    v_mfma_f32_16x16x32_bf16 v[56:59], v[88:91], v[96:99], v[56:59]
    ds_read2_b32 a[220:221], v7 offset0:240 offset1:241
    v_cmp_eq_u32 vcc, 1, v1
    s_nop 1
    v_cndmask_b32 v149, 0, v31, vcc
    v_mfma_f32_16x16x32_bf16 v[60:63], v[92:95], v[96:99], v[60:63]
    ds_read2_b32 a[222:223], v7 offset0:242 offset1:243
    v_mov_b32 v146, 0
    v_mfma_f32_16x16x32_bf16 v[60:63], v[88:91], v[100:103], v[60:63]
    ds_read_b64_tr_b16 a[74:75], v12 offset:25600
    v_mov_b32 v147, 0
    v_mfma_f32_16x16x32_bf16 v[60:63], v[84:87], v[104:107], v[60:63]
    ds_read_b64_tr_b16 a[76:77], v13 offset:24576
    v_mov_b32 v150, 0
    v_mfma_f32_16x16x32_bf16 v[60:63], v[80:83], v[108:111], v[60:63]
    ds_read_b64_tr_b16 a[78:79], v13 offset:25600
    v_mov_b32 v151, 0
    v_mfma_f32_16x16x32_bf16 v[60:63], v[76:79], v[112:115], v[60:63]
    v_and_b32 v1, 15, v2
    v_lshrrev_b32 v31, 4, v2
    v_mfma_f32_16x16x32_bf16 v[60:63], v[72:75], v[116:119], v[60:63]
    v_lshlrev_b32 v3, 1, v1
    v_sub_u32 v3, v3, v31
    v_mfma_f32_16x16x32_bf16 v[60:63], v[68:71], v[120:123], v[60:63]
    s_lshl_b32 s4, s3, 7
    s_sub_u32 s4, 70128, s4
    v_lshl_add_u32 v30, v3, 4, s4
    v_mfma_f32_16x16x32_bf16 v[60:63], v[64:67], v[124:127], v[60:63]
    s_waitcnt lgkmcnt(0)
    s_barrier
    v_mfma_f32_16x16x32_bf16 v[60:63], a[220:223], a[224:227], v[60:63]
    v_and_b32 v1, 15, v2
    v_mfma_f32_16x16x32_bf16 v[60:63], a[216:219], a[228:231], v[60:63]
    v_add_u32 v1, 1, v1
    v_mfma_f32_16x16x32_bf16 v[60:63], a[212:215], a[232:235], v[60:63]
    v_and_b32 v3, 1, v1
    v_mfma_f32_16x16x32_bf16 v[60:63], a[208:211], a[236:239], v[60:63]
    v_mul_u32_u24 v3, 8736, v3
    v_lshrrev_b32 v1, 1, v1
    v_mfma_f32_16x16x32_bf16 v[60:63], a[204:207], a[240:243], v[60:63]
    v_lshl_add_u32 v3, v1, 2, v3
    v_mfma_f32_16x16x32_bf16 v[60:63], a[200:203], a[244:247], v[60:63]
    v_lshrrev_b32 v1, 4, v2
    v_lshl_add_u32 v3, v1, 4, v3
    v_mfma_f32_16x16x32_bf16 v[60:63], a[196:199], a[248:251], v[60:63]
    s_lshl_b32 s4, s3, 7
    s_add_u32 s4, s4, 65536
    v_add_u32 v4, s4, v3
    v_mfma_f32_16x16x32_bf16 v[60:63], a[192:195], a[252:255], v[60:63]
    v_add_u32 v5, 1024, v4
    v_add_u32 v6, 1024, v5
    v_mfma_f32_16x16x32_bf16 v[56:59], a[192:195], a[248:251], v[56:59]
    v_add_u32 v7, 1024, v6
    v_add_u32 v16, 90112, v21
    v_mfma_f32_16x16x32_bf16 v[56:59], a[196:199], a[244:247], v[56:59]
    v_add_u32 v17, 126976, v21
    v_subrev_u32 v12, 114688, v12
    v_mfma_f32_16x16x32_bf16 v[56:59], a[200:203], a[240:243], v[56:59]
    v_subrev_u32 v13, 114688, v13
    ds_read_b128 a[128:131], v30 offset:64
    v_mfma_f32_16x16x32_bf16 v[56:59], a[204:207], a[236:239], v[56:59]
    ds_read_b128 a[132:135], v30 offset:576
    v_mfma_f32_16x16x32_bf16 v[56:59], a[208:211], a[232:235], v[56:59]
    ds_read_b128 a[136:139], v30 offset:1088
    v_mfma_f32_16x16x32_bf16 v[56:59], a[212:215], a[228:231], v[56:59]
    ds_read_b128 a[140:143], v30 offset:1600
    v_mfma_f32_16x16x32_bf16 v[56:59], a[216:219], a[224:227], v[56:59]
    ds_read_b128 a[144:147], v30 offset:2112
    v_mfma_f32_16x16x32_bf16 v[52:55], a[212:215], a[224:227], v[52:55]
    ds_read_b128 a[148:151], v30 offset:2624
    v_mfma_f32_16x16x32_bf16 v[52:55], a[208:211], a[228:231], v[52:55]
    ds_read_b128 a[152:155], v30 offset:3136
    v_mfma_f32_16x16x32_bf16 v[52:55], a[204:207], a[232:235], v[52:55]
    v_cvt_pk_bf16_f32 v142, v60, v61
    ds_read_b128 a[156:159], v30 offset:3648
    v_mfma_f32_16x16x32_bf16 v[52:55], a[200:203], a[236:239], v[52:55]
    ds_read2_b32 a[160:161], v4 offset0:0 offset1:1
    v_mfma_f32_16x16x32_bf16 v[52:55], a[196:199], a[240:243], v[52:55]
    v_cvt_pk_bf16_f32 v143, v62, v63
    ds_read2_b32 a[162:163], v4 offset0:2 offset1:3
    v_mfma_f32_16x16x32_bf16 v[52:55], a[192:195], a[244:247], v[52:55]
    ds_read2_b32 a[164:165], v4 offset0:128 offset1:129
    v_mfma_f32_16x16x32_bf16 v[48:51], a[192:195], a[240:243], v[48:51]
    buffer_store_dwordx2 v[142:143], v20, s[44:47], s15 offen offset:3584 sc1
    v_mfma_f32_16x16x32_bf16 v[48:51], a[196:199], a[236:239], v[48:51]
    ds_read2_b32 a[166:167], v4 offset0:130 offset1:131
    v_mfma_f32_16x16x32_bf16 v[48:51], a[200:203], a[232:235], v[48:51]
    v_cvt_pk_bf16_f32 v140, v56, v57
    ds_read2_b32 a[168:169], v5 offset0:0 offset1:1
    v_mfma_f32_16x16x32_bf16 v[48:51], a[204:207], a[228:231], v[48:51]
    ds_read2_b32 a[170:171], v5 offset0:2 offset1:3
    v_mfma_f32_16x16x32_bf16 v[48:51], a[208:211], a[224:227], v[48:51]
    v_cvt_pk_bf16_f32 v141, v58, v59
    ds_read2_b32 a[172:173], v5 offset0:128 offset1:129
    v_mfma_f32_16x16x32_bf16 v[44:47], a[204:207], a[224:227], v[44:47]
    ds_read2_b32 a[174:175], v5 offset0:130 offset1:131
    v_mfma_f32_16x16x32_bf16 v[44:47], a[200:203], a[228:231], v[44:47]
    buffer_store_dwordx2 v[140:141], v20, s[44:47], s15 offen offset:3072 sc1
    v_mfma_f32_16x16x32_bf16 v[44:47], a[196:199], a[232:235], v[44:47]
    ds_read2_b32 a[176:177], v6 offset0:0 offset1:1
    v_mfma_f32_16x16x32_bf16 v[44:47], a[192:195], a[236:239], v[44:47]
    ds_read2_b32 a[178:179], v6 offset0:2 offset1:3
    v_mfma_f32_16x16x32_bf16 v[40:43], a[192:195], a[232:235], v[40:43]
    v_cvt_pk_bf16_f32 v138, v52, v53
    ds_read2_b32 a[180:181], v6 offset0:128 offset1:129
    v_mfma_f32_16x16x32_bf16 v[40:43], a[196:199], a[228:231], v[40:43]
    ds_read2_b32 a[182:183], v6 offset0:130 offset1:131
    v_mfma_f32_16x16x32_bf16 v[40:43], a[200:203], a[224:227], v[40:43]
    v_cvt_pk_bf16_f32 v139, v54, v55
    ds_read2_b32 a[184:185], v7 offset0:0 offset1:1
    v_mfma_f32_16x16x32_bf16 v[36:39], a[196:199], a[224:227], v[36:39]
    ds_read2_b32 a[186:187], v7 offset0:2 offset1:3
    v_mfma_f32_16x16x32_bf16 v[36:39], a[192:195], a[228:231], v[36:39]
    buffer_store_dwordx2 v[138:139], v20, s[44:47], s15 offen offset:2560 sc1
    ds_read2_b32 a[188:189], v7 offset0:128 offset1:129
    v_mfma_f32_16x16x32_bf16 v[32:35], a[192:195], a[224:227], v[32:35]
    ds_read2_b32 a[190:191], v7 offset0:130 offset1:131
    v_cvt_pk_bf16_f32 v136, v48, v49
    v_cvt_pk_bf16_f32 v137, v50, v51
    buffer_store_dwordx2 v[136:137], v20, s[44:47], s15 offen offset:2048 sc1
    v_cvt_pk_bf16_f32 v134, v44, v45
    v_cvt_pk_bf16_f32 v135, v46, v47
    buffer_store_dwordx2 v[134:135], v20, s[44:47], s15 offen offset:1536 sc1
    v_cvt_pk_bf16_f32 v132, v40, v41
    v_cvt_pk_bf16_f32 v133, v42, v43
    buffer_store_dwordx2 v[132:133], v20, s[44:47], s15 offen offset:1024 sc1
    v_cvt_pk_bf16_f32 v130, v36, v37
    v_cvt_pk_bf16_f32 v131, v38, v39
    buffer_store_dwordx2 v[130:131], v20, s[44:47], s15 offen offset:512 sc1
    v_cvt_pk_bf16_f32 v128, v32, v33
    v_cvt_pk_bf16_f32 v129, v34, v35
    buffer_store_dwordx2 v[128:129], v20, s[44:47], s15 offen offset:0 sc1
    s_add_u32 m0, s20, 0
    s_lshl_b32 s14, s95, 1
    buffer_load_dwordx4 v8, s[52:55], s14 offen offset:0 lds
    buffer_load_dwordx4 v9, s[52:55], s14 offen offset:1024 lds
    buffer_load_dwordx4 v10, s[52:55], s14 offen offset:2048 lds
    buffer_load_dwordx4 v11, s[52:55], s14 offen offset:3072 lds
    s_waitcnt vmcnt(0)
    s_barrier
    ds_read_b64_tr_b16 a[80:81], v12 offset:0
    ds_read_b64_tr_b16 a[82:83], v12 offset:1024
    ds_read_b64_tr_b16 a[84:85], v13 offset:0
    ds_read_b64_tr_b16 a[86:87], v13 offset:1024
    ds_read_b64_tr_b16 a[88:89], v12 offset:8192
    ds_read_b64_tr_b16 a[90:91], v12 offset:9216
    ds_read_b64_tr_b16 a[92:93], v13 offset:8192
    ds_read_b64_tr_b16 a[94:95], v13 offset:9216
    s_waitcnt lgkmcnt(0)
    s_barrier
    s_add_u32 m0, s20, 16384
    s_lshl_b32 s14, s96, 1
    buffer_load_dwordx4 v8, s[52:55], s14 offen offset:0 lds
    buffer_load_dwordx4 v9, s[52:55], s14 offen offset:1024 lds
    buffer_load_dwordx4 v10, s[52:55], s14 offen offset:2048 lds
    buffer_load_dwordx4 v11, s[52:55], s14 offen offset:3072 lds
    s_add_u32 m0, s20, 32768
    s_lshl_b32 s14, s97, 1
    buffer_load_dwordx4 v8, s[52:55], s14 offen offset:0 lds
    buffer_load_dwordx4 v9, s[52:55], s14 offen offset:1024 lds
    buffer_load_dwordx4 v10, s[52:55], s14 offen offset:2048 lds
    buffer_load_dwordx4 v11, s[52:55], s14 offen offset:3072 lds
    s_add_u32 m0, s20, 49152
    s_lshl_b32 s14, s98, 1
    buffer_load_dwordx4 v8, s[52:55], s14 offen offset:0 lds
    buffer_load_dwordx4 v9, s[52:55], s14 offen offset:1024 lds
    buffer_load_dwordx4 v10, s[52:55], s14 offen offset:2048 lds
    buffer_load_dwordx4 v11, s[52:55], s14 offen offset:3072 lds
    s_mov_b32 s30, 0x40000000
    s_mov_b32 s32, 0x40000000
    s_mov_b32 s31, 0
    s_waitcnt lgkmcnt(0)
    s_branch L_D
L_end:
.section .rodata,"a"
.p2align 6
.amdhsa_kernel recurrent_scan__ssm_conv_h3__mixer_token_mlp__prompt_kernel
  .amdhsa_next_free_vgpr 512
  .amdhsa_next_free_sgpr 102
  .amdhsa_accum_offset 256
  .amdhsa_group_segment_fixed_size 0
  .amdhsa_kernarg_size 112
  .amdhsa_user_sgpr_count 2
  .amdhsa_user_sgpr_kernarg_segment_ptr 1
  .amdhsa_system_sgpr_workgroup_id_x 1
  .amdhsa_float_denorm_mode_32 3
.end_amdhsa_kernel
```
